```python
import torch

def _softmax(x, axis=-1):
    return torch.softmax(x, dim=axis)
def _gelu(x):
    return torch.nn.functional.gelu(x, approximate="tanh")
def _silu(x):
    return torch.nn.functional.silu(x)
def _sigmoid(x):
    return torch.sigmoid(x)
def _layernorm(x, axis=-1, eps=1e-5):
    m = x.mean(dim=axis, keepdim=True)
    v = x.var(dim=axis, keepdim=True, unbiased=False)
    return (x - m) / torch.sqrt(v + eps)
def _scatter_add(tgt, idx, src, axis=0):
    return tgt.clone().index_add_(axis, idx, src)
def _segment_sum(src, seg, n):
    out = torch.zeros((n,) + src.shape[1:], dtype=src.dtype)
    return out.index_add_(0, seg, src)
def _pad(x, pw):
    flat = tuple(v for pair in reversed(pw) for v in pair)
    return torch.nn.functional.pad(x, flat)

kernel_name = 'interleave_layers__sliding_local_dilated__dense_activation_gelu__prompt'

def setup_inputs():

    _w = (lambda a: (lambda t: t.to(torch.bfloat16) if t.is_floating_point() else t)(torch.as_tensor(a)))
    def _A_setup():
        B, S, D = 1, 2048, 1024
        return {
            "x": _w((lambda *s: torch.randn(*s, dtype=torch.bfloat16) * 0.05)(B, S, D)),
            "wqkv": _w((lambda *s: torch.randn(*s, dtype=torch.bfloat16) * 0.05)(D, 3 * D)),
            "wo": _w((lambda *s: torch.randn(*s, dtype=torch.bfloat16) * 0.05)(D, D)),
        }
    _A_in = _A_setup()

    def _B_setup():
        B, S, D, F = 1, 2048, 1024, 3584
        return {
            "x": _w((lambda *s: torch.randn(*s, dtype=torch.bfloat16) * 0.05)(B, S, D)),
            "w1": _w((lambda *s: torch.randn(*s, dtype=torch.bfloat16) * 1.6)(D, F) * (D ** -0.5)),
            "b1": _w((lambda *s: torch.randn(*s, dtype=torch.bfloat16) * 1.6)(F) * 0.01),
            "w2": _w((lambda *s: torch.randn(*s, dtype=torch.bfloat16) * 1.6)(F, D) * (F ** -0.5)),
            "b2": _w((lambda *s: torch.randn(*s, dtype=torch.bfloat16) * 1.6)(D) * 0.01),
        }
    _B_in = _B_setup()

    return {
        "A_x": _A_in["x"],
        "A_wqkv": _A_in["wqkv"],
        "A_wo": _A_in["wo"],
        "B_x": _B_in["x"],
        "B_w1": _B_in["w1"],
        "B_b1": _B_in["b1"],
        "B_w2": _B_in["w2"],
        "B_b2": _B_in["b2"],
    }

def reference(A_x, A_wqkv, A_wo, B_x, B_w1, B_b1, B_w2, B_b2):
    def _A_ref(x, wqkv, wo):
        B, S, D = x.shape
        H = 32; Dh = D // H
        W, dil = 8, 2
        qkv = (lambda x, *d: x.permute(*d))((x @ wqkv).reshape(B, S, 3, H, Dh), 2, 0, 3, 1, 4)
        q, k, v = qkv[0], qkv[1], qkv[2]
        scale = Dh ** -0.5
        pos = torch.arange(S)
        off = torch.arange(W) * dil
        idx = pos[:, None] - off[None, :]
        mask = idx >= 0
        idx_c = torch.where(mask, idx, 0).reshape(-1)
        kg = k[:, :, idx_c, :].reshape(B, H, S, W, Dh)
        vg = v[:, :, idx_c, :].reshape(B, H, S, W, Dh)
        logits = torch.einsum("bhsd,bhswd->bhsw", q, kg) * scale
        logits = torch.where(mask[None, None, :, :], logits, -1e9)
        attn = _softmax(logits, axis=-1)
        o = torch.einsum("bhsw,bhswd->bhsd", attn, vg)
        return (lambda x, *d: x.permute(*d))(o, 0, 2, 1, 3).reshape(B, S, D) @ wo

    def _B_ref(x, w1, b1, w2, b2):
        h = torch.einsum("bsd,df->bsf", x, w1) + b1
        h = _gelu(h)
        return torch.einsum("bsf,fd->bsd", h, w2) + b2

    x = A_x
    x = x + _A_ref(_layernorm(x, axis=-1), A_wqkv, A_wo)
    x = x + _B_ref(_layernorm(x, axis=-1), B_w1, B_b1, B_w2, B_b2)
    x = x + _A_ref(_layernorm(x, axis=-1), A_wqkv, A_wo)
    x = x + _B_ref(_layernorm(x, axis=-1), B_w1, B_b1, B_w2, B_b2)
    return x
```

```asm
; @launch kernel=mega_kernel grid=(256,1,1) block=(512,1,1) lds=156672
.amdgcn_target "amdgcn-amd-amdhsa--gfx950"
.text
.globl mega_kernel
.p2align 8
.type mega_kernel,@function
mega_kernel:
  s_cmp_ge_u32 s2, 256
  s_cbranch_scc1 L_end
  s_load_dwordx16 s[16:31], s[0:1], 0
  s_load_dwordx2 s[32:33], s[0:1], 64
  s_load_dwordx2 s[34:35], s[0:1], 80
  s_load_dwordx2 s[36:37], s[0:1], 72
  v_and_b32 v1, 63, v0
  v_lshrrev_b32 v2, 6, v0
  s_and_b32 s3, s2, 7
  s_lshr_b32 s4, s2, 3
  v_readfirstlane_b32 s81, v2
  s_and_b32 s5, s3, 1
  s_lshl_b32 s5, s5, 3
  s_and_b32 s6, s4, 7
  s_add_u32 s76, s5, s6
  s_lshr_b32 s5, s3, 1
  s_lshl_b32 s5, s5, 2
  s_lshr_b32 s6, s4, 3
  s_add_u32 s77, s5, s6
  s_and_b32 s80, s77, 7
  s_lshr_b32 s79, s77, 3
  s_lshl_b32 s78, s80, 1
  s_add_u32 s78, s78, s79
  s_lshl_b32 s5, s76, 4
  s_add_u32 s5, s5, s77
  s_lshl_b32 s84, s5, 11
  s_mov_b32 s82, 0
  s_mov_b32 s83, 3145728
  s_mov_b32 s87, 512
  s_mov_b32 s88, 0
  s_and_b32 s85, s81, 1
  s_lshr_b32 s86, s81, 1
  s_waitcnt lgkmcnt(0)
  s_mov_b32 s40, s34
  s_mov_b32 s41, s35
  s_and_b32 s41, s41, 0xffff
  s_mov_b32 s42, 100663296
  s_mov_b32 s43, 0x00020000
  s_mov_b32 s44, s16
  s_mov_b32 s45, s17
  s_and_b32 s45, s45, 0xffff
  s_mov_b32 s46, 4194304
  s_mov_b32 s47, 0x00020000
  s_mov_b32 s72, s16
  s_mov_b32 s73, s17
  s_and_b32 s73, s73, 0xffff
  s_mov_b32 s74, 4194304
  s_mov_b32 s75, 0x00020000
  s_mov_b32 s48, s18
  s_mov_b32 s49, s19
  s_and_b32 s49, s49, 0xffff
  s_mov_b32 s50, 6291456
  s_mov_b32 s51, 0x00020000
  s_mov_b32 s52, s20
  s_mov_b32 s53, s21
  s_and_b32 s53, s53, 0xffff
  s_mov_b32 s54, 2097152
  s_mov_b32 s55, 0x00020000
  s_mov_b32 s56, s24
  s_mov_b32 s57, s25
  s_and_b32 s57, s57, 0xffff
  s_mov_b32 s58, 7340032
  s_mov_b32 s59, 0x00020000
  s_mov_b32 s60, s28
  s_mov_b32 s61, s29
  s_and_b32 s61, s61, 0xffff
  s_mov_b32 s62, 7340032
  s_mov_b32 s63, 0x00020000
  s_mov_b32 s64, s32
  s_mov_b32 s65, s33
  s_and_b32 s65, s65, 0xffff
  s_mov_b32 s66, 4194304
  s_mov_b32 s67, 0x00020000
  s_mov_b32 s68, s36
  s_and_b32 s69, s37, 0xffff
  s_mov_b32 s70, 256
  s_mov_b32 s71, 0x00020000
  s_cmp_ge_u32 s81, 6
  s_cbranch_scc1 L_wload
  s_cmp_ge_u32 s81, 4
  s_cbranch_scc1 L_xload
  s_setprio 1
  v_lshlrev_b32 v11, 4, v1
  v_lshlrev_b32 v30, 3, v1
  v_mov_b32 v27, 1
  v_mov_b32 v28, 156416
  v_and_b32 v29, 48, v1
  s_cmp_lg_u32 s81, 0
  s_cbranch_scc1 L_1
  v_mov_b32 v32, 0
  v_mov_b32 v33, 0
  v_mov_b32 v34, 0
  v_mov_b32 v35, 0
  buffer_store_dwordx4 v[32:35], v11, s[40:43], s84 offen sc0 sc1
  buffer_store_dwordx4 v[32:35], v11, s[40:43], s84 offen offset:1024 sc0 sc1
L_1:
  v_and_b32 v2, 15, v1
  v_lshlrev_b32 v3, 12, v2
  v_and_b32 v2, 16, v1
  v_lshl_add_u32 v3, v2, 1, v3
  v_and_b32 v2, 32, v1
  v_lshrrev_b32 v2, 1, v2
  v_add_u32 v3, v2, v3
  s_lshl_b32 s5, s76, 18
  s_lshl_b32 s4, s85, 11
  s_add_u32 s5, s5, s4
  s_lshl_b32 s4, s78, 7
  s_add_u32 s5, s5, s4
  s_lshl_b32 s4, s86, 6
  s_add_u32 s5, s5, s4
  buffer_load_dwordx4 v[240:243], v3, s[44:47], s5 offen
  s_add_u32 s5, s5, 0x10000
  buffer_load_dwordx4 v[244:247], v3, s[44:47], s5 offen
  s_add_u32 s5, s5, 0x10000
  buffer_load_dwordx4 v[248:251], v3, s[44:47], s5 offen
  s_add_u32 s5, s5, 0x10000
  buffer_load_dwordx4 v[252:255], v3, s[44:47], s5 offen
  s_cmp_eq_u32 s81, 1
  s_cbranch_scc1 L_2
  s_cmp_eq_u32 s81, 2
  s_cbranch_scc1 L_3
  s_cmp_eq_u32 s81, 3
  s_cbranch_scc1 L_4
  s_waitcnt vmcnt(4)
  s_lshl_b32 s4, s76, 4
  v_mov_b32 v2, 0
  s_mov_b64 exec, 1
  buffer_atomic_add v27, v2, s[68:71], s4 offen sc1
  s_mov_b64 exec, -1
  s_branch L_5
L_2:
  s_mov_b32 s68, s26
  s_mov_b32 s69, s27
  s_and_b32 s69, s69, 0xffff
  s_mov_b32 s70, 7168
  s_mov_b32 s71, 0x00020000
  s_mul_i32 s4, s77, 448
  s_and_b32 s5, s77, 1
  s_lshl_b32 s6, s5, 6
  s_add_u32 s6, s6, s4
  s_mul_i32 s5, s5, 384
  s_sub_u32 s5, s4, s5
  v_lshlrev_b32 v2, 1, v1
  buffer_load_ushort v32, v2, s[68:71], s6 offen offset:0
  buffer_load_ushort v33, v2, s[68:71], s6 offen offset:128
  buffer_load_ushort v34, v2, s[68:71], s6 offen offset:256
  buffer_load_ushort v35, v2, s[68:71], s5 offen offset:384
  v_lshlrev_b32 v2, 2, v1
  v_add_u32 v2, 155136, v2
  s_waitcnt vmcnt(0)
  v_lshlrev_b32 v32, 16, v32
  ds_write_b32 v2, v32 offset:0
  v_lshlrev_b32 v33, 16, v33
  ds_write_b32 v2, v33 offset:256
  v_lshlrev_b32 v34, 16, v34
  ds_write_b32 v2, v34 offset:512
  v_lshlrev_b32 v35, 16, v35
  ds_write_b32 v2, v35 offset:768
  s_branch L_5
L_3:
  s_mov_b32 s68, s30
  s_mov_b32 s69, s31
  s_and_b32 s69, s69, 0xffff
  s_mov_b32 s70, 2048
  s_mov_b32 s71, 0x00020000
  s_lshl_b32 s4, s78, 7
  v_lshlrev_b32 v2, 1, v1
  buffer_load_ushort v32, v2, s[68:71], s4 offen
  v_lshlrev_b32 v2, 2, v1
  v_add_u32 v2, 156160, v2
  s_waitcnt vmcnt(0)
  v_lshlrev_b32 v32, 16, v32
  ds_write_b32 v2, v32
  s_branch L_5
L_4:
  v_mov_b32 v32, 0
  v_mov_b32 v33, 0
  v_mov_b32 v34, 0
  v_mov_b32 v35, 0
  v_add_u32 v2, 153088, v11
  ds_write_b128 v2, v[32:35]
  ds_write_b128 v2, v[32:35] offset:1024
  ds_write_b32 v28, v32
L_5:
  s_lshl_b32 s4, s76, 15
  s_lshl_b32 s5, s77, 2
  s_add_u32 s4, s4, s5
  v_lshlrev_b32 v24, 11, v1
  v_and_b32 v2, 16, v1
  v_lshl_add_u32 v24, v2, 2, v24
  v_add_u32 v24, s4, v24
  v_lshrrev_b32 v2, 2, v1
  v_lshlrev_b32 v25, 7, v2
  v_and_b32 v2, 3, v1
  v_lshl_add_u32 v25, v2, 3, v25
  v_add_u32 v25, 65536, v25
  v_bfe_u32 v26, v1, 3, 2
  v_and_b32 v2, 15, v1
  v_lshrrev_b32 v3, 2, v29
  v_sub_u32 v2, v2, v3
  s_mov_b32 s4, 0xf149f2ca
  v_mov_b32 v32, s4
  v_subrev_u32 v3, 0, v2
  v_cmp_gt_u32 vcc, 8, v3
  s_nop 1
  v_cndmask_b32_e64 v12, v32, 0, vcc
  v_cmp_ge_i32 vcc, -9, v3
  s_nop 1
  v_cndmask_b32_e64 v16, v32, 0, vcc
  v_mov_b32 v20, v16
  v_subrev_u32 v3, 1, v2
  v_cmp_gt_u32 vcc, 8, v3
  s_nop 1
  v_cndmask_b32_e64 v13, v32, 0, vcc
  v_cmp_ge_i32 vcc, -9, v3
  s_nop 1
  v_cndmask_b32_e64 v17, v32, 0, vcc
  v_mov_b32 v21, v17
  v_subrev_u32 v3, 2, v2
  v_cmp_gt_u32 vcc, 8, v3
  s_nop 1
  v_cndmask_b32_e64 v14, v32, 0, vcc
  v_cmp_ge_i32 vcc, -9, v3
  s_nop 1
  v_cndmask_b32_e64 v18, v32, 0, vcc
  v_mov_b32 v22, v18
  v_subrev_u32 v3, 3, v2
  v_cmp_gt_u32 vcc, 8, v3
  s_nop 1
  v_cndmask_b32_e64 v15, v32, 0, vcc
  v_cmp_ge_i32 vcc, -9, v3
  s_nop 1
  v_cndmask_b32_e64 v19, v32, 0, vcc
  v_mov_b32 v23, v19
  s_cmp_lg_u32 s76, 0
  s_cbranch_scc1 L_6
  v_mov_b32 v20, v32
  v_mov_b32 v21, v32
  v_mov_b32 v22, v32
  v_mov_b32 v23, v32
L_6:
  s_waitcnt lgkmcnt(0)
L_clayer:
  s_mov_b32 s16, 0
  s_mov_b32 s17, 20480
  s_mov_b32 s18, 0xffff6000
  s_mov_b32 s19, 0
  s_mov_b32 s20, 24576
  s_mov_b32 s21, 0xffff4000
  s_mul_i32 s4, s85, 10240
  v_add_u32 v4, s4, v11
  v_add_u32 v5, 1024, v4
  s_cmp_lg_u32 s82, 0
  s_cbranch_scc1 L_7
  v_and_b32 v2, 15, v1
  v_lshrrev_b32 v3, 1, v2
  v_lshrrev_b32 v32, 4, v1
  v_xor_b32 v3, v3, v32
  v_lshlrev_b32 v3, 4, v3
  v_lshl_add_u32 v3, v2, 7, v3
  v_add_u32 v4, s4, v3
  v_xor_b32 v3, 64, v3
  v_add_u32 v5, s4, v3
L_7:
  s_lshl_b32 s4, s86, 1
  v_xor_b32 v2, s4, v26
  v_lshl_add_u32 v6, v2, 5, v25
  s_add_u32 s4, s4, 1
  v_xor_b32 v2, s4, v26
  v_lshl_add_u32 v7, v2, 5, v25
  v_mov_b32 v128, 0
  v_mov_b32 v129, 0
  v_mov_b32 v130, 0
  v_mov_b32 v131, 0
  v_mov_b32 v132, 0
  v_mov_b32 v133, 0
  v_mov_b32 v134, 0
  v_mov_b32 v135, 0
  v_mov_b32 v136, 0
  v_mov_b32 v137, 0
  v_mov_b32 v138, 0
  v_mov_b32 v139, 0
  v_mov_b32 v140, 0
  v_mov_b32 v141, 0
  v_mov_b32 v142, 0
  v_mov_b32 v143, 0
  v_mov_b32 v144, 0
  v_mov_b32 v145, 0
  v_mov_b32 v146, 0
  v_mov_b32 v147, 0
  v_mov_b32 v148, 0
  v_mov_b32 v149, 0
  v_mov_b32 v150, 0
  v_mov_b32 v151, 0
  v_mov_b32 v152, 0
  v_mov_b32 v153, 0
  v_mov_b32 v154, 0
  v_mov_b32 v155, 0
  v_mov_b32 v156, 0
  v_mov_b32 v157, 0
  v_mov_b32 v158, 0
  v_mov_b32 v159, 0
  v_mov_b32 v160, 0
  v_mov_b32 v161, 0
  v_mov_b32 v162, 0
  v_mov_b32 v163, 0
  v_mov_b32 v164, 0
  v_mov_b32 v165, 0
  v_mov_b32 v166, 0
  v_mov_b32 v167, 0
  v_mov_b32 v168, 0
  v_mov_b32 v169, 0
  v_mov_b32 v170, 0
  v_mov_b32 v171, 0
  v_mov_b32 v172, 0
  v_mov_b32 v173, 0
  v_mov_b32 v174, 0
  v_mov_b32 v175, 0
  v_mov_b32 v176, 0
  v_mov_b32 v177, 0
  v_mov_b32 v178, 0
  v_mov_b32 v179, 0
  v_mov_b32 v180, 0
  v_mov_b32 v181, 0
  v_mov_b32 v182, 0
  v_mov_b32 v183, 0
  v_mov_b32 v184, 0
  v_mov_b32 v185, 0
  v_mov_b32 v186, 0
  v_mov_b32 v187, 0
  v_mov_b32 v188, 0
  v_mov_b32 v189, 0
  v_mov_b32 v190, 0
  v_mov_b32 v191, 0
  v_mov_b32 v192, 0
  v_mov_b32 v193, 0
  v_mov_b32 v194, 0
  v_mov_b32 v195, 0
  v_mov_b32 v196, 0
  v_mov_b32 v197, 0
  v_mov_b32 v198, 0
  v_mov_b32 v199, 0
  v_mov_b32 v200, 0
  v_mov_b32 v201, 0
  v_mov_b32 v202, 0
  v_mov_b32 v203, 0
  v_mov_b32 v204, 0
  v_mov_b32 v205, 0
  v_mov_b32 v206, 0
  v_mov_b32 v207, 0
  v_mov_b32 v208, 0
  v_mov_b32 v209, 0
  v_mov_b32 v210, 0
  v_mov_b32 v211, 0
  v_mov_b32 v212, 0
  v_mov_b32 v213, 0
  v_mov_b32 v214, 0
  v_mov_b32 v215, 0
  v_mov_b32 v216, 0
  v_mov_b32 v217, 0
  v_mov_b32 v218, 0
  v_mov_b32 v219, 0
  v_mov_b32 v220, 0
  v_mov_b32 v221, 0
  v_mov_b32 v222, 0
  v_mov_b32 v223, 0
  v_mov_b32 v224, 0
  v_mov_b32 v225, 0
  v_mov_b32 v226, 0
  v_mov_b32 v227, 0
  v_mov_b32 v228, 0
  v_mov_b32 v229, 0
  v_mov_b32 v230, 0
  v_mov_b32 v231, 0
  v_mov_b32 v232, 0
  v_mov_b32 v233, 0
  v_mov_b32 v234, 0
  v_mov_b32 v235, 0
  v_mov_b32 v236, 0
  v_mov_b32 v237, 0
  v_mov_b32 v238, 0
  v_mov_b32 v239, 0
  s_mov_b32 s22, 16
  s_barrier
  ds_read_b64_tr_b16 v[52:53], v6 offset:0
  ds_read_b64_tr_b16 v[54:55], v6 offset:2048
  ds_read_b128 v[32:35], v4 offset:0
  ds_read_b128 v[36:39], v4 offset:2048
  ds_read_b128 v[40:43], v4 offset:4096
  ds_read_b128 v[44:47], v4 offset:6144
  ds_read_b128 v[48:51], v4 offset:8192
  ds_read_b64_tr_b16 v[56:57], v7 offset:0
  ds_read_b64_tr_b16 v[58:59], v7 offset:2048
  ds_read_b64_tr_b16 v[60:61], v6 offset:8192
  ds_read_b64_tr_b16 v[62:63], v6 offset:10240
  ds_read_b64_tr_b16 v[64:65], v7 offset:8192
  ds_read_b64_tr_b16 v[66:67], v7 offset:10240
  ds_read_b64_tr_b16 v[68:69], v6 offset:16384
  ds_read_b64_tr_b16 v[70:71], v6 offset:18432
  ds_read_b64_tr_b16 v[72:73], v7 offset:16384
  ds_read_b64_tr_b16 v[74:75], v7 offset:18432
Lk_8:
  s_waitcnt lgkmcnt(0)
  v_mfma_f32_16x16x32_bf16 v[128:131], v[52:55], v[32:35], v[128:131]
  ds_read_b64_tr_b16 v[96:97], v6 offset:4096
  v_mfma_f32_16x16x32_bf16 v[136:139], v[52:55], v[36:39], v[136:139]
  ds_read_b64_tr_b16 v[98:99], v6 offset:6144
  v_mfma_f32_16x16x32_bf16 v[144:147], v[52:55], v[40:43], v[144:147]
  ds_read_b128 v[76:79], v5 offset:0
  v_mfma_f32_16x16x32_bf16 v[152:155], v[52:55], v[44:47], v[152:155]
  ds_read_b128 v[80:83], v5 offset:2048
  v_mfma_f32_16x16x32_bf16 v[132:135], v[56:59], v[32:35], v[132:135]
  ds_read_b128 v[84:87], v5 offset:4096
  v_mfma_f32_16x16x32_bf16 v[140:143], v[56:59], v[36:39], v[140:143]
  ds_read_b128 v[88:91], v5 offset:6144
  v_mfma_f32_16x16x32_bf16 v[148:151], v[56:59], v[40:43], v[148:151]
  ds_read_b128 v[92:95], v5 offset:8192
  v_mfma_f32_16x16x32_bf16 v[156:159], v[56:59], v[44:47], v[156:159]
  ds_read_b64_tr_b16 v[100:101], v7 offset:4096
  v_mfma_f32_16x16x32_bf16 v[160:163], v[60:63], v[32:35], v[160:163]
  ds_read_b64_tr_b16 v[102:103], v7 offset:6144
  v_mfma_f32_16x16x32_bf16 v[168:171], v[60:63], v[36:39], v[168:171]
  ds_read_b64_tr_b16 v[104:105], v6 offset:12288
  v_mfma_f32_16x16x32_bf16 v[176:179], v[60:63], v[40:43], v[176:179]
  ds_read_b64_tr_b16 v[106:107], v6 offset:14336
  v_mfma_f32_16x16x32_bf16 v[184:187], v[60:63], v[44:47], v[184:187]
  ds_read_b64_tr_b16 v[108:109], v7 offset:12288
  v_mfma_f32_16x16x32_bf16 v[192:195], v[60:63], v[48:51], v[192:195]
  ds_read_b64_tr_b16 v[110:111], v7 offset:14336
  v_mfma_f32_16x16x32_bf16 v[164:167], v[64:67], v[32:35], v[164:167]
  ds_read_b64_tr_b16 v[112:113], v6 offset:20480
  v_mfma_f32_16x16x32_bf16 v[172:175], v[64:67], v[36:39], v[172:175]
  ds_read_b64_tr_b16 v[114:115], v6 offset:22528
  v_mfma_f32_16x16x32_bf16 v[180:183], v[64:67], v[40:43], v[180:183]
  ds_read_b64_tr_b16 v[116:117], v7 offset:20480
  v_mfma_f32_16x16x32_bf16 v[188:191], v[64:67], v[44:47], v[188:191]
  ds_read_b64_tr_b16 v[118:119], v7 offset:22528
  v_mfma_f32_16x16x32_bf16 v[196:199], v[64:67], v[48:51], v[196:199]
  s_add_u32 s16, s16, s17
  s_cmp_eq_u32 s16, 61440
  s_cselect_b32 s23, s18, s17
  v_mfma_f32_16x16x32_bf16 v[200:203], v[32:35], v[68:71], v[200:203]
  s_cselect_b32 s16, 0, s16
  v_add_u32 v4, s23, v4
  v_add_u32 v5, s23, v5
  v_mfma_f32_16x16x32_bf16 v[208:211], v[36:39], v[68:71], v[208:211]
  s_add_u32 s19, s19, s20
  s_cmp_eq_u32 s19, 73728
  s_cselect_b32 s23, s21, s20
  v_mfma_f32_16x16x32_bf16 v[216:219], v[40:43], v[68:71], v[216:219]
  s_cselect_b32 s19, 0, s19
  v_add_u32 v6, s23, v6
  v_add_u32 v7, s23, v7
  v_mfma_f32_16x16x32_bf16 v[224:227], v[44:47], v[68:71], v[224:227]
  v_mfma_f32_16x16x32_bf16 v[232:235], v[48:51], v[68:71], v[232:235]
  v_mfma_f32_16x16x32_bf16 v[204:207], v[32:35], v[72:75], v[204:207]
  v_mfma_f32_16x16x32_bf16 v[212:215], v[36:39], v[72:75], v[212:215]
  v_mfma_f32_16x16x32_bf16 v[220:223], v[40:43], v[72:75], v[220:223]
  v_mfma_f32_16x16x32_bf16 v[228:231], v[44:47], v[72:75], v[228:231]
  v_mfma_f32_16x16x32_bf16 v[236:239], v[48:51], v[72:75], v[236:239]
  s_waitcnt lgkmcnt(0)
  s_barrier
  v_mfma_f32_16x16x32_bf16 v[128:131], v[96:99], v[76:79], v[128:131]
  ds_read_b64_tr_b16 v[52:53], v6 offset:0
  v_mfma_f32_16x16x32_bf16 v[136:139], v[96:99], v[80:83], v[136:139]
  ds_read_b64_tr_b16 v[54:55], v6 offset:2048
  v_mfma_f32_16x16x32_bf16 v[144:147], v[96:99], v[84:87], v[144:147]
  ds_read_b128 v[32:35], v4 offset:0
  v_mfma_f32_16x16x32_bf16 v[152:155], v[96:99], v[88:91], v[152:155]
  ds_read_b128 v[36:39], v4 offset:2048
  v_mfma_f32_16x16x32_bf16 v[132:135], v[100:103], v[76:79], v[132:135]
  ds_read_b128 v[40:43], v4 offset:4096
  v_mfma_f32_16x16x32_bf16 v[140:143], v[100:103], v[80:83], v[140:143]
  ds_read_b128 v[44:47], v4 offset:6144
  v_mfma_f32_16x16x32_bf16 v[148:151], v[100:103], v[84:87], v[148:151]
  ds_read_b128 v[48:51], v4 offset:8192
  v_mfma_f32_16x16x32_bf16 v[156:159], v[100:103], v[88:91], v[156:159]
  ds_read_b64_tr_b16 v[56:57], v7 offset:0
  v_mfma_f32_16x16x32_bf16 v[160:163], v[104:107], v[76:79], v[160:163]
  ds_read_b64_tr_b16 v[58:59], v7 offset:2048
  v_mfma_f32_16x16x32_bf16 v[168:171], v[104:107], v[80:83], v[168:171]
  ds_read_b64_tr_b16 v[60:61], v6 offset:8192
  v_mfma_f32_16x16x32_bf16 v[176:179], v[104:107], v[84:87], v[176:179]
  ds_read_b64_tr_b16 v[62:63], v6 offset:10240
  v_mfma_f32_16x16x32_bf16 v[184:187], v[104:107], v[88:91], v[184:187]
  ds_read_b64_tr_b16 v[64:65], v7 offset:8192
  v_mfma_f32_16x16x32_bf16 v[192:195], v[104:107], v[92:95], v[192:195]
  ds_read_b64_tr_b16 v[66:67], v7 offset:10240
  v_mfma_f32_16x16x32_bf16 v[164:167], v[108:111], v[76:79], v[164:167]
  ds_read_b64_tr_b16 v[68:69], v6 offset:16384
  v_mfma_f32_16x16x32_bf16 v[172:175], v[108:111], v[80:83], v[172:175]
  ds_read_b64_tr_b16 v[70:71], v6 offset:18432
  v_mfma_f32_16x16x32_bf16 v[180:183], v[108:111], v[84:87], v[180:183]
  ds_read_b64_tr_b16 v[72:73], v7 offset:16384
  v_mfma_f32_16x16x32_bf16 v[188:191], v[108:111], v[88:91], v[188:191]
  ds_read_b64_tr_b16 v[74:75], v7 offset:18432
  v_mfma_f32_16x16x32_bf16 v[196:199], v[108:111], v[92:95], v[196:199]
  s_sub_u32 s22, s22, 1
  v_mfma_f32_16x16x32_bf16 v[200:203], v[76:79], v[112:115], v[200:203]
  s_cmp_lg_u32 s22, 0
  v_mfma_f32_16x16x32_bf16 v[208:211], v[80:83], v[112:115], v[208:211]
  v_mfma_f32_16x16x32_bf16 v[216:219], v[84:87], v[112:115], v[216:219]
  v_mfma_f32_16x16x32_bf16 v[224:227], v[88:91], v[112:115], v[224:227]
  v_mfma_f32_16x16x32_bf16 v[232:235], v[92:95], v[112:115], v[232:235]
  v_mfma_f32_16x16x32_bf16 v[204:207], v[76:79], v[116:119], v[204:207]
  v_mfma_f32_16x16x32_bf16 v[212:215], v[80:83], v[116:119], v[212:215]
  v_mfma_f32_16x16x32_bf16 v[220:223], v[84:87], v[116:119], v[220:223]
  v_mfma_f32_16x16x32_bf16 v[228:231], v[88:91], v[116:119], v[228:231]
  v_mfma_f32_16x16x32_bf16 v[236:239], v[92:95], v[116:119], v[236:239]
  s_cbranch_scc1 Lk_8
  s_cmp_lg_u32 s82, 0
  s_cbranch_scc1 L_9
  s_waitcnt vmcnt(0)
  v_permlane16_swap_b32 v240, v242
  v_permlane16_swap_b32 v241, v243
  v_permlane16_swap_b32 v244, v246
  v_permlane16_swap_b32 v245, v247
  v_permlane16_swap_b32 v248, v250
  v_permlane16_swap_b32 v249, v251
  v_permlane16_swap_b32 v252, v254
  v_permlane16_swap_b32 v253, v255
L_9:
  s_waitcnt lgkmcnt(0)
  s_mul_i32 s4, s85, 320
  s_add_u32 s4, s4, 151552
  v_and_b32 v2, 15, v1
  v_lshl_add_u32 v3, v2, 2, s4
  ds_read2_b32 v[88:89], v3 offset0:0 offset1:160
  ds_read2_b32 v[90:91], v3 offset0:16 offset1:176
  ds_read2_b32 v[92:93], v3 offset0:32 offset1:192
  ds_read2_b32 v[94:95], v3 offset0:48 offset1:208
  ds_read2_b32 v[96:97], v3 offset0:64 offset1:224
  s_lshl_b32 s5, s86, 7
  s_add_u32 s5, s5, 153088
  v_add_u32 v3, s5, v29
  ds_read_b128 v[98:101], v3 offset:0
  ds_read_b128 v[102:105], v3 offset:64
  ds_read_b128 v[106:109], v3 offset:256
  ds_read_b128 v[110:113], v3 offset:320
  v_lshl_add_u32 v3, v2, 2, s5
  ds_read2_b32 v[114:115], v3 offset0:128 offset1:144
  v_add_u32 v124, s4, v29
  v_mov_b32 v120, 0x3f803f80
  v_mov_b32 v121, 0x3f803f80
  v_mov_b32 v122, 0x3f803f80
  v_mov_b32 v123, 0x3f803f80
  s_waitcnt lgkmcnt(0)
  v_pk_mul_f32 v[116:117], v[98:99], v[88:89] op_sel:[0,1] op_sel_hi:[1,1]
  v_pk_mul_f32 v[118:119], v[100:101], v[88:89] op_sel:[0,1] op_sel_hi:[1,1]
  v_pk_fma_f32 v[128:129], v[128:129], v[88:89], v[116:117] op_sel:[0,0,0] op_sel_hi:[1,0,1] neg_lo:[0,0,1] neg_hi:[0,0,1]
  v_pk_fma_f32 v[130:131], v[130:131], v[88:89], v[118:119] op_sel:[0,0,0] op_sel_hi:[1,0,1] neg_lo:[0,0,1] neg_hi:[0,0,1]
  v_cvt_pk_bf16_f32 v32, v128, v129
  v_cvt_pk_bf16_f32 v33, v130, v131
  v_pk_mul_f32 v[116:117], v[102:103], v[88:89] op_sel:[0,1] op_sel_hi:[1,1]
  v_pk_mul_f32 v[118:119], v[104:105], v[88:89] op_sel:[0,1] op_sel_hi:[1,1]
  v_pk_fma_f32 v[132:133], v[132:133], v[88:89], v[116:117] op_sel:[0,0,0] op_sel_hi:[1,0,1] neg_lo:[0,0,1] neg_hi:[0,0,1]
  v_pk_fma_f32 v[134:135], v[134:135], v[88:89], v[118:119] op_sel:[0,0,0] op_sel_hi:[1,0,1] neg_lo:[0,0,1] neg_hi:[0,0,1]
  v_cvt_pk_bf16_f32 v34, v132, v133
  v_cvt_pk_bf16_f32 v35, v134, v135
  v_pk_mul_f32 v[116:117], v[98:99], v[90:91] op_sel:[0,1] op_sel_hi:[1,1]
  v_pk_mul_f32 v[118:119], v[100:101], v[90:91] op_sel:[0,1] op_sel_hi:[1,1]
  v_pk_fma_f32 v[136:137], v[136:137], v[90:91], v[116:117] op_sel:[0,0,0] op_sel_hi:[1,0,1] neg_lo:[0,0,1] neg_hi:[0,0,1]
  v_pk_fma_f32 v[138:139], v[138:139], v[90:91], v[118:119] op_sel:[0,0,0] op_sel_hi:[1,0,1] neg_lo:[0,0,1] neg_hi:[0,0,1]
  v_cvt_pk_bf16_f32 v36, v136, v137
  v_cvt_pk_bf16_f32 v37, v138, v139
  v_pk_mul_f32 v[116:117], v[102:103], v[90:91] op_sel:[0,1] op_sel_hi:[1,1]
  v_pk_mul_f32 v[118:119], v[104:105], v[90:91] op_sel:[0,1] op_sel_hi:[1,1]
  v_pk_fma_f32 v[140:141], v[140:141], v[90:91], v[116:117] op_sel:[0,0,0] op_sel_hi:[1,0,1] neg_lo:[0,0,1] neg_hi:[0,0,1]
  v_pk_fma_f32 v[142:143], v[142:143], v[90:91], v[118:119] op_sel:[0,0,0] op_sel_hi:[1,0,1] neg_lo:[0,0,1] neg_hi:[0,0,1]
  v_cvt_pk_bf16_f32 v38, v140, v141
  v_cvt_pk_bf16_f32 v39, v142, v143
  v_pk_mul_f32 v[116:117], v[98:99], v[92:93] op_sel:[0,1] op_sel_hi:[1,1]
  v_pk_mul_f32 v[118:119], v[100:101], v[92:93] op_sel:[0,1] op_sel_hi:[1,1]
  v_pk_fma_f32 v[144:145], v[144:145], v[92:93], v[116:117] op_sel:[0,0,0] op_sel_hi:[1,0,1] neg_lo:[0,0,1] neg_hi:[0,0,1]
  v_pk_fma_f32 v[146:147], v[146:147], v[92:93], v[118:119] op_sel:[0,0,0] op_sel_hi:[1,0,1] neg_lo:[0,0,1] neg_hi:[0,0,1]
  v_cvt_pk_bf16_f32 v40, v144, v145
  v_cvt_pk_bf16_f32 v41, v146, v147
  v_pk_mul_f32 v[116:117], v[102:103], v[92:93] op_sel:[0,1] op_sel_hi:[1,1]
  v_pk_mul_f32 v[118:119], v[104:105], v[92:93] op_sel:[0,1] op_sel_hi:[1,1]
  v_pk_fma_f32 v[148:149], v[148:149], v[92:93], v[116:117] op_sel:[0,0,0] op_sel_hi:[1,0,1] neg_lo:[0,0,1] neg_hi:[0,0,1]
  v_pk_fma_f32 v[150:151], v[150:151], v[92:93], v[118:119] op_sel:[0,0,0] op_sel_hi:[1,0,1] neg_lo:[0,0,1] neg_hi:[0,0,1]
  v_cvt_pk_bf16_f32 v42, v148, v149
  v_cvt_pk_bf16_f32 v43, v150, v151
  v_pk_mul_f32 v[116:117], v[98:99], v[94:95] op_sel:[0,1] op_sel_hi:[1,1]
  v_pk_mul_f32 v[118:119], v[100:101], v[94:95] op_sel:[0,1] op_sel_hi:[1,1]
  v_pk_fma_f32 v[152:153], v[152:153], v[94:95], v[116:117] op_sel:[0,0,0] op_sel_hi:[1,0,1] neg_lo:[0,0,1] neg_hi:[0,0,1]
  v_pk_fma_f32 v[154:155], v[154:155], v[94:95], v[118:119] op_sel:[0,0,0] op_sel_hi:[1,0,1] neg_lo:[0,0,1] neg_hi:[0,0,1]
  v_cvt_pk_bf16_f32 v44, v152, v153
  v_cvt_pk_bf16_f32 v45, v154, v155
  v_pk_mul_f32 v[116:117], v[102:103], v[94:95] op_sel:[0,1] op_sel_hi:[1,1]
  v_pk_mul_f32 v[118:119], v[104:105], v[94:95] op_sel:[0,1] op_sel_hi:[1,1]
  v_pk_fma_f32 v[156:157], v[156:157], v[94:95], v[116:117] op_sel:[0,0,0] op_sel_hi:[1,0,1] neg_lo:[0,0,1] neg_hi:[0,0,1]
  v_pk_fma_f32 v[158:159], v[158:159], v[94:95], v[118:119] op_sel:[0,0,0] op_sel_hi:[1,0,1] neg_lo:[0,0,1] neg_hi:[0,0,1]
  v_cvt_pk_bf16_f32 v46, v156, v157
  v_cvt_pk_bf16_f32 v47, v158, v159
  ds_read_b128 v[128:131], v124 offset:0
  ds_read_b128 v[132:135], v124 offset:640
  ds_read_b128 v[136:139], v124 offset:64
  ds_read_b128 v[140:143], v124 offset:704
  ds_read_b128 v[144:147], v124 offset:128
  ds_read_b128 v[148:151], v124 offset:768
  ds_read_b128 v[152:155], v124 offset:192
  ds_read_b128 v[156:159], v124 offset:832
  ds_read_b128 v[98:101], v124 offset:256
  ds_read_b128 v[102:105], v124 offset:896
  v_pk_mul_f32 v[116:117], v[106:107], v[96:97] op_sel:[0,1] op_sel_hi:[1,1]
  v_pk_mul_f32 v[118:119], v[108:109], v[96:97] op_sel:[0,1] op_sel_hi:[1,1]
  v_pk_fma_f32 v[192:193], v[192:193], v[96:97], v[116:117] op_sel:[0,0,0] op_sel_hi:[1,0,1] neg_lo:[0,0,1] neg_hi:[0,0,1]
  v_pk_fma_f32 v[194:195], v[194:195], v[96:97], v[118:119] op_sel:[0,0,0] op_sel_hi:[1,0,1] neg_lo:[0,0,1] neg_hi:[0,0,1]
  v_cvt_pk_bf16_f32 v64, v192, v193
  v_cvt_pk_bf16_f32 v65, v194, v195
  v_pk_mul_f32 v[116:117], v[110:111], v[96:97] op_sel:[0,1] op_sel_hi:[1,1]
  v_pk_mul_f32 v[118:119], v[112:113], v[96:97] op_sel:[0,1] op_sel_hi:[1,1]
  v_pk_fma_f32 v[196:197], v[196:197], v[96:97], v[116:117] op_sel:[0,0,0] op_sel_hi:[1,0,1] neg_lo:[0,0,1] neg_hi:[0,0,1]
  v_pk_fma_f32 v[198:199], v[198:199], v[96:97], v[118:119] op_sel:[0,0,0] op_sel_hi:[1,0,1] neg_lo:[0,0,1] neg_hi:[0,0,1]
  v_cvt_pk_bf16_f32 v66, v196, v197
  v_cvt_pk_bf16_f32 v67, v198, v199
  v_pk_mul_f32 v[116:117], v[106:107], v[88:89] op_sel:[0,1] op_sel_hi:[1,1]
  v_pk_mul_f32 v[118:119], v[108:109], v[88:89] op_sel:[0,1] op_sel_hi:[1,1]
  v_pk_fma_f32 v[160:161], v[160:161], v[88:89], v[116:117] op_sel:[0,0,0] op_sel_hi:[1,0,1] neg_lo:[0,0,1] neg_hi:[0,0,1]
  v_pk_fma_f32 v[162:163], v[162:163], v[88:89], v[118:119] op_sel:[0,0,0] op_sel_hi:[1,0,1] neg_lo:[0,0,1] neg_hi:[0,0,1]
  v_cvt_pk_bf16_f32 v48, v160, v161
  v_cvt_pk_bf16_f32 v49, v162, v163
  v_pk_mul_f32 v[116:117], v[110:111], v[88:89] op_sel:[0,1] op_sel_hi:[1,1]
  v_pk_mul_f32 v[118:119], v[112:113], v[88:89] op_sel:[0,1] op_sel_hi:[1,1]
  v_pk_fma_f32 v[164:165], v[164:165], v[88:89], v[116:117] op_sel:[0,0,0] op_sel_hi:[1,0,1] neg_lo:[0,0,1] neg_hi:[0,0,1]
  v_pk_fma_f32 v[166:167], v[166:167], v[88:89], v[118:119] op_sel:[0,0,0] op_sel_hi:[1,0,1] neg_lo:[0,0,1] neg_hi:[0,0,1]
  v_cvt_pk_bf16_f32 v50, v164, v165
  v_cvt_pk_bf16_f32 v51, v166, v167
  v_pk_mul_f32 v[116:117], v[106:107], v[90:91] op_sel:[0,1] op_sel_hi:[1,1]
  v_pk_mul_f32 v[118:119], v[108:109], v[90:91] op_sel:[0,1] op_sel_hi:[1,1]
  v_pk_fma_f32 v[168:169], v[168:169], v[90:91], v[116:117] op_sel:[0,0,0] op_sel_hi:[1,0,1] neg_lo:[0,0,1] neg_hi:[0,0,1]
  v_pk_fma_f32 v[170:171], v[170:171], v[90:91], v[118:119] op_sel:[0,0,0] op_sel_hi:[1,0,1] neg_lo:[0,0,1] neg_hi:[0,0,1]
  v_cvt_pk_bf16_f32 v52, v168, v169
  v_cvt_pk_bf16_f32 v53, v170, v171
  v_pk_mul_f32 v[116:117], v[110:111], v[90:91] op_sel:[0,1] op_sel_hi:[1,1]
  v_pk_mul_f32 v[118:119], v[112:113], v[90:91] op_sel:[0,1] op_sel_hi:[1,1]
  v_pk_fma_f32 v[172:173], v[172:173], v[90:91], v[116:117] op_sel:[0,0,0] op_sel_hi:[1,0,1] neg_lo:[0,0,1] neg_hi:[0,0,1]
  v_pk_fma_f32 v[174:175], v[174:175], v[90:91], v[118:119] op_sel:[0,0,0] op_sel_hi:[1,0,1] neg_lo:[0,0,1] neg_hi:[0,0,1]
  v_cvt_pk_bf16_f32 v54, v172, v173
  v_cvt_pk_bf16_f32 v55, v174, v175
  v_pk_mul_f32 v[116:117], v[106:107], v[92:93] op_sel:[0,1] op_sel_hi:[1,1]
  v_pk_mul_f32 v[118:119], v[108:109], v[92:93] op_sel:[0,1] op_sel_hi:[1,1]
  v_pk_fma_f32 v[176:177], v[176:177], v[92:93], v[116:117] op_sel:[0,0,0] op_sel_hi:[1,0,1] neg_lo:[0,0,1] neg_hi:[0,0,1]
  v_pk_fma_f32 v[178:179], v[178:179], v[92:93], v[118:119] op_sel:[0,0,0] op_sel_hi:[1,0,1] neg_lo:[0,0,1] neg_hi:[0,0,1]
  v_cvt_pk_bf16_f32 v56, v176, v177
  v_cvt_pk_bf16_f32 v57, v178, v179
  v_pk_mul_f32 v[116:117], v[110:111], v[92:93] op_sel:[0,1] op_sel_hi:[1,1]
  v_pk_mul_f32 v[118:119], v[112:113], v[92:93] op_sel:[0,1] op_sel_hi:[1,1]
  v_pk_fma_f32 v[180:181], v[180:181], v[92:93], v[116:117] op_sel:[0,0,0] op_sel_hi:[1,0,1] neg_lo:[0,0,1] neg_hi:[0,0,1]
  v_pk_fma_f32 v[182:183], v[182:183], v[92:93], v[118:119] op_sel:[0,0,0] op_sel_hi:[1,0,1] neg_lo:[0,0,1] neg_hi:[0,0,1]
  v_cvt_pk_bf16_f32 v58, v180, v181
  v_cvt_pk_bf16_f32 v59, v182, v183
  v_pk_mul_f32 v[116:117], v[106:107], v[94:95] op_sel:[0,1] op_sel_hi:[1,1]
  v_pk_mul_f32 v[118:119], v[108:109], v[94:95] op_sel:[0,1] op_sel_hi:[1,1]
  v_pk_fma_f32 v[184:185], v[184:185], v[94:95], v[116:117] op_sel:[0,0,0] op_sel_hi:[1,0,1] neg_lo:[0,0,1] neg_hi:[0,0,1]
  v_pk_fma_f32 v[186:187], v[186:187], v[94:95], v[118:119] op_sel:[0,0,0] op_sel_hi:[1,0,1] neg_lo:[0,0,1] neg_hi:[0,0,1]
  v_cvt_pk_bf16_f32 v60, v184, v185
  v_cvt_pk_bf16_f32 v61, v186, v187
  v_pk_mul_f32 v[116:117], v[110:111], v[94:95] op_sel:[0,1] op_sel_hi:[1,1]
  v_pk_mul_f32 v[118:119], v[112:113], v[94:95] op_sel:[0,1] op_sel_hi:[1,1]
  v_pk_fma_f32 v[188:189], v[188:189], v[94:95], v[116:117] op_sel:[0,0,0] op_sel_hi:[1,0,1] neg_lo:[0,0,1] neg_hi:[0,0,1]
  v_pk_fma_f32 v[190:191], v[190:191], v[94:95], v[118:119] op_sel:[0,0,0] op_sel_hi:[1,0,1] neg_lo:[0,0,1] neg_hi:[0,0,1]
  v_cvt_pk_bf16_f32 v62, v188, v189
  v_cvt_pk_bf16_f32 v63, v190, v191
  v_mfma_f32_16x16x32_bf16 v[160:163], v[64:67], v[32:35], v[20:23]
  v_mfma_f32_16x16x32_bf16 v[164:167], v[48:51], v[32:35], v[12:15]
  v_mfma_f32_16x16x32_bf16 v[168:171], v[48:51], v[36:39], v[16:19]
  v_mfma_f32_16x16x32_bf16 v[172:175], v[52:55], v[36:39], v[12:15]
  v_mfma_f32_16x16x32_bf16 v[176:179], v[52:55], v[40:43], v[16:19]
  v_mfma_f32_16x16x32_bf16 v[180:183], v[56:59], v[40:43], v[12:15]
  v_mfma_f32_16x16x32_bf16 v[184:187], v[56:59], v[44:47], v[16:19]
  v_mfma_f32_16x16x32_bf16 v[188:191], v[60:63], v[44:47], v[12:15]
  s_waitcnt lgkmcnt(0)
  v_pk_mul_f32 v[116:117], v[132:133], v[114:115] op_sel:[0,0] op_sel_hi:[1,0]
  v_pk_mul_f32 v[118:119], v[134:135], v[114:115] op_sel:[0,0] op_sel_hi:[1,0]
  v_pk_fma_f32 v[200:201], v[200:201], v[128:129], v[116:117] neg_lo:[0,0,1] neg_hi:[0,0,1]
  v_pk_fma_f32 v[202:203], v[202:203], v[130:131], v[118:119] neg_lo:[0,0,1] neg_hi:[0,0,1]
  v_cvt_pk_bf16_f32 v70, v200, v201
  v_cvt_pk_bf16_f32 v71, v202, v203
  v_pk_mul_f32 v[116:117], v[132:133], v[114:115] op_sel:[0,1] op_sel_hi:[1,1]
  v_pk_mul_f32 v[118:119], v[134:135], v[114:115] op_sel:[0,1] op_sel_hi:[1,1]
  v_pk_fma_f32 v[204:205], v[204:205], v[128:129], v[116:117] neg_lo:[0,0,1] neg_hi:[0,0,1]
  v_pk_fma_f32 v[206:207], v[206:207], v[130:131], v[118:119] neg_lo:[0,0,1] neg_hi:[0,0,1]
  v_cvt_pk_bf16_f32 v80, v204, v205
  v_cvt_pk_bf16_f32 v81, v206, v207
  v_pk_mul_f32 v[116:117], v[140:141], v[114:115] op_sel:[0,0] op_sel_hi:[1,0]
  v_pk_mul_f32 v[118:119], v[142:143], v[114:115] op_sel:[0,0] op_sel_hi:[1,0]
  v_pk_fma_f32 v[208:209], v[208:209], v[136:137], v[116:117] neg_lo:[0,0,1] neg_hi:[0,0,1]
  v_pk_fma_f32 v[210:211], v[210:211], v[138:139], v[118:119] neg_lo:[0,0,1] neg_hi:[0,0,1]
  v_cvt_pk_bf16_f32 v72, v208, v209
  v_cvt_pk_bf16_f32 v73, v210, v211
  v_pk_mul_f32 v[116:117], v[140:141], v[114:115] op_sel:[0,1] op_sel_hi:[1,1]
  v_pk_mul_f32 v[118:119], v[142:143], v[114:115] op_sel:[0,1] op_sel_hi:[1,1]
  v_pk_fma_f32 v[212:213], v[212:213], v[136:137], v[116:117] neg_lo:[0,0,1] neg_hi:[0,0,1]
  v_pk_fma_f32 v[214:215], v[214:215], v[138:139], v[118:119] neg_lo:[0,0,1] neg_hi:[0,0,1]
  v_cvt_pk_bf16_f32 v82, v212, v213
  v_cvt_pk_bf16_f32 v83, v214, v215
  v_pk_mul_f32 v[116:117], v[148:149], v[114:115] op_sel:[0,0] op_sel_hi:[1,0]
  v_pk_mul_f32 v[118:119], v[150:151], v[114:115] op_sel:[0,0] op_sel_hi:[1,0]
  v_pk_fma_f32 v[216:217], v[216:217], v[144:145], v[116:117] neg_lo:[0,0,1] neg_hi:[0,0,1]
  v_pk_fma_f32 v[218:219], v[218:219], v[146:147], v[118:119] neg_lo:[0,0,1] neg_hi:[0,0,1]
  v_cvt_pk_bf16_f32 v74, v216, v217
  v_cvt_pk_bf16_f32 v75, v218, v219
  v_pk_mul_f32 v[116:117], v[148:149], v[114:115] op_sel:[0,1] op_sel_hi:[1,1]
  v_pk_mul_f32 v[118:119], v[150:151], v[114:115] op_sel:[0,1] op_sel_hi:[1,1]
  v_pk_fma_f32 v[220:221], v[220:221], v[144:145], v[116:117] neg_lo:[0,0,1] neg_hi:[0,0,1]
  v_pk_fma_f32 v[222:223], v[222:223], v[146:147], v[118:119] neg_lo:[0,0,1] neg_hi:[0,0,1]
  v_cvt_pk_bf16_f32 v84, v220, v221
  v_cvt_pk_bf16_f32 v85, v222, v223
  v_pk_mul_f32 v[116:117], v[156:157], v[114:115] op_sel:[0,0] op_sel_hi:[1,0]
  v_pk_mul_f32 v[118:119], v[158:159], v[114:115] op_sel:[0,0] op_sel_hi:[1,0]
  v_pk_fma_f32 v[224:225], v[224:225], v[152:153], v[116:117] neg_lo:[0,0,1] neg_hi:[0,0,1]
  v_pk_fma_f32 v[226:227], v[226:227], v[154:155], v[118:119] neg_lo:[0,0,1] neg_hi:[0,0,1]
  v_cvt_pk_bf16_f32 v76, v224, v225
  v_cvt_pk_bf16_f32 v77, v226, v227
  v_pk_mul_f32 v[116:117], v[156:157], v[114:115] op_sel:[0,1] op_sel_hi:[1,1]
  v_pk_mul_f32 v[118:119], v[158:159], v[114:115] op_sel:[0,1] op_sel_hi:[1,1]
  v_pk_fma_f32 v[228:229], v[228:229], v[152:153], v[116:117] neg_lo:[0,0,1] neg_hi:[0,0,1]
  v_pk_fma_f32 v[230:231], v[230:231], v[154:155], v[118:119] neg_lo:[0,0,1] neg_hi:[0,0,1]
  v_cvt_pk_bf16_f32 v86, v228, v229
  v_cvt_pk_bf16_f32 v87, v230, v231
  v_pk_mul_f32 v[116:117], v[102:103], v[114:115] op_sel:[0,0] op_sel_hi:[1,0]
  v_pk_mul_f32 v[118:119], v[104:105], v[114:115] op_sel:[0,0] op_sel_hi:[1,0]
  v_pk_fma_f32 v[232:233], v[232:233], v[98:99], v[116:117] neg_lo:[0,0,1] neg_hi:[0,0,1]
  v_pk_fma_f32 v[234:235], v[234:235], v[100:101], v[118:119] neg_lo:[0,0,1] neg_hi:[0,0,1]
  v_cvt_pk_bf16_f32 v68, v232, v233
  v_cvt_pk_bf16_f32 v69, v234, v235
  v_pk_mul_f32 v[116:117], v[102:103], v[114:115] op_sel:[0,1] op_sel_hi:[1,1]
  v_pk_mul_f32 v[118:119], v[104:105], v[114:115] op_sel:[0,1] op_sel_hi:[1,1]
  v_pk_fma_f32 v[236:237], v[236:237], v[98:99], v[116:117] neg_lo:[0,0,1] neg_hi:[0,0,1]
  v_pk_fma_f32 v[238:239], v[238:239], v[100:101], v[118:119] neg_lo:[0,0,1] neg_hi:[0,0,1]
  v_cvt_pk_bf16_f32 v78, v236, v237
  v_cvt_pk_bf16_f32 v79, v238, v239
  v_max3_f32 v88, v160, v161, v162
  v_max3_f32 v98, v163, v164, v165
  v_max3_f32 v90, v168, v169, v170
  v_max3_f32 v99, v171, v172, v173
  v_max3_f32 v92, v176, v177, v178
  v_max3_f32 v100, v179, v180, v181
  v_max3_f32 v94, v184, v185, v186
  v_max3_f32 v101, v187, v188, v189
  v_max3_f32 v88, v88, v166, v167
  v_max3_f32 v90, v90, v174, v175
  v_max3_f32 v92, v92, v182, v183
  v_max3_f32 v94, v94, v190, v191
  v_max_f32 v88, v88, v98
  v_max_f32 v90, v90, v99
  v_max_f32 v92, v92, v100
  v_max_f32 v94, v94, v101
  v_mov_b32 v98, v88
  v_mov_b32 v99, v90
  v_mov_b32 v100, v92
  v_mov_b32 v101, v94
  v_permlane32_swap_b32 v88, v98
  v_permlane32_swap_b32 v90, v99
  v_permlane32_swap_b32 v92, v100
  v_permlane32_swap_b32 v94, v101
  v_max_f32 v88, v88, v98
  v_max_f32 v90, v90, v99
  v_max_f32 v92, v92, v100
  v_max_f32 v94, v94, v101
  v_mov_b32 v98, v88
  v_mov_b32 v99, v90
  v_mov_b32 v100, v92
  v_mov_b32 v101, v94
  v_permlane16_swap_b32 v88, v98
  v_permlane16_swap_b32 v90, v99
  v_permlane16_swap_b32 v92, v100
  v_permlane16_swap_b32 v94, v101
  v_max_f32 v88, v88, v98
  v_max_f32 v90, v90, v99
  v_max_f32 v92, v92, v100
  v_max_f32 v94, v94, v101
  s_mov_b32 s4, 0x3e8293ee
  v_mul_f32 v88, s4, v88
  v_mov_b32 v89, s4
  v_mul_f32 v90, s4, v90
  v_mov_b32 v91, s4
  v_mul_f32 v92, s4, v92
  v_mov_b32 v93, s4
  v_mul_f32 v94, s4, v94
  v_mov_b32 v95, s4
  v_pk_fma_f32 v[160:161], v[160:161], v[88:89], v[88:89] op_sel:[0,1,0] op_sel_hi:[1,1,0] neg_lo:[0,0,1] neg_hi:[0,0,1]
  v_pk_fma_f32 v[162:163], v[162:163], v[88:89], v[88:89] op_sel:[0,1,0] op_sel_hi:[1,1,0] neg_lo:[0,0,1] neg_hi:[0,0,1]
  v_pk_fma_f32 v[164:165], v[164:165], v[88:89], v[88:89] op_sel:[0,1,0] op_sel_hi:[1,1,0] neg_lo:[0,0,1] neg_hi:[0,0,1]
  v_pk_fma_f32 v[166:167], v[166:167], v[88:89], v[88:89] op_sel:[0,1,0] op_sel_hi:[1,1,0] neg_lo:[0,0,1] neg_hi:[0,0,1]
  v_pk_fma_f32 v[168:169], v[168:169], v[90:91], v[90:91] op_sel:[0,1,0] op_sel_hi:[1,1,0] neg_lo:[0,0,1] neg_hi:[0,0,1]
  v_pk_fma_f32 v[170:171], v[170:171], v[90:91], v[90:91] op_sel:[0,1,0] op_sel_hi:[1,1,0] neg_lo:[0,0,1] neg_hi:[0,0,1]
  v_pk_fma_f32 v[172:173], v[172:173], v[90:91], v[90:91] op_sel:[0,1,0] op_sel_hi:[1,1,0] neg_lo:[0,0,1] neg_hi:[0,0,1]
  v_pk_fma_f32 v[174:175], v[174:175], v[90:91], v[90:91] op_sel:[0,1,0] op_sel_hi:[1,1,0] neg_lo:[0,0,1] neg_hi:[0,0,1]
  v_pk_fma_f32 v[176:177], v[176:177], v[92:93], v[92:93] op_sel:[0,1,0] op_sel_hi:[1,1,0] neg_lo:[0,0,1] neg_hi:[0,0,1]
  v_pk_fma_f32 v[178:179], v[178:179], v[92:93], v[92:93] op_sel:[0,1,0] op_sel_hi:[1,1,0] neg_lo:[0,0,1] neg_hi:[0,0,1]
  v_pk_fma_f32 v[180:181], v[180:181], v[92:93], v[92:93] op_sel:[0,1,0] op_sel_hi:[1,1,0] neg_lo:[0,0,1] neg_hi:[0,0,1]
  v_pk_fma_f32 v[182:183], v[182:183], v[92:93], v[92:93] op_sel:[0,1,0] op_sel_hi:[1,1,0] neg_lo:[0,0,1] neg_hi:[0,0,1]
  v_pk_fma_f32 v[184:185], v[184:185], v[94:95], v[94:95] op_sel:[0,1,0] op_sel_hi:[1,1,0] neg_lo:[0,0,1] neg_hi:[0,0,1]
  v_pk_fma_f32 v[186:187], v[186:187], v[94:95], v[94:95] op_sel:[0,1,0] op_sel_hi:[1,1,0] neg_lo:[0,0,1] neg_hi:[0,0,1]
  v_pk_fma_f32 v[188:189], v[188:189], v[94:95], v[94:95] op_sel:[0,1,0] op_sel_hi:[1,1,0] neg_lo:[0,0,1] neg_hi:[0,0,1]
  v_pk_fma_f32 v[190:191], v[190:191], v[94:95], v[94:95] op_sel:[0,1,0] op_sel_hi:[1,1,0] neg_lo:[0,0,1] neg_hi:[0,0,1]
  s_lshl_b32 s4, s76, 5
  s_lshl_b32 s5, s77, 1
  s_add_u32 s4, s4, s5
  s_add_u32 s4, s4, s86
  s_lshl_b32 s6, s4, 13
  s_lshl_b32 s7, s85, 12
  s_add_u32 s6, s6, s7
  s_add_u32 s6, s6, s83
  v_exp_f32 v160, v160
  v_exp_f32 v161, v161
  v_exp_f32 v162, v162
  v_exp_f32 v163, v163
  v_exp_f32 v164, v164
  v_exp_f32 v165, v165
  v_exp_f32 v166, v166
  v_exp_f32 v167, v167
  v_cvt_pk_bf16_f32 v32, v160, v161
  v_cvt_pk_bf16_f32 v33, v162, v163
  v_cvt_pk_bf16_f32 v34, v164, v165
  v_cvt_pk_bf16_f32 v35, v166, v167
  v_exp_f32 v168, v168
  v_exp_f32 v169, v169
  v_exp_f32 v170, v170
  v_exp_f32 v171, v171
  v_exp_f32 v172, v172
  v_exp_f32 v173, v173
  v_exp_f32 v174, v174
  v_exp_f32 v175, v175
  v_cvt_pk_bf16_f32 v36, v168, v169
  v_cvt_pk_bf16_f32 v37, v170, v171
  v_cvt_pk_bf16_f32 v38, v172, v173
  v_cvt_pk_bf16_f32 v39, v174, v175
  v_mfma_f32_16x16x32_bf16 v[128:131], v[120:123], v[32:35], 0
  v_mfma_f32_16x16x32_bf16 v[200:203], v[68:71], v[32:35], 0
  v_mfma_f32_16x16x32_bf16 v[204:207], v[78:81], v[32:35], 0
  v_exp_f32 v176, v176
  v_exp_f32 v177, v177
  v_exp_f32 v178, v178
  v_exp_f32 v179, v179
  v_exp_f32 v180, v180
  v_exp_f32 v181, v181
  v_exp_f32 v182, v182
  v_exp_f32 v183, v183
  v_cvt_pk_bf16_f32 v40, v176, v177
  v_cvt_pk_bf16_f32 v41, v178, v179
  v_cvt_pk_bf16_f32 v42, v180, v181
  v_cvt_pk_bf16_f32 v43, v182, v183
  v_mfma_f32_16x16x32_bf16 v[132:135], v[120:123], v[36:39], 0
  v_mfma_f32_16x16x32_bf16 v[208:211], v[70:73], v[36:39], 0
  v_mfma_f32_16x16x32_bf16 v[212:215], v[80:83], v[36:39], 0
  v_exp_f32 v184, v184
  v_exp_f32 v185, v185
  v_exp_f32 v186, v186
  v_exp_f32 v187, v187
  v_exp_f32 v188, v188
  v_exp_f32 v189, v189
  v_exp_f32 v190, v190
  v_exp_f32 v191, v191
  v_cvt_pk_bf16_f32 v44, v184, v185
  v_cvt_pk_bf16_f32 v45, v186, v187
  v_cvt_pk_bf16_f32 v46, v188, v189
  v_cvt_pk_bf16_f32 v47, v190, v191
  v_mfma_f32_16x16x32_bf16 v[136:139], v[120:123], v[40:43], 0
  v_mfma_f32_16x16x32_bf16 v[216:219], v[72:75], v[40:43], 0
  v_mfma_f32_16x16x32_bf16 v[220:223], v[82:85], v[40:43], 0
  v_mfma_f32_16x16x32_bf16 v[140:143], v[120:123], v[44:47], 0
  v_mfma_f32_16x16x32_bf16 v[224:227], v[74:77], v[44:47], 0
  v_mfma_f32_16x16x32_bf16 v[228:231], v[84:87], v[44:47], 0
  v_rcp_f32 v128, v128
  s_nop 0
  v_pk_mul_f32 v[200:201], v[200:201], v[128:129] op_sel_hi:[1,0]
  v_pk_mul_f32 v[202:203], v[202:203], v[128:129] op_sel_hi:[1,0]
  v_pk_mul_f32 v[204:205], v[204:205], v[128:129] op_sel_hi:[1,0]
  v_pk_mul_f32 v[206:207], v[206:207], v[128:129] op_sel_hi:[1,0]
  v_cvt_pk_bf16_f32 v48, v200, v201
  v_cvt_pk_bf16_f32 v49, v202, v203
  v_cvt_pk_bf16_f32 v50, v204, v205
  v_cvt_pk_bf16_f32 v51, v206, v207
  buffer_store_dwordx4 v[48:51], v11, s[40:43], s6 offen offset:0 sc0 sc1
  v_rcp_f32 v132, v132
  s_nop 0
  v_pk_mul_f32 v[208:209], v[208:209], v[132:133] op_sel_hi:[1,0]
  v_pk_mul_f32 v[210:211], v[210:211], v[132:133] op_sel_hi:[1,0]
  v_pk_mul_f32 v[212:213], v[212:213], v[132:133] op_sel_hi:[1,0]
  v_pk_mul_f32 v[214:215], v[214:215], v[132:133] op_sel_hi:[1,0]
  v_cvt_pk_bf16_f32 v52, v208, v209
  v_cvt_pk_bf16_f32 v53, v210, v211
  v_cvt_pk_bf16_f32 v54, v212, v213
  v_cvt_pk_bf16_f32 v55, v214, v215
  buffer_store_dwordx4 v[52:55], v11, s[40:43], s6 offen offset:1024 sc0 sc1
  v_rcp_f32 v136, v136
  s_nop 0
  v_pk_mul_f32 v[216:217], v[216:217], v[136:137] op_sel_hi:[1,0]
  v_pk_mul_f32 v[218:219], v[218:219], v[136:137] op_sel_hi:[1,0]
  v_pk_mul_f32 v[220:221], v[220:221], v[136:137] op_sel_hi:[1,0]
  v_pk_mul_f32 v[222:223], v[222:223], v[136:137] op_sel_hi:[1,0]
  v_cvt_pk_bf16_f32 v56, v216, v217
  v_cvt_pk_bf16_f32 v57, v218, v219
  v_cvt_pk_bf16_f32 v58, v220, v221
  v_cvt_pk_bf16_f32 v59, v222, v223
  buffer_store_dwordx4 v[56:59], v11, s[40:43], s6 offen offset:2048 sc0 sc1
  v_rcp_f32 v140, v140
  s_nop 0
  v_pk_mul_f32 v[224:225], v[224:225], v[140:141] op_sel_hi:[1,0]
  v_pk_mul_f32 v[226:227], v[226:227], v[140:141] op_sel_hi:[1,0]
  v_pk_mul_f32 v[228:229], v[228:229], v[140:141] op_sel_hi:[1,0]
  v_pk_mul_f32 v[230:231], v[230:231], v[140:141] op_sel_hi:[1,0]
  v_cvt_pk_bf16_f32 v60, v224, v225
  v_cvt_pk_bf16_f32 v61, v226, v227
  v_cvt_pk_bf16_f32 v62, v228, v229
  v_cvt_pk_bf16_f32 v63, v230, v231
  buffer_store_dwordx4 v[60:63], v11, s[40:43], s6 offen offset:3072 sc0 sc1
  s_add_u32 s5, s87, 0
  s_waitcnt vmcnt(0)
  s_mov_b64 exec, 1
  ds_add_rtn_u32 v2, v28, v27
  s_waitcnt lgkmcnt(0)
  v_readfirstlane_b32 s4, v2
  s_and_b32 s4, s4, 3
  s_cmp_lg_u32 s4, 3
  s_cbranch_scc1 Ls_10
  s_mov_b32 exec_lo, 0xffff
  buffer_store_dword v27, v24, s[40:43], s5 offen sc0 sc1
Ls_10:
  s_mov_b64 exec, -1
  s_mov_b32 s16, 0
  s_mov_b32 s17, 16384
  s_mov_b32 s18, 0xffff4000
  s_mov_b32 s19, 0
  s_mov_b32 s20, 8192
  s_mov_b32 s21, 0xfffee000
  s_mul_i32 s4, s85, 8192
  v_add_u32 v4, s4, v11
  v_add_u32 v5, 1024, v4
  s_lshl_b32 s4, s86, 1
  v_xor_b32 v2, s4, v26
  v_lshl_add_u32 v6, v2, 5, v25
  s_add_u32 s4, s4, 1
  v_xor_b32 v2, s4, v26
  v_lshl_add_u32 v7, v2, 5, v25
  s_mov_b32 s4, 0xffff0000
  v_lshlrev_b32 v128, 16, v240
  v_and_b32 v129, s4, v240
  v_lshlrev_b32 v130, 16, v241
  v_and_b32 v131, s4, v241
  v_lshlrev_b32 v132, 16, v242
  v_and_b32 v133, s4, v242
  v_lshlrev_b32 v134, 16, v243
  v_and_b32 v135, s4, v243
  v_lshlrev_b32 v136, 16, v244
  v_and_b32 v137, s4, v244
  v_lshlrev_b32 v138, 16, v245
  v_and_b32 v139, s4, v245
  v_lshlrev_b32 v140, 16, v246
  v_and_b32 v141, s4, v246
  v_lshlrev_b32 v142, 16, v247
  v_and_b32 v143, s4, v247
  v_lshlrev_b32 v144, 16, v248
  v_and_b32 v145, s4, v248
  v_lshlrev_b32 v146, 16, v249
  v_and_b32 v147, s4, v249
  v_lshlrev_b32 v148, 16, v250
  v_and_b32 v149, s4, v250
  v_lshlrev_b32 v150, 16, v251
  v_and_b32 v151, s4, v251
  v_lshlrev_b32 v152, 16, v252
  v_and_b32 v153, s4, v252
  v_lshlrev_b32 v154, 16, v253
  v_and_b32 v155, s4, v253
  v_lshlrev_b32 v156, 16, v254
  v_and_b32 v157, s4, v254
  v_lshlrev_b32 v158, 16, v255
  v_and_b32 v159, s4, v255
  s_mov_b32 s22, 16
  s_barrier
  ds_read_b64_tr_b16 v[48:49], v6 offset:0
  ds_read_b64_tr_b16 v[50:51], v6 offset:2048
  ds_read_b128 v[32:35], v4 offset:0
  ds_read_b128 v[36:39], v4 offset:2048
  ds_read_b128 v[40:43], v4 offset:4096
  ds_read_b128 v[44:47], v4 offset:6144
  ds_read_b64_tr_b16 v[52:53], v7 offset:0
  ds_read_b64_tr_b16 v[54:55], v7 offset:2048
Lk_11:
  s_waitcnt lgkmcnt(0)
  v_mfma_f32_16x16x32_bf16 v[128:131], v[48:51], v[32:35], v[128:131]
  ds_read_b64_tr_b16 v[92:93], v6 offset:4096
  ds_read_b64_tr_b16 v[94:95], v6 offset:6144
  v_mfma_f32_16x16x32_bf16 v[136:139], v[48:51], v[36:39], v[136:139]
  ds_read_b128 v[76:79], v5 offset:0
  ds_read_b128 v[80:83], v5 offset:2048
  v_mfma_f32_16x16x32_bf16 v[144:147], v[48:51], v[40:43], v[144:147]
  ds_read_b128 v[84:87], v5 offset:4096
  ds_read_b128 v[88:91], v5 offset:6144
  v_mfma_f32_16x16x32_bf16 v[152:155], v[48:51], v[44:47], v[152:155]
  ds_read_b64_tr_b16 v[96:97], v7 offset:4096
  ds_read_b64_tr_b16 v[98:99], v7 offset:6144
  v_mfma_f32_16x16x32_bf16 v[132:135], v[52:55], v[32:35], v[132:135]
  s_add_u32 s16, s16, s17
  s_cmp_eq_u32 s16, 65536
  s_cselect_b32 s23, s18, s17
  v_mfma_f32_16x16x32_bf16 v[140:143], v[52:55], v[36:39], v[140:143]
  s_cselect_b32 s16, 0, s16
  v_add_u32 v4, s23, v4
  v_add_u32 v5, s23, v5
  v_mfma_f32_16x16x32_bf16 v[148:151], v[52:55], v[40:43], v[148:151]
  s_add_u32 s19, s19, s20
  s_cmp_eq_u32 s19, 81920
  s_cselect_b32 s23, s21, s20
  v_mfma_f32_16x16x32_bf16 v[156:159], v[52:55], v[44:47], v[156:159]
  s_cselect_b32 s19, 0, s19
  v_add_u32 v6, s23, v6
  v_add_u32 v7, s23, v7
  s_waitcnt lgkmcnt(0)
  s_barrier
  v_mfma_f32_16x16x32_bf16 v[128:131], v[92:95], v[76:79], v[128:131]
  ds_read_b64_tr_b16 v[48:49], v6 offset:0
  ds_read_b64_tr_b16 v[50:51], v6 offset:2048
  v_mfma_f32_16x16x32_bf16 v[136:139], v[92:95], v[80:83], v[136:139]
  ds_read_b128 v[32:35], v4 offset:0
  ds_read_b128 v[36:39], v4 offset:2048
  v_mfma_f32_16x16x32_bf16 v[144:147], v[92:95], v[84:87], v[144:147]
  ds_read_b128 v[40:43], v4 offset:4096
  ds_read_b128 v[44:47], v4 offset:6144
  v_mfma_f32_16x16x32_bf16 v[152:155], v[92:95], v[88:91], v[152:155]
  ds_read_b64_tr_b16 v[52:53], v7 offset:0
  ds_read_b64_tr_b16 v[54:55], v7 offset:2048
  v_mfma_f32_16x16x32_bf16 v[132:135], v[96:99], v[76:79], v[132:135]
  s_sub_u32 s22, s22, 1
  s_cmp_lg_u32 s22, 0
  v_mfma_f32_16x16x32_bf16 v[140:143], v[96:99], v[80:83], v[140:143]
  v_mfma_f32_16x16x32_bf16 v[148:151], v[96:99], v[84:87], v[148:151]
  v_mfma_f32_16x16x32_bf16 v[156:159], v[96:99], v[88:91], v[156:159]
  s_cbranch_scc1 Lk_11
  s_waitcnt lgkmcnt(0)
  v_cvt_pk_bf16_f32 v240, v128, v129
  v_cvt_pk_bf16_f32 v241, v130, v131
  v_cvt_pk_bf16_f32 v242, v132, v133
  v_cvt_pk_bf16_f32 v243, v134, v135
  v_cvt_pk_bf16_f32 v244, v136, v137
  v_cvt_pk_bf16_f32 v245, v138, v139
  v_cvt_pk_bf16_f32 v246, v140, v141
  v_cvt_pk_bf16_f32 v247, v142, v143
  v_cvt_pk_bf16_f32 v248, v144, v145
  v_cvt_pk_bf16_f32 v249, v146, v147
  v_cvt_pk_bf16_f32 v250, v148, v149
  v_cvt_pk_bf16_f32 v251, v150, v151
  v_cvt_pk_bf16_f32 v252, v152, v153
  v_cvt_pk_bf16_f32 v253, v154, v155
  v_cvt_pk_bf16_f32 v254, v156, v157
  v_cvt_pk_bf16_f32 v255, v158, v159
  s_lshl_b32 s4, s76, 5
  s_lshl_b32 s5, s78, 1
  s_add_u32 s4, s4, s5
  s_add_u32 s4, s4, s86
  s_lshl_b32 s6, s4, 13
  s_lshl_b32 s7, s85, 12
  s_add_u32 s6, s6, s7
  s_add_u32 s6, s6, s83
  s_add_u32 s6, s6, 4194304
  buffer_store_dwordx4 v[240:243], v11, s[40:43], s6 offen offset:0 sc0 sc1
  buffer_store_dwordx4 v[244:247], v11, s[40:43], s6 offen offset:1024 sc0 sc1
  buffer_store_dwordx4 v[248:251], v11, s[40:43], s6 offen offset:2048 sc0 sc1
  buffer_store_dwordx4 v[252:255], v11, s[40:43], s6 offen offset:3072 sc0 sc1
  v_mov_b32 v40, 0x3f803f80
  v_dot2_f32_bf16 v32, v240, v40, 0
  v_dot2_f32_bf16 v36, v240, v240, 0
  v_dot2_f32_bf16 v33, v244, v40, 0
  v_dot2_f32_bf16 v37, v244, v244, 0
  v_dot2_f32_bf16 v34, v248, v40, 0
  v_dot2_f32_bf16 v38, v248, v248, 0
  v_dot2_f32_bf16 v35, v252, v40, 0
  v_dot2_f32_bf16 v39, v252, v252, 0
  v_dot2_f32_bf16 v32, v241, v40, v32
  v_dot2_f32_bf16 v36, v241, v241, v36
  v_dot2_f32_bf16 v33, v245, v40, v33
  v_dot2_f32_bf16 v37, v245, v245, v37
  v_dot2_f32_bf16 v34, v249, v40, v34
  v_dot2_f32_bf16 v38, v249, v249, v38
  v_dot2_f32_bf16 v35, v253, v40, v35
  v_dot2_f32_bf16 v39, v253, v253, v39
  v_dot2_f32_bf16 v32, v242, v40, v32
  v_dot2_f32_bf16 v36, v242, v242, v36
  v_dot2_f32_bf16 v33, v246, v40, v33
  v_dot2_f32_bf16 v37, v246, v246, v37
  v_dot2_f32_bf16 v34, v250, v40, v34
  v_dot2_f32_bf16 v38, v250, v250, v38
  v_dot2_f32_bf16 v35, v254, v40, v35
  v_dot2_f32_bf16 v39, v254, v254, v39
  v_dot2_f32_bf16 v32, v243, v40, v32
  v_dot2_f32_bf16 v36, v243, v243, v36
  v_dot2_f32_bf16 v33, v247, v40, v33
  v_dot2_f32_bf16 v37, v247, v247, v37
  v_dot2_f32_bf16 v34, v251, v40, v34
  v_dot2_f32_bf16 v38, v251, v251, v38
  v_dot2_f32_bf16 v35, v255, v40, v35
  v_dot2_f32_bf16 v39, v255, v255, v39
  s_lshl_b32 s6, s76, 6
  s_lshl_b32 s7, s85, 5
  s_add_u32 s6, s6, s7
  s_add_u32 s6, s6, s5
  s_add_u32 s6, s6, s86
  s_lshl_b32 s6, s6, 9
  s_add_u32 s6, s6, s83
  s_add_u32 s6, s6, 31457280
  v_permlane32_swap_b32 v32, v34
  v_permlane32_swap_b32 v33, v35
  v_permlane32_swap_b32 v36, v38
  v_permlane32_swap_b32 v37, v39
  v_add_f32 v32, v32, v34
  v_add_f32 v33, v33, v35
  v_add_f32 v36, v36, v38
  v_add_f32 v37, v37, v39
  v_permlane16_swap_b32 v32, v33
  s_nop 0
  v_permlane16_swap_b32 v36, v37
  v_add_f32 v42, v32, v33
  v_add_f32 v43, v36, v37
  buffer_store_dwordx2 v[42:43], v30, s[40:43], s6 offen sc0 sc1
  s_add_u32 s5, s87, 128
  s_waitcnt vmcnt(0)
  s_mov_b64 exec, 1
  ds_add_rtn_u32 v2, v28, v27
  s_waitcnt lgkmcnt(0)
  v_readfirstlane_b32 s4, v2
  s_and_b32 s4, s4, 3
  s_cmp_lg_u32 s4, 3
  s_cbranch_scc1 Ls_12
  s_mov_b32 exec_lo, 0xffff
  buffer_store_dword v27, v24, s[40:43], s5 offen sc0 sc1
Ls_12:
  s_mov_b64 exec, -1
  s_mov_b32 s16, 0
  s_mov_b32 s17, 16384
  s_mov_b32 s18, 0xffff4000
  s_mov_b32 s19, 0
  s_mov_b32 s20, 28672
  s_mov_b32 s21, 0xffff2000
  s_mul_i32 s4, s85, 8192
  v_add_u32 v4, s4, v11
  v_add_u32 v5, 1024, v4
  s_mul_i32 s4, s86, 6
  s_add_u32 s4, s4, 0
  s_lshr_b32 s5, s4, 2
  s_lshl_b32 s5, s5, 13
  s_and_b32 s4, s4, 3
  v_xor_b32 v2, s4, v26
  v_lshl_add_u32 v6, v2, 5, v25
  v_add_u32 v6, s5, v6
  s_mul_i32 s4, s86, 6
  s_add_u32 s4, s4, 1
  s_lshr_b32 s5, s4, 2
  s_lshl_b32 s5, s5, 13
  s_and_b32 s4, s4, 3
  v_xor_b32 v2, s4, v26
  v_lshl_add_u32 v7, v2, 5, v25
  v_add_u32 v7, s5, v7
  s_mul_i32 s4, s86, 6
  s_add_u32 s4, s4, 2
  s_lshr_b32 s5, s4, 2
  s_lshl_b32 s5, s5, 13
  s_and_b32 s4, s4, 3
  v_xor_b32 v2, s4, v26
  v_lshl_add_u32 v8, v2, 5, v25
  v_add_u32 v8, s5, v8
  s_mul_i32 s4, s86, 6
  s_add_u32 s4, s4, 3
  s_lshr_b32 s5, s4, 2
  s_lshl_b32 s5, s5, 13
  s_and_b32 s4, s4, 3
  v_xor_b32 v2, s4, v26
  v_lshl_add_u32 v9, v2, 5, v25
  v_add_u32 v9, s5, v9
  v_lshrrev_b32 v2, 2, v1
  v_lshlrev_b32 v3, 6, v2
  v_and_b32 v2, 3, v1
  v_lshl_add_u32 v3, v2, 3, v3
  v_bfe_u32 v2, v1, 4, 1
  v_xor_b32 v2, s86, v2
  v_lshl_add_u32 v3, v2, 5, v3
  v_add_u32 v10, 90112, v3
  v_mov_b32 v128, 0
  v_mov_b32 v129, 0
  v_mov_b32 v130, 0
  v_mov_b32 v131, 0
  v_mov_b32 v132, 0
  v_mov_b32 v133, 0
  v_mov_b32 v134, 0
  v_mov_b32 v135, 0
  v_mov_b32 v136, 0
  v_mov_b32 v137, 0
  v_mov_b32 v138, 0
  v_mov_b32 v139, 0
  v_mov_b32 v140, 0
  v_mov_b32 v141, 0
  v_mov_b32 v142, 0
  v_mov_b32 v143, 0
  v_mov_b32 v144, 0
  v_mov_b32 v145, 0
  v_mov_b32 v146, 0
  v_mov_b32 v147, 0
  v_mov_b32 v148, 0
  v_mov_b32 v149, 0
  v_mov_b32 v150, 0
  v_mov_b32 v151, 0
  v_mov_b32 v152, 0
  v_mov_b32 v153, 0
  v_mov_b32 v154, 0
  v_mov_b32 v155, 0
  v_mov_b32 v156, 0
  v_mov_b32 v157, 0
  v_mov_b32 v158, 0
  v_mov_b32 v159, 0
  v_mov_b32 v160, 0
  v_mov_b32 v161, 0
  v_mov_b32 v162, 0
  v_mov_b32 v163, 0
  v_mov_b32 v164, 0
  v_mov_b32 v165, 0
  v_mov_b32 v166, 0
  v_mov_b32 v167, 0
  v_mov_b32 v168, 0
  v_mov_b32 v169, 0
  v_mov_b32 v170, 0
  v_mov_b32 v171, 0
  v_mov_b32 v172, 0
  v_mov_b32 v173, 0
  v_mov_b32 v174, 0
  v_mov_b32 v175, 0
  v_mov_b32 v176, 0
  v_mov_b32 v177, 0
  v_mov_b32 v178, 0
  v_mov_b32 v179, 0
  v_mov_b32 v180, 0
  v_mov_b32 v181, 0
  v_mov_b32 v182, 0
  v_mov_b32 v183, 0
  v_mov_b32 v184, 0
  v_mov_b32 v185, 0
  v_mov_b32 v186, 0
  v_mov_b32 v187, 0
  v_mov_b32 v188, 0
  v_mov_b32 v189, 0
  v_mov_b32 v190, 0
  v_mov_b32 v191, 0
  v_mov_b32 v192, 0
  v_mov_b32 v193, 0
  v_mov_b32 v194, 0
  v_mov_b32 v195, 0
  v_mov_b32 v196, 0
  v_mov_b32 v197, 0
  v_mov_b32 v198, 0
  v_mov_b32 v199, 0
  v_mov_b32 v200, 0
  v_mov_b32 v201, 0
  v_mov_b32 v202, 0
  v_mov_b32 v203, 0
  v_mov_b32 v204, 0
  v_mov_b32 v205, 0
  v_mov_b32 v206, 0
  v_mov_b32 v207, 0
  v_mov_b32 v208, 0
  v_mov_b32 v209, 0
  v_mov_b32 v210, 0
  v_mov_b32 v211, 0
  v_mov_b32 v212, 0
  v_mov_b32 v213, 0
  v_mov_b32 v214, 0
  v_mov_b32 v215, 0
  v_mov_b32 v216, 0
  v_mov_b32 v217, 0
  v_mov_b32 v218, 0
  v_mov_b32 v219, 0
  v_mov_b32 v220, 0
  v_mov_b32 v221, 0
  v_mov_b32 v222, 0
  v_mov_b32 v223, 0
  v_mov_b32 v224, 0
  v_mov_b32 v225, 0
  v_mov_b32 v226, 0
  v_mov_b32 v227, 0
  v_mov_b32 v228, 0
  v_mov_b32 v229, 0
  v_mov_b32 v230, 0
  v_mov_b32 v231, 0
  v_mov_b32 v232, 0
  v_mov_b32 v233, 0
  v_mov_b32 v234, 0
  v_mov_b32 v235, 0
  v_mov_b32 v236, 0
  v_mov_b32 v237, 0
  v_mov_b32 v238, 0
  v_mov_b32 v239, 0
  s_mov_b32 s22, 16
  s_barrier
  ds_read_b64_tr_b16 v[48:49], v6 offset:0
  ds_read_b64_tr_b16 v[50:51], v6 offset:2048
  ds_read_b128 v[32:35], v4 offset:0
  ds_read_b128 v[36:39], v4 offset:2048
  ds_read_b128 v[40:43], v4 offset:4096
  ds_read_b128 v[44:47], v4 offset:6144
  ds_read_b64_tr_b16 v[52:53], v7 offset:0
  ds_read_b64_tr_b16 v[54:55], v7 offset:2048
  ds_read_b64_tr_b16 v[56:57], v8 offset:0
  ds_read_b64_tr_b16 v[58:59], v8 offset:2048
  ds_read_b64_tr_b16 v[60:61], v9 offset:0
  ds_read_b64_tr_b16 v[62:63], v9 offset:2048
  ds_read_b64_tr_b16 v[64:65], v6 offset:8192
  ds_read_b64_tr_b16 v[66:67], v6 offset:10240
  ds_read_b64_tr_b16 v[68:69], v7 offset:8192
  ds_read_b64_tr_b16 v[70:71], v7 offset:10240
  ds_read_b64_tr_b16 v[72:73], v10 offset:0
  ds_read_b64_tr_b16 v[74:75], v10 offset:1024
Lk_13:
  s_waitcnt lgkmcnt(0)
  v_mfma_f32_16x16x32_bf16 v[128:131], v[48:51], v[32:35], v[128:131]
  ds_read_b64_tr_b16 v[92:93], v6 offset:4096
  v_mfma_f32_16x16x32_bf16 v[132:135], v[48:51], v[36:39], v[132:135]
  ds_read_b64_tr_b16 v[94:95], v6 offset:6144
  v_mfma_f32_16x16x32_bf16 v[136:139], v[48:51], v[40:43], v[136:139]
  ds_read_b128 v[76:79], v5 offset:0
  v_mfma_f32_16x16x32_bf16 v[140:143], v[48:51], v[44:47], v[140:143]
  ds_read_b128 v[80:83], v5 offset:2048
  v_mfma_f32_16x16x32_bf16 v[144:147], v[52:55], v[32:35], v[144:147]
  ds_read_b128 v[84:87], v5 offset:4096
  v_mfma_f32_16x16x32_bf16 v[148:151], v[52:55], v[36:39], v[148:151]
  ds_read_b128 v[88:91], v5 offset:6144
  v_mfma_f32_16x16x32_bf16 v[152:155], v[52:55], v[40:43], v[152:155]
  ds_read_b64_tr_b16 v[96:97], v7 offset:4096
  v_mfma_f32_16x16x32_bf16 v[156:159], v[52:55], v[44:47], v[156:159]
  ds_read_b64_tr_b16 v[98:99], v7 offset:6144
  v_mfma_f32_16x16x32_bf16 v[160:163], v[56:59], v[32:35], v[160:163]
  ds_read_b64_tr_b16 v[100:101], v8 offset:4096
  v_mfma_f32_16x16x32_bf16 v[164:167], v[56:59], v[36:39], v[164:167]
  ds_read_b64_tr_b16 v[102:103], v8 offset:6144
  v_mfma_f32_16x16x32_bf16 v[168:171], v[56:59], v[40:43], v[168:171]
  ds_read_b64_tr_b16 v[104:105], v9 offset:4096
  v_mfma_f32_16x16x32_bf16 v[172:175], v[56:59], v[44:47], v[172:175]
  ds_read_b64_tr_b16 v[106:107], v9 offset:6144
  v_mfma_f32_16x16x32_bf16 v[176:179], v[60:63], v[32:35], v[176:179]
  ds_read_b64_tr_b16 v[108:109], v6 offset:12288
  v_mfma_f32_16x16x32_bf16 v[180:183], v[60:63], v[36:39], v[180:183]
  ds_read_b64_tr_b16 v[110:111], v6 offset:14336
  v_mfma_f32_16x16x32_bf16 v[184:187], v[60:63], v[40:43], v[184:187]
  ds_read_b64_tr_b16 v[112:113], v7 offset:12288
  v_mfma_f32_16x16x32_bf16 v[188:191], v[60:63], v[44:47], v[188:191]
  ds_read_b64_tr_b16 v[114:115], v7 offset:14336
  v_mfma_f32_16x16x32_bf16 v[192:195], v[64:67], v[32:35], v[192:195]
  ds_read_b64_tr_b16 v[116:117], v10 offset:2048
  v_mfma_f32_16x16x32_bf16 v[196:199], v[64:67], v[36:39], v[196:199]
  ds_read_b64_tr_b16 v[118:119], v10 offset:3072
  v_mfma_f32_16x16x32_bf16 v[200:203], v[64:67], v[40:43], v[200:203]
  s_add_u32 s16, s16, s17
  s_cmp_eq_u32 s16, 65536
  s_cselect_b32 s23, s18, s17
  v_mfma_f32_16x16x32_bf16 v[204:207], v[64:67], v[44:47], v[204:207]
  s_cselect_b32 s16, 0, s16
  v_add_u32 v4, s23, v4
  v_add_u32 v5, s23, v5
  v_mfma_f32_16x16x32_bf16 v[208:211], v[68:71], v[32:35], v[208:211]
  s_add_u32 s19, s19, s20
  s_cmp_eq_u32 s19, 86016
  s_cselect_b32 s23, s21, s20
  v_mfma_f32_16x16x32_bf16 v[212:215], v[68:71], v[36:39], v[212:215]
  s_cselect_b32 s19, 0, s19
  v_add_u32 v6, s23, v6
  v_add_u32 v7, s23, v7
  v_mfma_f32_16x16x32_bf16 v[216:219], v[68:71], v[40:43], v[216:219]
  v_add_u32 v8, s23, v8
  v_add_u32 v9, s23, v9
  v_add_u32 v10, s23, v10
  v_mfma_f32_16x16x32_bf16 v[220:223], v[68:71], v[44:47], v[220:223]
  v_mfma_f32_16x16x32_bf16 v[224:227], v[72:75], v[32:35], v[224:227]
  v_mfma_f32_16x16x32_bf16 v[228:231], v[72:75], v[36:39], v[228:231]
  v_mfma_f32_16x16x32_bf16 v[232:235], v[72:75], v[40:43], v[232:235]
  v_mfma_f32_16x16x32_bf16 v[236:239], v[72:75], v[44:47], v[236:239]
  s_waitcnt lgkmcnt(0)
  s_barrier
  v_mfma_f32_16x16x32_bf16 v[128:131], v[92:95], v[76:79], v[128:131]
  ds_read_b64_tr_b16 v[48:49], v6 offset:0
  v_mfma_f32_16x16x32_bf16 v[132:135], v[92:95], v[80:83], v[132:135]
  ds_read_b64_tr_b16 v[50:51], v6 offset:2048
  v_mfma_f32_16x16x32_bf16 v[136:139], v[92:95], v[84:87], v[136:139]
  ds_read_b128 v[32:35], v4 offset:0
  v_mfma_f32_16x16x32_bf16 v[140:143], v[92:95], v[88:91], v[140:143]
  ds_read_b128 v[36:39], v4 offset:2048
  v_mfma_f32_16x16x32_bf16 v[144:147], v[96:99], v[76:79], v[144:147]
  ds_read_b128 v[40:43], v4 offset:4096
  v_mfma_f32_16x16x32_bf16 v[148:151], v[96:99], v[80:83], v[148:151]
  ds_read_b128 v[44:47], v4 offset:6144
  v_mfma_f32_16x16x32_bf16 v[152:155], v[96:99], v[84:87], v[152:155]
  ds_read_b64_tr_b16 v[52:53], v7 offset:0
  v_mfma_f32_16x16x32_bf16 v[156:159], v[96:99], v[88:91], v[156:159]
  ds_read_b64_tr_b16 v[54:55], v7 offset:2048
  v_mfma_f32_16x16x32_bf16 v[160:163], v[100:103], v[76:79], v[160:163]
  ds_read_b64_tr_b16 v[56:57], v8 offset:0
  v_mfma_f32_16x16x32_bf16 v[164:167], v[100:103], v[80:83], v[164:167]
  ds_read_b64_tr_b16 v[58:59], v8 offset:2048
  v_mfma_f32_16x16x32_bf16 v[168:171], v[100:103], v[84:87], v[168:171]
  ds_read_b64_tr_b16 v[60:61], v9 offset:0
  v_mfma_f32_16x16x32_bf16 v[172:175], v[100:103], v[88:91], v[172:175]
  ds_read_b64_tr_b16 v[62:63], v9 offset:2048
  v_mfma_f32_16x16x32_bf16 v[176:179], v[104:107], v[76:79], v[176:179]
  ds_read_b64_tr_b16 v[64:65], v6 offset:8192
  v_mfma_f32_16x16x32_bf16 v[180:183], v[104:107], v[80:83], v[180:183]
  ds_read_b64_tr_b16 v[66:67], v6 offset:10240
  v_mfma_f32_16x16x32_bf16 v[184:187], v[104:107], v[84:87], v[184:187]
  ds_read_b64_tr_b16 v[68:69], v7 offset:8192
  v_mfma_f32_16x16x32_bf16 v[188:191], v[104:107], v[88:91], v[188:191]
  ds_read_b64_tr_b16 v[70:71], v7 offset:10240
  v_mfma_f32_16x16x32_bf16 v[192:195], v[108:111], v[76:79], v[192:195]
  ds_read_b64_tr_b16 v[72:73], v10 offset:0
  v_mfma_f32_16x16x32_bf16 v[196:199], v[108:111], v[80:83], v[196:199]
  ds_read_b64_tr_b16 v[74:75], v10 offset:1024
  v_mfma_f32_16x16x32_bf16 v[200:203], v[108:111], v[84:87], v[200:203]
  s_sub_u32 s22, s22, 1
  v_mfma_f32_16x16x32_bf16 v[204:207], v[108:111], v[88:91], v[204:207]
  s_cmp_lg_u32 s22, 0
  v_mfma_f32_16x16x32_bf16 v[208:211], v[112:115], v[76:79], v[208:211]
  v_mfma_f32_16x16x32_bf16 v[212:215], v[112:115], v[80:83], v[212:215]
  v_mfma_f32_16x16x32_bf16 v[216:219], v[112:115], v[84:87], v[216:219]
  v_mfma_f32_16x16x32_bf16 v[220:223], v[112:115], v[88:91], v[220:223]
  v_mfma_f32_16x16x32_bf16 v[224:227], v[116:119], v[76:79], v[224:227]
  v_mfma_f32_16x16x32_bf16 v[228:231], v[116:119], v[80:83], v[228:231]
  v_mfma_f32_16x16x32_bf16 v[232:235], v[116:119], v[84:87], v[232:235]
  v_mfma_f32_16x16x32_bf16 v[236:239], v[116:119], v[88:91], v[236:239]
  s_cbranch_scc1 Lk_13
  s_waitcnt lgkmcnt(0)
  s_mul_i32 s4, s85, 320
  s_add_u32 s4, s4, 151552
  v_and_b32 v2, 15, v1
  v_lshl_add_u32 v3, v2, 2, s4
  ds_read2_b32 v[88:89], v3 offset0:0 offset1:160
  ds_read2_b32 v[90:91], v3 offset0:16 offset1:176
  ds_read2_b32 v[92:93], v3 offset0:32 offset1:192
  ds_read2_b32 v[94:95], v3 offset0:48 offset1:208
  s_mul_i32 s5, s86, 384
  s_add_u32 s5, s5, 154112
  v_add_u32 v3, s5, v29
  s_lshl_b32 s5, s86, 6
  s_add_u32 s5, s5, 154880
  v_add_u32 v2, s5, v29
  ds_read_b128 v[32:35], v3 offset:0
  ds_read_b128 v[36:39], v3 offset:1024
  ds_read_b128 v[40:43], v3 offset:64
  ds_read_b128 v[44:47], v3 offset:1088
  ds_read_b128 v[48:51], v3 offset:128
  ds_read_b128 v[52:55], v3 offset:1152
  ds_read_b128 v[56:59], v3 offset:192
  ds_read_b128 v[60:63], v3 offset:1216
  ds_read_b128 v[64:67], v3 offset:256
  ds_read_b128 v[68:71], v3 offset:1280
  s_waitcnt lgkmcnt(6)
  ds_read_b128 v[72:75], v3 offset:320
  ds_read_b128 v[76:79], v3 offset:1344
  ds_read_b128 v[80:83], v2 offset:0
  ds_read_b128 v[84:87], v2 offset:1024
  v_mov_b32 v96, 0xc0135761
  v_mov_b32 v97, 0xbdd2d3e8
  v_mov_b32 v98, 1.0
  s_mul_i32 s4, s76, 112
  s_mul_i32 s5, s77, 7
  s_add_u32 s4, s4, s5
  s_and_b32 s5, s77, 1
  s_mul_i32 s6, s86, 3
  s_add_u32 s6, s6, s5
  s_add_u32 s6, s6, s4
  s_mul_i32 s5, s5, 6
  s_sub_u32 s7, 6, s5
  s_add_u32 s7, s7, s4
  s_lshl_b32 s8, s85, 12
  s_add_u32 s8, s8, s83
  s_add_u32 s8, s8, 8388608
  s_lshl_b32 s6, s6, 13
  s_add_u32 s6, s6, s8
  s_lshl_b32 s7, s7, 13
  s_add_u32 s7, s7, s8
  s_lshl_b32 s8, s86, 3
  s_add_u32 s7, s7, s8
  s_waitcnt lgkmcnt(0)
  v_pk_fma_f32 v[100:101], v[32:33], v[88:89], v[36:37] op_sel:[0,1,0] op_sel_hi:[1,1,1] neg_lo:[0,1,0] neg_hi:[0,1,0]
  v_pk_fma_f32 v[102:103], v[34:35], v[88:89], v[38:39] op_sel:[0,1,0] op_sel_hi:[1,1,1] neg_lo:[0,1,0] neg_hi:[0,1,0]
  v_pk_fma_f32 v[104:105], v[40:41], v[88:89], v[44:45] op_sel:[0,1,0] op_sel_hi:[1,1,1] neg_lo:[0,1,0] neg_hi:[0,1,0]
  v_pk_fma_f32 v[106:107], v[42:43], v[88:89], v[46:47] op_sel:[0,1,0] op_sel_hi:[1,1,1] neg_lo:[0,1,0] neg_hi:[0,1,0]
  v_pk_fma_f32 v[128:129], v[128:129], v[88:89], v[100:101] op_sel:[0,0,0] op_sel_hi:[1,0,1]
  v_pk_fma_f32 v[130:131], v[130:131], v[88:89], v[102:103] op_sel:[0,0,0] op_sel_hi:[1,0,1]
  v_pk_fma_f32 v[144:145], v[144:145], v[88:89], v[104:105] op_sel:[0,0,0] op_sel_hi:[1,0,1]
  v_pk_fma_f32 v[146:147], v[146:147], v[88:89], v[106:107] op_sel:[0,0,0] op_sel_hi:[1,0,1]
  v_pk_mul_f32 v[100:101], v[128:129], v[128:129]
  v_pk_mul_f32 v[102:103], v[130:131], v[130:131]
  v_pk_mul_f32 v[104:105], v[144:145], v[144:145]
  v_pk_mul_f32 v[106:107], v[146:147], v[146:147]
  v_pk_fma_f32 v[100:101], v[100:101], v[96:97], v[96:97] op_sel:[0,1,0] op_sel_hi:[1,1,0]
  v_pk_fma_f32 v[102:103], v[102:103], v[96:97], v[96:97] op_sel:[0,1,0] op_sel_hi:[1,1,0]
  v_pk_fma_f32 v[104:105], v[104:105], v[96:97], v[96:97] op_sel:[0,1,0] op_sel_hi:[1,1,0]
  v_pk_fma_f32 v[106:107], v[106:107], v[96:97], v[96:97] op_sel:[0,1,0] op_sel_hi:[1,1,0]
  v_pk_mul_f32 v[100:101], v[100:101], v[128:129]
  v_pk_mul_f32 v[102:103], v[102:103], v[130:131]
  v_pk_mul_f32 v[104:105], v[104:105], v[144:145]
  v_pk_mul_f32 v[106:107], v[106:107], v[146:147]
  v_exp_f32 v100, v100
  v_exp_f32 v101, v101
  v_exp_f32 v102, v102
  v_exp_f32 v103, v103
  v_exp_f32 v104, v104
  v_exp_f32 v105, v105
  v_exp_f32 v106, v106
  v_exp_f32 v107, v107
  v_pk_add_f32 v[100:101], v[100:101], v[98:99] op_sel_hi:[1,0]
  v_pk_add_f32 v[102:103], v[102:103], v[98:99] op_sel_hi:[1,0]
  v_pk_add_f32 v[104:105], v[104:105], v[98:99] op_sel_hi:[1,0]
  v_pk_add_f32 v[106:107], v[106:107], v[98:99] op_sel_hi:[1,0]
  v_rcp_f32 v100, v100
  v_rcp_f32 v101, v101
  v_rcp_f32 v102, v102
  v_rcp_f32 v103, v103
  v_rcp_f32 v104, v104
  v_rcp_f32 v105, v105
  v_rcp_f32 v106, v106
  v_rcp_f32 v107, v107
  v_pk_mul_f32 v[128:129], v[128:129], v[100:101]
  v_pk_mul_f32 v[130:131], v[130:131], v[102:103]
  v_pk_mul_f32 v[144:145], v[144:145], v[104:105]
  v_pk_mul_f32 v[146:147], v[146:147], v[106:107]
  v_cvt_pk_bf16_f32 v116, v128, v129
  v_cvt_pk_bf16_f32 v117, v130, v131
  v_cvt_pk_bf16_f32 v118, v144, v145
  v_cvt_pk_bf16_f32 v119, v146, v147
  buffer_store_dwordx4 v[116:119], v11, s[40:43], s6 offen offset:0 sc0 sc1
  v_pk_fma_f32 v[100:101], v[32:33], v[90:91], v[36:37] op_sel:[0,1,0] op_sel_hi:[1,1,1] neg_lo:[0,1,0] neg_hi:[0,1,0]
  v_pk_fma_f32 v[102:103], v[34:35], v[90:91], v[38:39] op_sel:[0,1,0] op_sel_hi:[1,1,1] neg_lo:[0,1,0] neg_hi:[0,1,0]
  v_pk_fma_f32 v[104:105], v[40:41], v[90:91], v[44:45] op_sel:[0,1,0] op_sel_hi:[1,1,1] neg_lo:[0,1,0] neg_hi:[0,1,0]
  v_pk_fma_f32 v[106:107], v[42:43], v[90:91], v[46:47] op_sel:[0,1,0] op_sel_hi:[1,1,1] neg_lo:[0,1,0] neg_hi:[0,1,0]
  v_pk_fma_f32 v[132:133], v[132:133], v[90:91], v[100:101] op_sel:[0,0,0] op_sel_hi:[1,0,1]
  v_pk_fma_f32 v[134:135], v[134:135], v[90:91], v[102:103] op_sel:[0,0,0] op_sel_hi:[1,0,1]
  v_pk_fma_f32 v[148:149], v[148:149], v[90:91], v[104:105] op_sel:[0,0,0] op_sel_hi:[1,0,1]
  v_pk_fma_f32 v[150:151], v[150:151], v[90:91], v[106:107] op_sel:[0,0,0] op_sel_hi:[1,0,1]
  v_pk_mul_f32 v[100:101], v[132:133], v[132:133]
  v_pk_mul_f32 v[102:103], v[134:135], v[134:135]
  v_pk_mul_f32 v[104:105], v[148:149], v[148:149]
  v_pk_mul_f32 v[106:107], v[150:151], v[150:151]
  v_pk_fma_f32 v[100:101], v[100:101], v[96:97], v[96:97] op_sel:[0,1,0] op_sel_hi:[1,1,0]
  v_pk_fma_f32 v[102:103], v[102:103], v[96:97], v[96:97] op_sel:[0,1,0] op_sel_hi:[1,1,0]
  v_pk_fma_f32 v[104:105], v[104:105], v[96:97], v[96:97] op_sel:[0,1,0] op_sel_hi:[1,1,0]
  v_pk_fma_f32 v[106:107], v[106:107], v[96:97], v[96:97] op_sel:[0,1,0] op_sel_hi:[1,1,0]
  v_pk_mul_f32 v[100:101], v[100:101], v[132:133]
  v_pk_mul_f32 v[102:103], v[102:103], v[134:135]
  v_pk_mul_f32 v[104:105], v[104:105], v[148:149]
  v_pk_mul_f32 v[106:107], v[106:107], v[150:151]
  v_exp_f32 v100, v100
  v_exp_f32 v101, v101
  v_exp_f32 v102, v102
  v_exp_f32 v103, v103
  v_exp_f32 v104, v104
  v_exp_f32 v105, v105
  v_exp_f32 v106, v106
  v_exp_f32 v107, v107
  v_pk_add_f32 v[100:101], v[100:101], v[98:99] op_sel_hi:[1,0]
  v_pk_add_f32 v[102:103], v[102:103], v[98:99] op_sel_hi:[1,0]
  v_pk_add_f32 v[104:105], v[104:105], v[98:99] op_sel_hi:[1,0]
  v_pk_add_f32 v[106:107], v[106:107], v[98:99] op_sel_hi:[1,0]
  v_rcp_f32 v100, v100
  v_rcp_f32 v101, v101
  v_rcp_f32 v102, v102
  v_rcp_f32 v103, v103
  v_rcp_f32 v104, v104
  v_rcp_f32 v105, v105
  v_rcp_f32 v106, v106
  v_rcp_f32 v107, v107
  v_pk_mul_f32 v[132:133], v[132:133], v[100:101]
  v_pk_mul_f32 v[134:135], v[134:135], v[102:103]
  v_pk_mul_f32 v[148:149], v[148:149], v[104:105]
  v_pk_mul_f32 v[150:151], v[150:151], v[106:107]
  v_cvt_pk_bf16_f32 v120, v132, v133
  v_cvt_pk_bf16_f32 v121, v134, v135
  v_cvt_pk_bf16_f32 v122, v148, v149
  v_cvt_pk_bf16_f32 v123, v150, v151
  buffer_store_dwordx4 v[120:123], v11, s[40:43], s6 offen offset:1024 sc0 sc1
  v_pk_fma_f32 v[100:101], v[32:33], v[92:93], v[36:37] op_sel:[0,1,0] op_sel_hi:[1,1,1] neg_lo:[0,1,0] neg_hi:[0,1,0]
  v_pk_fma_f32 v[102:103], v[34:35], v[92:93], v[38:39] op_sel:[0,1,0] op_sel_hi:[1,1,1] neg_lo:[0,1,0] neg_hi:[0,1,0]
  v_pk_fma_f32 v[104:105], v[40:41], v[92:93], v[44:45] op_sel:[0,1,0] op_sel_hi:[1,1,1] neg_lo:[0,1,0] neg_hi:[0,1,0]
  v_pk_fma_f32 v[106:107], v[42:43], v[92:93], v[46:47] op_sel:[0,1,0] op_sel_hi:[1,1,1] neg_lo:[0,1,0] neg_hi:[0,1,0]
  v_pk_fma_f32 v[136:137], v[136:137], v[92:93], v[100:101] op_sel:[0,0,0] op_sel_hi:[1,0,1]
  v_pk_fma_f32 v[138:139], v[138:139], v[92:93], v[102:103] op_sel:[0,0,0] op_sel_hi:[1,0,1]
  v_pk_fma_f32 v[152:153], v[152:153], v[92:93], v[104:105] op_sel:[0,0,0] op_sel_hi:[1,0,1]
  v_pk_fma_f32 v[154:155], v[154:155], v[92:93], v[106:107] op_sel:[0,0,0] op_sel_hi:[1,0,1]
  v_pk_mul_f32 v[100:101], v[136:137], v[136:137]
  v_pk_mul_f32 v[102:103], v[138:139], v[138:139]
  v_pk_mul_f32 v[104:105], v[152:153], v[152:153]
  v_pk_mul_f32 v[106:107], v[154:155], v[154:155]
  v_pk_fma_f32 v[100:101], v[100:101], v[96:97], v[96:97] op_sel:[0,1,0] op_sel_hi:[1,1,0]
  v_pk_fma_f32 v[102:103], v[102:103], v[96:97], v[96:97] op_sel:[0,1,0] op_sel_hi:[1,1,0]
  v_pk_fma_f32 v[104:105], v[104:105], v[96:97], v[96:97] op_sel:[0,1,0] op_sel_hi:[1,1,0]
  v_pk_fma_f32 v[106:107], v[106:107], v[96:97], v[96:97] op_sel:[0,1,0] op_sel_hi:[1,1,0]
  v_pk_mul_f32 v[100:101], v[100:101], v[136:137]
  v_pk_mul_f32 v[102:103], v[102:103], v[138:139]
  v_pk_mul_f32 v[104:105], v[104:105], v[152:153]
  v_pk_mul_f32 v[106:107], v[106:107], v[154:155]
  v_exp_f32 v100, v100
  v_exp_f32 v101, v101
  v_exp_f32 v102, v102
  v_exp_f32 v103, v103
  v_exp_f32 v104, v104
  v_exp_f32 v105, v105
  v_exp_f32 v106, v106
  v_exp_f32 v107, v107
  v_pk_add_f32 v[100:101], v[100:101], v[98:99] op_sel_hi:[1,0]
  v_pk_add_f32 v[102:103], v[102:103], v[98:99] op_sel_hi:[1,0]
  v_pk_add_f32 v[104:105], v[104:105], v[98:99] op_sel_hi:[1,0]
  v_pk_add_f32 v[106:107], v[106:107], v[98:99] op_sel_hi:[1,0]
  v_rcp_f32 v100, v100
  v_rcp_f32 v101, v101
  v_rcp_f32 v102, v102
  v_rcp_f32 v103, v103
  v_rcp_f32 v104, v104
  v_rcp_f32 v105, v105
  v_rcp_f32 v106, v106
  v_rcp_f32 v107, v107
  v_pk_mul_f32 v[136:137], v[136:137], v[100:101]
  v_pk_mul_f32 v[138:139], v[138:139], v[102:103]
  v_pk_mul_f32 v[152:153], v[152:153], v[104:105]
  v_pk_mul_f32 v[154:155], v[154:155], v[106:107]
  v_cvt_pk_bf16_f32 v116, v136, v137
  v_cvt_pk_bf16_f32 v117, v138, v139
  v_cvt_pk_bf16_f32 v118, v152, v153
  v_cvt_pk_bf16_f32 v119, v154, v155
  buffer_store_dwordx4 v[116:119], v11, s[40:43], s6 offen offset:2048 sc0 sc1
  v_pk_fma_f32 v[100:101], v[32:33], v[94:95], v[36:37] op_sel:[0,1,0] op_sel_hi:[1,1,1] neg_lo:[0,1,0] neg_hi:[0,1,0]
  v_pk_fma_f32 v[102:103], v[34:35], v[94:95], v[38:39] op_sel:[0,1,0] op_sel_hi:[1,1,1] neg_lo:[0,1,0] neg_hi:[0,1,0]
  v_pk_fma_f32 v[104:105], v[40:41], v[94:95], v[44:45] op_sel:[0,1,0] op_sel_hi:[1,1,1] neg_lo:[0,1,0] neg_hi:[0,1,0]
  v_pk_fma_f32 v[106:107], v[42:43], v[94:95], v[46:47] op_sel:[0,1,0] op_sel_hi:[1,1,1] neg_lo:[0,1,0] neg_hi:[0,1,0]
  v_pk_fma_f32 v[140:141], v[140:141], v[94:95], v[100:101] op_sel:[0,0,0] op_sel_hi:[1,0,1]
  v_pk_fma_f32 v[142:143], v[142:143], v[94:95], v[102:103] op_sel:[0,0,0] op_sel_hi:[1,0,1]
  v_pk_fma_f32 v[156:157], v[156:157], v[94:95], v[104:105] op_sel:[0,0,0] op_sel_hi:[1,0,1]
  v_pk_fma_f32 v[158:159], v[158:159], v[94:95], v[106:107] op_sel:[0,0,0] op_sel_hi:[1,0,1]
  v_pk_mul_f32 v[100:101], v[140:141], v[140:141]
  v_pk_mul_f32 v[102:103], v[142:143], v[142:143]
  v_pk_mul_f32 v[104:105], v[156:157], v[156:157]
  v_pk_mul_f32 v[106:107], v[158:159], v[158:159]
  v_pk_fma_f32 v[100:101], v[100:101], v[96:97], v[96:97] op_sel:[0,1,0] op_sel_hi:[1,1,0]
  v_pk_fma_f32 v[102:103], v[102:103], v[96:97], v[96:97] op_sel:[0,1,0] op_sel_hi:[1,1,0]
  v_pk_fma_f32 v[104:105], v[104:105], v[96:97], v[96:97] op_sel:[0,1,0] op_sel_hi:[1,1,0]
  v_pk_fma_f32 v[106:107], v[106:107], v[96:97], v[96:97] op_sel:[0,1,0] op_sel_hi:[1,1,0]
  v_pk_mul_f32 v[100:101], v[100:101], v[140:141]
  v_pk_mul_f32 v[102:103], v[102:103], v[142:143]
  v_pk_mul_f32 v[104:105], v[104:105], v[156:157]
  v_pk_mul_f32 v[106:107], v[106:107], v[158:159]
  v_exp_f32 v100, v100
  v_exp_f32 v101, v101
  v_exp_f32 v102, v102
  v_exp_f32 v103, v103
  v_exp_f32 v104, v104
  v_exp_f32 v105, v105
  v_exp_f32 v106, v106
  v_exp_f32 v107, v107
  v_pk_add_f32 v[100:101], v[100:101], v[98:99] op_sel_hi:[1,0]
  v_pk_add_f32 v[102:103], v[102:103], v[98:99] op_sel_hi:[1,0]
  v_pk_add_f32 v[104:105], v[104:105], v[98:99] op_sel_hi:[1,0]
  v_pk_add_f32 v[106:107], v[106:107], v[98:99] op_sel_hi:[1,0]
  v_rcp_f32 v100, v100
  v_rcp_f32 v101, v101
  v_rcp_f32 v102, v102
  v_rcp_f32 v103, v103
  v_rcp_f32 v104, v104
  v_rcp_f32 v105, v105
  v_rcp_f32 v106, v106
  v_rcp_f32 v107, v107
  v_pk_mul_f32 v[140:141], v[140:141], v[100:101]
  v_pk_mul_f32 v[142:143], v[142:143], v[102:103]
  v_pk_mul_f32 v[156:157], v[156:157], v[104:105]
  v_pk_mul_f32 v[158:159], v[158:159], v[106:107]
  v_cvt_pk_bf16_f32 v120, v140, v141
  v_cvt_pk_bf16_f32 v121, v142, v143
  v_cvt_pk_bf16_f32 v122, v156, v157
  v_cvt_pk_bf16_f32 v123, v158, v159
  buffer_store_dwordx4 v[120:123], v11, s[40:43], s6 offen offset:3072 sc0 sc1
  s_add_u32 s6, s6, 8192
  v_pk_fma_f32 v[100:101], v[48:49], v[88:89], v[52:53] op_sel:[0,1,0] op_sel_hi:[1,1,1] neg_lo:[0,1,0] neg_hi:[0,1,0]
  v_pk_fma_f32 v[102:103], v[50:51], v[88:89], v[54:55] op_sel:[0,1,0] op_sel_hi:[1,1,1] neg_lo:[0,1,0] neg_hi:[0,1,0]
  v_pk_fma_f32 v[104:105], v[56:57], v[88:89], v[60:61] op_sel:[0,1,0] op_sel_hi:[1,1,1] neg_lo:[0,1,0] neg_hi:[0,1,0]
  v_pk_fma_f32 v[106:107], v[58:59], v[88:89], v[62:63] op_sel:[0,1,0] op_sel_hi:[1,1,1] neg_lo:[0,1,0] neg_hi:[0,1,0]
  v_pk_fma_f32 v[160:161], v[160:161], v[88:89], v[100:101] op_sel:[0,0,0] op_sel_hi:[1,0,1]
  v_pk_fma_f32 v[162:163], v[162:163], v[88:89], v[102:103] op_sel:[0,0,0] op_sel_hi:[1,0,1]
  v_pk_fma_f32 v[176:177], v[176:177], v[88:89], v[104:105] op_sel:[0,0,0] op_sel_hi:[1,0,1]
  v_pk_fma_f32 v[178:179], v[178:179], v[88:89], v[106:107] op_sel:[0,0,0] op_sel_hi:[1,0,1]
  v_pk_mul_f32 v[100:101], v[160:161], v[160:161]
  v_pk_mul_f32 v[102:103], v[162:163], v[162:163]
  v_pk_mul_f32 v[104:105], v[176:177], v[176:177]
  v_pk_mul_f32 v[106:107], v[178:179], v[178:179]
  v_pk_fma_f32 v[100:101], v[100:101], v[96:97], v[96:97] op_sel:[0,1,0] op_sel_hi:[1,1,0]
  v_pk_fma_f32 v[102:103], v[102:103], v[96:97], v[96:97] op_sel:[0,1,0] op_sel_hi:[1,1,0]
  v_pk_fma_f32 v[104:105], v[104:105], v[96:97], v[96:97] op_sel:[0,1,0] op_sel_hi:[1,1,0]
  v_pk_fma_f32 v[106:107], v[106:107], v[96:97], v[96:97] op_sel:[0,1,0] op_sel_hi:[1,1,0]
  v_pk_mul_f32 v[100:101], v[100:101], v[160:161]
  v_pk_mul_f32 v[102:103], v[102:103], v[162:163]
  v_pk_mul_f32 v[104:105], v[104:105], v[176:177]
  v_pk_mul_f32 v[106:107], v[106:107], v[178:179]
  v_exp_f32 v100, v100
  v_exp_f32 v101, v101
  v_exp_f32 v102, v102
  v_exp_f32 v103, v103
  v_exp_f32 v104, v104
  v_exp_f32 v105, v105
  v_exp_f32 v106, v106
  v_exp_f32 v107, v107
  v_pk_add_f32 v[100:101], v[100:101], v[98:99] op_sel_hi:[1,0]
  v_pk_add_f32 v[102:103], v[102:103], v[98:99] op_sel_hi:[1,0]
  v_pk_add_f32 v[104:105], v[104:105], v[98:99] op_sel_hi:[1,0]
  v_pk_add_f32 v[106:107], v[106:107], v[98:99] op_sel_hi:[1,0]
  v_rcp_f32 v100, v100
  v_rcp_f32 v101, v101
  v_rcp_f32 v102, v102
  v_rcp_f32 v103, v103
  v_rcp_f32 v104, v104
  v_rcp_f32 v105, v105
  v_rcp_f32 v106, v106
  v_rcp_f32 v107, v107
  v_pk_mul_f32 v[160:161], v[160:161], v[100:101]
  v_pk_mul_f32 v[162:163], v[162:163], v[102:103]
  v_pk_mul_f32 v[176:177], v[176:177], v[104:105]
  v_pk_mul_f32 v[178:179], v[178:179], v[106:107]
  v_cvt_pk_bf16_f32 v116, v160, v161
  v_cvt_pk_bf16_f32 v117, v162, v163
  v_cvt_pk_bf16_f32 v118, v176, v177
  v_cvt_pk_bf16_f32 v119, v178, v179
  buffer_store_dwordx4 v[116:119], v11, s[40:43], s6 offen offset:0 sc0 sc1
  v_pk_fma_f32 v[100:101], v[48:49], v[90:91], v[52:53] op_sel:[0,1,0] op_sel_hi:[1,1,1] neg_lo:[0,1,0] neg_hi:[0,1,0]
  v_pk_fma_f32 v[102:103], v[50:51], v[90:91], v[54:55] op_sel:[0,1,0] op_sel_hi:[1,1,1] neg_lo:[0,1,0] neg_hi:[0,1,0]
  v_pk_fma_f32 v[104:105], v[56:57], v[90:91], v[60:61] op_sel:[0,1,0] op_sel_hi:[1,1,1] neg_lo:[0,1,0] neg_hi:[0,1,0]
  v_pk_fma_f32 v[106:107], v[58:59], v[90:91], v[62:63] op_sel:[0,1,0] op_sel_hi:[1,1,1] neg_lo:[0,1,0] neg_hi:[0,1,0]
  v_pk_fma_f32 v[164:165], v[164:165], v[90:91], v[100:101] op_sel:[0,0,0] op_sel_hi:[1,0,1]
  v_pk_fma_f32 v[166:167], v[166:167], v[90:91], v[102:103] op_sel:[0,0,0] op_sel_hi:[1,0,1]
  v_pk_fma_f32 v[180:181], v[180:181], v[90:91], v[104:105] op_sel:[0,0,0] op_sel_hi:[1,0,1]
  v_pk_fma_f32 v[182:183], v[182:183], v[90:91], v[106:107] op_sel:[0,0,0] op_sel_hi:[1,0,1]
  v_pk_mul_f32 v[100:101], v[164:165], v[164:165]
  v_pk_mul_f32 v[102:103], v[166:167], v[166:167]
  v_pk_mul_f32 v[104:105], v[180:181], v[180:181]
  v_pk_mul_f32 v[106:107], v[182:183], v[182:183]
  v_pk_fma_f32 v[100:101], v[100:101], v[96:97], v[96:97] op_sel:[0,1,0] op_sel_hi:[1,1,0]
  v_pk_fma_f32 v[102:103], v[102:103], v[96:97], v[96:97] op_sel:[0,1,0] op_sel_hi:[1,1,0]
  v_pk_fma_f32 v[104:105], v[104:105], v[96:97], v[96:97] op_sel:[0,1,0] op_sel_hi:[1,1,0]
  v_pk_fma_f32 v[106:107], v[106:107], v[96:97], v[96:97] op_sel:[0,1,0] op_sel_hi:[1,1,0]
  v_pk_mul_f32 v[100:101], v[100:101], v[164:165]
  v_pk_mul_f32 v[102:103], v[102:103], v[166:167]
  v_pk_mul_f32 v[104:105], v[104:105], v[180:181]
  v_pk_mul_f32 v[106:107], v[106:107], v[182:183]
  v_exp_f32 v100, v100
  v_exp_f32 v101, v101
  v_exp_f32 v102, v102
  v_exp_f32 v103, v103
  v_exp_f32 v104, v104
  v_exp_f32 v105, v105
  v_exp_f32 v106, v106
  v_exp_f32 v107, v107
  v_pk_add_f32 v[100:101], v[100:101], v[98:99] op_sel_hi:[1,0]
  v_pk_add_f32 v[102:103], v[102:103], v[98:99] op_sel_hi:[1,0]
  v_pk_add_f32 v[104:105], v[104:105], v[98:99] op_sel_hi:[1,0]
  v_pk_add_f32 v[106:107], v[106:107], v[98:99] op_sel_hi:[1,0]
  v_rcp_f32 v100, v100
  v_rcp_f32 v101, v101
  v_rcp_f32 v102, v102
  v_rcp_f32 v103, v103
  v_rcp_f32 v104, v104
  v_rcp_f32 v105, v105
  v_rcp_f32 v106, v106
  v_rcp_f32 v107, v107
  v_pk_mul_f32 v[164:165], v[164:165], v[100:101]
  v_pk_mul_f32 v[166:167], v[166:167], v[102:103]
  v_pk_mul_f32 v[180:181], v[180:181], v[104:105]
  v_pk_mul_f32 v[182:183], v[182:183], v[106:107]
  v_cvt_pk_bf16_f32 v120, v164, v165
  v_cvt_pk_bf16_f32 v121, v166, v167
  v_cvt_pk_bf16_f32 v122, v180, v181
  v_cvt_pk_bf16_f32 v123, v182, v183
  buffer_store_dwordx4 v[120:123], v11, s[40:43], s6 offen offset:1024 sc0 sc1
  v_pk_fma_f32 v[100:101], v[48:49], v[92:93], v[52:53] op_sel:[0,1,0] op_sel_hi:[1,1,1] neg_lo:[0,1,0] neg_hi:[0,1,0]
  v_pk_fma_f32 v[102:103], v[50:51], v[92:93], v[54:55] op_sel:[0,1,0] op_sel_hi:[1,1,1] neg_lo:[0,1,0] neg_hi:[0,1,0]
  v_pk_fma_f32 v[104:105], v[56:57], v[92:93], v[60:61] op_sel:[0,1,0] op_sel_hi:[1,1,1] neg_lo:[0,1,0] neg_hi:[0,1,0]
  v_pk_fma_f32 v[106:107], v[58:59], v[92:93], v[62:63] op_sel:[0,1,0] op_sel_hi:[1,1,1] neg_lo:[0,1,0] neg_hi:[0,1,0]
  v_pk_fma_f32 v[168:169], v[168:169], v[92:93], v[100:101] op_sel:[0,0,0] op_sel_hi:[1,0,1]
  v_pk_fma_f32 v[170:171], v[170:171], v[92:93], v[102:103] op_sel:[0,0,0] op_sel_hi:[1,0,1]
  v_pk_fma_f32 v[184:185], v[184:185], v[92:93], v[104:105] op_sel:[0,0,0] op_sel_hi:[1,0,1]
  v_pk_fma_f32 v[186:187], v[186:187], v[92:93], v[106:107] op_sel:[0,0,0] op_sel_hi:[1,0,1]
  v_pk_mul_f32 v[100:101], v[168:169], v[168:169]
  v_pk_mul_f32 v[102:103], v[170:171], v[170:171]
  v_pk_mul_f32 v[104:105], v[184:185], v[184:185]
  v_pk_mul_f32 v[106:107], v[186:187], v[186:187]
  v_pk_fma_f32 v[100:101], v[100:101], v[96:97], v[96:97] op_sel:[0,1,0] op_sel_hi:[1,1,0]
  v_pk_fma_f32 v[102:103], v[102:103], v[96:97], v[96:97] op_sel:[0,1,0] op_sel_hi:[1,1,0]
  v_pk_fma_f32 v[104:105], v[104:105], v[96:97], v[96:97] op_sel:[0,1,0] op_sel_hi:[1,1,0]
  v_pk_fma_f32 v[106:107], v[106:107], v[96:97], v[96:97] op_sel:[0,1,0] op_sel_hi:[1,1,0]
  v_pk_mul_f32 v[100:101], v[100:101], v[168:169]
  v_pk_mul_f32 v[102:103], v[102:103], v[170:171]
  v_pk_mul_f32 v[104:105], v[104:105], v[184:185]
  v_pk_mul_f32 v[106:107], v[106:107], v[186:187]
  v_exp_f32 v100, v100
  v_exp_f32 v101, v101
  v_exp_f32 v102, v102
  v_exp_f32 v103, v103
  v_exp_f32 v104, v104
  v_exp_f32 v105, v105
  v_exp_f32 v106, v106
  v_exp_f32 v107, v107
  v_pk_add_f32 v[100:101], v[100:101], v[98:99] op_sel_hi:[1,0]
  v_pk_add_f32 v[102:103], v[102:103], v[98:99] op_sel_hi:[1,0]
  v_pk_add_f32 v[104:105], v[104:105], v[98:99] op_sel_hi:[1,0]
  v_pk_add_f32 v[106:107], v[106:107], v[98:99] op_sel_hi:[1,0]
  v_rcp_f32 v100, v100
  v_rcp_f32 v101, v101
  v_rcp_f32 v102, v102
  v_rcp_f32 v103, v103
  v_rcp_f32 v104, v104
  v_rcp_f32 v105, v105
  v_rcp_f32 v106, v106
  v_rcp_f32 v107, v107
  v_pk_mul_f32 v[168:169], v[168:169], v[100:101]
  v_pk_mul_f32 v[170:171], v[170:171], v[102:103]
  v_pk_mul_f32 v[184:185], v[184:185], v[104:105]
  v_pk_mul_f32 v[186:187], v[186:187], v[106:107]
  v_cvt_pk_bf16_f32 v116, v168, v169
  v_cvt_pk_bf16_f32 v117, v170, v171
  v_cvt_pk_bf16_f32 v118, v184, v185
  v_cvt_pk_bf16_f32 v119, v186, v187
  buffer_store_dwordx4 v[116:119], v11, s[40:43], s6 offen offset:2048 sc0 sc1
  v_pk_fma_f32 v[100:101], v[48:49], v[94:95], v[52:53] op_sel:[0,1,0] op_sel_hi:[1,1,1] neg_lo:[0,1,0] neg_hi:[0,1,0]
  v_pk_fma_f32 v[102:103], v[50:51], v[94:95], v[54:55] op_sel:[0,1,0] op_sel_hi:[1,1,1] neg_lo:[0,1,0] neg_hi:[0,1,0]
  v_pk_fma_f32 v[104:105], v[56:57], v[94:95], v[60:61] op_sel:[0,1,0] op_sel_hi:[1,1,1] neg_lo:[0,1,0] neg_hi:[0,1,0]
  v_pk_fma_f32 v[106:107], v[58:59], v[94:95], v[62:63] op_sel:[0,1,0] op_sel_hi:[1,1,1] neg_lo:[0,1,0] neg_hi:[0,1,0]
  v_pk_fma_f32 v[172:173], v[172:173], v[94:95], v[100:101] op_sel:[0,0,0] op_sel_hi:[1,0,1]
  v_pk_fma_f32 v[174:175], v[174:175], v[94:95], v[102:103] op_sel:[0,0,0] op_sel_hi:[1,0,1]
  v_pk_fma_f32 v[188:189], v[188:189], v[94:95], v[104:105] op_sel:[0,0,0] op_sel_hi:[1,0,1]
  v_pk_fma_f32 v[190:191], v[190:191], v[94:95], v[106:107] op_sel:[0,0,0] op_sel_hi:[1,0,1]
  v_pk_mul_f32 v[100:101], v[172:173], v[172:173]
  v_pk_mul_f32 v[102:103], v[174:175], v[174:175]
  v_pk_mul_f32 v[104:105], v[188:189], v[188:189]
  v_pk_mul_f32 v[106:107], v[190:191], v[190:191]
  v_pk_fma_f32 v[100:101], v[100:101], v[96:97], v[96:97] op_sel:[0,1,0] op_sel_hi:[1,1,0]
  v_pk_fma_f32 v[102:103], v[102:103], v[96:97], v[96:97] op_sel:[0,1,0] op_sel_hi:[1,1,0]
  v_pk_fma_f32 v[104:105], v[104:105], v[96:97], v[96:97] op_sel:[0,1,0] op_sel_hi:[1,1,0]
  v_pk_fma_f32 v[106:107], v[106:107], v[96:97], v[96:97] op_sel:[0,1,0] op_sel_hi:[1,1,0]
  v_pk_mul_f32 v[100:101], v[100:101], v[172:173]
  v_pk_mul_f32 v[102:103], v[102:103], v[174:175]
  v_pk_mul_f32 v[104:105], v[104:105], v[188:189]
  v_pk_mul_f32 v[106:107], v[106:107], v[190:191]
  v_exp_f32 v100, v100
  v_exp_f32 v101, v101
  v_exp_f32 v102, v102
  v_exp_f32 v103, v103
  v_exp_f32 v104, v104
  v_exp_f32 v105, v105
  v_exp_f32 v106, v106
  v_exp_f32 v107, v107
  v_pk_add_f32 v[100:101], v[100:101], v[98:99] op_sel_hi:[1,0]
  v_pk_add_f32 v[102:103], v[102:103], v[98:99] op_sel_hi:[1,0]
  v_pk_add_f32 v[104:105], v[104:105], v[98:99] op_sel_hi:[1,0]
  v_pk_add_f32 v[106:107], v[106:107], v[98:99] op_sel_hi:[1,0]
  v_rcp_f32 v100, v100
  v_rcp_f32 v101, v101
  v_rcp_f32 v102, v102
  v_rcp_f32 v103, v103
  v_rcp_f32 v104, v104
  v_rcp_f32 v105, v105
  v_rcp_f32 v106, v106
  v_rcp_f32 v107, v107
  v_pk_mul_f32 v[172:173], v[172:173], v[100:101]
  v_pk_mul_f32 v[174:175], v[174:175], v[102:103]
  v_pk_mul_f32 v[188:189], v[188:189], v[104:105]
  v_pk_mul_f32 v[190:191], v[190:191], v[106:107]
  v_cvt_pk_bf16_f32 v120, v172, v173
  v_cvt_pk_bf16_f32 v121, v174, v175
  v_cvt_pk_bf16_f32 v122, v188, v189
  v_cvt_pk_bf16_f32 v123, v190, v191
  buffer_store_dwordx4 v[120:123], v11, s[40:43], s6 offen offset:3072 sc0 sc1
  s_add_u32 s6, s6, 8192
  v_pk_fma_f32 v[100:101], v[64:65], v[88:89], v[68:69] op_sel:[0,1,0] op_sel_hi:[1,1,1] neg_lo:[0,1,0] neg_hi:[0,1,0]
  v_pk_fma_f32 v[102:103], v[66:67], v[88:89], v[70:71] op_sel:[0,1,0] op_sel_hi:[1,1,1] neg_lo:[0,1,0] neg_hi:[0,1,0]
  v_pk_fma_f32 v[104:105], v[72:73], v[88:89], v[76:77] op_sel:[0,1,0] op_sel_hi:[1,1,1] neg_lo:[0,1,0] neg_hi:[0,1,0]
  v_pk_fma_f32 v[106:107], v[74:75], v[88:89], v[78:79] op_sel:[0,1,0] op_sel_hi:[1,1,1] neg_lo:[0,1,0] neg_hi:[0,1,0]
  v_pk_fma_f32 v[192:193], v[192:193], v[88:89], v[100:101] op_sel:[0,0,0] op_sel_hi:[1,0,1]
  v_pk_fma_f32 v[194:195], v[194:195], v[88:89], v[102:103] op_sel:[0,0,0] op_sel_hi:[1,0,1]
  v_pk_fma_f32 v[208:209], v[208:209], v[88:89], v[104:105] op_sel:[0,0,0] op_sel_hi:[1,0,1]
  v_pk_fma_f32 v[210:211], v[210:211], v[88:89], v[106:107] op_sel:[0,0,0] op_sel_hi:[1,0,1]
  v_pk_mul_f32 v[100:101], v[192:193], v[192:193]
  v_pk_mul_f32 v[102:103], v[194:195], v[194:195]
  v_pk_mul_f32 v[104:105], v[208:209], v[208:209]
  v_pk_mul_f32 v[106:107], v[210:211], v[210:211]
  v_pk_fma_f32 v[100:101], v[100:101], v[96:97], v[96:97] op_sel:[0,1,0] op_sel_hi:[1,1,0]
  v_pk_fma_f32 v[102:103], v[102:103], v[96:97], v[96:97] op_sel:[0,1,0] op_sel_hi:[1,1,0]
  v_pk_fma_f32 v[104:105], v[104:105], v[96:97], v[96:97] op_sel:[0,1,0] op_sel_hi:[1,1,0]
  v_pk_fma_f32 v[106:107], v[106:107], v[96:97], v[96:97] op_sel:[0,1,0] op_sel_hi:[1,1,0]
  v_pk_mul_f32 v[100:101], v[100:101], v[192:193]
  v_pk_mul_f32 v[102:103], v[102:103], v[194:195]
  v_pk_mul_f32 v[104:105], v[104:105], v[208:209]
  v_pk_mul_f32 v[106:107], v[106:107], v[210:211]
  v_exp_f32 v100, v100
  v_exp_f32 v101, v101
  v_exp_f32 v102, v102
  v_exp_f32 v103, v103
  v_exp_f32 v104, v104
  v_exp_f32 v105, v105
  v_exp_f32 v106, v106
  v_exp_f32 v107, v107
  v_pk_add_f32 v[100:101], v[100:101], v[98:99] op_sel_hi:[1,0]
  v_pk_add_f32 v[102:103], v[102:103], v[98:99] op_sel_hi:[1,0]
  v_pk_add_f32 v[104:105], v[104:105], v[98:99] op_sel_hi:[1,0]
  v_pk_add_f32 v[106:107], v[106:107], v[98:99] op_sel_hi:[1,0]
  v_rcp_f32 v100, v100
  v_rcp_f32 v101, v101
  v_rcp_f32 v102, v102
  v_rcp_f32 v103, v103
  v_rcp_f32 v104, v104
  v_rcp_f32 v105, v105
  v_rcp_f32 v106, v106
  v_rcp_f32 v107, v107
  v_pk_mul_f32 v[192:193], v[192:193], v[100:101]
  v_pk_mul_f32 v[194:195], v[194:195], v[102:103]
  v_pk_mul_f32 v[208:209], v[208:209], v[104:105]
  v_pk_mul_f32 v[210:211], v[210:211], v[106:107]
  v_cvt_pk_bf16_f32 v116, v192, v193
  v_cvt_pk_bf16_f32 v117, v194, v195
  v_cvt_pk_bf16_f32 v118, v208, v209
  v_cvt_pk_bf16_f32 v119, v210, v211
  buffer_store_dwordx4 v[116:119], v11, s[40:43], s6 offen offset:0 sc0 sc1
  v_pk_fma_f32 v[100:101], v[64:65], v[90:91], v[68:69] op_sel:[0,1,0] op_sel_hi:[1,1,1] neg_lo:[0,1,0] neg_hi:[0,1,0]
  v_pk_fma_f32 v[102:103], v[66:67], v[90:91], v[70:71] op_sel:[0,1,0] op_sel_hi:[1,1,1] neg_lo:[0,1,0] neg_hi:[0,1,0]
  v_pk_fma_f32 v[104:105], v[72:73], v[90:91], v[76:77] op_sel:[0,1,0] op_sel_hi:[1,1,1] neg_lo:[0,1,0] neg_hi:[0,1,0]
  v_pk_fma_f32 v[106:107], v[74:75], v[90:91], v[78:79] op_sel:[0,1,0] op_sel_hi:[1,1,1] neg_lo:[0,1,0] neg_hi:[0,1,0]
  v_pk_fma_f32 v[196:197], v[196:197], v[90:91], v[100:101] op_sel:[0,0,0] op_sel_hi:[1,0,1]
  v_pk_fma_f32 v[198:199], v[198:199], v[90:91], v[102:103] op_sel:[0,0,0] op_sel_hi:[1,0,1]
  v_pk_fma_f32 v[212:213], v[212:213], v[90:91], v[104:105] op_sel:[0,0,0] op_sel_hi:[1,0,1]
  v_pk_fma_f32 v[214:215], v[214:215], v[90:91], v[106:107] op_sel:[0,0,0] op_sel_hi:[1,0,1]
  v_pk_mul_f32 v[100:101], v[196:197], v[196:197]
  v_pk_mul_f32 v[102:103], v[198:199], v[198:199]
  v_pk_mul_f32 v[104:105], v[212:213], v[212:213]
  v_pk_mul_f32 v[106:107], v[214:215], v[214:215]
  v_pk_fma_f32 v[100:101], v[100:101], v[96:97], v[96:97] op_sel:[0,1,0] op_sel_hi:[1,1,0]
  v_pk_fma_f32 v[102:103], v[102:103], v[96:97], v[96:97] op_sel:[0,1,0] op_sel_hi:[1,1,0]
  v_pk_fma_f32 v[104:105], v[104:105], v[96:97], v[96:97] op_sel:[0,1,0] op_sel_hi:[1,1,0]
  v_pk_fma_f32 v[106:107], v[106:107], v[96:97], v[96:97] op_sel:[0,1,0] op_sel_hi:[1,1,0]
  v_pk_mul_f32 v[100:101], v[100:101], v[196:197]
  v_pk_mul_f32 v[102:103], v[102:103], v[198:199]
  v_pk_mul_f32 v[104:105], v[104:105], v[212:213]
  v_pk_mul_f32 v[106:107], v[106:107], v[214:215]
  v_exp_f32 v100, v100
  v_exp_f32 v101, v101
  v_exp_f32 v102, v102
  v_exp_f32 v103, v103
  v_exp_f32 v104, v104
  v_exp_f32 v105, v105
  v_exp_f32 v106, v106
  v_exp_f32 v107, v107
  v_pk_add_f32 v[100:101], v[100:101], v[98:99] op_sel_hi:[1,0]
  v_pk_add_f32 v[102:103], v[102:103], v[98:99] op_sel_hi:[1,0]
  v_pk_add_f32 v[104:105], v[104:105], v[98:99] op_sel_hi:[1,0]
  v_pk_add_f32 v[106:107], v[106:107], v[98:99] op_sel_hi:[1,0]
  v_rcp_f32 v100, v100
  v_rcp_f32 v101, v101
  v_rcp_f32 v102, v102
  v_rcp_f32 v103, v103
  v_rcp_f32 v104, v104
  v_rcp_f32 v105, v105
  v_rcp_f32 v106, v106
  v_rcp_f32 v107, v107
  v_pk_mul_f32 v[196:197], v[196:197], v[100:101]
  v_pk_mul_f32 v[198:199], v[198:199], v[102:103]
  v_pk_mul_f32 v[212:213], v[212:213], v[104:105]
  v_pk_mul_f32 v[214:215], v[214:215], v[106:107]
  v_cvt_pk_bf16_f32 v120, v196, v197
  v_cvt_pk_bf16_f32 v121, v198, v199
  v_cvt_pk_bf16_f32 v122, v212, v213
  v_cvt_pk_bf16_f32 v123, v214, v215
  buffer_store_dwordx4 v[120:123], v11, s[40:43], s6 offen offset:1024 sc0 sc1
  v_pk_fma_f32 v[100:101], v[64:65], v[92:93], v[68:69] op_sel:[0,1,0] op_sel_hi:[1,1,1] neg_lo:[0,1,0] neg_hi:[0,1,0]
  v_pk_fma_f32 v[102:103], v[66:67], v[92:93], v[70:71] op_sel:[0,1,0] op_sel_hi:[1,1,1] neg_lo:[0,1,0] neg_hi:[0,1,0]
  v_pk_fma_f32 v[104:105], v[72:73], v[92:93], v[76:77] op_sel:[0,1,0] op_sel_hi:[1,1,1] neg_lo:[0,1,0] neg_hi:[0,1,0]
  v_pk_fma_f32 v[106:107], v[74:75], v[92:93], v[78:79] op_sel:[0,1,0] op_sel_hi:[1,1,1] neg_lo:[0,1,0] neg_hi:[0,1,0]
  v_pk_fma_f32 v[200:201], v[200:201], v[92:93], v[100:101] op_sel:[0,0,0] op_sel_hi:[1,0,1]
  v_pk_fma_f32 v[202:203], v[202:203], v[92:93], v[102:103] op_sel:[0,0,0] op_sel_hi:[1,0,1]
  v_pk_fma_f32 v[216:217], v[216:217], v[92:93], v[104:105] op_sel:[0,0,0] op_sel_hi:[1,0,1]
  v_pk_fma_f32 v[218:219], v[218:219], v[92:93], v[106:107] op_sel:[0,0,0] op_sel_hi:[1,0,1]
  v_pk_mul_f32 v[100:101], v[200:201], v[200:201]
  v_pk_mul_f32 v[102:103], v[202:203], v[202:203]
  v_pk_mul_f32 v[104:105], v[216:217], v[216:217]
  v_pk_mul_f32 v[106:107], v[218:219], v[218:219]
  v_pk_fma_f32 v[100:101], v[100:101], v[96:97], v[96:97] op_sel:[0,1,0] op_sel_hi:[1,1,0]
  v_pk_fma_f32 v[102:103], v[102:103], v[96:97], v[96:97] op_sel:[0,1,0] op_sel_hi:[1,1,0]
  v_pk_fma_f32 v[104:105], v[104:105], v[96:97], v[96:97] op_sel:[0,1,0] op_sel_hi:[1,1,0]
  v_pk_fma_f32 v[106:107], v[106:107], v[96:97], v[96:97] op_sel:[0,1,0] op_sel_hi:[1,1,0]
  v_pk_mul_f32 v[100:101], v[100:101], v[200:201]
  v_pk_mul_f32 v[102:103], v[102:103], v[202:203]
  v_pk_mul_f32 v[104:105], v[104:105], v[216:217]
  v_pk_mul_f32 v[106:107], v[106:107], v[218:219]
  v_exp_f32 v100, v100
  v_exp_f32 v101, v101
  v_exp_f32 v102, v102
  v_exp_f32 v103, v103
  v_exp_f32 v104, v104
  v_exp_f32 v105, v105
  v_exp_f32 v106, v106
  v_exp_f32 v107, v107
  v_pk_add_f32 v[100:101], v[100:101], v[98:99] op_sel_hi:[1,0]
  v_pk_add_f32 v[102:103], v[102:103], v[98:99] op_sel_hi:[1,0]
  v_pk_add_f32 v[104:105], v[104:105], v[98:99] op_sel_hi:[1,0]
  v_pk_add_f32 v[106:107], v[106:107], v[98:99] op_sel_hi:[1,0]
  v_rcp_f32 v100, v100
  v_rcp_f32 v101, v101
  v_rcp_f32 v102, v102
  v_rcp_f32 v103, v103
  v_rcp_f32 v104, v104
  v_rcp_f32 v105, v105
  v_rcp_f32 v106, v106
  v_rcp_f32 v107, v107
  v_pk_mul_f32 v[200:201], v[200:201], v[100:101]
  v_pk_mul_f32 v[202:203], v[202:203], v[102:103]
  v_pk_mul_f32 v[216:217], v[216:217], v[104:105]
  v_pk_mul_f32 v[218:219], v[218:219], v[106:107]
  v_cvt_pk_bf16_f32 v116, v200, v201
  v_cvt_pk_bf16_f32 v117, v202, v203
  v_cvt_pk_bf16_f32 v118, v216, v217
  v_cvt_pk_bf16_f32 v119, v218, v219
  buffer_store_dwordx4 v[116:119], v11, s[40:43], s6 offen offset:2048 sc0 sc1
  v_pk_fma_f32 v[100:101], v[64:65], v[94:95], v[68:69] op_sel:[0,1,0] op_sel_hi:[1,1,1] neg_lo:[0,1,0] neg_hi:[0,1,0]
  v_pk_fma_f32 v[102:103], v[66:67], v[94:95], v[70:71] op_sel:[0,1,0] op_sel_hi:[1,1,1] neg_lo:[0,1,0] neg_hi:[0,1,0]
  v_pk_fma_f32 v[104:105], v[72:73], v[94:95], v[76:77] op_sel:[0,1,0] op_sel_hi:[1,1,1] neg_lo:[0,1,0] neg_hi:[0,1,0]
  v_pk_fma_f32 v[106:107], v[74:75], v[94:95], v[78:79] op_sel:[0,1,0] op_sel_hi:[1,1,1] neg_lo:[0,1,0] neg_hi:[0,1,0]
  v_pk_fma_f32 v[204:205], v[204:205], v[94:95], v[100:101] op_sel:[0,0,0] op_sel_hi:[1,0,1]
  v_pk_fma_f32 v[206:207], v[206:207], v[94:95], v[102:103] op_sel:[0,0,0] op_sel_hi:[1,0,1]
  v_pk_fma_f32 v[220:221], v[220:221], v[94:95], v[104:105] op_sel:[0,0,0] op_sel_hi:[1,0,1]
  v_pk_fma_f32 v[222:223], v[222:223], v[94:95], v[106:107] op_sel:[0,0,0] op_sel_hi:[1,0,1]
  v_pk_mul_f32 v[100:101], v[204:205], v[204:205]
  v_pk_mul_f32 v[102:103], v[206:207], v[206:207]
  v_pk_mul_f32 v[104:105], v[220:221], v[220:221]
  v_pk_mul_f32 v[106:107], v[222:223], v[222:223]
  v_pk_fma_f32 v[100:101], v[100:101], v[96:97], v[96:97] op_sel:[0,1,0] op_sel_hi:[1,1,0]
  v_pk_fma_f32 v[102:103], v[102:103], v[96:97], v[96:97] op_sel:[0,1,0] op_sel_hi:[1,1,0]
  v_pk_fma_f32 v[104:105], v[104:105], v[96:97], v[96:97] op_sel:[0,1,0] op_sel_hi:[1,1,0]
  v_pk_fma_f32 v[106:107], v[106:107], v[96:97], v[96:97] op_sel:[0,1,0] op_sel_hi:[1,1,0]
  v_pk_mul_f32 v[100:101], v[100:101], v[204:205]
  v_pk_mul_f32 v[102:103], v[102:103], v[206:207]
  v_pk_mul_f32 v[104:105], v[104:105], v[220:221]
  v_pk_mul_f32 v[106:107], v[106:107], v[222:223]
  v_exp_f32 v100, v100
  v_exp_f32 v101, v101
  v_exp_f32 v102, v102
  v_exp_f32 v103, v103
  v_exp_f32 v104, v104
  v_exp_f32 v105, v105
  v_exp_f32 v106, v106
  v_exp_f32 v107, v107
  v_pk_add_f32 v[100:101], v[100:101], v[98:99] op_sel_hi:[1,0]
  v_pk_add_f32 v[102:103], v[102:103], v[98:99] op_sel_hi:[1,0]
  v_pk_add_f32 v[104:105], v[104:105], v[98:99] op_sel_hi:[1,0]
  v_pk_add_f32 v[106:107], v[106:107], v[98:99] op_sel_hi:[1,0]
  v_rcp_f32 v100, v100
  v_rcp_f32 v101, v101
  v_rcp_f32 v102, v102
  v_rcp_f32 v103, v103
  v_rcp_f32 v104, v104
  v_rcp_f32 v105, v105
  v_rcp_f32 v106, v106
  v_rcp_f32 v107, v107
  v_pk_mul_f32 v[204:205], v[204:205], v[100:101]
  v_pk_mul_f32 v[206:207], v[206:207], v[102:103]
  v_pk_mul_f32 v[220:221], v[220:221], v[104:105]
  v_pk_mul_f32 v[222:223], v[222:223], v[106:107]
  v_cvt_pk_bf16_f32 v120, v204, v205
  v_cvt_pk_bf16_f32 v121, v206, v207
  v_cvt_pk_bf16_f32 v122, v220, v221
  v_cvt_pk_bf16_f32 v123, v222, v223
  buffer_store_dwordx4 v[120:123], v11, s[40:43], s6 offen offset:3072 sc0 sc1
  v_pk_fma_f32 v[100:101], v[80:81], v[88:89], v[84:85] op_sel:[0,1,0] op_sel_hi:[1,1,1] neg_lo:[0,1,0] neg_hi:[0,1,0]
  v_pk_fma_f32 v[102:103], v[82:83], v[88:89], v[86:87] op_sel:[0,1,0] op_sel_hi:[1,1,1] neg_lo:[0,1,0] neg_hi:[0,1,0]
  v_pk_fma_f32 v[104:105], v[80:81], v[90:91], v[84:85] op_sel:[0,1,0] op_sel_hi:[1,1,1] neg_lo:[0,1,0] neg_hi:[0,1,0]
  v_pk_fma_f32 v[106:107], v[82:83], v[90:91], v[86:87] op_sel:[0,1,0] op_sel_hi:[1,1,1] neg_lo:[0,1,0] neg_hi:[0,1,0]
  v_pk_fma_f32 v[224:225], v[224:225], v[88:89], v[100:101] op_sel:[0,0,0] op_sel_hi:[1,0,1]
  v_pk_fma_f32 v[226:227], v[226:227], v[88:89], v[102:103] op_sel:[0,0,0] op_sel_hi:[1,0,1]
  v_pk_fma_f32 v[228:229], v[228:229], v[90:91], v[104:105] op_sel:[0,0,0] op_sel_hi:[1,0,1]
  v_pk_fma_f32 v[230:231], v[230:231], v[90:91], v[106:107] op_sel:[0,0,0] op_sel_hi:[1,0,1]
  v_pk_mul_f32 v[100:101], v[224:225], v[224:225]
  v_pk_mul_f32 v[102:103], v[226:227], v[226:227]
  v_pk_mul_f32 v[104:105], v[228:229], v[228:229]
  v_pk_mul_f32 v[106:107], v[230:231], v[230:231]
  v_pk_fma_f32 v[100:101], v[100:101], v[96:97], v[96:97] op_sel:[0,1,0] op_sel_hi:[1,1,0]
  v_pk_fma_f32 v[102:103], v[102:103], v[96:97], v[96:97] op_sel:[0,1,0] op_sel_hi:[1,1,0]
  v_pk_fma_f32 v[104:105], v[104:105], v[96:97], v[96:97] op_sel:[0,1,0] op_sel_hi:[1,1,0]
  v_pk_fma_f32 v[106:107], v[106:107], v[96:97], v[96:97] op_sel:[0,1,0] op_sel_hi:[1,1,0]
  v_pk_mul_f32 v[100:101], v[100:101], v[224:225]
  v_pk_mul_f32 v[102:103], v[102:103], v[226:227]
  v_pk_mul_f32 v[104:105], v[104:105], v[228:229]
  v_pk_mul_f32 v[106:107], v[106:107], v[230:231]
  v_exp_f32 v100, v100
  v_exp_f32 v101, v101
  v_exp_f32 v102, v102
  v_exp_f32 v103, v103
  v_exp_f32 v104, v104
  v_exp_f32 v105, v105
  v_exp_f32 v106, v106
  v_exp_f32 v107, v107
  v_pk_add_f32 v[100:101], v[100:101], v[98:99] op_sel_hi:[1,0]
  v_pk_add_f32 v[102:103], v[102:103], v[98:99] op_sel_hi:[1,0]
  v_pk_add_f32 v[104:105], v[104:105], v[98:99] op_sel_hi:[1,0]
  v_pk_add_f32 v[106:107], v[106:107], v[98:99] op_sel_hi:[1,0]
  v_rcp_f32 v100, v100
  v_rcp_f32 v101, v101
  v_rcp_f32 v102, v102
  v_rcp_f32 v103, v103
  v_rcp_f32 v104, v104
  v_rcp_f32 v105, v105
  v_rcp_f32 v106, v106
  v_rcp_f32 v107, v107
  v_pk_mul_f32 v[224:225], v[224:225], v[100:101]
  v_pk_mul_f32 v[226:227], v[226:227], v[102:103]
  v_pk_mul_f32 v[228:229], v[228:229], v[104:105]
  v_pk_mul_f32 v[230:231], v[230:231], v[106:107]
  v_cvt_pk_bf16_f32 v116, v224, v225
  v_cvt_pk_bf16_f32 v117, v226, v227
  v_cvt_pk_bf16_f32 v118, v228, v229
  v_cvt_pk_bf16_f32 v119, v230, v231
  buffer_store_dwordx2 v[116:117], v11, s[40:43], s7 offen offset:0 sc0 sc1
  buffer_store_dwordx2 v[118:119], v11, s[40:43], s7 offen offset:1024 sc0 sc1
  v_pk_fma_f32 v[100:101], v[80:81], v[92:93], v[84:85] op_sel:[0,1,0] op_sel_hi:[1,1,1] neg_lo:[0,1,0] neg_hi:[0,1,0]
  v_pk_fma_f32 v[102:103], v[82:83], v[92:93], v[86:87] op_sel:[0,1,0] op_sel_hi:[1,1,1] neg_lo:[0,1,0] neg_hi:[0,1,0]
  v_pk_fma_f32 v[104:105], v[80:81], v[94:95], v[84:85] op_sel:[0,1,0] op_sel_hi:[1,1,1] neg_lo:[0,1,0] neg_hi:[0,1,0]
  v_pk_fma_f32 v[106:107], v[82:83], v[94:95], v[86:87] op_sel:[0,1,0] op_sel_hi:[1,1,1] neg_lo:[0,1,0] neg_hi:[0,1,0]
  v_pk_fma_f32 v[232:233], v[232:233], v[92:93], v[100:101] op_sel:[0,0,0] op_sel_hi:[1,0,1]
  v_pk_fma_f32 v[234:235], v[234:235], v[92:93], v[102:103] op_sel:[0,0,0] op_sel_hi:[1,0,1]
  v_pk_fma_f32 v[236:237], v[236:237], v[94:95], v[104:105] op_sel:[0,0,0] op_sel_hi:[1,0,1]
  v_pk_fma_f32 v[238:239], v[238:239], v[94:95], v[106:107] op_sel:[0,0,0] op_sel_hi:[1,0,1]
  v_pk_mul_f32 v[100:101], v[232:233], v[232:233]
  v_pk_mul_f32 v[102:103], v[234:235], v[234:235]
  v_pk_mul_f32 v[104:105], v[236:237], v[236:237]
  v_pk_mul_f32 v[106:107], v[238:239], v[238:239]
  v_pk_fma_f32 v[100:101], v[100:101], v[96:97], v[96:97] op_sel:[0,1,0] op_sel_hi:[1,1,0]
  v_pk_fma_f32 v[102:103], v[102:103], v[96:97], v[96:97] op_sel:[0,1,0] op_sel_hi:[1,1,0]
  v_pk_fma_f32 v[104:105], v[104:105], v[96:97], v[96:97] op_sel:[0,1,0] op_sel_hi:[1,1,0]
  v_pk_fma_f32 v[106:107], v[106:107], v[96:97], v[96:97] op_sel:[0,1,0] op_sel_hi:[1,1,0]
  v_pk_mul_f32 v[100:101], v[100:101], v[232:233]
  v_pk_mul_f32 v[102:103], v[102:103], v[234:235]
  v_pk_mul_f32 v[104:105], v[104:105], v[236:237]
  v_pk_mul_f32 v[106:107], v[106:107], v[238:239]
  v_exp_f32 v100, v100
  v_exp_f32 v101, v101
  v_exp_f32 v102, v102
  v_exp_f32 v103, v103
  v_exp_f32 v104, v104
  v_exp_f32 v105, v105
  v_exp_f32 v106, v106
  v_exp_f32 v107, v107
  v_pk_add_f32 v[100:101], v[100:101], v[98:99] op_sel_hi:[1,0]
  v_pk_add_f32 v[102:103], v[102:103], v[98:99] op_sel_hi:[1,0]
  v_pk_add_f32 v[104:105], v[104:105], v[98:99] op_sel_hi:[1,0]
  v_pk_add_f32 v[106:107], v[106:107], v[98:99] op_sel_hi:[1,0]
  v_rcp_f32 v100, v100
  v_rcp_f32 v101, v101
  v_rcp_f32 v102, v102
  v_rcp_f32 v103, v103
  v_rcp_f32 v104, v104
  v_rcp_f32 v105, v105
  v_rcp_f32 v106, v106
  v_rcp_f32 v107, v107
  v_pk_mul_f32 v[232:233], v[232:233], v[100:101]
  v_pk_mul_f32 v[234:235], v[234:235], v[102:103]
  v_pk_mul_f32 v[236:237], v[236:237], v[104:105]
  v_pk_mul_f32 v[238:239], v[238:239], v[106:107]
  v_cvt_pk_bf16_f32 v120, v232, v233
  v_cvt_pk_bf16_f32 v121, v234, v235
  v_cvt_pk_bf16_f32 v122, v236, v237
  v_cvt_pk_bf16_f32 v123, v238, v239
  buffer_store_dwordx2 v[120:121], v11, s[40:43], s7 offen offset:2048 sc0 sc1
  buffer_store_dwordx2 v[122:123], v11, s[40:43], s7 offen offset:3072 sc0 sc1
  s_add_u32 s5, s87, 256
  s_waitcnt vmcnt(0)
  s_mov_b64 exec, 1
  ds_add_rtn_u32 v2, v28, v27
  s_waitcnt lgkmcnt(0)
  v_readfirstlane_b32 s4, v2
  s_and_b32 s4, s4, 3
  s_cmp_lg_u32 s4, 3
  s_cbranch_scc1 Ls_14
  s_mov_b32 exec_lo, 0xffff
  buffer_store_dword v27, v24, s[40:43], s5 offen sc0 sc1
Ls_14:
  s_mov_b64 exec, -1
  s_mov_b32 s16, 0
  s_mov_b32 s17, 16384
  s_mov_b32 s18, 0xffff4000
  s_mov_b32 s19, 0
  s_mov_b32 s20, 16384
  s_mov_b32 s21, 0xffff0000
  s_mul_i32 s4, s85, 8192
  v_add_u32 v4, s4, v11
  v_add_u32 v5, 1024, v4
  s_lshl_b32 s4, s86, 1
  v_xor_b32 v2, s4, v26
  v_lshl_add_u32 v6, v2, 5, v25
  s_add_u32 s4, s4, 1
  v_xor_b32 v2, s4, v26
  v_lshl_add_u32 v7, v2, 5, v25
  s_mov_b32 s4, 0xffff0000
  v_lshlrev_b32 v128, 16, v240
  v_and_b32 v129, s4, v240
  v_lshlrev_b32 v130, 16, v241
  v_and_b32 v131, s4, v241
  v_lshlrev_b32 v132, 16, v242
  v_and_b32 v133, s4, v242
  v_lshlrev_b32 v134, 16, v243
  v_and_b32 v135, s4, v243
  v_lshlrev_b32 v136, 16, v244
  v_and_b32 v137, s4, v244
  v_lshlrev_b32 v138, 16, v245
  v_and_b32 v139, s4, v245
  v_lshlrev_b32 v140, 16, v246
  v_and_b32 v141, s4, v246
  v_lshlrev_b32 v142, 16, v247
  v_and_b32 v143, s4, v247
  v_lshlrev_b32 v144, 16, v248
  v_and_b32 v145, s4, v248
  v_lshlrev_b32 v146, 16, v249
  v_and_b32 v147, s4, v249
  v_lshlrev_b32 v148, 16, v250
  v_and_b32 v149, s4, v250
  v_lshlrev_b32 v150, 16, v251
  v_and_b32 v151, s4, v251
  v_lshlrev_b32 v152, 16, v252
  v_and_b32 v153, s4, v252
  v_lshlrev_b32 v154, 16, v253
  v_and_b32 v155, s4, v253
  v_lshlrev_b32 v156, 16, v254
  v_and_b32 v157, s4, v254
  v_lshlrev_b32 v158, 16, v255
  v_and_b32 v159, s4, v255
  s_lshl_b32 s5, s86, 7
  s_add_u32 s5, s5, 156160
  v_add_u32 v3, s5, v29
  ds_read_b128 v[32:35], v3
  ds_read_b128 v[36:39], v3 offset:64
  v_mov_b32 v160, 0
  v_mov_b32 v161, 0
  v_mov_b32 v162, 0
  v_mov_b32 v163, 0
  v_mov_b32 v164, 0
  v_mov_b32 v165, 0
  v_mov_b32 v166, 0
  v_mov_b32 v167, 0
  v_mov_b32 v168, 0
  v_mov_b32 v169, 0
  v_mov_b32 v170, 0
  v_mov_b32 v171, 0
  v_mov_b32 v172, 0
  v_mov_b32 v173, 0
  v_mov_b32 v174, 0
  v_mov_b32 v175, 0
  v_mov_b32 v176, 0
  v_mov_b32 v177, 0
  v_mov_b32 v178, 0
  v_mov_b32 v179, 0
  v_mov_b32 v180, 0
  v_mov_b32 v181, 0
  v_mov_b32 v182, 0
  v_mov_b32 v183, 0
  v_mov_b32 v184, 0
  v_mov_b32 v185, 0
  v_mov_b32 v186, 0
  v_mov_b32 v187, 0
  v_mov_b32 v188, 0
  v_mov_b32 v189, 0
  v_mov_b32 v190, 0
  v_mov_b32 v191, 0
  s_waitcnt lgkmcnt(0)
  v_pk_add_f32 v[128:129], v[128:129], v[32:33]
  v_pk_add_f32 v[130:131], v[130:131], v[34:35]
  v_pk_add_f32 v[132:133], v[132:133], v[36:37]
  v_pk_add_f32 v[134:135], v[134:135], v[38:39]
  v_pk_add_f32 v[136:137], v[136:137], v[32:33]
  v_pk_add_f32 v[138:139], v[138:139], v[34:35]
  v_pk_add_f32 v[140:141], v[140:141], v[36:37]
  v_pk_add_f32 v[142:143], v[142:143], v[38:39]
  v_pk_add_f32 v[144:145], v[144:145], v[32:33]
  v_pk_add_f32 v[146:147], v[146:147], v[34:35]
  v_pk_add_f32 v[148:149], v[148:149], v[36:37]
  v_pk_add_f32 v[150:151], v[150:151], v[38:39]
  v_pk_add_f32 v[152:153], v[152:153], v[32:33]
  v_pk_add_f32 v[154:155], v[154:155], v[34:35]
  v_pk_add_f32 v[156:157], v[156:157], v[36:37]
  v_pk_add_f32 v[158:159], v[158:159], v[38:39]
  s_mov_b32 s22, 28
  s_barrier
  ds_read_b64_tr_b16 v[48:49], v6 offset:0
  ds_read_b64_tr_b16 v[50:51], v6 offset:2048
  ds_read_b128 v[32:35], v4 offset:0
  ds_read_b128 v[36:39], v4 offset:2048
  ds_read_b128 v[40:43], v4 offset:4096
  ds_read_b128 v[44:47], v4 offset:6144
  ds_read_b64_tr_b16 v[52:53], v7 offset:0
  ds_read_b64_tr_b16 v[54:55], v7 offset:2048
  ds_read_b64_tr_b16 v[56:57], v6 offset:8192
  ds_read_b64_tr_b16 v[58:59], v6 offset:10240
  ds_read_b64_tr_b16 v[60:61], v7 offset:8192
  ds_read_b64_tr_b16 v[62:63], v7 offset:10240
Lk_15:
  s_waitcnt lgkmcnt(0)
  v_mfma_f32_16x16x32_bf16 v[128:131], v[48:51], v[32:35], v[128:131]
  ds_read_b64_tr_b16 v[92:93], v6 offset:4096
  ds_read_b64_tr_b16 v[94:95], v6 offset:6144
  v_mfma_f32_16x16x32_bf16 v[136:139], v[48:51], v[36:39], v[136:139]
  ds_read_b128 v[76:79], v5 offset:0
  ds_read_b128 v[80:83], v5 offset:2048
  v_mfma_f32_16x16x32_bf16 v[144:147], v[48:51], v[40:43], v[144:147]
  ds_read_b128 v[84:87], v5 offset:4096
  ds_read_b128 v[88:91], v5 offset:6144
  v_mfma_f32_16x16x32_bf16 v[152:155], v[48:51], v[44:47], v[152:155]
  ds_read_b64_tr_b16 v[96:97], v7 offset:4096
  ds_read_b64_tr_b16 v[98:99], v7 offset:6144
  v_mfma_f32_16x16x32_bf16 v[132:135], v[52:55], v[32:35], v[132:135]
  ds_read_b64_tr_b16 v[100:101], v6 offset:12288
  ds_read_b64_tr_b16 v[102:103], v6 offset:14336
  v_mfma_f32_16x16x32_bf16 v[140:143], v[52:55], v[36:39], v[140:143]
  ds_read_b64_tr_b16 v[104:105], v7 offset:12288
  ds_read_b64_tr_b16 v[106:107], v7 offset:14336
  v_mfma_f32_16x16x32_bf16 v[148:151], v[52:55], v[40:43], v[148:151]
  s_add_u32 s16, s16, s17
  s_cmp_eq_u32 s16, 65536
  s_cselect_b32 s23, s18, s17
  v_mfma_f32_16x16x32_bf16 v[156:159], v[52:55], v[44:47], v[156:159]
  s_cselect_b32 s16, 0, s16
  v_add_u32 v4, s23, v4
  v_add_u32 v5, s23, v5
  v_mfma_f32_16x16x32_bf16 v[160:163], v[56:59], v[32:35], v[160:163]
  s_add_u32 s19, s19, s20
  s_cmp_eq_u32 s19, 81920
  s_cselect_b32 s23, s21, s20
  v_mfma_f32_16x16x32_bf16 v[168:171], v[56:59], v[36:39], v[168:171]
  s_cselect_b32 s19, 0, s19
  v_add_u32 v6, s23, v6
  v_add_u32 v7, s23, v7
  v_mfma_f32_16x16x32_bf16 v[176:179], v[56:59], v[40:43], v[176:179]
  v_mfma_f32_16x16x32_bf16 v[184:187], v[56:59], v[44:47], v[184:187]
  v_mfma_f32_16x16x32_bf16 v[164:167], v[60:63], v[32:35], v[164:167]
  v_mfma_f32_16x16x32_bf16 v[172:175], v[60:63], v[36:39], v[172:175]
  v_mfma_f32_16x16x32_bf16 v[180:183], v[60:63], v[40:43], v[180:183]
  v_mfma_f32_16x16x32_bf16 v[188:191], v[60:63], v[44:47], v[188:191]
  s_waitcnt lgkmcnt(0)
  s_barrier
  v_mfma_f32_16x16x32_bf16 v[128:131], v[92:95], v[76:79], v[128:131]
  ds_read_b64_tr_b16 v[48:49], v6 offset:0
  ds_read_b64_tr_b16 v[50:51], v6 offset:2048
  v_mfma_f32_16x16x32_bf16 v[136:139], v[92:95], v[80:83], v[136:139]
  ds_read_b128 v[32:35], v4 offset:0
  ds_read_b128 v[36:39], v4 offset:2048
  v_mfma_f32_16x16x32_bf16 v[144:147], v[92:95], v[84:87], v[144:147]
  ds_read_b128 v[40:43], v4 offset:4096
  ds_read_b128 v[44:47], v4 offset:6144
  v_mfma_f32_16x16x32_bf16 v[152:155], v[92:95], v[88:91], v[152:155]
  ds_read_b64_tr_b16 v[52:53], v7 offset:0
  ds_read_b64_tr_b16 v[54:55], v7 offset:2048
  v_mfma_f32_16x16x32_bf16 v[132:135], v[96:99], v[76:79], v[132:135]
  ds_read_b64_tr_b16 v[56:57], v6 offset:8192
  ds_read_b64_tr_b16 v[58:59], v6 offset:10240
  v_mfma_f32_16x16x32_bf16 v[140:143], v[96:99], v[80:83], v[140:143]
  ds_read_b64_tr_b16 v[60:61], v7 offset:8192
  ds_read_b64_tr_b16 v[62:63], v7 offset:10240
  v_mfma_f32_16x16x32_bf16 v[148:151], v[96:99], v[84:87], v[148:151]
  s_sub_u32 s22, s22, 1
  s_cmp_lg_u32 s22, 0
  v_mfma_f32_16x16x32_bf16 v[156:159], v[96:99], v[88:91], v[156:159]
  v_mfma_f32_16x16x32_bf16 v[160:163], v[100:103], v[76:79], v[160:163]
  v_mfma_f32_16x16x32_bf16 v[168:171], v[100:103], v[80:83], v[168:171]
  v_mfma_f32_16x16x32_bf16 v[176:179], v[100:103], v[84:87], v[176:179]
  v_mfma_f32_16x16x32_bf16 v[184:187], v[100:103], v[88:91], v[184:187]
  v_mfma_f32_16x16x32_bf16 v[164:167], v[104:107], v[76:79], v[164:167]
  v_mfma_f32_16x16x32_bf16 v[172:175], v[104:107], v[80:83], v[172:175]
  v_mfma_f32_16x16x32_bf16 v[180:183], v[104:107], v[84:87], v[180:183]
  v_mfma_f32_16x16x32_bf16 v[188:191], v[104:107], v[88:91], v[188:191]
  s_cbranch_scc1 Lk_15
  s_xor_b32 s8, s84, 16384
  s_lshl_b32 s6, s8, 4
  s_lshl_b32 s7, s81, 13
  s_add_u32 s7, s7, s83
  s_add_u32 s7, s7, 23068672
  s_add_u32 s6, s6, s7
  s_add_u32 s9, s6, 4096
  buffer_store_dwordx4 v[160:163], v11, s[40:43], s6 offen offset:0 sc0 sc1
  buffer_store_dwordx4 v[164:167], v11, s[40:43], s6 offen offset:1024 sc0 sc1
  buffer_store_dwordx4 v[168:171], v11, s[40:43], s6 offen offset:2048 sc0 sc1
  buffer_store_dwordx4 v[172:175], v11, s[40:43], s6 offen offset:3072 sc0 sc1
  buffer_store_dwordx4 v[176:179], v11, s[40:43], s9 offen offset:0 sc0 sc1
  buffer_store_dwordx4 v[180:183], v11, s[40:43], s9 offen offset:1024 sc0 sc1
  buffer_store_dwordx4 v[184:187], v11, s[40:43], s9 offen offset:2048 sc0 sc1
  buffer_store_dwordx4 v[188:191], v11, s[40:43], s9 offen offset:3072 sc0 sc1
  s_add_u32 s8, s8, s87
  s_lshl_b32 s4, s81, 2
  s_add_u32 s8, s8, s4
  s_add_u32 s8, s8, 384
  s_xor_b32 s10, s8, 16384
  s_lshl_b32 s6, s84, 4
  s_add_u32 s6, s6, s7
  s_add_u32 s9, s6, 4096
  v_mov_b32 v2, 0
  s_waitcnt vmcnt(0) lgkmcnt(0)
  s_mov_b64 exec, 1
  buffer_store_dword v27, v2, s[40:43], s8 offen sc0 sc1
  s_mov_b32 s89, 200000
Lp_16:
  buffer_load_dword v3, v2, s[40:43], s10 offen sc0 sc1
  s_waitcnt vmcnt(0)
Lp_17:
  v_cmp_ne_u32 vcc, 0, v3
  s_andn2_b32 s3, 1, vcc_lo
  s_cbranch_scc0 Lp_18
  s_sleep 1
  s_sub_u32 s89, s89, 1
  s_cbranch_scc0 Lp_16
Lp_18:
  s_mov_b64 exec, -1
  buffer_load_dwordx4 v[32:35], v11, s[40:43], s6 offen offset:0 sc0 sc1
  buffer_load_dwordx4 v[36:39], v11, s[40:43], s6 offen offset:1024 sc0 sc1
  buffer_load_dwordx4 v[40:43], v11, s[40:43], s6 offen offset:2048 sc0 sc1
  buffer_load_dwordx4 v[44:47], v11, s[40:43], s6 offen offset:3072 sc0 sc1
  buffer_load_dwordx4 v[48:51], v11, s[40:43], s9 offen offset:0 sc0 sc1
  buffer_load_dwordx4 v[52:55], v11, s[40:43], s9 offen offset:1024 sc0 sc1
  buffer_load_dwordx4 v[56:59], v11, s[40:43], s9 offen offset:2048 sc0 sc1
  buffer_load_dwordx4 v[60:63], v11, s[40:43], s9 offen offset:3072 sc0 sc1
  s_waitcnt vmcnt(7)
  v_pk_add_f32 v[128:129], v[128:129], v[32:33]
  v_pk_add_f32 v[130:131], v[130:131], v[34:35]
  s_waitcnt vmcnt(6)
  v_pk_add_f32 v[132:133], v[132:133], v[36:37]
  v_pk_add_f32 v[134:135], v[134:135], v[38:39]
  s_waitcnt vmcnt(5)
  v_pk_add_f32 v[136:137], v[136:137], v[40:41]
  v_pk_add_f32 v[138:139], v[138:139], v[42:43]
  s_waitcnt vmcnt(4)
  v_pk_add_f32 v[140:141], v[140:141], v[44:45]
  v_pk_add_f32 v[142:143], v[142:143], v[46:47]
  s_waitcnt vmcnt(3)
  v_pk_add_f32 v[144:145], v[144:145], v[48:49]
  v_pk_add_f32 v[146:147], v[146:147], v[50:51]
  s_waitcnt vmcnt(2)
  v_pk_add_f32 v[148:149], v[148:149], v[52:53]
  v_pk_add_f32 v[150:151], v[150:151], v[54:55]
  s_waitcnt vmcnt(1)
  v_pk_add_f32 v[152:153], v[152:153], v[56:57]
  v_pk_add_f32 v[154:155], v[154:155], v[58:59]
  s_waitcnt vmcnt(0)
  v_pk_add_f32 v[156:157], v[156:157], v[60:61]
  v_pk_add_f32 v[158:159], v[158:159], v[62:63]
  v_cvt_pk_bf16_f32 v240, v128, v129
  v_cvt_pk_bf16_f32 v241, v130, v131
  v_cvt_pk_bf16_f32 v242, v132, v133
  v_cvt_pk_bf16_f32 v243, v134, v135
  v_cvt_pk_bf16_f32 v244, v136, v137
  v_cvt_pk_bf16_f32 v245, v138, v139
  v_cvt_pk_bf16_f32 v246, v140, v141
  v_cvt_pk_bf16_f32 v247, v142, v143
  v_cvt_pk_bf16_f32 v248, v144, v145
  v_cvt_pk_bf16_f32 v249, v146, v147
  v_cvt_pk_bf16_f32 v250, v148, v149
  v_cvt_pk_bf16_f32 v251, v150, v151
  v_cvt_pk_bf16_f32 v252, v152, v153
  v_cvt_pk_bf16_f32 v253, v154, v155
  v_cvt_pk_bf16_f32 v254, v156, v157
  v_cvt_pk_bf16_f32 v255, v158, v159
  s_cmp_lg_u32 s82, 0
  s_cbranch_scc1 L_cfinal
  s_lshl_b32 s4, s76, 5
  s_lshl_b32 s5, s78, 1
  s_add_u32 s4, s4, s5
  s_add_u32 s4, s4, s86
  s_lshl_b32 s6, s4, 13
  s_lshl_b32 s7, s85, 12
  s_add_u32 s6, s6, s7
  s_add_u32 s6, s6, s83
  s_add_u32 s6, s6, 32505856
  buffer_store_dwordx4 v[240:243], v11, s[40:43], s6 offen offset:0 sc0 sc1
  buffer_store_dwordx4 v[244:247], v11, s[40:43], s6 offen offset:1024 sc0 sc1
  buffer_store_dwordx4 v[248:251], v11, s[40:43], s6 offen offset:2048 sc0 sc1
  buffer_store_dwordx4 v[252:255], v11, s[40:43], s6 offen offset:3072 sc0 sc1
  v_mov_b32 v40, 0x3f803f80
  v_dot2_f32_bf16 v32, v240, v40, 0
  v_dot2_f32_bf16 v36, v240, v240, 0
  v_dot2_f32_bf16 v33, v244, v40, 0
  v_dot2_f32_bf16 v37, v244, v244, 0
  v_dot2_f32_bf16 v34, v248, v40, 0
  v_dot2_f32_bf16 v38, v248, v248, 0
  v_dot2_f32_bf16 v35, v252, v40, 0
  v_dot2_f32_bf16 v39, v252, v252, 0
  v_dot2_f32_bf16 v32, v241, v40, v32
  v_dot2_f32_bf16 v36, v241, v241, v36
  v_dot2_f32_bf16 v33, v245, v40, v33
  v_dot2_f32_bf16 v37, v245, v245, v37
  v_dot2_f32_bf16 v34, v249, v40, v34
  v_dot2_f32_bf16 v38, v249, v249, v38
  v_dot2_f32_bf16 v35, v253, v40, v35
  v_dot2_f32_bf16 v39, v253, v253, v39
  v_dot2_f32_bf16 v32, v242, v40, v32
  v_dot2_f32_bf16 v36, v242, v242, v36
  v_dot2_f32_bf16 v33, v246, v40, v33
  v_dot2_f32_bf16 v37, v246, v246, v37
  v_dot2_f32_bf16 v34, v250, v40, v34
  v_dot2_f32_bf16 v38, v250, v250, v38
  v_dot2_f32_bf16 v35, v254, v40, v35
  v_dot2_f32_bf16 v39, v254, v254, v39
  v_dot2_f32_bf16 v32, v243, v40, v32
  v_dot2_f32_bf16 v36, v243, v243, v36
  v_dot2_f32_bf16 v33, v247, v40, v33
  v_dot2_f32_bf16 v37, v247, v247, v37
  v_dot2_f32_bf16 v34, v251, v40, v34
  v_dot2_f32_bf16 v38, v251, v251, v38
  v_dot2_f32_bf16 v35, v255, v40, v35
  v_dot2_f32_bf16 v39, v255, v255, v39
  s_lshl_b32 s6, s76, 6
  s_lshl_b32 s7, s85, 5
  s_add_u32 s6, s6, s7
  s_add_u32 s6, s6, s5
  s_add_u32 s6, s6, s86
  s_lshl_b32 s6, s6, 9
  s_add_u32 s6, s6, s83
  s_add_u32 s6, s6, 36700160
  v_permlane32_swap_b32 v32, v34
  v_permlane32_swap_b32 v33, v35
  v_permlane32_swap_b32 v36, v38
  v_permlane32_swap_b32 v37, v39
  v_add_f32 v32, v32, v34
  v_add_f32 v33, v33, v35
  v_add_f32 v36, v36, v38
  v_add_f32 v37, v37, v39
  v_permlane16_swap_b32 v32, v33
  s_nop 0
  v_permlane16_swap_b32 v36, v37
  v_add_f32 v42, v32, v33
  v_add_f32 v43, v36, v37
  buffer_store_dwordx2 v[42:43], v30, s[40:43], s6 offen sc0 sc1
  s_add_u32 s5, s87, 512
  s_waitcnt vmcnt(0)
  s_mov_b64 exec, 1
  ds_add_rtn_u32 v2, v28, v27
  s_waitcnt lgkmcnt(0)
  v_readfirstlane_b32 s4, v2
  s_and_b32 s4, s4, 3
  s_cmp_lg_u32 s4, 3
  s_cbranch_scc1 Ls_19
  s_mov_b32 exec_lo, 0xffffffff
  buffer_store_dword v27, v24, s[40:43], s5 offen sc0 sc1
Ls_19:
  s_mov_b64 exec, -1
  s_mov_b32 s82, 1
  s_add_u32 s83, s83, 37748736
  s_add_u32 s87, s87, 640
  s_branch L_clayer
L_cfinal:
  s_nop 1
  v_permlane16_swap_b32 v240, v242
  v_permlane16_swap_b32 v241, v243
  v_permlane16_swap_b32 v244, v246
  v_permlane16_swap_b32 v245, v247
  v_permlane16_swap_b32 v248, v250
  v_permlane16_swap_b32 v249, v251
  v_permlane16_swap_b32 v252, v254
  v_permlane16_swap_b32 v253, v255
  v_and_b32 v2, 15, v1
  v_lshlrev_b32 v3, 12, v2
  v_and_b32 v2, 16, v1
  v_lshl_add_u32 v3, v2, 1, v3
  v_and_b32 v2, 32, v1
  v_lshrrev_b32 v2, 1, v2
  v_add_u32 v3, v2, v3
  s_lshl_b32 s5, s76, 18
  s_lshl_b32 s4, s85, 11
  s_add_u32 s5, s5, s4
  s_lshl_b32 s4, s78, 7
  s_add_u32 s5, s5, s4
  s_lshl_b32 s4, s86, 6
  s_add_u32 s5, s5, s4
  buffer_store_dwordx4 v[240:243], v3, s[64:67], s5 offen
  s_add_u32 s5, s5, 0x10000
  buffer_store_dwordx4 v[244:247], v3, s[64:67], s5 offen
  s_add_u32 s5, s5, 0x10000
  buffer_store_dwordx4 v[248:251], v3, s[64:67], s5 offen
  s_add_u32 s5, s5, 0x10000
  buffer_store_dwordx4 v[252:255], v3, s[64:67], s5 offen
  s_endpgm
L_xload:
  v_lshrrev_b32 v2, 3, v1
  v_lshlrev_b32 v3, 12, v2
  v_and_b32 v2, 7, v1
  v_lshl_add_u32 v3, v2, 4, v3
  s_lshl_b32 s5, s76, 18
  s_lshl_b32 s4, s85, 11
  s_add_u32 s5, s5, s4
  s_lshl_b32 s4, s78, 7
  s_add_u32 s6, s5, s4
  buffer_load_dwordx4 v[32:35], v3, s[44:47], s6 offen
  s_add_u32 s6, s6, 0x8000
  buffer_load_dwordx4 v[36:39], v3, s[44:47], s6 offen
  s_add_u32 s6, s6, 0x8000
  buffer_load_dwordx4 v[40:43], v3, s[44:47], s6 offen
  s_add_u32 s6, s6, 0x8000
  buffer_load_dwordx4 v[44:47], v3, s[44:47], s6 offen
  s_add_u32 s6, s6, 0x8000
  buffer_load_dwordx4 v[48:51], v3, s[44:47], s6 offen
  s_add_u32 s6, s6, 0x8000
  buffer_load_dwordx4 v[52:55], v3, s[44:47], s6 offen
  s_add_u32 s6, s6, 0x8000
  buffer_load_dwordx4 v[56:59], v3, s[44:47], s6 offen
  s_add_u32 s6, s6, 0x8000
  buffer_load_dwordx4 v[60:63], v3, s[44:47], s6 offen
  v_lshrrev_b32 v2, 4, v1
  v_and_b32 v3, 7, v1
  v_xor_b32 v2, v2, v3
  v_lshrrev_b32 v3, 3, v1
  v_lshlrev_b32 v3, 12, v3
  v_lshl_add_u32 v4, v2, 4, v3
  v_add_u32 v6, 63488, v4
  v_lshrrev_b32 v2, 4, v1
  v_add_u32 v2, 4, v2
  v_and_b32 v3, 7, v1
  v_xor_b32 v2, v2, v3
  v_lshrrev_b32 v3, 3, v1
  v_lshlrev_b32 v3, 12, v3
  v_lshl_add_u32 v5, v2, 4, v3
  v_add_u32 v5, 31744, v5
  v_add_u32 v7, 63488, v5
  s_mov_b32 s23, 0x20000
  s_mov_b32 s24, 0xffff0000
  s_mov_b32 s17, 128
  s_mul_i32 s19, s17, 16
  s_add_u32 s18, s5, s19
  s_mov_b32 s6, s76
  s_mul_i32 s6, s6, s17
  s_add_u32 s16, s5, s6
  s_mov_b32 s22, 2
  s_lshl_b32 s27, s85, 7
  s_add_u32 s27, s27, s84
  s_mov_b32 s28, 1638400
  v_lshlrev_b32 v13, 4, v1
  v_and_b32 v2, 31, v1
  v_lshlrev_b32 v8, 2, v2
  v_and_b32 v2, 15, v1
  v_lshlrev_b32 v10, 4, v2
  v_mov_b32 v14, 1
  s_lshl_b32 s4, s76, 15
  s_lshl_b32 s5, s77, 2
  s_add_u32 s4, s4, s5
  v_lshlrev_b32 v12, 11, v1
  v_and_b32 v2, 16, v1
  v_lshl_add_u32 v12, v2, 2, v12
  v_add_u32 v12, s4, v12
  v_lshrrev_b32 v2, 3, v1
  v_lshlrev_b32 v15, 9, v2
  v_and_b32 v2, 7, v1
  v_lshl_add_u32 v15, v2, 4, v15
  v_add_u32 v15, 384, v15
  v_lshlrev_b32 v2, 3, v2
  v_add_u32 v2, 256, v2
  v_lshlrev_b32 v3, 3, v1
  v_cmp_gt_u32 vcc, 32, v1
  s_nop 1
  v_cndmask_b32 v16, v2, v3, vcc
  s_mul_i32 s4, s85, 320
  s_add_u32 s4, s4, 151552
  v_add_u32 v16, s4, v16
L_xlayer:
  s_mul_i32 s20, s85, 10240
  s_add_u32 s25, s20, 61440
  s_cmp_eq_u32 s76, 0
  s_cselect_b32 s24, 0x70000000, s24
  s_mov_b32 s29, 0xffff8000
  s_cselect_b32 s29, 0x70000000, s29
  s_cselect_b32 s26, 0xffff, -1
  s_mov_b32 m0, s20
  s_add_u32 s5, s16, s23
  buffer_load_dwordx4 v4, s[72:75], s16 offen offset:0 sc1 lds
  buffer_load_dwordx4 v5, s[72:75], s16 offen offset:1024 sc1 lds
  buffer_load_dwordx4 v6, s[72:75], s16 offen offset:2048 sc1 lds
  buffer_load_dwordx4 v7, s[72:75], s16 offen offset:3072 sc1 lds
  s_add_u32 m0, s20, 4096
  s_add_u32 s6, s16, s24
  buffer_load_dwordx4 v4, s[72:75], s5 offen offset:0 sc1 lds
  buffer_load_dwordx4 v5, s[72:75], s5 offen offset:1024 sc1 lds
  buffer_load_dwordx4 v6, s[72:75], s5 offen offset:2048 sc1 lds
  buffer_load_dwordx4 v7, s[72:75], s5 offen offset:3072 sc1 lds
  s_add_u32 m0, s20, 8192
  s_nop 0
  buffer_load_dwordx4 v4, s[72:75], s6 offen offset:0 sc1 lds
  buffer_load_dwordx4 v5, s[72:75], s6 offen offset:1024 sc1 lds
  s_add_u32 s16, s16, s17
  s_cmp_eq_u32 s16, s18
  s_cselect_b32 s4, s19, 0
  s_sub_u32 s16, s16, s4
  s_add_u32 s20, s20, 20480
  s_cmp_eq_u32 s20, s25
  s_cselect_b32 s4, 61440, 0
  s_sub_u32 s20, s20, s4
  s_mov_b32 m0, s20
  s_add_u32 s5, s16, s23
  buffer_load_dwordx4 v4, s[72:75], s16 offen offset:0 sc1 lds
  buffer_load_dwordx4 v5, s[72:75], s16 offen offset:1024 sc1 lds
  buffer_load_dwordx4 v6, s[72:75], s16 offen offset:2048 sc1 lds
  buffer_load_dwordx4 v7, s[72:75], s16 offen offset:3072 sc1 lds
  s_add_u32 m0, s20, 4096
  s_add_u32 s6, s16, s24
  buffer_load_dwordx4 v4, s[72:75], s5 offen offset:0 sc1 lds
  buffer_load_dwordx4 v5, s[72:75], s5 offen offset:1024 sc1 lds
  buffer_load_dwordx4 v6, s[72:75], s5 offen offset:2048 sc1 lds
  buffer_load_dwordx4 v7, s[72:75], s5 offen offset:3072 sc1 lds
  s_add_u32 m0, s20, 8192
  s_nop 0
  buffer_load_dwordx4 v4, s[72:75], s6 offen offset:0 sc1 lds
  buffer_load_dwordx4 v5, s[72:75], s6 offen offset:1024 sc1 lds
  s_add_u32 s16, s16, s17
  s_cmp_eq_u32 s16, s18
  s_cselect_b32 s4, s19, 0
  s_sub_u32 s16, s16, s4
  s_add_u32 s20, s20, 20480
  s_cmp_eq_u32 s20, s25
  s_cselect_b32 s4, 61440, 0
  s_sub_u32 s20, s20, s4
  s_mov_b32 m0, s20
  s_add_u32 s5, s16, s23
  buffer_load_dwordx4 v4, s[72:75], s16 offen offset:0 sc1 lds
  buffer_load_dwordx4 v5, s[72:75], s16 offen offset:1024 sc1 lds
  buffer_load_dwordx4 v6, s[72:75], s16 offen offset:2048 sc1 lds
  buffer_load_dwordx4 v7, s[72:75], s16 offen offset:3072 sc1 lds
  s_add_u32 m0, s20, 4096
  s_add_u32 s6, s16, s24
  buffer_load_dwordx4 v4, s[72:75], s5 offen offset:0 sc1 lds
  buffer_load_dwordx4 v5, s[72:75], s5 offen offset:1024 sc1 lds
  buffer_load_dwordx4 v6, s[72:75], s5 offen offset:2048 sc1 lds
  buffer_load_dwordx4 v7, s[72:75], s5 offen offset:3072 sc1 lds
  s_add_u32 m0, s20, 8192
  s_nop 0
  buffer_load_dwordx4 v4, s[72:75], s6 offen offset:0 sc1 lds
  buffer_load_dwordx4 v5, s[72:75], s6 offen offset:1024 sc1 lds
  s_add_u32 s16, s16, s17
  s_cmp_eq_u32 s16, s18
  s_cselect_b32 s4, s19, 0
  s_sub_u32 s16, s16, s4
  s_add_u32 s20, s20, 20480
  s_cmp_eq_u32 s20, s25
  s_cselect_b32 s4, 61440, 0
  s_sub_u32 s20, s20, s4
  s_cmp_lg_u32 s82, 0
  s_cbranch_scc1 L_20
  s_waitcnt vmcnt(30)
  v_mov_b32 v100, 0x3f803f80
  v_dot2_f32_bf16 v64, v32, v100, 0
  v_dot2_f32_bf16 v72, v32, v32, 0
  v_dot2_f32_bf16 v65, v36, v100, 0
  v_dot2_f32_bf16 v73, v36, v36, 0
  v_dot2_f32_bf16 v66, v40, v100, 0
  v_dot2_f32_bf16 v74, v40, v40, 0
  v_dot2_f32_bf16 v67, v44, v100, 0
  v_dot2_f32_bf16 v75, v44, v44, 0
  v_dot2_f32_bf16 v68, v48, v100, 0
  v_dot2_f32_bf16 v76, v48, v48, 0
  v_dot2_f32_bf16 v69, v52, v100, 0
  v_dot2_f32_bf16 v77, v52, v52, 0
  v_dot2_f32_bf16 v70, v56, v100, 0
  v_dot2_f32_bf16 v78, v56, v56, 0
  v_dot2_f32_bf16 v71, v60, v100, 0
  v_dot2_f32_bf16 v79, v60, v60, 0
  v_dot2_f32_bf16 v64, v33, v100, v64
  v_dot2_f32_bf16 v72, v33, v33, v72
  v_dot2_f32_bf16 v65, v37, v100, v65
  v_dot2_f32_bf16 v73, v37, v37, v73
  v_dot2_f32_bf16 v66, v41, v100, v66
  v_dot2_f32_bf16 v74, v41, v41, v74
  v_dot2_f32_bf16 v67, v45, v100, v67
  v_dot2_f32_bf16 v75, v45, v45, v75
  v_dot2_f32_bf16 v68, v49, v100, v68
  v_dot2_f32_bf16 v76, v49, v49, v76
  v_dot2_f32_bf16 v69, v53, v100, v69
  v_dot2_f32_bf16 v77, v53, v53, v77
  v_dot2_f32_bf16 v70, v57, v100, v70
  v_dot2_f32_bf16 v78, v57, v57, v78
  v_dot2_f32_bf16 v71, v61, v100, v71
  v_dot2_f32_bf16 v79, v61, v61, v79
  v_dot2_f32_bf16 v64, v34, v100, v64
  v_dot2_f32_bf16 v72, v34, v34, v72
  v_dot2_f32_bf16 v65, v38, v100, v65
  v_dot2_f32_bf16 v73, v38, v38, v73
  v_dot2_f32_bf16 v66, v42, v100, v66
  v_dot2_f32_bf16 v74, v42, v42, v74
  v_dot2_f32_bf16 v67, v46, v100, v67
  v_dot2_f32_bf16 v75, v46, v46, v75
  v_dot2_f32_bf16 v68, v50, v100, v68
  v_dot2_f32_bf16 v76, v50, v50, v76
  v_dot2_f32_bf16 v69, v54, v100, v69
  v_dot2_f32_bf16 v77, v54, v54, v77
  v_dot2_f32_bf16 v70, v58, v100, v70
  v_dot2_f32_bf16 v78, v58, v58, v78
  v_dot2_f32_bf16 v71, v62, v100, v71
  v_dot2_f32_bf16 v79, v62, v62, v79
  v_dot2_f32_bf16 v64, v35, v100, v64
  v_dot2_f32_bf16 v72, v35, v35, v72
  v_dot2_f32_bf16 v65, v39, v100, v65
  v_dot2_f32_bf16 v73, v39, v39, v73
  v_dot2_f32_bf16 v66, v43, v100, v66
  v_dot2_f32_bf16 v74, v43, v43, v74
  v_dot2_f32_bf16 v67, v47, v100, v67
  v_dot2_f32_bf16 v75, v47, v47, v75
  v_dot2_f32_bf16 v68, v51, v100, v68
  v_dot2_f32_bf16 v76, v51, v51, v76
  v_dot2_f32_bf16 v69, v55, v100, v69
  v_dot2_f32_bf16 v77, v55, v55, v77
  v_dot2_f32_bf16 v70, v59, v100, v70
  v_dot2_f32_bf16 v78, v59, v59, v78
  v_dot2_f32_bf16 v71, v63, v100, v71
  v_dot2_f32_bf16 v79, v63, v63, v79
  v_add_f32_dpp v64, v64, v64 quad_perm:[1,0,3,2] row_mask:0xf bank_mask:0xf
  v_add_f32_dpp v65, v65, v65 quad_perm:[1,0,3,2] row_mask:0xf bank_mask:0xf
  v_add_f32_dpp v66, v66, v66 quad_perm:[1,0,3,2] row_mask:0xf bank_mask:0xf
  v_add_f32_dpp v67, v67, v67 quad_perm:[1,0,3,2] row_mask:0xf bank_mask:0xf
  v_add_f32_dpp v68, v68, v68 quad_perm:[1,0,3,2] row_mask:0xf bank_mask:0xf
  v_add_f32_dpp v69, v69, v69 quad_perm:[1,0,3,2] row_mask:0xf bank_mask:0xf
  v_add_f32_dpp v70, v70, v70 quad_perm:[1,0,3,2] row_mask:0xf bank_mask:0xf
  v_add_f32_dpp v71, v71, v71 quad_perm:[1,0,3,2] row_mask:0xf bank_mask:0xf
  v_add_f32_dpp v72, v72, v72 quad_perm:[1,0,3,2] row_mask:0xf bank_mask:0xf
  v_add_f32_dpp v73, v73, v73 quad_perm:[1,0,3,2] row_mask:0xf bank_mask:0xf
  v_add_f32_dpp v74, v74, v74 quad_perm:[1,0,3,2] row_mask:0xf bank_mask:0xf
  v_add_f32_dpp v75, v75, v75 quad_perm:[1,0,3,2] row_mask:0xf bank_mask:0xf
  v_add_f32_dpp v76, v76, v76 quad_perm:[1,0,3,2] row_mask:0xf bank_mask:0xf
  v_add_f32_dpp v77, v77, v77 quad_perm:[1,0,3,2] row_mask:0xf bank_mask:0xf
  v_add_f32_dpp v78, v78, v78 quad_perm:[1,0,3,2] row_mask:0xf bank_mask:0xf
  v_add_f32_dpp v79, v79, v79 quad_perm:[1,0,3,2] row_mask:0xf bank_mask:0xf
  v_add_f32_dpp v64, v64, v64 quad_perm:[2,3,0,1] row_mask:0xf bank_mask:0xf
  v_add_f32_dpp v65, v65, v65 quad_perm:[2,3,0,1] row_mask:0xf bank_mask:0xf
  v_add_f32_dpp v66, v66, v66 quad_perm:[2,3,0,1] row_mask:0xf bank_mask:0xf
  v_add_f32_dpp v67, v67, v67 quad_perm:[2,3,0,1] row_mask:0xf bank_mask:0xf
  v_add_f32_dpp v68, v68, v68 quad_perm:[2,3,0,1] row_mask:0xf bank_mask:0xf
  v_add_f32_dpp v69, v69, v69 quad_perm:[2,3,0,1] row_mask:0xf bank_mask:0xf
  v_add_f32_dpp v70, v70, v70 quad_perm:[2,3,0,1] row_mask:0xf bank_mask:0xf
  v_add_f32_dpp v71, v71, v71 quad_perm:[2,3,0,1] row_mask:0xf bank_mask:0xf
  v_add_f32_dpp v72, v72, v72 quad_perm:[2,3,0,1] row_mask:0xf bank_mask:0xf
  v_add_f32_dpp v73, v73, v73 quad_perm:[2,3,0,1] row_mask:0xf bank_mask:0xf
  v_add_f32_dpp v74, v74, v74 quad_perm:[2,3,0,1] row_mask:0xf bank_mask:0xf
  v_add_f32_dpp v75, v75, v75 quad_perm:[2,3,0,1] row_mask:0xf bank_mask:0xf
  v_add_f32_dpp v76, v76, v76 quad_perm:[2,3,0,1] row_mask:0xf bank_mask:0xf
  v_add_f32_dpp v77, v77, v77 quad_perm:[2,3,0,1] row_mask:0xf bank_mask:0xf
  v_add_f32_dpp v78, v78, v78 quad_perm:[2,3,0,1] row_mask:0xf bank_mask:0xf
  v_add_f32_dpp v79, v79, v79 quad_perm:[2,3,0,1] row_mask:0xf bank_mask:0xf
  v_add_f32_dpp v64, v64, v64 row_half_mirror row_mask:0xf bank_mask:0xf
  v_add_f32_dpp v65, v65, v65 row_half_mirror row_mask:0xf bank_mask:0xf
  v_add_f32_dpp v66, v66, v66 row_half_mirror row_mask:0xf bank_mask:0xf
  v_add_f32_dpp v67, v67, v67 row_half_mirror row_mask:0xf bank_mask:0xf
  v_add_f32_dpp v68, v68, v68 row_half_mirror row_mask:0xf bank_mask:0xf
  v_add_f32_dpp v69, v69, v69 row_half_mirror row_mask:0xf bank_mask:0xf
  v_add_f32_dpp v70, v70, v70 row_half_mirror row_mask:0xf bank_mask:0xf
  v_add_f32_dpp v71, v71, v71 row_half_mirror row_mask:0xf bank_mask:0xf
  v_add_f32_dpp v72, v72, v72 row_half_mirror row_mask:0xf bank_mask:0xf
  v_add_f32_dpp v73, v73, v73 row_half_mirror row_mask:0xf bank_mask:0xf
  v_add_f32_dpp v74, v74, v74 row_half_mirror row_mask:0xf bank_mask:0xf
  v_add_f32_dpp v75, v75, v75 row_half_mirror row_mask:0xf bank_mask:0xf
  v_add_f32_dpp v76, v76, v76 row_half_mirror row_mask:0xf bank_mask:0xf
  v_add_f32_dpp v77, v77, v77 row_half_mirror row_mask:0xf bank_mask:0xf
  v_add_f32_dpp v78, v78, v78 row_half_mirror row_mask:0xf bank_mask:0xf
  v_add_f32_dpp v79, v79, v79 row_half_mirror row_mask:0xf bank_mask:0xf
  s_mov_b32 s8, 0x01010101
  s_mov_b32 s9, 0x01010101
  s_lshl_b64 s[8:9], s[8:9], 1
  v_cndmask_b32_e64 v64, v64, v65, s[8:9]
  v_cndmask_b32_e64 v72, v72, v73, s[8:9]
  s_lshl_b64 s[8:9], s[8:9], 1
  v_cndmask_b32_e64 v64, v64, v66, s[8:9]
  v_cndmask_b32_e64 v72, v72, v74, s[8:9]
  s_lshl_b64 s[8:9], s[8:9], 1
  v_cndmask_b32_e64 v64, v64, v67, s[8:9]
  v_cndmask_b32_e64 v72, v72, v75, s[8:9]
  s_lshl_b64 s[8:9], s[8:9], 1
  v_cndmask_b32_e64 v64, v64, v68, s[8:9]
  v_cndmask_b32_e64 v72, v72, v76, s[8:9]
  s_lshl_b64 s[8:9], s[8:9], 1
  v_cndmask_b32_e64 v64, v64, v69, s[8:9]
  v_cndmask_b32_e64 v72, v72, v77, s[8:9]
  s_lshl_b64 s[8:9], s[8:9], 1
  v_cndmask_b32_e64 v64, v64, v70, s[8:9]
  v_cndmask_b32_e64 v72, v72, v78, s[8:9]
  s_lshl_b64 s[8:9], s[8:9], 1
  v_cndmask_b32_e64 v64, v64, v71, s[8:9]
  v_cndmask_b32_e64 v72, v72, v79, s[8:9]
  v_mov_b32 v65, v72
  v_mov_b32 v66, 0
  v_mov_b32 v67, 0
  v_and_b32 v2, 7, v1
  v_lshlrev_b32 v2, 6, v2
  v_and_b32 v3, 56, v1
  v_add_u32 v2, v2, v3
  s_lshl_b32 s5, s76, 15
  s_lshl_b32 s4, s85, 14
  s_add_u32 s5, s5, s4
  s_lshl_b32 s4, s78, 10
  s_add_u32 s5, s5, s4
  s_add_u32 s5, s5, 1638400
  buffer_store_dwordx2 v[64:65], v2, s[40:43], s5 offen sc0 sc1
  buffer_store_dwordx2 v[66:67], v2, s[40:43], s5 offen offset:512 sc0 sc1
L_20:
  s_waitcnt vmcnt(20)
  s_barrier
  s_waitcnt vmcnt(10)
  s_barrier
  s_mov_b32 s21, 1
Ll_21:
  s_mov_b32 m0, s20
  s_add_u32 s5, s16, s23
  buffer_load_dwordx4 v4, s[72:75], s16 offen offset:0 sc1 lds
  buffer_load_dwordx4 v5, s[72:75], s16 offen offset:1024 sc1 lds
  buffer_load_dwordx4 v6, s[72:75], s16 offen offset:2048 sc1 lds
  buffer_load_dwordx4 v7, s[72:75], s16 offen offset:3072 sc1 lds
  s_add_u32 m0, s20, 4096
  s_add_u32 s6, s16, s24
  buffer_load_dwordx4 v4, s[72:75], s5 offen offset:0 sc1 lds
  buffer_load_dwordx4 v5, s[72:75], s5 offen offset:1024 sc1 lds
  buffer_load_dwordx4 v6, s[72:75], s5 offen offset:2048 sc1 lds
  buffer_load_dwordx4 v7, s[72:75], s5 offen offset:3072 sc1 lds
  s_add_u32 m0, s20, 8192
  s_nop 0
  buffer_load_dwordx4 v4, s[72:75], s6 offen offset:0 sc1 lds
  buffer_load_dwordx4 v5, s[72:75], s6 offen offset:1024 sc1 lds
  s_add_u32 s16, s16, s17
  s_cmp_eq_u32 s16, s18
  s_cselect_b32 s4, s19, 0
  s_sub_u32 s16, s16, s4
  s_add_u32 s20, s20, 20480
  s_cmp_eq_u32 s20, s25
  s_cselect_b32 s4, 61440, 0
  s_sub_u32 s20, s20, s4
  s_cmp_eq_u32 s21, s22
  s_cbranch_scc1 Lj_22
Lr_23:
  s_add_u32 s21, s21, 1
  s_cmp_le_u32 s21, 13
  s_waitcnt vmcnt(10)
  s_barrier
  s_cbranch_scc1 Ll_21
  s_waitcnt vmcnt(0)
  s_barrier
  s_waitcnt lgkmcnt(0)
  s_barrier
  s_branch Lsk_24
Lj_22:
  s_cmp_eq_u32 s21, 2
  s_cbranch_scc1 Ljob_25
  s_cmp_eq_u32 s21, 4
  s_cbranch_scc1 Ljob_26
  s_cmp_eq_u32 s21, 7
  s_cbranch_scc1 Ljob_27
  s_cmp_eq_u32 s21, 9
  s_cbranch_scc1 Ljob_28
  s_branch Ljob_29
Ljob_25:
  s_nop 4
  buffer_load_dword v11, v10, s[68:71], 0 offen sc0 sc1
  s_mov_b32 s22, 4
  s_branch Lr_23
Ljob_26:
  s_nop 4
  s_waitcnt vmcnt(20)
  s_mov_b32 s89, 200000
  s_branch Lg_31
Lg_30:
  buffer_load_dword v11, v10, s[68:71], 0 offen sc0 sc1
  s_waitcnt vmcnt(0)
Lg_31:
  v_cmp_eq_u32 vcc, 16, v11
  s_andn2_b32 s3, 0xffff, vcc_lo
  s_cbranch_scc0 Lg_32
  s_sleep 2
  s_sub_u32 s89, s89, 1
  s_cbranch_scc0 Lg_30
Lg_32:
  s_lshl_b32 s5, s85, 7
  s_mov_b32 exec_hi, 0
  buffer_store_dword v14, v12, s[40:43], s5 offen sc0 sc1
  s_mov_b64 exec, -1
  s_mov_b32 s22, 7
  s_branch Lr_23
Ljob_27:
  s_nop 4
  buffer_load_dword v9, v8, s[40:43], s27 offen sc0 sc1
  s_mov_b32 s22, 9
  s_branch Lr_23
Ljob_28:
  s_nop 4
  s_waitcnt vmcnt(20)
  s_mov_b32 s89, 200000
  s_branch Lp_34
Lp_33:
  buffer_load_dword v9, v8, s[40:43], s27 offen sc0 sc1
  s_waitcnt vmcnt(0)
Lp_34:
  v_cmp_ne_u32 vcc, 0, v9
  s_andn2_b32 s3, s26, vcc_lo
  s_cbranch_scc0 Lp_35
  s_sleep 1
  s_sub_u32 s89, s89, 1
  s_cbranch_scc0 Lp_33
Lp_35:
  s_lshl_b32 s5, s76, 15
  s_lshl_b32 s4, s85, 14
  s_add_u32 s5, s5, s4
  s_add_u32 s5, s5, s28
  s_add_u32 s6, s5, s29
  buffer_load_dwordx4 v[32:35], v13, s[40:43], s5 offen offset:0 sc0 sc1
  buffer_load_dwordx4 v[36:39], v13, s[40:43], s5 offen offset:1024 sc0 sc1
  buffer_load_dwordx4 v[40:43], v13, s[40:43], s5 offen offset:2048 sc0 sc1
  buffer_load_dwordx4 v[44:47], v13, s[40:43], s5 offen offset:3072 sc0 sc1
  s_add_u32 s5, s5, 4096
  buffer_load_dwordx4 v[48:51], v13, s[40:43], s5 offen offset:0 sc0 sc1
  buffer_load_dwordx4 v[52:55], v13, s[40:43], s5 offen offset:1024 sc0 sc1
  buffer_load_dwordx4 v[56:59], v13, s[40:43], s5 offen offset:2048 sc0 sc1
  buffer_load_dwordx4 v[60:63], v13, s[40:43], s5 offen offset:3072 sc0 sc1
  s_add_u32 s5, s5, 4096
  buffer_load_dwordx4 v[64:67], v13, s[40:43], s5 offen offset:0 sc0 sc1
  buffer_load_dwordx4 v[68:71], v13, s[40:43], s5 offen offset:1024 sc0 sc1
  buffer_load_dwordx4 v[72:75], v13, s[40:43], s5 offen offset:2048 sc0 sc1
  buffer_load_dwordx4 v[76:79], v13, s[40:43], s5 offen offset:3072 sc0 sc1
  s_add_u32 s5, s5, 4096
  buffer_load_dwordx4 v[80:83], v13, s[40:43], s5 offen offset:0 sc0 sc1
  buffer_load_dwordx4 v[84:87], v13, s[40:43], s5 offen offset:1024 sc0 sc1
  buffer_load_dwordx4 v[88:91], v13, s[40:43], s5 offen offset:2048 sc0 sc1
  buffer_load_dwordx4 v[92:95], v13, s[40:43], s5 offen offset:3072 sc0 sc1
  buffer_load_dwordx4 v[96:99], v15, s[40:43], s6 offen sc0 sc1
  s_add_u32 s6, s6, 4096
  buffer_load_dwordx4 v[100:103], v15, s[40:43], s6 offen sc0 sc1
  s_add_u32 s6, s6, 4096
  buffer_load_dwordx4 v[104:107], v15, s[40:43], s6 offen sc0 sc1
  s_add_u32 s6, s6, 4096
  buffer_load_dwordx4 v[108:111], v15, s[40:43], s6 offen sc0 sc1
  s_mov_b32 s22, 11
  s_branch Lr_23
Ljob_29:
  s_nop 4
  s_waitcnt vmcnt(20)
  v_pk_add_f32 v[32:33], v[32:33], v[64:65]
  v_pk_add_f32 v[34:35], v[34:35], v[66:67]
  v_pk_add_f32 v[36:37], v[36:37], v[68:69]
  v_pk_add_f32 v[38:39], v[38:39], v[70:71]
  v_pk_add_f32 v[40:41], v[40:41], v[72:73]
  v_pk_add_f32 v[42:43], v[42:43], v[74:75]
  v_pk_add_f32 v[44:45], v[44:45], v[76:77]
  v_pk_add_f32 v[46:47], v[46:47], v[78:79]
  v_pk_add_f32 v[48:49], v[48:49], v[80:81]
  v_pk_add_f32 v[50:51], v[50:51], v[82:83]
  v_pk_add_f32 v[52:53], v[52:53], v[84:85]
  v_pk_add_f32 v[54:55], v[54:55], v[86:87]
  v_pk_add_f32 v[56:57], v[56:57], v[88:89]
  v_pk_add_f32 v[58:59], v[58:59], v[90:91]
  v_pk_add_f32 v[60:61], v[60:61], v[92:93]
  v_pk_add_f32 v[62:63], v[62:63], v[94:95]
  v_pk_add_f32 v[32:33], v[32:33], v[48:49]
  v_pk_add_f32 v[34:35], v[34:35], v[50:51]
  v_pk_add_f32 v[36:37], v[36:37], v[52:53]
  v_pk_add_f32 v[38:39], v[38:39], v[54:55]
  v_pk_add_f32 v[40:41], v[40:41], v[56:57]
  v_pk_add_f32 v[42:43], v[42:43], v[58:59]
  v_pk_add_f32 v[44:45], v[44:45], v[60:61]
  v_pk_add_f32 v[46:47], v[46:47], v[62:63]
  v_pk_add_f32 v[32:33], v[32:33], v[40:41]
  v_pk_add_f32 v[34:35], v[34:35], v[42:43]
  v_pk_add_f32 v[36:37], v[36:37], v[44:45]
  v_pk_add_f32 v[38:39], v[38:39], v[46:47]
  v_pk_add_f32 v[32:33], v[32:33], v[36:37]
  v_pk_add_f32 v[34:35], v[34:35], v[38:39]
  v_pk_add_f32 v[96:97], v[96:97], v[104:105]
  v_pk_add_f32 v[98:99], v[98:99], v[106:107]
  v_pk_add_f32 v[100:101], v[100:101], v[108:109]
  v_pk_add_f32 v[102:103], v[102:103], v[110:111]
  v_pk_add_f32 v[96:97], v[96:97], v[100:101]
  v_pk_add_f32 v[98:99], v[98:99], v[102:103]
  s_nop 0
  v_add_f32_dpp v96, v96, v96 row_ror:8 row_mask:0xf bank_mask:0xf
  v_add_f32_dpp v97, v97, v97 row_ror:8 row_mask:0xf bank_mask:0xf
  v_add_f32_dpp v98, v98, v98 row_ror:8 row_mask:0xf bank_mask:0xf
  v_add_f32_dpp v99, v99, v99 row_ror:8 row_mask:0xf bank_mask:0xf
  v_mov_b32 v100, v96
  v_mov_b32 v101, v97
  v_mov_b32 v102, v98
  v_mov_b32 v103, v99
  v_permlane16_swap_b32 v96, v100
  v_permlane16_swap_b32 v97, v101
  v_permlane16_swap_b32 v98, v102
  v_permlane16_swap_b32 v99, v103
  v_add_f32 v96, v96, v100
  v_add_f32 v97, v97, v101
  v_add_f32 v98, v98, v102
  v_add_f32 v99, v99, v103
  v_permlane32_swap_b32 v32, v96
  v_permlane32_swap_b32 v33, v97
  v_permlane32_swap_b32 v34, v98
  v_permlane32_swap_b32 v35, v99
  v_add_f32 v32, v32, v96
  v_add_f32 v33, v33, v97
  v_add_f32 v34, v34, v98
  v_add_f32 v35, v35, v99
  v_mul_f32 v32, 0x3a800000, v32
  v_mul_f32 v33, 0x3a800000, v33
  v_mul_f32 v34, 0x3a800000, v34
  v_mul_f32 v35, 0x3a800000, v35
  v_fma_f32 v36, -v32, v32, v33
  v_fma_f32 v37, -v34, v34, v35
  v_max_f32 v36, 0, v36
  v_max_f32 v37, 0, v37
  v_add_f32 v36, 0x3727c5ac, v36
  v_add_f32 v37, 0x3727c5ac, v37
  v_rsq_f32 v36, v36
  v_rsq_f32 v37, v37
  v_mul_f32 v38, v32, v36
  v_mul_f32 v39, v34, v37
  ds_write_b64 v16, v[36:37]
  ds_write_b64 v16, v[38:39] offset:640
  s_mov_b32 s22, 0
  s_branch Lr_23
Lsk_24:
  v_add_u32 v4, 4096, v13
  v_add_u32 v5, 11264, v13
  v_add_u32 v6, 3072, v13
  v_add_u32 v7, 10240, v13
  s_mov_b32 s23, 2048
  s_mul_i32 s20, s85, 8192
  s_add_u32 s25, s20, 65536
  s_mul_i32 s5, s76, 32
  s_lshl_b32 s5, s5, 13
  s_lshl_b32 s4, s85, 12
  s_add_u32 s5, s5, s4
  s_add_u32 s5, s5, s83
  s_add_u32 s5, s5, 0xfffff000
  s_mov_b32 s17, 16384
  s_mul_i32 s19, s17, 16
  s_add_u32 s18, s5, s19
  s_mov_b32 s6, s76
  s_mul_i32 s6, s6, s17
  s_add_u32 s16, s5, s6
  s_add_u32 s27, s84, s87
  s_mov_b32 s89, 200000
Lp_36:
  buffer_load_dword v9, v8, s[40:43], s27 offen sc0 sc1
  s_waitcnt vmcnt(0)
Lp_37:
  v_cmp_ne_u32 vcc, 0, v9
  s_andn2_b32 s3, 0xffff, vcc_lo
  s_cbranch_scc0 Lp_38
  s_sleep 1
  s_sub_u32 s89, s89, 1
  s_cbranch_scc0 Lp_36
Lp_38:
  s_mov_b32 m0, s20
  s_add_u32 s5, s16, s23
  buffer_load_dwordx4 v4, s[40:43], s16 offen offset:0 sc1 lds
  buffer_load_dwordx4 v5, s[40:43], s16 offen offset:1024 sc1 lds
  buffer_load_dwordx4 v6, s[40:43], s16 offen offset:2048 sc1 lds
  buffer_load_dwordx4 v7, s[40:43], s16 offen offset:3072 sc1 lds
  s_add_u32 m0, s20, 4096
  s_nop 0
  buffer_load_dwordx4 v4, s[40:43], s5 offen offset:0 sc1 lds
  buffer_load_dwordx4 v5, s[40:43], s5 offen offset:1024 sc1 lds
  buffer_load_dwordx4 v6, s[40:43], s5 offen offset:2048 sc1 lds
  buffer_load_dwordx4 v7, s[40:43], s5 offen offset:3072 sc1 lds
  s_add_u32 s16, s16, s17
  s_cmp_eq_u32 s16, s18
  s_cselect_b32 s4, s19, 0
  s_sub_u32 s16, s16, s4
  s_add_u32 s20, s20, 16384
  s_cmp_eq_u32 s20, s25
  s_cselect_b32 s4, 65536, 0
  s_sub_u32 s20, s20, s4
  s_mov_b32 m0, s20
  s_add_u32 s5, s16, s23
  buffer_load_dwordx4 v4, s[40:43], s16 offen offset:0 sc1 lds
  buffer_load_dwordx4 v5, s[40:43], s16 offen offset:1024 sc1 lds
  buffer_load_dwordx4 v6, s[40:43], s16 offen offset:2048 sc1 lds
  buffer_load_dwordx4 v7, s[40:43], s16 offen offset:3072 sc1 lds
  s_add_u32 m0, s20, 4096
  s_nop 0
  buffer_load_dwordx4 v4, s[40:43], s5 offen offset:0 sc1 lds
  buffer_load_dwordx4 v5, s[40:43], s5 offen offset:1024 sc1 lds
  buffer_load_dwordx4 v6, s[40:43], s5 offen offset:2048 sc1 lds
  buffer_load_dwordx4 v7, s[40:43], s5 offen offset:3072 sc1 lds
  s_add_u32 s16, s16, s17
  s_cmp_eq_u32 s16, s18
  s_cselect_b32 s4, s19, 0
  s_sub_u32 s16, s16, s4
  s_add_u32 s20, s20, 16384
  s_cmp_eq_u32 s20, s25
  s_cselect_b32 s4, 65536, 0
  s_sub_u32 s20, s20, s4
  s_mov_b32 m0, s20
  s_add_u32 s5, s16, s23
  buffer_load_dwordx4 v4, s[40:43], s16 offen offset:0 sc1 lds
  buffer_load_dwordx4 v5, s[40:43], s16 offen offset:1024 sc1 lds
  buffer_load_dwordx4 v6, s[40:43], s16 offen offset:2048 sc1 lds
  buffer_load_dwordx4 v7, s[40:43], s16 offen offset:3072 sc1 lds
  s_add_u32 m0, s20, 4096
  s_nop 0
  buffer_load_dwordx4 v4, s[40:43], s5 offen offset:0 sc1 lds
  buffer_load_dwordx4 v5, s[40:43], s5 offen offset:1024 sc1 lds
  buffer_load_dwordx4 v6, s[40:43], s5 offen offset:2048 sc1 lds
  buffer_load_dwordx4 v7, s[40:43], s5 offen offset:3072 sc1 lds
  s_add_u32 s16, s16, s17
  s_cmp_eq_u32 s16, s18
  s_cselect_b32 s4, s19, 0
  s_sub_u32 s16, s16, s4
  s_add_u32 s20, s20, 16384
  s_cmp_eq_u32 s20, s25
  s_cselect_b32 s4, 65536, 0
  s_sub_u32 s20, s20, s4
  s_mov_b32 m0, s20
  s_add_u32 s5, s16, s23
  buffer_load_dwordx4 v4, s[40:43], s16 offen offset:0 sc1 lds
  buffer_load_dwordx4 v5, s[40:43], s16 offen offset:1024 sc1 lds
  buffer_load_dwordx4 v6, s[40:43], s16 offen offset:2048 sc1 lds
  buffer_load_dwordx4 v7, s[40:43], s16 offen offset:3072 sc1 lds
  s_add_u32 m0, s20, 4096
  s_nop 0
  buffer_load_dwordx4 v4, s[40:43], s5 offen offset:0 sc1 lds
  buffer_load_dwordx4 v5, s[40:43], s5 offen offset:1024 sc1 lds
  buffer_load_dwordx4 v6, s[40:43], s5 offen offset:2048 sc1 lds
  buffer_load_dwordx4 v7, s[40:43], s5 offen offset:3072 sc1 lds
  s_add_u32 s16, s16, s17
  s_cmp_eq_u32 s16, s18
  s_cselect_b32 s4, s19, 0
  s_sub_u32 s16, s16, s4
  s_add_u32 s20, s20, 16384
  s_cmp_eq_u32 s20, s25
  s_cselect_b32 s4, 65536, 0
  s_sub_u32 s20, s20, s4
  s_waitcnt vmcnt(24)
  s_barrier
  s_waitcnt vmcnt(16)
  s_barrier
  s_mov_b32 s21, 1
Ll_39:
  s_mov_b32 m0, s20
  s_add_u32 s5, s16, s23
  buffer_load_dwordx4 v4, s[40:43], s16 offen offset:0 sc1 lds
  buffer_load_dwordx4 v5, s[40:43], s16 offen offset:1024 sc1 lds
  buffer_load_dwordx4 v6, s[40:43], s16 offen offset:2048 sc1 lds
  buffer_load_dwordx4 v7, s[40:43], s16 offen offset:3072 sc1 lds
  s_add_u32 m0, s20, 4096
  s_nop 0
  buffer_load_dwordx4 v4, s[40:43], s5 offen offset:0 sc1 lds
  buffer_load_dwordx4 v5, s[40:43], s5 offen offset:1024 sc1 lds
  buffer_load_dwordx4 v6, s[40:43], s5 offen offset:2048 sc1 lds
  buffer_load_dwordx4 v7, s[40:43], s5 offen offset:3072 sc1 lds
  s_add_u32 s16, s16, s17
  s_cmp_eq_u32 s16, s18
  s_cselect_b32 s4, s19, 0
  s_sub_u32 s16, s16, s4
  s_add_u32 s20, s20, 16384
  s_cmp_eq_u32 s20, s25
  s_cselect_b32 s4, 65536, 0
  s_sub_u32 s20, s20, s4
Lr_41:
  s_add_u32 s21, s21, 1
  s_cmp_le_u32 s21, 12
  s_waitcnt vmcnt(16)
  s_barrier
  s_cbranch_scc1 Ll_39
  s_waitcnt vmcnt(8)
  s_barrier
  s_waitcnt vmcnt(0)
  s_barrier
  s_waitcnt lgkmcnt(0)
  s_barrier
  s_mul_i32 s20, s85, 8192
  s_add_u32 s25, s20, 65536
  s_mul_i32 s5, s76, 32
  s_lshl_b32 s5, s5, 13
  s_lshl_b32 s4, s85, 12
  s_add_u32 s5, s5, s4
  s_add_u32 s5, s5, s83
  s_add_u32 s5, s5, 0x3ff000
  s_mov_b32 s17, 16384
  s_mul_i32 s19, s17, 16
  s_add_u32 s18, s5, s19
  s_mov_b32 s6, s76
  s_mul_i32 s6, s6, s17
  s_add_u32 s16, s5, s6
  s_add_u32 s28, s83, 31457280
  s_mov_b32 s29, 0x70000000
  s_mov_b32 s22, 2
  s_add_u32 s27, s27, 128
  s_mov_b32 s89, 200000
Lp_42:
  buffer_load_dword v9, v8, s[40:43], s27 offen sc0 sc1
  s_waitcnt vmcnt(0)
Lp_43:
  v_cmp_ne_u32 vcc, 0, v9
  s_andn2_b32 s3, 0xffff, vcc_lo
  s_cbranch_scc0 Lp_44
  s_sleep 1
  s_sub_u32 s89, s89, 1
  s_cbranch_scc0 Lp_42
Lp_44:
  s_mov_b32 m0, s20
  s_add_u32 s5, s16, s23
  buffer_load_dwordx4 v4, s[40:43], s16 offen offset:0 sc1 lds
  buffer_load_dwordx4 v5, s[40:43], s16 offen offset:1024 sc1 lds
  buffer_load_dwordx4 v6, s[40:43], s16 offen offset:2048 sc1 lds
  buffer_load_dwordx4 v7, s[40:43], s16 offen offset:3072 sc1 lds
  s_add_u32 m0, s20, 4096
  s_nop 0
  buffer_load_dwordx4 v4, s[40:43], s5 offen offset:0 sc1 lds
  buffer_load_dwordx4 v5, s[40:43], s5 offen offset:1024 sc1 lds
  buffer_load_dwordx4 v6, s[40:43], s5 offen offset:2048 sc1 lds
  buffer_load_dwordx4 v7, s[40:43], s5 offen offset:3072 sc1 lds
  s_add_u32 s16, s16, s17
  s_cmp_eq_u32 s16, s18
  s_cselect_b32 s4, s19, 0
  s_sub_u32 s16, s16, s4
  s_add_u32 s20, s20, 16384
  s_cmp_eq_u32 s20, s25
  s_cselect_b32 s4, 65536, 0
  s_sub_u32 s20, s20, s4
  s_mov_b32 m0, s20
  s_add_u32 s5, s16, s23
  buffer_load_dwordx4 v4, s[40:43], s16 offen offset:0 sc1 lds
  buffer_load_dwordx4 v5, s[40:43], s16 offen offset:1024 sc1 lds
  buffer_load_dwordx4 v6, s[40:43], s16 offen offset:2048 sc1 lds
  buffer_load_dwordx4 v7, s[40:43], s16 offen offset:3072 sc1 lds
  s_add_u32 m0, s20, 4096
  s_nop 0
  buffer_load_dwordx4 v4, s[40:43], s5 offen offset:0 sc1 lds
  buffer_load_dwordx4 v5, s[40:43], s5 offen offset:1024 sc1 lds
  buffer_load_dwordx4 v6, s[40:43], s5 offen offset:2048 sc1 lds
  buffer_load_dwordx4 v7, s[40:43], s5 offen offset:3072 sc1 lds
  s_add_u32 s16, s16, s17
  s_cmp_eq_u32 s16, s18
  s_cselect_b32 s4, s19, 0
  s_sub_u32 s16, s16, s4
  s_add_u32 s20, s20, 16384
  s_cmp_eq_u32 s20, s25
  s_cselect_b32 s4, 65536, 0
  s_sub_u32 s20, s20, s4
  s_mov_b32 m0, s20
  s_add_u32 s5, s16, s23
  buffer_load_dwordx4 v4, s[40:43], s16 offen offset:0 sc1 lds
  buffer_load_dwordx4 v5, s[40:43], s16 offen offset:1024 sc1 lds
  buffer_load_dwordx4 v6, s[40:43], s16 offen offset:2048 sc1 lds
  buffer_load_dwordx4 v7, s[40:43], s16 offen offset:3072 sc1 lds
  s_add_u32 m0, s20, 4096
  s_nop 0
  buffer_load_dwordx4 v4, s[40:43], s5 offen offset:0 sc1 lds
  buffer_load_dwordx4 v5, s[40:43], s5 offen offset:1024 sc1 lds
  buffer_load_dwordx4 v6, s[40:43], s5 offen offset:2048 sc1 lds
  buffer_load_dwordx4 v7, s[40:43], s5 offen offset:3072 sc1 lds
  s_add_u32 s16, s16, s17
  s_cmp_eq_u32 s16, s18
  s_cselect_b32 s4, s19, 0
  s_sub_u32 s16, s16, s4
  s_add_u32 s20, s20, 16384
  s_cmp_eq_u32 s20, s25
  s_cselect_b32 s4, 65536, 0
  s_sub_u32 s20, s20, s4
  s_mov_b32 m0, s20
  s_add_u32 s5, s16, s23
  buffer_load_dwordx4 v4, s[40:43], s16 offen offset:0 sc1 lds
  buffer_load_dwordx4 v5, s[40:43], s16 offen offset:1024 sc1 lds
  buffer_load_dwordx4 v6, s[40:43], s16 offen offset:2048 sc1 lds
  buffer_load_dwordx4 v7, s[40:43], s16 offen offset:3072 sc1 lds
  s_add_u32 m0, s20, 4096
  s_nop 0
  buffer_load_dwordx4 v4, s[40:43], s5 offen offset:0 sc1 lds
  buffer_load_dwordx4 v5, s[40:43], s5 offen offset:1024 sc1 lds
  buffer_load_dwordx4 v6, s[40:43], s5 offen offset:2048 sc1 lds
  buffer_load_dwordx4 v7, s[40:43], s5 offen offset:3072 sc1 lds
  s_add_u32 s16, s16, s17
  s_cmp_eq_u32 s16, s18
  s_cselect_b32 s4, s19, 0
  s_sub_u32 s16, s16, s4
  s_add_u32 s20, s20, 16384
  s_cmp_eq_u32 s20, s25
  s_cselect_b32 s4, 65536, 0
  s_sub_u32 s20, s20, s4
  s_waitcnt vmcnt(24)
  s_barrier
  s_waitcnt vmcnt(16)
  s_barrier
  s_mov_b32 s21, 1
Ll_45:
  s_mov_b32 m0, s20
  s_add_u32 s5, s16, s23
  buffer_load_dwordx4 v4, s[40:43], s16 offen offset:0 sc1 lds
  buffer_load_dwordx4 v5, s[40:43], s16 offen offset:1024 sc1 lds
  buffer_load_dwordx4 v6, s[40:43], s16 offen offset:2048 sc1 lds
  buffer_load_dwordx4 v7, s[40:43], s16 offen offset:3072 sc1 lds
  s_add_u32 m0, s20, 4096
  s_nop 0
  buffer_load_dwordx4 v4, s[40:43], s5 offen offset:0 sc1 lds
  buffer_load_dwordx4 v5, s[40:43], s5 offen offset:1024 sc1 lds
  buffer_load_dwordx4 v6, s[40:43], s5 offen offset:2048 sc1 lds
  buffer_load_dwordx4 v7, s[40:43], s5 offen offset:3072 sc1 lds
  s_add_u32 s16, s16, s17
  s_cmp_eq_u32 s16, s18
  s_cselect_b32 s4, s19, 0
  s_sub_u32 s16, s16, s4
  s_add_u32 s20, s20, 16384
  s_cmp_eq_u32 s20, s25
  s_cselect_b32 s4, 65536, 0
  s_sub_u32 s20, s20, s4
  s_cmp_eq_u32 s21, s22
  s_cbranch_scc1 Lj_46
Lr_47:
  s_add_u32 s21, s21, 1
  s_cmp_le_u32 s21, 12
  s_waitcnt vmcnt(16)
  s_barrier
  s_cbranch_scc1 Ll_45
  s_waitcnt vmcnt(8)
  s_barrier
  s_waitcnt vmcnt(0)
  s_barrier
  s_waitcnt lgkmcnt(0)
  s_barrier
  s_branch Lsk_48
Lj_46:
  s_cmp_eq_u32 s21, 2
  s_cbranch_scc1 Ljob_49
  s_branch Ljob_50
Ljob_49:
  s_nop 4
  s_lshl_b32 s5, s76, 15
  s_lshl_b32 s4, s85, 14
  s_add_u32 s5, s5, s4
  s_add_u32 s5, s5, s28
  s_add_u32 s6, s5, s29
  buffer_load_dwordx4 v[32:35], v13, s[40:43], s5 offen offset:0 sc0 sc1
  buffer_load_dwordx4 v[36:39], v13, s[40:43], s5 offen offset:1024 sc0 sc1
  buffer_load_dwordx4 v[40:43], v13, s[40:43], s5 offen offset:2048 sc0 sc1
  buffer_load_dwordx4 v[44:47], v13, s[40:43], s5 offen offset:3072 sc0 sc1
  s_add_u32 s5, s5, 4096
  buffer_load_dwordx4 v[48:51], v13, s[40:43], s5 offen offset:0 sc0 sc1
  buffer_load_dwordx4 v[52:55], v13, s[40:43], s5 offen offset:1024 sc0 sc1
  buffer_load_dwordx4 v[56:59], v13, s[40:43], s5 offen offset:2048 sc0 sc1
  buffer_load_dwordx4 v[60:63], v13, s[40:43], s5 offen offset:3072 sc0 sc1
  s_add_u32 s5, s5, 4096
  buffer_load_dwordx4 v[64:67], v13, s[40:43], s5 offen offset:0 sc0 sc1
  buffer_load_dwordx4 v[68:71], v13, s[40:43], s5 offen offset:1024 sc0 sc1
  buffer_load_dwordx4 v[72:75], v13, s[40:43], s5 offen offset:2048 sc0 sc1
  buffer_load_dwordx4 v[76:79], v13, s[40:43], s5 offen offset:3072 sc0 sc1
  s_add_u32 s5, s5, 4096
  buffer_load_dwordx4 v[80:83], v13, s[40:43], s5 offen offset:0 sc0 sc1
  buffer_load_dwordx4 v[84:87], v13, s[40:43], s5 offen offset:1024 sc0 sc1
  buffer_load_dwordx4 v[88:91], v13, s[40:43], s5 offen offset:2048 sc0 sc1
  buffer_load_dwordx4 v[92:95], v13, s[40:43], s5 offen offset:3072 sc0 sc1
  buffer_load_dwordx4 v[96:99], v15, s[40:43], s6 offen sc0 sc1
  s_add_u32 s6, s6, 4096
  buffer_load_dwordx4 v[100:103], v15, s[40:43], s6 offen sc0 sc1
  s_add_u32 s6, s6, 4096
  buffer_load_dwordx4 v[104:107], v15, s[40:43], s6 offen sc0 sc1
  s_add_u32 s6, s6, 4096
  buffer_load_dwordx4 v[108:111], v15, s[40:43], s6 offen sc0 sc1
  s_mov_b32 s22, 5
  s_branch Lr_47
Ljob_50:
  s_nop 4
  s_waitcnt vmcnt(24)
  v_pk_add_f32 v[32:33], v[32:33], v[64:65]
  v_pk_add_f32 v[34:35], v[34:35], v[66:67]
  v_pk_add_f32 v[36:37], v[36:37], v[68:69]
  v_pk_add_f32 v[38:39], v[38:39], v[70:71]
  v_pk_add_f32 v[40:41], v[40:41], v[72:73]
  v_pk_add_f32 v[42:43], v[42:43], v[74:75]
  v_pk_add_f32 v[44:45], v[44:45], v[76:77]
  v_pk_add_f32 v[46:47], v[46:47], v[78:79]
  v_pk_add_f32 v[48:49], v[48:49], v[80:81]
  v_pk_add_f32 v[50:51], v[50:51], v[82:83]
  v_pk_add_f32 v[52:53], v[52:53], v[84:85]
  v_pk_add_f32 v[54:55], v[54:55], v[86:87]
  v_pk_add_f32 v[56:57], v[56:57], v[88:89]
  v_pk_add_f32 v[58:59], v[58:59], v[90:91]
  v_pk_add_f32 v[60:61], v[60:61], v[92:93]
  v_pk_add_f32 v[62:63], v[62:63], v[94:95]
  v_pk_add_f32 v[32:33], v[32:33], v[48:49]
  v_pk_add_f32 v[34:35], v[34:35], v[50:51]
  v_pk_add_f32 v[36:37], v[36:37], v[52:53]
  v_pk_add_f32 v[38:39], v[38:39], v[54:55]
  v_pk_add_f32 v[40:41], v[40:41], v[56:57]
  v_pk_add_f32 v[42:43], v[42:43], v[58:59]
  v_pk_add_f32 v[44:45], v[44:45], v[60:61]
  v_pk_add_f32 v[46:47], v[46:47], v[62:63]
  v_pk_add_f32 v[32:33], v[32:33], v[40:41]
  v_pk_add_f32 v[34:35], v[34:35], v[42:43]
  v_pk_add_f32 v[36:37], v[36:37], v[44:45]
  v_pk_add_f32 v[38:39], v[38:39], v[46:47]
  v_pk_add_f32 v[32:33], v[32:33], v[36:37]
  v_pk_add_f32 v[34:35], v[34:35], v[38:39]
  v_pk_add_f32 v[96:97], v[96:97], v[104:105]
  v_pk_add_f32 v[98:99], v[98:99], v[106:107]
  v_pk_add_f32 v[100:101], v[100:101], v[108:109]
  v_pk_add_f32 v[102:103], v[102:103], v[110:111]
  v_pk_add_f32 v[96:97], v[96:97], v[100:101]
  v_pk_add_f32 v[98:99], v[98:99], v[102:103]
  s_nop 0
  v_add_f32_dpp v96, v96, v96 row_ror:8 row_mask:0xf bank_mask:0xf
  v_add_f32_dpp v97, v97, v97 row_ror:8 row_mask:0xf bank_mask:0xf
  v_add_f32_dpp v98, v98, v98 row_ror:8 row_mask:0xf bank_mask:0xf
  v_add_f32_dpp v99, v99, v99 row_ror:8 row_mask:0xf bank_mask:0xf
  v_mov_b32 v100, v96
  v_mov_b32 v101, v97
  v_mov_b32 v102, v98
  v_mov_b32 v103, v99
  v_permlane16_swap_b32 v96, v100
  v_permlane16_swap_b32 v97, v101
  v_permlane16_swap_b32 v98, v102
  v_permlane16_swap_b32 v99, v103
  v_add_f32 v96, v96, v100
  v_add_f32 v97, v97, v101
  v_add_f32 v98, v98, v102
  v_add_f32 v99, v99, v103
  v_permlane32_swap_b32 v32, v96
  v_permlane32_swap_b32 v33, v97
  v_permlane32_swap_b32 v34, v98
  v_permlane32_swap_b32 v35, v99
  v_add_f32 v32, v32, v96
  v_add_f32 v33, v33, v97
  v_add_f32 v34, v34, v98
  v_add_f32 v35, v35, v99
  v_mul_f32 v32, 0x3a800000, v32
  v_mul_f32 v33, 0x3a800000, v33
  v_mul_f32 v34, 0x3a800000, v34
  v_mul_f32 v35, 0x3a800000, v35
  v_fma_f32 v36, -v32, v32, v33
  v_fma_f32 v37, -v34, v34, v35
  v_max_f32 v36, 0, v36
  v_max_f32 v37, 0, v37
  v_add_f32 v36, 0x3727c5ac, v36
  v_add_f32 v37, 0x3727c5ac, v37
  v_rsq_f32 v36, v36
  v_rsq_f32 v37, v37
  v_mul_f32 v38, v32, v36
  v_mul_f32 v39, v34, v37
  ds_write_b64 v16, v[36:37]
  ds_write_b64 v16, v[38:39] offset:640
  s_mov_b32 s22, 0
  s_branch Lr_47
Lsk_48:
  s_mul_i32 s20, s85, 8192
  s_add_u32 s25, s20, 65536
  s_mul_i32 s5, s76, 112
  s_mul_i32 s4, s79, 56
  s_add_u32 s5, s5, s4
  s_lshl_b32 s5, s5, 13
  s_lshl_b32 s4, s85, 12
  s_add_u32 s5, s5, s4
  s_add_u32 s5, s5, s83
  s_add_u32 s5, s5, 0x7ff000
  s_mov_b32 s17, 16384
  s_mul_i32 s19, s17, 28
  s_add_u32 s18, s5, s19
  s_mul_i32 s6, s76, 7
  s_lshr_b32 s6, s6, 2
  s_mul_i32 s6, s6, s17
  s_add_u32 s16, s5, s6
  s_add_u32 s27, s27, 128
  s_lshl_b32 s4, s79, 3
  s_lshl_b32 s26, 0xff, s4
  s_mov_b32 s89, 200000
Lp_51:
  buffer_load_dword v9, v8, s[40:43], s27 offen sc0 sc1
  s_waitcnt vmcnt(0)
Lp_52:
  v_cmp_ne_u32 vcc, 0, v9
  s_andn2_b32 s3, s26, vcc_lo
  s_cbranch_scc0 Lp_53
  s_sleep 1
  s_sub_u32 s89, s89, 1
  s_cbranch_scc0 Lp_51
Lp_53:
  s_mov_b32 m0, s20
  s_add_u32 s5, s16, s23
  buffer_load_dwordx4 v4, s[40:43], s16 offen offset:0 sc1 lds
  buffer_load_dwordx4 v5, s[40:43], s16 offen offset:1024 sc1 lds
  buffer_load_dwordx4 v6, s[40:43], s16 offen offset:2048 sc1 lds
  buffer_load_dwordx4 v7, s[40:43], s16 offen offset:3072 sc1 lds
  s_add_u32 m0, s20, 4096
  s_nop 0
  buffer_load_dwordx4 v4, s[40:43], s5 offen offset:0 sc1 lds
  buffer_load_dwordx4 v5, s[40:43], s5 offen offset:1024 sc1 lds
  buffer_load_dwordx4 v6, s[40:43], s5 offen offset:2048 sc1 lds
  buffer_load_dwordx4 v7, s[40:43], s5 offen offset:3072 sc1 lds
  s_add_u32 s16, s16, s17
  s_cmp_eq_u32 s16, s18
  s_cselect_b32 s4, s19, 0
  s_sub_u32 s16, s16, s4
  s_add_u32 s20, s20, 16384
  s_cmp_eq_u32 s20, s25
  s_cselect_b32 s4, 65536, 0
  s_sub_u32 s20, s20, s4
  s_mov_b32 m0, s20
  s_add_u32 s5, s16, s23
  buffer_load_dwordx4 v4, s[40:43], s16 offen offset:0 sc1 lds
  buffer_load_dwordx4 v5, s[40:43], s16 offen offset:1024 sc1 lds
  buffer_load_dwordx4 v6, s[40:43], s16 offen offset:2048 sc1 lds
  buffer_load_dwordx4 v7, s[40:43], s16 offen offset:3072 sc1 lds
  s_add_u32 m0, s20, 4096
  s_nop 0
  buffer_load_dwordx4 v4, s[40:43], s5 offen offset:0 sc1 lds
  buffer_load_dwordx4 v5, s[40:43], s5 offen offset:1024 sc1 lds
  buffer_load_dwordx4 v6, s[40:43], s5 offen offset:2048 sc1 lds
  buffer_load_dwordx4 v7, s[40:43], s5 offen offset:3072 sc1 lds
  s_add_u32 s16, s16, s17
  s_cmp_eq_u32 s16, s18
  s_cselect_b32 s4, s19, 0
  s_sub_u32 s16, s16, s4
  s_add_u32 s20, s20, 16384
  s_cmp_eq_u32 s20, s25
  s_cselect_b32 s4, 65536, 0
  s_sub_u32 s20, s20, s4
  s_mov_b32 m0, s20
  s_add_u32 s5, s16, s23
  buffer_load_dwordx4 v4, s[40:43], s16 offen offset:0 sc1 lds
  buffer_load_dwordx4 v5, s[40:43], s16 offen offset:1024 sc1 lds
  buffer_load_dwordx4 v6, s[40:43], s16 offen offset:2048 sc1 lds
  buffer_load_dwordx4 v7, s[40:43], s16 offen offset:3072 sc1 lds
  s_add_u32 m0, s20, 4096
  s_nop 0
  buffer_load_dwordx4 v4, s[40:43], s5 offen offset:0 sc1 lds
  buffer_load_dwordx4 v5, s[40:43], s5 offen offset:1024 sc1 lds
  buffer_load_dwordx4 v6, s[40:43], s5 offen offset:2048 sc1 lds
  buffer_load_dwordx4 v7, s[40:43], s5 offen offset:3072 sc1 lds
  s_add_u32 s16, s16, s17
  s_cmp_eq_u32 s16, s18
  s_cselect_b32 s4, s19, 0
  s_sub_u32 s16, s16, s4
  s_add_u32 s20, s20, 16384
  s_cmp_eq_u32 s20, s25
  s_cselect_b32 s4, 65536, 0
  s_sub_u32 s20, s20, s4
  s_mov_b32 m0, s20
  s_add_u32 s5, s16, s23
  buffer_load_dwordx4 v4, s[40:43], s16 offen offset:0 sc1 lds
  buffer_load_dwordx4 v5, s[40:43], s16 offen offset:1024 sc1 lds
  buffer_load_dwordx4 v6, s[40:43], s16 offen offset:2048 sc1 lds
  buffer_load_dwordx4 v7, s[40:43], s16 offen offset:3072 sc1 lds
  s_add_u32 m0, s20, 4096
  s_nop 0
  buffer_load_dwordx4 v4, s[40:43], s5 offen offset:0 sc1 lds
  buffer_load_dwordx4 v5, s[40:43], s5 offen offset:1024 sc1 lds
  buffer_load_dwordx4 v6, s[40:43], s5 offen offset:2048 sc1 lds
  buffer_load_dwordx4 v7, s[40:43], s5 offen offset:3072 sc1 lds
  s_add_u32 s16, s16, s17
  s_cmp_eq_u32 s16, s18
  s_cselect_b32 s4, s19, 0
  s_sub_u32 s16, s16, s4
  s_add_u32 s20, s20, 16384
  s_cmp_eq_u32 s20, s25
  s_cselect_b32 s4, 65536, 0
  s_sub_u32 s20, s20, s4
  s_waitcnt vmcnt(24)
  s_barrier
  s_waitcnt vmcnt(16)
  s_barrier
  s_mov_b32 s21, 1
Ll_54:
  s_mov_b32 m0, s20
  s_add_u32 s5, s16, s23
  buffer_load_dwordx4 v4, s[40:43], s16 offen offset:0 sc1 lds
  buffer_load_dwordx4 v5, s[40:43], s16 offen offset:1024 sc1 lds
  buffer_load_dwordx4 v6, s[40:43], s16 offen offset:2048 sc1 lds
  buffer_load_dwordx4 v7, s[40:43], s16 offen offset:3072 sc1 lds
  s_add_u32 m0, s20, 4096
  s_nop 0
  buffer_load_dwordx4 v4, s[40:43], s5 offen offset:0 sc1 lds
  buffer_load_dwordx4 v5, s[40:43], s5 offen offset:1024 sc1 lds
  buffer_load_dwordx4 v6, s[40:43], s5 offen offset:2048 sc1 lds
  buffer_load_dwordx4 v7, s[40:43], s5 offen offset:3072 sc1 lds
  s_add_u32 s16, s16, s17
  s_cmp_eq_u32 s16, s18
  s_cselect_b32 s4, s19, 0
  s_sub_u32 s16, s16, s4
  s_add_u32 s20, s20, 16384
  s_cmp_eq_u32 s20, s25
  s_cselect_b32 s4, 65536, 0
  s_sub_u32 s20, s20, s4
Lr_56:
  s_add_u32 s21, s21, 1
  s_cmp_le_u32 s21, 24
  s_waitcnt vmcnt(16)
  s_barrier
  s_cbranch_scc1 Ll_54
  s_waitcnt vmcnt(8)
  s_barrier
  s_waitcnt vmcnt(0)
  s_barrier
  s_waitcnt lgkmcnt(0)
  s_barrier
  s_cmp_lg_u32 s82, 0
  s_cbranch_scc1 L_lend
  s_mov_b32 s72, s40
  s_mov_b32 s73, s41
  s_mov_b32 s74, s42
  s_mul_i32 s5, s76, 32
  s_lshl_b32 s5, s5, 13
  s_lshl_b32 s4, s85, 12
  s_add_u32 s5, s5, s4
  s_add_u32 s5, s5, s83
  s_add_u32 s5, s5, 0x1eff000
  s_mov_b32 s17, 16384
  s_mul_i32 s19, s17, 16
  s_add_u32 s18, s5, s19
  s_mov_b32 s6, s76
  s_mul_i32 s6, s6, s17
  s_add_u32 s16, s5, s6
  s_mov_b32 s24, 0xfffc0c00
  s_add_u32 s28, s83, 36700160
  s_mov_b32 s22, 9
  s_add_u32 s27, s27, 256
  s_cmp_eq_u32 s76, 0
  s_cselect_b32 s26, 0xffff, -1
  s_mov_b32 s89, 200000
Lp_57:
  buffer_load_dword v9, v8, s[40:43], s27 offen sc0 sc1
  s_waitcnt vmcnt(0)
Lp_58:
  v_cmp_ne_u32 vcc, 0, v9
  s_andn2_b32 s3, s26, vcc_lo
  s_cbranch_scc0 Lp_59
  s_sleep 1
  s_sub_u32 s89, s89, 1
  s_cbranch_scc0 Lp_57
Lp_59:
  s_mov_b32 s82, 1
  s_add_u32 s83, s83, 37748736
  s_add_u32 s87, s87, 640
  s_branch L_xlayer
L_wload:
  v_bfe_u32 v2, v1, 1, 2
  v_bfe_u32 v3, v1, 4, 2
  v_xor_b32 v2, v2, v3
  v_lshlrev_b32 v22, 5, v2
  v_and_b32 v2, 1, v1
  v_lshl_add_u32 v22, v2, 4, v22
  v_lshrrev_b32 v2, 5, v1
  v_bfe_u32 v3, v1, 3, 2
  v_lshl_add_u32 v2, v2, 3, v3
  s_movk_i32 s4, 6144
  v_mad_u32_u24 v4, v2, s4, v22
  v_add_u32 v5, 97280, v4
  v_add_u32 v6, 22528, v4
  v_add_u32 v7, 119808, v4
  s_lshl_b32 s5, s77, 7
  s_mul_i32 s4, s85, 196608
  s_add_u32 s5, s5, s4
  s_mov_b32 s17, 393216
  s_mul_i32 s19, s17, 16
  s_add_u32 s18, s5, s19
  s_mov_b32 s6, s76
  s_mul_i32 s6, s6, s17
  s_add_u32 s16, s5, s6
  s_lshl_b32 s20, s85, 12
  s_add_u32 s20, s20, 65536
  s_add_u32 s25, s20, 73728
  s_mov_b32 m0, s20
  s_nop 0
  buffer_load_dwordx4 v4, s[48:51], s16 offen offset:0 lds
  buffer_load_dwordx4 v5, s[48:51], s16 offen offset:1024 lds
  buffer_load_dwordx4 v6, s[48:51], s16 offen offset:2048 lds
  buffer_load_dwordx4 v7, s[48:51], s16 offen offset:3072 lds
  s_add_u32 m0, s20, 8192
  s_add_u32 s5, s16, 2048
  buffer_load_dwordx4 v4, s[48:51], s5 offen offset:0 lds
  buffer_load_dwordx4 v5, s[48:51], s5 offen offset:1024 lds
  buffer_load_dwordx4 v6, s[48:51], s5 offen offset:2048 lds
  buffer_load_dwordx4 v7, s[48:51], s5 offen offset:3072 lds
  s_add_u32 m0, s20, 16384
  s_add_u32 s5, s16, 4096
  buffer_load_dwordx4 v4, s[48:51], s5 offen offset:0 lds
  buffer_load_dwordx4 v5, s[48:51], s5 offen offset:1024 lds
  buffer_load_dwordx4 v6, s[48:51], s5 offen offset:2048 lds
  buffer_load_dwordx4 v7, s[48:51], s5 offen offset:3072 lds
  s_add_u32 s16, s16, s17
  s_cmp_eq_u32 s16, s18
  s_cselect_b32 s4, s19, 0
  s_sub_u32 s16, s16, s4
  s_add_u32 s20, s20, 24576
  s_cmp_eq_u32 s20, s25
  s_cselect_b32 s4, 73728, 0
  s_sub_u32 s20, s20, s4
  s_mov_b32 m0, s20
  s_nop 0
  buffer_load_dwordx4 v4, s[48:51], s16 offen offset:0 lds
  buffer_load_dwordx4 v5, s[48:51], s16 offen offset:1024 lds
  buffer_load_dwordx4 v6, s[48:51], s16 offen offset:2048 lds
  buffer_load_dwordx4 v7, s[48:51], s16 offen offset:3072 lds
  s_add_u32 m0, s20, 8192
  s_add_u32 s5, s16, 2048
  buffer_load_dwordx4 v4, s[48:51], s5 offen offset:0 lds
  buffer_load_dwordx4 v5, s[48:51], s5 offen offset:1024 lds
  buffer_load_dwordx4 v6, s[48:51], s5 offen offset:2048 lds
  buffer_load_dwordx4 v7, s[48:51], s5 offen offset:3072 lds
  s_add_u32 m0, s20, 16384
  s_add_u32 s5, s16, 4096
  buffer_load_dwordx4 v4, s[48:51], s5 offen offset:0 lds
  buffer_load_dwordx4 v5, s[48:51], s5 offen offset:1024 lds
  buffer_load_dwordx4 v6, s[48:51], s5 offen offset:2048 lds
  buffer_load_dwordx4 v7, s[48:51], s5 offen offset:3072 lds
  s_add_u32 s16, s16, s17
  s_cmp_eq_u32 s16, s18
  s_cselect_b32 s4, s19, 0
  s_sub_u32 s16, s16, s4
  s_add_u32 s20, s20, 24576
  s_cmp_eq_u32 s20, s25
  s_cselect_b32 s4, 73728, 0
  s_sub_u32 s20, s20, s4
  s_mov_b32 m0, s20
  s_nop 0
  buffer_load_dwordx4 v4, s[48:51], s16 offen offset:0 lds
  buffer_load_dwordx4 v5, s[48:51], s16 offen offset:1024 lds
  buffer_load_dwordx4 v6, s[48:51], s16 offen offset:2048 lds
  buffer_load_dwordx4 v7, s[48:51], s16 offen offset:3072 lds
  s_add_u32 m0, s20, 8192
  s_add_u32 s5, s16, 2048
  buffer_load_dwordx4 v4, s[48:51], s5 offen offset:0 lds
  buffer_load_dwordx4 v5, s[48:51], s5 offen offset:1024 lds
  buffer_load_dwordx4 v6, s[48:51], s5 offen offset:2048 lds
  buffer_load_dwordx4 v7, s[48:51], s5 offen offset:3072 lds
  s_add_u32 m0, s20, 16384
  s_add_u32 s5, s16, 4096
  buffer_load_dwordx4 v4, s[48:51], s5 offen offset:0 lds
  buffer_load_dwordx4 v5, s[48:51], s5 offen offset:1024 lds
  buffer_load_dwordx4 v6, s[48:51], s5 offen offset:2048 lds
  buffer_load_dwordx4 v7, s[48:51], s5 offen offset:3072 lds
  s_add_u32 s16, s16, s17
  s_cmp_eq_u32 s16, s18
  s_cselect_b32 s4, s19, 0
  s_sub_u32 s16, s16, s4
  s_add_u32 s20, s20, 24576
  s_cmp_eq_u32 s20, s25
  s_cselect_b32 s4, 73728, 0
  s_sub_u32 s20, s20, s4
  v_lshlrev_b32 v25, 4, v1
  v_mov_b32 v24, 1
  v_and_b32 v2, 31, v1
  v_lshlrev_b32 v26, 2, v2
  v_and_b32 v2, 15, v1
  v_lshlrev_b32 v28, 4, v2
  v_lshlrev_b32 v30, 6, v2
  v_and_b32 v3, 48, v1
  v_add_u32 v30, v30, v3
  v_lshlrev_b32 v23, 15, v1
  s_lshl_b32 s4, s77, 11
  s_lshl_b32 s5, s85, 6
  s_add_u32 s4, s4, s5
  s_lshl_b32 s5, s76, 2
  s_add_u32 s4, s4, s5
  v_add_u32 v23, s4, v23
  s_lshl_b32 s4, s85, 4
  s_lshl_b32 s26, 0xffff, s4
  v_lshrrev_b32 v2, 2, v1
  v_lshlrev_b32 v32, 7, v2
  v_lshlrev_b32 v33, 6, v2
  v_and_b32 v2, 3, v1
  v_lshl_add_u32 v32, v2, 3, v32
  v_lshl_add_u32 v33, v2, 3, v33
  s_lshl_b32 s4, s85, 12
  s_add_u32 s4, s4, 65536
  v_add_u32 v32, s4, v32
  s_lshl_b32 s4, s85, 11
  s_add_u32 s4, s4, 90112
  v_add_u32 v33, s4, v33
  v_bfe_u32 v3, v1, 3, 2
  v_xor_b32 v2, 0, v3
  v_lshl_add_u32 v16, v2, 5, v32
  v_xor_b32 v2, 1, v3
  v_lshl_add_u32 v17, v2, 5, v32
  v_xor_b32 v2, 2, v3
  v_lshl_add_u32 v18, v2, 5, v32
  v_xor_b32 v2, 3, v3
  v_lshl_add_u32 v19, v2, 5, v32
  v_bfe_u32 v3, v1, 4, 1
  v_xor_b32 v2, 0, v3
  v_lshl_add_u32 v20, v2, 5, v33
  v_xor_b32 v2, 1, v3
  v_lshl_add_u32 v21, v2, 5, v33
  v_mov_b32 v2, 0x3f803f80
  s_mov_b32 s8, 0x00010001
  s_mov_b32 s9, 0x00010001
  v_cndmask_b32_e64 v64, 0, v2, s[8:9]
  v_cndmask_b32_e64 v65, 0, v2, s[8:9]
  v_cndmask_b32_e64 v66, 0, v2, s[8:9]
  v_cndmask_b32_e64 v67, 0, v2, s[8:9]
  s_lshl_b64 s[8:9], s[8:9], 1
  v_cndmask_b32_e64 v68, 0, v2, s[8:9]
  v_cndmask_b32_e64 v69, 0, v2, s[8:9]
  v_cndmask_b32_e64 v70, 0, v2, s[8:9]
  v_cndmask_b32_e64 v71, 0, v2, s[8:9]
  s_lshl_b64 s[8:9], s[8:9], 1
  v_cndmask_b32_e64 v72, 0, v2, s[8:9]
  v_cndmask_b32_e64 v73, 0, v2, s[8:9]
  v_cndmask_b32_e64 v74, 0, v2, s[8:9]
  v_cndmask_b32_e64 v75, 0, v2, s[8:9]
  s_lshl_b64 s[8:9], s[8:9], 1
  v_cndmask_b32_e64 v76, 0, v2, s[8:9]
  v_cndmask_b32_e64 v77, 0, v2, s[8:9]
  v_cndmask_b32_e64 v78, 0, v2, s[8:9]
  v_cndmask_b32_e64 v79, 0, v2, s[8:9]
  s_lshl_b64 s[8:9], s[8:9], 1
  v_cndmask_b32_e64 v80, 0, v2, s[8:9]
  v_cndmask_b32_e64 v81, 0, v2, s[8:9]
  v_cndmask_b32_e64 v82, 0, v2, s[8:9]
  v_cndmask_b32_e64 v83, 0, v2, s[8:9]
  s_lshl_b64 s[8:9], s[8:9], 1
  v_cndmask_b32_e64 v84, 0, v2, s[8:9]
  v_cndmask_b32_e64 v85, 0, v2, s[8:9]
  v_cndmask_b32_e64 v86, 0, v2, s[8:9]
  v_cndmask_b32_e64 v87, 0, v2, s[8:9]
  s_lshl_b64 s[8:9], s[8:9], 1
  v_cndmask_b32_e64 v88, 0, v2, s[8:9]
  v_cndmask_b32_e64 v89, 0, v2, s[8:9]
  v_cndmask_b32_e64 v90, 0, v2, s[8:9]
  v_cndmask_b32_e64 v91, 0, v2, s[8:9]
  s_lshl_b64 s[8:9], s[8:9], 1
  v_cndmask_b32_e64 v92, 0, v2, s[8:9]
  v_cndmask_b32_e64 v93, 0, v2, s[8:9]
  v_cndmask_b32_e64 v94, 0, v2, s[8:9]
  v_cndmask_b32_e64 v95, 0, v2, s[8:9]
  s_lshl_b64 s[8:9], s[8:9], 1
  v_cndmask_b32_e64 v96, 0, v2, s[8:9]
  v_cndmask_b32_e64 v97, 0, v2, s[8:9]
  v_cndmask_b32_e64 v98, 0, v2, s[8:9]
  v_cndmask_b32_e64 v99, 0, v2, s[8:9]
  s_lshl_b64 s[8:9], s[8:9], 1
  v_cndmask_b32_e64 v100, 0, v2, s[8:9]
  v_cndmask_b32_e64 v101, 0, v2, s[8:9]
  v_cndmask_b32_e64 v102, 0, v2, s[8:9]
  v_cndmask_b32_e64 v103, 0, v2, s[8:9]
  s_lshl_b64 s[8:9], s[8:9], 1
  v_cndmask_b32_e64 v104, 0, v2, s[8:9]
  v_cndmask_b32_e64 v105, 0, v2, s[8:9]
  v_cndmask_b32_e64 v106, 0, v2, s[8:9]
  v_cndmask_b32_e64 v107, 0, v2, s[8:9]
  s_lshl_b64 s[8:9], s[8:9], 1
  v_cndmask_b32_e64 v108, 0, v2, s[8:9]
  v_cndmask_b32_e64 v109, 0, v2, s[8:9]
  v_cndmask_b32_e64 v110, 0, v2, s[8:9]
  v_cndmask_b32_e64 v111, 0, v2, s[8:9]
  s_lshl_b64 s[8:9], s[8:9], 1
  v_cndmask_b32_e64 v112, 0, v2, s[8:9]
  v_cndmask_b32_e64 v113, 0, v2, s[8:9]
  v_cndmask_b32_e64 v114, 0, v2, s[8:9]
  v_cndmask_b32_e64 v115, 0, v2, s[8:9]
  s_lshl_b64 s[8:9], s[8:9], 1
  v_cndmask_b32_e64 v116, 0, v2, s[8:9]
  v_cndmask_b32_e64 v117, 0, v2, s[8:9]
  v_cndmask_b32_e64 v118, 0, v2, s[8:9]
  v_cndmask_b32_e64 v119, 0, v2, s[8:9]
  s_lshl_b64 s[8:9], s[8:9], 1
  s_mov_b32 s22, 2
L_wlayer:
  s_waitcnt vmcnt(24)
  s_barrier
  s_cmp_lg_u32 s82, 0
  s_cbranch_scc1 L_60
  ds_read_b64_tr_b16 v[128:129], v16 offset:0
  ds_read_b64_tr_b16 v[130:131], v16 offset:2048
  ds_read_b64_tr_b16 v[132:133], v17 offset:0
  ds_read_b64_tr_b16 v[134:135], v17 offset:2048
  ds_read_b64_tr_b16 v[136:137], v18 offset:0
  ds_read_b64_tr_b16 v[138:139], v18 offset:2048
  ds_read_b64_tr_b16 v[140:141], v19 offset:0
  ds_read_b64_tr_b16 v[142:143], v19 offset:2048
  ds_read_b64_tr_b16 v[144:145], v16 offset:8192
  ds_read_b64_tr_b16 v[146:147], v16 offset:10240
  ds_read_b64_tr_b16 v[148:149], v17 offset:8192
  ds_read_b64_tr_b16 v[150:151], v17 offset:10240
  ds_read_b64_tr_b16 v[152:153], v18 offset:8192
  ds_read_b64_tr_b16 v[154:155], v18 offset:10240
  s_waitcnt lgkmcnt(0)
  ds_read_b64_tr_b16 v[156:157], v19 offset:8192
  ds_read_b64_tr_b16 v[158:159], v19 offset:10240
  ds_read_b64_tr_b16 v[160:161], v16 offset:16384
  ds_read_b64_tr_b16 v[162:163], v16 offset:18432
  ds_read_b64_tr_b16 v[164:165], v17 offset:16384
  ds_read_b64_tr_b16 v[166:167], v17 offset:18432
  ds_read_b64_tr_b16 v[168:169], v18 offset:16384
  ds_read_b64_tr_b16 v[170:171], v18 offset:18432
  ds_read_b64_tr_b16 v[172:173], v19 offset:16384
  ds_read_b64_tr_b16 v[174:175], v19 offset:18432
  s_lshl_b32 s5, s77, 15
  s_lshl_b32 s4, s85, 14
  s_add_u32 s5, s5, s4
  s_lshl_b32 s4, s76, 10
  s_add_u32 s5, s5, s4
  s_add_u32 s5, s5, 589824
  s_waitcnt lgkmcnt(0)
  v_mfma_f32_16x16x32_bf16 v[192:195], v[128:131], v[64:67], 0
  v_mfma_f32_16x16x32_bf16 v[192:195], v[132:135], v[68:71], v[192:195]
  v_mfma_f32_16x16x32_bf16 v[192:195], v[136:139], v[72:75], v[192:195]
  v_mfma_f32_16x16x32_bf16 v[192:195], v[140:143], v[76:79], v[192:195]
  v_mfma_f32_16x16x32_bf16 v[192:195], v[144:147], v[80:83], v[192:195]
  v_mfma_f32_16x16x32_bf16 v[192:195], v[148:151], v[84:87], v[192:195]
  v_mfma_f32_16x16x32_bf16 v[192:195], v[152:155], v[88:91], v[192:195]
  v_mfma_f32_16x16x32_bf16 v[192:195], v[156:159], v[92:95], v[192:195]
  v_mfma_f32_16x16x32_bf16 v[192:195], v[160:163], v[96:99], v[192:195]
  v_mfma_f32_16x16x32_bf16 v[192:195], v[164:167], v[100:103], v[192:195]
  v_mfma_f32_16x16x32_bf16 v[192:195], v[168:171], v[104:107], v[192:195]
  v_mfma_f32_16x16x32_bf16 v[192:195], v[172:175], v[108:111], v[192:195]
  s_nop 7
  buffer_store_dwordx4 v[192:195], v30, s[40:43], s5 offen sc0 sc1
L_60:
  s_waitcnt vmcnt(12)
  s_barrier
  s_mov_b32 s21, 1
Ll_61:
  s_mov_b32 m0, s20
  s_nop 0
  buffer_load_dwordx4 v4, s[48:51], s16 offen offset:0 lds
  buffer_load_dwordx4 v5, s[48:51], s16 offen offset:1024 lds
  buffer_load_dwordx4 v6, s[48:51], s16 offen offset:2048 lds
  buffer_load_dwordx4 v7, s[48:51], s16 offen offset:3072 lds
  s_add_u32 m0, s20, 8192
  s_add_u32 s5, s16, 2048
  buffer_load_dwordx4 v4, s[48:51], s5 offen offset:0 lds
  buffer_load_dwordx4 v5, s[48:51], s5 offen offset:1024 lds
  buffer_load_dwordx4 v6, s[48:51], s5 offen offset:2048 lds
  buffer_load_dwordx4 v7, s[48:51], s5 offen offset:3072 lds
  s_add_u32 m0, s20, 16384
  s_add_u32 s5, s16, 4096
  buffer_load_dwordx4 v4, s[48:51], s5 offen offset:0 lds
  buffer_load_dwordx4 v5, s[48:51], s5 offen offset:1024 lds
  buffer_load_dwordx4 v6, s[48:51], s5 offen offset:2048 lds
  buffer_load_dwordx4 v7, s[48:51], s5 offen offset:3072 lds
  s_add_u32 s16, s16, s17
  s_cmp_eq_u32 s16, s18
  s_cselect_b32 s4, s19, 0
  s_sub_u32 s16, s16, s4
  s_add_u32 s20, s20, 24576
  s_cmp_eq_u32 s20, s25
  s_cselect_b32 s4, 73728, 0
  s_sub_u32 s20, s20, s4
  s_cmp_eq_u32 s21, s22
  s_cbranch_scc1 Lj_62
Lr_63:
  s_add_u32 s21, s21, 1
  s_cmp_le_u32 s21, 13
  s_waitcnt vmcnt(12)
  s_barrier
  s_cbranch_scc1 Ll_61
  s_waitcnt vmcnt(0)
  s_barrier
  s_waitcnt lgkmcnt(0)
  s_barrier
  s_branch Lsk_64
Lj_62:
  s_cmp_eq_u32 s21, 2
  s_cbranch_scc1 Ljob_65
  s_cmp_eq_u32 s21, 4
  s_cbranch_scc1 Ljob_66
  s_cmp_eq_u32 s21, 8
  s_cbranch_scc1 Ljob_67
  s_cmp_eq_u32 s21, 10
  s_cbranch_scc1 Ljob_68
  s_branch Ljob_69
Ljob_65:
  s_nop 4
  buffer_load_dword v29, v28, s[68:71], 0 offen sc0 sc1
  s_mov_b32 s22, 4
  s_branch Lr_63
Ljob_66:
  s_nop 4
  s_waitcnt vmcnt(24)
  s_mov_b32 s89, 200000
  s_branch Lg_71
Lg_70:
  buffer_load_dword v29, v28, s[68:71], 0 offen sc0 sc1
  s_waitcnt vmcnt(0)
Lg_71:
  v_cmp_eq_u32 vcc, 16, v29
  s_andn2_b32 s3, 0xffff, vcc_lo
  s_cbranch_scc0 Lg_72
  s_sleep 2
  s_sub_u32 s89, s89, 1
  s_cbranch_scc0 Lg_70
Lg_72:
  s_movk_i32 s5, 256
  s_mov_b64 exec, 0xffff
  buffer_store_dword v24, v23, s[40:43], s5 offen sc0 sc1
  s_mov_b64 exec, -1
  s_mov_b32 s22, 8
  s_branch Lr_63
Ljob_67:
  s_nop 4
  s_add_u32 s27, s84, 256
  buffer_load_dword v27, v26, s[40:43], s27 offen sc0 sc1
  s_mov_b32 s22, 10
  s_branch Lr_63
Ljob_68:
  s_nop 4
  s_waitcnt vmcnt(24)
  s_mov_b32 s89, 200000
  s_branch Lp_74
Lp_73:
  buffer_load_dword v27, v26, s[40:43], s27 offen sc0 sc1
  s_waitcnt vmcnt(0)
Lp_74:
  v_cmp_ne_u32 vcc, 0, v27
  s_andn2_b32 s3, s26, vcc_lo
  s_cbranch_scc0 Lp_75
  s_sleep 1
  s_sub_u32 s89, s89, 1
  s_cbranch_scc0 Lp_73
Lp_75:
  s_lshl_b32 s5, s77, 15
  s_lshl_b32 s4, s85, 14
  s_add_u32 s5, s5, s4
  s_add_u32 s5, s5, 589824
  buffer_load_dwordx4 v[128:131], v25, s[40:43], s5 offen offset:0 sc0 sc1
  buffer_load_dwordx4 v[132:135], v25, s[40:43], s5 offen offset:1024 sc0 sc1
  buffer_load_dwordx4 v[136:139], v25, s[40:43], s5 offen offset:2048 sc0 sc1
  buffer_load_dwordx4 v[140:143], v25, s[40:43], s5 offen offset:3072 sc0 sc1
  s_add_u32 s5, s5, 4096
  buffer_load_dwordx4 v[144:147], v25, s[40:43], s5 offen offset:0 sc0 sc1
  buffer_load_dwordx4 v[148:151], v25, s[40:43], s5 offen offset:1024 sc0 sc1
  buffer_load_dwordx4 v[152:155], v25, s[40:43], s5 offen offset:2048 sc0 sc1
  buffer_load_dwordx4 v[156:159], v25, s[40:43], s5 offen offset:3072 sc0 sc1
  s_add_u32 s5, s5, 4096
  buffer_load_dwordx4 v[160:163], v25, s[40:43], s5 offen offset:0 sc0 sc1
  buffer_load_dwordx4 v[164:167], v25, s[40:43], s5 offen offset:1024 sc0 sc1
  buffer_load_dwordx4 v[168:171], v25, s[40:43], s5 offen offset:2048 sc0 sc1
  buffer_load_dwordx4 v[172:175], v25, s[40:43], s5 offen offset:3072 sc0 sc1
  s_add_u32 s5, s5, 4096
  buffer_load_dwordx4 v[176:179], v25, s[40:43], s5 offen offset:0 sc0 sc1
  buffer_load_dwordx4 v[180:183], v25, s[40:43], s5 offen offset:1024 sc0 sc1
  buffer_load_dwordx4 v[184:187], v25, s[40:43], s5 offen offset:2048 sc0 sc1
  buffer_load_dwordx4 v[188:191], v25, s[40:43], s5 offen offset:3072 sc0 sc1
  s_mov_b32 s22, 12
  s_branch Lr_63
Ljob_69:
  s_nop 4
  s_waitcnt vmcnt(24)
  v_pk_add_f32 v[128:129], v[128:129], v[160:161]
  v_pk_add_f32 v[130:131], v[130:131], v[162:163]
  v_pk_add_f32 v[132:133], v[132:133], v[164:165]
  v_pk_add_f32 v[134:135], v[134:135], v[166:167]
  v_pk_add_f32 v[136:137], v[136:137], v[168:169]
  v_pk_add_f32 v[138:139], v[138:139], v[170:171]
  v_pk_add_f32 v[140:141], v[140:141], v[172:173]
  v_pk_add_f32 v[142:143], v[142:143], v[174:175]
  v_pk_add_f32 v[144:145], v[144:145], v[176:177]
  v_pk_add_f32 v[146:147], v[146:147], v[178:179]
  v_pk_add_f32 v[148:149], v[148:149], v[180:181]
  v_pk_add_f32 v[150:151], v[150:151], v[182:183]
  v_pk_add_f32 v[152:153], v[152:153], v[184:185]
  v_pk_add_f32 v[154:155], v[154:155], v[186:187]
  v_pk_add_f32 v[156:157], v[156:157], v[188:189]
  v_pk_add_f32 v[158:159], v[158:159], v[190:191]
  v_pk_add_f32 v[128:129], v[128:129], v[144:145]
  v_pk_add_f32 v[130:131], v[130:131], v[146:147]
  v_pk_add_f32 v[132:133], v[132:133], v[148:149]
  v_pk_add_f32 v[134:135], v[134:135], v[150:151]
  v_pk_add_f32 v[136:137], v[136:137], v[152:153]
  v_pk_add_f32 v[138:139], v[138:139], v[154:155]
  v_pk_add_f32 v[140:141], v[140:141], v[156:157]
  v_pk_add_f32 v[142:143], v[142:143], v[158:159]
  v_pk_add_f32 v[128:129], v[128:129], v[136:137]
  v_pk_add_f32 v[130:131], v[130:131], v[138:139]
  v_pk_add_f32 v[132:133], v[132:133], v[140:141]
  v_pk_add_f32 v[134:135], v[134:135], v[142:143]
  v_pk_add_f32 v[128:129], v[128:129], v[132:133]
  v_pk_add_f32 v[130:131], v[130:131], v[134:135]
  v_add_u32 v2, 153088, v25
  ds_add_f32 v2, v128 offset:0
  ds_add_f32 v2, v129 offset:4
  ds_add_f32 v2, v130 offset:8
  ds_add_f32 v2, v131 offset:12
  s_mov_b32 s22, 0
  s_branch Lr_63
Lsk_64:
  v_lshrrev_b32 v2, 3, v1
  s_movk_i32 s4, 2048
  v_mad_u32_u24 v4, v2, s4, v22
  v_add_u32 v5, 15360, v4
  v_add_u32 v6, 30720, v4
  v_add_u32 v7, 46080, v4
  s_lshl_b32 s5, s78, 7
  s_mul_i32 s4, s85, 65536
  s_add_u32 s5, s5, s4
  s_mov_b32 s17, 131072
  s_mul_i32 s19, s17, 16
  s_add_u32 s18, s5, s19
  s_mov_b32 s6, s76
  s_mul_i32 s6, s6, s17
  s_add_u32 s16, s5, s6
  s_lshl_b32 s20, s85, 12
  s_add_u32 s20, s20, 65536
  s_add_u32 s25, s20, 81920
  s_mov_b32 m0, s20
  s_nop 0
  buffer_load_dwordx4 v4, s[52:55], s16 offen offset:0 lds
  buffer_load_dwordx4 v5, s[52:55], s16 offen offset:1024 lds
  buffer_load_dwordx4 v6, s[52:55], s16 offen offset:2048 lds
  buffer_load_dwordx4 v7, s[52:55], s16 offen offset:3072 lds
  s_add_u32 s16, s16, s17
  s_cmp_eq_u32 s16, s18
  s_cselect_b32 s4, s19, 0
  s_sub_u32 s16, s16, s4
  s_add_u32 s20, s20, 8192
  s_cmp_eq_u32 s20, s25
  s_cselect_b32 s4, 81920, 0
  s_sub_u32 s20, s20, s4
  s_mov_b32 m0, s20
  s_nop 0
  buffer_load_dwordx4 v4, s[52:55], s16 offen offset:0 lds
  buffer_load_dwordx4 v5, s[52:55], s16 offen offset:1024 lds
  buffer_load_dwordx4 v6, s[52:55], s16 offen offset:2048 lds
  buffer_load_dwordx4 v7, s[52:55], s16 offen offset:3072 lds
  s_add_u32 s16, s16, s17
  s_cmp_eq_u32 s16, s18
  s_cselect_b32 s4, s19, 0
  s_sub_u32 s16, s16, s4
  s_add_u32 s20, s20, 8192
  s_cmp_eq_u32 s20, s25
  s_cselect_b32 s4, 81920, 0
  s_sub_u32 s20, s20, s4
  s_mov_b32 m0, s20
  s_nop 0
  buffer_load_dwordx4 v4, s[52:55], s16 offen offset:0 lds
  buffer_load_dwordx4 v5, s[52:55], s16 offen offset:1024 lds
  buffer_load_dwordx4 v6, s[52:55], s16 offen offset:2048 lds
  buffer_load_dwordx4 v7, s[52:55], s16 offen offset:3072 lds
  s_add_u32 s16, s16, s17
  s_cmp_eq_u32 s16, s18
  s_cselect_b32 s4, s19, 0
  s_sub_u32 s16, s16, s4
  s_add_u32 s20, s20, 8192
  s_cmp_eq_u32 s20, s25
  s_cselect_b32 s4, 81920, 0
  s_sub_u32 s20, s20, s4
  s_mov_b32 m0, s20
  s_nop 0
  buffer_load_dwordx4 v4, s[52:55], s16 offen offset:0 lds
  buffer_load_dwordx4 v5, s[52:55], s16 offen offset:1024 lds
  buffer_load_dwordx4 v6, s[52:55], s16 offen offset:2048 lds
  buffer_load_dwordx4 v7, s[52:55], s16 offen offset:3072 lds
  s_add_u32 s16, s16, s17
  s_cmp_eq_u32 s16, s18
  s_cselect_b32 s4, s19, 0
  s_sub_u32 s16, s16, s4
  s_add_u32 s20, s20, 8192
  s_cmp_eq_u32 s20, s25
  s_cselect_b32 s4, 81920, 0
  s_sub_u32 s20, s20, s4
  s_mov_b32 m0, s20
  s_nop 0
  buffer_load_dwordx4 v4, s[52:55], s16 offen offset:0 lds
  buffer_load_dwordx4 v5, s[52:55], s16 offen offset:1024 lds
  buffer_load_dwordx4 v6, s[52:55], s16 offen offset:2048 lds
  buffer_load_dwordx4 v7, s[52:55], s16 offen offset:3072 lds
  s_add_u32 s16, s16, s17
  s_cmp_eq_u32 s16, s18
  s_cselect_b32 s4, s19, 0
  s_sub_u32 s16, s16, s4
  s_add_u32 s20, s20, 8192
  s_cmp_eq_u32 s20, s25
  s_cselect_b32 s4, 81920, 0
  s_sub_u32 s20, s20, s4
  s_mov_b32 m0, s20
  s_nop 0
  buffer_load_dwordx4 v4, s[52:55], s16 offen offset:0 lds
  buffer_load_dwordx4 v5, s[52:55], s16 offen offset:1024 lds
  buffer_load_dwordx4 v6, s[52:55], s16 offen offset:2048 lds
  buffer_load_dwordx4 v7, s[52:55], s16 offen offset:3072 lds
  s_add_u32 s16, s16, s17
  s_cmp_eq_u32 s16, s18
  s_cselect_b32 s4, s19, 0
  s_sub_u32 s16, s16, s4
  s_add_u32 s20, s20, 8192
  s_cmp_eq_u32 s20, s25
  s_cselect_b32 s4, 81920, 0
  s_sub_u32 s20, s20, s4
  s_mov_b32 m0, s20
  s_nop 0
  buffer_load_dwordx4 v4, s[52:55], s16 offen offset:0 lds
  buffer_load_dwordx4 v5, s[52:55], s16 offen offset:1024 lds
  buffer_load_dwordx4 v6, s[52:55], s16 offen offset:2048 lds
  buffer_load_dwordx4 v7, s[52:55], s16 offen offset:3072 lds
  s_add_u32 s16, s16, s17
  s_cmp_eq_u32 s16, s18
  s_cselect_b32 s4, s19, 0
  s_sub_u32 s16, s16, s4
  s_add_u32 s20, s20, 8192
  s_cmp_eq_u32 s20, s25
  s_cselect_b32 s4, 81920, 0
  s_sub_u32 s20, s20, s4
  s_mov_b32 m0, s20
  s_nop 0
  buffer_load_dwordx4 v4, s[52:55], s16 offen offset:0 lds
  buffer_load_dwordx4 v5, s[52:55], s16 offen offset:1024 lds
  buffer_load_dwordx4 v6, s[52:55], s16 offen offset:2048 lds
  buffer_load_dwordx4 v7, s[52:55], s16 offen offset:3072 lds
  s_add_u32 s16, s16, s17
  s_cmp_eq_u32 s16, s18
  s_cselect_b32 s4, s19, 0
  s_sub_u32 s16, s16, s4
  s_add_u32 s20, s20, 8192
  s_cmp_eq_u32 s20, s25
  s_cselect_b32 s4, 81920, 0
  s_sub_u32 s20, s20, s4
  s_mov_b32 m0, s20
  s_nop 0
  buffer_load_dwordx4 v4, s[52:55], s16 offen offset:0 lds
  buffer_load_dwordx4 v5, s[52:55], s16 offen offset:1024 lds
  buffer_load_dwordx4 v6, s[52:55], s16 offen offset:2048 lds
  buffer_load_dwordx4 v7, s[52:55], s16 offen offset:3072 lds
  s_add_u32 s16, s16, s17
  s_cmp_eq_u32 s16, s18
  s_cselect_b32 s4, s19, 0
  s_sub_u32 s16, s16, s4
  s_add_u32 s20, s20, 8192
  s_cmp_eq_u32 s20, s25
  s_cselect_b32 s4, 81920, 0
  s_sub_u32 s20, s20, s4
  s_mov_b32 m0, s20
  s_nop 0
  buffer_load_dwordx4 v4, s[52:55], s16 offen offset:0 lds
  buffer_load_dwordx4 v5, s[52:55], s16 offen offset:1024 lds
  buffer_load_dwordx4 v6, s[52:55], s16 offen offset:2048 lds
  buffer_load_dwordx4 v7, s[52:55], s16 offen offset:3072 lds
  s_add_u32 s16, s16, s17
  s_cmp_eq_u32 s16, s18
  s_cselect_b32 s4, s19, 0
  s_sub_u32 s16, s16, s4
  s_add_u32 s20, s20, 8192
  s_cmp_eq_u32 s20, s25
  s_cselect_b32 s4, 81920, 0
  s_sub_u32 s20, s20, s4
  s_waitcnt vmcnt(36)
  s_barrier
  s_waitcnt vmcnt(32)
  s_barrier
  s_mov_b32 s21, 1
Ll_76:
  s_mov_b32 m0, s20
  s_nop 0
  buffer_load_dwordx4 v4, s[52:55], s16 offen offset:0 lds
  buffer_load_dwordx4 v5, s[52:55], s16 offen offset:1024 lds
  buffer_load_dwordx4 v6, s[52:55], s16 offen offset:2048 lds
  buffer_load_dwordx4 v7, s[52:55], s16 offen offset:3072 lds
  s_add_u32 s16, s16, s17
  s_cmp_eq_u32 s16, s18
  s_cselect_b32 s4, s19, 0
  s_sub_u32 s16, s16, s4
  s_add_u32 s20, s20, 8192
  s_cmp_eq_u32 s20, s25
  s_cselect_b32 s4, 81920, 0
  s_sub_u32 s20, s20, s4
Lr_78:
  s_add_u32 s21, s21, 1
  s_cmp_le_u32 s21, 6
  s_waitcnt vmcnt(32)
  s_barrier
  s_cbranch_scc1 Ll_76
  s_waitcnt vmcnt(28)
  s_barrier
  s_waitcnt vmcnt(24)
  s_barrier
  s_waitcnt vmcnt(20)
  s_barrier
  s_waitcnt vmcnt(16)
  s_barrier
  s_waitcnt vmcnt(12)
  s_barrier
  s_waitcnt vmcnt(8)
  s_barrier
  s_waitcnt vmcnt(4)
  s_barrier
  s_waitcnt vmcnt(0)
  s_barrier
  s_waitcnt lgkmcnt(0)
  s_barrier
  v_lshrrev_b32 v2, 3, v1
  s_movk_i32 s4, 7168
  v_mad_u32_u24 v4, v2, s4, v22
  v_add_u32 v5, 56320, v4
  v_add_u32 v6, 112640, v4
  v_add_u32 v7, 168960, v4
  v_lshrrev_b32 v2, 2, v1
  s_movk_i32 s4, 7168
  v_mul_u32_u24 v2, s4, v2
  v_and_b32 v3, 48, v22
  v_add_u32 v8, v2, v3
  v_add_u32 v9, 113664, v8
  s_mul_i32 s5, s77, 448
  s_and_b32 s4, s77, 1
  s_mul_i32 s30, s4, 448
  s_sub_u32 s30, 384, s30
  s_lshl_b32 s4, s4, 6
  s_add_u32 s5, s5, s4
  s_mul_i32 s4, s85, 229376
  s_add_u32 s5, s5, s4
  s_mov_b32 s17, 458752
  s_mul_i32 s19, s17, 16
  s_add_u32 s18, s5, s19
  s_mov_b32 s6, s76
  s_mul_i32 s6, s6, s17
  s_add_u32 s16, s5, s6
  s_lshl_b32 s20, s85, 12
  s_add_u32 s20, s20, 65536
  s_add_u32 s25, s20, 86016
  s_lshl_b32 s4, s85, 11
  s_sub_u32 s23, 24576, s4
  s_cmp_eq_u32 s82, 0
  s_cselect_b32 s22, 2, 0
  s_mov_b32 m0, s20
  s_nop 0
  buffer_load_dwordx4 v4, s[56:59], s16 offen offset:0 lds
  buffer_load_dwordx4 v5, s[56:59], s16 offen offset:1024 lds
  buffer_load_dwordx4 v6, s[56:59], s16 offen offset:2048 lds
  buffer_load_dwordx4 v7, s[56:59], s16 offen offset:3072 lds
  s_add_u32 m0, s20, 8192
  s_add_u32 s5, s16, 128
  buffer_load_dwordx4 v4, s[56:59], s5 offen offset:0 lds
  buffer_load_dwordx4 v5, s[56:59], s5 offen offset:1024 lds
  buffer_load_dwordx4 v6, s[56:59], s5 offen offset:2048 lds
  buffer_load_dwordx4 v7, s[56:59], s5 offen offset:3072 lds
  s_add_u32 m0, s20, 16384
  s_add_u32 s5, s16, 256
  buffer_load_dwordx4 v4, s[56:59], s5 offen offset:0 lds
  buffer_load_dwordx4 v5, s[56:59], s5 offen offset:1024 lds
  buffer_load_dwordx4 v6, s[56:59], s5 offen offset:2048 lds
  buffer_load_dwordx4 v7, s[56:59], s5 offen offset:3072 lds
  s_add_u32 m0, s20, s23
  s_add_u32 s5, s16, s30
  buffer_load_dwordx4 v8, s[56:59], s5 offen offset:0 lds
  buffer_load_dwordx4 v9, s[56:59], s5 offen offset:1024 lds
  s_add_u32 s16, s16, s17
  s_cmp_eq_u32 s16, s18
  s_cselect_b32 s4, s19, 0
  s_sub_u32 s16, s16, s4
  s_add_u32 s20, s20, 28672
  s_cmp_eq_u32 s20, s25
  s_cselect_b32 s4, 86016, 0
  s_sub_u32 s20, s20, s4
  s_mov_b32 m0, s20
  s_nop 0
  buffer_load_dwordx4 v4, s[56:59], s16 offen offset:0 lds
  buffer_load_dwordx4 v5, s[56:59], s16 offen offset:1024 lds
  buffer_load_dwordx4 v6, s[56:59], s16 offen offset:2048 lds
  buffer_load_dwordx4 v7, s[56:59], s16 offen offset:3072 lds
  s_add_u32 m0, s20, 8192
  s_add_u32 s5, s16, 128
  buffer_load_dwordx4 v4, s[56:59], s5 offen offset:0 lds
  buffer_load_dwordx4 v5, s[56:59], s5 offen offset:1024 lds
  buffer_load_dwordx4 v6, s[56:59], s5 offen offset:2048 lds
  buffer_load_dwordx4 v7, s[56:59], s5 offen offset:3072 lds
  s_add_u32 m0, s20, 16384
  s_add_u32 s5, s16, 256
  buffer_load_dwordx4 v4, s[56:59], s5 offen offset:0 lds
  buffer_load_dwordx4 v5, s[56:59], s5 offen offset:1024 lds
  buffer_load_dwordx4 v6, s[56:59], s5 offen offset:2048 lds
  buffer_load_dwordx4 v7, s[56:59], s5 offen offset:3072 lds
  s_add_u32 m0, s20, s23
  s_add_u32 s5, s16, s30
  buffer_load_dwordx4 v8, s[56:59], s5 offen offset:0 lds
  buffer_load_dwordx4 v9, s[56:59], s5 offen offset:1024 lds
  s_add_u32 s16, s16, s17
  s_cmp_eq_u32 s16, s18
  s_cselect_b32 s4, s19, 0
  s_sub_u32 s16, s16, s4
  s_add_u32 s20, s20, 28672
  s_cmp_eq_u32 s20, s25
  s_cselect_b32 s4, 86016, 0
  s_sub_u32 s20, s20, s4
  s_mov_b32 m0, s20
  s_nop 0
  buffer_load_dwordx4 v4, s[56:59], s16 offen offset:0 lds
  buffer_load_dwordx4 v5, s[56:59], s16 offen offset:1024 lds
  buffer_load_dwordx4 v6, s[56:59], s16 offen offset:2048 lds
  buffer_load_dwordx4 v7, s[56:59], s16 offen offset:3072 lds
  s_add_u32 m0, s20, 8192
  s_add_u32 s5, s16, 128
  buffer_load_dwordx4 v4, s[56:59], s5 offen offset:0 lds
  buffer_load_dwordx4 v5, s[56:59], s5 offen offset:1024 lds
  buffer_load_dwordx4 v6, s[56:59], s5 offen offset:2048 lds
  buffer_load_dwordx4 v7, s[56:59], s5 offen offset:3072 lds
  s_add_u32 m0, s20, 16384
  s_add_u32 s5, s16, 256
  buffer_load_dwordx4 v4, s[56:59], s5 offen offset:0 lds
  buffer_load_dwordx4 v5, s[56:59], s5 offen offset:1024 lds
  buffer_load_dwordx4 v6, s[56:59], s5 offen offset:2048 lds
  buffer_load_dwordx4 v7, s[56:59], s5 offen offset:3072 lds
  s_add_u32 m0, s20, s23
  s_add_u32 s5, s16, s30
  buffer_load_dwordx4 v8, s[56:59], s5 offen offset:0 lds
  buffer_load_dwordx4 v9, s[56:59], s5 offen offset:1024 lds
  s_add_u32 s16, s16, s17
  s_cmp_eq_u32 s16, s18
  s_cselect_b32 s4, s19, 0
  s_sub_u32 s16, s16, s4
  s_add_u32 s20, s20, 28672
  s_cmp_eq_u32 s20, s25
  s_cselect_b32 s4, 86016, 0
  s_sub_u32 s20, s20, s4
  s_waitcnt vmcnt(28)
  s_barrier
  s_cmp_lg_u32 s82, 0
  s_cbranch_scc1 L_79
  ds_read_b64_tr_b16 v[128:129], v16 offset:0
  ds_read_b64_tr_b16 v[130:131], v16 offset:2048
  ds_read_b64_tr_b16 v[132:133], v17 offset:0
  ds_read_b64_tr_b16 v[134:135], v17 offset:2048
  ds_read_b64_tr_b16 v[136:137], v18 offset:0
  ds_read_b64_tr_b16 v[138:139], v18 offset:2048
  ds_read_b64_tr_b16 v[140:141], v19 offset:0
  ds_read_b64_tr_b16 v[142:143], v19 offset:2048
  ds_read_b64_tr_b16 v[144:145], v16 offset:8192
  ds_read_b64_tr_b16 v[146:147], v16 offset:10240
  ds_read_b64_tr_b16 v[148:149], v17 offset:8192
  ds_read_b64_tr_b16 v[150:151], v17 offset:10240
  ds_read_b64_tr_b16 v[152:153], v18 offset:8192
  ds_read_b64_tr_b16 v[154:155], v18 offset:10240
  s_waitcnt lgkmcnt(0)
  ds_read_b64_tr_b16 v[156:157], v19 offset:8192
  ds_read_b64_tr_b16 v[158:159], v19 offset:10240
  ds_read_b64_tr_b16 v[160:161], v16 offset:16384
  ds_read_b64_tr_b16 v[162:163], v16 offset:18432
  ds_read_b64_tr_b16 v[164:165], v17 offset:16384
  ds_read_b64_tr_b16 v[166:167], v17 offset:18432
  ds_read_b64_tr_b16 v[168:169], v18 offset:16384
  ds_read_b64_tr_b16 v[170:171], v18 offset:18432
  ds_read_b64_tr_b16 v[172:173], v19 offset:16384
  ds_read_b64_tr_b16 v[174:175], v19 offset:18432
  ds_read_b64_tr_b16 v[176:177], v20 offset:0
  ds_read_b64_tr_b16 v[178:179], v20 offset:1024
  ds_read_b64_tr_b16 v[180:181], v21 offset:0
  ds_read_b64_tr_b16 v[182:183], v21 offset:1024
  s_lshl_b32 s5, s77, 15
  s_lshl_b32 s4, s85, 14
  s_add_u32 s5, s5, s4
  s_lshl_b32 s4, s76, 10
  s_add_u32 s5, s5, s4
  s_add_u32 s5, s5, 1114112
  s_waitcnt lgkmcnt(0)
  v_mfma_f32_16x16x32_bf16 v[192:195], v[128:131], v[64:67], 0
  v_mfma_f32_16x16x32_bf16 v[192:195], v[132:135], v[68:71], v[192:195]
  v_mfma_f32_16x16x32_bf16 v[192:195], v[136:139], v[72:75], v[192:195]
  v_mfma_f32_16x16x32_bf16 v[192:195], v[140:143], v[76:79], v[192:195]
  v_mfma_f32_16x16x32_bf16 v[192:195], v[144:147], v[80:83], v[192:195]
  v_mfma_f32_16x16x32_bf16 v[192:195], v[148:151], v[84:87], v[192:195]
  v_mfma_f32_16x16x32_bf16 v[192:195], v[152:155], v[88:91], v[192:195]
  v_mfma_f32_16x16x32_bf16 v[192:195], v[156:159], v[92:95], v[192:195]
  v_mfma_f32_16x16x32_bf16 v[192:195], v[160:163], v[96:99], v[192:195]
  v_mfma_f32_16x16x32_bf16 v[192:195], v[164:167], v[100:103], v[192:195]
  v_mfma_f32_16x16x32_bf16 v[192:195], v[168:171], v[104:107], v[192:195]
  v_mfma_f32_16x16x32_bf16 v[192:195], v[172:175], v[108:111], v[192:195]
  v_mfma_f32_16x16x32_bf16 v[192:195], v[176:179], v[112:115], v[192:195]
  v_mfma_f32_16x16x32_bf16 v[192:195], v[180:183], v[116:119], v[192:195]
  s_nop 7
  buffer_store_dwordx4 v[192:195], v30, s[40:43], s5 offen sc0 sc1
L_79:
  s_waitcnt vmcnt(14)
  s_barrier
  s_mov_b32 s21, 1
Ll_80:
  s_mov_b32 m0, s20
  s_nop 0
  buffer_load_dwordx4 v4, s[56:59], s16 offen offset:0 lds
  buffer_load_dwordx4 v5, s[56:59], s16 offen offset:1024 lds
  buffer_load_dwordx4 v6, s[56:59], s16 offen offset:2048 lds
  buffer_load_dwordx4 v7, s[56:59], s16 offen offset:3072 lds
  s_add_u32 m0, s20, 8192
  s_add_u32 s5, s16, 128
  buffer_load_dwordx4 v4, s[56:59], s5 offen offset:0 lds
  buffer_load_dwordx4 v5, s[56:59], s5 offen offset:1024 lds
  buffer_load_dwordx4 v6, s[56:59], s5 offen offset:2048 lds
  buffer_load_dwordx4 v7, s[56:59], s5 offen offset:3072 lds
  s_add_u32 m0, s20, 16384
  s_add_u32 s5, s16, 256
  buffer_load_dwordx4 v4, s[56:59], s5 offen offset:0 lds
  buffer_load_dwordx4 v5, s[56:59], s5 offen offset:1024 lds
  buffer_load_dwordx4 v6, s[56:59], s5 offen offset:2048 lds
  buffer_load_dwordx4 v7, s[56:59], s5 offen offset:3072 lds
  s_add_u32 m0, s20, s23
  s_add_u32 s5, s16, s30
  buffer_load_dwordx4 v8, s[56:59], s5 offen offset:0 lds
  buffer_load_dwordx4 v9, s[56:59], s5 offen offset:1024 lds
  s_add_u32 s16, s16, s17
  s_cmp_eq_u32 s16, s18
  s_cselect_b32 s4, s19, 0
  s_sub_u32 s16, s16, s4
  s_add_u32 s20, s20, 28672
  s_cmp_eq_u32 s20, s25
  s_cselect_b32 s4, 86016, 0
  s_sub_u32 s20, s20, s4
  s_cmp_eq_u32 s21, s22
  s_cbranch_scc1 Lj_81
Lr_82:
  s_add_u32 s21, s21, 1
  s_cmp_le_u32 s21, 13
  s_waitcnt vmcnt(14)
  s_barrier
  s_cbranch_scc1 Ll_80
  s_waitcnt vmcnt(0)
  s_barrier
  s_waitcnt lgkmcnt(0)
  s_barrier
  s_branch Lsk_83
Lj_81:
  s_cmp_eq_u32 s21, 2
  s_cbranch_scc1 Ljob_84
  s_cmp_eq_u32 s21, 6
  s_cbranch_scc1 Ljob_85
  s_cmp_eq_u32 s21, 8
  s_cbranch_scc1 Ljob_86
  s_branch Ljob_87
Ljob_84:
  s_nop 4
  s_waitcnt vmcnt(28)
  s_movk_i32 s5, 384
  s_mov_b64 exec, 0xffff
  buffer_store_dword v24, v23, s[40:43], s5 offen sc0 sc1
  s_mov_b64 exec, -1
  s_mov_b32 s22, 6
  s_branch Lr_82
Ljob_85:
  s_nop 4
  s_add_u32 s27, s84, 384
  buffer_load_dword v27, v26, s[40:43], s27 offen sc0 sc1
  s_mov_b32 s22, 8
  s_branch Lr_82
Ljob_86:
  s_nop 4
  s_waitcnt vmcnt(28)
  s_mov_b32 s89, 200000
  s_branch Lp_89
Lp_88:
  buffer_load_dword v27, v26, s[40:43], s27 offen sc0 sc1
  s_waitcnt vmcnt(0)
Lp_89:
  v_cmp_ne_u32 vcc, 0, v27
  s_andn2_b32 s3, s26, vcc_lo
  s_cbranch_scc0 Lp_90
  s_sleep 1
  s_sub_u32 s89, s89, 1
  s_cbranch_scc0 Lp_88
Lp_90:
  s_lshl_b32 s5, s77, 15
  s_lshl_b32 s4, s85, 14
  s_add_u32 s5, s5, s4
  s_add_u32 s5, s5, 1114112
  buffer_load_dwordx4 v[128:131], v25, s[40:43], s5 offen offset:0 sc0 sc1
  buffer_load_dwordx4 v[132:135], v25, s[40:43], s5 offen offset:1024 sc0 sc1
  buffer_load_dwordx4 v[136:139], v25, s[40:43], s5 offen offset:2048 sc0 sc1
  buffer_load_dwordx4 v[140:143], v25, s[40:43], s5 offen offset:3072 sc0 sc1
  s_add_u32 s5, s5, 4096
  buffer_load_dwordx4 v[144:147], v25, s[40:43], s5 offen offset:0 sc0 sc1
  buffer_load_dwordx4 v[148:151], v25, s[40:43], s5 offen offset:1024 sc0 sc1
  buffer_load_dwordx4 v[152:155], v25, s[40:43], s5 offen offset:2048 sc0 sc1
  buffer_load_dwordx4 v[156:159], v25, s[40:43], s5 offen offset:3072 sc0 sc1
  s_add_u32 s5, s5, 4096
  buffer_load_dwordx4 v[160:163], v25, s[40:43], s5 offen offset:0 sc0 sc1
  buffer_load_dwordx4 v[164:167], v25, s[40:43], s5 offen offset:1024 sc0 sc1
  buffer_load_dwordx4 v[168:171], v25, s[40:43], s5 offen offset:2048 sc0 sc1
  buffer_load_dwordx4 v[172:175], v25, s[40:43], s5 offen offset:3072 sc0 sc1
  s_add_u32 s5, s5, 4096
  buffer_load_dwordx4 v[176:179], v25, s[40:43], s5 offen offset:0 sc0 sc1
  buffer_load_dwordx4 v[180:183], v25, s[40:43], s5 offen offset:1024 sc0 sc1
  buffer_load_dwordx4 v[184:187], v25, s[40:43], s5 offen offset:2048 sc0 sc1
  buffer_load_dwordx4 v[188:191], v25, s[40:43], s5 offen offset:3072 sc0 sc1
  s_mov_b32 s22, 10
  s_branch Lr_82
Ljob_87:
  s_nop 4
  s_waitcnt vmcnt(28)
  v_pk_add_f32 v[128:129], v[128:129], v[160:161]
  v_pk_add_f32 v[130:131], v[130:131], v[162:163]
  v_pk_add_f32 v[132:133], v[132:133], v[164:165]
  v_pk_add_f32 v[134:135], v[134:135], v[166:167]
  v_pk_add_f32 v[136:137], v[136:137], v[168:169]
  v_pk_add_f32 v[138:139], v[138:139], v[170:171]
  v_pk_add_f32 v[140:141], v[140:141], v[172:173]
  v_pk_add_f32 v[142:143], v[142:143], v[174:175]
  v_pk_add_f32 v[144:145], v[144:145], v[176:177]
  v_pk_add_f32 v[146:147], v[146:147], v[178:179]
  v_pk_add_f32 v[148:149], v[148:149], v[180:181]
  v_pk_add_f32 v[150:151], v[150:151], v[182:183]
  v_pk_add_f32 v[152:153], v[152:153], v[184:185]
  v_pk_add_f32 v[154:155], v[154:155], v[186:187]
  v_pk_add_f32 v[156:157], v[156:157], v[188:189]
  v_pk_add_f32 v[158:159], v[158:159], v[190:191]
  v_pk_add_f32 v[128:129], v[128:129], v[144:145]
  v_pk_add_f32 v[130:131], v[130:131], v[146:147]
  v_pk_add_f32 v[132:133], v[132:133], v[148:149]
  v_pk_add_f32 v[134:135], v[134:135], v[150:151]
  v_pk_add_f32 v[136:137], v[136:137], v[152:153]
  v_pk_add_f32 v[138:139], v[138:139], v[154:155]
  v_pk_add_f32 v[140:141], v[140:141], v[156:157]
  v_pk_add_f32 v[142:143], v[142:143], v[158:159]
  v_pk_add_f32 v[128:129], v[128:129], v[136:137]
  v_pk_add_f32 v[130:131], v[130:131], v[138:139]
  v_pk_add_f32 v[132:133], v[132:133], v[140:141]
  v_pk_add_f32 v[134:135], v[134:135], v[142:143]
  v_pk_add_f32 v[128:129], v[128:129], v[132:133]
  v_pk_add_f32 v[130:131], v[130:131], v[134:135]
  v_add_u32 v2, 154112, v25
  ds_add_f32 v2, v128 offset:0
  ds_add_f32 v2, v129 offset:4
  ds_add_f32 v2, v130 offset:8
  ds_add_f32 v2, v131 offset:12
  s_mov_b32 s22, 0
  s_branch Lr_82
Lsk_83:
  v_lshrrev_b32 v2, 3, v1
  s_movk_i32 s4, 2048
  v_mad_u32_u24 v4, v2, s4, v22
  v_add_u32 v5, 15360, v4
  v_add_u32 v6, 30720, v4
  v_add_u32 v7, 46080, v4
  s_lshl_b32 s5, s78, 7
  s_mul_i32 s4, s79, 3670016
  s_add_u32 s5, s5, s4
  s_lshl_b32 s30, s79, 8
  s_sub_u32 s30, 128, s30
  s_mul_i32 s4, s85, 65536
  s_add_u32 s5, s5, s4
  s_mov_b32 s17, 131072
  s_mul_i32 s19, s17, 28
  s_add_u32 s18, s5, s19
  s_mul_i32 s6, s76, 7
  s_lshr_b32 s6, s6, 2
  s_mul_i32 s6, s6, s17
  s_add_u32 s16, s5, s6
  s_lshl_b32 s20, s85, 12
  s_add_u32 s20, s20, 65536
  s_add_u32 s25, s20, 81920
  s_mov_b32 m0, s20
  s_nop 0
  buffer_load_dwordx4 v4, s[60:63], s16 offen offset:0 lds
  buffer_load_dwordx4 v5, s[60:63], s16 offen offset:1024 lds
  buffer_load_dwordx4 v6, s[60:63], s16 offen offset:2048 lds
  buffer_load_dwordx4 v7, s[60:63], s16 offen offset:3072 lds
  s_add_u32 m0, s20, 8192
  s_add_u32 s5, s16, s30
  buffer_load_dwordx4 v4, s[60:63], s5 offen offset:0 lds
  buffer_load_dwordx4 v5, s[60:63], s5 offen offset:1024 lds
  buffer_load_dwordx4 v6, s[60:63], s5 offen offset:2048 lds
  buffer_load_dwordx4 v7, s[60:63], s5 offen offset:3072 lds
  s_add_u32 s16, s16, s17
  s_cmp_eq_u32 s16, s18
  s_cselect_b32 s4, s19, 0
  s_sub_u32 s16, s16, s4
  s_add_u32 s20, s20, 16384
  s_cmp_eq_u32 s20, s25
  s_cselect_b32 s4, 81920, 0
  s_sub_u32 s20, s20, s4
  s_mov_b32 m0, s20
  s_nop 0
  buffer_load_dwordx4 v4, s[60:63], s16 offen offset:0 lds
  buffer_load_dwordx4 v5, s[60:63], s16 offen offset:1024 lds
  buffer_load_dwordx4 v6, s[60:63], s16 offen offset:2048 lds
  buffer_load_dwordx4 v7, s[60:63], s16 offen offset:3072 lds
  s_add_u32 m0, s20, 8192
  s_add_u32 s5, s16, s30
  buffer_load_dwordx4 v4, s[60:63], s5 offen offset:0 lds
  buffer_load_dwordx4 v5, s[60:63], s5 offen offset:1024 lds
  buffer_load_dwordx4 v6, s[60:63], s5 offen offset:2048 lds
  buffer_load_dwordx4 v7, s[60:63], s5 offen offset:3072 lds
  s_add_u32 s16, s16, s17
  s_cmp_eq_u32 s16, s18
  s_cselect_b32 s4, s19, 0
  s_sub_u32 s16, s16, s4
  s_add_u32 s20, s20, 16384
  s_cmp_eq_u32 s20, s25
  s_cselect_b32 s4, 81920, 0
  s_sub_u32 s20, s20, s4
  s_mov_b32 m0, s20
  s_nop 0
  buffer_load_dwordx4 v4, s[60:63], s16 offen offset:0 lds
  buffer_load_dwordx4 v5, s[60:63], s16 offen offset:1024 lds
  buffer_load_dwordx4 v6, s[60:63], s16 offen offset:2048 lds
  buffer_load_dwordx4 v7, s[60:63], s16 offen offset:3072 lds
  s_add_u32 m0, s20, 8192
  s_add_u32 s5, s16, s30
  buffer_load_dwordx4 v4, s[60:63], s5 offen offset:0 lds
  buffer_load_dwordx4 v5, s[60:63], s5 offen offset:1024 lds
  buffer_load_dwordx4 v6, s[60:63], s5 offen offset:2048 lds
  buffer_load_dwordx4 v7, s[60:63], s5 offen offset:3072 lds
  s_add_u32 s16, s16, s17
  s_cmp_eq_u32 s16, s18
  s_cselect_b32 s4, s19, 0
  s_sub_u32 s16, s16, s4
  s_add_u32 s20, s20, 16384
  s_cmp_eq_u32 s20, s25
  s_cselect_b32 s4, 81920, 0
  s_sub_u32 s20, s20, s4
  s_mov_b32 m0, s20
  s_nop 0
  buffer_load_dwordx4 v4, s[60:63], s16 offen offset:0 lds
  buffer_load_dwordx4 v5, s[60:63], s16 offen offset:1024 lds
  buffer_load_dwordx4 v6, s[60:63], s16 offen offset:2048 lds
  buffer_load_dwordx4 v7, s[60:63], s16 offen offset:3072 lds
  s_add_u32 m0, s20, 8192
  s_add_u32 s5, s16, s30
  buffer_load_dwordx4 v4, s[60:63], s5 offen offset:0 lds
  buffer_load_dwordx4 v5, s[60:63], s5 offen offset:1024 lds
  buffer_load_dwordx4 v6, s[60:63], s5 offen offset:2048 lds
  buffer_load_dwordx4 v7, s[60:63], s5 offen offset:3072 lds
  s_add_u32 s16, s16, s17
  s_cmp_eq_u32 s16, s18
  s_cselect_b32 s4, s19, 0
  s_sub_u32 s16, s16, s4
  s_add_u32 s20, s20, 16384
  s_cmp_eq_u32 s20, s25
  s_cselect_b32 s4, 81920, 0
  s_sub_u32 s20, s20, s4
  s_mov_b32 m0, s20
  s_nop 0
  buffer_load_dwordx4 v4, s[60:63], s16 offen offset:0 lds
  buffer_load_dwordx4 v5, s[60:63], s16 offen offset:1024 lds
  buffer_load_dwordx4 v6, s[60:63], s16 offen offset:2048 lds
  buffer_load_dwordx4 v7, s[60:63], s16 offen offset:3072 lds
  s_add_u32 m0, s20, 8192
  s_add_u32 s5, s16, s30
  buffer_load_dwordx4 v4, s[60:63], s5 offen offset:0 lds
  buffer_load_dwordx4 v5, s[60:63], s5 offen offset:1024 lds
  buffer_load_dwordx4 v6, s[60:63], s5 offen offset:2048 lds
  buffer_load_dwordx4 v7, s[60:63], s5 offen offset:3072 lds
  s_add_u32 s16, s16, s17
  s_cmp_eq_u32 s16, s18
  s_cselect_b32 s4, s19, 0
  s_sub_u32 s16, s16, s4
  s_add_u32 s20, s20, 16384
  s_cmp_eq_u32 s20, s25
  s_cselect_b32 s4, 81920, 0
  s_sub_u32 s20, s20, s4
  s_waitcnt vmcnt(32)
  s_barrier
  s_waitcnt vmcnt(24)
  s_barrier
  s_mov_b32 s21, 1
Ll_91:
  s_mov_b32 m0, s20
  s_nop 0
  buffer_load_dwordx4 v4, s[60:63], s16 offen offset:0 lds
  buffer_load_dwordx4 v5, s[60:63], s16 offen offset:1024 lds
  buffer_load_dwordx4 v6, s[60:63], s16 offen offset:2048 lds
  buffer_load_dwordx4 v7, s[60:63], s16 offen offset:3072 lds
  s_add_u32 m0, s20, 8192
  s_add_u32 s5, s16, s30
  buffer_load_dwordx4 v4, s[60:63], s5 offen offset:0 lds
  buffer_load_dwordx4 v5, s[60:63], s5 offen offset:1024 lds
  buffer_load_dwordx4 v6, s[60:63], s5 offen offset:2048 lds
  buffer_load_dwordx4 v7, s[60:63], s5 offen offset:3072 lds
  s_add_u32 s16, s16, s17
  s_cmp_eq_u32 s16, s18
  s_cselect_b32 s4, s19, 0
  s_sub_u32 s16, s16, s4
  s_add_u32 s20, s20, 16384
  s_cmp_eq_u32 s20, s25
  s_cselect_b32 s4, 81920, 0
  s_sub_u32 s20, s20, s4
Lr_93:
  s_add_u32 s21, s21, 1
  s_cmp_le_u32 s21, 23
  s_waitcnt vmcnt(24)
  s_barrier
  s_cbranch_scc1 Ll_91
  s_waitcnt vmcnt(16)
  s_barrier
  s_waitcnt vmcnt(8)
  s_barrier
  s_waitcnt vmcnt(0)
  s_barrier
  s_waitcnt lgkmcnt(0)
  s_barrier
  s_cmp_lg_u32 s82, 0
  s_cbranch_scc1 L_lend
  v_lshrrev_b32 v2, 3, v1
  s_movk_i32 s4, 6144
  v_mad_u32_u24 v4, v2, s4, v22
  v_add_u32 v5, 48128, v4
  v_add_u32 v6, 96256, v4
  v_add_u32 v7, 144384, v4
  s_lshl_b32 s5, s77, 7
  s_mul_i32 s4, s85, 196608
  s_add_u32 s5, s5, s4
  s_mov_b32 s17, 393216
  s_mul_i32 s19, s17, 16
  s_add_u32 s18, s5, s19
  s_mov_b32 s6, s76
  s_mul_i32 s6, s6, s17
  s_add_u32 s16, s5, s6
  s_lshl_b32 s20, s85, 12
  s_add_u32 s20, s20, 65536
  s_add_u32 s25, s20, 73728
  s_mov_b32 m0, s20
  s_nop 0
  buffer_load_dwordx4 v4, s[48:51], s16 offen offset:0 lds
  buffer_load_dwordx4 v5, s[48:51], s16 offen offset:1024 lds
  buffer_load_dwordx4 v6, s[48:51], s16 offen offset:2048 lds
  buffer_load_dwordx4 v7, s[48:51], s16 offen offset:3072 lds
  s_add_u32 m0, s20, 8192
  s_add_u32 s5, s16, 2048
  buffer_load_dwordx4 v4, s[48:51], s5 offen offset:0 lds
  buffer_load_dwordx4 v5, s[48:51], s5 offen offset:1024 lds
  buffer_load_dwordx4 v6, s[48:51], s5 offen offset:2048 lds
  buffer_load_dwordx4 v7, s[48:51], s5 offen offset:3072 lds
  s_add_u32 m0, s20, 16384
  s_add_u32 s5, s16, 4096
  buffer_load_dwordx4 v4, s[48:51], s5 offen offset:0 lds
  buffer_load_dwordx4 v5, s[48:51], s5 offen offset:1024 lds
  buffer_load_dwordx4 v6, s[48:51], s5 offen offset:2048 lds
  buffer_load_dwordx4 v7, s[48:51], s5 offen offset:3072 lds
  s_add_u32 s16, s16, s17
  s_cmp_eq_u32 s16, s18
  s_cselect_b32 s4, s19, 0
  s_sub_u32 s16, s16, s4
  s_add_u32 s20, s20, 24576
  s_cmp_eq_u32 s20, s25
  s_cselect_b32 s4, 73728, 0
  s_sub_u32 s20, s20, s4
  s_mov_b32 m0, s20
  s_nop 0
  buffer_load_dwordx4 v4, s[48:51], s16 offen offset:0 lds
  buffer_load_dwordx4 v5, s[48:51], s16 offen offset:1024 lds
  buffer_load_dwordx4 v6, s[48:51], s16 offen offset:2048 lds
  buffer_load_dwordx4 v7, s[48:51], s16 offen offset:3072 lds
  s_add_u32 m0, s20, 8192
  s_add_u32 s5, s16, 2048
  buffer_load_dwordx4 v4, s[48:51], s5 offen offset:0 lds
  buffer_load_dwordx4 v5, s[48:51], s5 offen offset:1024 lds
  buffer_load_dwordx4 v6, s[48:51], s5 offen offset:2048 lds
  buffer_load_dwordx4 v7, s[48:51], s5 offen offset:3072 lds
  s_add_u32 m0, s20, 16384
  s_add_u32 s5, s16, 4096
  buffer_load_dwordx4 v4, s[48:51], s5 offen offset:0 lds
  buffer_load_dwordx4 v5, s[48:51], s5 offen offset:1024 lds
  buffer_load_dwordx4 v6, s[48:51], s5 offen offset:2048 lds
  buffer_load_dwordx4 v7, s[48:51], s5 offen offset:3072 lds
  s_add_u32 s16, s16, s17
  s_cmp_eq_u32 s16, s18
  s_cselect_b32 s4, s19, 0
  s_sub_u32 s16, s16, s4
  s_add_u32 s20, s20, 24576
  s_cmp_eq_u32 s20, s25
  s_cselect_b32 s4, 73728, 0
  s_sub_u32 s20, s20, s4
  s_mov_b32 m0, s20
  s_nop 0
  buffer_load_dwordx4 v4, s[48:51], s16 offen offset:0 lds
  buffer_load_dwordx4 v5, s[48:51], s16 offen offset:1024 lds
  buffer_load_dwordx4 v6, s[48:51], s16 offen offset:2048 lds
  buffer_load_dwordx4 v7, s[48:51], s16 offen offset:3072 lds
  s_add_u32 m0, s20, 8192
  s_add_u32 s5, s16, 2048
  buffer_load_dwordx4 v4, s[48:51], s5 offen offset:0 lds
  buffer_load_dwordx4 v5, s[48:51], s5 offen offset:1024 lds
  buffer_load_dwordx4 v6, s[48:51], s5 offen offset:2048 lds
  buffer_load_dwordx4 v7, s[48:51], s5 offen offset:3072 lds
  s_add_u32 m0, s20, 16384
  s_add_u32 s5, s16, 4096
  buffer_load_dwordx4 v4, s[48:51], s5 offen offset:0 lds
  buffer_load_dwordx4 v5, s[48:51], s5 offen offset:1024 lds
  buffer_load_dwordx4 v6, s[48:51], s5 offen offset:2048 lds
  buffer_load_dwordx4 v7, s[48:51], s5 offen offset:3072 lds
  s_add_u32 s16, s16, s17
  s_cmp_eq_u32 s16, s18
  s_cselect_b32 s4, s19, 0
  s_sub_u32 s16, s16, s4
  s_add_u32 s20, s20, 24576
  s_cmp_eq_u32 s20, s25
  s_cselect_b32 s4, 73728, 0
  s_sub_u32 s20, s20, s4
  s_mov_b32 s22, 0
  s_mov_b32 s82, 1
  s_branch L_wlayer
L_lend:
L_end:
  s_endpgm
.section .rodata,"a"
.p2align 6
.amdhsa_kernel mega_kernel
  .amdhsa_next_free_vgpr 256
  .amdhsa_next_free_sgpr 102
  .amdhsa_accum_offset 256
  .amdhsa_group_segment_fixed_size 0
  .amdhsa_kernarg_size 88
  .amdhsa_user_sgpr_count 2
  .amdhsa_user_sgpr_kernarg_segment_ptr 1
  .amdhsa_system_sgpr_workgroup_id_x 1
  .amdhsa_float_denorm_mode_32 3
  .amdhsa_float_denorm_mode_16_64 3
.end_amdhsa_kernel
.text
```

```asm
; @launch kernel=mega_kernel grid=(256,1,1) block=(512,1,1) lds=156672
.amdgcn_target "amdgcn-amd-amdhsa--gfx950"
.text
.globl mega_kernel
.p2align 8
.type mega_kernel,@function
mega_kernel:
  s_cmp_ge_u32 s2, 256
  s_cbranch_scc1 L_end
  s_load_dwordx16 s[16:31], s[0:1], 0
  s_load_dwordx2 s[32:33], s[0:1], 64
  s_load_dwordx4 s[36:39], s[0:1], 72
  v_lshrrev_b32 v2, 6, v0
  v_and_b32 v1, 63, v0
  v_readfirstlane_b32 s81, v2
  s_and_b32 s3, s2, 7
  s_lshr_b32 s4, s2, 3
  s_and_b32 s5, s3, 1
  s_lshl_b32 s5, s5, 3
  s_and_b32 s6, s4, 7
  s_add_u32 s76, s5, s6
  s_lshr_b32 s5, s3, 1
  s_lshl_b32 s5, s5, 2
  s_lshr_b32 s6, s4, 3
  s_add_u32 s77, s5, s6
  s_mov_b32 s82, 0
  s_mov_b32 s88, 0
  s_and_b32 s85, s81, 1
  s_cmp_lt_u32 s81, 4
  s_cbranch_scc1 L_comp
  s_cmp_eq_u32 s81, 5
  s_cbranch_scc1 L_serv
  s_setprio 0
  s_cmp_eq_u32 s81, 4
  s_cbranch_scc1 L_xload
  v_bfe_u32 v2, v1, 1, 2
  v_bfe_u32 v3, v1, 4, 2
  v_xor_b32 v2, v2, v3
  v_lshlrev_b32 v10, 5, v2
  v_and_b32 v2, 1, v1
  v_lshl_add_u32 v10, v2, 4, v10
  v_lshrrev_b32 v2, 5, v1
  v_bfe_u32 v3, v1, 3, 2
  v_lshl_add_u32 v2, v2, 3, v3
  s_movk_i32 s4, 6144
  v_mad_u32_u24 v4, v2, s4, v10
  v_add_u32 v5, 97280, v4
  v_add_u32 v6, 22528, v4
  v_add_u32 v7, 119808, v4
  s_waitcnt lgkmcnt(0)
  s_mov_b32 s48, s18
  s_and_b32 s49, s19, 0xffff
  s_mov_b32 s50, 6291456
  s_mov_b32 s51, 0x00020000
L_wlayer:
  s_lshl_b32 s5, s77, 7
  s_mul_i32 s4, s85, 196608
  s_add_u32 s5, s5, s4
  s_mov_b32 s8, 393216
  s_mov_b32 s10, 6291456
  s_add_u32 s9, s5, s10
  s_mul_i32 s6, s76, 11
  s_lshr_b32 s6, s6, 5
  s_mul_i32 s6, s6, 1179648
  s_add_u32 s7, s5, s6
  s_lshl_b32 s11, s85, 12
  s_add_u32 s11, s11, 65536
  s_add_u32 s15, s11, 73728
  s_mov_b32 s12, 0
  s_mov_b32 m0, s11
Ll_15:
  s_nop 0
  buffer_load_dwordx4 v4, s[48:51], s7 offen offset:0 lds
  buffer_load_dwordx4 v5, s[48:51], s7 offen offset:1024 lds
  buffer_load_dwordx4 v6, s[48:51], s7 offen offset:2048 lds
  buffer_load_dwordx4 v7, s[48:51], s7 offen offset:3072 lds
  s_add_u32 m0, s11, 8192
  s_add_u32 s5, s7, 2048
  buffer_load_dwordx4 v4, s[48:51], s5 offen offset:0 lds
  buffer_load_dwordx4 v5, s[48:51], s5 offen offset:1024 lds
  buffer_load_dwordx4 v6, s[48:51], s5 offen offset:2048 lds
  buffer_load_dwordx4 v7, s[48:51], s5 offen offset:3072 lds
  s_add_u32 m0, s11, 16384
  s_add_u32 s5, s7, 4096
  buffer_load_dwordx4 v4, s[48:51], s5 offen offset:0 lds
  s_add_u32 s7, s7, s8
  s_cmp_eq_u32 s7, s9
  s_cselect_b32 s4, s10, 0
  s_sub_u32 s7, s7, s4
  buffer_load_dwordx4 v5, s[48:51], s5 offen offset:1024 lds
  s_add_u32 s11, s11, 24576
  s_cmp_eq_u32 s11, s15
  s_cselect_b32 s4, 73728, 0
  s_sub_u32 s11, s11, s4
  buffer_load_dwordx4 v6, s[48:51], s5 offen offset:2048 lds
  s_add_u32 s12, s12, 1
  s_cmp_lg_u32 s12, 3
  buffer_load_dwordx4 v7, s[48:51], s5 offen offset:3072 lds
  s_mov_b32 m0, s11
  s_cbranch_scc1 Ll_15
  s_waitcnt vmcnt(24)
  s_barrier
  s_waitcnt vmcnt(12)
  s_barrier
  buffer_load_dwordx4 v4, s[48:51], s7 offen offset:0 lds
  buffer_load_dwordx4 v5, s[48:51], s7 offen offset:1024 lds
  buffer_load_dwordx4 v6, s[48:51], s7 offen offset:2048 lds
  buffer_load_dwordx4 v7, s[48:51], s7 offen offset:3072 lds
Ll_17:
  s_add_u32 m0, s11, 8192
  s_add_u32 s5, s7, 2048
  buffer_load_dwordx4 v4, s[48:51], s5 offen offset:0 lds
  buffer_load_dwordx4 v5, s[48:51], s5 offen offset:1024 lds
  buffer_load_dwordx4 v6, s[48:51], s5 offen offset:2048 lds
  buffer_load_dwordx4 v7, s[48:51], s5 offen offset:3072 lds
  s_add_u32 m0, s11, 16384
  s_add_u32 s5, s7, 4096
  buffer_load_dwordx4 v4, s[48:51], s5 offen offset:0 lds
  s_add_u32 s7, s7, s8
  s_cmp_eq_u32 s7, s9
  s_cselect_b32 s4, s10, 0
  s_sub_u32 s7, s7, s4
  buffer_load_dwordx4 v5, s[48:51], s5 offen offset:1024 lds
  s_add_u32 s11, s11, 24576
  s_cmp_eq_u32 s11, s15
  s_cselect_b32 s4, 73728, 0
  s_sub_u32 s11, s11, s4
  buffer_load_dwordx4 v6, s[48:51], s5 offen offset:2048 lds
  s_add_u32 s12, s12, 1
  s_cmp_eq_u32 s12, 16
  buffer_load_dwordx4 v7, s[48:51], s5 offen offset:3072 lds
  s_mov_b32 m0, s11
  s_cbranch_scc1 Ll_18
  s_waitcnt vmcnt(12)
  s_barrier
  buffer_load_dwordx4 v4, s[48:51], s7 offen offset:0 lds
  buffer_load_dwordx4 v5, s[48:51], s7 offen offset:1024 lds
  buffer_load_dwordx4 v6, s[48:51], s7 offen offset:2048 lds
  buffer_load_dwordx4 v7, s[48:51], s7 offen offset:3072 lds
  s_branch Ll_17
Ll_18:
  s_waitcnt vmcnt(12)
  s_barrier
  s_waitcnt vmcnt(0)
  s_barrier
  s_barrier
  s_branch L_w1
L_xload:
  s_setprio 0
  v_lshrrev_b32 v2, 4, v1
  v_and_b32 v3, 7, v1
  v_xor_b32 v2, v2, v3
  v_lshrrev_b32 v3, 3, v1
  v_lshlrev_b32 v3, 12, v3
  v_lshl_add_u32 v4, v2, 4, v3
  v_xor_b32 v5, 64, v4
  v_add_u32 v5, 31744, v5
  v_add_u32 v6, 63488, v4
  v_add_u32 v7, 63488, v5
  s_mov_b32 s13, 0x20000
  s_mov_b32 s14, 0xffff0000
  s_movk_i32 s95, 2048
  s_lshl_b32 s5, s76, 18
  s_mov_b32 s8, 128
  s_mov_b32 s10, 2048
  s_add_u32 s9, s5, s10
  s_mul_i32 s6, s76, 11
  s_lshr_b32 s6, s6, 5
  s_mul_i32 s6, s6, 384
  s_add_u32 s7, s5, s6
  s_waitcnt lgkmcnt(0)
  s_mov_b32 s72, s16
  s_and_b32 s73, s17, 0xffff
  s_mov_b32 s74, 4194304
  s_mov_b32 s75, 0x00020000
L_xlayer:
  s_mov_b32 s11, 0
  s_mov_b32 s15, 61440
  s_cmp_eq_u32 s76, 0
  s_cselect_b32 s14, 0x70000000, s14
  s_mov_b32 s12, 0
  s_mov_b32 m0, s11
Ll_31:
  s_nop 0
  buffer_load_dwordx4 v4, s[72:75], s7 offen offset:0 sc1 lds
  buffer_load_dwordx4 v5, s[72:75], s7 offen offset:1024 sc1 lds
  buffer_load_dwordx4 v6, s[72:75], s7 offen offset:2048 sc1 lds
  buffer_load_dwordx4 v7, s[72:75], s7 offen offset:3072 sc1 lds
  s_add_u32 m0, s11, 8192
  s_add_u32 s5, s7, s14
  buffer_load_dwordx4 v4, s[72:75], s5 offen offset:0 sc1 lds
  buffer_load_dwordx4 v5, s[72:75], s5 offen offset:1024 sc1 lds
  s_add_u32 m0, s11, 4096
  s_add_u32 s5, s7, s13
  buffer_load_dwordx4 v4, s[72:75], s5 offen offset:0 sc1 lds
  buffer_load_dwordx4 v5, s[72:75], s5 offen offset:1024 sc1 lds
  buffer_load_dwordx4 v6, s[72:75], s5 offen offset:2048 sc1 lds
  buffer_load_dwordx4 v7, s[72:75], s5 offen offset:3072 sc1 lds
  s_add_u32 m0, s11, 10240
  s_add_u32 s3, s7, s95
  buffer_load_dwordx4 v4, s[72:75], s3 offen offset:0 sc1 lds
  buffer_load_dwordx4 v5, s[72:75], s3 offen offset:1024 sc1 lds
  buffer_load_dwordx4 v6, s[72:75], s3 offen offset:2048 sc1 lds
  buffer_load_dwordx4 v7, s[72:75], s3 offen offset:3072 sc1 lds
  s_add_u32 m0, s11, 18432
  s_add_u32 s5, s3, s14
  buffer_load_dwordx4 v4, s[72:75], s5 offen offset:0 sc1 lds
  buffer_load_dwordx4 v5, s[72:75], s5 offen offset:1024 sc1 lds
  s_add_u32 m0, s11, 14336
  s_add_u32 s5, s3, s13
  buffer_load_dwordx4 v4, s[72:75], s5 offen offset:0 sc1 lds
  s_add_u32 s7, s7, s8
  s_cmp_eq_u32 s7, s9
  s_cselect_b32 s4, s10, 0
  s_sub_u32 s7, s7, s4
  buffer_load_dwordx4 v5, s[72:75], s5 offen offset:1024 sc1 lds
  s_add_u32 s11, s11, 20480
  s_cmp_eq_u32 s11, s15
  s_cselect_b32 s4, 61440, 0
  s_sub_u32 s11, s11, s4
  buffer_load_dwordx4 v6, s[72:75], s5 offen offset:2048 sc1 lds
  s_add_u32 s12, s12, 1
  s_cmp_lg_u32 s12, 3
  buffer_load_dwordx4 v7, s[72:75], s5 offen offset:3072 sc1 lds
  s_mov_b32 m0, s11
  s_cbranch_scc1 Ll_31
  s_waitcnt vmcnt(40)
  s_barrier
  s_waitcnt vmcnt(20)
  s_barrier
  buffer_load_dwordx4 v4, s[72:75], s7 offen offset:0 sc1 lds
  buffer_load_dwordx4 v5, s[72:75], s7 offen offset:1024 sc1 lds
  buffer_load_dwordx4 v6, s[72:75], s7 offen offset:2048 sc1 lds
  buffer_load_dwordx4 v7, s[72:75], s7 offen offset:3072 sc1 lds
Ll_33:
  s_add_u32 m0, s11, 8192
  s_add_u32 s5, s7, s14
  buffer_load_dwordx4 v4, s[72:75], s5 offen offset:0 sc1 lds
  buffer_load_dwordx4 v5, s[72:75], s5 offen offset:1024 sc1 lds
  s_add_u32 m0, s11, 4096
  s_add_u32 s5, s7, s13
  buffer_load_dwordx4 v4, s[72:75], s5 offen offset:0 sc1 lds
  buffer_load_dwordx4 v5, s[72:75], s5 offen offset:1024 sc1 lds
  buffer_load_dwordx4 v6, s[72:75], s5 offen offset:2048 sc1 lds
  buffer_load_dwordx4 v7, s[72:75], s5 offen offset:3072 sc1 lds
  s_add_u32 m0, s11, 10240
  s_add_u32 s3, s7, s95
  buffer_load_dwordx4 v4, s[72:75], s3 offen offset:0 sc1 lds
  buffer_load_dwordx4 v5, s[72:75], s3 offen offset:1024 sc1 lds
  buffer_load_dwordx4 v6, s[72:75], s3 offen offset:2048 sc1 lds
  buffer_load_dwordx4 v7, s[72:75], s3 offen offset:3072 sc1 lds
  s_add_u32 m0, s11, 18432
  s_add_u32 s5, s3, s14
  buffer_load_dwordx4 v4, s[72:75], s5 offen offset:0 sc1 lds
  buffer_load_dwordx4 v5, s[72:75], s5 offen offset:1024 sc1 lds
  s_add_u32 m0, s11, 14336
  s_add_u32 s5, s3, s13
  buffer_load_dwordx4 v4, s[72:75], s5 offen offset:0 sc1 lds
  s_add_u32 s7, s7, s8
  s_cmp_eq_u32 s7, s9
  s_cselect_b32 s4, s10, 0
  s_sub_u32 s7, s7, s4
  buffer_load_dwordx4 v5, s[72:75], s5 offen offset:1024 sc1 lds
  s_add_u32 s11, s11, 20480
  s_cmp_eq_u32 s11, s15
  s_cselect_b32 s4, 61440, 0
  s_sub_u32 s11, s11, s4
  buffer_load_dwordx4 v6, s[72:75], s5 offen offset:2048 sc1 lds
  s_add_u32 s12, s12, 1
  s_cmp_eq_u32 s12, 16
  buffer_load_dwordx4 v7, s[72:75], s5 offen offset:3072 sc1 lds
  s_mov_b32 m0, s11
  s_cbranch_scc1 Ll_34
  s_waitcnt vmcnt(20)
  s_barrier
  buffer_load_dwordx4 v4, s[72:75], s7 offen offset:0 sc1 lds
  buffer_load_dwordx4 v5, s[72:75], s7 offen offset:1024 sc1 lds
  buffer_load_dwordx4 v6, s[72:75], s7 offen offset:2048 sc1 lds
  buffer_load_dwordx4 v7, s[72:75], s7 offen offset:3072 sc1 lds
  s_branch Ll_33
Ll_34:
  s_waitcnt vmcnt(20)
  s_barrier
  s_waitcnt vmcnt(0)
  s_barrier
  s_barrier
  s_branch L_x1
L_serv:
  s_setprio 3
  s_and_b32 s80, s77, 7
  s_lshr_b32 s79, s77, 3
  s_lshl_b32 s78, s80, 1
  s_add_u32 s78, s78, s79
  s_lshl_b32 s5, s76, 4
  s_add_u32 s5, s5, s77
  s_lshl_b32 s84, s5, 11
  s_mov_b32 s83, 3145728
  s_mov_b32 s87, 512
  s_lshr_b32 s86, s81, 1
  v_lshlrev_b32 v4, 4, v1
  v_mov_b32 v24, 0
  v_mov_b32 v25, 0
  v_mov_b32 v26, 0
  v_mov_b32 v27, 0
  v_and_b32 v2, 14, v1
  v_lshlrev_b32 v3, 11, v2
  v_and_b32 v2, 1, v1
  v_lshl_add_u32 v3, v2, 4, v3
  v_and_b32 v2, 48, v1
  v_lshl_add_u32 v3, v2, 1, v3
  v_bfe_u32 v2, v1, 3, 2
  v_and_b32 v22, 7, v1
  v_lshlrev_b32 v2, 14, v2
  v_lshl_add_u32 v2, v22, 3, v2
  s_lshl_b32 s5, s76, 7
  s_lshl_b32 s4, s80, 4
  s_add_u32 s6, s5, s4
  s_add_u32 s6, s6, s79
  s_lshl_b32 s6, s6, 11
  s_lshr_b32 s10, s84, 5
  s_add_u32 s10, s10, 1638400
  s_waitcnt lgkmcnt(0)
  s_mov_b32 s48, s18
  s_and_b32 s49, s19, 0xffff
  s_mov_b32 s50, 6291456
  s_mov_b32 s51, 0x00020000
  s_sub_u32 s4, 384, s48
  s_and_b32 s4, s4, 1023
  s_mul_i32 s5, s84, 12
  s_add_u32 s4, s4, s5
  v_lshlrev_b32 v109, 10, v1
  s_mov_b64 exec, 0xffffff
  buffer_load_dword v109, v109, s[48:51], s4 offen
  s_mov_b64 exec, -1
  s_mov_b32 s40, s38
  s_and_b32 s41, s39, 0xffff
  s_mov_b32 s42, 100663296
  s_mov_b32 s43, 0x00020000
  s_mov_b32 s44, s16
  s_and_b32 s45, s17, 0xffff
  s_mov_b32 s46, 4194304
  s_mov_b32 s47, 0x00020000
  s_mov_b32 s68, s36
  s_and_b32 s69, s37, 0xffff
  s_mov_b32 s70, 256
  s_mov_b32 s71, 0x00020000
  buffer_store_dwordx4 v[24:27], v4, s[40:43], s84 offen sc0 sc1
  buffer_store_dwordx4 v[24:27], v4, s[40:43], s84 offen offset:1024 sc0 sc1
  buffer_store_dwordx2 v[24:25], v2, s[40:43], s10 offen sc0 sc1
  v_mov_b32 v108, v3
  s_mov_b32 s7, s6
  s_branch L_s1
L_comp:
  s_and_b32 s80, s77, 7
  s_lshr_b32 s79, s77, 3
  s_lshl_b32 s78, s80, 1
  s_add_u32 s78, s78, s79
  s_lshl_b32 s5, s76, 4
  s_add_u32 s5, s5, s77
  s_lshl_b32 s84, s5, 11
  s_mov_b32 s83, 3145728
  s_mov_b32 s87, 512
  s_lshr_b32 s86, s81, 1
  s_waitcnt lgkmcnt(0)
  s_mov_b32 s40, s38
  s_and_b32 s41, s39, 0xffff
  s_mov_b32 s42, 100663296
  s_mov_b32 s43, 0x00020000
  s_mov_b32 s44, s16
  s_and_b32 s45, s17, 0xffff
  s_mov_b32 s46, 4194304
  s_mov_b32 s47, 0x00020000
  s_mov_b32 s64, s32
  s_and_b32 s65, s33, 0xffff
  s_mov_b32 s66, 4194304
  s_mov_b32 s67, 0x00020000
  s_setprio 1
  v_lshlrev_b32 v11, 4, v1
  v_lshrrev_b32 v2, 3, v1
  v_and_b32 v3, 7, v1
  v_lshlrev_b32 v3, 3, v3
  v_lshl_add_u32 v30, v2, 11, v3
  v_mov_b32 v27, 1
  v_mov_b32 v28, 156416
  v_and_b32 v29, 48, v1
  s_lshl_b32 s4, s76, 15
  s_lshl_b32 s5, s77, 2
  s_add_u32 s4, s4, s5
  v_lshlrev_b32 v24, 11, v1
  v_and_b32 v2, 16, v1
  v_lshl_add_u32 v24, v2, 2, v24
  v_add_u32 v24, s4, v24
  v_lshrrev_b32 v2, 2, v1
  v_lshlrev_b32 v25, 7, v2
  v_and_b32 v2, 3, v1
  v_lshl_add_u32 v25, v2, 3, v25
  v_add_u32 v25, 65536, v25
  v_bfe_u32 v26, v1, 3, 2
  v_and_b32 v2, 15, v1
  v_lshrrev_b32 v3, 2, v29
  v_sub_u32 v2, v2, v3
  s_mov_b32 s4, 0xf149f2ca
  v_mov_b32 v32, s4
  v_subrev_u32 v3, 0, v2
  v_cmp_gt_u32 vcc, 8, v3
  s_nop 1
  v_cndmask_b32_e64 v12, v32, 0, vcc
  v_cmp_ge_i32 vcc, -9, v3
  s_nop 1
  v_cndmask_b32_e64 v16, v32, 0, vcc
  v_mov_b32 v20, v16
  v_subrev_u32 v3, 1, v2
  v_cmp_gt_u32 vcc, 8, v3
  s_nop 1
  v_cndmask_b32_e64 v13, v32, 0, vcc
  v_cmp_ge_i32 vcc, -9, v3
  s_nop 1
  v_cndmask_b32_e64 v17, v32, 0, vcc
  v_mov_b32 v21, v17
  v_subrev_u32 v3, 2, v2
  v_cmp_gt_u32 vcc, 8, v3
  s_nop 1
  v_cndmask_b32_e64 v14, v32, 0, vcc
  v_cmp_ge_i32 vcc, -9, v3
  s_nop 1
  v_cndmask_b32_e64 v18, v32, 0, vcc
  v_mov_b32 v22, v18
  v_subrev_u32 v3, 3, v2
  v_cmp_gt_u32 vcc, 8, v3
  s_nop 1
  v_cndmask_b32_e64 v15, v32, 0, vcc
  v_cmp_ge_i32 vcc, -9, v3
  s_nop 1
  v_cndmask_b32_e64 v19, v32, 0, vcc
  v_mov_b32 v23, v19
  s_cmp_lg_u32 s76, 0
  s_cbranch_scc1 L_1
  v_mov_b32 v20, v32
  v_mov_b32 v21, v32
  v_mov_b32 v22, v32
  v_mov_b32 v23, v32
L_1:
L_clayer:
  s_mov_b32 s16, 0
  s_mov_b32 s17, 20480
  s_mov_b32 s18, 0xffff6000
  s_mov_b32 s19, 0
  s_mov_b32 s20, 24576
  s_mov_b32 s21, 0xffff4000
  s_mul_i32 s4, s85, 10240
  v_add_u32 v4, s4, v11
  v_add_u32 v5, 1024, v4
  s_cmp_lg_u32 s82, 0
  s_cbranch_scc1 L_2
  v_and_b32 v2, 15, v1
  v_lshrrev_b32 v3, 1, v2
  v_lshrrev_b32 v32, 4, v1
  v_xor_b32 v3, v3, v32
  v_lshlrev_b32 v3, 4, v3
  v_lshl_add_u32 v3, v2, 7, v3
  v_add_u32 v4, s4, v3
  v_xor_b32 v3, 64, v3
  v_add_u32 v5, s4, v3
L_2:
  s_lshl_b32 s4, s86, 1
  v_xor_b32 v2, s4, v26
  v_lshl_add_u32 v6, v2, 5, v25
  s_add_u32 s4, s4, 1
  v_xor_b32 v2, s4, v26
  v_lshl_add_u32 v7, v2, 5, v25
  v_mov_b64 v[128:129], 0
  v_mov_b64 v[130:131], 0
  v_mov_b64 v[132:133], 0
  v_mov_b64 v[134:135], 0
  v_mov_b64 v[136:137], 0
  v_mov_b64 v[138:139], 0
  v_mov_b64 v[140:141], 0
  v_mov_b64 v[142:143], 0
  v_mov_b64 v[144:145], 0
  v_mov_b64 v[146:147], 0
  v_mov_b64 v[148:149], 0
  v_mov_b64 v[150:151], 0
  v_mov_b64 v[152:153], 0
  v_mov_b64 v[154:155], 0
  v_mov_b64 v[156:157], 0
  v_mov_b64 v[158:159], 0
  v_mov_b64 v[160:161], 0
  v_mov_b64 v[162:163], 0
  v_mov_b64 v[164:165], 0
  v_mov_b64 v[166:167], 0
  v_mov_b64 v[168:169], 0
  v_mov_b64 v[170:171], 0
  v_mov_b64 v[172:173], 0
  v_mov_b64 v[174:175], 0
  v_mov_b64 v[176:177], 0
  v_mov_b64 v[178:179], 0
  v_mov_b64 v[180:181], 0
  v_mov_b64 v[182:183], 0
  v_mov_b64 v[184:185], 0
  v_mov_b64 v[186:187], 0
  v_mov_b64 v[188:189], 0
  v_mov_b64 v[190:191], 0
  v_mov_b64 v[192:193], 0
  v_mov_b64 v[194:195], 0
  v_mov_b64 v[196:197], 0
  v_mov_b64 v[198:199], 0
  v_mov_b64 v[200:201], 0
  v_mov_b64 v[202:203], 0
  v_mov_b64 v[204:205], 0
  v_mov_b64 v[206:207], 0
  v_mov_b64 v[208:209], 0
  v_mov_b64 v[210:211], 0
  v_mov_b64 v[212:213], 0
  v_mov_b64 v[214:215], 0
  v_mov_b64 v[216:217], 0
  v_mov_b64 v[218:219], 0
  v_mov_b64 v[220:221], 0
  v_mov_b64 v[222:223], 0
  v_mov_b64 v[224:225], 0
  v_mov_b64 v[226:227], 0
  v_mov_b64 v[228:229], 0
  v_mov_b64 v[230:231], 0
  v_mov_b64 v[232:233], 0
  v_mov_b64 v[234:235], 0
  v_mov_b64 v[236:237], 0
  v_mov_b64 v[238:239], 0
  s_mov_b32 s22, 16
  s_barrier
  ds_read_b64_tr_b16 v[52:53], v6 offset:0
  ds_read_b64_tr_b16 v[54:55], v6 offset:2048
  ds_read_b128 v[32:35], v4 offset:0
  ds_read_b128 v[36:39], v4 offset:2048
  ds_read_b128 v[40:43], v4 offset:4096
  ds_read_b128 v[44:47], v4 offset:6144
  ds_read_b128 v[48:51], v4 offset:8192
  ds_read_b64_tr_b16 v[56:57], v7 offset:0
  ds_read_b64_tr_b16 v[58:59], v7 offset:2048
  ds_read_b64_tr_b16 v[60:61], v6 offset:8192
  ds_read_b64_tr_b16 v[62:63], v6 offset:10240
  ds_read_b64_tr_b16 v[64:65], v7 offset:8192
  ds_read_b64_tr_b16 v[66:67], v7 offset:10240
  ds_read_b64_tr_b16 v[68:69], v6 offset:16384
  ds_read_b64_tr_b16 v[70:71], v6 offset:18432
  ds_read_b64_tr_b16 v[72:73], v7 offset:16384
  ds_read_b64_tr_b16 v[74:75], v7 offset:18432
Lk_3:
  s_waitcnt lgkmcnt(0)
  v_mfma_f32_16x16x32_bf16 v[128:131], v[52:55], v[32:35], v[128:131]
  ds_read_b64_tr_b16 v[96:97], v6 offset:4096
  v_mfma_f32_16x16x32_bf16 v[136:139], v[52:55], v[36:39], v[136:139]
  ds_read_b64_tr_b16 v[98:99], v6 offset:6144
  v_mfma_f32_16x16x32_bf16 v[144:147], v[52:55], v[40:43], v[144:147]
  ds_read_b128 v[76:79], v5 offset:0
  v_mfma_f32_16x16x32_bf16 v[152:155], v[52:55], v[44:47], v[152:155]
  ds_read_b128 v[80:83], v5 offset:2048
  v_mfma_f32_16x16x32_bf16 v[132:135], v[56:59], v[32:35], v[132:135]
  ds_read_b128 v[84:87], v5 offset:4096
  v_mfma_f32_16x16x32_bf16 v[140:143], v[56:59], v[36:39], v[140:143]
  ds_read_b128 v[88:91], v5 offset:6144
  v_mfma_f32_16x16x32_bf16 v[148:151], v[56:59], v[40:43], v[148:151]
  ds_read_b128 v[92:95], v5 offset:8192
  v_mfma_f32_16x16x32_bf16 v[156:159], v[56:59], v[44:47], v[156:159]
  ds_read_b64_tr_b16 v[100:101], v7 offset:4096
  v_mfma_f32_16x16x32_bf16 v[160:163], v[60:63], v[32:35], v[160:163]
  ds_read_b64_tr_b16 v[102:103], v7 offset:6144
  v_mfma_f32_16x16x32_bf16 v[168:171], v[60:63], v[36:39], v[168:171]
  ds_read_b64_tr_b16 v[104:105], v6 offset:12288
  v_mfma_f32_16x16x32_bf16 v[176:179], v[60:63], v[40:43], v[176:179]
  ds_read_b64_tr_b16 v[106:107], v6 offset:14336
  v_mfma_f32_16x16x32_bf16 v[184:187], v[60:63], v[44:47], v[184:187]
  ds_read_b64_tr_b16 v[108:109], v7 offset:12288
  v_mfma_f32_16x16x32_bf16 v[192:195], v[60:63], v[48:51], v[192:195]
  ds_read_b64_tr_b16 v[110:111], v7 offset:14336
  v_mfma_f32_16x16x32_bf16 v[164:167], v[64:67], v[32:35], v[164:167]
  ds_read_b64_tr_b16 v[112:113], v6 offset:20480
  v_mfma_f32_16x16x32_bf16 v[172:175], v[64:67], v[36:39], v[172:175]
  ds_read_b64_tr_b16 v[114:115], v6 offset:22528
  v_mfma_f32_16x16x32_bf16 v[180:183], v[64:67], v[40:43], v[180:183]
  ds_read_b64_tr_b16 v[116:117], v7 offset:20480
  v_mfma_f32_16x16x32_bf16 v[188:191], v[64:67], v[44:47], v[188:191]
  ds_read_b64_tr_b16 v[118:119], v7 offset:22528
  v_mfma_f32_16x16x32_bf16 v[196:199], v[64:67], v[48:51], v[196:199]
  s_add_u32 s16, s16, s17
  s_cmp_eq_u32 s16, 61440
  s_cselect_b32 s23, s18, s17
  v_mfma_f32_16x16x32_bf16 v[200:203], v[32:35], v[68:71], v[200:203]
  s_cselect_b32 s16, 0, s16
  v_add_u32 v4, s23, v4
  v_add_u32 v5, s23, v5
  v_mfma_f32_16x16x32_bf16 v[208:211], v[36:39], v[68:71], v[208:211]
  s_add_u32 s19, s19, s20
  s_cmp_eq_u32 s19, 73728
  s_cselect_b32 s23, s21, s20
  v_mfma_f32_16x16x32_bf16 v[216:219], v[40:43], v[68:71], v[216:219]
  s_cselect_b32 s19, 0, s19
  v_add_u32 v6, s23, v6
  v_add_u32 v7, s23, v7
  v_mfma_f32_16x16x32_bf16 v[224:227], v[44:47], v[68:71], v[224:227]
  v_mfma_f32_16x16x32_bf16 v[232:235], v[48:51], v[68:71], v[232:235]
  v_mfma_f32_16x16x32_bf16 v[204:207], v[32:35], v[72:75], v[204:207]
  v_mfma_f32_16x16x32_bf16 v[212:215], v[36:39], v[72:75], v[212:215]
  v_mfma_f32_16x16x32_bf16 v[220:223], v[40:43], v[72:75], v[220:223]
  v_mfma_f32_16x16x32_bf16 v[228:231], v[44:47], v[72:75], v[228:231]
  v_mfma_f32_16x16x32_bf16 v[236:239], v[48:51], v[72:75], v[236:239]
  s_waitcnt lgkmcnt(0)
  s_barrier
  v_mfma_f32_16x16x32_bf16 v[128:131], v[96:99], v[76:79], v[128:131]
  ds_read_b64_tr_b16 v[52:53], v6 offset:0
  v_mfma_f32_16x16x32_bf16 v[136:139], v[96:99], v[80:83], v[136:139]
  ds_read_b64_tr_b16 v[54:55], v6 offset:2048
  v_mfma_f32_16x16x32_bf16 v[144:147], v[96:99], v[84:87], v[144:147]
  ds_read_b128 v[32:35], v4 offset:0
  v_mfma_f32_16x16x32_bf16 v[152:155], v[96:99], v[88:91], v[152:155]
  ds_read_b128 v[36:39], v4 offset:2048
  v_mfma_f32_16x16x32_bf16 v[132:135], v[100:103], v[76:79], v[132:135]
  ds_read_b128 v[40:43], v4 offset:4096
  v_mfma_f32_16x16x32_bf16 v[140:143], v[100:103], v[80:83], v[140:143]
  ds_read_b128 v[44:47], v4 offset:6144
  v_mfma_f32_16x16x32_bf16 v[148:151], v[100:103], v[84:87], v[148:151]
  ds_read_b128 v[48:51], v4 offset:8192
  v_mfma_f32_16x16x32_bf16 v[156:159], v[100:103], v[88:91], v[156:159]
  ds_read_b64_tr_b16 v[56:57], v7 offset:0
  v_mfma_f32_16x16x32_bf16 v[160:163], v[104:107], v[76:79], v[160:163]
  ds_read_b64_tr_b16 v[58:59], v7 offset:2048
  v_mfma_f32_16x16x32_bf16 v[168:171], v[104:107], v[80:83], v[168:171]
  ds_read_b64_tr_b16 v[60:61], v6 offset:8192
  v_mfma_f32_16x16x32_bf16 v[176:179], v[104:107], v[84:87], v[176:179]
  ds_read_b64_tr_b16 v[62:63], v6 offset:10240
  v_mfma_f32_16x16x32_bf16 v[184:187], v[104:107], v[88:91], v[184:187]
  ds_read_b64_tr_b16 v[64:65], v7 offset:8192
  v_mfma_f32_16x16x32_bf16 v[192:195], v[104:107], v[92:95], v[192:195]
  ds_read_b64_tr_b16 v[66:67], v7 offset:10240
  v_mfma_f32_16x16x32_bf16 v[164:167], v[108:111], v[76:79], v[164:167]
  ds_read_b64_tr_b16 v[68:69], v6 offset:16384
  v_mfma_f32_16x16x32_bf16 v[172:175], v[108:111], v[80:83], v[172:175]
  ds_read_b64_tr_b16 v[70:71], v6 offset:18432
  v_mfma_f32_16x16x32_bf16 v[180:183], v[108:111], v[84:87], v[180:183]
  ds_read_b64_tr_b16 v[72:73], v7 offset:16384
  v_mfma_f32_16x16x32_bf16 v[188:191], v[108:111], v[88:91], v[188:191]
  ds_read_b64_tr_b16 v[74:75], v7 offset:18432
  v_mfma_f32_16x16x32_bf16 v[196:199], v[108:111], v[92:95], v[196:199]
  s_sub_u32 s22, s22, 1
  v_mfma_f32_16x16x32_bf16 v[200:203], v[76:79], v[112:115], v[200:203]
  s_cmp_lg_u32 s22, 0
  v_mfma_f32_16x16x32_bf16 v[208:211], v[80:83], v[112:115], v[208:211]
  v_mfma_f32_16x16x32_bf16 v[216:219], v[84:87], v[112:115], v[216:219]
  v_mfma_f32_16x16x32_bf16 v[224:227], v[88:91], v[112:115], v[224:227]
  v_mfma_f32_16x16x32_bf16 v[232:235], v[92:95], v[112:115], v[232:235]
  v_mfma_f32_16x16x32_bf16 v[204:207], v[76:79], v[116:119], v[204:207]
  v_mfma_f32_16x16x32_bf16 v[212:215], v[80:83], v[116:119], v[212:215]
  v_mfma_f32_16x16x32_bf16 v[220:223], v[84:87], v[116:119], v[220:223]
  v_mfma_f32_16x16x32_bf16 v[228:231], v[88:91], v[116:119], v[228:231]
  v_mfma_f32_16x16x32_bf16 v[236:239], v[92:95], v[116:119], v[236:239]
  s_cbranch_scc1 Lk_3
  s_cmp_lg_u32 s82, 0
  s_cbranch_scc1 L_4
  v_and_b32 v2, 15, v1
  v_lshlrev_b32 v3, 12, v2
  v_and_b32 v2, 16, v1
  v_lshl_add_u32 v3, v2, 1, v3
  v_and_b32 v2, 32, v1
  v_lshrrev_b32 v2, 1, v2
  v_add_u32 v3, v2, v3
  s_lshl_b32 s5, s76, 18
  s_lshl_b32 s4, s85, 11
  s_add_u32 s5, s5, s4
  s_lshl_b32 s4, s78, 7
  s_add_u32 s5, s5, s4
  s_lshl_b32 s4, s86, 6
  s_add_u32 s5, s5, s4
  buffer_load_dwordx4 v[240:243], v3, s[44:47], s5 offen
  s_add_u32 s5, s5, 0x10000
  buffer_load_dwordx4 v[244:247], v3, s[44:47], s5 offen
  s_add_u32 s5, s5, 0x10000
  buffer_load_dwordx4 v[248:251], v3, s[44:47], s5 offen
  s_add_u32 s5, s5, 0x10000
  buffer_load_dwordx4 v[252:255], v3, s[44:47], s5 offen
L_4:
  s_waitcnt lgkmcnt(0)
  s_mul_i32 s4, s85, 320
  s_add_u32 s4, s4, 151552
  v_and_b32 v2, 15, v1
  v_lshl_add_u32 v3, v2, 2, s4
  ds_read2_b32 v[88:89], v3 offset0:0 offset1:160
  ds_read2_b32 v[90:91], v3 offset0:16 offset1:176
  ds_read2_b32 v[92:93], v3 offset0:32 offset1:192
  ds_read2_b32 v[94:95], v3 offset0:48 offset1:208
  ds_read2_b32 v[96:97], v3 offset0:64 offset1:224
  s_lshl_b32 s5, s86, 7
  s_add_u32 s5, s5, 153088
  v_add_u32 v3, s5, v29
  ds_read_b128 v[98:101], v3 offset:0
  ds_read_b128 v[102:105], v3 offset:64
  ds_read_b128 v[106:109], v3 offset:256
  ds_read_b128 v[110:113], v3 offset:320
  v_lshl_add_u32 v3, v2, 2, s5
  ds_read2_b32 v[114:115], v3 offset0:128 offset1:144
  v_add_u32 v124, s4, v29
  v_mov_b32 v120, 0x3f803f80
  v_mov_b32 v121, 0x3f803f80
  v_mov_b32 v122, 0x3f803f80
  v_mov_b32 v123, 0x3f803f80
  s_waitcnt lgkmcnt(0)
  v_pk_mul_f32 v[116:117], v[98:99], v[88:89] op_sel:[0,1] op_sel_hi:[1,1]
  v_pk_mul_f32 v[118:119], v[100:101], v[88:89] op_sel:[0,1] op_sel_hi:[1,1]
  v_pk_fma_f32 v[128:129], v[128:129], v[88:89], v[116:117] op_sel:[0,0,0] op_sel_hi:[1,0,1] neg_lo:[0,0,1] neg_hi:[0,0,1]
  v_pk_fma_f32 v[130:131], v[130:131], v[88:89], v[118:119] op_sel:[0,0,0] op_sel_hi:[1,0,1] neg_lo:[0,0,1] neg_hi:[0,0,1]
  v_cvt_pk_bf16_f32 v32, v128, v129
  v_cvt_pk_bf16_f32 v33, v130, v131
  v_pk_mul_f32 v[116:117], v[102:103], v[88:89] op_sel:[0,1] op_sel_hi:[1,1]
  v_pk_mul_f32 v[118:119], v[104:105], v[88:89] op_sel:[0,1] op_sel_hi:[1,1]
  v_pk_fma_f32 v[132:133], v[132:133], v[88:89], v[116:117] op_sel:[0,0,0] op_sel_hi:[1,0,1] neg_lo:[0,0,1] neg_hi:[0,0,1]
  v_pk_fma_f32 v[134:135], v[134:135], v[88:89], v[118:119] op_sel:[0,0,0] op_sel_hi:[1,0,1] neg_lo:[0,0,1] neg_hi:[0,0,1]
  v_cvt_pk_bf16_f32 v34, v132, v133
  v_cvt_pk_bf16_f32 v35, v134, v135
  v_pk_mul_f32 v[116:117], v[98:99], v[90:91] op_sel:[0,1] op_sel_hi:[1,1]
  v_pk_mul_f32 v[118:119], v[100:101], v[90:91] op_sel:[0,1] op_sel_hi:[1,1]
  v_pk_fma_f32 v[136:137], v[136:137], v[90:91], v[116:117] op_sel:[0,0,0] op_sel_hi:[1,0,1] neg_lo:[0,0,1] neg_hi:[0,0,1]
  v_pk_fma_f32 v[138:139], v[138:139], v[90:91], v[118:119] op_sel:[0,0,0] op_sel_hi:[1,0,1] neg_lo:[0,0,1] neg_hi:[0,0,1]
  v_cvt_pk_bf16_f32 v36, v136, v137
  v_cvt_pk_bf16_f32 v37, v138, v139
  v_pk_mul_f32 v[116:117], v[102:103], v[90:91] op_sel:[0,1] op_sel_hi:[1,1]
  v_pk_mul_f32 v[118:119], v[104:105], v[90:91] op_sel:[0,1] op_sel_hi:[1,1]
  v_pk_fma_f32 v[140:141], v[140:141], v[90:91], v[116:117] op_sel:[0,0,0] op_sel_hi:[1,0,1] neg_lo:[0,0,1] neg_hi:[0,0,1]
  v_pk_fma_f32 v[142:143], v[142:143], v[90:91], v[118:119] op_sel:[0,0,0] op_sel_hi:[1,0,1] neg_lo:[0,0,1] neg_hi:[0,0,1]
  v_cvt_pk_bf16_f32 v38, v140, v141
  v_cvt_pk_bf16_f32 v39, v142, v143
  v_pk_mul_f32 v[116:117], v[98:99], v[92:93] op_sel:[0,1] op_sel_hi:[1,1]
  v_pk_mul_f32 v[118:119], v[100:101], v[92:93] op_sel:[0,1] op_sel_hi:[1,1]
  v_pk_fma_f32 v[144:145], v[144:145], v[92:93], v[116:117] op_sel:[0,0,0] op_sel_hi:[1,0,1] neg_lo:[0,0,1] neg_hi:[0,0,1]
  v_pk_fma_f32 v[146:147], v[146:147], v[92:93], v[118:119] op_sel:[0,0,0] op_sel_hi:[1,0,1] neg_lo:[0,0,1] neg_hi:[0,0,1]
  v_cvt_pk_bf16_f32 v40, v144, v145
  v_cvt_pk_bf16_f32 v41, v146, v147
  v_pk_mul_f32 v[116:117], v[102:103], v[92:93] op_sel:[0,1] op_sel_hi:[1,1]
  v_pk_mul_f32 v[118:119], v[104:105], v[92:93] op_sel:[0,1] op_sel_hi:[1,1]
  v_pk_fma_f32 v[148:149], v[148:149], v[92:93], v[116:117] op_sel:[0,0,0] op_sel_hi:[1,0,1] neg_lo:[0,0,1] neg_hi:[0,0,1]
  v_pk_fma_f32 v[150:151], v[150:151], v[92:93], v[118:119] op_sel:[0,0,0] op_sel_hi:[1,0,1] neg_lo:[0,0,1] neg_hi:[0,0,1]
  v_cvt_pk_bf16_f32 v42, v148, v149
  v_cvt_pk_bf16_f32 v43, v150, v151
  v_pk_mul_f32 v[116:117], v[98:99], v[94:95] op_sel:[0,1] op_sel_hi:[1,1]
  v_pk_mul_f32 v[118:119], v[100:101], v[94:95] op_sel:[0,1] op_sel_hi:[1,1]
  v_pk_fma_f32 v[152:153], v[152:153], v[94:95], v[116:117] op_sel:[0,0,0] op_sel_hi:[1,0,1] neg_lo:[0,0,1] neg_hi:[0,0,1]
  v_pk_fma_f32 v[154:155], v[154:155], v[94:95], v[118:119] op_sel:[0,0,0] op_sel_hi:[1,0,1] neg_lo:[0,0,1] neg_hi:[0,0,1]
  v_cvt_pk_bf16_f32 v44, v152, v153
  v_cvt_pk_bf16_f32 v45, v154, v155
  v_pk_mul_f32 v[116:117], v[102:103], v[94:95] op_sel:[0,1] op_sel_hi:[1,1]
  v_pk_mul_f32 v[118:119], v[104:105], v[94:95] op_sel:[0,1] op_sel_hi:[1,1]
  v_pk_fma_f32 v[156:157], v[156:157], v[94:95], v[116:117] op_sel:[0,0,0] op_sel_hi:[1,0,1] neg_lo:[0,0,1] neg_hi:[0,0,1]
  v_pk_fma_f32 v[158:159], v[158:159], v[94:95], v[118:119] op_sel:[0,0,0] op_sel_hi:[1,0,1] neg_lo:[0,0,1] neg_hi:[0,0,1]
  v_cvt_pk_bf16_f32 v46, v156, v157
  v_cvt_pk_bf16_f32 v47, v158, v159
  ds_read_b128 v[128:131], v124 offset:0
  ds_read_b128 v[132:135], v124 offset:640
  ds_read_b128 v[136:139], v124 offset:64
  ds_read_b128 v[140:143], v124 offset:704
  ds_read_b128 v[144:147], v124 offset:128
  ds_read_b128 v[148:151], v124 offset:768
  ds_read_b128 v[152:155], v124 offset:192
  ds_read_b128 v[156:159], v124 offset:832
  ds_read_b128 v[98:101], v124 offset:256
  ds_read_b128 v[102:105], v124 offset:896
  v_pk_mul_f32 v[116:117], v[106:107], v[96:97] op_sel:[0,1] op_sel_hi:[1,1]
  v_pk_mul_f32 v[118:119], v[108:109], v[96:97] op_sel:[0,1] op_sel_hi:[1,1]
  v_pk_fma_f32 v[192:193], v[192:193], v[96:97], v[116:117] op_sel:[0,0,0] op_sel_hi:[1,0,1] neg_lo:[0,0,1] neg_hi:[0,0,1]
  v_pk_fma_f32 v[194:195], v[194:195], v[96:97], v[118:119] op_sel:[0,0,0] op_sel_hi:[1,0,1] neg_lo:[0,0,1] neg_hi:[0,0,1]
  v_cvt_pk_bf16_f32 v64, v192, v193
  v_cvt_pk_bf16_f32 v65, v194, v195
  v_pk_mul_f32 v[116:117], v[110:111], v[96:97] op_sel:[0,1] op_sel_hi:[1,1]
  v_pk_mul_f32 v[118:119], v[112:113], v[96:97] op_sel:[0,1] op_sel_hi:[1,1]
  v_pk_fma_f32 v[196:197], v[196:197], v[96:97], v[116:117] op_sel:[0,0,0] op_sel_hi:[1,0,1] neg_lo:[0,0,1] neg_hi:[0,0,1]
  v_pk_fma_f32 v[198:199], v[198:199], v[96:97], v[118:119] op_sel:[0,0,0] op_sel_hi:[1,0,1] neg_lo:[0,0,1] neg_hi:[0,0,1]
  v_cvt_pk_bf16_f32 v66, v196, v197
  v_cvt_pk_bf16_f32 v67, v198, v199
  v_pk_mul_f32 v[116:117], v[106:107], v[88:89] op_sel:[0,1] op_sel_hi:[1,1]
  v_pk_mul_f32 v[118:119], v[108:109], v[88:89] op_sel:[0,1] op_sel_hi:[1,1]
  v_pk_fma_f32 v[160:161], v[160:161], v[88:89], v[116:117] op_sel:[0,0,0] op_sel_hi:[1,0,1] neg_lo:[0,0,1] neg_hi:[0,0,1]
  v_pk_fma_f32 v[162:163], v[162:163], v[88:89], v[118:119] op_sel:[0,0,0] op_sel_hi:[1,0,1] neg_lo:[0,0,1] neg_hi:[0,0,1]
  v_cvt_pk_bf16_f32 v48, v160, v161
  v_cvt_pk_bf16_f32 v49, v162, v163
  v_pk_mul_f32 v[116:117], v[110:111], v[88:89] op_sel:[0,1] op_sel_hi:[1,1]
  v_pk_mul_f32 v[118:119], v[112:113], v[88:89] op_sel:[0,1] op_sel_hi:[1,1]
  v_pk_fma_f32 v[164:165], v[164:165], v[88:89], v[116:117] op_sel:[0,0,0] op_sel_hi:[1,0,1] neg_lo:[0,0,1] neg_hi:[0,0,1]
  v_pk_fma_f32 v[166:167], v[166:167], v[88:89], v[118:119] op_sel:[0,0,0] op_sel_hi:[1,0,1] neg_lo:[0,0,1] neg_hi:[0,0,1]
  v_cvt_pk_bf16_f32 v50, v164, v165
  v_cvt_pk_bf16_f32 v51, v166, v167
  v_pk_mul_f32 v[116:117], v[106:107], v[90:91] op_sel:[0,1] op_sel_hi:[1,1]
  v_pk_mul_f32 v[118:119], v[108:109], v[90:91] op_sel:[0,1] op_sel_hi:[1,1]
  v_pk_fma_f32 v[168:169], v[168:169], v[90:91], v[116:117] op_sel:[0,0,0] op_sel_hi:[1,0,1] neg_lo:[0,0,1] neg_hi:[0,0,1]
  v_pk_fma_f32 v[170:171], v[170:171], v[90:91], v[118:119] op_sel:[0,0,0] op_sel_hi:[1,0,1] neg_lo:[0,0,1] neg_hi:[0,0,1]
  v_cvt_pk_bf16_f32 v52, v168, v169
  v_cvt_pk_bf16_f32 v53, v170, v171
  v_pk_mul_f32 v[116:117], v[110:111], v[90:91] op_sel:[0,1] op_sel_hi:[1,1]
  v_pk_mul_f32 v[118:119], v[112:113], v[90:91] op_sel:[0,1] op_sel_hi:[1,1]
  v_pk_fma_f32 v[172:173], v[172:173], v[90:91], v[116:117] op_sel:[0,0,0] op_sel_hi:[1,0,1] neg_lo:[0,0,1] neg_hi:[0,0,1]
  v_pk_fma_f32 v[174:175], v[174:175], v[90:91], v[118:119] op_sel:[0,0,0] op_sel_hi:[1,0,1] neg_lo:[0,0,1] neg_hi:[0,0,1]
  v_cvt_pk_bf16_f32 v54, v172, v173
  v_cvt_pk_bf16_f32 v55, v174, v175
  v_pk_mul_f32 v[116:117], v[106:107], v[92:93] op_sel:[0,1] op_sel_hi:[1,1]
  v_pk_mul_f32 v[118:119], v[108:109], v[92:93] op_sel:[0,1] op_sel_hi:[1,1]
  v_pk_fma_f32 v[176:177], v[176:177], v[92:93], v[116:117] op_sel:[0,0,0] op_sel_hi:[1,0,1] neg_lo:[0,0,1] neg_hi:[0,0,1]
  v_pk_fma_f32 v[178:179], v[178:179], v[92:93], v[118:119] op_sel:[0,0,0] op_sel_hi:[1,0,1] neg_lo:[0,0,1] neg_hi:[0,0,1]
  v_cvt_pk_bf16_f32 v56, v176, v177
  v_cvt_pk_bf16_f32 v57, v178, v179
  v_pk_mul_f32 v[116:117], v[110:111], v[92:93] op_sel:[0,1] op_sel_hi:[1,1]
  v_pk_mul_f32 v[118:119], v[112:113], v[92:93] op_sel:[0,1] op_sel_hi:[1,1]
  v_pk_fma_f32 v[180:181], v[180:181], v[92:93], v[116:117] op_sel:[0,0,0] op_sel_hi:[1,0,1] neg_lo:[0,0,1] neg_hi:[0,0,1]
  v_pk_fma_f32 v[182:183], v[182:183], v[92:93], v[118:119] op_sel:[0,0,0] op_sel_hi:[1,0,1] neg_lo:[0,0,1] neg_hi:[0,0,1]
  v_cvt_pk_bf16_f32 v58, v180, v181
  v_cvt_pk_bf16_f32 v59, v182, v183
  v_pk_mul_f32 v[116:117], v[106:107], v[94:95] op_sel:[0,1] op_sel_hi:[1,1]
  v_pk_mul_f32 v[118:119], v[108:109], v[94:95] op_sel:[0,1] op_sel_hi:[1,1]
  v_pk_fma_f32 v[184:185], v[184:185], v[94:95], v[116:117] op_sel:[0,0,0] op_sel_hi:[1,0,1] neg_lo:[0,0,1] neg_hi:[0,0,1]
  v_pk_fma_f32 v[186:187], v[186:187], v[94:95], v[118:119] op_sel:[0,0,0] op_sel_hi:[1,0,1] neg_lo:[0,0,1] neg_hi:[0,0,1]
  v_cvt_pk_bf16_f32 v60, v184, v185
  v_cvt_pk_bf16_f32 v61, v186, v187
  v_pk_mul_f32 v[116:117], v[110:111], v[94:95] op_sel:[0,1] op_sel_hi:[1,1]
  v_pk_mul_f32 v[118:119], v[112:113], v[94:95] op_sel:[0,1] op_sel_hi:[1,1]
  v_pk_fma_f32 v[188:189], v[188:189], v[94:95], v[116:117] op_sel:[0,0,0] op_sel_hi:[1,0,1] neg_lo:[0,0,1] neg_hi:[0,0,1]
  v_pk_fma_f32 v[190:191], v[190:191], v[94:95], v[118:119] op_sel:[0,0,0] op_sel_hi:[1,0,1] neg_lo:[0,0,1] neg_hi:[0,0,1]
  v_cvt_pk_bf16_f32 v62, v188, v189
  v_cvt_pk_bf16_f32 v63, v190, v191
  v_mfma_f32_16x16x32_bf16 v[160:163], v[64:67], v[32:35], v[20:23]
  v_mfma_f32_16x16x32_bf16 v[164:167], v[48:51], v[32:35], v[12:15]
  v_mfma_f32_16x16x32_bf16 v[168:171], v[48:51], v[36:39], v[16:19]
  v_mfma_f32_16x16x32_bf16 v[172:175], v[52:55], v[36:39], v[12:15]
  v_mfma_f32_16x16x32_bf16 v[176:179], v[52:55], v[40:43], v[16:19]
  v_mfma_f32_16x16x32_bf16 v[180:183], v[56:59], v[40:43], v[12:15]
  v_mfma_f32_16x16x32_bf16 v[184:187], v[56:59], v[44:47], v[16:19]
  v_mfma_f32_16x16x32_bf16 v[188:191], v[60:63], v[44:47], v[12:15]
  s_waitcnt lgkmcnt(0)
  v_pk_mul_f32 v[116:117], v[132:133], v[114:115] op_sel:[0,0] op_sel_hi:[1,0]
  v_pk_mul_f32 v[118:119], v[134:135], v[114:115] op_sel:[0,0] op_sel_hi:[1,0]
  v_pk_fma_f32 v[200:201], v[200:201], v[128:129], v[116:117] neg_lo:[0,0,1] neg_hi:[0,0,1]
  v_pk_fma_f32 v[202:203], v[202:203], v[130:131], v[118:119] neg_lo:[0,0,1] neg_hi:[0,0,1]
  v_cvt_pk_bf16_f32 v70, v200, v201
  v_cvt_pk_bf16_f32 v71, v202, v203
  v_pk_mul_f32 v[116:117], v[132:133], v[114:115] op_sel:[0,1] op_sel_hi:[1,1]
  v_pk_mul_f32 v[118:119], v[134:135], v[114:115] op_sel:[0,1] op_sel_hi:[1,1]
  v_pk_fma_f32 v[204:205], v[204:205], v[128:129], v[116:117] neg_lo:[0,0,1] neg_hi:[0,0,1]
  v_pk_fma_f32 v[206:207], v[206:207], v[130:131], v[118:119] neg_lo:[0,0,1] neg_hi:[0,0,1]
  v_cvt_pk_bf16_f32 v80, v204, v205
  v_cvt_pk_bf16_f32 v81, v206, v207
  v_pk_mul_f32 v[116:117], v[140:141], v[114:115] op_sel:[0,0] op_sel_hi:[1,0]
  v_pk_mul_f32 v[118:119], v[142:143], v[114:115] op_sel:[0,0] op_sel_hi:[1,0]
  v_pk_fma_f32 v[208:209], v[208:209], v[136:137], v[116:117] neg_lo:[0,0,1] neg_hi:[0,0,1]
  v_pk_fma_f32 v[210:211], v[210:211], v[138:139], v[118:119] neg_lo:[0,0,1] neg_hi:[0,0,1]
  v_cvt_pk_bf16_f32 v72, v208, v209
  v_cvt_pk_bf16_f32 v73, v210, v211
  v_pk_mul_f32 v[116:117], v[140:141], v[114:115] op_sel:[0,1] op_sel_hi:[1,1]
  v_pk_mul_f32 v[118:119], v[142:143], v[114:115] op_sel:[0,1] op_sel_hi:[1,1]
  v_pk_fma_f32 v[212:213], v[212:213], v[136:137], v[116:117] neg_lo:[0,0,1] neg_hi:[0,0,1]
  v_pk_fma_f32 v[214:215], v[214:215], v[138:139], v[118:119] neg_lo:[0,0,1] neg_hi:[0,0,1]
  v_cvt_pk_bf16_f32 v82, v212, v213
  v_cvt_pk_bf16_f32 v83, v214, v215
  v_pk_mul_f32 v[116:117], v[148:149], v[114:115] op_sel:[0,0] op_sel_hi:[1,0]
  v_pk_mul_f32 v[118:119], v[150:151], v[114:115] op_sel:[0,0] op_sel_hi:[1,0]
  v_pk_fma_f32 v[216:217], v[216:217], v[144:145], v[116:117] neg_lo:[0,0,1] neg_hi:[0,0,1]
  v_pk_fma_f32 v[218:219], v[218:219], v[146:147], v[118:119] neg_lo:[0,0,1] neg_hi:[0,0,1]
  v_cvt_pk_bf16_f32 v74, v216, v217
  v_cvt_pk_bf16_f32 v75, v218, v219
  v_pk_mul_f32 v[116:117], v[148:149], v[114:115] op_sel:[0,1] op_sel_hi:[1,1]
  v_pk_mul_f32 v[118:119], v[150:151], v[114:115] op_sel:[0,1] op_sel_hi:[1,1]
  v_pk_fma_f32 v[220:221], v[220:221], v[144:145], v[116:117] neg_lo:[0,0,1] neg_hi:[0,0,1]
  v_pk_fma_f32 v[222:223], v[222:223], v[146:147], v[118:119] neg_lo:[0,0,1] neg_hi:[0,0,1]
  v_cvt_pk_bf16_f32 v84, v220, v221
  v_cvt_pk_bf16_f32 v85, v222, v223
  v_pk_mul_f32 v[116:117], v[156:157], v[114:115] op_sel:[0,0] op_sel_hi:[1,0]
  v_pk_mul_f32 v[118:119], v[158:159], v[114:115] op_sel:[0,0] op_sel_hi:[1,0]
  v_pk_fma_f32 v[224:225], v[224:225], v[152:153], v[116:117] neg_lo:[0,0,1] neg_hi:[0,0,1]
  v_pk_fma_f32 v[226:227], v[226:227], v[154:155], v[118:119] neg_lo:[0,0,1] neg_hi:[0,0,1]
  v_cvt_pk_bf16_f32 v76, v224, v225
  v_cvt_pk_bf16_f32 v77, v226, v227
  v_pk_mul_f32 v[116:117], v[156:157], v[114:115] op_sel:[0,1] op_sel_hi:[1,1]
  v_pk_mul_f32 v[118:119], v[158:159], v[114:115] op_sel:[0,1] op_sel_hi:[1,1]
  v_pk_fma_f32 v[228:229], v[228:229], v[152:153], v[116:117] neg_lo:[0,0,1] neg_hi:[0,0,1]
  v_pk_fma_f32 v[230:231], v[230:231], v[154:155], v[118:119] neg_lo:[0,0,1] neg_hi:[0,0,1]
  v_cvt_pk_bf16_f32 v86, v228, v229
  v_cvt_pk_bf16_f32 v87, v230, v231
  v_pk_mul_f32 v[116:117], v[102:103], v[114:115] op_sel:[0,0] op_sel_hi:[1,0]
  v_pk_mul_f32 v[118:119], v[104:105], v[114:115] op_sel:[0,0] op_sel_hi:[1,0]
  v_pk_fma_f32 v[232:233], v[232:233], v[98:99], v[116:117] neg_lo:[0,0,1] neg_hi:[0,0,1]
  v_pk_fma_f32 v[234:235], v[234:235], v[100:101], v[118:119] neg_lo:[0,0,1] neg_hi:[0,0,1]
  v_cvt_pk_bf16_f32 v68, v232, v233
  v_cvt_pk_bf16_f32 v69, v234, v235
  v_pk_mul_f32 v[116:117], v[102:103], v[114:115] op_sel:[0,1] op_sel_hi:[1,1]
  v_pk_mul_f32 v[118:119], v[104:105], v[114:115] op_sel:[0,1] op_sel_hi:[1,1]
  v_pk_fma_f32 v[236:237], v[236:237], v[98:99], v[116:117] neg_lo:[0,0,1] neg_hi:[0,0,1]
  v_pk_fma_f32 v[238:239], v[238:239], v[100:101], v[118:119] neg_lo:[0,0,1] neg_hi:[0,0,1]
  v_cvt_pk_bf16_f32 v78, v236, v237
  v_cvt_pk_bf16_f32 v79, v238, v239
  v_max3_f32 v88, v160, v161, v162
  v_max3_f32 v98, v163, v164, v165
  v_max3_f32 v90, v168, v169, v170
  v_max3_f32 v99, v171, v172, v173
  v_max3_f32 v92, v176, v177, v178
  v_max3_f32 v100, v179, v180, v181
  v_max3_f32 v94, v184, v185, v186
  v_max3_f32 v101, v187, v188, v189
  v_max3_f32 v88, v88, v166, v167
  v_max3_f32 v90, v90, v174, v175
  v_max3_f32 v92, v92, v182, v183
  v_max3_f32 v94, v94, v190, v191
  v_max_f32 v88, v88, v98
  v_max_f32 v90, v90, v99
  v_max_f32 v92, v92, v100
  v_max_f32 v94, v94, v101
  v_mov_b32 v98, v88
  v_mov_b32 v99, v90
  v_mov_b32 v100, v92
  v_mov_b32 v101, v94
  v_permlane32_swap_b32 v88, v98
  v_permlane32_swap_b32 v90, v99
  v_permlane32_swap_b32 v92, v100
  v_permlane32_swap_b32 v94, v101
  v_max_f32 v88, v88, v98
  v_max_f32 v90, v90, v99
  v_max_f32 v92, v92, v100
  v_max_f32 v94, v94, v101
  v_mov_b32 v98, v88
  v_mov_b32 v99, v90
  v_mov_b32 v100, v92
  v_mov_b32 v101, v94
  v_permlane16_swap_b32 v88, v98
  v_permlane16_swap_b32 v90, v99
  v_permlane16_swap_b32 v92, v100
  v_permlane16_swap_b32 v94, v101
  v_max_f32 v88, v88, v98
  v_max_f32 v90, v90, v99
  v_max_f32 v92, v92, v100
  v_max_f32 v94, v94, v101
  s_mov_b32 s4, 0x3e8293ee
  v_mul_f32 v88, s4, v88
  v_mov_b32 v89, s4
  v_mul_f32 v90, s4, v90
  v_mov_b32 v91, s4
  v_mul_f32 v92, s4, v92
  v_mov_b32 v93, s4
  v_mul_f32 v94, s4, v94
  v_mov_b32 v95, s4
  v_pk_fma_f32 v[160:161], v[160:161], v[88:89], v[88:89] op_sel:[0,1,0] op_sel_hi:[1,1,0] neg_lo:[0,0,1] neg_hi:[0,0,1]
  v_pk_fma_f32 v[162:163], v[162:163], v[88:89], v[88:89] op_sel:[0,1,0] op_sel_hi:[1,1,0] neg_lo:[0,0,1] neg_hi:[0,0,1]
  v_pk_fma_f32 v[164:165], v[164:165], v[88:89], v[88:89] op_sel:[0,1,0] op_sel_hi:[1,1,0] neg_lo:[0,0,1] neg_hi:[0,0,1]
  v_pk_fma_f32 v[166:167], v[166:167], v[88:89], v[88:89] op_sel:[0,1,0] op_sel_hi:[1,1,0] neg_lo:[0,0,1] neg_hi:[0,0,1]
  v_pk_fma_f32 v[168:169], v[168:169], v[90:91], v[90:91] op_sel:[0,1,0] op_sel_hi:[1,1,0] neg_lo:[0,0,1] neg_hi:[0,0,1]
  v_pk_fma_f32 v[170:171], v[170:171], v[90:91], v[90:91] op_sel:[0,1,0] op_sel_hi:[1,1,0] neg_lo:[0,0,1] neg_hi:[0,0,1]
  v_pk_fma_f32 v[172:173], v[172:173], v[90:91], v[90:91] op_sel:[0,1,0] op_sel_hi:[1,1,0] neg_lo:[0,0,1] neg_hi:[0,0,1]
  v_pk_fma_f32 v[174:175], v[174:175], v[90:91], v[90:91] op_sel:[0,1,0] op_sel_hi:[1,1,0] neg_lo:[0,0,1] neg_hi:[0,0,1]
  v_pk_fma_f32 v[176:177], v[176:177], v[92:93], v[92:93] op_sel:[0,1,0] op_sel_hi:[1,1,0] neg_lo:[0,0,1] neg_hi:[0,0,1]
  v_pk_fma_f32 v[178:179], v[178:179], v[92:93], v[92:93] op_sel:[0,1,0] op_sel_hi:[1,1,0] neg_lo:[0,0,1] neg_hi:[0,0,1]
  v_pk_fma_f32 v[180:181], v[180:181], v[92:93], v[92:93] op_sel:[0,1,0] op_sel_hi:[1,1,0] neg_lo:[0,0,1] neg_hi:[0,0,1]
  v_pk_fma_f32 v[182:183], v[182:183], v[92:93], v[92:93] op_sel:[0,1,0] op_sel_hi:[1,1,0] neg_lo:[0,0,1] neg_hi:[0,0,1]
  v_pk_fma_f32 v[184:185], v[184:185], v[94:95], v[94:95] op_sel:[0,1,0] op_sel_hi:[1,1,0] neg_lo:[0,0,1] neg_hi:[0,0,1]
  v_pk_fma_f32 v[186:187], v[186:187], v[94:95], v[94:95] op_sel:[0,1,0] op_sel_hi:[1,1,0] neg_lo:[0,0,1] neg_hi:[0,0,1]
  v_pk_fma_f32 v[188:189], v[188:189], v[94:95], v[94:95] op_sel:[0,1,0] op_sel_hi:[1,1,0] neg_lo:[0,0,1] neg_hi:[0,0,1]
  v_pk_fma_f32 v[190:191], v[190:191], v[94:95], v[94:95] op_sel:[0,1,0] op_sel_hi:[1,1,0] neg_lo:[0,0,1] neg_hi:[0,0,1]
  s_lshl_b32 s4, s76, 5
  s_lshl_b32 s5, s77, 1
  s_add_u32 s4, s4, s5
  s_add_u32 s4, s4, s86
  s_lshl_b32 s6, s4, 13
  s_lshl_b32 s7, s85, 12
  s_add_u32 s6, s6, s7
  s_add_u32 s6, s6, s83
  v_exp_f32 v160, v160
  v_exp_f32 v161, v161
  v_exp_f32 v162, v162
  v_exp_f32 v163, v163
  v_exp_f32 v164, v164
  v_exp_f32 v165, v165
  v_exp_f32 v166, v166
  v_exp_f32 v167, v167
  v_cvt_pk_bf16_f32 v32, v160, v161
  v_cvt_pk_bf16_f32 v33, v162, v163
  v_cvt_pk_bf16_f32 v34, v164, v165
  v_cvt_pk_bf16_f32 v35, v166, v167
  v_exp_f32 v168, v168
  v_exp_f32 v169, v169
  v_exp_f32 v170, v170
  v_exp_f32 v171, v171
  v_exp_f32 v172, v172
  v_exp_f32 v173, v173
  v_exp_f32 v174, v174
  v_exp_f32 v175, v175
  v_cvt_pk_bf16_f32 v36, v168, v169
  v_cvt_pk_bf16_f32 v37, v170, v171
  v_cvt_pk_bf16_f32 v38, v172, v173
  v_cvt_pk_bf16_f32 v39, v174, v175
  v_mfma_f32_16x16x32_bf16 v[128:131], v[120:123], v[32:35], 0
  v_mfma_f32_16x16x32_bf16 v[200:203], v[68:71], v[32:35], 0
  v_mfma_f32_16x16x32_bf16 v[204:207], v[78:81], v[32:35], 0
  v_exp_f32 v176, v176
  v_exp_f32 v177, v177
  v_exp_f32 v178, v178
  v_exp_f32 v179, v179
  v_exp_f32 v180, v180
  v_exp_f32 v181, v181
  v_exp_f32 v182, v182
  v_exp_f32 v183, v183
  v_cvt_pk_bf16_f32 v40, v176, v177
  v_cvt_pk_bf16_f32 v41, v178, v179
  v_cvt_pk_bf16_f32 v42, v180, v181
  v_cvt_pk_bf16_f32 v43, v182, v183
  v_mfma_f32_16x16x32_bf16 v[132:135], v[120:123], v[36:39], 0
  v_mfma_f32_16x16x32_bf16 v[208:211], v[70:73], v[36:39], 0
  v_mfma_f32_16x16x32_bf16 v[212:215], v[80:83], v[36:39], 0
  v_exp_f32 v184, v184
  v_exp_f32 v185, v185
  v_exp_f32 v186, v186
  v_exp_f32 v187, v187
  v_exp_f32 v188, v188
  v_exp_f32 v189, v189
  v_exp_f32 v190, v190
  v_exp_f32 v191, v191
  v_cvt_pk_bf16_f32 v44, v184, v185
  v_cvt_pk_bf16_f32 v45, v186, v187
  v_cvt_pk_bf16_f32 v46, v188, v189
  v_cvt_pk_bf16_f32 v47, v190, v191
  v_mfma_f32_16x16x32_bf16 v[136:139], v[120:123], v[40:43], 0
  v_mfma_f32_16x16x32_bf16 v[216:219], v[72:75], v[40:43], 0
  v_mfma_f32_16x16x32_bf16 v[220:223], v[82:85], v[40:43], 0
  v_mfma_f32_16x16x32_bf16 v[140:143], v[120:123], v[44:47], 0
  v_mfma_f32_16x16x32_bf16 v[224:227], v[74:77], v[44:47], 0
  v_mfma_f32_16x16x32_bf16 v[228:231], v[84:87], v[44:47], 0
  v_rcp_f32 v128, v128
  s_nop 0
  v_pk_mul_f32 v[200:201], v[200:201], v[128:129] op_sel_hi:[1,0]
  v_pk_mul_f32 v[202:203], v[202:203], v[128:129] op_sel_hi:[1,0]
  v_pk_mul_f32 v[204:205], v[204:205], v[128:129] op_sel_hi:[1,0]
  v_pk_mul_f32 v[206:207], v[206:207], v[128:129] op_sel_hi:[1,0]
  v_cvt_pk_bf16_f32 v48, v200, v201
  v_cvt_pk_bf16_f32 v49, v202, v203
  v_cvt_pk_bf16_f32 v50, v204, v205
  v_cvt_pk_bf16_f32 v51, v206, v207
  buffer_store_dwordx4 v[48:51], v11, s[40:43], s6 offen offset:0 sc0 sc1
  v_rcp_f32 v132, v132
  s_nop 0
  v_pk_mul_f32 v[208:209], v[208:209], v[132:133] op_sel_hi:[1,0]
  v_pk_mul_f32 v[210:211], v[210:211], v[132:133] op_sel_hi:[1,0]
  v_pk_mul_f32 v[212:213], v[212:213], v[132:133] op_sel_hi:[1,0]
  v_pk_mul_f32 v[214:215], v[214:215], v[132:133] op_sel_hi:[1,0]
  v_cvt_pk_bf16_f32 v52, v208, v209
  v_cvt_pk_bf16_f32 v53, v210, v211
  v_cvt_pk_bf16_f32 v54, v212, v213
  v_cvt_pk_bf16_f32 v55, v214, v215
  buffer_store_dwordx4 v[52:55], v11, s[40:43], s6 offen offset:1024 sc0 sc1
  v_rcp_f32 v136, v136
  s_nop 0
  v_pk_mul_f32 v[216:217], v[216:217], v[136:137] op_sel_hi:[1,0]
  v_pk_mul_f32 v[218:219], v[218:219], v[136:137] op_sel_hi:[1,0]
  v_pk_mul_f32 v[220:221], v[220:221], v[136:137] op_sel_hi:[1,0]
  v_pk_mul_f32 v[222:223], v[222:223], v[136:137] op_sel_hi:[1,0]
  v_cvt_pk_bf16_f32 v56, v216, v217
  v_cvt_pk_bf16_f32 v57, v218, v219
  v_cvt_pk_bf16_f32 v58, v220, v221
  v_cvt_pk_bf16_f32 v59, v222, v223
  buffer_store_dwordx4 v[56:59], v11, s[40:43], s6 offen offset:2048 sc0 sc1
  v_rcp_f32 v140, v140
  s_nop 0
  v_pk_mul_f32 v[224:225], v[224:225], v[140:141] op_sel_hi:[1,0]
  v_pk_mul_f32 v[226:227], v[226:227], v[140:141] op_sel_hi:[1,0]
  v_pk_mul_f32 v[228:229], v[228:229], v[140:141] op_sel_hi:[1,0]
  v_pk_mul_f32 v[230:231], v[230:231], v[140:141] op_sel_hi:[1,0]
  v_cvt_pk_bf16_f32 v60, v224, v225
  v_cvt_pk_bf16_f32 v61, v226, v227
  v_cvt_pk_bf16_f32 v62, v228, v229
  v_cvt_pk_bf16_f32 v63, v230, v231
  buffer_store_dwordx4 v[60:63], v11, s[40:43], s6 offen offset:3072 sc0 sc1
  s_add_u32 s5, s87, 0
  s_waitcnt vmcnt(0)
  s_mov_b64 exec, 1
  ds_add_rtn_u32 v2, v28, v27
  s_waitcnt lgkmcnt(0)
  v_readfirstlane_b32 s4, v2
  s_and_b32 s4, s4, 3
  s_cmp_lg_u32 s4, 3
  s_cbranch_scc1 Ls_5
  s_mov_b32 exec_lo, 0xffff
  buffer_store_dword v27, v24, s[40:43], s5 offen sc0 sc1
Ls_5:
  s_mov_b64 exec, -1
  s_cmp_lg_u32 s82, 0
  s_cbranch_scc1 L_6
  v_permlane16_swap_b32 v240, v242
  v_permlane16_swap_b32 v241, v243
  v_permlane16_swap_b32 v244, v246
  v_permlane16_swap_b32 v245, v247
  v_permlane16_swap_b32 v248, v250
  v_permlane16_swap_b32 v249, v251
  v_permlane16_swap_b32 v252, v254
  v_permlane16_swap_b32 v253, v255
L_6:
  s_mov_b32 s16, 0
  s_mov_b32 s17, 16384
  s_mov_b32 s18, 0xffff4000
  s_mov_b32 s19, 0
  s_mov_b32 s20, 8192
  s_mov_b32 s21, 0xfffee000
  s_mul_i32 s4, s85, 8192
  v_add_u32 v4, s4, v11
  v_add_u32 v5, 1024, v4
  s_lshl_b32 s4, s86, 1
  v_xor_b32 v2, s4, v26
  v_lshl_add_u32 v6, v2, 5, v25
  s_add_u32 s4, s4, 1
  v_xor_b32 v2, s4, v26
  v_lshl_add_u32 v7, v2, 5, v25
  s_mov_b32 s4, 0xffff0000
  v_lshlrev_b32 v128, 16, v240
  v_and_b32 v129, s4, v240
  v_lshlrev_b32 v130, 16, v241
  v_and_b32 v131, s4, v241
  v_lshlrev_b32 v132, 16, v242
  v_and_b32 v133, s4, v242
  v_lshlrev_b32 v134, 16, v243
  v_and_b32 v135, s4, v243
  v_lshlrev_b32 v136, 16, v244
  v_and_b32 v137, s4, v244
  v_lshlrev_b32 v138, 16, v245
  v_and_b32 v139, s4, v245
  v_lshlrev_b32 v140, 16, v246
  v_and_b32 v141, s4, v246
  v_lshlrev_b32 v142, 16, v247
  v_and_b32 v143, s4, v247
  v_lshlrev_b32 v144, 16, v248
  v_and_b32 v145, s4, v248
  v_lshlrev_b32 v146, 16, v249
  v_and_b32 v147, s4, v249
  v_lshlrev_b32 v148, 16, v250
  v_and_b32 v149, s4, v250
  v_lshlrev_b32 v150, 16, v251
  v_and_b32 v151, s4, v251
  v_lshlrev_b32 v152, 16, v252
  v_and_b32 v153, s4, v252
  v_lshlrev_b32 v154, 16, v253
  v_and_b32 v155, s4, v253
  v_lshlrev_b32 v156, 16, v254
  v_and_b32 v157, s4, v254
  v_lshlrev_b32 v158, 16, v255
  v_and_b32 v159, s4, v255
  s_mov_b32 s22, 8
  s_barrier
  ds_read_b64_tr_b16 v[48:49], v6 offset:0
  ds_read_b64_tr_b16 v[50:51], v6 offset:2048
  ds_read_b128 v[32:35], v4 offset:0
  ds_read_b128 v[36:39], v4 offset:2048
  ds_read_b128 v[40:43], v4 offset:4096
  ds_read_b128 v[44:47], v4 offset:6144
  ds_read_b64_tr_b16 v[52:53], v7 offset:0
  ds_read_b64_tr_b16 v[54:55], v7 offset:2048
  ds_read_b64_tr_b16 v[80:81], v6 offset:4096
  ds_read_b64_tr_b16 v[82:83], v6 offset:6144
  ds_read_b128 v[64:67], v5 offset:0
  ds_read_b128 v[68:71], v5 offset:2048
  ds_read_b128 v[72:75], v5 offset:4096
  s_waitcnt lgkmcnt(4)
  ds_read_b128 v[76:79], v5 offset:6144
  ds_read_b64_tr_b16 v[84:85], v7 offset:4096
  ds_read_b64_tr_b16 v[86:87], v7 offset:6144
  s_add_u32 s16, s16, s17
  s_cmp_eq_u32 s16, 65536
  s_cselect_b32 s23, s18, s17
  s_cselect_b32 s16, 0, s16
  v_add_u32 v4, s23, v4
  v_add_u32 v5, s23, v5
  s_add_u32 s19, s19, s20
  s_cmp_eq_u32 s19, 81920
  s_cselect_b32 s23, s21, s20
  s_cselect_b32 s19, 0, s19
  v_add_u32 v6, s23, v6
  v_add_u32 v7, s23, v7
  s_waitcnt lgkmcnt(0)
Lk_7:
  s_barrier
  v_mfma_f32_16x16x32_bf16 v[128:131], v[48:51], v[32:35], v[128:131]
  ds_read_b64_tr_b16 v[112:113], v6 offset:0
  ds_read_b64_tr_b16 v[114:115], v6 offset:2048
  v_mfma_f32_16x16x32_bf16 v[136:139], v[48:51], v[36:39], v[136:139]
  ds_read_b128 v[96:99], v4 offset:0
  ds_read_b128 v[100:103], v4 offset:2048
  v_mfma_f32_16x16x32_bf16 v[144:147], v[48:51], v[40:43], v[144:147]
  ds_read_b128 v[104:107], v4 offset:4096
  ds_read_b128 v[108:111], v4 offset:6144
  v_mfma_f32_16x16x32_bf16 v[152:155], v[48:51], v[44:47], v[152:155]
  ds_read_b64_tr_b16 v[116:117], v7 offset:0
  ds_read_b64_tr_b16 v[118:119], v7 offset:2048
  v_mfma_f32_16x16x32_bf16 v[132:135], v[52:55], v[32:35], v[132:135]
  ds_read_b64_tr_b16 v[208:209], v6 offset:4096
  ds_read_b64_tr_b16 v[210:211], v6 offset:6144
  v_mfma_f32_16x16x32_bf16 v[140:143], v[52:55], v[36:39], v[140:143]
  ds_read_b128 v[192:195], v5 offset:0
  ds_read_b128 v[196:199], v5 offset:2048
  v_mfma_f32_16x16x32_bf16 v[148:151], v[52:55], v[40:43], v[148:151]
  ds_read_b128 v[200:203], v5 offset:4096
  ds_read_b128 v[204:207], v5 offset:6144
  v_mfma_f32_16x16x32_bf16 v[156:159], v[52:55], v[44:47], v[156:159]
  ds_read_b64_tr_b16 v[212:213], v7 offset:4096
  ds_read_b64_tr_b16 v[214:215], v7 offset:6144
  v_mfma_f32_16x16x32_bf16 v[128:131], v[80:83], v[64:67], v[128:131]
  s_add_u32 s16, s16, s17
  s_cmp_eq_u32 s16, 65536
  s_cselect_b32 s23, s18, s17
  v_mfma_f32_16x16x32_bf16 v[136:139], v[80:83], v[68:71], v[136:139]
  s_cselect_b32 s16, 0, s16
  v_add_u32 v4, s23, v4
  v_add_u32 v5, s23, v5
  v_mfma_f32_16x16x32_bf16 v[144:147], v[80:83], v[72:75], v[144:147]
  s_add_u32 s19, s19, s20
  s_cmp_eq_u32 s19, 81920
  s_cselect_b32 s23, s21, s20
  v_mfma_f32_16x16x32_bf16 v[152:155], v[80:83], v[76:79], v[152:155]
  s_cselect_b32 s19, 0, s19
  v_add_u32 v6, s23, v6
  v_add_u32 v7, s23, v7
  v_mfma_f32_16x16x32_bf16 v[132:135], v[84:87], v[64:67], v[132:135]
  v_mfma_f32_16x16x32_bf16 v[140:143], v[84:87], v[68:71], v[140:143]
  v_mfma_f32_16x16x32_bf16 v[148:151], v[84:87], v[72:75], v[148:151]
  s_waitcnt lgkmcnt(0)
  v_mfma_f32_16x16x32_bf16 v[156:159], v[84:87], v[76:79], v[156:159]
  s_barrier
  v_mfma_f32_16x16x32_bf16 v[128:131], v[112:115], v[96:99], v[128:131]
  ds_read_b64_tr_b16 v[48:49], v6 offset:0
  ds_read_b64_tr_b16 v[50:51], v6 offset:2048
  v_mfma_f32_16x16x32_bf16 v[136:139], v[112:115], v[100:103], v[136:139]
  ds_read_b128 v[32:35], v4 offset:0
  ds_read_b128 v[36:39], v4 offset:2048
  v_mfma_f32_16x16x32_bf16 v[144:147], v[112:115], v[104:107], v[144:147]
  ds_read_b128 v[40:43], v4 offset:4096
  ds_read_b128 v[44:47], v4 offset:6144
  v_mfma_f32_16x16x32_bf16 v[152:155], v[112:115], v[108:111], v[152:155]
  ds_read_b64_tr_b16 v[52:53], v7 offset:0
  ds_read_b64_tr_b16 v[54:55], v7 offset:2048
  v_mfma_f32_16x16x32_bf16 v[132:135], v[116:119], v[96:99], v[132:135]
  ds_read_b64_tr_b16 v[80:81], v6 offset:4096
  ds_read_b64_tr_b16 v[82:83], v6 offset:6144
  v_mfma_f32_16x16x32_bf16 v[140:143], v[116:119], v[100:103], v[140:143]
  ds_read_b128 v[64:67], v5 offset:0
  ds_read_b128 v[68:71], v5 offset:2048
  v_mfma_f32_16x16x32_bf16 v[148:151], v[116:119], v[104:107], v[148:151]
  ds_read_b128 v[72:75], v5 offset:4096
  ds_read_b128 v[76:79], v5 offset:6144
  v_mfma_f32_16x16x32_bf16 v[156:159], v[116:119], v[108:111], v[156:159]
  ds_read_b64_tr_b16 v[84:85], v7 offset:4096
  ds_read_b64_tr_b16 v[86:87], v7 offset:6144
  v_mfma_f32_16x16x32_bf16 v[128:131], v[208:211], v[192:195], v[128:131]
  s_add_u32 s16, s16, s17
  s_cmp_eq_u32 s16, 65536
  s_cselect_b32 s23, s18, s17
  v_mfma_f32_16x16x32_bf16 v[136:139], v[208:211], v[196:199], v[136:139]
  s_cselect_b32 s16, 0, s16
  v_add_u32 v4, s23, v4
  v_add_u32 v5, s23, v5
  v_mfma_f32_16x16x32_bf16 v[144:147], v[208:211], v[200:203], v[144:147]
  s_add_u32 s19, s19, s20
  s_cmp_eq_u32 s19, 81920
  s_cselect_b32 s23, s21, s20
  v_mfma_f32_16x16x32_bf16 v[152:155], v[208:211], v[204:207], v[152:155]
  s_cselect_b32 s19, 0, s19
  v_add_u32 v6, s23, v6
  v_add_u32 v7, s23, v7
  v_mfma_f32_16x16x32_bf16 v[132:135], v[212:215], v[192:195], v[132:135]
  s_sub_u32 s22, s22, 1
  s_cmp_lg_u32 s22, 0
  v_mfma_f32_16x16x32_bf16 v[140:143], v[212:215], v[196:199], v[140:143]
  v_mfma_f32_16x16x32_bf16 v[148:151], v[212:215], v[200:203], v[148:151]
  s_waitcnt lgkmcnt(0)
  v_mfma_f32_16x16x32_bf16 v[156:159], v[212:215], v[204:207], v[156:159]
  s_cbranch_scc1 Lk_7
  s_waitcnt lgkmcnt(0)
  v_cvt_pk_bf16_f32 v240, v128, v129
  v_cvt_pk_bf16_f32 v241, v130, v131
  v_cvt_pk_bf16_f32 v242, v132, v133
  v_cvt_pk_bf16_f32 v243, v134, v135
  v_cvt_pk_bf16_f32 v244, v136, v137
  v_cvt_pk_bf16_f32 v245, v138, v139
  v_cvt_pk_bf16_f32 v246, v140, v141
  v_cvt_pk_bf16_f32 v247, v142, v143
  v_cvt_pk_bf16_f32 v248, v144, v145
  v_cvt_pk_bf16_f32 v249, v146, v147
  v_cvt_pk_bf16_f32 v250, v148, v149
  v_cvt_pk_bf16_f32 v251, v150, v151
  v_cvt_pk_bf16_f32 v252, v152, v153
  v_cvt_pk_bf16_f32 v253, v154, v155
  v_cvt_pk_bf16_f32 v254, v156, v157
  v_cvt_pk_bf16_f32 v255, v158, v159
  s_lshl_b32 s4, s76, 5
  s_lshl_b32 s5, s78, 1
  s_add_u32 s4, s4, s5
  s_add_u32 s4, s4, s86
  s_lshl_b32 s6, s4, 13
  s_lshl_b32 s7, s85, 12
  s_add_u32 s6, s6, s7
  s_add_u32 s6, s6, s83
  s_add_u32 s6, s6, 4194304
  buffer_store_dwordx4 v[240:243], v11, s[40:43], s6 offen offset:0 sc0 sc1
  buffer_store_dwordx4 v[244:247], v11, s[40:43], s6 offen offset:1024 sc0 sc1
  buffer_store_dwordx4 v[248:251], v11, s[40:43], s6 offen offset:2048 sc0 sc1
  buffer_store_dwordx4 v[252:255], v11, s[40:43], s6 offen offset:3072 sc0 sc1
  v_mov_b32 v40, 0x3f803f80
  v_dot2_f32_bf16 v32, v240, v40, 0
  v_dot2_f32_bf16 v36, v240, v240, 0
  v_dot2_f32_bf16 v33, v244, v40, 0
  v_dot2_f32_bf16 v37, v244, v244, 0
  v_dot2_f32_bf16 v34, v248, v40, 0
  v_dot2_f32_bf16 v38, v248, v248, 0
  v_dot2_f32_bf16 v35, v252, v40, 0
  v_dot2_f32_bf16 v39, v252, v252, 0
  v_dot2_f32_bf16 v32, v241, v40, v32
  v_dot2_f32_bf16 v36, v241, v241, v36
  v_dot2_f32_bf16 v33, v245, v40, v33
  v_dot2_f32_bf16 v37, v245, v245, v37
  v_dot2_f32_bf16 v34, v249, v40, v34
  v_dot2_f32_bf16 v38, v249, v249, v38
  v_dot2_f32_bf16 v35, v253, v40, v35
  v_dot2_f32_bf16 v39, v253, v253, v39
  v_dot2_f32_bf16 v32, v242, v40, v32
  v_dot2_f32_bf16 v36, v242, v242, v36
  v_dot2_f32_bf16 v33, v246, v40, v33
  v_dot2_f32_bf16 v37, v246, v246, v37
  v_dot2_f32_bf16 v34, v250, v40, v34
  v_dot2_f32_bf16 v38, v250, v250, v38
  v_dot2_f32_bf16 v35, v254, v40, v35
  v_dot2_f32_bf16 v39, v254, v254, v39
  v_dot2_f32_bf16 v32, v243, v40, v32
  v_dot2_f32_bf16 v36, v243, v243, v36
  v_dot2_f32_bf16 v33, v247, v40, v33
  v_dot2_f32_bf16 v37, v247, v247, v37
  v_dot2_f32_bf16 v34, v251, v40, v34
  v_dot2_f32_bf16 v38, v251, v251, v38
  v_dot2_f32_bf16 v35, v255, v40, v35
  v_dot2_f32_bf16 v39, v255, v255, v39
  s_lshl_b32 s6, s76, 9
  s_lshl_b32 s7, s85, 8
  s_add_u32 s6, s6, s7
  s_add_u32 s6, s6, s5
  s_add_u32 s6, s6, s86
  s_lshl_b32 s6, s6, 6
  s_add_u32 s6, s6, s83
  s_add_u32 s6, s6, 31457280
  v_permlane32_swap_b32 v32, v34
  v_permlane32_swap_b32 v33, v35
  v_permlane32_swap_b32 v36, v38
  v_permlane32_swap_b32 v37, v39
  v_add_f32 v32, v32, v34
  v_add_f32 v33, v33, v35
  v_add_f32 v36, v36, v38
  v_add_f32 v37, v37, v39
  v_permlane16_swap_b32 v32, v33
  s_nop 0
  v_permlane16_swap_b32 v36, v37
  v_add_f32 v42, v32, v33
  v_add_f32 v43, v36, v37
  buffer_store_dwordx2 v[42:43], v30, s[40:43], s6 offen sc0 sc1
  s_add_u32 s5, s87, 128
  s_waitcnt vmcnt(0)
  s_mov_b64 exec, 1
  ds_add_rtn_u32 v2, v28, v27
  s_waitcnt lgkmcnt(0)
  v_readfirstlane_b32 s4, v2
  s_and_b32 s4, s4, 3
  s_cmp_lg_u32 s4, 3
  s_cbranch_scc1 Ls_8
  s_mov_b32 exec_lo, 0xffff
  buffer_store_dword v27, v24, s[40:43], s5 offen sc0 sc1
Ls_8:
  s_mov_b64 exec, -1
  s_mov_b32 s16, 0
  s_mov_b32 s17, 16384
  s_mov_b32 s18, 0xffff4000
  s_mov_b32 s19, 0
  s_mov_b32 s20, 28672
  s_mov_b32 s21, 0xffff2000
  s_mul_i32 s4, s85, 8192
  v_add_u32 v4, s4, v11
  v_add_u32 v5, 1024, v4
  s_mul_i32 s4, s86, 6
  s_add_u32 s4, s4, 0
  s_lshr_b32 s5, s4, 2
  s_lshl_b32 s5, s5, 13
  s_and_b32 s4, s4, 3
  v_xor_b32 v2, s4, v26
  v_lshl_add_u32 v6, v2, 5, v25
  v_add_u32 v6, s5, v6
  s_mul_i32 s4, s86, 6
  s_add_u32 s4, s4, 1
  s_lshr_b32 s5, s4, 2
  s_lshl_b32 s5, s5, 13
  s_and_b32 s4, s4, 3
  v_xor_b32 v2, s4, v26
  v_lshl_add_u32 v7, v2, 5, v25
  v_add_u32 v7, s5, v7
  s_mul_i32 s4, s86, 6
  s_add_u32 s4, s4, 2
  s_lshr_b32 s5, s4, 2
  s_lshl_b32 s5, s5, 13
  s_and_b32 s4, s4, 3
  v_xor_b32 v2, s4, v26
  v_lshl_add_u32 v8, v2, 5, v25
  v_add_u32 v8, s5, v8
  s_mul_i32 s4, s86, 6
  s_add_u32 s4, s4, 3
  s_lshr_b32 s5, s4, 2
  s_lshl_b32 s5, s5, 13
  s_and_b32 s4, s4, 3
  v_xor_b32 v2, s4, v26
  v_lshl_add_u32 v9, v2, 5, v25
  v_add_u32 v9, s5, v9
  v_lshrrev_b32 v2, 2, v1
  v_lshlrev_b32 v3, 6, v2
  v_and_b32 v2, 3, v1
  v_lshl_add_u32 v3, v2, 3, v3
  v_bfe_u32 v2, v1, 4, 1
  v_xor_b32 v2, s86, v2
  v_lshl_add_u32 v3, v2, 5, v3
  v_add_u32 v10, 90112, v3
  v_mov_b64 v[128:129], 0
  v_mov_b64 v[130:131], 0
  v_mov_b64 v[132:133], 0
  v_mov_b64 v[134:135], 0
  v_mov_b64 v[136:137], 0
  v_mov_b64 v[138:139], 0
  v_mov_b64 v[140:141], 0
  v_mov_b64 v[142:143], 0
  v_mov_b64 v[144:145], 0
  v_mov_b64 v[146:147], 0
  v_mov_b64 v[148:149], 0
  v_mov_b64 v[150:151], 0
  v_mov_b64 v[152:153], 0
  v_mov_b64 v[154:155], 0
  v_mov_b64 v[156:157], 0
  v_mov_b64 v[158:159], 0
  v_mov_b64 v[160:161], 0
  v_mov_b64 v[162:163], 0
  v_mov_b64 v[164:165], 0
  v_mov_b64 v[166:167], 0
  v_mov_b64 v[168:169], 0
  v_mov_b64 v[170:171], 0
  v_mov_b64 v[172:173], 0
  v_mov_b64 v[174:175], 0
  v_mov_b64 v[176:177], 0
  v_mov_b64 v[178:179], 0
  v_mov_b64 v[180:181], 0
  v_mov_b64 v[182:183], 0
  v_mov_b64 v[184:185], 0
  v_mov_b64 v[186:187], 0
  v_mov_b64 v[188:189], 0
  v_mov_b64 v[190:191], 0
  v_mov_b64 v[192:193], 0
  v_mov_b64 v[194:195], 0
  v_mov_b64 v[196:197], 0
  v_mov_b64 v[198:199], 0
  v_mov_b64 v[200:201], 0
  v_mov_b64 v[202:203], 0
  v_mov_b64 v[204:205], 0
  v_mov_b64 v[206:207], 0
  v_mov_b64 v[208:209], 0
  v_mov_b64 v[210:211], 0
  v_mov_b64 v[212:213], 0
  v_mov_b64 v[214:215], 0
  v_mov_b64 v[216:217], 0
  v_mov_b64 v[218:219], 0
  v_mov_b64 v[220:221], 0
  v_mov_b64 v[222:223], 0
  v_mov_b64 v[224:225], 0
  v_mov_b64 v[226:227], 0
  v_mov_b64 v[228:229], 0
  v_mov_b64 v[230:231], 0
  v_mov_b64 v[232:233], 0
  v_mov_b64 v[234:235], 0
  v_mov_b64 v[236:237], 0
  v_mov_b64 v[238:239], 0
  s_mov_b32 s22, 16
  s_barrier
  ds_read_b64_tr_b16 v[48:49], v6 offset:0
  ds_read_b64_tr_b16 v[50:51], v6 offset:2048
  ds_read_b128 v[32:35], v4 offset:0
  ds_read_b128 v[36:39], v4 offset:2048
  ds_read_b128 v[40:43], v4 offset:4096
  ds_read_b128 v[44:47], v4 offset:6144
  ds_read_b64_tr_b16 v[52:53], v7 offset:0
  ds_read_b64_tr_b16 v[54:55], v7 offset:2048
  ds_read_b64_tr_b16 v[56:57], v8 offset:0
  ds_read_b64_tr_b16 v[58:59], v8 offset:2048
  ds_read_b64_tr_b16 v[60:61], v9 offset:0
  ds_read_b64_tr_b16 v[62:63], v9 offset:2048
  ds_read_b64_tr_b16 v[64:65], v6 offset:8192
  ds_read_b64_tr_b16 v[66:67], v6 offset:10240
  ds_read_b64_tr_b16 v[68:69], v7 offset:8192
  ds_read_b64_tr_b16 v[70:71], v7 offset:10240
  ds_read_b64_tr_b16 v[72:73], v10 offset:0
  ds_read_b64_tr_b16 v[74:75], v10 offset:1024
Lk_9:
  s_waitcnt lgkmcnt(0)
  v_mfma_f32_16x16x32_bf16 v[128:131], v[48:51], v[32:35], v[128:131]
  ds_read_b64_tr_b16 v[92:93], v6 offset:4096
  v_mfma_f32_16x16x32_bf16 v[132:135], v[48:51], v[36:39], v[132:135]
  ds_read_b64_tr_b16 v[94:95], v6 offset:6144
  v_mfma_f32_16x16x32_bf16 v[136:139], v[48:51], v[40:43], v[136:139]
  ds_read_b128 v[76:79], v5 offset:0
  v_mfma_f32_16x16x32_bf16 v[140:143], v[48:51], v[44:47], v[140:143]
  ds_read_b128 v[80:83], v5 offset:2048
  v_mfma_f32_16x16x32_bf16 v[144:147], v[52:55], v[32:35], v[144:147]
  ds_read_b128 v[84:87], v5 offset:4096
  v_mfma_f32_16x16x32_bf16 v[148:151], v[52:55], v[36:39], v[148:151]
  ds_read_b128 v[88:91], v5 offset:6144
  v_mfma_f32_16x16x32_bf16 v[152:155], v[52:55], v[40:43], v[152:155]
  ds_read_b64_tr_b16 v[96:97], v7 offset:4096
  v_mfma_f32_16x16x32_bf16 v[156:159], v[52:55], v[44:47], v[156:159]
  ds_read_b64_tr_b16 v[98:99], v7 offset:6144
  v_mfma_f32_16x16x32_bf16 v[160:163], v[56:59], v[32:35], v[160:163]
  ds_read_b64_tr_b16 v[100:101], v8 offset:4096
  v_mfma_f32_16x16x32_bf16 v[164:167], v[56:59], v[36:39], v[164:167]
  ds_read_b64_tr_b16 v[102:103], v8 offset:6144
  v_mfma_f32_16x16x32_bf16 v[168:171], v[56:59], v[40:43], v[168:171]
  ds_read_b64_tr_b16 v[104:105], v9 offset:4096
  v_mfma_f32_16x16x32_bf16 v[172:175], v[56:59], v[44:47], v[172:175]
  ds_read_b64_tr_b16 v[106:107], v9 offset:6144
  v_mfma_f32_16x16x32_bf16 v[176:179], v[60:63], v[32:35], v[176:179]
  ds_read_b64_tr_b16 v[108:109], v6 offset:12288
  v_mfma_f32_16x16x32_bf16 v[180:183], v[60:63], v[36:39], v[180:183]
  ds_read_b64_tr_b16 v[110:111], v6 offset:14336
  v_mfma_f32_16x16x32_bf16 v[184:187], v[60:63], v[40:43], v[184:187]
  ds_read_b64_tr_b16 v[112:113], v7 offset:12288
  v_mfma_f32_16x16x32_bf16 v[188:191], v[60:63], v[44:47], v[188:191]
  ds_read_b64_tr_b16 v[114:115], v7 offset:14336
  v_mfma_f32_16x16x32_bf16 v[192:195], v[64:67], v[32:35], v[192:195]
  ds_read_b64_tr_b16 v[116:117], v10 offset:2048
  v_mfma_f32_16x16x32_bf16 v[196:199], v[64:67], v[36:39], v[196:199]
  ds_read_b64_tr_b16 v[118:119], v10 offset:3072
  v_mfma_f32_16x16x32_bf16 v[200:203], v[64:67], v[40:43], v[200:203]
  s_add_u32 s16, s16, s17
  s_cmp_eq_u32 s16, 65536
  s_cselect_b32 s23, s18, s17
  v_mfma_f32_16x16x32_bf16 v[204:207], v[64:67], v[44:47], v[204:207]
  s_cselect_b32 s16, 0, s16
  v_add_u32 v4, s23, v4
  v_add_u32 v5, s23, v5
  v_mfma_f32_16x16x32_bf16 v[208:211], v[68:71], v[32:35], v[208:211]
  s_add_u32 s19, s19, s20
  s_cmp_eq_u32 s19, 86016
  s_cselect_b32 s23, s21, s20
  v_mfma_f32_16x16x32_bf16 v[212:215], v[68:71], v[36:39], v[212:215]
  s_cselect_b32 s19, 0, s19
  v_add_u32 v6, s23, v6
  v_add_u32 v7, s23, v7
  v_mfma_f32_16x16x32_bf16 v[216:219], v[68:71], v[40:43], v[216:219]
  v_add_u32 v8, s23, v8
  v_add_u32 v9, s23, v9
  v_add_u32 v10, s23, v10
  v_mfma_f32_16x16x32_bf16 v[220:223], v[68:71], v[44:47], v[220:223]
  v_mfma_f32_16x16x32_bf16 v[224:227], v[72:75], v[32:35], v[224:227]
  v_mfma_f32_16x16x32_bf16 v[228:231], v[72:75], v[36:39], v[228:231]
  v_mfma_f32_16x16x32_bf16 v[232:235], v[72:75], v[40:43], v[232:235]
  v_mfma_f32_16x16x32_bf16 v[236:239], v[72:75], v[44:47], v[236:239]
  s_waitcnt lgkmcnt(0)
  s_barrier
  v_mfma_f32_16x16x32_bf16 v[128:131], v[92:95], v[76:79], v[128:131]
  ds_read_b64_tr_b16 v[48:49], v6 offset:0
  v_mfma_f32_16x16x32_bf16 v[132:135], v[92:95], v[80:83], v[132:135]
  ds_read_b64_tr_b16 v[50:51], v6 offset:2048
  v_mfma_f32_16x16x32_bf16 v[136:139], v[92:95], v[84:87], v[136:139]
  ds_read_b128 v[32:35], v4 offset:0
  v_mfma_f32_16x16x32_bf16 v[140:143], v[92:95], v[88:91], v[140:143]
  ds_read_b128 v[36:39], v4 offset:2048
  v_mfma_f32_16x16x32_bf16 v[144:147], v[96:99], v[76:79], v[144:147]
  ds_read_b128 v[40:43], v4 offset:4096
  v_mfma_f32_16x16x32_bf16 v[148:151], v[96:99], v[80:83], v[148:151]
  ds_read_b128 v[44:47], v4 offset:6144
  v_mfma_f32_16x16x32_bf16 v[152:155], v[96:99], v[84:87], v[152:155]
  ds_read_b64_tr_b16 v[52:53], v7 offset:0
  v_mfma_f32_16x16x32_bf16 v[156:159], v[96:99], v[88:91], v[156:159]
  ds_read_b64_tr_b16 v[54:55], v7 offset:2048
  v_mfma_f32_16x16x32_bf16 v[160:163], v[100:103], v[76:79], v[160:163]
  ds_read_b64_tr_b16 v[56:57], v8 offset:0
  v_mfma_f32_16x16x32_bf16 v[164:167], v[100:103], v[80:83], v[164:167]
  ds_read_b64_tr_b16 v[58:59], v8 offset:2048
  v_mfma_f32_16x16x32_bf16 v[168:171], v[100:103], v[84:87], v[168:171]
  ds_read_b64_tr_b16 v[60:61], v9 offset:0
  v_mfma_f32_16x16x32_bf16 v[172:175], v[100:103], v[88:91], v[172:175]
  ds_read_b64_tr_b16 v[62:63], v9 offset:2048
  v_mfma_f32_16x16x32_bf16 v[176:179], v[104:107], v[76:79], v[176:179]
  ds_read_b64_tr_b16 v[64:65], v6 offset:8192
  v_mfma_f32_16x16x32_bf16 v[180:183], v[104:107], v[80:83], v[180:183]
  ds_read_b64_tr_b16 v[66:67], v6 offset:10240
  v_mfma_f32_16x16x32_bf16 v[184:187], v[104:107], v[84:87], v[184:187]
  ds_read_b64_tr_b16 v[68:69], v7 offset:8192
  v_mfma_f32_16x16x32_bf16 v[188:191], v[104:107], v[88:91], v[188:191]
  ds_read_b64_tr_b16 v[70:71], v7 offset:10240
  v_mfma_f32_16x16x32_bf16 v[192:195], v[108:111], v[76:79], v[192:195]
  ds_read_b64_tr_b16 v[72:73], v10 offset:0
  v_mfma_f32_16x16x32_bf16 v[196:199], v[108:111], v[80:83], v[196:199]
  ds_read_b64_tr_b16 v[74:75], v10 offset:1024
  v_mfma_f32_16x16x32_bf16 v[200:203], v[108:111], v[84:87], v[200:203]
  s_sub_u32 s22, s22, 1
  v_mfma_f32_16x16x32_bf16 v[204:207], v[108:111], v[88:91], v[204:207]
  s_cmp_lg_u32 s22, 0
  v_mfma_f32_16x16x32_bf16 v[208:211], v[112:115], v[76:79], v[208:211]
  v_mfma_f32_16x16x32_bf16 v[212:215], v[112:115], v[80:83], v[212:215]
  v_mfma_f32_16x16x32_bf16 v[216:219], v[112:115], v[84:87], v[216:219]
  v_mfma_f32_16x16x32_bf16 v[220:223], v[112:115], v[88:91], v[220:223]
  v_mfma_f32_16x16x32_bf16 v[224:227], v[116:119], v[76:79], v[224:227]
  v_mfma_f32_16x16x32_bf16 v[228:231], v[116:119], v[80:83], v[228:231]
  v_mfma_f32_16x16x32_bf16 v[232:235], v[116:119], v[84:87], v[232:235]
  v_mfma_f32_16x16x32_bf16 v[236:239], v[116:119], v[88:91], v[236:239]
  s_cbranch_scc1 Lk_9
  s_waitcnt lgkmcnt(0)
  s_mul_i32 s4, s85, 320
  s_add_u32 s4, s4, 151552
  v_and_b32 v2, 15, v1
  v_lshl_add_u32 v3, v2, 2, s4
  ds_read2_b32 v[88:89], v3 offset0:0 offset1:160
  ds_read2_b32 v[90:91], v3 offset0:16 offset1:176
  ds_read2_b32 v[92:93], v3 offset0:32 offset1:192
  ds_read2_b32 v[94:95], v3 offset0:48 offset1:208
  s_mul_i32 s5, s86, 384
  s_add_u32 s5, s5, 154112
  v_add_u32 v3, s5, v29
  s_lshl_b32 s5, s86, 6
  s_add_u32 s5, s5, 154880
  v_add_u32 v2, s5, v29
  ds_read_b128 v[32:35], v3 offset:0
  ds_read_b128 v[36:39], v3 offset:1024
  ds_read_b128 v[40:43], v3 offset:64
  ds_read_b128 v[44:47], v3 offset:1088
  ds_read_b128 v[48:51], v3 offset:128
  ds_read_b128 v[52:55], v3 offset:1152
  ds_read_b128 v[56:59], v3 offset:192
  ds_read_b128 v[60:63], v3 offset:1216
  ds_read_b128 v[64:67], v3 offset:256
  ds_read_b128 v[68:71], v3 offset:1280
  s_waitcnt lgkmcnt(6)
  ds_read_b128 v[72:75], v3 offset:320
  ds_read_b128 v[76:79], v3 offset:1344
  ds_read_b128 v[80:83], v2 offset:0
  ds_read_b128 v[84:87], v2 offset:1024
  v_mov_b32 v96, 0xc0135761
  v_mov_b32 v97, 0xbdd2d3e8
  v_mov_b32 v98, 1.0
  s_mul_i32 s4, s76, 112
  s_mul_i32 s5, s77, 7
  s_add_u32 s4, s4, s5
  s_and_b32 s5, s77, 1
  s_mul_i32 s6, s86, 3
  s_add_u32 s6, s6, s5
  s_add_u32 s6, s6, s4
  s_mul_i32 s5, s5, 6
  s_sub_u32 s7, 6, s5
  s_add_u32 s7, s7, s4
  s_lshl_b32 s8, s85, 12
  s_add_u32 s8, s8, s83
  s_add_u32 s8, s8, 8388608
  s_lshl_b32 s6, s6, 13
  s_add_u32 s6, s6, s8
  s_lshl_b32 s7, s7, 13
  s_add_u32 s7, s7, s8
  s_lshl_b32 s8, s86, 3
  s_add_u32 s7, s7, s8
  s_waitcnt lgkmcnt(0)
  v_pk_fma_f32 v[100:101], v[80:81], v[88:89], v[84:85] op_sel:[0,1,0] op_sel_hi:[1,1,1] neg_lo:[0,1,0] neg_hi:[0,1,0]
  v_pk_fma_f32 v[102:103], v[82:83], v[88:89], v[86:87] op_sel:[0,1,0] op_sel_hi:[1,1,1] neg_lo:[0,1,0] neg_hi:[0,1,0]
  v_pk_fma_f32 v[104:105], v[80:81], v[90:91], v[84:85] op_sel:[0,1,0] op_sel_hi:[1,1,1] neg_lo:[0,1,0] neg_hi:[0,1,0]
  v_pk_fma_f32 v[106:107], v[82:83], v[90:91], v[86:87] op_sel:[0,1,0] op_sel_hi:[1,1,1] neg_lo:[0,1,0] neg_hi:[0,1,0]
  v_pk_fma_f32 v[224:225], v[224:225], v[88:89], v[100:101] op_sel:[0,0,0] op_sel_hi:[1,0,1]
  v_pk_fma_f32 v[226:227], v[226:227], v[88:89], v[102:103] op_sel:[0,0,0] op_sel_hi:[1,0,1]
  v_pk_fma_f32 v[228:229], v[228:229], v[90:91], v[104:105] op_sel:[0,0,0] op_sel_hi:[1,0,1]
  v_pk_fma_f32 v[230:231], v[230:231], v[90:91], v[106:107] op_sel:[0,0,0] op_sel_hi:[1,0,1]
  v_pk_mul_f32 v[100:101], v[224:225], v[224:225]
  v_pk_mul_f32 v[102:103], v[226:227], v[226:227]
  v_pk_mul_f32 v[104:105], v[228:229], v[228:229]
  v_pk_mul_f32 v[106:107], v[230:231], v[230:231]
  v_pk_fma_f32 v[100:101], v[100:101], v[96:97], v[96:97] op_sel:[0,1,0] op_sel_hi:[1,1,0]
  v_pk_fma_f32 v[102:103], v[102:103], v[96:97], v[96:97] op_sel:[0,1,0] op_sel_hi:[1,1,0]
  v_pk_fma_f32 v[104:105], v[104:105], v[96:97], v[96:97] op_sel:[0,1,0] op_sel_hi:[1,1,0]
  v_pk_fma_f32 v[106:107], v[106:107], v[96:97], v[96:97] op_sel:[0,1,0] op_sel_hi:[1,1,0]
  v_pk_mul_f32 v[100:101], v[100:101], v[224:225]
  v_pk_mul_f32 v[102:103], v[102:103], v[226:227]
  v_pk_mul_f32 v[104:105], v[104:105], v[228:229]
  v_pk_mul_f32 v[106:107], v[106:107], v[230:231]
  v_exp_f32 v100, v100
  v_exp_f32 v101, v101
  v_exp_f32 v102, v102
  v_exp_f32 v103, v103
  v_exp_f32 v104, v104
  v_exp_f32 v105, v105
  v_exp_f32 v106, v106
  v_exp_f32 v107, v107
  v_pk_add_f32 v[100:101], v[100:101], v[98:99] op_sel_hi:[1,0]
  v_pk_add_f32 v[102:103], v[102:103], v[98:99] op_sel_hi:[1,0]
  v_pk_add_f32 v[104:105], v[104:105], v[98:99] op_sel_hi:[1,0]
  v_pk_add_f32 v[106:107], v[106:107], v[98:99] op_sel_hi:[1,0]
  v_rcp_f32 v100, v100
  v_rcp_f32 v101, v101
  v_rcp_f32 v102, v102
  v_rcp_f32 v103, v103
  v_rcp_f32 v104, v104
  v_rcp_f32 v105, v105
  v_rcp_f32 v106, v106
  v_rcp_f32 v107, v107
  v_pk_mul_f32 v[224:225], v[224:225], v[100:101]
  v_pk_mul_f32 v[226:227], v[226:227], v[102:103]
  v_pk_mul_f32 v[228:229], v[228:229], v[104:105]
  v_pk_mul_f32 v[230:231], v[230:231], v[106:107]
  v_cvt_pk_bf16_f32 v116, v224, v225
  v_cvt_pk_bf16_f32 v117, v226, v227
  v_cvt_pk_bf16_f32 v118, v228, v229
  v_cvt_pk_bf16_f32 v119, v230, v231
  buffer_store_dwordx2 v[116:117], v11, s[40:43], s7 offen offset:0 sc0 sc1
  buffer_store_dwordx2 v[118:119], v11, s[40:43], s7 offen offset:1024 sc0 sc1
  v_pk_fma_f32 v[100:101], v[80:81], v[92:93], v[84:85] op_sel:[0,1,0] op_sel_hi:[1,1,1] neg_lo:[0,1,0] neg_hi:[0,1,0]
  v_pk_fma_f32 v[102:103], v[82:83], v[92:93], v[86:87] op_sel:[0,1,0] op_sel_hi:[1,1,1] neg_lo:[0,1,0] neg_hi:[0,1,0]
  v_pk_fma_f32 v[104:105], v[80:81], v[94:95], v[84:85] op_sel:[0,1,0] op_sel_hi:[1,1,1] neg_lo:[0,1,0] neg_hi:[0,1,0]
  v_pk_fma_f32 v[106:107], v[82:83], v[94:95], v[86:87] op_sel:[0,1,0] op_sel_hi:[1,1,1] neg_lo:[0,1,0] neg_hi:[0,1,0]
  v_pk_fma_f32 v[232:233], v[232:233], v[92:93], v[100:101] op_sel:[0,0,0] op_sel_hi:[1,0,1]
  v_pk_fma_f32 v[234:235], v[234:235], v[92:93], v[102:103] op_sel:[0,0,0] op_sel_hi:[1,0,1]
  v_pk_fma_f32 v[236:237], v[236:237], v[94:95], v[104:105] op_sel:[0,0,0] op_sel_hi:[1,0,1]
  v_pk_fma_f32 v[238:239], v[238:239], v[94:95], v[106:107] op_sel:[0,0,0] op_sel_hi:[1,0,1]
  v_pk_mul_f32 v[100:101], v[232:233], v[232:233]
  v_pk_mul_f32 v[102:103], v[234:235], v[234:235]
  v_pk_mul_f32 v[104:105], v[236:237], v[236:237]
  v_pk_mul_f32 v[106:107], v[238:239], v[238:239]
  v_pk_fma_f32 v[100:101], v[100:101], v[96:97], v[96:97] op_sel:[0,1,0] op_sel_hi:[1,1,0]
  v_pk_fma_f32 v[102:103], v[102:103], v[96:97], v[96:97] op_sel:[0,1,0] op_sel_hi:[1,1,0]
  v_pk_fma_f32 v[104:105], v[104:105], v[96:97], v[96:97] op_sel:[0,1,0] op_sel_hi:[1,1,0]
  v_pk_fma_f32 v[106:107], v[106:107], v[96:97], v[96:97] op_sel:[0,1,0] op_sel_hi:[1,1,0]
  v_pk_mul_f32 v[100:101], v[100:101], v[232:233]
  v_pk_mul_f32 v[102:103], v[102:103], v[234:235]
  v_pk_mul_f32 v[104:105], v[104:105], v[236:237]
  v_pk_mul_f32 v[106:107], v[106:107], v[238:239]
  v_exp_f32 v100, v100
  v_exp_f32 v101, v101
  v_exp_f32 v102, v102
  v_exp_f32 v103, v103
  v_exp_f32 v104, v104
  v_exp_f32 v105, v105
  v_exp_f32 v106, v106
  v_exp_f32 v107, v107
  v_pk_add_f32 v[100:101], v[100:101], v[98:99] op_sel_hi:[1,0]
  v_pk_add_f32 v[102:103], v[102:103], v[98:99] op_sel_hi:[1,0]
  v_pk_add_f32 v[104:105], v[104:105], v[98:99] op_sel_hi:[1,0]
  v_pk_add_f32 v[106:107], v[106:107], v[98:99] op_sel_hi:[1,0]
  v_rcp_f32 v100, v100
  v_rcp_f32 v101, v101
  v_rcp_f32 v102, v102
  v_rcp_f32 v103, v103
  v_rcp_f32 v104, v104
  v_rcp_f32 v105, v105
  v_rcp_f32 v106, v106
  v_rcp_f32 v107, v107
  v_pk_mul_f32 v[232:233], v[232:233], v[100:101]
  v_pk_mul_f32 v[234:235], v[234:235], v[102:103]
  v_pk_mul_f32 v[236:237], v[236:237], v[104:105]
  v_pk_mul_f32 v[238:239], v[238:239], v[106:107]
  v_cvt_pk_bf16_f32 v120, v232, v233
  v_cvt_pk_bf16_f32 v121, v234, v235
  v_cvt_pk_bf16_f32 v122, v236, v237
  v_cvt_pk_bf16_f32 v123, v238, v239
  buffer_store_dwordx2 v[120:121], v11, s[40:43], s7 offen offset:2048 sc0 sc1
  buffer_store_dwordx2 v[122:123], v11, s[40:43], s7 offen offset:3072 sc0 sc1
  v_pk_fma_f32 v[100:101], v[32:33], v[88:89], v[36:37] op_sel:[0,1,0] op_sel_hi:[1,1,1] neg_lo:[0,1,0] neg_hi:[0,1,0]
  v_pk_fma_f32 v[102:103], v[34:35], v[88:89], v[38:39] op_sel:[0,1,0] op_sel_hi:[1,1,1] neg_lo:[0,1,0] neg_hi:[0,1,0]
  v_pk_fma_f32 v[104:105], v[40:41], v[88:89], v[44:45] op_sel:[0,1,0] op_sel_hi:[1,1,1] neg_lo:[0,1,0] neg_hi:[0,1,0]
  v_pk_fma_f32 v[106:107], v[42:43], v[88:89], v[46:47] op_sel:[0,1,0] op_sel_hi:[1,1,1] neg_lo:[0,1,0] neg_hi:[0,1,0]
  v_pk_fma_f32 v[128:129], v[128:129], v[88:89], v[100:101] op_sel:[0,0,0] op_sel_hi:[1,0,1]
  v_pk_fma_f32 v[130:131], v[130:131], v[88:89], v[102:103] op_sel:[0,0,0] op_sel_hi:[1,0,1]
  v_pk_fma_f32 v[144:145], v[144:145], v[88:89], v[104:105] op_sel:[0,0,0] op_sel_hi:[1,0,1]
  v_pk_fma_f32 v[146:147], v[146:147], v[88:89], v[106:107] op_sel:[0,0,0] op_sel_hi:[1,0,1]
  v_pk_mul_f32 v[100:101], v[128:129], v[128:129]
  v_pk_mul_f32 v[102:103], v[130:131], v[130:131]
  v_pk_mul_f32 v[104:105], v[144:145], v[144:145]
  v_pk_mul_f32 v[106:107], v[146:147], v[146:147]
  v_pk_fma_f32 v[100:101], v[100:101], v[96:97], v[96:97] op_sel:[0,1,0] op_sel_hi:[1,1,0]
  v_pk_fma_f32 v[102:103], v[102:103], v[96:97], v[96:97] op_sel:[0,1,0] op_sel_hi:[1,1,0]
  v_pk_fma_f32 v[104:105], v[104:105], v[96:97], v[96:97] op_sel:[0,1,0] op_sel_hi:[1,1,0]
  v_pk_fma_f32 v[106:107], v[106:107], v[96:97], v[96:97] op_sel:[0,1,0] op_sel_hi:[1,1,0]
  v_pk_mul_f32 v[100:101], v[100:101], v[128:129]
  v_pk_mul_f32 v[102:103], v[102:103], v[130:131]
  v_pk_mul_f32 v[104:105], v[104:105], v[144:145]
  v_pk_mul_f32 v[106:107], v[106:107], v[146:147]
  v_exp_f32 v100, v100
  v_exp_f32 v101, v101
  v_exp_f32 v102, v102
  v_exp_f32 v103, v103
  v_exp_f32 v104, v104
  v_exp_f32 v105, v105
  v_exp_f32 v106, v106
  v_exp_f32 v107, v107
  v_pk_add_f32 v[100:101], v[100:101], v[98:99] op_sel_hi:[1,0]
  v_pk_add_f32 v[102:103], v[102:103], v[98:99] op_sel_hi:[1,0]
  v_pk_add_f32 v[104:105], v[104:105], v[98:99] op_sel_hi:[1,0]
  v_pk_add_f32 v[106:107], v[106:107], v[98:99] op_sel_hi:[1,0]
  v_rcp_f32 v100, v100
  v_rcp_f32 v101, v101
  v_rcp_f32 v102, v102
  v_rcp_f32 v103, v103
  v_rcp_f32 v104, v104
  v_rcp_f32 v105, v105
  v_rcp_f32 v106, v106
  v_rcp_f32 v107, v107
  v_pk_mul_f32 v[128:129], v[128:129], v[100:101]
  v_pk_mul_f32 v[130:131], v[130:131], v[102:103]
  v_pk_mul_f32 v[144:145], v[144:145], v[104:105]
  v_pk_mul_f32 v[146:147], v[146:147], v[106:107]
  v_cvt_pk_bf16_f32 v116, v128, v129
  v_cvt_pk_bf16_f32 v117, v130, v131
  v_cvt_pk_bf16_f32 v118, v144, v145
  v_cvt_pk_bf16_f32 v119, v146, v147
  buffer_store_dwordx4 v[116:119], v11, s[40:43], s6 offen offset:0 sc0 sc1
  v_pk_fma_f32 v[100:101], v[32:33], v[90:91], v[36:37] op_sel:[0,1,0] op_sel_hi:[1,1,1] neg_lo:[0,1,0] neg_hi:[0,1,0]
  v_pk_fma_f32 v[102:103], v[34:35], v[90:91], v[38:39] op_sel:[0,1,0] op_sel_hi:[1,1,1] neg_lo:[0,1,0] neg_hi:[0,1,0]
  v_pk_fma_f32 v[104:105], v[40:41], v[90:91], v[44:45] op_sel:[0,1,0] op_sel_hi:[1,1,1] neg_lo:[0,1,0] neg_hi:[0,1,0]
  v_pk_fma_f32 v[106:107], v[42:43], v[90:91], v[46:47] op_sel:[0,1,0] op_sel_hi:[1,1,1] neg_lo:[0,1,0] neg_hi:[0,1,0]
  v_pk_fma_f32 v[132:133], v[132:133], v[90:91], v[100:101] op_sel:[0,0,0] op_sel_hi:[1,0,1]
  v_pk_fma_f32 v[134:135], v[134:135], v[90:91], v[102:103] op_sel:[0,0,0] op_sel_hi:[1,0,1]
  v_pk_fma_f32 v[148:149], v[148:149], v[90:91], v[104:105] op_sel:[0,0,0] op_sel_hi:[1,0,1]
  v_pk_fma_f32 v[150:151], v[150:151], v[90:91], v[106:107] op_sel:[0,0,0] op_sel_hi:[1,0,1]
  v_pk_mul_f32 v[100:101], v[132:133], v[132:133]
  v_pk_mul_f32 v[102:103], v[134:135], v[134:135]
  v_pk_mul_f32 v[104:105], v[148:149], v[148:149]
  v_pk_mul_f32 v[106:107], v[150:151], v[150:151]
  v_pk_fma_f32 v[100:101], v[100:101], v[96:97], v[96:97] op_sel:[0,1,0] op_sel_hi:[1,1,0]
  v_pk_fma_f32 v[102:103], v[102:103], v[96:97], v[96:97] op_sel:[0,1,0] op_sel_hi:[1,1,0]
  v_pk_fma_f32 v[104:105], v[104:105], v[96:97], v[96:97] op_sel:[0,1,0] op_sel_hi:[1,1,0]
  v_pk_fma_f32 v[106:107], v[106:107], v[96:97], v[96:97] op_sel:[0,1,0] op_sel_hi:[1,1,0]
  v_pk_mul_f32 v[100:101], v[100:101], v[132:133]
  v_pk_mul_f32 v[102:103], v[102:103], v[134:135]
  v_pk_mul_f32 v[104:105], v[104:105], v[148:149]
  v_pk_mul_f32 v[106:107], v[106:107], v[150:151]
  v_exp_f32 v100, v100
  v_exp_f32 v101, v101
  v_exp_f32 v102, v102
  v_exp_f32 v103, v103
  v_exp_f32 v104, v104
  v_exp_f32 v105, v105
  v_exp_f32 v106, v106
  v_exp_f32 v107, v107
  v_pk_add_f32 v[100:101], v[100:101], v[98:99] op_sel_hi:[1,0]
  v_pk_add_f32 v[102:103], v[102:103], v[98:99] op_sel_hi:[1,0]
  v_pk_add_f32 v[104:105], v[104:105], v[98:99] op_sel_hi:[1,0]
  v_pk_add_f32 v[106:107], v[106:107], v[98:99] op_sel_hi:[1,0]
  v_rcp_f32 v100, v100
  v_rcp_f32 v101, v101
  v_rcp_f32 v102, v102
  v_rcp_f32 v103, v103
  v_rcp_f32 v104, v104
  v_rcp_f32 v105, v105
  v_rcp_f32 v106, v106
  v_rcp_f32 v107, v107
  v_pk_mul_f32 v[132:133], v[132:133], v[100:101]
  v_pk_mul_f32 v[134:135], v[134:135], v[102:103]
  v_pk_mul_f32 v[148:149], v[148:149], v[104:105]
  v_pk_mul_f32 v[150:151], v[150:151], v[106:107]
  v_cvt_pk_bf16_f32 v120, v132, v133
  v_cvt_pk_bf16_f32 v121, v134, v135
  v_cvt_pk_bf16_f32 v122, v148, v149
  v_cvt_pk_bf16_f32 v123, v150, v151
  buffer_store_dwordx4 v[120:123], v11, s[40:43], s6 offen offset:1024 sc0 sc1
  v_pk_fma_f32 v[100:101], v[32:33], v[92:93], v[36:37] op_sel:[0,1,0] op_sel_hi:[1,1,1] neg_lo:[0,1,0] neg_hi:[0,1,0]
  v_pk_fma_f32 v[102:103], v[34:35], v[92:93], v[38:39] op_sel:[0,1,0] op_sel_hi:[1,1,1] neg_lo:[0,1,0] neg_hi:[0,1,0]
  v_pk_fma_f32 v[104:105], v[40:41], v[92:93], v[44:45] op_sel:[0,1,0] op_sel_hi:[1,1,1] neg_lo:[0,1,0] neg_hi:[0,1,0]
  v_pk_fma_f32 v[106:107], v[42:43], v[92:93], v[46:47] op_sel:[0,1,0] op_sel_hi:[1,1,1] neg_lo:[0,1,0] neg_hi:[0,1,0]
  v_pk_fma_f32 v[136:137], v[136:137], v[92:93], v[100:101] op_sel:[0,0,0] op_sel_hi:[1,0,1]
  v_pk_fma_f32 v[138:139], v[138:139], v[92:93], v[102:103] op_sel:[0,0,0] op_sel_hi:[1,0,1]
  v_pk_fma_f32 v[152:153], v[152:153], v[92:93], v[104:105] op_sel:[0,0,0] op_sel_hi:[1,0,1]
  v_pk_fma_f32 v[154:155], v[154:155], v[92:93], v[106:107] op_sel:[0,0,0] op_sel_hi:[1,0,1]
  v_pk_mul_f32 v[100:101], v[136:137], v[136:137]
  v_pk_mul_f32 v[102:103], v[138:139], v[138:139]
  v_pk_mul_f32 v[104:105], v[152:153], v[152:153]
  v_pk_mul_f32 v[106:107], v[154:155], v[154:155]
  v_pk_fma_f32 v[100:101], v[100:101], v[96:97], v[96:97] op_sel:[0,1,0] op_sel_hi:[1,1,0]
  v_pk_fma_f32 v[102:103], v[102:103], v[96:97], v[96:97] op_sel:[0,1,0] op_sel_hi:[1,1,0]
  v_pk_fma_f32 v[104:105], v[104:105], v[96:97], v[96:97] op_sel:[0,1,0] op_sel_hi:[1,1,0]
  v_pk_fma_f32 v[106:107], v[106:107], v[96:97], v[96:97] op_sel:[0,1,0] op_sel_hi:[1,1,0]
  v_pk_mul_f32 v[100:101], v[100:101], v[136:137]
  v_pk_mul_f32 v[102:103], v[102:103], v[138:139]
  v_pk_mul_f32 v[104:105], v[104:105], v[152:153]
  v_pk_mul_f32 v[106:107], v[106:107], v[154:155]
  v_exp_f32 v100, v100
  v_exp_f32 v101, v101
  v_exp_f32 v102, v102
  v_exp_f32 v103, v103
  v_exp_f32 v104, v104
  v_exp_f32 v105, v105
  v_exp_f32 v106, v106
  v_exp_f32 v107, v107
  v_pk_add_f32 v[100:101], v[100:101], v[98:99] op_sel_hi:[1,0]
  v_pk_add_f32 v[102:103], v[102:103], v[98:99] op_sel_hi:[1,0]
  v_pk_add_f32 v[104:105], v[104:105], v[98:99] op_sel_hi:[1,0]
  v_pk_add_f32 v[106:107], v[106:107], v[98:99] op_sel_hi:[1,0]
  v_rcp_f32 v100, v100
  v_rcp_f32 v101, v101
  v_rcp_f32 v102, v102
  v_rcp_f32 v103, v103
  v_rcp_f32 v104, v104
  v_rcp_f32 v105, v105
  v_rcp_f32 v106, v106
  v_rcp_f32 v107, v107
  v_pk_mul_f32 v[136:137], v[136:137], v[100:101]
  v_pk_mul_f32 v[138:139], v[138:139], v[102:103]
  v_pk_mul_f32 v[152:153], v[152:153], v[104:105]
  v_pk_mul_f32 v[154:155], v[154:155], v[106:107]
  v_cvt_pk_bf16_f32 v116, v136, v137
  v_cvt_pk_bf16_f32 v117, v138, v139
  v_cvt_pk_bf16_f32 v118, v152, v153
  v_cvt_pk_bf16_f32 v119, v154, v155
  buffer_store_dwordx4 v[116:119], v11, s[40:43], s6 offen offset:2048 sc0 sc1
  v_pk_fma_f32 v[100:101], v[32:33], v[94:95], v[36:37] op_sel:[0,1,0] op_sel_hi:[1,1,1] neg_lo:[0,1,0] neg_hi:[0,1,0]
  v_pk_fma_f32 v[102:103], v[34:35], v[94:95], v[38:39] op_sel:[0,1,0] op_sel_hi:[1,1,1] neg_lo:[0,1,0] neg_hi:[0,1,0]
  v_pk_fma_f32 v[104:105], v[40:41], v[94:95], v[44:45] op_sel:[0,1,0] op_sel_hi:[1,1,1] neg_lo:[0,1,0] neg_hi:[0,1,0]
  v_pk_fma_f32 v[106:107], v[42:43], v[94:95], v[46:47] op_sel:[0,1,0] op_sel_hi:[1,1,1] neg_lo:[0,1,0] neg_hi:[0,1,0]
  v_pk_fma_f32 v[140:141], v[140:141], v[94:95], v[100:101] op_sel:[0,0,0] op_sel_hi:[1,0,1]
  v_pk_fma_f32 v[142:143], v[142:143], v[94:95], v[102:103] op_sel:[0,0,0] op_sel_hi:[1,0,1]
  v_pk_fma_f32 v[156:157], v[156:157], v[94:95], v[104:105] op_sel:[0,0,0] op_sel_hi:[1,0,1]
  v_pk_fma_f32 v[158:159], v[158:159], v[94:95], v[106:107] op_sel:[0,0,0] op_sel_hi:[1,0,1]
  v_pk_mul_f32 v[100:101], v[140:141], v[140:141]
  v_pk_mul_f32 v[102:103], v[142:143], v[142:143]
  v_pk_mul_f32 v[104:105], v[156:157], v[156:157]
  v_pk_mul_f32 v[106:107], v[158:159], v[158:159]
  v_pk_fma_f32 v[100:101], v[100:101], v[96:97], v[96:97] op_sel:[0,1,0] op_sel_hi:[1,1,0]
  v_pk_fma_f32 v[102:103], v[102:103], v[96:97], v[96:97] op_sel:[0,1,0] op_sel_hi:[1,1,0]
  v_pk_fma_f32 v[104:105], v[104:105], v[96:97], v[96:97] op_sel:[0,1,0] op_sel_hi:[1,1,0]
  v_pk_fma_f32 v[106:107], v[106:107], v[96:97], v[96:97] op_sel:[0,1,0] op_sel_hi:[1,1,0]
  v_pk_mul_f32 v[100:101], v[100:101], v[140:141]
  v_pk_mul_f32 v[102:103], v[102:103], v[142:143]
  v_pk_mul_f32 v[104:105], v[104:105], v[156:157]
  v_pk_mul_f32 v[106:107], v[106:107], v[158:159]
  v_exp_f32 v100, v100
  v_exp_f32 v101, v101
  v_exp_f32 v102, v102
  v_exp_f32 v103, v103
  v_exp_f32 v104, v104
  v_exp_f32 v105, v105
  v_exp_f32 v106, v106
  v_exp_f32 v107, v107
  v_pk_add_f32 v[100:101], v[100:101], v[98:99] op_sel_hi:[1,0]
  v_pk_add_f32 v[102:103], v[102:103], v[98:99] op_sel_hi:[1,0]
  v_pk_add_f32 v[104:105], v[104:105], v[98:99] op_sel_hi:[1,0]
  v_pk_add_f32 v[106:107], v[106:107], v[98:99] op_sel_hi:[1,0]
  v_rcp_f32 v100, v100
  v_rcp_f32 v101, v101
  v_rcp_f32 v102, v102
  v_rcp_f32 v103, v103
  v_rcp_f32 v104, v104
  v_rcp_f32 v105, v105
  v_rcp_f32 v106, v106
  v_rcp_f32 v107, v107
  v_pk_mul_f32 v[140:141], v[140:141], v[100:101]
  v_pk_mul_f32 v[142:143], v[142:143], v[102:103]
  v_pk_mul_f32 v[156:157], v[156:157], v[104:105]
  v_pk_mul_f32 v[158:159], v[158:159], v[106:107]
  v_cvt_pk_bf16_f32 v120, v140, v141
  v_cvt_pk_bf16_f32 v121, v142, v143
  v_cvt_pk_bf16_f32 v122, v156, v157
  v_cvt_pk_bf16_f32 v123, v158, v159
  buffer_store_dwordx4 v[120:123], v11, s[40:43], s6 offen offset:3072 sc0 sc1
  s_add_u32 s6, s6, 8192
  v_pk_fma_f32 v[100:101], v[48:49], v[88:89], v[52:53] op_sel:[0,1,0] op_sel_hi:[1,1,1] neg_lo:[0,1,0] neg_hi:[0,1,0]
  v_pk_fma_f32 v[102:103], v[50:51], v[88:89], v[54:55] op_sel:[0,1,0] op_sel_hi:[1,1,1] neg_lo:[0,1,0] neg_hi:[0,1,0]
  v_pk_fma_f32 v[104:105], v[56:57], v[88:89], v[60:61] op_sel:[0,1,0] op_sel_hi:[1,1,1] neg_lo:[0,1,0] neg_hi:[0,1,0]
  v_pk_fma_f32 v[106:107], v[58:59], v[88:89], v[62:63] op_sel:[0,1,0] op_sel_hi:[1,1,1] neg_lo:[0,1,0] neg_hi:[0,1,0]
  v_pk_fma_f32 v[160:161], v[160:161], v[88:89], v[100:101] op_sel:[0,0,0] op_sel_hi:[1,0,1]
  v_pk_fma_f32 v[162:163], v[162:163], v[88:89], v[102:103] op_sel:[0,0,0] op_sel_hi:[1,0,1]
  v_pk_fma_f32 v[176:177], v[176:177], v[88:89], v[104:105] op_sel:[0,0,0] op_sel_hi:[1,0,1]
  v_pk_fma_f32 v[178:179], v[178:179], v[88:89], v[106:107] op_sel:[0,0,0] op_sel_hi:[1,0,1]
  v_pk_mul_f32 v[100:101], v[160:161], v[160:161]
  v_pk_mul_f32 v[102:103], v[162:163], v[162:163]
  v_pk_mul_f32 v[104:105], v[176:177], v[176:177]
  v_pk_mul_f32 v[106:107], v[178:179], v[178:179]
  v_pk_fma_f32 v[100:101], v[100:101], v[96:97], v[96:97] op_sel:[0,1,0] op_sel_hi:[1,1,0]
  v_pk_fma_f32 v[102:103], v[102:103], v[96:97], v[96:97] op_sel:[0,1,0] op_sel_hi:[1,1,0]
  v_pk_fma_f32 v[104:105], v[104:105], v[96:97], v[96:97] op_sel:[0,1,0] op_sel_hi:[1,1,0]
  v_pk_fma_f32 v[106:107], v[106:107], v[96:97], v[96:97] op_sel:[0,1,0] op_sel_hi:[1,1,0]
  v_pk_mul_f32 v[100:101], v[100:101], v[160:161]
  v_pk_mul_f32 v[102:103], v[102:103], v[162:163]
  v_pk_mul_f32 v[104:105], v[104:105], v[176:177]
  v_pk_mul_f32 v[106:107], v[106:107], v[178:179]
  v_exp_f32 v100, v100
  v_exp_f32 v101, v101
  v_exp_f32 v102, v102
  v_exp_f32 v103, v103
  v_exp_f32 v104, v104
  v_exp_f32 v105, v105
  v_exp_f32 v106, v106
  v_exp_f32 v107, v107
  v_pk_add_f32 v[100:101], v[100:101], v[98:99] op_sel_hi:[1,0]
  v_pk_add_f32 v[102:103], v[102:103], v[98:99] op_sel_hi:[1,0]
  v_pk_add_f32 v[104:105], v[104:105], v[98:99] op_sel_hi:[1,0]
  v_pk_add_f32 v[106:107], v[106:107], v[98:99] op_sel_hi:[1,0]
  v_rcp_f32 v100, v100
  v_rcp_f32 v101, v101
  v_rcp_f32 v102, v102
  v_rcp_f32 v103, v103
  v_rcp_f32 v104, v104
  v_rcp_f32 v105, v105
  v_rcp_f32 v106, v106
  v_rcp_f32 v107, v107
  v_pk_mul_f32 v[160:161], v[160:161], v[100:101]
  v_pk_mul_f32 v[162:163], v[162:163], v[102:103]
  v_pk_mul_f32 v[176:177], v[176:177], v[104:105]
  v_pk_mul_f32 v[178:179], v[178:179], v[106:107]
  v_cvt_pk_bf16_f32 v116, v160, v161
  v_cvt_pk_bf16_f32 v117, v162, v163
  v_cvt_pk_bf16_f32 v118, v176, v177
  v_cvt_pk_bf16_f32 v119, v178, v179
  buffer_store_dwordx4 v[116:119], v11, s[40:43], s6 offen offset:0 sc0 sc1
  v_pk_fma_f32 v[100:101], v[48:49], v[90:91], v[52:53] op_sel:[0,1,0] op_sel_hi:[1,1,1] neg_lo:[0,1,0] neg_hi:[0,1,0]
  v_pk_fma_f32 v[102:103], v[50:51], v[90:91], v[54:55] op_sel:[0,1,0] op_sel_hi:[1,1,1] neg_lo:[0,1,0] neg_hi:[0,1,0]
  v_pk_fma_f32 v[104:105], v[56:57], v[90:91], v[60:61] op_sel:[0,1,0] op_sel_hi:[1,1,1] neg_lo:[0,1,0] neg_hi:[0,1,0]
  v_pk_fma_f32 v[106:107], v[58:59], v[90:91], v[62:63] op_sel:[0,1,0] op_sel_hi:[1,1,1] neg_lo:[0,1,0] neg_hi:[0,1,0]
  v_pk_fma_f32 v[164:165], v[164:165], v[90:91], v[100:101] op_sel:[0,0,0] op_sel_hi:[1,0,1]
  v_pk_fma_f32 v[166:167], v[166:167], v[90:91], v[102:103] op_sel:[0,0,0] op_sel_hi:[1,0,1]
  v_pk_fma_f32 v[180:181], v[180:181], v[90:91], v[104:105] op_sel:[0,0,0] op_sel_hi:[1,0,1]
  v_pk_fma_f32 v[182:183], v[182:183], v[90:91], v[106:107] op_sel:[0,0,0] op_sel_hi:[1,0,1]
  v_pk_mul_f32 v[100:101], v[164:165], v[164:165]
  v_pk_mul_f32 v[102:103], v[166:167], v[166:167]
  v_pk_mul_f32 v[104:105], v[180:181], v[180:181]
  v_pk_mul_f32 v[106:107], v[182:183], v[182:183]
  v_pk_fma_f32 v[100:101], v[100:101], v[96:97], v[96:97] op_sel:[0,1,0] op_sel_hi:[1,1,0]
  v_pk_fma_f32 v[102:103], v[102:103], v[96:97], v[96:97] op_sel:[0,1,0] op_sel_hi:[1,1,0]
  v_pk_fma_f32 v[104:105], v[104:105], v[96:97], v[96:97] op_sel:[0,1,0] op_sel_hi:[1,1,0]
  v_pk_fma_f32 v[106:107], v[106:107], v[96:97], v[96:97] op_sel:[0,1,0] op_sel_hi:[1,1,0]
  v_pk_mul_f32 v[100:101], v[100:101], v[164:165]
  v_pk_mul_f32 v[102:103], v[102:103], v[166:167]
  v_pk_mul_f32 v[104:105], v[104:105], v[180:181]
  v_pk_mul_f32 v[106:107], v[106:107], v[182:183]
  v_exp_f32 v100, v100
  v_exp_f32 v101, v101
  v_exp_f32 v102, v102
  v_exp_f32 v103, v103
  v_exp_f32 v104, v104
  v_exp_f32 v105, v105
  v_exp_f32 v106, v106
  v_exp_f32 v107, v107
  v_pk_add_f32 v[100:101], v[100:101], v[98:99] op_sel_hi:[1,0]
  v_pk_add_f32 v[102:103], v[102:103], v[98:99] op_sel_hi:[1,0]
  v_pk_add_f32 v[104:105], v[104:105], v[98:99] op_sel_hi:[1,0]
  v_pk_add_f32 v[106:107], v[106:107], v[98:99] op_sel_hi:[1,0]
  v_rcp_f32 v100, v100
  v_rcp_f32 v101, v101
  v_rcp_f32 v102, v102
  v_rcp_f32 v103, v103
  v_rcp_f32 v104, v104
  v_rcp_f32 v105, v105
  v_rcp_f32 v106, v106
  v_rcp_f32 v107, v107
  v_pk_mul_f32 v[164:165], v[164:165], v[100:101]
  v_pk_mul_f32 v[166:167], v[166:167], v[102:103]
  v_pk_mul_f32 v[180:181], v[180:181], v[104:105]
  v_pk_mul_f32 v[182:183], v[182:183], v[106:107]
  v_cvt_pk_bf16_f32 v120, v164, v165
  v_cvt_pk_bf16_f32 v121, v166, v167
  v_cvt_pk_bf16_f32 v122, v180, v181
  v_cvt_pk_bf16_f32 v123, v182, v183
  buffer_store_dwordx4 v[120:123], v11, s[40:43], s6 offen offset:1024 sc0 sc1
  v_pk_fma_f32 v[100:101], v[48:49], v[92:93], v[52:53] op_sel:[0,1,0] op_sel_hi:[1,1,1] neg_lo:[0,1,0] neg_hi:[0,1,0]
  v_pk_fma_f32 v[102:103], v[50:51], v[92:93], v[54:55] op_sel:[0,1,0] op_sel_hi:[1,1,1] neg_lo:[0,1,0] neg_hi:[0,1,0]
  v_pk_fma_f32 v[104:105], v[56:57], v[92:93], v[60:61] op_sel:[0,1,0] op_sel_hi:[1,1,1] neg_lo:[0,1,0] neg_hi:[0,1,0]
  v_pk_fma_f32 v[106:107], v[58:59], v[92:93], v[62:63] op_sel:[0,1,0] op_sel_hi:[1,1,1] neg_lo:[0,1,0] neg_hi:[0,1,0]
  v_pk_fma_f32 v[168:169], v[168:169], v[92:93], v[100:101] op_sel:[0,0,0] op_sel_hi:[1,0,1]
  v_pk_fma_f32 v[170:171], v[170:171], v[92:93], v[102:103] op_sel:[0,0,0] op_sel_hi:[1,0,1]
  v_pk_fma_f32 v[184:185], v[184:185], v[92:93], v[104:105] op_sel:[0,0,0] op_sel_hi:[1,0,1]
  v_pk_fma_f32 v[186:187], v[186:187], v[92:93], v[106:107] op_sel:[0,0,0] op_sel_hi:[1,0,1]
  v_pk_mul_f32 v[100:101], v[168:169], v[168:169]
  v_pk_mul_f32 v[102:103], v[170:171], v[170:171]
  v_pk_mul_f32 v[104:105], v[184:185], v[184:185]
  v_pk_mul_f32 v[106:107], v[186:187], v[186:187]
  v_pk_fma_f32 v[100:101], v[100:101], v[96:97], v[96:97] op_sel:[0,1,0] op_sel_hi:[1,1,0]
  v_pk_fma_f32 v[102:103], v[102:103], v[96:97], v[96:97] op_sel:[0,1,0] op_sel_hi:[1,1,0]
  v_pk_fma_f32 v[104:105], v[104:105], v[96:97], v[96:97] op_sel:[0,1,0] op_sel_hi:[1,1,0]
  v_pk_fma_f32 v[106:107], v[106:107], v[96:97], v[96:97] op_sel:[0,1,0] op_sel_hi:[1,1,0]
  v_pk_mul_f32 v[100:101], v[100:101], v[168:169]
  v_pk_mul_f32 v[102:103], v[102:103], v[170:171]
  v_pk_mul_f32 v[104:105], v[104:105], v[184:185]
  v_pk_mul_f32 v[106:107], v[106:107], v[186:187]
  v_exp_f32 v100, v100
  v_exp_f32 v101, v101
  v_exp_f32 v102, v102
  v_exp_f32 v103, v103
  v_exp_f32 v104, v104
  v_exp_f32 v105, v105
  v_exp_f32 v106, v106
  v_exp_f32 v107, v107
  v_pk_add_f32 v[100:101], v[100:101], v[98:99] op_sel_hi:[1,0]
  v_pk_add_f32 v[102:103], v[102:103], v[98:99] op_sel_hi:[1,0]
  v_pk_add_f32 v[104:105], v[104:105], v[98:99] op_sel_hi:[1,0]
  v_pk_add_f32 v[106:107], v[106:107], v[98:99] op_sel_hi:[1,0]
  v_rcp_f32 v100, v100
  v_rcp_f32 v101, v101
  v_rcp_f32 v102, v102
  v_rcp_f32 v103, v103
  v_rcp_f32 v104, v104
  v_rcp_f32 v105, v105
  v_rcp_f32 v106, v106
  v_rcp_f32 v107, v107
  v_pk_mul_f32 v[168:169], v[168:169], v[100:101]
  v_pk_mul_f32 v[170:171], v[170:171], v[102:103]
  v_pk_mul_f32 v[184:185], v[184:185], v[104:105]
  v_pk_mul_f32 v[186:187], v[186:187], v[106:107]
  v_cvt_pk_bf16_f32 v116, v168, v169
  v_cvt_pk_bf16_f32 v117, v170, v171
  v_cvt_pk_bf16_f32 v118, v184, v185
  v_cvt_pk_bf16_f32 v119, v186, v187
  buffer_store_dwordx4 v[116:119], v11, s[40:43], s6 offen offset:2048 sc0 sc1
  v_pk_fma_f32 v[100:101], v[48:49], v[94:95], v[52:53] op_sel:[0,1,0] op_sel_hi:[1,1,1] neg_lo:[0,1,0] neg_hi:[0,1,0]
  v_pk_fma_f32 v[102:103], v[50:51], v[94:95], v[54:55] op_sel:[0,1,0] op_sel_hi:[1,1,1] neg_lo:[0,1,0] neg_hi:[0,1,0]
  v_pk_fma_f32 v[104:105], v[56:57], v[94:95], v[60:61] op_sel:[0,1,0] op_sel_hi:[1,1,1] neg_lo:[0,1,0] neg_hi:[0,1,0]
  v_pk_fma_f32 v[106:107], v[58:59], v[94:95], v[62:63] op_sel:[0,1,0] op_sel_hi:[1,1,1] neg_lo:[0,1,0] neg_hi:[0,1,0]
  v_pk_fma_f32 v[172:173], v[172:173], v[94:95], v[100:101] op_sel:[0,0,0] op_sel_hi:[1,0,1]
  v_pk_fma_f32 v[174:175], v[174:175], v[94:95], v[102:103] op_sel:[0,0,0] op_sel_hi:[1,0,1]
  v_pk_fma_f32 v[188:189], v[188:189], v[94:95], v[104:105] op_sel:[0,0,0] op_sel_hi:[1,0,1]
  v_pk_fma_f32 v[190:191], v[190:191], v[94:95], v[106:107] op_sel:[0,0,0] op_sel_hi:[1,0,1]
  v_pk_mul_f32 v[100:101], v[172:173], v[172:173]
  v_pk_mul_f32 v[102:103], v[174:175], v[174:175]
  v_pk_mul_f32 v[104:105], v[188:189], v[188:189]
  v_pk_mul_f32 v[106:107], v[190:191], v[190:191]
  v_pk_fma_f32 v[100:101], v[100:101], v[96:97], v[96:97] op_sel:[0,1,0] op_sel_hi:[1,1,0]
  v_pk_fma_f32 v[102:103], v[102:103], v[96:97], v[96:97] op_sel:[0,1,0] op_sel_hi:[1,1,0]
  v_pk_fma_f32 v[104:105], v[104:105], v[96:97], v[96:97] op_sel:[0,1,0] op_sel_hi:[1,1,0]
  v_pk_fma_f32 v[106:107], v[106:107], v[96:97], v[96:97] op_sel:[0,1,0] op_sel_hi:[1,1,0]
  v_pk_mul_f32 v[100:101], v[100:101], v[172:173]
  v_pk_mul_f32 v[102:103], v[102:103], v[174:175]
  v_pk_mul_f32 v[104:105], v[104:105], v[188:189]
  v_pk_mul_f32 v[106:107], v[106:107], v[190:191]
  v_exp_f32 v100, v100
  v_exp_f32 v101, v101
  v_exp_f32 v102, v102
  v_exp_f32 v103, v103
  v_exp_f32 v104, v104
  v_exp_f32 v105, v105
  v_exp_f32 v106, v106
  v_exp_f32 v107, v107
  v_pk_add_f32 v[100:101], v[100:101], v[98:99] op_sel_hi:[1,0]
  v_pk_add_f32 v[102:103], v[102:103], v[98:99] op_sel_hi:[1,0]
  v_pk_add_f32 v[104:105], v[104:105], v[98:99] op_sel_hi:[1,0]
  v_pk_add_f32 v[106:107], v[106:107], v[98:99] op_sel_hi:[1,0]
  v_rcp_f32 v100, v100
  v_rcp_f32 v101, v101
  v_rcp_f32 v102, v102
  v_rcp_f32 v103, v103
  v_rcp_f32 v104, v104
  v_rcp_f32 v105, v105
  v_rcp_f32 v106, v106
  v_rcp_f32 v107, v107
  v_pk_mul_f32 v[172:173], v[172:173], v[100:101]
  v_pk_mul_f32 v[174:175], v[174:175], v[102:103]
  v_pk_mul_f32 v[188:189], v[188:189], v[104:105]
  v_pk_mul_f32 v[190:191], v[190:191], v[106:107]
  v_cvt_pk_bf16_f32 v120, v172, v173
  v_cvt_pk_bf16_f32 v121, v174, v175
  v_cvt_pk_bf16_f32 v122, v188, v189
  v_cvt_pk_bf16_f32 v123, v190, v191
  buffer_store_dwordx4 v[120:123], v11, s[40:43], s6 offen offset:3072 sc0 sc1
  s_add_u32 s6, s6, 8192
  v_pk_fma_f32 v[100:101], v[64:65], v[88:89], v[68:69] op_sel:[0,1,0] op_sel_hi:[1,1,1] neg_lo:[0,1,0] neg_hi:[0,1,0]
  v_pk_fma_f32 v[102:103], v[66:67], v[88:89], v[70:71] op_sel:[0,1,0] op_sel_hi:[1,1,1] neg_lo:[0,1,0] neg_hi:[0,1,0]
  v_pk_fma_f32 v[104:105], v[72:73], v[88:89], v[76:77] op_sel:[0,1,0] op_sel_hi:[1,1,1] neg_lo:[0,1,0] neg_hi:[0,1,0]
  v_pk_fma_f32 v[106:107], v[74:75], v[88:89], v[78:79] op_sel:[0,1,0] op_sel_hi:[1,1,1] neg_lo:[0,1,0] neg_hi:[0,1,0]
  v_pk_fma_f32 v[192:193], v[192:193], v[88:89], v[100:101] op_sel:[0,0,0] op_sel_hi:[1,0,1]
  v_pk_fma_f32 v[194:195], v[194:195], v[88:89], v[102:103] op_sel:[0,0,0] op_sel_hi:[1,0,1]
  v_pk_fma_f32 v[208:209], v[208:209], v[88:89], v[104:105] op_sel:[0,0,0] op_sel_hi:[1,0,1]
  v_pk_fma_f32 v[210:211], v[210:211], v[88:89], v[106:107] op_sel:[0,0,0] op_sel_hi:[1,0,1]
  v_pk_mul_f32 v[100:101], v[192:193], v[192:193]
  v_pk_mul_f32 v[102:103], v[194:195], v[194:195]
  v_pk_mul_f32 v[104:105], v[208:209], v[208:209]
  v_pk_mul_f32 v[106:107], v[210:211], v[210:211]
  v_pk_fma_f32 v[100:101], v[100:101], v[96:97], v[96:97] op_sel:[0,1,0] op_sel_hi:[1,1,0]
  v_pk_fma_f32 v[102:103], v[102:103], v[96:97], v[96:97] op_sel:[0,1,0] op_sel_hi:[1,1,0]
  v_pk_fma_f32 v[104:105], v[104:105], v[96:97], v[96:97] op_sel:[0,1,0] op_sel_hi:[1,1,0]
  v_pk_fma_f32 v[106:107], v[106:107], v[96:97], v[96:97] op_sel:[0,1,0] op_sel_hi:[1,1,0]
  v_pk_mul_f32 v[100:101], v[100:101], v[192:193]
  v_pk_mul_f32 v[102:103], v[102:103], v[194:195]
  v_pk_mul_f32 v[104:105], v[104:105], v[208:209]
  v_pk_mul_f32 v[106:107], v[106:107], v[210:211]
  v_exp_f32 v100, v100
  v_exp_f32 v101, v101
  v_exp_f32 v102, v102
  v_exp_f32 v103, v103
  v_exp_f32 v104, v104
  v_exp_f32 v105, v105
  v_exp_f32 v106, v106
  v_exp_f32 v107, v107
  v_pk_add_f32 v[100:101], v[100:101], v[98:99] op_sel_hi:[1,0]
  v_pk_add_f32 v[102:103], v[102:103], v[98:99] op_sel_hi:[1,0]
  v_pk_add_f32 v[104:105], v[104:105], v[98:99] op_sel_hi:[1,0]
  v_pk_add_f32 v[106:107], v[106:107], v[98:99] op_sel_hi:[1,0]
  v_rcp_f32 v100, v100
  v_rcp_f32 v101, v101
  v_rcp_f32 v102, v102
  v_rcp_f32 v103, v103
  v_rcp_f32 v104, v104
  v_rcp_f32 v105, v105
  v_rcp_f32 v106, v106
  v_rcp_f32 v107, v107
  v_pk_mul_f32 v[192:193], v[192:193], v[100:101]
  v_pk_mul_f32 v[194:195], v[194:195], v[102:103]
  v_pk_mul_f32 v[208:209], v[208:209], v[104:105]
  v_pk_mul_f32 v[210:211], v[210:211], v[106:107]
  v_cvt_pk_bf16_f32 v116, v192, v193
  v_cvt_pk_bf16_f32 v117, v194, v195
  v_cvt_pk_bf16_f32 v118, v208, v209
  v_cvt_pk_bf16_f32 v119, v210, v211
  buffer_store_dwordx4 v[116:119], v11, s[40:43], s6 offen offset:0 sc0 sc1
  v_pk_fma_f32 v[100:101], v[64:65], v[90:91], v[68:69] op_sel:[0,1,0] op_sel_hi:[1,1,1] neg_lo:[0,1,0] neg_hi:[0,1,0]
  v_pk_fma_f32 v[102:103], v[66:67], v[90:91], v[70:71] op_sel:[0,1,0] op_sel_hi:[1,1,1] neg_lo:[0,1,0] neg_hi:[0,1,0]
  v_pk_fma_f32 v[104:105], v[72:73], v[90:91], v[76:77] op_sel:[0,1,0] op_sel_hi:[1,1,1] neg_lo:[0,1,0] neg_hi:[0,1,0]
  v_pk_fma_f32 v[106:107], v[74:75], v[90:91], v[78:79] op_sel:[0,1,0] op_sel_hi:[1,1,1] neg_lo:[0,1,0] neg_hi:[0,1,0]
  v_pk_fma_f32 v[196:197], v[196:197], v[90:91], v[100:101] op_sel:[0,0,0] op_sel_hi:[1,0,1]
  v_pk_fma_f32 v[198:199], v[198:199], v[90:91], v[102:103] op_sel:[0,0,0] op_sel_hi:[1,0,1]
  v_pk_fma_f32 v[212:213], v[212:213], v[90:91], v[104:105] op_sel:[0,0,0] op_sel_hi:[1,0,1]
  v_pk_fma_f32 v[214:215], v[214:215], v[90:91], v[106:107] op_sel:[0,0,0] op_sel_hi:[1,0,1]
  v_pk_mul_f32 v[100:101], v[196:197], v[196:197]
  v_pk_mul_f32 v[102:103], v[198:199], v[198:199]
  v_pk_mul_f32 v[104:105], v[212:213], v[212:213]
  v_pk_mul_f32 v[106:107], v[214:215], v[214:215]
  v_pk_fma_f32 v[100:101], v[100:101], v[96:97], v[96:97] op_sel:[0,1,0] op_sel_hi:[1,1,0]
  v_pk_fma_f32 v[102:103], v[102:103], v[96:97], v[96:97] op_sel:[0,1,0] op_sel_hi:[1,1,0]
  v_pk_fma_f32 v[104:105], v[104:105], v[96:97], v[96:97] op_sel:[0,1,0] op_sel_hi:[1,1,0]
  v_pk_fma_f32 v[106:107], v[106:107], v[96:97], v[96:97] op_sel:[0,1,0] op_sel_hi:[1,1,0]
  v_pk_mul_f32 v[100:101], v[100:101], v[196:197]
  v_pk_mul_f32 v[102:103], v[102:103], v[198:199]
  v_pk_mul_f32 v[104:105], v[104:105], v[212:213]
  v_pk_mul_f32 v[106:107], v[106:107], v[214:215]
  v_exp_f32 v100, v100
  v_exp_f32 v101, v101
  v_exp_f32 v102, v102
  v_exp_f32 v103, v103
  v_exp_f32 v104, v104
  v_exp_f32 v105, v105
  v_exp_f32 v106, v106
  v_exp_f32 v107, v107
  v_pk_add_f32 v[100:101], v[100:101], v[98:99] op_sel_hi:[1,0]
  v_pk_add_f32 v[102:103], v[102:103], v[98:99] op_sel_hi:[1,0]
  v_pk_add_f32 v[104:105], v[104:105], v[98:99] op_sel_hi:[1,0]
  v_pk_add_f32 v[106:107], v[106:107], v[98:99] op_sel_hi:[1,0]
  v_rcp_f32 v100, v100
  v_rcp_f32 v101, v101
  v_rcp_f32 v102, v102
  v_rcp_f32 v103, v103
  v_rcp_f32 v104, v104
  v_rcp_f32 v105, v105
  v_rcp_f32 v106, v106
  v_rcp_f32 v107, v107
  v_pk_mul_f32 v[196:197], v[196:197], v[100:101]
  v_pk_mul_f32 v[198:199], v[198:199], v[102:103]
  v_pk_mul_f32 v[212:213], v[212:213], v[104:105]
  v_pk_mul_f32 v[214:215], v[214:215], v[106:107]
  v_cvt_pk_bf16_f32 v120, v196, v197
  v_cvt_pk_bf16_f32 v121, v198, v199
  v_cvt_pk_bf16_f32 v122, v212, v213
  v_cvt_pk_bf16_f32 v123, v214, v215
  buffer_store_dwordx4 v[120:123], v11, s[40:43], s6 offen offset:1024 sc0 sc1
  v_pk_fma_f32 v[100:101], v[64:65], v[92:93], v[68:69] op_sel:[0,1,0] op_sel_hi:[1,1,1] neg_lo:[0,1,0] neg_hi:[0,1,0]
  v_pk_fma_f32 v[102:103], v[66:67], v[92:93], v[70:71] op_sel:[0,1,0] op_sel_hi:[1,1,1] neg_lo:[0,1,0] neg_hi:[0,1,0]
  v_pk_fma_f32 v[104:105], v[72:73], v[92:93], v[76:77] op_sel:[0,1,0] op_sel_hi:[1,1,1] neg_lo:[0,1,0] neg_hi:[0,1,0]
  v_pk_fma_f32 v[106:107], v[74:75], v[92:93], v[78:79] op_sel:[0,1,0] op_sel_hi:[1,1,1] neg_lo:[0,1,0] neg_hi:[0,1,0]
  v_pk_fma_f32 v[200:201], v[200:201], v[92:93], v[100:101] op_sel:[0,0,0] op_sel_hi:[1,0,1]
  v_pk_fma_f32 v[202:203], v[202:203], v[92:93], v[102:103] op_sel:[0,0,0] op_sel_hi:[1,0,1]
  v_pk_fma_f32 v[216:217], v[216:217], v[92:93], v[104:105] op_sel:[0,0,0] op_sel_hi:[1,0,1]
  v_pk_fma_f32 v[218:219], v[218:219], v[92:93], v[106:107] op_sel:[0,0,0] op_sel_hi:[1,0,1]
  v_pk_mul_f32 v[100:101], v[200:201], v[200:201]
  v_pk_mul_f32 v[102:103], v[202:203], v[202:203]
  v_pk_mul_f32 v[104:105], v[216:217], v[216:217]
  v_pk_mul_f32 v[106:107], v[218:219], v[218:219]
  v_pk_fma_f32 v[100:101], v[100:101], v[96:97], v[96:97] op_sel:[0,1,0] op_sel_hi:[1,1,0]
  v_pk_fma_f32 v[102:103], v[102:103], v[96:97], v[96:97] op_sel:[0,1,0] op_sel_hi:[1,1,0]
  v_pk_fma_f32 v[104:105], v[104:105], v[96:97], v[96:97] op_sel:[0,1,0] op_sel_hi:[1,1,0]
  v_pk_fma_f32 v[106:107], v[106:107], v[96:97], v[96:97] op_sel:[0,1,0] op_sel_hi:[1,1,0]
  v_pk_mul_f32 v[100:101], v[100:101], v[200:201]
  v_pk_mul_f32 v[102:103], v[102:103], v[202:203]
  v_pk_mul_f32 v[104:105], v[104:105], v[216:217]
  v_pk_mul_f32 v[106:107], v[106:107], v[218:219]
  v_exp_f32 v100, v100
  v_exp_f32 v101, v101
  v_exp_f32 v102, v102
  v_exp_f32 v103, v103
  v_exp_f32 v104, v104
  v_exp_f32 v105, v105
  v_exp_f32 v106, v106
  v_exp_f32 v107, v107
  v_pk_add_f32 v[100:101], v[100:101], v[98:99] op_sel_hi:[1,0]
  v_pk_add_f32 v[102:103], v[102:103], v[98:99] op_sel_hi:[1,0]
  v_pk_add_f32 v[104:105], v[104:105], v[98:99] op_sel_hi:[1,0]
  v_pk_add_f32 v[106:107], v[106:107], v[98:99] op_sel_hi:[1,0]
  v_rcp_f32 v100, v100
  v_rcp_f32 v101, v101
  v_rcp_f32 v102, v102
  v_rcp_f32 v103, v103
  v_rcp_f32 v104, v104
  v_rcp_f32 v105, v105
  v_rcp_f32 v106, v106
  v_rcp_f32 v107, v107
  v_pk_mul_f32 v[200:201], v[200:201], v[100:101]
  v_pk_mul_f32 v[202:203], v[202:203], v[102:103]
  v_pk_mul_f32 v[216:217], v[216:217], v[104:105]
  v_pk_mul_f32 v[218:219], v[218:219], v[106:107]
  v_cvt_pk_bf16_f32 v116, v200, v201
  v_cvt_pk_bf16_f32 v117, v202, v203
  v_cvt_pk_bf16_f32 v118, v216, v217
  v_cvt_pk_bf16_f32 v119, v218, v219
  buffer_store_dwordx4 v[116:119], v11, s[40:43], s6 offen offset:2048 sc0 sc1
  v_pk_fma_f32 v[100:101], v[64:65], v[94:95], v[68:69] op_sel:[0,1,0] op_sel_hi:[1,1,1] neg_lo:[0,1,0] neg_hi:[0,1,0]
  v_pk_fma_f32 v[102:103], v[66:67], v[94:95], v[70:71] op_sel:[0,1,0] op_sel_hi:[1,1,1] neg_lo:[0,1,0] neg_hi:[0,1,0]
  v_pk_fma_f32 v[104:105], v[72:73], v[94:95], v[76:77] op_sel:[0,1,0] op_sel_hi:[1,1,1] neg_lo:[0,1,0] neg_hi:[0,1,0]
  v_pk_fma_f32 v[106:107], v[74:75], v[94:95], v[78:79] op_sel:[0,1,0] op_sel_hi:[1,1,1] neg_lo:[0,1,0] neg_hi:[0,1,0]
  v_pk_fma_f32 v[204:205], v[204:205], v[94:95], v[100:101] op_sel:[0,0,0] op_sel_hi:[1,0,1]
  v_pk_fma_f32 v[206:207], v[206:207], v[94:95], v[102:103] op_sel:[0,0,0] op_sel_hi:[1,0,1]
  v_pk_fma_f32 v[220:221], v[220:221], v[94:95], v[104:105] op_sel:[0,0,0] op_sel_hi:[1,0,1]
  v_pk_fma_f32 v[222:223], v[222:223], v[94:95], v[106:107] op_sel:[0,0,0] op_sel_hi:[1,0,1]
  v_pk_mul_f32 v[100:101], v[204:205], v[204:205]
  v_pk_mul_f32 v[102:103], v[206:207], v[206:207]
  v_pk_mul_f32 v[104:105], v[220:221], v[220:221]
  v_pk_mul_f32 v[106:107], v[222:223], v[222:223]
  v_pk_fma_f32 v[100:101], v[100:101], v[96:97], v[96:97] op_sel:[0,1,0] op_sel_hi:[1,1,0]
  v_pk_fma_f32 v[102:103], v[102:103], v[96:97], v[96:97] op_sel:[0,1,0] op_sel_hi:[1,1,0]
  v_pk_fma_f32 v[104:105], v[104:105], v[96:97], v[96:97] op_sel:[0,1,0] op_sel_hi:[1,1,0]
  v_pk_fma_f32 v[106:107], v[106:107], v[96:97], v[96:97] op_sel:[0,1,0] op_sel_hi:[1,1,0]
  v_pk_mul_f32 v[100:101], v[100:101], v[204:205]
  v_pk_mul_f32 v[102:103], v[102:103], v[206:207]
  v_pk_mul_f32 v[104:105], v[104:105], v[220:221]
  v_pk_mul_f32 v[106:107], v[106:107], v[222:223]
  v_exp_f32 v100, v100
  v_exp_f32 v101, v101
  v_exp_f32 v102, v102
  v_exp_f32 v103, v103
  v_exp_f32 v104, v104
  v_exp_f32 v105, v105
  v_exp_f32 v106, v106
  v_exp_f32 v107, v107
  v_pk_add_f32 v[100:101], v[100:101], v[98:99] op_sel_hi:[1,0]
  v_pk_add_f32 v[102:103], v[102:103], v[98:99] op_sel_hi:[1,0]
  v_pk_add_f32 v[104:105], v[104:105], v[98:99] op_sel_hi:[1,0]
  v_pk_add_f32 v[106:107], v[106:107], v[98:99] op_sel_hi:[1,0]
  v_rcp_f32 v100, v100
  v_rcp_f32 v101, v101
  v_rcp_f32 v102, v102
  v_rcp_f32 v103, v103
  v_rcp_f32 v104, v104
  v_rcp_f32 v105, v105
  v_rcp_f32 v106, v106
  v_rcp_f32 v107, v107
  v_pk_mul_f32 v[204:205], v[204:205], v[100:101]
  v_pk_mul_f32 v[206:207], v[206:207], v[102:103]
  v_pk_mul_f32 v[220:221], v[220:221], v[104:105]
  v_pk_mul_f32 v[222:223], v[222:223], v[106:107]
  v_cvt_pk_bf16_f32 v120, v204, v205
  v_cvt_pk_bf16_f32 v121, v206, v207
  v_cvt_pk_bf16_f32 v122, v220, v221
  v_cvt_pk_bf16_f32 v123, v222, v223
  buffer_store_dwordx4 v[120:123], v11, s[40:43], s6 offen offset:3072 sc0 sc1
  s_add_u32 s5, s87, 256
  s_waitcnt vmcnt(0)
  s_mov_b64 exec, 1
  ds_add_rtn_u32 v2, v28, v27
  s_waitcnt lgkmcnt(0)
  v_readfirstlane_b32 s4, v2
  s_and_b32 s4, s4, 3
  s_cmp_lg_u32 s4, 3
  s_cbranch_scc1 Ls_10
  s_mov_b32 exec_lo, 0xffff
  buffer_store_dword v27, v24, s[40:43], s5 offen sc0 sc1
Ls_10:
  s_mov_b64 exec, -1
  s_mov_b32 s16, 0
  s_mov_b32 s17, 16384
  s_mov_b32 s18, 0xffff4000
  s_mov_b32 s19, 0
  s_mov_b32 s20, 16384
  s_mov_b32 s21, 0xffff0000
  s_mul_i32 s4, s85, 8192
  v_add_u32 v4, s4, v11
  v_add_u32 v5, 1024, v4
  s_lshl_b32 s4, s86, 1
  v_xor_b32 v2, s4, v26
  v_lshl_add_u32 v6, v2, 5, v25
  s_add_u32 s4, s4, 1
  v_xor_b32 v2, s4, v26
  v_lshl_add_u32 v7, v2, 5, v25
  s_mov_b32 s4, 0xffff0000
  v_lshlrev_b32 v128, 16, v240
  v_and_b32 v129, s4, v240
  v_lshlrev_b32 v130, 16, v241
  v_and_b32 v131, s4, v241
  v_lshlrev_b32 v132, 16, v242
  v_and_b32 v133, s4, v242
  v_lshlrev_b32 v134, 16, v243
  v_and_b32 v135, s4, v243
  v_lshlrev_b32 v136, 16, v244
  v_and_b32 v137, s4, v244
  v_lshlrev_b32 v138, 16, v245
  v_and_b32 v139, s4, v245
  v_lshlrev_b32 v140, 16, v246
  v_and_b32 v141, s4, v246
  v_lshlrev_b32 v142, 16, v247
  v_and_b32 v143, s4, v247
  v_lshlrev_b32 v144, 16, v248
  v_and_b32 v145, s4, v248
  v_lshlrev_b32 v146, 16, v249
  v_and_b32 v147, s4, v249
  v_lshlrev_b32 v148, 16, v250
  v_and_b32 v149, s4, v250
  v_lshlrev_b32 v150, 16, v251
  v_and_b32 v151, s4, v251
  v_lshlrev_b32 v152, 16, v252
  v_and_b32 v153, s4, v252
  v_lshlrev_b32 v154, 16, v253
  v_and_b32 v155, s4, v253
  v_lshlrev_b32 v156, 16, v254
  v_and_b32 v157, s4, v254
  v_lshlrev_b32 v158, 16, v255
  v_and_b32 v159, s4, v255
  s_lshl_b32 s5, s86, 7
  s_add_u32 s5, s5, 156160
  v_add_u32 v3, s5, v29
  ds_read_b128 v[32:35], v3
  ds_read_b128 v[36:39], v3 offset:64
  v_mov_b64 v[160:161], 0
  v_mov_b64 v[162:163], 0
  v_mov_b64 v[164:165], 0
  v_mov_b64 v[166:167], 0
  v_mov_b64 v[168:169], 0
  v_mov_b64 v[170:171], 0
  v_mov_b64 v[172:173], 0
  v_mov_b64 v[174:175], 0
  v_mov_b64 v[176:177], 0
  v_mov_b64 v[178:179], 0
  v_mov_b64 v[180:181], 0
  v_mov_b64 v[182:183], 0
  v_mov_b64 v[184:185], 0
  v_mov_b64 v[186:187], 0
  v_mov_b64 v[188:189], 0
  v_mov_b64 v[190:191], 0
  s_waitcnt lgkmcnt(0)
  v_pk_add_f32 v[128:129], v[128:129], v[32:33]
  v_pk_add_f32 v[130:131], v[130:131], v[34:35]
  v_pk_add_f32 v[132:133], v[132:133], v[36:37]
  v_pk_add_f32 v[134:135], v[134:135], v[38:39]
  v_pk_add_f32 v[136:137], v[136:137], v[32:33]
  v_pk_add_f32 v[138:139], v[138:139], v[34:35]
  v_pk_add_f32 v[140:141], v[140:141], v[36:37]
  v_pk_add_f32 v[142:143], v[142:143], v[38:39]
  v_pk_add_f32 v[144:145], v[144:145], v[32:33]
  v_pk_add_f32 v[146:147], v[146:147], v[34:35]
  v_pk_add_f32 v[148:149], v[148:149], v[36:37]
  v_pk_add_f32 v[150:151], v[150:151], v[38:39]
  v_pk_add_f32 v[152:153], v[152:153], v[32:33]
  v_pk_add_f32 v[154:155], v[154:155], v[34:35]
  v_pk_add_f32 v[156:157], v[156:157], v[36:37]
  v_pk_add_f32 v[158:159], v[158:159], v[38:39]
  s_mov_b32 s22, 14
  s_barrier
  ds_read_b64_tr_b16 v[48:49], v6 offset:0
  ds_read_b64_tr_b16 v[50:51], v6 offset:2048
  ds_read_b128 v[32:35], v4 offset:0
  ds_read_b128 v[36:39], v4 offset:2048
  ds_read_b128 v[40:43], v4 offset:4096
  ds_read_b128 v[44:47], v4 offset:6144
  ds_read_b64_tr_b16 v[52:53], v7 offset:0
  ds_read_b64_tr_b16 v[54:55], v7 offset:2048
  ds_read_b64_tr_b16 v[56:57], v6 offset:8192
  ds_read_b64_tr_b16 v[58:59], v6 offset:10240
  ds_read_b64_tr_b16 v[60:61], v7 offset:8192
  ds_read_b64_tr_b16 v[62:63], v7 offset:10240
  ds_read_b64_tr_b16 v[80:81], v6 offset:4096
  s_waitcnt lgkmcnt(4)
  ds_read_b64_tr_b16 v[82:83], v6 offset:6144
  ds_read_b128 v[64:67], v5 offset:0
  ds_read_b128 v[68:71], v5 offset:2048
  ds_read_b128 v[72:75], v5 offset:4096
  ds_read_b128 v[76:79], v5 offset:6144
  ds_read_b64_tr_b16 v[84:85], v7 offset:4096
  ds_read_b64_tr_b16 v[86:87], v7 offset:6144
  ds_read_b64_tr_b16 v[88:89], v6 offset:12288
  ds_read_b64_tr_b16 v[90:91], v6 offset:14336
  ds_read_b64_tr_b16 v[92:93], v7 offset:12288
  ds_read_b64_tr_b16 v[94:95], v7 offset:14336
  s_add_u32 s16, s16, s17
  s_cmp_eq_u32 s16, 65536
  s_cselect_b32 s23, s18, s17
  s_cselect_b32 s16, 0, s16
  v_add_u32 v4, s23, v4
  v_add_u32 v5, s23, v5
  s_add_u32 s19, s19, s20
  s_cmp_eq_u32 s19, 81920
  s_cselect_b32 s23, s21, s20
  s_cselect_b32 s19, 0, s19
  v_add_u32 v6, s23, v6
  v_add_u32 v7, s23, v7
  s_waitcnt lgkmcnt(0)
Lk_11:
  s_barrier
  v_mfma_f32_16x16x32_bf16 v[128:131], v[48:51], v[32:35], v[128:131]
  ds_read_b64_tr_b16 v[112:113], v6 offset:0
  v_mfma_f32_16x16x32_bf16 v[136:139], v[48:51], v[36:39], v[136:139]
  ds_read_b64_tr_b16 v[114:115], v6 offset:2048
  v_mfma_f32_16x16x32_bf16 v[144:147], v[48:51], v[40:43], v[144:147]
  ds_read_b128 v[96:99], v4 offset:0
  v_mfma_f32_16x16x32_bf16 v[152:155], v[48:51], v[44:47], v[152:155]
  ds_read_b128 v[100:103], v4 offset:2048
  v_mfma_f32_16x16x32_bf16 v[132:135], v[52:55], v[32:35], v[132:135]
  ds_read_b128 v[104:107], v4 offset:4096
  v_mfma_f32_16x16x32_bf16 v[140:143], v[52:55], v[36:39], v[140:143]
  ds_read_b128 v[108:111], v4 offset:6144
  v_mfma_f32_16x16x32_bf16 v[148:151], v[52:55], v[40:43], v[148:151]
  ds_read_b64_tr_b16 v[116:117], v7 offset:0
  v_mfma_f32_16x16x32_bf16 v[156:159], v[52:55], v[44:47], v[156:159]
  ds_read_b64_tr_b16 v[118:119], v7 offset:2048
  v_mfma_f32_16x16x32_bf16 v[160:163], v[56:59], v[32:35], v[160:163]
  ds_read_b64_tr_b16 v[120:121], v6 offset:8192
  v_mfma_f32_16x16x32_bf16 v[168:171], v[56:59], v[36:39], v[168:171]
  ds_read_b64_tr_b16 v[122:123], v6 offset:10240
  v_mfma_f32_16x16x32_bf16 v[176:179], v[56:59], v[40:43], v[176:179]
  ds_read_b64_tr_b16 v[124:125], v7 offset:8192
  v_mfma_f32_16x16x32_bf16 v[184:187], v[56:59], v[44:47], v[184:187]
  ds_read_b64_tr_b16 v[126:127], v7 offset:10240
  v_mfma_f32_16x16x32_bf16 v[164:167], v[60:63], v[32:35], v[164:167]
  ds_read_b64_tr_b16 v[208:209], v6 offset:4096
  v_mfma_f32_16x16x32_bf16 v[172:175], v[60:63], v[36:39], v[172:175]
  ds_read_b64_tr_b16 v[210:211], v6 offset:6144
  v_mfma_f32_16x16x32_bf16 v[180:183], v[60:63], v[40:43], v[180:183]
  ds_read_b128 v[192:195], v5 offset:0
  v_mfma_f32_16x16x32_bf16 v[188:191], v[60:63], v[44:47], v[188:191]
  ds_read_b128 v[196:199], v5 offset:2048
  v_mfma_f32_16x16x32_bf16 v[128:131], v[80:83], v[64:67], v[128:131]
  ds_read_b128 v[200:203], v5 offset:4096
  v_mfma_f32_16x16x32_bf16 v[136:139], v[80:83], v[68:71], v[136:139]
  ds_read_b128 v[204:207], v5 offset:6144
  v_mfma_f32_16x16x32_bf16 v[144:147], v[80:83], v[72:75], v[144:147]
  ds_read_b64_tr_b16 v[212:213], v7 offset:4096
  v_mfma_f32_16x16x32_bf16 v[152:155], v[80:83], v[76:79], v[152:155]
  ds_read_b64_tr_b16 v[214:215], v7 offset:6144
  v_mfma_f32_16x16x32_bf16 v[132:135], v[84:87], v[64:67], v[132:135]
  ds_read_b64_tr_b16 v[216:217], v6 offset:12288
  v_mfma_f32_16x16x32_bf16 v[140:143], v[84:87], v[68:71], v[140:143]
  ds_read_b64_tr_b16 v[218:219], v6 offset:14336
  v_mfma_f32_16x16x32_bf16 v[148:151], v[84:87], v[72:75], v[148:151]
  ds_read_b64_tr_b16 v[220:221], v7 offset:12288
  v_mfma_f32_16x16x32_bf16 v[156:159], v[84:87], v[76:79], v[156:159]
  ds_read_b64_tr_b16 v[222:223], v7 offset:14336
  v_mfma_f32_16x16x32_bf16 v[160:163], v[88:91], v[64:67], v[160:163]
  s_add_u32 s16, s16, s17
  s_cmp_eq_u32 s16, 65536
  s_cselect_b32 s23, s18, s17
  v_mfma_f32_16x16x32_bf16 v[168:171], v[88:91], v[68:71], v[168:171]
  s_cselect_b32 s16, 0, s16
  v_add_u32 v4, s23, v4
  v_add_u32 v5, s23, v5
  v_mfma_f32_16x16x32_bf16 v[176:179], v[88:91], v[72:75], v[176:179]
  s_add_u32 s19, s19, s20
  s_cmp_eq_u32 s19, 81920
  s_cselect_b32 s23, s21, s20
  v_mfma_f32_16x16x32_bf16 v[184:187], v[88:91], v[76:79], v[184:187]
  s_cselect_b32 s19, 0, s19
  v_add_u32 v6, s23, v6
  v_add_u32 v7, s23, v7
  v_mfma_f32_16x16x32_bf16 v[164:167], v[92:95], v[64:67], v[164:167]
  v_mfma_f32_16x16x32_bf16 v[172:175], v[92:95], v[68:71], v[172:175]
  v_mfma_f32_16x16x32_bf16 v[180:183], v[92:95], v[72:75], v[180:183]
  s_waitcnt lgkmcnt(0)
  v_mfma_f32_16x16x32_bf16 v[188:191], v[92:95], v[76:79], v[188:191]
  s_barrier
  v_mfma_f32_16x16x32_bf16 v[128:131], v[112:115], v[96:99], v[128:131]
  ds_read_b64_tr_b16 v[48:49], v6 offset:0
  v_mfma_f32_16x16x32_bf16 v[136:139], v[112:115], v[100:103], v[136:139]
  ds_read_b64_tr_b16 v[50:51], v6 offset:2048
  v_mfma_f32_16x16x32_bf16 v[144:147], v[112:115], v[104:107], v[144:147]
  ds_read_b128 v[32:35], v4 offset:0
  v_mfma_f32_16x16x32_bf16 v[152:155], v[112:115], v[108:111], v[152:155]
  ds_read_b128 v[36:39], v4 offset:2048
  v_mfma_f32_16x16x32_bf16 v[132:135], v[116:119], v[96:99], v[132:135]
  ds_read_b128 v[40:43], v4 offset:4096
  v_mfma_f32_16x16x32_bf16 v[140:143], v[116:119], v[100:103], v[140:143]
  ds_read_b128 v[44:47], v4 offset:6144
  v_mfma_f32_16x16x32_bf16 v[148:151], v[116:119], v[104:107], v[148:151]
  ds_read_b64_tr_b16 v[52:53], v7 offset:0
  v_mfma_f32_16x16x32_bf16 v[156:159], v[116:119], v[108:111], v[156:159]
  ds_read_b64_tr_b16 v[54:55], v7 offset:2048
  v_mfma_f32_16x16x32_bf16 v[160:163], v[120:123], v[96:99], v[160:163]
  ds_read_b64_tr_b16 v[56:57], v6 offset:8192
  v_mfma_f32_16x16x32_bf16 v[168:171], v[120:123], v[100:103], v[168:171]
  ds_read_b64_tr_b16 v[58:59], v6 offset:10240
  v_mfma_f32_16x16x32_bf16 v[176:179], v[120:123], v[104:107], v[176:179]
  ds_read_b64_tr_b16 v[60:61], v7 offset:8192
  v_mfma_f32_16x16x32_bf16 v[184:187], v[120:123], v[108:111], v[184:187]
  ds_read_b64_tr_b16 v[62:63], v7 offset:10240
  v_mfma_f32_16x16x32_bf16 v[164:167], v[124:127], v[96:99], v[164:167]
  ds_read_b64_tr_b16 v[80:81], v6 offset:4096
  v_mfma_f32_16x16x32_bf16 v[172:175], v[124:127], v[100:103], v[172:175]
  ds_read_b64_tr_b16 v[82:83], v6 offset:6144
  v_mfma_f32_16x16x32_bf16 v[180:183], v[124:127], v[104:107], v[180:183]
  ds_read_b128 v[64:67], v5 offset:0
  v_mfma_f32_16x16x32_bf16 v[188:191], v[124:127], v[108:111], v[188:191]
  ds_read_b128 v[68:71], v5 offset:2048
  v_mfma_f32_16x16x32_bf16 v[128:131], v[208:211], v[192:195], v[128:131]
  ds_read_b128 v[72:75], v5 offset:4096
  v_mfma_f32_16x16x32_bf16 v[136:139], v[208:211], v[196:199], v[136:139]
  ds_read_b128 v[76:79], v5 offset:6144
  v_mfma_f32_16x16x32_bf16 v[144:147], v[208:211], v[200:203], v[144:147]
  ds_read_b64_tr_b16 v[84:85], v7 offset:4096
  v_mfma_f32_16x16x32_bf16 v[152:155], v[208:211], v[204:207], v[152:155]
  ds_read_b64_tr_b16 v[86:87], v7 offset:6144
  v_mfma_f32_16x16x32_bf16 v[132:135], v[212:215], v[192:195], v[132:135]
  ds_read_b64_tr_b16 v[88:89], v6 offset:12288
  v_mfma_f32_16x16x32_bf16 v[140:143], v[212:215], v[196:199], v[140:143]
  ds_read_b64_tr_b16 v[90:91], v6 offset:14336
  v_mfma_f32_16x16x32_bf16 v[148:151], v[212:215], v[200:203], v[148:151]
  ds_read_b64_tr_b16 v[92:93], v7 offset:12288
  v_mfma_f32_16x16x32_bf16 v[156:159], v[212:215], v[204:207], v[156:159]
  ds_read_b64_tr_b16 v[94:95], v7 offset:14336
  v_mfma_f32_16x16x32_bf16 v[160:163], v[216:219], v[192:195], v[160:163]
  s_add_u32 s16, s16, s17
  s_cmp_eq_u32 s16, 65536
  s_cselect_b32 s23, s18, s17
  v_mfma_f32_16x16x32_bf16 v[168:171], v[216:219], v[196:199], v[168:171]
  s_cselect_b32 s16, 0, s16
  v_add_u32 v4, s23, v4
  v_add_u32 v5, s23, v5
  v_mfma_f32_16x16x32_bf16 v[176:179], v[216:219], v[200:203], v[176:179]
  s_add_u32 s19, s19, s20
  s_cmp_eq_u32 s19, 81920
  s_cselect_b32 s23, s21, s20
  v_mfma_f32_16x16x32_bf16 v[184:187], v[216:219], v[204:207], v[184:187]
  s_cselect_b32 s19, 0, s19
  v_add_u32 v6, s23, v6
  v_add_u32 v7, s23, v7
  v_mfma_f32_16x16x32_bf16 v[164:167], v[220:223], v[192:195], v[164:167]
  s_sub_u32 s22, s22, 1
  s_cmp_lg_u32 s22, 0
  v_mfma_f32_16x16x32_bf16 v[172:175], v[220:223], v[196:199], v[172:175]
  v_mfma_f32_16x16x32_bf16 v[180:183], v[220:223], v[200:203], v[180:183]
  s_waitcnt lgkmcnt(0)
  v_mfma_f32_16x16x32_bf16 v[188:191], v[220:223], v[204:207], v[188:191]
  s_cbranch_scc1 Lk_11
  s_xor_b32 s8, s84, 16384
  s_lshl_b32 s6, s8, 4
  s_lshl_b32 s7, s81, 13
  s_add_u32 s7, s7, s83
  s_add_u32 s7, s7, 23068672
  s_add_u32 s6, s6, s7
  s_add_u32 s9, s6, 4096
  buffer_store_dwordx4 v[160:163], v11, s[40:43], s6 offen offset:0 sc0 sc1
  buffer_store_dwordx4 v[164:167], v11, s[40:43], s6 offen offset:1024 sc0 sc1
  buffer_store_dwordx4 v[168:171], v11, s[40:43], s6 offen offset:2048 sc0 sc1
  buffer_store_dwordx4 v[172:175], v11, s[40:43], s6 offen offset:3072 sc0 sc1
  buffer_store_dwordx4 v[176:179], v11, s[40:43], s9 offen offset:0 sc0 sc1
  buffer_store_dwordx4 v[180:183], v11, s[40:43], s9 offen offset:1024 sc0 sc1
  buffer_store_dwordx4 v[184:187], v11, s[40:43], s9 offen offset:2048 sc0 sc1
  buffer_store_dwordx4 v[188:191], v11, s[40:43], s9 offen offset:3072 sc0 sc1
  s_add_u32 s8, s8, s87
  s_lshl_b32 s4, s81, 2
  s_add_u32 s8, s8, s4
  s_add_u32 s8, s8, 384
  s_xor_b32 s10, s8, 16384
  s_lshl_b32 s6, s84, 4
  s_add_u32 s6, s6, s7
  s_add_u32 s9, s6, 4096
  v_mov_b32 v2, 0
  s_waitcnt vmcnt(0) lgkmcnt(0)
  s_mov_b64 exec, 1
  buffer_store_dword v27, v2, s[40:43], s8 offen sc0 sc1
  s_mov_b32 s89, 200000
  buffer_load_dword v120, v2, s[40:43], s10 offen sc0 sc1
Lp_12:
  s_waitcnt vmcnt(0)
  v_cmp_ne_u32 vcc, 0, v120
  s_andn2_b32 s3, 1, vcc_lo
  s_cbranch_scc0 Lp_13
  s_sleep 1
  buffer_load_dword v120, v2, s[40:43], s10 offen sc0 sc1
  s_sub_u32 s89, s89, 1
  s_cbranch_scc0 Lp_12
Lp_13:
  s_mov_b64 exec, -1
  buffer_load_dwordx4 v[32:35], v11, s[40:43], s6 offen offset:0 sc0 sc1
  buffer_load_dwordx4 v[36:39], v11, s[40:43], s6 offen offset:1024 sc0 sc1
  buffer_load_dwordx4 v[40:43], v11, s[40:43], s6 offen offset:2048 sc0 sc1
  buffer_load_dwordx4 v[44:47], v11, s[40:43], s6 offen offset:3072 sc0 sc1
  buffer_load_dwordx4 v[48:51], v11, s[40:43], s9 offen offset:0 sc0 sc1
  buffer_load_dwordx4 v[52:55], v11, s[40:43], s9 offen offset:1024 sc0 sc1
  buffer_load_dwordx4 v[56:59], v11, s[40:43], s9 offen offset:2048 sc0 sc1
  buffer_load_dwordx4 v[60:63], v11, s[40:43], s9 offen offset:3072 sc0 sc1
  s_waitcnt vmcnt(7)
  v_pk_add_f32 v[128:129], v[128:129], v[32:33]
  v_pk_add_f32 v[130:131], v[130:131], v[34:35]
  s_waitcnt vmcnt(6)
  v_pk_add_f32 v[132:133], v[132:133], v[36:37]
  v_pk_add_f32 v[134:135], v[134:135], v[38:39]
  s_waitcnt vmcnt(5)
  v_pk_add_f32 v[136:137], v[136:137], v[40:41]
  v_pk_add_f32 v[138:139], v[138:139], v[42:43]
  s_waitcnt vmcnt(4)
  v_pk_add_f32 v[140:141], v[140:141], v[44:45]
  v_pk_add_f32 v[142:143], v[142:143], v[46:47]
  s_waitcnt vmcnt(3)
  v_pk_add_f32 v[144:145], v[144:145], v[48:49]
  v_pk_add_f32 v[146:147], v[146:147], v[50:51]
  s_waitcnt vmcnt(2)
  v_pk_add_f32 v[148:149], v[148:149], v[52:53]
  v_pk_add_f32 v[150:151], v[150:151], v[54:55]
  s_waitcnt vmcnt(1)
  v_pk_add_f32 v[152:153], v[152:153], v[56:57]
  v_pk_add_f32 v[154:155], v[154:155], v[58:59]
  s_waitcnt vmcnt(0)
  v_pk_add_f32 v[156:157], v[156:157], v[60:61]
  v_pk_add_f32 v[158:159], v[158:159], v[62:63]
  v_cvt_pk_bf16_f32 v240, v128, v129
  v_cvt_pk_bf16_f32 v241, v130, v131
  v_cvt_pk_bf16_f32 v242, v132, v133
  v_cvt_pk_bf16_f32 v243, v134, v135
  v_cvt_pk_bf16_f32 v244, v136, v137
  v_cvt_pk_bf16_f32 v245, v138, v139
  v_cvt_pk_bf16_f32 v246, v140, v141
  v_cvt_pk_bf16_f32 v247, v142, v143
  v_cvt_pk_bf16_f32 v248, v144, v145
  v_cvt_pk_bf16_f32 v249, v146, v147
  v_cvt_pk_bf16_f32 v250, v148, v149
  v_cvt_pk_bf16_f32 v251, v150, v151
  v_cvt_pk_bf16_f32 v252, v152, v153
  v_cvt_pk_bf16_f32 v253, v154, v155
  v_cvt_pk_bf16_f32 v254, v156, v157
  v_cvt_pk_bf16_f32 v255, v158, v159
  s_cmp_lg_u32 s82, 0
  s_cbranch_scc1 L_cfinal
  s_lshl_b32 s4, s76, 5
  s_lshl_b32 s5, s78, 1
  s_add_u32 s4, s4, s5
  s_add_u32 s4, s4, s86
  s_lshl_b32 s6, s4, 13
  s_lshl_b32 s7, s85, 12
  s_add_u32 s6, s6, s7
  s_add_u32 s6, s6, s83
  s_add_u32 s6, s6, 32505856
  buffer_store_dwordx4 v[240:243], v11, s[40:43], s6 offen offset:0 sc0 sc1
  buffer_store_dwordx4 v[244:247], v11, s[40:43], s6 offen offset:1024 sc0 sc1
  buffer_store_dwordx4 v[248:251], v11, s[40:43], s6 offen offset:2048 sc0 sc1
  buffer_store_dwordx4 v[252:255], v11, s[40:43], s6 offen offset:3072 sc0 sc1
  v_mov_b32 v40, 0x3f803f80
  v_dot2_f32_bf16 v32, v240, v40, 0
  v_dot2_f32_bf16 v36, v240, v240, 0
  v_dot2_f32_bf16 v33, v244, v40, 0
  v_dot2_f32_bf16 v37, v244, v244, 0
  v_dot2_f32_bf16 v34, v248, v40, 0
  v_dot2_f32_bf16 v38, v248, v248, 0
  v_dot2_f32_bf16 v35, v252, v40, 0
  v_dot2_f32_bf16 v39, v252, v252, 0
  v_dot2_f32_bf16 v32, v241, v40, v32
  v_dot2_f32_bf16 v36, v241, v241, v36
  v_dot2_f32_bf16 v33, v245, v40, v33
  v_dot2_f32_bf16 v37, v245, v245, v37
  v_dot2_f32_bf16 v34, v249, v40, v34
  v_dot2_f32_bf16 v38, v249, v249, v38
  v_dot2_f32_bf16 v35, v253, v40, v35
  v_dot2_f32_bf16 v39, v253, v253, v39
  v_dot2_f32_bf16 v32, v242, v40, v32
  v_dot2_f32_bf16 v36, v242, v242, v36
  v_dot2_f32_bf16 v33, v246, v40, v33
  v_dot2_f32_bf16 v37, v246, v246, v37
  v_dot2_f32_bf16 v34, v250, v40, v34
  v_dot2_f32_bf16 v38, v250, v250, v38
  v_dot2_f32_bf16 v35, v254, v40, v35
  v_dot2_f32_bf16 v39, v254, v254, v39
  v_dot2_f32_bf16 v32, v243, v40, v32
  v_dot2_f32_bf16 v36, v243, v243, v36
  v_dot2_f32_bf16 v33, v247, v40, v33
  v_dot2_f32_bf16 v37, v247, v247, v37
  v_dot2_f32_bf16 v34, v251, v40, v34
  v_dot2_f32_bf16 v38, v251, v251, v38
  v_dot2_f32_bf16 v35, v255, v40, v35
  v_dot2_f32_bf16 v39, v255, v255, v39
  s_lshl_b32 s6, s76, 9
  s_lshl_b32 s7, s85, 8
  s_add_u32 s6, s6, s7
  s_add_u32 s6, s6, s5
  s_add_u32 s6, s6, s86
  s_lshl_b32 s6, s6, 6
  s_add_u32 s6, s6, s83
  s_add_u32 s6, s6, 36700160
  v_permlane32_swap_b32 v32, v34
  v_permlane32_swap_b32 v33, v35
  v_permlane32_swap_b32 v36, v38
  v_permlane32_swap_b32 v37, v39
  v_add_f32 v32, v32, v34
  v_add_f32 v33, v33, v35
  v_add_f32 v36, v36, v38
  v_add_f32 v37, v37, v39
  v_permlane16_swap_b32 v32, v33
  s_nop 0
  v_permlane16_swap_b32 v36, v37
  v_add_f32 v42, v32, v33
  v_add_f32 v43, v36, v37
  buffer_store_dwordx2 v[42:43], v30, s[40:43], s6 offen sc0 sc1
  s_add_u32 s5, s87, 512
  s_waitcnt vmcnt(0)
  s_mov_b64 exec, 1
  ds_add_rtn_u32 v2, v28, v27
  s_waitcnt lgkmcnt(0)
  v_readfirstlane_b32 s4, v2
  s_and_b32 s4, s4, 3
  s_cmp_lg_u32 s4, 3
  s_cbranch_scc1 Ls_14
  s_mov_b32 exec_lo, 0xffffffff
  buffer_store_dword v27, v24, s[40:43], s5 offen sc0 sc1
Ls_14:
  s_mov_b64 exec, -1
  s_mov_b32 s82, 1
  s_add_u32 s83, s83, 0
  s_add_u32 s87, s87, 640
  s_branch L_clayer
L_cfinal:
  s_nop 1
  v_permlane16_swap_b32 v240, v242
  v_permlane16_swap_b32 v241, v243
  v_permlane16_swap_b32 v244, v246
  v_permlane16_swap_b32 v245, v247
  v_permlane16_swap_b32 v248, v250
  v_permlane16_swap_b32 v249, v251
  v_permlane16_swap_b32 v252, v254
  v_permlane16_swap_b32 v253, v255
  v_and_b32 v2, 15, v1
  v_lshlrev_b32 v3, 12, v2
  v_and_b32 v2, 16, v1
  v_lshl_add_u32 v3, v2, 1, v3
  v_and_b32 v2, 32, v1
  v_lshrrev_b32 v2, 1, v2
  v_add_u32 v3, v2, v3
  s_lshl_b32 s5, s76, 18
  s_lshl_b32 s4, s85, 11
  s_add_u32 s5, s5, s4
  s_lshl_b32 s4, s78, 7
  s_add_u32 s5, s5, s4
  s_lshl_b32 s4, s86, 6
  s_add_u32 s5, s5, s4
  buffer_store_dwordx4 v[240:243], v3, s[64:67], s5 offen
  s_add_u32 s5, s5, 0x10000
  buffer_store_dwordx4 v[244:247], v3, s[64:67], s5 offen
  s_add_u32 s5, s5, 0x10000
  buffer_store_dwordx4 v[248:251], v3, s[64:67], s5 offen
  s_add_u32 s5, s5, 0x10000
  buffer_store_dwordx4 v[252:255], v3, s[64:67], s5 offen
  s_endpgm
L_w1:
  s_and_b32 s80, s77, 7
  s_lshr_b32 s79, s77, 3
  s_lshl_b32 s78, s80, 1
  s_add_u32 s78, s78, s79
  s_lshl_b32 s5, s76, 4
  s_add_u32 s5, s5, s77
  s_lshl_b32 s84, s5, 11
  s_mov_b32 s83, 3145728
  s_mov_b32 s87, 512
  s_lshr_b32 s86, s81, 1
  s_mov_b32 s40, s38
  s_and_b32 s41, s39, 0xffff
  s_mov_b32 s42, 100663296
  s_mov_b32 s43, 0x00020000
  s_mov_b32 s52, s20
  s_and_b32 s53, s21, 0xffff
  s_mov_b32 s54, 2097152
  s_mov_b32 s55, 0x00020000
  s_mov_b32 s56, s24
  s_and_b32 s57, s25, 0xffff
  s_mov_b32 s58, 7340032
  s_mov_b32 s59, 0x00020000
  s_mov_b32 s60, s28
  s_and_b32 s61, s29, 0xffff
  s_mov_b32 s62, 7340032
  s_mov_b32 s63, 0x00020000
  v_lshrrev_b32 v2, 3, v1
  s_movk_i32 s4, 2048
  v_mad_u32_u24 v4, v2, s4, v10
  v_add_u32 v5, 15360, v4
  v_add_u32 v6, 30720, v4
  v_add_u32 v7, 46080, v4
  s_lshl_b32 s5, s78, 7
  s_mul_i32 s4, s85, 65536
  s_add_u32 s5, s5, s4
  s_mov_b32 s8, 131072
  s_mov_b32 s10, 2097152
  s_add_u32 s9, s5, s10
  s_mul_i32 s6, s76, s8
  s_add_u32 s7, s5, s6
  s_lshl_b32 s11, s85, 12
  s_add_u32 s11, s11, 65536
  s_add_u32 s15, s11, 81920
  s_mov_b32 s12, 0
  s_mov_b32 m0, s11
Ll_19:
  s_nop 0
  buffer_load_dwordx4 v4, s[52:55], s7 offen offset:0 lds
  s_mov_b32 s5, s7
  buffer_load_dwordx4 v5, s[52:55], s5 offen offset:1024 lds
  s_add_u32 s7, s7, s8
  s_cmp_eq_u32 s7, s9
  s_cselect_b32 s4, s10, 0
  s_sub_u32 s7, s7, s4
  s_add_u32 s11, s11, 8192
  buffer_load_dwordx4 v6, s[52:55], s5 offen offset:2048 lds
  s_cmp_eq_u32 s11, s15
  s_cselect_b32 s4, 81920, 0
  s_sub_u32 s11, s11, s4
  s_add_u32 s12, s12, 1
  s_cmp_lg_u32 s12, 10
  buffer_load_dwordx4 v7, s[52:55], s5 offen offset:3072 lds
  s_mov_b32 m0, s11
  s_cbranch_scc1 Ll_19
  s_waitcnt vmcnt(36)
  s_barrier
  s_waitcnt vmcnt(32)
  s_barrier
  buffer_load_dwordx4 v4, s[52:55], s7 offen offset:0 lds
Ll_21:
  s_mov_b32 s5, s7
  buffer_load_dwordx4 v5, s[52:55], s5 offen offset:1024 lds
  s_add_u32 s7, s7, s8
  s_cmp_eq_u32 s7, s9
  s_cselect_b32 s4, s10, 0
  s_sub_u32 s7, s7, s4
  s_add_u32 s11, s11, 8192
  buffer_load_dwordx4 v6, s[52:55], s5 offen offset:2048 lds
  s_cmp_eq_u32 s11, s15
  s_cselect_b32 s4, 81920, 0
  s_sub_u32 s11, s11, s4
  s_add_u32 s12, s12, 1
  s_cmp_eq_u32 s12, 16
  buffer_load_dwordx4 v7, s[52:55], s5 offen offset:3072 lds
  s_mov_b32 m0, s11
  s_cbranch_scc1 Ll_22
  s_waitcnt vmcnt(32)
  s_barrier
  buffer_load_dwordx4 v4, s[52:55], s7 offen offset:0 lds
  s_branch Ll_21
Ll_22:
  s_waitcnt vmcnt(32)
  s_barrier
  s_waitcnt vmcnt(28)
  s_barrier
  s_waitcnt vmcnt(24)
  s_barrier
  s_waitcnt vmcnt(20)
  s_barrier
  s_waitcnt vmcnt(16)
  s_barrier
  s_waitcnt vmcnt(12)
  s_barrier
  s_waitcnt vmcnt(8)
  s_barrier
  s_waitcnt vmcnt(4)
  s_barrier
  s_waitcnt vmcnt(0)
  s_barrier
  s_barrier
  v_lshrrev_b32 v2, 3, v1
  s_movk_i32 s4, 7168
  v_mad_u32_u24 v4, v2, s4, v10
  v_add_u32 v5, 56320, v4
  v_add_u32 v6, 112640, v4
  v_add_u32 v7, 168960, v4
  v_lshrrev_b32 v2, 2, v1
  s_movk_i32 s4, 7168
  v_mul_u32_u24 v2, s4, v2
  v_and_b32 v3, 48, v10
  v_add_u32 v8, v2, v3
  v_add_u32 v9, 113664, v8
  s_mul_i32 s5, s77, 448
  s_and_b32 s4, s77, 1
  s_mul_i32 s94, s4, 448
  s_sub_u32 s94, 384, s94
  s_lshl_b32 s4, s4, 6
  s_add_u32 s5, s5, s4
  s_mul_i32 s4, s85, 229376
  s_add_u32 s5, s5, s4
  s_mov_b32 s8, 458752
  s_mov_b32 s10, 7340032
  s_add_u32 s9, s5, s10
  s_mul_i32 s6, s76, s8
  s_add_u32 s7, s5, s6
  s_lshl_b32 s11, s85, 12
  s_add_u32 s11, s11, 65536
  s_add_u32 s15, s11, 86016
  s_lshl_b32 s4, s85, 11
  s_sub_u32 s13, 24576, s4
  s_mov_b32 s12, 0
  s_mov_b32 m0, s11
Ll_23:
  s_nop 0
  buffer_load_dwordx4 v4, s[56:59], s7 offen offset:0 lds
  buffer_load_dwordx4 v5, s[56:59], s7 offen offset:1024 lds
  buffer_load_dwordx4 v6, s[56:59], s7 offen offset:2048 lds
  buffer_load_dwordx4 v7, s[56:59], s7 offen offset:3072 lds
  s_add_u32 m0, s11, s13
  s_add_u32 s5, s7, s94
  buffer_load_dwordx4 v8, s[56:59], s5 offen offset:0 lds
  buffer_load_dwordx4 v9, s[56:59], s5 offen offset:1024 lds
  s_add_u32 m0, s11, 8192
  s_add_u32 s5, s7, 128
  buffer_load_dwordx4 v4, s[56:59], s5 offen offset:0 lds
  buffer_load_dwordx4 v5, s[56:59], s5 offen offset:1024 lds
  buffer_load_dwordx4 v6, s[56:59], s5 offen offset:2048 lds
  buffer_load_dwordx4 v7, s[56:59], s5 offen offset:3072 lds
  s_add_u32 m0, s11, 16384
  s_add_u32 s5, s7, 256
  buffer_load_dwordx4 v4, s[56:59], s5 offen offset:0 lds
  s_add_u32 s7, s7, s8
  s_cmp_eq_u32 s7, s9
  s_cselect_b32 s4, s10, 0
  s_sub_u32 s7, s7, s4
  buffer_load_dwordx4 v5, s[56:59], s5 offen offset:1024 lds
  s_add_u32 s11, s11, 28672
  s_cmp_eq_u32 s11, s15
  s_cselect_b32 s4, 86016, 0
  s_sub_u32 s11, s11, s4
  buffer_load_dwordx4 v6, s[56:59], s5 offen offset:2048 lds
  s_add_u32 s12, s12, 1
  s_cmp_lg_u32 s12, 3
  buffer_load_dwordx4 v7, s[56:59], s5 offen offset:3072 lds
  s_mov_b32 m0, s11
  s_cbranch_scc1 Ll_23
  s_waitcnt vmcnt(28)
  s_barrier
  s_waitcnt vmcnt(14)
  s_barrier
  buffer_load_dwordx4 v4, s[56:59], s7 offen offset:0 lds
  buffer_load_dwordx4 v5, s[56:59], s7 offen offset:1024 lds
  buffer_load_dwordx4 v6, s[56:59], s7 offen offset:2048 lds
  buffer_load_dwordx4 v7, s[56:59], s7 offen offset:3072 lds
Ll_25:
  s_add_u32 m0, s11, s13
  s_add_u32 s5, s7, s94
  buffer_load_dwordx4 v8, s[56:59], s5 offen offset:0 lds
  buffer_load_dwordx4 v9, s[56:59], s5 offen offset:1024 lds
  s_add_u32 m0, s11, 8192
  s_add_u32 s5, s7, 128
  buffer_load_dwordx4 v4, s[56:59], s5 offen offset:0 lds
  buffer_load_dwordx4 v5, s[56:59], s5 offen offset:1024 lds
  buffer_load_dwordx4 v6, s[56:59], s5 offen offset:2048 lds
  buffer_load_dwordx4 v7, s[56:59], s5 offen offset:3072 lds
  s_add_u32 m0, s11, 16384
  s_add_u32 s5, s7, 256
  buffer_load_dwordx4 v4, s[56:59], s5 offen offset:0 lds
  s_add_u32 s7, s7, s8
  s_cmp_eq_u32 s7, s9
  s_cselect_b32 s4, s10, 0
  s_sub_u32 s7, s7, s4
  buffer_load_dwordx4 v5, s[56:59], s5 offen offset:1024 lds
  s_add_u32 s11, s11, 28672
  s_cmp_eq_u32 s11, s15
  s_cselect_b32 s4, 86016, 0
  s_sub_u32 s11, s11, s4
  buffer_load_dwordx4 v6, s[56:59], s5 offen offset:2048 lds
  s_add_u32 s12, s12, 1
  s_cmp_eq_u32 s12, 16
  buffer_load_dwordx4 v7, s[56:59], s5 offen offset:3072 lds
  s_mov_b32 m0, s11
  s_cbranch_scc1 Ll_26
  s_waitcnt vmcnt(14)
  s_barrier
  buffer_load_dwordx4 v4, s[56:59], s7 offen offset:0 lds
  buffer_load_dwordx4 v5, s[56:59], s7 offen offset:1024 lds
  buffer_load_dwordx4 v6, s[56:59], s7 offen offset:2048 lds
  buffer_load_dwordx4 v7, s[56:59], s7 offen offset:3072 lds
  s_branch Ll_25
Ll_26:
  s_waitcnt vmcnt(14)
  s_barrier
  s_waitcnt vmcnt(0)
  s_barrier
  s_barrier
  v_lshrrev_b32 v2, 3, v1
  s_movk_i32 s4, 2048
  v_mad_u32_u24 v4, v2, s4, v10
  v_add_u32 v5, 15360, v4
  v_add_u32 v6, 30720, v4
  v_add_u32 v7, 46080, v4
  s_lshl_b32 s5, s78, 7
  s_mul_i32 s4, s79, 3670016
  s_add_u32 s5, s5, s4
  s_lshl_b32 s94, s79, 8
  s_sub_u32 s94, 128, s94
  s_mul_i32 s4, s85, 65536
  s_add_u32 s5, s5, s4
  s_mov_b32 s8, 131072
  s_mov_b32 s10, 3670016
  s_add_u32 s9, s5, s10
  s_mul_i32 s6, s76, 7
  s_lshr_b32 s6, s6, 2
  s_mul_i32 s6, s6, s8
  s_add_u32 s7, s5, s6
  s_lshl_b32 s11, s85, 12
  s_add_u32 s11, s11, 65536
  s_add_u32 s15, s11, 81920
  s_mov_b32 s12, 0
  s_mov_b32 m0, s11
Ll_27:
  s_nop 0
  buffer_load_dwordx4 v4, s[60:63], s7 offen offset:0 lds
  buffer_load_dwordx4 v5, s[60:63], s7 offen offset:1024 lds
  buffer_load_dwordx4 v6, s[60:63], s7 offen offset:2048 lds
  buffer_load_dwordx4 v7, s[60:63], s7 offen offset:3072 lds
  s_add_u32 m0, s11, 8192
  s_add_u32 s5, s7, s94
  buffer_load_dwordx4 v4, s[60:63], s5 offen offset:0 lds
  s_add_u32 s7, s7, s8
  s_cmp_eq_u32 s7, s9
  s_cselect_b32 s4, s10, 0
  s_sub_u32 s7, s7, s4
  buffer_load_dwordx4 v5, s[60:63], s5 offen offset:1024 lds
  s_add_u32 s11, s11, 16384
  s_cmp_eq_u32 s11, s15
  s_cselect_b32 s4, 81920, 0
  s_sub_u32 s11, s11, s4
  buffer_load_dwordx4 v6, s[60:63], s5 offen offset:2048 lds
  s_add_u32 s12, s12, 1
  s_cmp_lg_u32 s12, 5
  buffer_load_dwordx4 v7, s[60:63], s5 offen offset:3072 lds
  s_mov_b32 m0, s11
  s_cbranch_scc1 Ll_27
  s_waitcnt vmcnt(32)
  s_barrier
  s_waitcnt vmcnt(24)
  s_barrier
  buffer_load_dwordx4 v4, s[60:63], s7 offen offset:0 lds
  buffer_load_dwordx4 v5, s[60:63], s7 offen offset:1024 lds
  buffer_load_dwordx4 v6, s[60:63], s7 offen offset:2048 lds
  buffer_load_dwordx4 v7, s[60:63], s7 offen offset:3072 lds
Ll_29:
  s_add_u32 m0, s11, 8192
  s_add_u32 s5, s7, s94
  buffer_load_dwordx4 v4, s[60:63], s5 offen offset:0 lds
  s_add_u32 s7, s7, s8
  s_cmp_eq_u32 s7, s9
  s_cselect_b32 s4, s10, 0
  s_sub_u32 s7, s7, s4
  buffer_load_dwordx4 v5, s[60:63], s5 offen offset:1024 lds
  s_add_u32 s11, s11, 16384
  s_cmp_eq_u32 s11, s15
  s_cselect_b32 s4, 81920, 0
  s_sub_u32 s11, s11, s4
  buffer_load_dwordx4 v6, s[60:63], s5 offen offset:2048 lds
  s_add_u32 s12, s12, 1
  s_cmp_eq_u32 s12, 28
  buffer_load_dwordx4 v7, s[60:63], s5 offen offset:3072 lds
  s_mov_b32 m0, s11
  s_cbranch_scc1 Ll_30
  s_waitcnt vmcnt(24)
  s_barrier
  buffer_load_dwordx4 v4, s[60:63], s7 offen offset:0 lds
  buffer_load_dwordx4 v5, s[60:63], s7 offen offset:1024 lds
  buffer_load_dwordx4 v6, s[60:63], s7 offen offset:2048 lds
  buffer_load_dwordx4 v7, s[60:63], s7 offen offset:3072 lds
  s_branch Ll_29
Ll_30:
  s_waitcnt vmcnt(24)
  s_barrier
  s_waitcnt vmcnt(16)
  s_barrier
  s_waitcnt vmcnt(8)
  s_barrier
  s_waitcnt vmcnt(0)
  s_barrier
  s_barrier
  s_cmp_lg_u32 s82, 0
  s_cbranch_scc1 L_lend
  v_lshrrev_b32 v2, 3, v1
  s_movk_i32 s4, 6144
  v_mad_u32_u24 v4, v2, s4, v10
  v_add_u32 v5, 48128, v4
  v_add_u32 v6, 96256, v4
  v_add_u32 v7, 144384, v4
  s_mov_b32 s82, 1
  s_branch L_wlayer
L_x1:
  s_cmp_lg_u32 s82, 0
  s_cbranch_scc1 L_35
  s_and_b32 s80, s77, 7
  s_lshr_b32 s79, s77, 3
  s_lshl_b32 s78, s80, 1
  s_add_u32 s78, s78, s79
  s_lshl_b32 s5, s76, 4
  s_add_u32 s5, s5, s77
  s_lshl_b32 s84, s5, 11
  s_mov_b32 s83, 3145728
  s_mov_b32 s87, 512
  s_lshr_b32 s86, s81, 1
  v_lshlrev_b32 v2, 4, v1
  v_add_u32 v4, 4096, v2
  v_add_u32 v5, 11264, v2
  v_add_u32 v6, 3072, v2
  v_add_u32 v7, 10240, v2
  s_movk_i32 s13, 2048
  s_movk_i32 s95, 4096
  v_and_b32 v2, 31, v1
  v_lshlrev_b32 v8, 2, v2
L_35:
  s_mov_b32 s40, s38
  s_and_b32 s41, s39, 0xffff
  s_mov_b32 s42, 100663296
  s_mov_b32 s43, 0x00020000
  s_mov_b32 s11, 0
  s_mov_b32 s15, 65536
  s_mul_i32 s5, s76, 32
  s_lshl_b32 s5, s5, 13
  s_add_u32 s5, s5, s83
  s_add_u32 s5, s5, 0xfffff000
  s_mov_b32 s8, 16384
  s_mov_b32 s10, 262144
  s_add_u32 s9, s5, s10
  s_mul_i32 s6, s76, s8
  s_add_u32 s7, s5, s6
  s_add_u32 s91, s84, s87
  s_mov_b32 s89, 200000
  buffer_load_dword v12, v8, s[40:43], s91 offen sc0 sc1
Lp_36:
  s_waitcnt vmcnt(0)
  v_cmp_ne_u32 vcc, 0, v12
  s_andn2_b32 s3, 0xffff, vcc_lo
  s_cbranch_scc0 Lp_37
  s_sleep 1
  buffer_load_dword v12, v8, s[40:43], s91 offen sc0 sc1
  s_sub_u32 s89, s89, 1
  s_cbranch_scc0 Lp_36
Lp_37:
  s_mov_b32 s12, 0
  s_mov_b32 m0, s11
Ll_38:
  s_nop 0
  buffer_load_dwordx4 v4, s[40:43], s7 offen offset:0 sc1 lds
  buffer_load_dwordx4 v5, s[40:43], s7 offen offset:1024 sc1 lds
  buffer_load_dwordx4 v6, s[40:43], s7 offen offset:2048 sc1 lds
  buffer_load_dwordx4 v7, s[40:43], s7 offen offset:3072 sc1 lds
  s_add_u32 m0, s11, 4096
  s_add_u32 s5, s7, s13
  buffer_load_dwordx4 v4, s[40:43], s5 offen offset:0 sc1 lds
  buffer_load_dwordx4 v5, s[40:43], s5 offen offset:1024 sc1 lds
  buffer_load_dwordx4 v6, s[40:43], s5 offen offset:2048 sc1 lds
  buffer_load_dwordx4 v7, s[40:43], s5 offen offset:3072 sc1 lds
  s_add_u32 m0, s11, 8192
  s_add_u32 s3, s7, s95
  buffer_load_dwordx4 v4, s[40:43], s3 offen offset:0 sc1 lds
  buffer_load_dwordx4 v5, s[40:43], s3 offen offset:1024 sc1 lds
  buffer_load_dwordx4 v6, s[40:43], s3 offen offset:2048 sc1 lds
  buffer_load_dwordx4 v7, s[40:43], s3 offen offset:3072 sc1 lds
  s_add_u32 m0, s11, 12288
  s_add_u32 s5, s3, s13
  buffer_load_dwordx4 v4, s[40:43], s5 offen offset:0 sc1 lds
  s_add_u32 s7, s7, s8
  s_cmp_eq_u32 s7, s9
  s_cselect_b32 s4, s10, 0
  s_sub_u32 s7, s7, s4
  buffer_load_dwordx4 v5, s[40:43], s5 offen offset:1024 sc1 lds
  s_add_u32 s11, s11, 16384
  s_cmp_eq_u32 s11, s15
  s_cselect_b32 s4, 65536, 0
  s_sub_u32 s11, s11, s4
  buffer_load_dwordx4 v6, s[40:43], s5 offen offset:2048 sc1 lds
  s_add_u32 s12, s12, 1
  s_cmp_lg_u32 s12, 3
  buffer_load_dwordx4 v7, s[40:43], s5 offen offset:3072 sc1 lds
  s_mov_b32 m0, s11
  s_cbranch_scc1 Ll_39
  s_waitcnt vmcnt(32)
  s_barrier
Ll_39:
  s_cmp_lt_u32 s12, 4
  s_cbranch_scc1 Ll_38
  s_waitcnt vmcnt(32)
  s_barrier
  buffer_load_dwordx4 v4, s[40:43], s7 offen offset:0 sc1 lds
  buffer_load_dwordx4 v5, s[40:43], s7 offen offset:1024 sc1 lds
  buffer_load_dwordx4 v6, s[40:43], s7 offen offset:2048 sc1 lds
  buffer_load_dwordx4 v7, s[40:43], s7 offen offset:3072 sc1 lds
Ll_40:
  s_add_u32 m0, s11, 4096
  s_add_u32 s5, s7, s13
  buffer_load_dwordx4 v4, s[40:43], s5 offen offset:0 sc1 lds
  buffer_load_dwordx4 v5, s[40:43], s5 offen offset:1024 sc1 lds
  buffer_load_dwordx4 v6, s[40:43], s5 offen offset:2048 sc1 lds
  buffer_load_dwordx4 v7, s[40:43], s5 offen offset:3072 sc1 lds
  s_add_u32 m0, s11, 8192
  s_add_u32 s3, s7, s95
  buffer_load_dwordx4 v4, s[40:43], s3 offen offset:0 sc1 lds
  buffer_load_dwordx4 v5, s[40:43], s3 offen offset:1024 sc1 lds
  buffer_load_dwordx4 v6, s[40:43], s3 offen offset:2048 sc1 lds
  buffer_load_dwordx4 v7, s[40:43], s3 offen offset:3072 sc1 lds
  s_add_u32 m0, s11, 12288
  s_add_u32 s5, s3, s13
  buffer_load_dwordx4 v4, s[40:43], s5 offen offset:0 sc1 lds
  s_add_u32 s7, s7, s8
  s_cmp_eq_u32 s7, s9
  s_cselect_b32 s4, s10, 0
  s_sub_u32 s7, s7, s4
  buffer_load_dwordx4 v5, s[40:43], s5 offen offset:1024 sc1 lds
  s_add_u32 s11, s11, 16384
  s_cmp_eq_u32 s11, s15
  s_cselect_b32 s4, 65536, 0
  s_sub_u32 s11, s11, s4
  buffer_load_dwordx4 v6, s[40:43], s5 offen offset:2048 sc1 lds
  s_add_u32 s12, s12, 1
  s_cmp_eq_u32 s12, 16
  buffer_load_dwordx4 v7, s[40:43], s5 offen offset:3072 sc1 lds
  s_mov_b32 m0, s11
  s_cbranch_scc1 Ll_41
  s_waitcnt vmcnt(32)
  s_barrier
  buffer_load_dwordx4 v4, s[40:43], s7 offen offset:0 sc1 lds
  buffer_load_dwordx4 v5, s[40:43], s7 offen offset:1024 sc1 lds
  buffer_load_dwordx4 v6, s[40:43], s7 offen offset:2048 sc1 lds
  buffer_load_dwordx4 v7, s[40:43], s7 offen offset:3072 sc1 lds
  s_branch Ll_40
Ll_41:
  s_waitcnt vmcnt(32)
  s_barrier
  s_waitcnt vmcnt(16)
  s_barrier
  s_waitcnt vmcnt(0)
  s_barrier
  s_barrier
  s_mov_b32 s11, 0
  s_mov_b32 s15, 65536
  s_mul_i32 s5, s76, 32
  s_lshl_b32 s5, s5, 13
  s_add_u32 s5, s5, s83
  s_add_u32 s5, s5, 0x3ff000
  s_mov_b32 s8, 16384
  s_mov_b32 s10, 262144
  s_add_u32 s9, s5, s10
  s_mul_i32 s6, s76, s8
  s_add_u32 s7, s5, s6
  s_add_u32 s91, s91, 128
  s_mov_b32 s89, 200000
  buffer_load_dword v12, v8, s[40:43], s91 offen sc0 sc1
Lp_42:
  s_waitcnt vmcnt(0)
  v_cmp_ne_u32 vcc, 0, v12
  s_andn2_b32 s3, 0xffff, vcc_lo
  s_cbranch_scc0 Lp_43
  s_sleep 1
  buffer_load_dword v12, v8, s[40:43], s91 offen sc0 sc1
  s_sub_u32 s89, s89, 1
  s_cbranch_scc0 Lp_42
Lp_43:
  s_mov_b32 s12, 0
  s_mov_b32 m0, s11
Ll_44:
  s_nop 0
  buffer_load_dwordx4 v4, s[40:43], s7 offen offset:0 sc1 lds
  buffer_load_dwordx4 v5, s[40:43], s7 offen offset:1024 sc1 lds
  buffer_load_dwordx4 v6, s[40:43], s7 offen offset:2048 sc1 lds
  buffer_load_dwordx4 v7, s[40:43], s7 offen offset:3072 sc1 lds
  s_add_u32 m0, s11, 4096
  s_add_u32 s5, s7, s13
  buffer_load_dwordx4 v4, s[40:43], s5 offen offset:0 sc1 lds
  buffer_load_dwordx4 v5, s[40:43], s5 offen offset:1024 sc1 lds
  buffer_load_dwordx4 v6, s[40:43], s5 offen offset:2048 sc1 lds
  buffer_load_dwordx4 v7, s[40:43], s5 offen offset:3072 sc1 lds
  s_add_u32 m0, s11, 8192
  s_add_u32 s3, s7, s95
  buffer_load_dwordx4 v4, s[40:43], s3 offen offset:0 sc1 lds
  buffer_load_dwordx4 v5, s[40:43], s3 offen offset:1024 sc1 lds
  buffer_load_dwordx4 v6, s[40:43], s3 offen offset:2048 sc1 lds
  buffer_load_dwordx4 v7, s[40:43], s3 offen offset:3072 sc1 lds
  s_add_u32 m0, s11, 12288
  s_add_u32 s5, s3, s13
  buffer_load_dwordx4 v4, s[40:43], s5 offen offset:0 sc1 lds
  s_add_u32 s7, s7, s8
  s_cmp_eq_u32 s7, s9
  s_cselect_b32 s4, s10, 0
  s_sub_u32 s7, s7, s4
  buffer_load_dwordx4 v5, s[40:43], s5 offen offset:1024 sc1 lds
  s_add_u32 s11, s11, 16384
  s_cmp_eq_u32 s11, s15
  s_cselect_b32 s4, 65536, 0
  s_sub_u32 s11, s11, s4
  buffer_load_dwordx4 v6, s[40:43], s5 offen offset:2048 sc1 lds
  s_add_u32 s12, s12, 1
  s_cmp_lg_u32 s12, 3
  buffer_load_dwordx4 v7, s[40:43], s5 offen offset:3072 sc1 lds
  s_mov_b32 m0, s11
  s_cbranch_scc1 Ll_45
  s_waitcnt vmcnt(32)
  s_barrier
Ll_45:
  s_cmp_lt_u32 s12, 4
  s_cbranch_scc1 Ll_44
  s_waitcnt vmcnt(32)
  s_barrier
  buffer_load_dwordx4 v4, s[40:43], s7 offen offset:0 sc1 lds
  buffer_load_dwordx4 v5, s[40:43], s7 offen offset:1024 sc1 lds
  buffer_load_dwordx4 v6, s[40:43], s7 offen offset:2048 sc1 lds
  buffer_load_dwordx4 v7, s[40:43], s7 offen offset:3072 sc1 lds
Ll_46:
  s_add_u32 m0, s11, 4096
  s_add_u32 s5, s7, s13
  buffer_load_dwordx4 v4, s[40:43], s5 offen offset:0 sc1 lds
  buffer_load_dwordx4 v5, s[40:43], s5 offen offset:1024 sc1 lds
  buffer_load_dwordx4 v6, s[40:43], s5 offen offset:2048 sc1 lds
  buffer_load_dwordx4 v7, s[40:43], s5 offen offset:3072 sc1 lds
  s_add_u32 m0, s11, 8192
  s_add_u32 s3, s7, s95
  buffer_load_dwordx4 v4, s[40:43], s3 offen offset:0 sc1 lds
  buffer_load_dwordx4 v5, s[40:43], s3 offen offset:1024 sc1 lds
  buffer_load_dwordx4 v6, s[40:43], s3 offen offset:2048 sc1 lds
  buffer_load_dwordx4 v7, s[40:43], s3 offen offset:3072 sc1 lds
  s_add_u32 m0, s11, 12288
  s_add_u32 s5, s3, s13
  buffer_load_dwordx4 v4, s[40:43], s5 offen offset:0 sc1 lds
  s_add_u32 s7, s7, s8
  s_cmp_eq_u32 s7, s9
  s_cselect_b32 s4, s10, 0
  s_sub_u32 s7, s7, s4
  buffer_load_dwordx4 v5, s[40:43], s5 offen offset:1024 sc1 lds
  s_add_u32 s11, s11, 16384
  s_cmp_eq_u32 s11, s15
  s_cselect_b32 s4, 65536, 0
  s_sub_u32 s11, s11, s4
  buffer_load_dwordx4 v6, s[40:43], s5 offen offset:2048 sc1 lds
  s_add_u32 s12, s12, 1
  s_cmp_eq_u32 s12, 16
  buffer_load_dwordx4 v7, s[40:43], s5 offen offset:3072 sc1 lds
  s_mov_b32 m0, s11
  s_cbranch_scc1 Ll_47
  s_waitcnt vmcnt(32)
  s_barrier
  buffer_load_dwordx4 v4, s[40:43], s7 offen offset:0 sc1 lds
  buffer_load_dwordx4 v5, s[40:43], s7 offen offset:1024 sc1 lds
  buffer_load_dwordx4 v6, s[40:43], s7 offen offset:2048 sc1 lds
  buffer_load_dwordx4 v7, s[40:43], s7 offen offset:3072 sc1 lds
  s_branch Ll_46
Ll_47:
  s_waitcnt vmcnt(32)
  s_barrier
  s_waitcnt vmcnt(16)
  s_barrier
  s_waitcnt vmcnt(0)
  s_barrier
  s_barrier
  s_mov_b32 s11, 0
  s_mov_b32 s15, 65536
  s_mul_i32 s5, s76, 112
  s_mul_i32 s4, s79, 56
  s_add_u32 s5, s5, s4
  s_lshl_b32 s5, s5, 13
  s_add_u32 s5, s5, s83
  s_add_u32 s5, s5, 0x7ff000
  s_mov_b32 s8, 16384
  s_mov_b32 s10, 458752
  s_add_u32 s9, s5, s10
  s_mul_i32 s6, s76, 7
  s_lshr_b32 s6, s6, 2
  s_mul_i32 s6, s6, s8
  s_add_u32 s7, s5, s6
  s_add_u32 s91, s91, 128
  s_lshl_b32 s4, s79, 3
  s_lshl_b32 s90, 0xff, s4
  s_mov_b32 s89, 200000
  buffer_load_dword v12, v8, s[40:43], s91 offen sc0 sc1
Lp_48:
  s_waitcnt vmcnt(0)
  v_cmp_ne_u32 vcc, 0, v12
  s_andn2_b32 s3, s90, vcc_lo
  s_cbranch_scc0 Lp_49
  s_sleep 1
  buffer_load_dword v12, v8, s[40:43], s91 offen sc0 sc1
  s_sub_u32 s89, s89, 1
  s_cbranch_scc0 Lp_48
Lp_49:
  s_mov_b32 s12, 0
  s_mov_b32 m0, s11
Ll_50:
  s_nop 0
  buffer_load_dwordx4 v4, s[40:43], s7 offen offset:0 sc1 lds
  buffer_load_dwordx4 v5, s[40:43], s7 offen offset:1024 sc1 lds
  buffer_load_dwordx4 v6, s[40:43], s7 offen offset:2048 sc1 lds
  buffer_load_dwordx4 v7, s[40:43], s7 offen offset:3072 sc1 lds
  s_add_u32 m0, s11, 4096
  s_add_u32 s5, s7, s13
  buffer_load_dwordx4 v4, s[40:43], s5 offen offset:0 sc1 lds
  buffer_load_dwordx4 v5, s[40:43], s5 offen offset:1024 sc1 lds
  buffer_load_dwordx4 v6, s[40:43], s5 offen offset:2048 sc1 lds
  buffer_load_dwordx4 v7, s[40:43], s5 offen offset:3072 sc1 lds
  s_add_u32 m0, s11, 8192
  s_add_u32 s3, s7, s95
  buffer_load_dwordx4 v4, s[40:43], s3 offen offset:0 sc1 lds
  buffer_load_dwordx4 v5, s[40:43], s3 offen offset:1024 sc1 lds
  buffer_load_dwordx4 v6, s[40:43], s3 offen offset:2048 sc1 lds
  buffer_load_dwordx4 v7, s[40:43], s3 offen offset:3072 sc1 lds
  s_add_u32 m0, s11, 12288
  s_add_u32 s5, s3, s13
  buffer_load_dwordx4 v4, s[40:43], s5 offen offset:0 sc1 lds
  s_add_u32 s7, s7, s8
  s_cmp_eq_u32 s7, s9
  s_cselect_b32 s4, s10, 0
  s_sub_u32 s7, s7, s4
  buffer_load_dwordx4 v5, s[40:43], s5 offen offset:1024 sc1 lds
  s_add_u32 s11, s11, 16384
  s_cmp_eq_u32 s11, s15
  s_cselect_b32 s4, 65536, 0
  s_sub_u32 s11, s11, s4
  buffer_load_dwordx4 v6, s[40:43], s5 offen offset:2048 sc1 lds
  s_add_u32 s12, s12, 1
  s_cmp_lg_u32 s12, 3
  buffer_load_dwordx4 v7, s[40:43], s5 offen offset:3072 sc1 lds
  s_mov_b32 m0, s11
  s_cbranch_scc1 Ll_51
  s_waitcnt vmcnt(32)
  s_barrier
Ll_51:
  s_cmp_lt_u32 s12, 4
  s_cbranch_scc1 Ll_50
  s_waitcnt vmcnt(32)
  s_barrier
  buffer_load_dwordx4 v4, s[40:43], s7 offen offset:0 sc1 lds
  buffer_load_dwordx4 v5, s[40:43], s7 offen offset:1024 sc1 lds
  buffer_load_dwordx4 v6, s[40:43], s7 offen offset:2048 sc1 lds
  buffer_load_dwordx4 v7, s[40:43], s7 offen offset:3072 sc1 lds
Ll_52:
  s_add_u32 m0, s11, 4096
  s_add_u32 s5, s7, s13
  buffer_load_dwordx4 v4, s[40:43], s5 offen offset:0 sc1 lds
  buffer_load_dwordx4 v5, s[40:43], s5 offen offset:1024 sc1 lds
  buffer_load_dwordx4 v6, s[40:43], s5 offen offset:2048 sc1 lds
  buffer_load_dwordx4 v7, s[40:43], s5 offen offset:3072 sc1 lds
  s_add_u32 m0, s11, 8192
  s_add_u32 s3, s7, s95
  buffer_load_dwordx4 v4, s[40:43], s3 offen offset:0 sc1 lds
  buffer_load_dwordx4 v5, s[40:43], s3 offen offset:1024 sc1 lds
  buffer_load_dwordx4 v6, s[40:43], s3 offen offset:2048 sc1 lds
  buffer_load_dwordx4 v7, s[40:43], s3 offen offset:3072 sc1 lds
  s_add_u32 m0, s11, 12288
  s_add_u32 s5, s3, s13
  buffer_load_dwordx4 v4, s[40:43], s5 offen offset:0 sc1 lds
  s_add_u32 s7, s7, s8
  s_cmp_eq_u32 s7, s9
  s_cselect_b32 s4, s10, 0
  s_sub_u32 s7, s7, s4
  buffer_load_dwordx4 v5, s[40:43], s5 offen offset:1024 sc1 lds
  s_add_u32 s11, s11, 16384
  s_cmp_eq_u32 s11, s15
  s_cselect_b32 s4, 65536, 0
  s_sub_u32 s11, s11, s4
  buffer_load_dwordx4 v6, s[40:43], s5 offen offset:2048 sc1 lds
  s_add_u32 s12, s12, 1
  s_cmp_eq_u32 s12, 28
  buffer_load_dwordx4 v7, s[40:43], s5 offen offset:3072 sc1 lds
  s_mov_b32 m0, s11
  s_cbranch_scc1 Ll_53
  s_waitcnt vmcnt(32)
  s_barrier
  buffer_load_dwordx4 v4, s[40:43], s7 offen offset:0 sc1 lds
  buffer_load_dwordx4 v5, s[40:43], s7 offen offset:1024 sc1 lds
  buffer_load_dwordx4 v6, s[40:43], s7 offen offset:2048 sc1 lds
  buffer_load_dwordx4 v7, s[40:43], s7 offen offset:3072 sc1 lds
  s_branch Ll_52
Ll_53:
  s_waitcnt vmcnt(32)
  s_barrier
  s_waitcnt vmcnt(16)
  s_barrier
  s_waitcnt vmcnt(0)
  s_barrier
  s_barrier
  s_cmp_lg_u32 s82, 0
  s_cbranch_scc1 L_lend
  s_mov_b32 s72, s40
  s_mov_b32 s73, s41
  s_mov_b32 s74, s42
  s_mul_i32 s5, s76, 32
  s_lshl_b32 s5, s5, 13
  s_add_u32 s5, s5, s83
  s_add_u32 s5, s5, 0x1eff000
  s_mov_b32 s8, 16384
  s_mov_b32 s10, 262144
  s_add_u32 s9, s5, s10
  s_mul_i32 s6, s76, 11
  s_lshr_b32 s6, s6, 5
  s_mul_i32 s6, s6, 49152
  s_add_u32 s7, s5, s6
  s_mov_b32 s14, 0xfffc0c00
  s_add_u32 s91, s91, 256
  s_cmp_eq_u32 s76, 0
  s_cselect_b32 s90, 0xffff, -1
  s_mov_b32 s82, 1
  s_add_u32 s83, s83, 0
  s_add_u32 s87, s87, 640
  s_mov_b32 s89, 200000
  buffer_load_dword v12, v8, s[40:43], s91 offen sc0 sc1
Lp_54:
  s_waitcnt vmcnt(0)
  v_cmp_ne_u32 vcc, 0, v12
  s_andn2_b32 s3, s90, vcc_lo
  s_cbranch_scc0 Lp_55
  s_sleep 1
  buffer_load_dword v12, v8, s[40:43], s91 offen sc0 sc1
  s_sub_u32 s89, s89, 1
  s_cbranch_scc0 Lp_54
Lp_55:
  s_branch L_xlayer
L_s1:
  v_mov_b32 v11, 1
  v_and_b32 v2, 31, v1
  v_lshlrev_b32 v5, 2, v2
  v_lshlrev_b32 v10, 3, v2
  v_lshrrev_b32 v3, 5, v1
  v_mul_u32_u24 v3, 320, v3
  v_add_u32 v10, v3, v10
  v_add_u32 v10, 151552, v10
  v_bfe_u32 v3, v1, 3, 1
  v_and_b32 v2, 7, v1
  v_lshlrev_b32 v12, 9, v3
  v_lshl_add_u32 v12, v2, 4, v12
  v_mul_u32_u24 v3, 320, v3
  v_lshl_add_u32 v13, v2, 3, v3
  v_add_u32 v13, 151808, v13
  v_and_b32 v2, 15, v1
  v_lshlrev_b32 v8, 4, v2
  v_lshlrev_b32 v15, 6, v2
  v_and_b32 v3, 48, v1
  v_add_u32 v15, v15, v3
  v_and_b32 v2, 14, v1
  v_lshlrev_b32 v6, 2, v2
  v_lshlrev_b32 v14, 15, v1
  s_lshl_b32 s4, s77, 11
  s_lshl_b32 s5, s76, 2
  s_add_u32 s4, s4, s5
  v_add_u32 v14, s4, v14
  v_lshrrev_b32 v2, 2, v1
  v_lshlrev_b32 v22, 7, v2
  v_lshlrev_b32 v96, 6, v2
  v_and_b32 v2, 3, v1
  v_lshl_add_u32 v22, v2, 3, v22
  v_lshl_add_u32 v96, v2, 3, v96
  v_add_u32 v22, 65536, v22
  v_add_u32 v96, 90112, v96
  v_bfe_u32 v3, v1, 3, 2
  v_xor_b32 v2, 0, v3
  v_lshl_add_u32 v16, v2, 5, v22
  v_xor_b32 v2, 1, v3
  v_lshl_add_u32 v17, v2, 5, v22
  v_xor_b32 v2, 2, v3
  v_lshl_add_u32 v18, v2, 5, v22
  v_xor_b32 v2, 3, v3
  v_lshl_add_u32 v19, v2, 5, v22
  v_bfe_u32 v3, v1, 4, 1
  v_xor_b32 v2, 0, v3
  v_lshl_add_u32 v20, v2, 5, v96
  v_xor_b32 v2, 1, v3
  v_lshl_add_u32 v21, v2, 5, v96
  v_mov_b32 v22, 0x3f803f80
  s_mul_i32 s4, s76, 11
  s_lshr_b32 s4, s4, 5
  s_mul_i32 s4, s4, 3
  s_sub_u32 s14, s76, s4
  s_mov_b32 s15, 32768
  s_mul_i32 s4, s14, 24576
  v_add_u32 v16, s4, v16
  v_add_u32 v17, s4, v17
  v_add_u32 v18, s4, v18
  v_add_u32 v19, s4, v19
  s_mov_b32 s98, 0x00010001
  s_mov_b32 s99, 0x00010001
  v_cndmask_b32_e64 v200, 0, v22, s[98:99]
  v_cndmask_b32_e64 v201, 0, v22, s[98:99]
  v_cndmask_b32_e64 v202, 0, v22, s[98:99]
  v_cndmask_b32_e64 v203, 0, v22, s[98:99]
  s_lshl_b64 s[98:99], s[98:99], 1
  v_cndmask_b32_e64 v204, 0, v22, s[98:99]
  v_cndmask_b32_e64 v205, 0, v22, s[98:99]
  v_cndmask_b32_e64 v206, 0, v22, s[98:99]
  v_cndmask_b32_e64 v207, 0, v22, s[98:99]
  s_lshl_b64 s[98:99], s[98:99], 1
  v_cndmask_b32_e64 v208, 0, v22, s[98:99]
  v_cndmask_b32_e64 v209, 0, v22, s[98:99]
  v_cndmask_b32_e64 v210, 0, v22, s[98:99]
  v_cndmask_b32_e64 v211, 0, v22, s[98:99]
  s_lshl_b64 s[98:99], s[98:99], 1
  v_cndmask_b32_e64 v212, 0, v22, s[98:99]
  v_cndmask_b32_e64 v213, 0, v22, s[98:99]
  v_cndmask_b32_e64 v214, 0, v22, s[98:99]
  v_cndmask_b32_e64 v215, 0, v22, s[98:99]
  s_lshl_b64 s[98:99], s[98:99], 1
  v_cndmask_b32_e64 v216, 0, v22, s[98:99]
  v_cndmask_b32_e64 v217, 0, v22, s[98:99]
  v_cndmask_b32_e64 v218, 0, v22, s[98:99]
  v_cndmask_b32_e64 v219, 0, v22, s[98:99]
  s_lshl_b64 s[98:99], s[98:99], 1
  v_cndmask_b32_e64 v220, 0, v22, s[98:99]
  v_cndmask_b32_e64 v221, 0, v22, s[98:99]
  v_cndmask_b32_e64 v222, 0, v22, s[98:99]
  v_cndmask_b32_e64 v223, 0, v22, s[98:99]
  s_lshl_b64 s[98:99], s[98:99], 1
  v_cndmask_b32_e64 v224, 0, v22, s[98:99]
  v_cndmask_b32_e64 v225, 0, v22, s[98:99]
  v_cndmask_b32_e64 v226, 0, v22, s[98:99]
  v_cndmask_b32_e64 v227, 0, v22, s[98:99]
  s_lshl_b64 s[98:99], s[98:99], 1
  v_cndmask_b32_e64 v228, 0, v22, s[98:99]
  v_cndmask_b32_e64 v229, 0, v22, s[98:99]
  v_cndmask_b32_e64 v230, 0, v22, s[98:99]
  v_cndmask_b32_e64 v231, 0, v22, s[98:99]
  s_lshl_b64 s[98:99], s[98:99], 1
  v_cndmask_b32_e64 v232, 0, v22, s[98:99]
  v_cndmask_b32_e64 v233, 0, v22, s[98:99]
  v_cndmask_b32_e64 v234, 0, v22, s[98:99]
  v_cndmask_b32_e64 v235, 0, v22, s[98:99]
  s_lshl_b64 s[98:99], s[98:99], 1
  v_cndmask_b32_e64 v236, 0, v22, s[98:99]
  v_cndmask_b32_e64 v237, 0, v22, s[98:99]
  v_cndmask_b32_e64 v238, 0, v22, s[98:99]
  v_cndmask_b32_e64 v239, 0, v22, s[98:99]
  s_lshl_b64 s[98:99], s[98:99], 1
  v_cndmask_b32_e64 v240, 0, v22, s[98:99]
  v_cndmask_b32_e64 v241, 0, v22, s[98:99]
  v_cndmask_b32_e64 v242, 0, v22, s[98:99]
  v_cndmask_b32_e64 v243, 0, v22, s[98:99]
  s_lshl_b64 s[98:99], s[98:99], 1
  v_cndmask_b32_e64 v244, 0, v22, s[98:99]
  v_cndmask_b32_e64 v245, 0, v22, s[98:99]
  v_cndmask_b32_e64 v246, 0, v22, s[98:99]
  v_cndmask_b32_e64 v247, 0, v22, s[98:99]
  s_lshl_b64 s[98:99], s[98:99], 1
  s_mov_b32 s56, s24
  s_and_b32 s57, s25, 0xffff
  s_mov_b32 s58, 7340032
  s_mov_b32 s59, 0x00020000
  s_mov_b32 s60, s28
  s_and_b32 s61, s29, 0xffff
  s_mov_b32 s62, 7340032
  s_mov_b32 s63, 0x00020000
  s_mul_i32 s12, s76, 458752
  s_mul_i32 s5, s77, 448
  s_andn2_b32 s5, s5, 127
  s_add_u32 s12, s12, s5
  v_lshrrev_b32 v2, 2, v1
  v_mul_u32_u24 v2, 7168, v2
  v_and_b32 v3, 3, v1
  v_lshl_add_u32 v110, v3, 7, v2
  s_mul_i32 s4, s76, 112
  s_mul_i32 s5, s79, 1792
  s_add_u32 s4, s4, s5
  s_lshl_b32 s4, s4, 11
  s_lshl_b32 s5, s80, 8
  s_add_u32 s13, s4, s5
  v_lshrrev_b32 v2, 1, v1
  v_lshlrev_b32 v2, 11, v2
  v_and_b32 v3, 1, v1
  v_lshl_add_u32 v111, v3, 7, v2
  s_mov_b32 s8, 0x00500005
  s_mov_b32 s9, 0x50000500
L_slayer:
  s_cmp_eq_u32 s76, 0
  s_mov_b32 s11, 0xfffffd80
  s_cselect_b32 s11, 0x70000000, s11
  s_cselect_b32 s90, 1, 0
  s_barrier
  s_cmp_lg_u32 s82, 0
  s_cbranch_scc1 L_56
  buffer_load_dwordx4 v[128:131], v108, s[44:47], s7 offen offset:0
  buffer_load_dwordx4 v[132:135], v108, s[44:47], s7 offen offset:128
  buffer_load_dwordx4 v[136:139], v108, s[44:47], s7 offen offset:256
  buffer_load_dwordx4 v[140:143], v108, s[44:47], s7 offen offset:384
  buffer_load_dwordx4 v[144:147], v108, s[44:47], s7 offen offset:512
  buffer_load_dwordx4 v[148:151], v108, s[44:47], s7 offen offset:640
  buffer_load_dwordx4 v[152:155], v108, s[44:47], s7 offen offset:768
  buffer_load_dwordx4 v[156:159], v108, s[44:47], s7 offen offset:896
  buffer_load_dwordx4 v[160:163], v108, s[44:47], s7 offen offset:1024
  buffer_load_dwordx4 v[164:167], v108, s[44:47], s7 offen offset:1152
  buffer_load_dwordx4 v[168:171], v108, s[44:47], s7 offen offset:1280
  buffer_load_dwordx4 v[172:175], v108, s[44:47], s7 offen offset:1408
  buffer_load_dwordx4 v[176:179], v108, s[44:47], s7 offen offset:1536
  buffer_load_dwordx4 v[180:183], v108, s[44:47], s7 offen offset:1664
  buffer_load_dwordx4 v[184:187], v108, s[44:47], s7 offen offset:1792
  buffer_load_dwordx4 v[188:191], v108, s[44:47], s7 offen offset:1920
  s_waitcnt vmcnt(16)
  s_lshl_b32 s4, s76, 4
  s_mov_b64 exec, 1
  buffer_atomic_add v11, v24, s[68:71], s4 offen sc1
  s_mov_b64 exec, -1
  s_branch L_57
L_56:
  s_add_u32 s5, s84, s92
  buffer_load_dwordx2 v[96:97], v6, s[40:43], s5 offen offset:0 sc1
  buffer_load_dwordx2 v[98:99], v6, s[40:43], s5 offen offset:512 sc1
  buffer_load_dwordx2 v[100:101], v6, s[40:43], s5 offen offset:1024 sc1
  buffer_load_dwordx2 v[102:103], v6, s[40:43], s5 offen offset:1536 sc1
L_57:
  s_cmp_le_u32 s14, 0
  s_cbranch_scc1 L_58
  s_barrier
L_58:
  s_cmp_le_u32 s14, 1
  s_cbranch_scc1 L_59
  s_barrier
L_59:
  s_cmp_lg_u32 s82, 0
  s_cbranch_scc1 L_60
  ds_read_b64_tr_b16 v[32:33], v16 offset:0
  ds_read_b64_tr_b16 v[34:35], v16 offset:2048
  ds_read_b64_tr_b16 v[36:37], v17 offset:0
  ds_read_b64_tr_b16 v[38:39], v17 offset:2048
  ds_read_b64_tr_b16 v[40:41], v18 offset:0
  ds_read_b64_tr_b16 v[42:43], v18 offset:2048
  ds_read_b64_tr_b16 v[44:45], v19 offset:0
  ds_read_b64_tr_b16 v[46:47], v19 offset:2048
  ds_read_b64_tr_b16 v[48:49], v16 offset:4096
  ds_read_b64_tr_b16 v[50:51], v16 offset:6144
  ds_read_b64_tr_b16 v[52:53], v17 offset:4096
  ds_read_b64_tr_b16 v[54:55], v17 offset:6144
  s_waitcnt lgkmcnt(4)
  ds_read_b64_tr_b16 v[56:57], v18 offset:4096
  ds_read_b64_tr_b16 v[58:59], v18 offset:6144
  ds_read_b64_tr_b16 v[60:61], v19 offset:4096
  ds_read_b64_tr_b16 v[62:63], v19 offset:6144
  s_cmp_eq_u32 s14, 2
  s_cselect_b32 s4, 0xffff6000, s15
  v_add_u32 v16, s4, v16
  v_add_u32 v17, s4, v17
  v_add_u32 v18, s4, v18
  v_add_u32 v19, s4, v19
  s_waitcnt lgkmcnt(0)
L_60:
  s_barrier
  s_cmp_lg_u32 s82, 0
  s_cbranch_scc1 L_62
  ds_read_b64_tr_b16 v[64:65], v16 offset:0
  ds_read_b64_tr_b16 v[66:67], v16 offset:2048
  ds_read_b64_tr_b16 v[68:69], v17 offset:0
  ds_read_b64_tr_b16 v[70:71], v17 offset:2048
  ds_read_b64_tr_b16 v[72:73], v18 offset:0
  ds_read_b64_tr_b16 v[74:75], v18 offset:2048
  ds_read_b64_tr_b16 v[76:77], v19 offset:0
  ds_read_b64_tr_b16 v[78:79], v19 offset:2048
  ds_read_b64_tr_b16 v[80:81], v16 offset:4096
  ds_read_b64_tr_b16 v[82:83], v16 offset:6144
  ds_read_b64_tr_b16 v[84:85], v17 offset:4096
  ds_read_b64_tr_b16 v[86:87], v17 offset:6144
  s_waitcnt lgkmcnt(4)
  ds_read_b64_tr_b16 v[88:89], v18 offset:4096
  ds_read_b64_tr_b16 v[90:91], v18 offset:6144
  ds_read_b64_tr_b16 v[92:93], v19 offset:4096
  ds_read_b64_tr_b16 v[94:95], v19 offset:6144
  s_cmp_eq_u32 s14, 1
  s_cselect_b32 s4, 0xffff6000, s15
  v_add_u32 v16, s4, v16
  v_add_u32 v17, s4, v17
  v_add_u32 v18, s4, v18
  v_add_u32 v19, s4, v19
  v_mfma_f32_16x16x32_bf16 v[28:31], v[32:35], v[200:203], 0
  v_mfma_f32_16x16x32_bf16 v[28:31], v[36:39], v[204:207], v[28:31]
  v_mfma_f32_16x16x32_bf16 v[28:31], v[40:43], v[208:211], v[28:31]
  v_mfma_f32_16x16x32_bf16 v[28:31], v[44:47], v[212:215], v[28:31]
  v_mfma_f32_16x16x32_bf16 v[28:31], v[48:51], v[200:203], v[28:31]
  v_mfma_f32_16x16x32_bf16 v[28:31], v[52:55], v[204:207], v[28:31]
  v_mfma_f32_16x16x32_bf16 v[28:31], v[56:59], v[208:211], v[28:31]
  v_mfma_f32_16x16x32_bf16 v[28:31], v[60:63], v[212:215], v[28:31]
  s_waitcnt lgkmcnt(0)
L_62:
  s_barrier
  s_cmp_lg_u32 s82, 0
  s_cbranch_scc1 L_64
  ds_read_b64_tr_b16 v[32:33], v16 offset:0
  ds_read_b64_tr_b16 v[34:35], v16 offset:2048
  ds_read_b64_tr_b16 v[36:37], v17 offset:0
  ds_read_b64_tr_b16 v[38:39], v17 offset:2048
  ds_read_b64_tr_b16 v[40:41], v18 offset:0
  ds_read_b64_tr_b16 v[42:43], v18 offset:2048
  ds_read_b64_tr_b16 v[44:45], v19 offset:0
  ds_read_b64_tr_b16 v[46:47], v19 offset:2048
  ds_read_b64_tr_b16 v[48:49], v16 offset:4096
  ds_read_b64_tr_b16 v[50:51], v16 offset:6144
  ds_read_b64_tr_b16 v[52:53], v17 offset:4096
  ds_read_b64_tr_b16 v[54:55], v17 offset:6144
  s_waitcnt lgkmcnt(4)
  ds_read_b64_tr_b16 v[56:57], v18 offset:4096
  ds_read_b64_tr_b16 v[58:59], v18 offset:6144
  ds_read_b64_tr_b16 v[60:61], v19 offset:4096
  ds_read_b64_tr_b16 v[62:63], v19 offset:6144
  v_mfma_f32_16x16x32_bf16 v[28:31], v[64:67], v[216:219], v[28:31]
  v_mfma_f32_16x16x32_bf16 v[28:31], v[68:71], v[220:223], v[28:31]
  v_mfma_f32_16x16x32_bf16 v[28:31], v[72:75], v[224:227], v[28:31]
  v_mfma_f32_16x16x32_bf16 v[28:31], v[76:79], v[228:231], v[28:31]
  v_mfma_f32_16x16x32_bf16 v[28:31], v[80:83], v[216:219], v[28:31]
  v_mfma_f32_16x16x32_bf16 v[28:31], v[84:87], v[220:223], v[28:31]
  v_mfma_f32_16x16x32_bf16 v[28:31], v[88:91], v[224:227], v[28:31]
  v_mfma_f32_16x16x32_bf16 v[28:31], v[92:95], v[228:231], v[28:31]
  s_waitcnt lgkmcnt(0)
L_64:
  s_barrier
  s_cmp_lg_u32 s82, 0
  s_cbranch_scc1 L_66
  v_mfma_f32_16x16x32_bf16 v[28:31], v[32:35], v[232:235], v[28:31]
  v_mfma_f32_16x16x32_bf16 v[28:31], v[36:39], v[236:239], v[28:31]
  v_mfma_f32_16x16x32_bf16 v[28:31], v[40:43], v[240:243], v[28:31]
  v_mfma_f32_16x16x32_bf16 v[28:31], v[44:47], v[244:247], v[28:31]
  v_mfma_f32_16x16x32_bf16 v[28:31], v[48:51], v[232:235], v[28:31]
  v_mfma_f32_16x16x32_bf16 v[28:31], v[52:55], v[236:239], v[28:31]
  v_mfma_f32_16x16x32_bf16 v[28:31], v[56:59], v[240:243], v[28:31]
  v_mfma_f32_16x16x32_bf16 v[28:31], v[60:63], v[244:247], v[28:31]
  s_lshl_b32 s5, s77, 14
  s_lshl_b32 s4, s76, 10
  s_add_u32 s5, s5, s4
  s_add_u32 s5, s5, 589824
  s_nop 3
  buffer_store_dwordx4 v[28:31], v15, s[40:43], s5 offen sc0 sc1
L_66:
  s_cmp_gt_u32 s14, 0
  s_cbranch_scc1 L_68
  s_barrier
L_68:
  s_cmp_gt_u32 s14, 1
  s_cbranch_scc1 L_69
  s_barrier
L_69:
  s_cmp_lg_u32 s82, 0
  s_cbranch_scc1 L_70
  s_waitcnt vmcnt(2)
  buffer_load_dword v9, v8, s[68:71], 0 offen sc0 sc1
  s_mov_b32 s72, s26
  s_and_b32 s73, s27, 0xffff
  s_mov_b32 s74, 7168
  s_mov_b32 s75, 0x00020000
  s_mul_i32 s4, s77, 448
  s_and_b32 s5, s77, 1
  s_lshl_b32 s6, s5, 6
  s_add_u32 s6, s6, s4
  s_mul_i32 s5, s5, 384
  s_sub_u32 s5, s4, s5
  v_lshlrev_b32 v2, 1, v1
  buffer_load_ushort v104, v2, s[72:75], s6 offen offset:0
  buffer_load_ushort v105, v2, s[72:75], s6 offen offset:128
  buffer_load_ushort v106, v2, s[72:75], s6 offen offset:256
  buffer_load_ushort v107, v2, s[72:75], s5 offen offset:384
  s_mov_b32 s64, s30
  s_and_b32 s65, s31, 0xffff
  s_mov_b32 s66, 2048
  s_mov_b32 s67, 0x00020000
  s_lshl_b32 s4, s78, 7
  buffer_load_ushort v108, v2, s[64:67], s4 offen
  s_mov_b32 s52, s20
  s_and_b32 s53, s21, 0xffff
  s_mov_b32 s54, 2097152
  s_mov_b32 s55, 0x00020000
  s_lshl_b32 s4, s76, 17
  s_lshl_b32 s5, s78, 7
  s_add_u32 s4, s4, s5
  v_lshlrev_b32 v2, 11, v1
  buffer_load_dword v109, v2, s[52:55], s4 offen
  v_mov_b32 v32, v22
  v_mov_b32 v33, v22
  v_mov_b32 v34, v22
  v_mov_b32 v35, v22
  s_nop 1
  v_mfma_f32_16x16x32_bf16 v[96:99], v[32:35], v[128:131], 0
  v_mfma_f32_16x16x32_bf16 v[100:103], v[128:131], v[128:131], 0
  v_mfma_f32_16x16x32_bf16 v[96:99], v[32:35], v[132:135], v[96:99]
  v_mfma_f32_16x16x32_bf16 v[100:103], v[132:135], v[132:135], v[100:103]
  v_mfma_f32_16x16x32_bf16 v[96:99], v[32:35], v[136:139], v[96:99]
  v_mfma_f32_16x16x32_bf16 v[100:103], v[136:139], v[136:139], v[100:103]
  v_mfma_f32_16x16x32_bf16 v[96:99], v[32:35], v[140:143], v[96:99]
  v_mfma_f32_16x16x32_bf16 v[100:103], v[140:143], v[140:143], v[100:103]
L_70:
  s_barrier
  s_cmp_lg_u32 s82, 0
  s_cbranch_scc1 L_72
  v_mfma_f32_16x16x32_bf16 v[96:99], v[32:35], v[144:147], v[96:99]
  v_mfma_f32_16x16x32_bf16 v[100:103], v[144:147], v[144:147], v[100:103]
  v_mfma_f32_16x16x32_bf16 v[96:99], v[32:35], v[148:151], v[96:99]
  v_mfma_f32_16x16x32_bf16 v[100:103], v[148:151], v[148:151], v[100:103]
  v_mfma_f32_16x16x32_bf16 v[96:99], v[32:35], v[152:155], v[96:99]
  v_mfma_f32_16x16x32_bf16 v[100:103], v[152:155], v[152:155], v[100:103]
  v_mfma_f32_16x16x32_bf16 v[96:99], v[32:35], v[156:159], v[96:99]
  v_mfma_f32_16x16x32_bf16 v[100:103], v[156:159], v[156:159], v[100:103]
L_72:
  s_barrier
  s_cmp_lg_u32 s82, 0
  s_cbranch_scc1 L_74
  v_mfma_f32_16x16x32_bf16 v[96:99], v[32:35], v[160:163], v[96:99]
  v_mfma_f32_16x16x32_bf16 v[100:103], v[160:163], v[160:163], v[100:103]
  v_mfma_f32_16x16x32_bf16 v[96:99], v[32:35], v[164:167], v[96:99]
  v_mfma_f32_16x16x32_bf16 v[100:103], v[164:167], v[164:167], v[100:103]
  v_mfma_f32_16x16x32_bf16 v[96:99], v[32:35], v[168:171], v[96:99]
  v_mfma_f32_16x16x32_bf16 v[100:103], v[168:171], v[168:171], v[100:103]
  v_mfma_f32_16x16x32_bf16 v[96:99], v[32:35], v[172:175], v[96:99]
  v_mfma_f32_16x16x32_bf16 v[100:103], v[172:175], v[172:175], v[100:103]
  s_waitcnt vmcnt(0)
  v_lshlrev_b32 v2, 2, v1
  v_add_u32 v2, 155136, v2
  v_lshlrev_b32 v104, 16, v104
  ds_write_b32 v2, v104 offset:0
  v_lshlrev_b32 v105, 16, v105
  ds_write_b32 v2, v105 offset:256
  v_lshlrev_b32 v106, 16, v106
  ds_write_b32 v2, v106 offset:512
  v_lshlrev_b32 v107, 16, v107
  ds_write_b32 v2, v107 offset:768
  v_lshlrev_b32 v108, 16, v108
  ds_write_b32 v2, v108 offset:1024
  v_mov_b32 v2, 156416
  ds_write_b32 v2, v24
  s_mov_b32 s89, 200000
  s_branch Lg_77
Lg_76:
  buffer_load_dword v9, v8, s[68:71], 0 offen sc0 sc1
  s_waitcnt vmcnt(0)
Lg_77:
  v_cmp_eq_u32 vcc, 16, v9
  s_andn2_b32 s3, 0xffff, vcc_lo
  s_cbranch_scc0 Lg_78
  s_sleep 2
  s_sub_u32 s89, s89, 1
  s_cbranch_scc0 Lg_76
Lg_78:
  s_movk_i32 s5, 256
  s_mov_b64 exec, 0xffff
  buffer_store_dword v11, v14, s[40:43], s5 offen sc0 sc1
  s_mov_b64 exec, -1
  s_getpc_b64 s[4:5]
L_pc0:
  s_sub_u32 s4, s4, L_pc0-mega_kernel
  s_subb_u32 s5, s5, 0
  s_bfe_u32 s6, s2, 0x20003
  s_lshl_b32 s6, s6, 13
  v_lshl_add_u32 v3, v1, 4, s6
  v_mov_b32 v119, s5
  v_min_u32 v118, L_end-mega_kernel-16, v3
  v_add_co_u32 v116, vcc, s4, v118
  v_add_u32 v3, 0x400, v3
  s_nop 0
  v_addc_co_u32 v117, vcc, 0, v119, vcc
  global_load_dwordx4 v[112:115], v[116:117], off
  v_min_u32 v118, L_end-mega_kernel-16, v3
  v_add_co_u32 v116, vcc, s4, v118
  v_add_u32 v3, 0x400, v3
  s_nop 0
  v_addc_co_u32 v117, vcc, 0, v119, vcc
  global_load_dwordx4 v[112:115], v[116:117], off
  v_min_u32 v118, L_end-mega_kernel-16, v3
  v_add_co_u32 v116, vcc, s4, v118
  v_add_u32 v3, 0x400, v3
  s_nop 0
  v_addc_co_u32 v117, vcc, 0, v119, vcc
  global_load_dwordx4 v[112:115], v[116:117], off
  v_min_u32 v118, L_end-mega_kernel-16, v3
  v_add_co_u32 v116, vcc, s4, v118
  s_nop 1
  v_addc_co_u32 v117, vcc, 0, v119, vcc
  global_load_dwordx4 v[112:115], v[116:117], off
L_74:
  s_cmp_lg_u32 s82, 0
  s_cbranch_scc1 L_79
  buffer_load_dword v109, v110, s[56:59], s12 offen
  s_add_u32 s12, s12, 114688
L_79:
  s_barrier
  s_cmp_lg_u32 s82, 0
  s_cbranch_scc1 L_81
  v_mfma_f32_16x16x32_bf16 v[96:99], v[32:35], v[176:179], v[96:99]
  v_mfma_f32_16x16x32_bf16 v[100:103], v[176:179], v[176:179], v[100:103]
  v_mfma_f32_16x16x32_bf16 v[96:99], v[32:35], v[180:183], v[96:99]
  v_mfma_f32_16x16x32_bf16 v[100:103], v[180:183], v[180:183], v[100:103]
  v_mfma_f32_16x16x32_bf16 v[96:99], v[32:35], v[184:187], v[96:99]
  v_mfma_f32_16x16x32_bf16 v[100:103], v[184:187], v[184:187], v[100:103]
  v_mfma_f32_16x16x32_bf16 v[96:99], v[32:35], v[188:191], v[96:99]
  v_mfma_f32_16x16x32_bf16 v[100:103], v[188:191], v[188:191], v[100:103]
  s_getpc_b64 s[4:5]
L_pc1:
  s_sub_u32 s4, s4, L_pc1-mega_kernel
  s_subb_u32 s5, s5, 0
  s_bfe_u32 s6, s2, 0x20003
  s_lshl_b32 s6, s6, 13
  s_add_u32 s6, s6, 4096
  v_lshl_add_u32 v3, v1, 4, s6
  v_mov_b32 v119, s5
  v_min_u32 v118, L_end-mega_kernel-16, v3
  v_add_co_u32 v116, vcc, s4, v118
  v_add_u32 v3, 0x400, v3
  s_nop 0
  v_addc_co_u32 v117, vcc, 0, v119, vcc
  global_load_dwordx4 v[112:115], v[116:117], off
  v_min_u32 v118, L_end-mega_kernel-16, v3
  v_add_co_u32 v116, vcc, s4, v118
  v_add_u32 v3, 0x400, v3
  s_nop 0
  v_addc_co_u32 v117, vcc, 0, v119, vcc
  global_load_dwordx4 v[112:115], v[116:117], off
  v_min_u32 v118, L_end-mega_kernel-16, v3
  v_add_co_u32 v116, vcc, s4, v118
  v_add_u32 v3, 0x400, v3
  s_nop 0
  v_addc_co_u32 v117, vcc, 0, v119, vcc
  global_load_dwordx4 v[112:115], v[116:117], off
  v_min_u32 v118, L_end-mega_kernel-16, v3
  v_add_co_u32 v116, vcc, s4, v118
  s_nop 1
  v_addc_co_u32 v117, vcc, 0, v119, vcc
  global_load_dwordx4 v[112:115], v[116:117], off
  s_mov_b32 s98, 0xaaaaaaaa
  s_mov_b32 s99, 0xaaaaaaaa
  v_cndmask_b32_e64 v100, v100, v101, s[98:99]
  v_cndmask_b32_e64 v102, v102, v103, s[98:99]
  s_mov_b32 s98, 0xcccccccc
  s_mov_b32 s99, 0xcccccccc
  v_cndmask_b32_e64 v97, v100, v102, s[98:99]
  v_add_f32_dpp v96, v96, v96 quad_perm:[1,0,3,2] row_mask:0xf bank_mask:0xf
  s_nop 0
  v_add_f32_dpp v97, v97, v97 quad_perm:[1,0,3,2] row_mask:0xf bank_mask:0xf
  s_branch L_82
L_81:
  s_waitcnt vmcnt(0)
  v_add_f32 v96, v96, v100
  v_add_f32 v97, v97, v101
  v_add_f32 v98, v98, v102
  v_add_f32 v99, v99, v103
  v_add_f32 v96, v96, v98
  v_add_f32 v97, v97, v99
  s_nop 0
  v_add_f32_dpp v96, v96, v96 row_ror:8 row_mask:0xf bank_mask:0xf
  v_add_f32_dpp v97, v97, v97 row_ror:8 row_mask:0xf bank_mask:0xf
  v_mov_b32 v98, v96
  v_mov_b32 v99, v97
  s_nop 0
  v_permlane16_swap_b32 v96, v98
  v_permlane16_swap_b32 v97, v99
  v_add_f32 v96, v96, v98
  v_add_f32 v97, v97, v99
  v_mov_b32 v98, v96
  v_mov_b32 v99, v97
  s_nop 0
  v_permlane32_swap_b32 v96, v98
  v_permlane32_swap_b32 v97, v99
  v_add_f32 v96, v96, v98
  v_add_f32 v97, v97, v99
L_82:
  v_mul_f32 v96, 0x3a800000, v96
  v_mul_f32 v97, 0x3a800000, v97
  v_fma_f32 v98, -v96, v96, v97
  v_max_f32 v98, 0, v98
  v_add_f32 v98, 0x3727c5ac, v98
  v_rsq_f32 v98, v98
  s_nop 0
  v_mul_f32 v99, v96, v98
  s_mov_b64 exec, s[8:9]
  buffer_store_dwordx2 v[98:99], v6, s[40:43], s10 offen sc0 sc1
  s_mov_b64 exec, -1
  s_cmp_lg_u32 s82, 0
  s_cbranch_scc1 L_83
  buffer_load_dword v109, v110, s[56:59], s12 offen
  s_add_u32 s12, s12, 114688
L_83:
  s_barrier
  s_cmp_lg_u32 s82, 0
  s_cbranch_scc1 L_85
  v_lshlrev_b32 v6, 3, v1
  s_mov_b64 s[8:9], 0xff
  s_add_u32 s91, s84, 256
  buffer_load_dword v7, v5, s[40:43], s91 offen sc0 sc1
L_85:
  s_barrier
  s_barrier
  s_waitcnt vmcnt(0)
  s_and_b32 s5, s10, 0xfffffc00
  buffer_load_dwordx4 v[120:123], v4, s[40:43], s5 offen sc1
  s_add_u32 s5, s5, s11
  buffer_load_dwordx4 v[124:127], v12, s[40:43], s5 offen sc1
  s_cmp_lg_u32 s82, 0
  s_cbranch_scc1 L_87
  s_mov_b32 s89, 200000
  s_branch Lp_90
Lp_89:
  buffer_load_dword v7, v5, s[40:43], s91 offen sc0 sc1
  s_waitcnt vmcnt(0)
Lp_90:
  v_cmp_ne_u32 vcc, 0, v7
  s_andn2_b32 s3, 0xffff, vcc_lo
  s_cbranch_scc0 Lp_91
  s_sleep 1
  s_sub_u32 s89, s89, 1
  s_cbranch_scc0 Lp_89
Lp_91:
  s_lshl_b32 s5, s77, 14
  s_add_u32 s5, s5, 589824
  buffer_load_dwordx4 v[192:195], v4, s[40:43], s5 offen offset:0 sc1
  buffer_load_dwordx4 v[196:199], v4, s[40:43], s5 offen offset:1024 sc1
  buffer_load_dwordx4 v[200:203], v4, s[40:43], s5 offen offset:2048 sc1
  buffer_load_dwordx4 v[204:207], v4, s[40:43], s5 offen offset:3072 sc1
  s_add_u32 s5, s5, 4096
  buffer_load_dwordx4 v[208:211], v4, s[40:43], s5 offen offset:0 sc1
  buffer_load_dwordx4 v[212:215], v4, s[40:43], s5 offen offset:1024 sc1
  buffer_load_dwordx4 v[216:219], v4, s[40:43], s5 offen offset:2048 sc1
  buffer_load_dwordx4 v[220:223], v4, s[40:43], s5 offen offset:3072 sc1
L_87:
  s_barrier
  s_cmp_lg_u32 s82, 0
  s_cbranch_scc1 L_92
  s_lshl_b32 s5, s77, 14
  s_add_u32 s5, s5, 598016
  buffer_load_dwordx4 v[224:227], v4, s[40:43], s5 offen offset:0 sc1
  buffer_load_dwordx4 v[228:231], v4, s[40:43], s5 offen offset:1024 sc1
  buffer_load_dwordx4 v[232:235], v4, s[40:43], s5 offen offset:2048 sc1
  buffer_load_dwordx4 v[236:239], v4, s[40:43], s5 offen offset:3072 sc1
  s_add_u32 s5, s5, 4096
  buffer_load_dwordx4 v[240:243], v4, s[40:43], s5 offen offset:0 sc1
  buffer_load_dwordx4 v[244:247], v4, s[40:43], s5 offen offset:1024 sc1
  buffer_load_dwordx4 v[248:251], v4, s[40:43], s5 offen offset:2048 sc1
  buffer_load_dwordx4 v[252:255], v4, s[40:43], s5 offen offset:3072 sc1
L_92:
  s_barrier
  s_cmp_lg_u32 s82, 0
  s_cbranch_scc1 L_94
  s_waitcnt vmcnt(16)
  s_branch L_95
L_94:
  s_waitcnt vmcnt(0)
L_95:
  s_mov_b32 s89, 200000
  s_branch Lp_97
Lp_96:
  s_and_b32 s5, s10, 0xfffffc00
  buffer_load_dwordx4 v[120:123], v4, s[40:43], s5 offen sc1
  s_add_u32 s5, s5, s11
  buffer_load_dwordx4 v[124:127], v12, s[40:43], s5 offen sc1
  s_waitcnt vmcnt(0)
Lp_97:
  v_min_u32 v2, v120, v122
  v_min_u32 v3, v124, v126
  v_or_b32 v3, s90, v3
  v_min_u32 v2, v2, v3
  v_cmp_eq_u32 vcc, 0, v2
  s_cmp_eq_u64 vcc, 0
  s_cbranch_scc1 Lp_98
  s_sleep 1
  s_sub_u32 s89, s89, 1
  s_cbranch_scc0 Lp_96
Lp_98:
  ds_write2_b32 v10, v120, v122 offset0:0 offset1:1
  ds_write2_b32 v10, v121, v123 offset0:160 offset1:161
  ds_write2_b32 v13, v124, v126 offset0:0 offset1:1
  ds_write2_b32 v13, v125, v127 offset0:160 offset1:161
  s_add_u32 s10, s10, 16384
  s_barrier
  s_cmp_lg_u32 s82, 0
  s_cbranch_scc1 L_99
  s_waitcnt vmcnt(0)
  v_add_f32 v192, v192, v224
  v_add_f32 v193, v193, v225
  v_add_f32 v194, v194, v226
  v_add_f32 v195, v195, v227
  v_add_f32 v196, v196, v228
  v_add_f32 v197, v197, v229
  v_add_f32 v198, v198, v230
  v_add_f32 v199, v199, v231
  v_add_f32 v200, v200, v232
  v_add_f32 v201, v201, v233
  v_add_f32 v202, v202, v234
  v_add_f32 v203, v203, v235
  v_add_f32 v204, v204, v236
  v_add_f32 v205, v205, v237
  v_add_f32 v206, v206, v238
  v_add_f32 v207, v207, v239
  v_add_f32 v208, v208, v240
  v_add_f32 v209, v209, v241
  v_add_f32 v210, v210, v242
  v_add_f32 v211, v211, v243
  v_add_f32 v212, v212, v244
  v_add_f32 v213, v213, v245
  v_add_f32 v214, v214, v246
  v_add_f32 v215, v215, v247
  v_add_f32 v216, v216, v248
  v_add_f32 v217, v217, v249
  v_add_f32 v218, v218, v250
  v_add_f32 v219, v219, v251
  v_add_f32 v220, v220, v252
  v_add_f32 v221, v221, v253
  v_add_f32 v222, v222, v254
  v_add_f32 v223, v223, v255
  v_add_f32 v192, v192, v208
  v_add_f32 v193, v193, v209
  v_add_f32 v194, v194, v210
  v_add_f32 v195, v195, v211
  v_add_f32 v196, v196, v212
  v_add_f32 v197, v197, v213
  v_add_f32 v198, v198, v214
  v_add_f32 v199, v199, v215
  v_add_f32 v200, v200, v216
  v_add_f32 v201, v201, v217
  v_add_f32 v202, v202, v218
  v_add_f32 v203, v203, v219
  v_add_f32 v204, v204, v220
  v_add_f32 v205, v205, v221
  v_add_f32 v206, v206, v222
  v_add_f32 v207, v207, v223
  v_add_f32 v192, v192, v200
  v_add_f32 v193, v193, v201
  v_add_f32 v194, v194, v202
  v_add_f32 v195, v195, v203
  v_add_f32 v196, v196, v204
  v_add_f32 v197, v197, v205
  v_add_f32 v198, v198, v206
  v_add_f32 v199, v199, v207
  v_add_f32 v192, v192, v196
  v_add_f32 v193, v193, v197
  v_add_f32 v194, v194, v198
  v_add_f32 v195, v195, v199
  v_add_u32 v2, 153088, v4
  ds_write_b128 v2, v[192:195]
L_99:
  s_cmp_lg_u32 s82, 0
  s_cbranch_scc1 L_101
  buffer_load_dword v109, v110, s[56:59], s12 offen
  s_add_u32 s12, s12, 114688
L_101:
  s_barrier
  s_waitcnt lgkmcnt(0)
  s_cmp_lg_u32 s82, 0
  s_cbranch_scc1 L_103
  buffer_load_dword v109, v110, s[56:59], s12 offen
  s_add_u32 s12, s12, 114688
L_103:
  s_barrier
  s_cmp_lg_u32 s82, 0
  s_cbranch_scc1 L_105
  v_lshrrev_b32 v2, 2, v1
  v_lshlrev_b32 v22, 7, v2
  v_lshlrev_b32 v96, 6, v2
  v_and_b32 v2, 3, v1
  v_lshl_add_u32 v22, v2, 3, v22
  v_lshl_add_u32 v96, v2, 3, v96
  v_add_u32 v22, 65536, v22
  v_add_u32 v96, 90112, v96
  v_bfe_u32 v3, v1, 3, 2
  v_xor_b32 v2, 0, v3
  v_lshl_add_u32 v16, v2, 5, v22
  v_xor_b32 v2, 1, v3
  v_lshl_add_u32 v17, v2, 5, v22
  v_xor_b32 v2, 2, v3
  v_lshl_add_u32 v18, v2, 5, v22
  v_xor_b32 v2, 3, v3
  v_lshl_add_u32 v19, v2, 5, v22
  v_bfe_u32 v3, v1, 4, 1
  v_xor_b32 v2, 0, v3
  v_lshl_add_u32 v20, v2, 5, v96
  v_xor_b32 v2, 1, v3
  v_lshl_add_u32 v21, v2, 5, v96
  v_mov_b32 v22, 0x3f803f80
  s_mov_b32 s98, 0x00010001
  s_mov_b32 s99, 0x00010001
  v_cndmask_b32_e64 v200, 0, v22, s[98:99]
  v_cndmask_b32_e64 v201, 0, v22, s[98:99]
  v_cndmask_b32_e64 v202, 0, v22, s[98:99]
  v_cndmask_b32_e64 v203, 0, v22, s[98:99]
  s_lshl_b64 s[98:99], s[98:99], 1
  v_cndmask_b32_e64 v204, 0, v22, s[98:99]
  v_cndmask_b32_e64 v205, 0, v22, s[98:99]
  v_cndmask_b32_e64 v206, 0, v22, s[98:99]
  v_cndmask_b32_e64 v207, 0, v22, s[98:99]
  s_lshl_b64 s[98:99], s[98:99], 1
  v_cndmask_b32_e64 v208, 0, v22, s[98:99]
  v_cndmask_b32_e64 v209, 0, v22, s[98:99]
  v_cndmask_b32_e64 v210, 0, v22, s[98:99]
  v_cndmask_b32_e64 v211, 0, v22, s[98:99]
  s_lshl_b64 s[98:99], s[98:99], 1
  v_cndmask_b32_e64 v212, 0, v22, s[98:99]
  v_cndmask_b32_e64 v213, 0, v22, s[98:99]
  v_cndmask_b32_e64 v214, 0, v22, s[98:99]
  v_cndmask_b32_e64 v215, 0, v22, s[98:99]
  s_lshl_b64 s[98:99], s[98:99], 1
  v_cndmask_b32_e64 v216, 0, v22, s[98:99]
  v_cndmask_b32_e64 v217, 0, v22, s[98:99]
  v_cndmask_b32_e64 v218, 0, v22, s[98:99]
  v_cndmask_b32_e64 v219, 0, v22, s[98:99]
  s_lshl_b64 s[98:99], s[98:99], 1
  v_cndmask_b32_e64 v220, 0, v22, s[98:99]
  v_cndmask_b32_e64 v221, 0, v22, s[98:99]
  v_cndmask_b32_e64 v222, 0, v22, s[98:99]
  v_cndmask_b32_e64 v223, 0, v22, s[98:99]
  s_lshl_b64 s[98:99], s[98:99], 1
  v_cndmask_b32_e64 v224, 0, v22, s[98:99]
  v_cndmask_b32_e64 v225, 0, v22, s[98:99]
  v_cndmask_b32_e64 v226, 0, v22, s[98:99]
  v_cndmask_b32_e64 v227, 0, v22, s[98:99]
  s_lshl_b64 s[98:99], s[98:99], 1
  v_cndmask_b32_e64 v228, 0, v22, s[98:99]
  v_cndmask_b32_e64 v229, 0, v22, s[98:99]
  v_cndmask_b32_e64 v230, 0, v22, s[98:99]
  v_cndmask_b32_e64 v231, 0, v22, s[98:99]
  s_lshl_b64 s[98:99], s[98:99], 1
  v_cndmask_b32_e64 v232, 0, v22, s[98:99]
  v_cndmask_b32_e64 v233, 0, v22, s[98:99]
  v_cndmask_b32_e64 v234, 0, v22, s[98:99]
  v_cndmask_b32_e64 v235, 0, v22, s[98:99]
  s_lshl_b64 s[98:99], s[98:99], 1
  v_cndmask_b32_e64 v236, 0, v22, s[98:99]
  v_cndmask_b32_e64 v237, 0, v22, s[98:99]
  v_cndmask_b32_e64 v238, 0, v22, s[98:99]
  v_cndmask_b32_e64 v239, 0, v22, s[98:99]
  s_lshl_b64 s[98:99], s[98:99], 1
  v_cndmask_b32_e64 v240, 0, v22, s[98:99]
  v_cndmask_b32_e64 v241, 0, v22, s[98:99]
  v_cndmask_b32_e64 v242, 0, v22, s[98:99]
  v_cndmask_b32_e64 v243, 0, v22, s[98:99]
  s_lshl_b64 s[98:99], s[98:99], 1
  v_cndmask_b32_e64 v244, 0, v22, s[98:99]
  v_cndmask_b32_e64 v245, 0, v22, s[98:99]
  v_cndmask_b32_e64 v246, 0, v22, s[98:99]
  v_cndmask_b32_e64 v247, 0, v22, s[98:99]
  s_lshl_b64 s[98:99], s[98:99], 1
  v_cndmask_b32_e64 v248, 0, v22, s[98:99]
  v_cndmask_b32_e64 v249, 0, v22, s[98:99]
  v_cndmask_b32_e64 v250, 0, v22, s[98:99]
  v_cndmask_b32_e64 v251, 0, v22, s[98:99]
  s_lshl_b64 s[98:99], s[98:99], 1
  v_cndmask_b32_e64 v252, 0, v22, s[98:99]
  v_cndmask_b32_e64 v253, 0, v22, s[98:99]
  v_cndmask_b32_e64 v254, 0, v22, s[98:99]
  v_cndmask_b32_e64 v255, 0, v22, s[98:99]
  s_lshl_b64 s[98:99], s[98:99], 1
L_105:
  s_barrier
  s_barrier
  s_barrier
  s_barrier
  s_barrier
  s_barrier
  s_barrier
  s_barrier
  s_barrier
  s_barrier
  s_barrier
  s_barrier
  s_barrier
  s_barrier
  s_barrier
  s_barrier
  s_barrier
  s_add_u32 s92, s83, 31457280
  s_barrier
  s_add_u32 s5, s84, s92
  buffer_load_dwordx2 v[96:97], v6, s[40:43], s5 offen offset:0 sc1
  buffer_load_dwordx2 v[98:99], v6, s[40:43], s5 offen offset:512 sc1
  buffer_load_dwordx2 v[100:101], v6, s[40:43], s5 offen offset:1024 sc1
  buffer_load_dwordx2 v[102:103], v6, s[40:43], s5 offen offset:1536 sc1
  s_cmp_lg_u32 s82, 0
  s_cbranch_scc1 L_107
  ds_read_b64_tr_b16 v[32:33], v16 offset:0
  ds_read_b64_tr_b16 v[34:35], v16 offset:2048
  ds_read_b64_tr_b16 v[36:37], v17 offset:0
  ds_read_b64_tr_b16 v[38:39], v17 offset:2048
  ds_read_b64_tr_b16 v[40:41], v18 offset:0
  ds_read_b64_tr_b16 v[42:43], v18 offset:2048
  ds_read_b64_tr_b16 v[44:45], v19 offset:0
  ds_read_b64_tr_b16 v[46:47], v19 offset:2048
  ds_read_b64_tr_b16 v[48:49], v16 offset:4096
  ds_read_b64_tr_b16 v[50:51], v16 offset:6144
  ds_read_b64_tr_b16 v[52:53], v17 offset:4096
  ds_read_b64_tr_b16 v[54:55], v17 offset:6144
  s_waitcnt lgkmcnt(4)
  ds_read_b64_tr_b16 v[56:57], v18 offset:4096
  ds_read_b64_tr_b16 v[58:59], v18 offset:6144
  ds_read_b64_tr_b16 v[60:61], v19 offset:4096
  ds_read_b64_tr_b16 v[62:63], v19 offset:6144
  v_add_u32 v16, 36864, v16
  v_add_u32 v17, 36864, v17
  v_add_u32 v18, 36864, v18
  v_add_u32 v19, 36864, v19
  s_waitcnt lgkmcnt(0)
L_107:
  s_cmp_lg_u32 s82, 0
  s_cbranch_scc1 L_109
  buffer_load_dword v109, v111, s[60:63], s13 offen
  s_add_u32 s13, s13, 57344
L_109:
  s_barrier
  s_cmp_lg_u32 s82, 0
  s_cbranch_scc1 L_111
  ds_read_b64_tr_b16 v[64:65], v16 offset:0
  ds_read_b64_tr_b16 v[66:67], v16 offset:2048
  ds_read_b64_tr_b16 v[68:69], v17 offset:0
  ds_read_b64_tr_b16 v[70:71], v17 offset:2048
  ds_read_b64_tr_b16 v[72:73], v18 offset:0
  ds_read_b64_tr_b16 v[74:75], v18 offset:2048
  ds_read_b64_tr_b16 v[76:77], v19 offset:0
  ds_read_b64_tr_b16 v[78:79], v19 offset:2048
  ds_read_b64_tr_b16 v[80:81], v16 offset:4096
  ds_read_b64_tr_b16 v[82:83], v16 offset:6144
  ds_read_b64_tr_b16 v[84:85], v17 offset:4096
  ds_read_b64_tr_b16 v[86:87], v17 offset:6144
  s_waitcnt lgkmcnt(4)
  ds_read_b64_tr_b16 v[88:89], v18 offset:4096
  ds_read_b64_tr_b16 v[90:91], v18 offset:6144
  ds_read_b64_tr_b16 v[92:93], v19 offset:4096
  ds_read_b64_tr_b16 v[94:95], v19 offset:6144
  v_add_u32 v16, 36864, v16
  v_add_u32 v17, 36864, v17
  v_add_u32 v18, 36864, v18
  v_add_u32 v19, 36864, v19
  v_mfma_f32_16x16x32_bf16 v[28:31], v[32:35], v[200:203], 0
  v_mfma_f32_16x16x32_bf16 v[28:31], v[36:39], v[204:207], v[28:31]
  v_mfma_f32_16x16x32_bf16 v[28:31], v[40:43], v[208:211], v[28:31]
  v_mfma_f32_16x16x32_bf16 v[28:31], v[44:47], v[212:215], v[28:31]
  v_mfma_f32_16x16x32_bf16 v[28:31], v[48:51], v[200:203], v[28:31]
  v_mfma_f32_16x16x32_bf16 v[28:31], v[52:55], v[204:207], v[28:31]
  v_mfma_f32_16x16x32_bf16 v[28:31], v[56:59], v[208:211], v[28:31]
  v_mfma_f32_16x16x32_bf16 v[28:31], v[60:63], v[212:215], v[28:31]
  s_waitcnt lgkmcnt(0)
L_111:
  s_cmp_lg_u32 s82, 0
  s_cbranch_scc1 L_113
  buffer_load_dword v109, v111, s[60:63], s13 offen
  s_add_u32 s13, s13, 57344
L_113:
  s_barrier
  s_cmp_lg_u32 s82, 0
  s_cbranch_scc1 L_115
  ds_read_b64_tr_b16 v[32:33], v16 offset:0
  ds_read_b64_tr_b16 v[34:35], v16 offset:2048
  ds_read_b64_tr_b16 v[36:37], v17 offset:0
  ds_read_b64_tr_b16 v[38:39], v17 offset:2048
  ds_read_b64_tr_b16 v[40:41], v18 offset:0
  ds_read_b64_tr_b16 v[42:43], v18 offset:2048
  ds_read_b64_tr_b16 v[44:45], v19 offset:0
  ds_read_b64_tr_b16 v[46:47], v19 offset:2048
  ds_read_b64_tr_b16 v[48:49], v16 offset:4096
  ds_read_b64_tr_b16 v[50:51], v16 offset:6144
  ds_read_b64_tr_b16 v[52:53], v17 offset:4096
  ds_read_b64_tr_b16 v[54:55], v17 offset:6144
  s_waitcnt lgkmcnt(4)
  ds_read_b64_tr_b16 v[56:57], v18 offset:4096
  ds_read_b64_tr_b16 v[58:59], v18 offset:6144
  ds_read_b64_tr_b16 v[60:61], v19 offset:4096
  ds_read_b64_tr_b16 v[62:63], v19 offset:6144
  v_mfma_f32_16x16x32_bf16 v[28:31], v[64:67], v[216:219], v[28:31]
  v_mfma_f32_16x16x32_bf16 v[28:31], v[68:71], v[220:223], v[28:31]
  v_mfma_f32_16x16x32_bf16 v[28:31], v[72:75], v[224:227], v[28:31]
  v_mfma_f32_16x16x32_bf16 v[28:31], v[76:79], v[228:231], v[28:31]
  v_mfma_f32_16x16x32_bf16 v[28:31], v[80:83], v[216:219], v[28:31]
  v_mfma_f32_16x16x32_bf16 v[28:31], v[84:87], v[220:223], v[28:31]
  v_mfma_f32_16x16x32_bf16 v[28:31], v[88:91], v[224:227], v[28:31]
  v_mfma_f32_16x16x32_bf16 v[28:31], v[92:95], v[228:231], v[28:31]
  s_waitcnt lgkmcnt(0)
L_115:
  s_barrier
  s_cmp_lg_u32 s82, 0
  s_cbranch_scc1 L_117
  ds_read_b64_tr_b16 v[64:65], v20 offset:0
  ds_read_b64_tr_b16 v[66:67], v20 offset:1024
  ds_read_b64_tr_b16 v[68:69], v21 offset:0
  ds_read_b64_tr_b16 v[70:71], v21 offset:1024
  ds_read_b64_tr_b16 v[80:81], v20 offset:2048
  ds_read_b64_tr_b16 v[82:83], v20 offset:3072
  ds_read_b64_tr_b16 v[84:85], v21 offset:2048
  ds_read_b64_tr_b16 v[86:87], v21 offset:3072
  v_mfma_f32_16x16x32_bf16 v[28:31], v[32:35], v[232:235], v[28:31]
  v_mfma_f32_16x16x32_bf16 v[28:31], v[36:39], v[236:239], v[28:31]
  v_mfma_f32_16x16x32_bf16 v[28:31], v[40:43], v[240:243], v[28:31]
  v_mfma_f32_16x16x32_bf16 v[28:31], v[44:47], v[244:247], v[28:31]
  v_mfma_f32_16x16x32_bf16 v[28:31], v[48:51], v[232:235], v[28:31]
  v_mfma_f32_16x16x32_bf16 v[28:31], v[52:55], v[236:239], v[28:31]
  v_mfma_f32_16x16x32_bf16 v[28:31], v[56:59], v[240:243], v[28:31]
  v_mfma_f32_16x16x32_bf16 v[28:31], v[60:63], v[244:247], v[28:31]
  s_waitcnt lgkmcnt(0)
L_117:
  s_barrier
  s_waitcnt vmcnt(0)
  v_add_f32 v96, v96, v100
  v_add_f32 v97, v97, v101
  v_add_f32 v98, v98, v102
  v_add_f32 v99, v99, v103
  v_add_f32 v96, v96, v98
  v_add_f32 v97, v97, v99
  s_nop 0
  v_add_f32_dpp v96, v96, v96 row_ror:8 row_mask:0xf bank_mask:0xf
  v_add_f32_dpp v97, v97, v97 row_ror:8 row_mask:0xf bank_mask:0xf
  v_mov_b32 v98, v96
  v_mov_b32 v99, v97
  s_nop 0
  v_permlane16_swap_b32 v96, v98
  v_permlane16_swap_b32 v97, v99
  v_add_f32 v96, v96, v98
  v_add_f32 v97, v97, v99
  v_mov_b32 v98, v96
  v_mov_b32 v99, v97
  s_nop 0
  v_permlane32_swap_b32 v96, v98
  v_permlane32_swap_b32 v97, v99
  v_add_f32 v96, v96, v98
  v_add_f32 v97, v97, v99
  v_mul_f32 v96, 0x3a800000, v96
  v_mul_f32 v97, 0x3a800000, v97
  v_fma_f32 v98, -v96, v96, v97
  v_max_f32 v98, 0, v98
  v_add_f32 v98, 0x3727c5ac, v98
  v_rsq_f32 v98, v98
  s_nop 0
  v_mul_f32 v99, v96, v98
  s_mov_b64 exec, s[8:9]
  buffer_store_dwordx2 v[98:99], v6, s[40:43], s10 offen sc0 sc1
  s_mov_b64 exec, -1
  s_cmp_lg_u32 s82, 0
  s_cbranch_scc1 L_119
  v_mfma_f32_16x16x32_bf16 v[28:31], v[64:67], v[248:251], v[28:31]
  v_mfma_f32_16x16x32_bf16 v[28:31], v[68:71], v[252:255], v[28:31]
  v_mfma_f32_16x16x32_bf16 v[28:31], v[80:83], v[248:251], v[28:31]
  v_mfma_f32_16x16x32_bf16 v[28:31], v[84:87], v[252:255], v[28:31]
  s_lshl_b32 s5, s77, 14
  s_lshl_b32 s4, s76, 10
  s_add_u32 s5, s5, s4
  s_add_u32 s5, s5, 1114112
  s_nop 3
  buffer_store_dwordx4 v[28:31], v15, s[40:43], s5 offen sc0 sc1
L_119:
  s_cmp_lg_u32 s82, 0
  s_cbranch_scc1 L_121
  buffer_load_dword v109, v111, s[60:63], s13 offen
  s_add_u32 s13, s13, 57344
L_121:
  s_barrier
  s_barrier
  s_barrier
  s_cmp_lg_u32 s82, 0
  s_cbranch_scc1 L_123
  s_waitcnt vmcnt(0)
  s_movk_i32 s5, 384
  s_mov_b64 exec, 0xffff
  buffer_store_dword v11, v14, s[40:43], s5 offen sc0 sc1
  s_mov_b64 exec, -1
L_123:
  s_cmp_lg_u32 s82, 0
  s_cbranch_scc1 L_125
  buffer_load_dword v109, v111, s[60:63], s13 offen
  s_add_u32 s13, s13, 57344
L_125:
  s_barrier
  s_barrier
  s_cmp_lg_u32 s82, 0
  s_cbranch_scc1 L_127
  s_add_u32 s91, s84, 384
  buffer_load_dword v7, v5, s[40:43], s91 offen sc0 sc1
L_127:
  s_and_b32 s5, s10, 0xfffffc00
  buffer_load_dwordx4 v[120:123], v4, s[40:43], s5 offen sc1
  s_barrier
  s_barrier
  s_waitcnt vmcnt(0)
  s_mov_b32 s89, 200000
  s_branch Lp_130
Lp_129:
  s_and_b32 s5, s10, 0xfffffc00
  buffer_load_dwordx4 v[120:123], v4, s[40:43], s5 offen sc1
  s_waitcnt vmcnt(0)
Lp_130:
  v_min_u32 v2, v120, v122
  v_cmp_eq_u32 vcc, 0, v2
  s_cmp_eq_u64 vcc, 0
  s_cbranch_scc1 Lp_131
  s_sleep 1
  s_sub_u32 s89, s89, 1
  s_cbranch_scc0 Lp_129
Lp_131:
  ds_write2_b32 v10, v120, v122 offset0:0 offset1:1
  ds_write2_b32 v10, v121, v123 offset0:160 offset1:161
  s_add_u32 s10, s10, 16384
  s_cmp_lg_u32 s82, 0
  s_cbranch_scc1 L_132
  s_mov_b32 s89, 200000
  s_branch Lp_135
Lp_134:
  buffer_load_dword v7, v5, s[40:43], s91 offen sc0 sc1
  s_waitcnt vmcnt(0)
Lp_135:
  v_cmp_ne_u32 vcc, 0, v7
  s_andn2_b32 s3, 0xffff, vcc_lo
  s_cbranch_scc0 Lp_136
  s_sleep 1
  s_sub_u32 s89, s89, 1
  s_cbranch_scc0 Lp_134
Lp_136:
  s_lshl_b32 s5, s77, 14
  s_add_u32 s5, s5, 1114112
  buffer_load_dwordx4 v[192:195], v4, s[40:43], s5 offen offset:0 sc1
  buffer_load_dwordx4 v[196:199], v4, s[40:43], s5 offen offset:1024 sc1
  buffer_load_dwordx4 v[200:203], v4, s[40:43], s5 offen offset:2048 sc1
  buffer_load_dwordx4 v[204:207], v4, s[40:43], s5 offen offset:3072 sc1
  s_add_u32 s5, s5, 4096
  buffer_load_dwordx4 v[208:211], v4, s[40:43], s5 offen offset:0 sc1
  buffer_load_dwordx4 v[212:215], v4, s[40:43], s5 offen offset:1024 sc1
  buffer_load_dwordx4 v[216:219], v4, s[40:43], s5 offen offset:2048 sc1
  buffer_load_dwordx4 v[220:223], v4, s[40:43], s5 offen offset:3072 sc1
L_132:
  s_barrier
  s_cmp_lg_u32 s82, 0
  s_cbranch_scc1 L_137
  s_lshl_b32 s5, s77, 14
  s_add_u32 s5, s5, 1122304
  buffer_load_dwordx4 v[224:227], v4, s[40:43], s5 offen offset:0 sc1
  buffer_load_dwordx4 v[228:231], v4, s[40:43], s5 offen offset:1024 sc1
  buffer_load_dwordx4 v[232:235], v4, s[40:43], s5 offen offset:2048 sc1
  buffer_load_dwordx4 v[236:239], v4, s[40:43], s5 offen offset:3072 sc1
  s_add_u32 s5, s5, 4096
  buffer_load_dwordx4 v[240:243], v4, s[40:43], s5 offen offset:0 sc1
  buffer_load_dwordx4 v[244:247], v4, s[40:43], s5 offen offset:1024 sc1
  buffer_load_dwordx4 v[248:251], v4, s[40:43], s5 offen offset:2048 sc1
  buffer_load_dwordx4 v[252:255], v4, s[40:43], s5 offen offset:3072 sc1
L_137:
  s_barrier
  s_barrier
  s_cmp_lg_u32 s82, 0
  s_cbranch_scc1 L_139
  s_waitcnt vmcnt(0)
  v_add_f32 v192, v192, v224
  v_add_f32 v193, v193, v225
  v_add_f32 v194, v194, v226
  v_add_f32 v195, v195, v227
  v_add_f32 v196, v196, v228
  v_add_f32 v197, v197, v229
  v_add_f32 v198, v198, v230
  v_add_f32 v199, v199, v231
  v_add_f32 v200, v200, v232
  v_add_f32 v201, v201, v233
  v_add_f32 v202, v202, v234
  v_add_f32 v203, v203, v235
  v_add_f32 v204, v204, v236
  v_add_f32 v205, v205, v237
  v_add_f32 v206, v206, v238
  v_add_f32 v207, v207, v239
  v_add_f32 v208, v208, v240
  v_add_f32 v209, v209, v241
  v_add_f32 v210, v210, v242
  v_add_f32 v211, v211, v243
  v_add_f32 v212, v212, v244
  v_add_f32 v213, v213, v245
  v_add_f32 v214, v214, v246
  v_add_f32 v215, v215, v247
  v_add_f32 v216, v216, v248
  v_add_f32 v217, v217, v249
  v_add_f32 v218, v218, v250
  v_add_f32 v219, v219, v251
  v_add_f32 v220, v220, v252
  v_add_f32 v221, v221, v253
  v_add_f32 v222, v222, v254
  v_add_f32 v223, v223, v255
  v_add_f32 v192, v192, v208
  v_add_f32 v193, v193, v209
  v_add_f32 v194, v194, v210
  v_add_f32 v195, v195, v211
  v_add_f32 v196, v196, v212
  v_add_f32 v197, v197, v213
  v_add_f32 v198, v198, v214
  v_add_f32 v199, v199, v215
  v_add_f32 v200, v200, v216
  v_add_f32 v201, v201, v217
  v_add_f32 v202, v202, v218
  v_add_f32 v203, v203, v219
  v_add_f32 v204, v204, v220
  v_add_f32 v205, v205, v221
  v_add_f32 v206, v206, v222
  v_add_f32 v207, v207, v223
  v_add_f32 v192, v192, v200
  v_add_f32 v193, v193, v201
  v_add_f32 v194, v194, v202
  v_add_f32 v195, v195, v203
  v_add_f32 v196, v196, v204
  v_add_f32 v197, v197, v205
  v_add_f32 v198, v198, v206
  v_add_f32 v199, v199, v207
  v_add_f32 v192, v192, v196
  v_add_f32 v193, v193, v197
  v_add_f32 v194, v194, v198
  v_add_f32 v195, v195, v199
  v_add_u32 v2, 154112, v4
  ds_write_b128 v2, v[192:195]
L_139:
  s_barrier
  s_waitcnt lgkmcnt(0)
  s_barrier
  s_barrier
  s_barrier
  s_barrier
  s_barrier
  s_barrier
  s_barrier
  s_barrier
  s_barrier
  s_barrier
  s_barrier
  s_barrier
  s_barrier
  s_barrier
  s_barrier
  s_barrier
  s_barrier
  s_barrier
  s_barrier
  s_barrier
  s_barrier
  s_barrier
  s_barrier
  s_barrier
  s_barrier
  s_barrier
  s_barrier
  s_barrier
  s_barrier
  s_barrier
  s_cmp_lg_u32 s82, 0
  s_cbranch_scc1 L_lend
  s_add_u32 s92, s83, 36700160
  s_mov_b32 s82, 1
  s_add_u32 s83, s83, 0
  s_branch L_slayer
L_lend:
L_end:
  s_endpgm
.section .rodata,"a"
.p2align 6
.amdhsa_kernel mega_kernel
  .amdhsa_next_free_vgpr 256
  .amdhsa_next_free_sgpr 102
  .amdhsa_accum_offset 256
  .amdhsa_group_segment_fixed_size 0
  .amdhsa_kernarg_size 88
  .amdhsa_user_sgpr_count 2
  .amdhsa_user_sgpr_kernarg_segment_ptr 1
  .amdhsa_system_sgpr_workgroup_id_x 1
  .amdhsa_float_denorm_mode_32 3
  .amdhsa_float_denorm_mode_16_64 3
.end_amdhsa_kernel
.text
```

```asm
; @launch kernel=mega_kernel grid=(256,1,1) block=(512,1,1) lds=156672
.amdgcn_target "amdgcn-amd-amdhsa--gfx950"
.text
.globl mega_kernel
.p2align 8
.type mega_kernel,@function
mega_kernel:
  s_cmp_ge_u32 s2, 256
  s_cbranch_scc1 L_end
  s_load_dwordx16 s[16:31], s[0:1], 0
  s_load_dwordx2 s[32:33], s[0:1], 64
  s_load_dwordx4 s[36:39], s[0:1], 72
  v_lshrrev_b32 v2, 6, v0
  v_and_b32 v1, 63, v0
  v_readfirstlane_b32 s81, v2
  s_and_b32 s3, s2, 7
  s_lshr_b32 s4, s2, 3
  s_and_b32 s5, s3, 1
  s_lshl_b32 s5, s5, 3
  s_and_b32 s6, s4, 7
  s_add_u32 s76, s5, s6
  s_lshr_b32 s5, s3, 1
  s_lshl_b32 s5, s5, 2
  s_lshr_b32 s6, s4, 3
  s_add_u32 s77, s5, s6
  s_mov_b32 s82, 0
  s_mov_b32 s88, 0
  s_and_b32 s85, s81, 1
  s_cmp_lt_u32 s81, 4
  s_cbranch_scc1 L_comp
  s_cmp_eq_u32 s81, 5
  s_cbranch_scc1 L_serv
  s_setprio 0
  s_cmp_eq_u32 s81, 4
  s_cbranch_scc1 L_xload
  v_bfe_u32 v2, v1, 1, 2
  v_bfe_u32 v3, v1, 4, 2
  v_xor_b32 v2, v2, v3
  v_lshlrev_b32 v10, 5, v2
  v_and_b32 v2, 1, v1
  v_lshl_add_u32 v10, v2, 4, v10
  v_lshrrev_b32 v2, 5, v1
  v_bfe_u32 v3, v1, 3, 2
  v_lshl_add_u32 v2, v2, 3, v3
  s_movk_i32 s4, 6144
  v_mad_u32_u24 v4, v2, s4, v10
  v_add_u32 v5, 97280, v4
  v_add_u32 v6, 22528, v4
  v_add_u32 v7, 119808, v4
  s_waitcnt lgkmcnt(0)
  s_mov_b32 s48, s18
  s_and_b32 s49, s19, 0xffff
  s_mov_b32 s50, 6291456
  s_mov_b32 s51, 0x00020000
L_wlayer:
  s_lshl_b32 s5, s77, 7
  s_mul_i32 s4, s85, 196608
  s_add_u32 s5, s5, s4
  s_mov_b32 s8, 393216
  s_mov_b32 s10, 6291456
  s_add_u32 s9, s5, s10
  s_mul_i32 s6, s76, 11
  s_lshr_b32 s6, s6, 5
  s_mul_i32 s6, s6, 1179648
  s_add_u32 s7, s5, s6
  s_lshl_b32 s11, s85, 12
  s_add_u32 s11, s11, 65536
  s_add_u32 s15, s11, 73728
  s_mov_b32 s12, 0
  s_mov_b32 m0, s11
  s_cmp_eq_u32 s82, 0
  s_cbranch_scc1 Ll_16
  s_waitcnt vmcnt(12)
  s_barrier
  s_waitcnt vmcnt(8)
  s_barrier
  s_waitcnt vmcnt(4)
  s_barrier
  s_branch Ll_16
Lt_22:
  s_cmp_lg_u32 s12, 1
  s_cbranch_scc1 Lt_20
  s_cmp_eq_u32 s82, 0
  s_cbranch_scc1 Ll_16
  s_waitcnt vmcnt(12)
  s_barrier
  s_branch Ll_16
Lt_20:
  s_cmp_lg_u32 s12, 2
  s_cbranch_scc1 Ll_16
  s_cmp_eq_u32 s82, 0
  s_cbranch_scc1 Ll_16
  s_barrier
Ll_16:
  buffer_load_dwordx4 v4, s[48:51], s7 offen offset:0 lds
  buffer_load_dwordx4 v5, s[48:51], s7 offen offset:1024 lds
  buffer_load_dwordx4 v6, s[48:51], s7 offen offset:2048 lds
  buffer_load_dwordx4 v7, s[48:51], s7 offen offset:3072 lds
  s_add_u32 m0, s11, 8192
  s_add_u32 s5, s7, 2048
  buffer_load_dwordx4 v4, s[48:51], s5 offen offset:0 lds
  buffer_load_dwordx4 v5, s[48:51], s5 offen offset:1024 lds
  buffer_load_dwordx4 v6, s[48:51], s5 offen offset:2048 lds
  buffer_load_dwordx4 v7, s[48:51], s5 offen offset:3072 lds
  s_add_u32 m0, s11, 16384
  s_add_u32 s5, s7, 4096
  buffer_load_dwordx4 v4, s[48:51], s5 offen offset:0 lds
  s_add_u32 s7, s7, s8
  s_cmp_eq_u32 s7, s9
  s_cselect_b32 s4, s10, 0
  s_sub_u32 s7, s7, s4
  buffer_load_dwordx4 v5, s[48:51], s5 offen offset:1024 lds
  s_add_u32 s11, s11, 24576
  s_cmp_eq_u32 s11, s15
  s_cselect_b32 s4, 73728, 0
  s_sub_u32 s11, s11, s4
  buffer_load_dwordx4 v6, s[48:51], s5 offen offset:2048 lds
  s_add_u32 s12, s12, 1
  s_cmp_lg_u32 s12, 3
  buffer_load_dwordx4 v7, s[48:51], s5 offen offset:3072 lds
  s_mov_b32 m0, s11
  s_cbranch_scc1 Lt_22
Lt_23:
  s_waitcnt vmcnt(24)
  s_barrier
  s_waitcnt vmcnt(12)
  s_barrier
  buffer_load_dwordx4 v4, s[48:51], s7 offen offset:0 lds
  buffer_load_dwordx4 v5, s[48:51], s7 offen offset:1024 lds
  buffer_load_dwordx4 v6, s[48:51], s7 offen offset:2048 lds
  buffer_load_dwordx4 v7, s[48:51], s7 offen offset:3072 lds
Ll_24:
  s_add_u32 m0, s11, 8192
  s_add_u32 s5, s7, 2048
  buffer_load_dwordx4 v4, s[48:51], s5 offen offset:0 lds
  buffer_load_dwordx4 v5, s[48:51], s5 offen offset:1024 lds
  buffer_load_dwordx4 v6, s[48:51], s5 offen offset:2048 lds
  buffer_load_dwordx4 v7, s[48:51], s5 offen offset:3072 lds
  s_add_u32 m0, s11, 16384
  s_add_u32 s5, s7, 4096
  buffer_load_dwordx4 v4, s[48:51], s5 offen offset:0 lds
  s_add_u32 s7, s7, s8
  s_cmp_eq_u32 s7, s9
  s_cselect_b32 s4, s10, 0
  s_sub_u32 s7, s7, s4
  buffer_load_dwordx4 v5, s[48:51], s5 offen offset:1024 lds
  s_add_u32 s11, s11, 24576
  s_cmp_eq_u32 s11, s15
  s_cselect_b32 s4, 73728, 0
  s_sub_u32 s11, s11, s4
  buffer_load_dwordx4 v6, s[48:51], s5 offen offset:2048 lds
  s_add_u32 s12, s12, 1
  s_cmp_eq_u32 s12, 16
  buffer_load_dwordx4 v7, s[48:51], s5 offen offset:3072 lds
  s_mov_b32 m0, s11
  s_cbranch_scc1 Ll_25
  s_waitcnt vmcnt(12)
  s_barrier
  buffer_load_dwordx4 v4, s[48:51], s7 offen offset:0 lds
  buffer_load_dwordx4 v5, s[48:51], s7 offen offset:1024 lds
  buffer_load_dwordx4 v6, s[48:51], s7 offen offset:2048 lds
  buffer_load_dwordx4 v7, s[48:51], s7 offen offset:3072 lds
  s_branch Ll_24
Ll_25:
  s_branch L_w1
L_xload:
  s_setprio 0
  v_lshrrev_b32 v2, 4, v1
  v_and_b32 v3, 7, v1
  v_xor_b32 v2, v2, v3
  v_lshrrev_b32 v3, 3, v1
  v_lshlrev_b32 v3, 12, v3
  v_lshl_add_u32 v4, v2, 4, v3
  v_xor_b32 v5, 64, v4
  v_add_u32 v5, 31744, v5
  v_add_u32 v6, 63488, v4
  v_add_u32 v7, 63488, v5
  s_mov_b32 s13, 0x20000
  s_mov_b32 s14, 0xffff0000
  s_movk_i32 s95, 2048
  s_lshl_b32 s5, s76, 18
  s_mov_b32 s8, 128
  s_mov_b32 s10, 2048
  s_add_u32 s9, s5, s10
  s_mul_i32 s6, s76, 11
  s_lshr_b32 s6, s6, 5
  s_mul_i32 s6, s6, 384
  s_add_u32 s7, s5, s6
  s_waitcnt lgkmcnt(0)
  s_mov_b32 s72, s16
  s_and_b32 s73, s17, 0xffff
  s_mov_b32 s74, 4194304
  s_mov_b32 s75, 0x00020000
L_xlayer:
  s_mov_b32 s11, 0
  s_mov_b32 s15, 61440
  s_cmp_eq_u32 s76, 0
  s_cselect_b32 s14, 0x70000000, s14
  s_mov_b32 s12, 0
  s_mov_b32 m0, s11
Ll_58:
  s_nop 0
  buffer_load_dwordx4 v4, s[72:75], s7 offen offset:0 sc1 lds
  buffer_load_dwordx4 v5, s[72:75], s7 offen offset:1024 sc1 lds
  buffer_load_dwordx4 v6, s[72:75], s7 offen offset:2048 sc1 lds
  buffer_load_dwordx4 v7, s[72:75], s7 offen offset:3072 sc1 lds
  s_add_u32 m0, s11, 8192
  s_add_u32 s5, s7, s14
  buffer_load_dwordx4 v4, s[72:75], s5 offen offset:0 sc1 lds
  buffer_load_dwordx4 v5, s[72:75], s5 offen offset:1024 sc1 lds
  s_add_u32 m0, s11, 4096
  s_add_u32 s5, s7, s13
  buffer_load_dwordx4 v4, s[72:75], s5 offen offset:0 sc1 lds
  buffer_load_dwordx4 v5, s[72:75], s5 offen offset:1024 sc1 lds
  buffer_load_dwordx4 v6, s[72:75], s5 offen offset:2048 sc1 lds
  buffer_load_dwordx4 v7, s[72:75], s5 offen offset:3072 sc1 lds
  s_add_u32 m0, s11, 10240
  s_add_u32 s3, s7, s95
  buffer_load_dwordx4 v4, s[72:75], s3 offen offset:0 sc1 lds
  buffer_load_dwordx4 v5, s[72:75], s3 offen offset:1024 sc1 lds
  buffer_load_dwordx4 v6, s[72:75], s3 offen offset:2048 sc1 lds
  buffer_load_dwordx4 v7, s[72:75], s3 offen offset:3072 sc1 lds
  s_add_u32 m0, s11, 18432
  s_add_u32 s5, s3, s14
  buffer_load_dwordx4 v4, s[72:75], s5 offen offset:0 sc1 lds
  buffer_load_dwordx4 v5, s[72:75], s5 offen offset:1024 sc1 lds
  s_add_u32 m0, s11, 14336
  s_add_u32 s5, s3, s13
  buffer_load_dwordx4 v4, s[72:75], s5 offen offset:0 sc1 lds
  s_add_u32 s7, s7, s8
  s_cmp_eq_u32 s7, s9
  s_cselect_b32 s4, s10, 0
  s_sub_u32 s7, s7, s4
  buffer_load_dwordx4 v5, s[72:75], s5 offen offset:1024 sc1 lds
  s_add_u32 s11, s11, 20480
  s_cmp_eq_u32 s11, s15
  s_cselect_b32 s4, 61440, 0
  s_sub_u32 s11, s11, s4
  buffer_load_dwordx4 v6, s[72:75], s5 offen offset:2048 sc1 lds
  s_add_u32 s12, s12, 1
  s_cmp_lg_u32 s12, 3
  buffer_load_dwordx4 v7, s[72:75], s5 offen offset:3072 sc1 lds
  s_mov_b32 m0, s11
  s_cbranch_scc1 Ll_58
  s_waitcnt vmcnt(40)
  s_barrier
  s_waitcnt vmcnt(20)
  s_barrier
  buffer_load_dwordx4 v4, s[72:75], s7 offen offset:0 sc1 lds
  buffer_load_dwordx4 v5, s[72:75], s7 offen offset:1024 sc1 lds
  buffer_load_dwordx4 v6, s[72:75], s7 offen offset:2048 sc1 lds
  buffer_load_dwordx4 v7, s[72:75], s7 offen offset:3072 sc1 lds
Ll_62:
  s_add_u32 m0, s11, 8192
  s_add_u32 s5, s7, s14
  buffer_load_dwordx4 v4, s[72:75], s5 offen offset:0 sc1 lds
  buffer_load_dwordx4 v5, s[72:75], s5 offen offset:1024 sc1 lds
  s_add_u32 m0, s11, 4096
  s_add_u32 s5, s7, s13
  buffer_load_dwordx4 v4, s[72:75], s5 offen offset:0 sc1 lds
  buffer_load_dwordx4 v5, s[72:75], s5 offen offset:1024 sc1 lds
  buffer_load_dwordx4 v6, s[72:75], s5 offen offset:2048 sc1 lds
  buffer_load_dwordx4 v7, s[72:75], s5 offen offset:3072 sc1 lds
  s_add_u32 m0, s11, 10240
  s_add_u32 s3, s7, s95
  buffer_load_dwordx4 v4, s[72:75], s3 offen offset:0 sc1 lds
  buffer_load_dwordx4 v5, s[72:75], s3 offen offset:1024 sc1 lds
  buffer_load_dwordx4 v6, s[72:75], s3 offen offset:2048 sc1 lds
  buffer_load_dwordx4 v7, s[72:75], s3 offen offset:3072 sc1 lds
  s_add_u32 m0, s11, 18432
  s_add_u32 s5, s3, s14
  buffer_load_dwordx4 v4, s[72:75], s5 offen offset:0 sc1 lds
  buffer_load_dwordx4 v5, s[72:75], s5 offen offset:1024 sc1 lds
  s_add_u32 m0, s11, 14336
  s_add_u32 s5, s3, s13
  buffer_load_dwordx4 v4, s[72:75], s5 offen offset:0 sc1 lds
  s_add_u32 s7, s7, s8
  s_cmp_eq_u32 s7, s9
  s_cselect_b32 s4, s10, 0
  s_sub_u32 s7, s7, s4
  buffer_load_dwordx4 v5, s[72:75], s5 offen offset:1024 sc1 lds
  s_add_u32 s11, s11, 20480
  s_cmp_eq_u32 s11, s15
  s_cselect_b32 s4, 61440, 0
  s_sub_u32 s11, s11, s4
  buffer_load_dwordx4 v6, s[72:75], s5 offen offset:2048 sc1 lds
  s_add_u32 s12, s12, 1
  s_cmp_eq_u32 s12, 16
  buffer_load_dwordx4 v7, s[72:75], s5 offen offset:3072 sc1 lds
  s_mov_b32 m0, s11
  s_cbranch_scc1 Ll_63
  s_waitcnt vmcnt(20)
  s_barrier
  buffer_load_dwordx4 v4, s[72:75], s7 offen offset:0 sc1 lds
  buffer_load_dwordx4 v5, s[72:75], s7 offen offset:1024 sc1 lds
  buffer_load_dwordx4 v6, s[72:75], s7 offen offset:2048 sc1 lds
  buffer_load_dwordx4 v7, s[72:75], s7 offen offset:3072 sc1 lds
  s_branch Ll_62
Ll_63:
  s_waitcnt vmcnt(20)
  s_barrier
  s_waitcnt vmcnt(0)
  s_barrier
  s_barrier
  s_branch L_x1
L_serv:
  s_setprio 3
  s_and_b32 s80, s77, 7
  s_lshr_b32 s79, s77, 3
  s_lshl_b32 s78, s80, 1
  s_add_u32 s78, s78, s79
  s_lshl_b32 s5, s76, 4
  s_add_u32 s5, s5, s77
  s_lshl_b32 s84, s5, 11
  s_mov_b32 s83, 3145728
  s_mov_b32 s87, 1835016
  s_lshr_b32 s86, s81, 1
  v_lshlrev_b32 v4, 4, v1
  v_mov_b32 v24, 0
  v_mov_b32 v25, 0
  v_mov_b32 v26, 0
  v_mov_b32 v27, 0
  v_and_b32 v2, 14, v1
  v_lshlrev_b32 v3, 11, v2
  v_and_b32 v2, 1, v1
  v_lshl_add_u32 v3, v2, 4, v3
  v_and_b32 v2, 48, v1
  v_lshl_add_u32 v3, v2, 1, v3
  v_bfe_u32 v2, v1, 3, 2
  v_and_b32 v22, 7, v1
  v_lshlrev_b32 v2, 14, v2
  v_lshl_add_u32 v2, v22, 3, v2
  s_lshl_b32 s5, s76, 7
  s_lshl_b32 s4, s80, 4
  s_add_u32 s6, s5, s4
  s_add_u32 s6, s6, s79
  s_lshl_b32 s6, s6, 11
  s_lshr_b32 s10, s84, 5
  s_add_u32 s10, s10, 1638400
  s_waitcnt lgkmcnt(0)
  s_mov_b32 s48, s18
  s_and_b32 s49, s19, 0xffff
  s_mov_b32 s50, 6291456
  s_mov_b32 s51, 0x00020000
  s_sub_u32 s4, 384, s48
  s_and_b32 s4, s4, 1023
  s_mul_i32 s5, s84, 12
  s_add_u32 s4, s4, s5
  v_lshlrev_b32 v109, 10, v1
  s_mov_b64 exec, 0xffffff
  buffer_load_dword v109, v109, s[48:51], s4 offen
  s_mov_b64 exec, -1
  s_mov_b32 s40, s38
  s_and_b32 s41, s39, 0xffff
  s_mov_b32 s42, 100663296
  s_mov_b32 s43, 0x00020000
  s_mov_b32 s44, s16
  s_and_b32 s45, s17, 0xffff
  s_mov_b32 s46, 4194304
  s_mov_b32 s47, 0x00020000
  s_mov_b32 s68, s36
  s_and_b32 s69, s37, 0xffff
  s_mov_b32 s70, 256
  s_mov_b32 s71, 0x00020000
  s_lshl_b32 s4, s84, 1
  s_add_u32 s4, s4, 1835008
  buffer_store_dwordx4 v[24:27], v4, s[40:43], s4 offen offset:0 sc0 sc1
  buffer_store_dwordx4 v[24:27], v4, s[40:43], s4 offen offset:1024 sc0 sc1
  buffer_store_dwordx4 v[24:27], v4, s[40:43], s4 offen offset:2048 sc0 sc1
  buffer_store_dwordx4 v[24:27], v4, s[40:43], s4 offen offset:3072 sc0 sc1
  buffer_store_dwordx2 v[24:25], v2, s[40:43], s10 offen sc0 sc1
  v_mov_b32 v108, v3
  s_mov_b32 s7, s6
  s_branch L_s1
L_comp:
  s_and_b32 s80, s77, 7
  s_lshr_b32 s79, s77, 3
  s_lshl_b32 s78, s80, 1
  s_add_u32 s78, s78, s79
  s_lshl_b32 s5, s76, 4
  s_add_u32 s5, s5, s77
  s_lshl_b32 s84, s5, 11
  s_mov_b32 s83, 3145728
  s_mov_b32 s87, 1835016
  s_lshr_b32 s86, s81, 1
  s_waitcnt lgkmcnt(0)
  s_mov_b32 s40, s38
  s_and_b32 s41, s39, 0xffff
  s_mov_b32 s42, 100663296
  s_mov_b32 s43, 0x00020000
  s_mov_b32 s44, s16
  s_and_b32 s45, s17, 0xffff
  s_mov_b32 s46, 4194304
  s_mov_b32 s47, 0x00020000
  s_mov_b32 s64, s32
  s_and_b32 s65, s33, 0xffff
  s_mov_b32 s66, 4194304
  s_mov_b32 s67, 0x00020000
  s_setprio 1
  v_lshlrev_b32 v11, 4, v1
  v_lshrrev_b32 v2, 3, v1
  v_and_b32 v3, 7, v1
  v_lshlrev_b32 v3, 3, v3
  v_lshl_add_u32 v30, v2, 11, v3
  v_mov_b32 v27, 1
  v_mov_b32 v28, 156416
  v_and_b32 v29, 48, v1
  s_lshl_b32 s4, s76, 16
  s_lshl_b32 s5, s77, 7
  s_add_u32 s4, s4, s5
  v_lshlrev_b32 v24, 12, v1
  v_and_b32 v2, 16, v1
  v_lshl_add_u32 v24, v2, 7, v24
  v_add_u32 v24, s4, v24
  v_lshrrev_b32 v2, 2, v1
  v_lshlrev_b32 v25, 7, v2
  v_and_b32 v2, 3, v1
  v_lshl_add_u32 v25, v2, 3, v25
  v_add_u32 v25, 65536, v25
  v_bfe_u32 v26, v1, 3, 2
  v_and_b32 v2, 15, v1
  v_lshrrev_b32 v3, 2, v29
  v_sub_u32 v2, v2, v3
  s_mov_b32 s4, 0xf149f2ca
  v_mov_b32 v32, s4
  v_subrev_u32 v3, 0, v2
  v_cmp_gt_u32 vcc, 8, v3
  s_nop 1
  v_cndmask_b32_e64 v12, v32, 0, vcc
  v_cmp_ge_i32 vcc, -9, v3
  s_nop 1
  v_cndmask_b32_e64 v16, v32, 0, vcc
  v_mov_b32 v20, v16
  v_subrev_u32 v3, 1, v2
  v_cmp_gt_u32 vcc, 8, v3
  s_nop 1
  v_cndmask_b32_e64 v13, v32, 0, vcc
  v_cmp_ge_i32 vcc, -9, v3
  s_nop 1
  v_cndmask_b32_e64 v17, v32, 0, vcc
  v_mov_b32 v21, v17
  v_subrev_u32 v3, 2, v2
  v_cmp_gt_u32 vcc, 8, v3
  s_nop 1
  v_cndmask_b32_e64 v14, v32, 0, vcc
  v_cmp_ge_i32 vcc, -9, v3
  s_nop 1
  v_cndmask_b32_e64 v18, v32, 0, vcc
  v_mov_b32 v22, v18
  v_subrev_u32 v3, 3, v2
  v_cmp_gt_u32 vcc, 8, v3
  s_nop 1
  v_cndmask_b32_e64 v15, v32, 0, vcc
  v_cmp_ge_i32 vcc, -9, v3
  s_nop 1
  v_cndmask_b32_e64 v19, v32, 0, vcc
  v_mov_b32 v23, v19
  s_cmp_lg_u32 s76, 0
  s_cbranch_scc1 L_1
  v_mov_b32 v20, v32
  v_mov_b32 v21, v32
  v_mov_b32 v22, v32
  v_mov_b32 v23, v32
L_1:
L_clayer:
  s_mov_b32 s16, 0
  s_mov_b32 s17, 20480
  s_mov_b32 s18, 0xffff6000
  s_mov_b32 s19, 0
  s_mov_b32 s20, 24576
  s_mov_b32 s21, 0xffff4000
  s_mul_i32 s4, s85, 10240
  v_add_u32 v4, s4, v11
  v_add_u32 v5, 1024, v4
  s_cmp_lg_u32 s82, 0
  s_cbranch_scc1 L_2
  v_and_b32 v2, 15, v1
  v_lshrrev_b32 v3, 1, v2
  v_lshrrev_b32 v32, 4, v1
  v_xor_b32 v3, v3, v32
  v_lshlrev_b32 v3, 4, v3
  v_lshl_add_u32 v3, v2, 7, v3
  v_add_u32 v4, s4, v3
  v_xor_b32 v3, 64, v3
  v_add_u32 v5, s4, v3
L_2:
  s_lshl_b32 s4, s86, 1
  v_xor_b32 v2, s4, v26
  v_lshl_add_u32 v6, v2, 5, v25
  s_add_u32 s4, s4, 1
  v_xor_b32 v2, s4, v26
  v_lshl_add_u32 v7, v2, 5, v25
  v_mov_b64 v[128:129], 0
  v_mov_b64 v[130:131], 0
  v_mov_b64 v[132:133], 0
  v_mov_b64 v[134:135], 0
  v_mov_b64 v[136:137], 0
  v_mov_b64 v[138:139], 0
  v_mov_b64 v[140:141], 0
  v_mov_b64 v[142:143], 0
  v_mov_b64 v[144:145], 0
  v_mov_b64 v[146:147], 0
  v_mov_b64 v[148:149], 0
  v_mov_b64 v[150:151], 0
  v_mov_b64 v[152:153], 0
  v_mov_b64 v[154:155], 0
  v_mov_b64 v[156:157], 0
  v_mov_b64 v[158:159], 0
  v_mov_b64 v[160:161], 0
  v_mov_b64 v[162:163], 0
  v_mov_b64 v[164:165], 0
  v_mov_b64 v[166:167], 0
  v_mov_b64 v[168:169], 0
  v_mov_b64 v[170:171], 0
  v_mov_b64 v[172:173], 0
  v_mov_b64 v[174:175], 0
  v_mov_b64 v[176:177], 0
  v_mov_b64 v[178:179], 0
  v_mov_b64 v[180:181], 0
  v_mov_b64 v[182:183], 0
  v_mov_b64 v[184:185], 0
  v_mov_b64 v[186:187], 0
  v_mov_b64 v[188:189], 0
  v_mov_b64 v[190:191], 0
  v_mov_b64 v[192:193], 0
  v_mov_b64 v[194:195], 0
  v_mov_b64 v[196:197], 0
  v_mov_b64 v[198:199], 0
  v_mov_b64 v[200:201], 0
  v_mov_b64 v[202:203], 0
  v_mov_b64 v[204:205], 0
  v_mov_b64 v[206:207], 0
  v_mov_b64 v[208:209], 0
  v_mov_b64 v[210:211], 0
  v_mov_b64 v[212:213], 0
  v_mov_b64 v[214:215], 0
  v_mov_b64 v[216:217], 0
  v_mov_b64 v[218:219], 0
  v_mov_b64 v[220:221], 0
  v_mov_b64 v[222:223], 0
  v_mov_b64 v[224:225], 0
  v_mov_b64 v[226:227], 0
  v_mov_b64 v[228:229], 0
  v_mov_b64 v[230:231], 0
  v_mov_b64 v[232:233], 0
  v_mov_b64 v[234:235], 0
  v_mov_b64 v[236:237], 0
  v_mov_b64 v[238:239], 0
  s_mov_b32 s22, 16
  s_barrier
  ds_read_b64_tr_b16 v[52:53], v6 offset:0
  ds_read_b64_tr_b16 v[54:55], v6 offset:2048
  ds_read_b128 v[32:35], v4 offset:0
  ds_read_b128 v[36:39], v4 offset:2048
  ds_read_b128 v[40:43], v4 offset:4096
  ds_read_b128 v[44:47], v4 offset:6144
  ds_read_b128 v[48:51], v4 offset:8192
  ds_read_b64_tr_b16 v[56:57], v7 offset:0
  ds_read_b64_tr_b16 v[58:59], v7 offset:2048
  ds_read_b64_tr_b16 v[60:61], v6 offset:8192
  ds_read_b64_tr_b16 v[62:63], v6 offset:10240
  ds_read_b64_tr_b16 v[64:65], v7 offset:8192
  ds_read_b64_tr_b16 v[66:67], v7 offset:10240
  ds_read_b64_tr_b16 v[68:69], v6 offset:16384
  ds_read_b64_tr_b16 v[70:71], v6 offset:18432
  ds_read_b64_tr_b16 v[72:73], v7 offset:16384
  ds_read_b64_tr_b16 v[74:75], v7 offset:18432
Lk_3:
  s_waitcnt lgkmcnt(0)
  v_mfma_f32_16x16x32_bf16 v[128:131], v[52:55], v[32:35], v[128:131]
  ds_read_b64_tr_b16 v[96:97], v6 offset:4096
  v_mfma_f32_16x16x32_bf16 v[136:139], v[52:55], v[36:39], v[136:139]
  ds_read_b64_tr_b16 v[98:99], v6 offset:6144
  v_mfma_f32_16x16x32_bf16 v[144:147], v[52:55], v[40:43], v[144:147]
  ds_read_b128 v[76:79], v5 offset:0
  v_mfma_f32_16x16x32_bf16 v[152:155], v[52:55], v[44:47], v[152:155]
  ds_read_b128 v[80:83], v5 offset:2048
  v_mfma_f32_16x16x32_bf16 v[132:135], v[56:59], v[32:35], v[132:135]
  ds_read_b128 v[84:87], v5 offset:4096
  v_mfma_f32_16x16x32_bf16 v[140:143], v[56:59], v[36:39], v[140:143]
  ds_read_b128 v[88:91], v5 offset:6144
  v_mfma_f32_16x16x32_bf16 v[148:151], v[56:59], v[40:43], v[148:151]
  ds_read_b128 v[92:95], v5 offset:8192
  v_mfma_f32_16x16x32_bf16 v[156:159], v[56:59], v[44:47], v[156:159]
  ds_read_b64_tr_b16 v[100:101], v7 offset:4096
  v_mfma_f32_16x16x32_bf16 v[160:163], v[60:63], v[32:35], v[160:163]
  ds_read_b64_tr_b16 v[102:103], v7 offset:6144
  v_mfma_f32_16x16x32_bf16 v[168:171], v[60:63], v[36:39], v[168:171]
  ds_read_b64_tr_b16 v[104:105], v6 offset:12288
  v_mfma_f32_16x16x32_bf16 v[176:179], v[60:63], v[40:43], v[176:179]
  ds_read_b64_tr_b16 v[106:107], v6 offset:14336
  v_mfma_f32_16x16x32_bf16 v[184:187], v[60:63], v[44:47], v[184:187]
  ds_read_b64_tr_b16 v[108:109], v7 offset:12288
  v_mfma_f32_16x16x32_bf16 v[192:195], v[60:63], v[48:51], v[192:195]
  ds_read_b64_tr_b16 v[110:111], v7 offset:14336
  v_mfma_f32_16x16x32_bf16 v[164:167], v[64:67], v[32:35], v[164:167]
  ds_read_b64_tr_b16 v[112:113], v6 offset:20480
  v_mfma_f32_16x16x32_bf16 v[172:175], v[64:67], v[36:39], v[172:175]
  ds_read_b64_tr_b16 v[114:115], v6 offset:22528
  v_mfma_f32_16x16x32_bf16 v[180:183], v[64:67], v[40:43], v[180:183]
  ds_read_b64_tr_b16 v[116:117], v7 offset:20480
  v_mfma_f32_16x16x32_bf16 v[188:191], v[64:67], v[44:47], v[188:191]
  ds_read_b64_tr_b16 v[118:119], v7 offset:22528
  v_mfma_f32_16x16x32_bf16 v[196:199], v[64:67], v[48:51], v[196:199]
  s_add_u32 s16, s16, s17
  s_cmp_eq_u32 s16, 61440
  s_cselect_b32 s23, s18, s17
  v_mfma_f32_16x16x32_bf16 v[200:203], v[32:35], v[68:71], v[200:203]
  s_cselect_b32 s16, 0, s16
  v_add_u32 v4, s23, v4
  v_add_u32 v5, s23, v5
  v_mfma_f32_16x16x32_bf16 v[208:211], v[36:39], v[68:71], v[208:211]
  s_add_u32 s19, s19, s20
  s_cmp_eq_u32 s19, 73728
  s_cselect_b32 s23, s21, s20
  v_mfma_f32_16x16x32_bf16 v[216:219], v[40:43], v[68:71], v[216:219]
  s_cselect_b32 s19, 0, s19
  v_add_u32 v6, s23, v6
  v_add_u32 v7, s23, v7
  v_mfma_f32_16x16x32_bf16 v[224:227], v[44:47], v[68:71], v[224:227]
  v_mfma_f32_16x16x32_bf16 v[232:235], v[48:51], v[68:71], v[232:235]
  v_mfma_f32_16x16x32_bf16 v[204:207], v[32:35], v[72:75], v[204:207]
  v_mfma_f32_16x16x32_bf16 v[212:215], v[36:39], v[72:75], v[212:215]
  v_mfma_f32_16x16x32_bf16 v[220:223], v[40:43], v[72:75], v[220:223]
  v_mfma_f32_16x16x32_bf16 v[228:231], v[44:47], v[72:75], v[228:231]
  v_mfma_f32_16x16x32_bf16 v[236:239], v[48:51], v[72:75], v[236:239]
  s_waitcnt lgkmcnt(0)
  s_barrier
  v_mfma_f32_16x16x32_bf16 v[128:131], v[96:99], v[76:79], v[128:131]
  ds_read_b64_tr_b16 v[52:53], v6 offset:0
  v_mfma_f32_16x16x32_bf16 v[136:139], v[96:99], v[80:83], v[136:139]
  ds_read_b64_tr_b16 v[54:55], v6 offset:2048
  v_mfma_f32_16x16x32_bf16 v[144:147], v[96:99], v[84:87], v[144:147]
  ds_read_b128 v[32:35], v4 offset:0
  v_mfma_f32_16x16x32_bf16 v[152:155], v[96:99], v[88:91], v[152:155]
  ds_read_b128 v[36:39], v4 offset:2048
  v_mfma_f32_16x16x32_bf16 v[132:135], v[100:103], v[76:79], v[132:135]
  ds_read_b128 v[40:43], v4 offset:4096
  v_mfma_f32_16x16x32_bf16 v[140:143], v[100:103], v[80:83], v[140:143]
  ds_read_b128 v[44:47], v4 offset:6144
  v_mfma_f32_16x16x32_bf16 v[148:151], v[100:103], v[84:87], v[148:151]
  ds_read_b128 v[48:51], v4 offset:8192
  v_mfma_f32_16x16x32_bf16 v[156:159], v[100:103], v[88:91], v[156:159]
  ds_read_b64_tr_b16 v[56:57], v7 offset:0
  v_mfma_f32_16x16x32_bf16 v[160:163], v[104:107], v[76:79], v[160:163]
  ds_read_b64_tr_b16 v[58:59], v7 offset:2048
  v_mfma_f32_16x16x32_bf16 v[168:171], v[104:107], v[80:83], v[168:171]
  ds_read_b64_tr_b16 v[60:61], v6 offset:8192
  v_mfma_f32_16x16x32_bf16 v[176:179], v[104:107], v[84:87], v[176:179]
  ds_read_b64_tr_b16 v[62:63], v6 offset:10240
  v_mfma_f32_16x16x32_bf16 v[184:187], v[104:107], v[88:91], v[184:187]
  ds_read_b64_tr_b16 v[64:65], v7 offset:8192
  v_mfma_f32_16x16x32_bf16 v[192:195], v[104:107], v[92:95], v[192:195]
  ds_read_b64_tr_b16 v[66:67], v7 offset:10240
  v_mfma_f32_16x16x32_bf16 v[164:167], v[108:111], v[76:79], v[164:167]
  ds_read_b64_tr_b16 v[68:69], v6 offset:16384
  v_mfma_f32_16x16x32_bf16 v[172:175], v[108:111], v[80:83], v[172:175]
  ds_read_b64_tr_b16 v[70:71], v6 offset:18432
  v_mfma_f32_16x16x32_bf16 v[180:183], v[108:111], v[84:87], v[180:183]
  ds_read_b64_tr_b16 v[72:73], v7 offset:16384
  v_mfma_f32_16x16x32_bf16 v[188:191], v[108:111], v[88:91], v[188:191]
  ds_read_b64_tr_b16 v[74:75], v7 offset:18432
  v_mfma_f32_16x16x32_bf16 v[196:199], v[108:111], v[92:95], v[196:199]
  s_sub_u32 s22, s22, 1
  v_mfma_f32_16x16x32_bf16 v[200:203], v[76:79], v[112:115], v[200:203]
  s_cmp_lg_u32 s22, 0
  v_mfma_f32_16x16x32_bf16 v[208:211], v[80:83], v[112:115], v[208:211]
  v_mfma_f32_16x16x32_bf16 v[216:219], v[84:87], v[112:115], v[216:219]
  v_mfma_f32_16x16x32_bf16 v[224:227], v[88:91], v[112:115], v[224:227]
  v_mfma_f32_16x16x32_bf16 v[232:235], v[92:95], v[112:115], v[232:235]
  v_mfma_f32_16x16x32_bf16 v[204:207], v[76:79], v[116:119], v[204:207]
  v_mfma_f32_16x16x32_bf16 v[212:215], v[80:83], v[116:119], v[212:215]
  v_mfma_f32_16x16x32_bf16 v[220:223], v[84:87], v[116:119], v[220:223]
  v_mfma_f32_16x16x32_bf16 v[228:231], v[88:91], v[116:119], v[228:231]
  v_mfma_f32_16x16x32_bf16 v[236:239], v[92:95], v[116:119], v[236:239]
  s_cbranch_scc1 Lk_3
  s_cmp_lg_u32 s82, 0
  s_cbranch_scc1 L_4
  v_and_b32 v2, 15, v1
  v_lshlrev_b32 v3, 12, v2
  v_and_b32 v2, 16, v1
  v_lshl_add_u32 v3, v2, 1, v3
  v_and_b32 v2, 32, v1
  v_lshrrev_b32 v2, 1, v2
  v_add_u32 v3, v2, v3
  s_lshl_b32 s5, s76, 18
  s_lshl_b32 s4, s85, 11
  s_add_u32 s5, s5, s4
  s_lshl_b32 s4, s78, 7
  s_add_u32 s5, s5, s4
  s_lshl_b32 s4, s86, 6
  s_add_u32 s5, s5, s4
  buffer_load_dwordx4 v[240:243], v3, s[44:47], s5 offen
  s_add_u32 s5, s5, 0x10000
  buffer_load_dwordx4 v[244:247], v3, s[44:47], s5 offen
  s_add_u32 s5, s5, 0x10000
  buffer_load_dwordx4 v[248:251], v3, s[44:47], s5 offen
  s_add_u32 s5, s5, 0x10000
  buffer_load_dwordx4 v[252:255], v3, s[44:47], s5 offen
L_4:
  s_waitcnt lgkmcnt(0)
  s_mul_i32 s4, s85, 320
  s_add_u32 s4, s4, 151552
  v_and_b32 v2, 15, v1
  v_lshl_add_u32 v3, v2, 2, s4
  ds_read2_b32 v[88:89], v3 offset0:0 offset1:160
  ds_read2_b32 v[90:91], v3 offset0:16 offset1:176
  ds_read2_b32 v[92:93], v3 offset0:32 offset1:192
  ds_read2_b32 v[94:95], v3 offset0:48 offset1:208
  ds_read2_b32 v[96:97], v3 offset0:64 offset1:224
  s_lshl_b32 s5, s86, 7
  s_add_u32 s5, s5, 153088
  v_add_u32 v3, s5, v29
  ds_read_b128 v[98:101], v3 offset:0
  ds_read_b128 v[102:105], v3 offset:64
  ds_read_b128 v[106:109], v3 offset:256
  ds_read_b128 v[110:113], v3 offset:320
  v_lshl_add_u32 v3, v2, 2, s5
  ds_read2_b32 v[114:115], v3 offset0:128 offset1:144
  v_add_u32 v124, s4, v29
  v_mov_b32 v120, 0x3f803f80
  v_mov_b32 v121, 0x3f803f80
  v_mov_b32 v122, 0x3f803f80
  v_mov_b32 v123, 0x3f803f80
  s_waitcnt lgkmcnt(0)
  v_pk_mul_f32 v[116:117], v[98:99], v[88:89] op_sel:[0,1] op_sel_hi:[1,1]
  v_pk_mul_f32 v[118:119], v[100:101], v[88:89] op_sel:[0,1] op_sel_hi:[1,1]
  v_pk_fma_f32 v[128:129], v[128:129], v[88:89], v[116:117] op_sel:[0,0,0] op_sel_hi:[1,0,1] neg_lo:[0,0,1] neg_hi:[0,0,1]
  v_pk_fma_f32 v[130:131], v[130:131], v[88:89], v[118:119] op_sel:[0,0,0] op_sel_hi:[1,0,1] neg_lo:[0,0,1] neg_hi:[0,0,1]
  v_cvt_pk_bf16_f32 v32, v128, v129
  v_cvt_pk_bf16_f32 v33, v130, v131
  v_pk_mul_f32 v[116:117], v[102:103], v[88:89] op_sel:[0,1] op_sel_hi:[1,1]
  v_pk_mul_f32 v[118:119], v[104:105], v[88:89] op_sel:[0,1] op_sel_hi:[1,1]
  v_pk_fma_f32 v[132:133], v[132:133], v[88:89], v[116:117] op_sel:[0,0,0] op_sel_hi:[1,0,1] neg_lo:[0,0,1] neg_hi:[0,0,1]
  v_pk_fma_f32 v[134:135], v[134:135], v[88:89], v[118:119] op_sel:[0,0,0] op_sel_hi:[1,0,1] neg_lo:[0,0,1] neg_hi:[0,0,1]
  v_cvt_pk_bf16_f32 v34, v132, v133
  v_cvt_pk_bf16_f32 v35, v134, v135
  v_pk_mul_f32 v[116:117], v[98:99], v[90:91] op_sel:[0,1] op_sel_hi:[1,1]
  v_pk_mul_f32 v[118:119], v[100:101], v[90:91] op_sel:[0,1] op_sel_hi:[1,1]
  v_pk_fma_f32 v[136:137], v[136:137], v[90:91], v[116:117] op_sel:[0,0,0] op_sel_hi:[1,0,1] neg_lo:[0,0,1] neg_hi:[0,0,1]
  v_pk_fma_f32 v[138:139], v[138:139], v[90:91], v[118:119] op_sel:[0,0,0] op_sel_hi:[1,0,1] neg_lo:[0,0,1] neg_hi:[0,0,1]
  v_cvt_pk_bf16_f32 v36, v136, v137
  v_cvt_pk_bf16_f32 v37, v138, v139
  v_pk_mul_f32 v[116:117], v[102:103], v[90:91] op_sel:[0,1] op_sel_hi:[1,1]
  v_pk_mul_f32 v[118:119], v[104:105], v[90:91] op_sel:[0,1] op_sel_hi:[1,1]
  v_pk_fma_f32 v[140:141], v[140:141], v[90:91], v[116:117] op_sel:[0,0,0] op_sel_hi:[1,0,1] neg_lo:[0,0,1] neg_hi:[0,0,1]
  v_pk_fma_f32 v[142:143], v[142:143], v[90:91], v[118:119] op_sel:[0,0,0] op_sel_hi:[1,0,1] neg_lo:[0,0,1] neg_hi:[0,0,1]
  v_cvt_pk_bf16_f32 v38, v140, v141
  v_cvt_pk_bf16_f32 v39, v142, v143
  v_pk_mul_f32 v[116:117], v[98:99], v[92:93] op_sel:[0,1] op_sel_hi:[1,1]
  v_pk_mul_f32 v[118:119], v[100:101], v[92:93] op_sel:[0,1] op_sel_hi:[1,1]
  v_pk_fma_f32 v[144:145], v[144:145], v[92:93], v[116:117] op_sel:[0,0,0] op_sel_hi:[1,0,1] neg_lo:[0,0,1] neg_hi:[0,0,1]
  v_pk_fma_f32 v[146:147], v[146:147], v[92:93], v[118:119] op_sel:[0,0,0] op_sel_hi:[1,0,1] neg_lo:[0,0,1] neg_hi:[0,0,1]
  v_cvt_pk_bf16_f32 v40, v144, v145
  v_cvt_pk_bf16_f32 v41, v146, v147
  v_pk_mul_f32 v[116:117], v[102:103], v[92:93] op_sel:[0,1] op_sel_hi:[1,1]
  v_pk_mul_f32 v[118:119], v[104:105], v[92:93] op_sel:[0,1] op_sel_hi:[1,1]
  v_pk_fma_f32 v[148:149], v[148:149], v[92:93], v[116:117] op_sel:[0,0,0] op_sel_hi:[1,0,1] neg_lo:[0,0,1] neg_hi:[0,0,1]
  v_pk_fma_f32 v[150:151], v[150:151], v[92:93], v[118:119] op_sel:[0,0,0] op_sel_hi:[1,0,1] neg_lo:[0,0,1] neg_hi:[0,0,1]
  v_cvt_pk_bf16_f32 v42, v148, v149
  v_cvt_pk_bf16_f32 v43, v150, v151
  v_pk_mul_f32 v[116:117], v[98:99], v[94:95] op_sel:[0,1] op_sel_hi:[1,1]
  v_pk_mul_f32 v[118:119], v[100:101], v[94:95] op_sel:[0,1] op_sel_hi:[1,1]
  v_pk_fma_f32 v[152:153], v[152:153], v[94:95], v[116:117] op_sel:[0,0,0] op_sel_hi:[1,0,1] neg_lo:[0,0,1] neg_hi:[0,0,1]
  v_pk_fma_f32 v[154:155], v[154:155], v[94:95], v[118:119] op_sel:[0,0,0] op_sel_hi:[1,0,1] neg_lo:[0,0,1] neg_hi:[0,0,1]
  v_cvt_pk_bf16_f32 v44, v152, v153
  v_cvt_pk_bf16_f32 v45, v154, v155
  v_pk_mul_f32 v[116:117], v[102:103], v[94:95] op_sel:[0,1] op_sel_hi:[1,1]
  v_pk_mul_f32 v[118:119], v[104:105], v[94:95] op_sel:[0,1] op_sel_hi:[1,1]
  v_pk_fma_f32 v[156:157], v[156:157], v[94:95], v[116:117] op_sel:[0,0,0] op_sel_hi:[1,0,1] neg_lo:[0,0,1] neg_hi:[0,0,1]
  v_pk_fma_f32 v[158:159], v[158:159], v[94:95], v[118:119] op_sel:[0,0,0] op_sel_hi:[1,0,1] neg_lo:[0,0,1] neg_hi:[0,0,1]
  v_cvt_pk_bf16_f32 v46, v156, v157
  v_cvt_pk_bf16_f32 v47, v158, v159
  ds_read_b128 v[128:131], v124 offset:0
  ds_read_b128 v[132:135], v124 offset:640
  ds_read_b128 v[136:139], v124 offset:64
  ds_read_b128 v[140:143], v124 offset:704
  ds_read_b128 v[144:147], v124 offset:128
  ds_read_b128 v[148:151], v124 offset:768
  ds_read_b128 v[152:155], v124 offset:192
  ds_read_b128 v[156:159], v124 offset:832
  ds_read_b128 v[98:101], v124 offset:256
  ds_read_b128 v[102:105], v124 offset:896
  v_pk_mul_f32 v[116:117], v[106:107], v[96:97] op_sel:[0,1] op_sel_hi:[1,1]
  v_pk_mul_f32 v[118:119], v[108:109], v[96:97] op_sel:[0,1] op_sel_hi:[1,1]
  v_pk_fma_f32 v[192:193], v[192:193], v[96:97], v[116:117] op_sel:[0,0,0] op_sel_hi:[1,0,1] neg_lo:[0,0,1] neg_hi:[0,0,1]
  v_pk_fma_f32 v[194:195], v[194:195], v[96:97], v[118:119] op_sel:[0,0,0] op_sel_hi:[1,0,1] neg_lo:[0,0,1] neg_hi:[0,0,1]
  v_cvt_pk_bf16_f32 v64, v192, v193
  v_cvt_pk_bf16_f32 v65, v194, v195
  v_pk_mul_f32 v[116:117], v[110:111], v[96:97] op_sel:[0,1] op_sel_hi:[1,1]
  v_pk_mul_f32 v[118:119], v[112:113], v[96:97] op_sel:[0,1] op_sel_hi:[1,1]
  v_pk_fma_f32 v[196:197], v[196:197], v[96:97], v[116:117] op_sel:[0,0,0] op_sel_hi:[1,0,1] neg_lo:[0,0,1] neg_hi:[0,0,1]
  v_pk_fma_f32 v[198:199], v[198:199], v[96:97], v[118:119] op_sel:[0,0,0] op_sel_hi:[1,0,1] neg_lo:[0,0,1] neg_hi:[0,0,1]
  v_cvt_pk_bf16_f32 v66, v196, v197
  v_cvt_pk_bf16_f32 v67, v198, v199
  v_pk_mul_f32 v[116:117], v[106:107], v[88:89] op_sel:[0,1] op_sel_hi:[1,1]
  v_pk_mul_f32 v[118:119], v[108:109], v[88:89] op_sel:[0,1] op_sel_hi:[1,1]
  v_pk_fma_f32 v[160:161], v[160:161], v[88:89], v[116:117] op_sel:[0,0,0] op_sel_hi:[1,0,1] neg_lo:[0,0,1] neg_hi:[0,0,1]
  v_pk_fma_f32 v[162:163], v[162:163], v[88:89], v[118:119] op_sel:[0,0,0] op_sel_hi:[1,0,1] neg_lo:[0,0,1] neg_hi:[0,0,1]
  v_cvt_pk_bf16_f32 v48, v160, v161
  v_cvt_pk_bf16_f32 v49, v162, v163
  v_pk_mul_f32 v[116:117], v[110:111], v[88:89] op_sel:[0,1] op_sel_hi:[1,1]
  v_pk_mul_f32 v[118:119], v[112:113], v[88:89] op_sel:[0,1] op_sel_hi:[1,1]
  v_pk_fma_f32 v[164:165], v[164:165], v[88:89], v[116:117] op_sel:[0,0,0] op_sel_hi:[1,0,1] neg_lo:[0,0,1] neg_hi:[0,0,1]
  v_pk_fma_f32 v[166:167], v[166:167], v[88:89], v[118:119] op_sel:[0,0,0] op_sel_hi:[1,0,1] neg_lo:[0,0,1] neg_hi:[0,0,1]
  v_cvt_pk_bf16_f32 v50, v164, v165
  v_cvt_pk_bf16_f32 v51, v166, v167
  v_pk_mul_f32 v[116:117], v[106:107], v[90:91] op_sel:[0,1] op_sel_hi:[1,1]
  v_pk_mul_f32 v[118:119], v[108:109], v[90:91] op_sel:[0,1] op_sel_hi:[1,1]
  v_pk_fma_f32 v[168:169], v[168:169], v[90:91], v[116:117] op_sel:[0,0,0] op_sel_hi:[1,0,1] neg_lo:[0,0,1] neg_hi:[0,0,1]
  v_pk_fma_f32 v[170:171], v[170:171], v[90:91], v[118:119] op_sel:[0,0,0] op_sel_hi:[1,0,1] neg_lo:[0,0,1] neg_hi:[0,0,1]
  v_cvt_pk_bf16_f32 v52, v168, v169
  v_cvt_pk_bf16_f32 v53, v170, v171
  v_pk_mul_f32 v[116:117], v[110:111], v[90:91] op_sel:[0,1] op_sel_hi:[1,1]
  v_pk_mul_f32 v[118:119], v[112:113], v[90:91] op_sel:[0,1] op_sel_hi:[1,1]
  v_pk_fma_f32 v[172:173], v[172:173], v[90:91], v[116:117] op_sel:[0,0,0] op_sel_hi:[1,0,1] neg_lo:[0,0,1] neg_hi:[0,0,1]
  v_pk_fma_f32 v[174:175], v[174:175], v[90:91], v[118:119] op_sel:[0,0,0] op_sel_hi:[1,0,1] neg_lo:[0,0,1] neg_hi:[0,0,1]
  v_cvt_pk_bf16_f32 v54, v172, v173
  v_cvt_pk_bf16_f32 v55, v174, v175
  v_pk_mul_f32 v[116:117], v[106:107], v[92:93] op_sel:[0,1] op_sel_hi:[1,1]
  v_pk_mul_f32 v[118:119], v[108:109], v[92:93] op_sel:[0,1] op_sel_hi:[1,1]
  v_pk_fma_f32 v[176:177], v[176:177], v[92:93], v[116:117] op_sel:[0,0,0] op_sel_hi:[1,0,1] neg_lo:[0,0,1] neg_hi:[0,0,1]
  v_pk_fma_f32 v[178:179], v[178:179], v[92:93], v[118:119] op_sel:[0,0,0] op_sel_hi:[1,0,1] neg_lo:[0,0,1] neg_hi:[0,0,1]
  v_cvt_pk_bf16_f32 v56, v176, v177
  v_cvt_pk_bf16_f32 v57, v178, v179
  v_pk_mul_f32 v[116:117], v[110:111], v[92:93] op_sel:[0,1] op_sel_hi:[1,1]
  v_pk_mul_f32 v[118:119], v[112:113], v[92:93] op_sel:[0,1] op_sel_hi:[1,1]
  v_pk_fma_f32 v[180:181], v[180:181], v[92:93], v[116:117] op_sel:[0,0,0] op_sel_hi:[1,0,1] neg_lo:[0,0,1] neg_hi:[0,0,1]
  v_pk_fma_f32 v[182:183], v[182:183], v[92:93], v[118:119] op_sel:[0,0,0] op_sel_hi:[1,0,1] neg_lo:[0,0,1] neg_hi:[0,0,1]
  v_cvt_pk_bf16_f32 v58, v180, v181
  v_cvt_pk_bf16_f32 v59, v182, v183
  v_pk_mul_f32 v[116:117], v[106:107], v[94:95] op_sel:[0,1] op_sel_hi:[1,1]
  v_pk_mul_f32 v[118:119], v[108:109], v[94:95] op_sel:[0,1] op_sel_hi:[1,1]
  v_pk_fma_f32 v[184:185], v[184:185], v[94:95], v[116:117] op_sel:[0,0,0] op_sel_hi:[1,0,1] neg_lo:[0,0,1] neg_hi:[0,0,1]
  v_pk_fma_f32 v[186:187], v[186:187], v[94:95], v[118:119] op_sel:[0,0,0] op_sel_hi:[1,0,1] neg_lo:[0,0,1] neg_hi:[0,0,1]
  v_cvt_pk_bf16_f32 v60, v184, v185
  v_cvt_pk_bf16_f32 v61, v186, v187
  v_pk_mul_f32 v[116:117], v[110:111], v[94:95] op_sel:[0,1] op_sel_hi:[1,1]
  v_pk_mul_f32 v[118:119], v[112:113], v[94:95] op_sel:[0,1] op_sel_hi:[1,1]
  v_pk_fma_f32 v[188:189], v[188:189], v[94:95], v[116:117] op_sel:[0,0,0] op_sel_hi:[1,0,1] neg_lo:[0,0,1] neg_hi:[0,0,1]
  v_pk_fma_f32 v[190:191], v[190:191], v[94:95], v[118:119] op_sel:[0,0,0] op_sel_hi:[1,0,1] neg_lo:[0,0,1] neg_hi:[0,0,1]
  v_cvt_pk_bf16_f32 v62, v188, v189
  v_cvt_pk_bf16_f32 v63, v190, v191
  v_mfma_f32_16x16x32_bf16 v[160:163], v[64:67], v[32:35], v[20:23]
  v_mfma_f32_16x16x32_bf16 v[164:167], v[48:51], v[32:35], v[12:15]
  v_mfma_f32_16x16x32_bf16 v[168:171], v[48:51], v[36:39], v[16:19]
  v_mfma_f32_16x16x32_bf16 v[172:175], v[52:55], v[36:39], v[12:15]
  v_mfma_f32_16x16x32_bf16 v[176:179], v[52:55], v[40:43], v[16:19]
  v_mfma_f32_16x16x32_bf16 v[180:183], v[56:59], v[40:43], v[12:15]
  v_mfma_f32_16x16x32_bf16 v[184:187], v[56:59], v[44:47], v[16:19]
  v_mfma_f32_16x16x32_bf16 v[188:191], v[60:63], v[44:47], v[12:15]
  s_waitcnt lgkmcnt(0)
  v_pk_mul_f32 v[116:117], v[132:133], v[114:115] op_sel:[0,0] op_sel_hi:[1,0]
  v_pk_mul_f32 v[118:119], v[134:135], v[114:115] op_sel:[0,0] op_sel_hi:[1,0]
  v_pk_fma_f32 v[200:201], v[200:201], v[128:129], v[116:117] neg_lo:[0,0,1] neg_hi:[0,0,1]
  v_pk_fma_f32 v[202:203], v[202:203], v[130:131], v[118:119] neg_lo:[0,0,1] neg_hi:[0,0,1]
  v_cvt_pk_bf16_f32 v70, v200, v201
  v_cvt_pk_bf16_f32 v71, v202, v203
  v_pk_mul_f32 v[116:117], v[132:133], v[114:115] op_sel:[0,1] op_sel_hi:[1,1]
  v_pk_mul_f32 v[118:119], v[134:135], v[114:115] op_sel:[0,1] op_sel_hi:[1,1]
  v_pk_fma_f32 v[204:205], v[204:205], v[128:129], v[116:117] neg_lo:[0,0,1] neg_hi:[0,0,1]
  v_pk_fma_f32 v[206:207], v[206:207], v[130:131], v[118:119] neg_lo:[0,0,1] neg_hi:[0,0,1]
  v_cvt_pk_bf16_f32 v80, v204, v205
  v_cvt_pk_bf16_f32 v81, v206, v207
  v_pk_mul_f32 v[116:117], v[140:141], v[114:115] op_sel:[0,0] op_sel_hi:[1,0]
  v_pk_mul_f32 v[118:119], v[142:143], v[114:115] op_sel:[0,0] op_sel_hi:[1,0]
  v_pk_fma_f32 v[208:209], v[208:209], v[136:137], v[116:117] neg_lo:[0,0,1] neg_hi:[0,0,1]
  v_pk_fma_f32 v[210:211], v[210:211], v[138:139], v[118:119] neg_lo:[0,0,1] neg_hi:[0,0,1]
  v_cvt_pk_bf16_f32 v72, v208, v209
  v_cvt_pk_bf16_f32 v73, v210, v211
  v_pk_mul_f32 v[116:117], v[140:141], v[114:115] op_sel:[0,1] op_sel_hi:[1,1]
  v_pk_mul_f32 v[118:119], v[142:143], v[114:115] op_sel:[0,1] op_sel_hi:[1,1]
  v_pk_fma_f32 v[212:213], v[212:213], v[136:137], v[116:117] neg_lo:[0,0,1] neg_hi:[0,0,1]
  v_pk_fma_f32 v[214:215], v[214:215], v[138:139], v[118:119] neg_lo:[0,0,1] neg_hi:[0,0,1]
  v_cvt_pk_bf16_f32 v82, v212, v213
  v_cvt_pk_bf16_f32 v83, v214, v215
  v_pk_mul_f32 v[116:117], v[148:149], v[114:115] op_sel:[0,0] op_sel_hi:[1,0]
  v_pk_mul_f32 v[118:119], v[150:151], v[114:115] op_sel:[0,0] op_sel_hi:[1,0]
  v_pk_fma_f32 v[216:217], v[216:217], v[144:145], v[116:117] neg_lo:[0,0,1] neg_hi:[0,0,1]
  v_pk_fma_f32 v[218:219], v[218:219], v[146:147], v[118:119] neg_lo:[0,0,1] neg_hi:[0,0,1]
  v_cvt_pk_bf16_f32 v74, v216, v217
  v_cvt_pk_bf16_f32 v75, v218, v219
  v_pk_mul_f32 v[116:117], v[148:149], v[114:115] op_sel:[0,1] op_sel_hi:[1,1]
  v_pk_mul_f32 v[118:119], v[150:151], v[114:115] op_sel:[0,1] op_sel_hi:[1,1]
  v_pk_fma_f32 v[220:221], v[220:221], v[144:145], v[116:117] neg_lo:[0,0,1] neg_hi:[0,0,1]
  v_pk_fma_f32 v[222:223], v[222:223], v[146:147], v[118:119] neg_lo:[0,0,1] neg_hi:[0,0,1]
  v_cvt_pk_bf16_f32 v84, v220, v221
  v_cvt_pk_bf16_f32 v85, v222, v223
  v_pk_mul_f32 v[116:117], v[156:157], v[114:115] op_sel:[0,0] op_sel_hi:[1,0]
  v_pk_mul_f32 v[118:119], v[158:159], v[114:115] op_sel:[0,0] op_sel_hi:[1,0]
  v_pk_fma_f32 v[224:225], v[224:225], v[152:153], v[116:117] neg_lo:[0,0,1] neg_hi:[0,0,1]
  v_pk_fma_f32 v[226:227], v[226:227], v[154:155], v[118:119] neg_lo:[0,0,1] neg_hi:[0,0,1]
  v_cvt_pk_bf16_f32 v76, v224, v225
  v_cvt_pk_bf16_f32 v77, v226, v227
  v_pk_mul_f32 v[116:117], v[156:157], v[114:115] op_sel:[0,1] op_sel_hi:[1,1]
  v_pk_mul_f32 v[118:119], v[158:159], v[114:115] op_sel:[0,1] op_sel_hi:[1,1]
  v_pk_fma_f32 v[228:229], v[228:229], v[152:153], v[116:117] neg_lo:[0,0,1] neg_hi:[0,0,1]
  v_pk_fma_f32 v[230:231], v[230:231], v[154:155], v[118:119] neg_lo:[0,0,1] neg_hi:[0,0,1]
  v_cvt_pk_bf16_f32 v86, v228, v229
  v_cvt_pk_bf16_f32 v87, v230, v231
  v_pk_mul_f32 v[116:117], v[102:103], v[114:115] op_sel:[0,0] op_sel_hi:[1,0]
  v_pk_mul_f32 v[118:119], v[104:105], v[114:115] op_sel:[0,0] op_sel_hi:[1,0]
  v_pk_fma_f32 v[232:233], v[232:233], v[98:99], v[116:117] neg_lo:[0,0,1] neg_hi:[0,0,1]
  v_pk_fma_f32 v[234:235], v[234:235], v[100:101], v[118:119] neg_lo:[0,0,1] neg_hi:[0,0,1]
  v_cvt_pk_bf16_f32 v68, v232, v233
  v_cvt_pk_bf16_f32 v69, v234, v235
  v_pk_mul_f32 v[116:117], v[102:103], v[114:115] op_sel:[0,1] op_sel_hi:[1,1]
  v_pk_mul_f32 v[118:119], v[104:105], v[114:115] op_sel:[0,1] op_sel_hi:[1,1]
  v_pk_fma_f32 v[236:237], v[236:237], v[98:99], v[116:117] neg_lo:[0,0,1] neg_hi:[0,0,1]
  v_pk_fma_f32 v[238:239], v[238:239], v[100:101], v[118:119] neg_lo:[0,0,1] neg_hi:[0,0,1]
  v_cvt_pk_bf16_f32 v78, v236, v237
  v_cvt_pk_bf16_f32 v79, v238, v239
  v_max3_f32 v88, v160, v161, v162
  v_max3_f32 v98, v163, v164, v165
  v_max3_f32 v90, v168, v169, v170
  v_max3_f32 v99, v171, v172, v173
  v_max3_f32 v92, v176, v177, v178
  v_max3_f32 v100, v179, v180, v181
  v_max3_f32 v94, v184, v185, v186
  v_max3_f32 v101, v187, v188, v189
  v_max3_f32 v88, v88, v166, v167
  v_max3_f32 v90, v90, v174, v175
  v_max3_f32 v92, v92, v182, v183
  v_max3_f32 v94, v94, v190, v191
  v_max_f32 v88, v88, v98
  v_max_f32 v90, v90, v99
  v_max_f32 v92, v92, v100
  v_max_f32 v94, v94, v101
  v_mov_b32 v98, v88
  v_mov_b32 v99, v90
  v_mov_b32 v100, v92
  v_mov_b32 v101, v94
  v_permlane32_swap_b32 v88, v98
  v_permlane32_swap_b32 v90, v99
  v_permlane32_swap_b32 v92, v100
  v_permlane32_swap_b32 v94, v101
  v_max_f32 v88, v88, v98
  v_max_f32 v90, v90, v99
  v_max_f32 v92, v92, v100
  v_max_f32 v94, v94, v101
  v_mov_b32 v98, v88
  v_mov_b32 v99, v90
  v_mov_b32 v100, v92
  v_mov_b32 v101, v94
  v_permlane16_swap_b32 v88, v98
  v_permlane16_swap_b32 v90, v99
  v_permlane16_swap_b32 v92, v100
  v_permlane16_swap_b32 v94, v101
  v_max_f32 v88, v88, v98
  v_max_f32 v90, v90, v99
  v_max_f32 v92, v92, v100
  v_max_f32 v94, v94, v101
  s_mov_b32 s4, 0x3e8293ee
  v_mul_f32 v88, s4, v88
  v_mov_b32 v89, s4
  v_mul_f32 v90, s4, v90
  v_mov_b32 v91, s4
  v_mul_f32 v92, s4, v92
  v_mov_b32 v93, s4
  v_mul_f32 v94, s4, v94
  v_mov_b32 v95, s4
  v_pk_fma_f32 v[160:161], v[160:161], v[88:89], v[88:89] op_sel:[0,1,0] op_sel_hi:[1,1,0] neg_lo:[0,0,1] neg_hi:[0,0,1]
  v_pk_fma_f32 v[162:163], v[162:163], v[88:89], v[88:89] op_sel:[0,1,0] op_sel_hi:[1,1,0] neg_lo:[0,0,1] neg_hi:[0,0,1]
  v_pk_fma_f32 v[164:165], v[164:165], v[88:89], v[88:89] op_sel:[0,1,0] op_sel_hi:[1,1,0] neg_lo:[0,0,1] neg_hi:[0,0,1]
  v_pk_fma_f32 v[166:167], v[166:167], v[88:89], v[88:89] op_sel:[0,1,0] op_sel_hi:[1,1,0] neg_lo:[0,0,1] neg_hi:[0,0,1]
  v_pk_fma_f32 v[168:169], v[168:169], v[90:91], v[90:91] op_sel:[0,1,0] op_sel_hi:[1,1,0] neg_lo:[0,0,1] neg_hi:[0,0,1]
  v_pk_fma_f32 v[170:171], v[170:171], v[90:91], v[90:91] op_sel:[0,1,0] op_sel_hi:[1,1,0] neg_lo:[0,0,1] neg_hi:[0,0,1]
  v_pk_fma_f32 v[172:173], v[172:173], v[90:91], v[90:91] op_sel:[0,1,0] op_sel_hi:[1,1,0] neg_lo:[0,0,1] neg_hi:[0,0,1]
  v_pk_fma_f32 v[174:175], v[174:175], v[90:91], v[90:91] op_sel:[0,1,0] op_sel_hi:[1,1,0] neg_lo:[0,0,1] neg_hi:[0,0,1]
  v_pk_fma_f32 v[176:177], v[176:177], v[92:93], v[92:93] op_sel:[0,1,0] op_sel_hi:[1,1,0] neg_lo:[0,0,1] neg_hi:[0,0,1]
  v_pk_fma_f32 v[178:179], v[178:179], v[92:93], v[92:93] op_sel:[0,1,0] op_sel_hi:[1,1,0] neg_lo:[0,0,1] neg_hi:[0,0,1]
  v_pk_fma_f32 v[180:181], v[180:181], v[92:93], v[92:93] op_sel:[0,1,0] op_sel_hi:[1,1,0] neg_lo:[0,0,1] neg_hi:[0,0,1]
  v_pk_fma_f32 v[182:183], v[182:183], v[92:93], v[92:93] op_sel:[0,1,0] op_sel_hi:[1,1,0] neg_lo:[0,0,1] neg_hi:[0,0,1]
  v_pk_fma_f32 v[184:185], v[184:185], v[94:95], v[94:95] op_sel:[0,1,0] op_sel_hi:[1,1,0] neg_lo:[0,0,1] neg_hi:[0,0,1]
  v_pk_fma_f32 v[186:187], v[186:187], v[94:95], v[94:95] op_sel:[0,1,0] op_sel_hi:[1,1,0] neg_lo:[0,0,1] neg_hi:[0,0,1]
  v_pk_fma_f32 v[188:189], v[188:189], v[94:95], v[94:95] op_sel:[0,1,0] op_sel_hi:[1,1,0] neg_lo:[0,0,1] neg_hi:[0,0,1]
  v_pk_fma_f32 v[190:191], v[190:191], v[94:95], v[94:95] op_sel:[0,1,0] op_sel_hi:[1,1,0] neg_lo:[0,0,1] neg_hi:[0,0,1]
  s_lshl_b32 s4, s76, 5
  s_lshl_b32 s5, s77, 1
  s_add_u32 s4, s4, s5
  s_add_u32 s4, s4, s86
  s_lshl_b32 s6, s4, 13
  s_lshl_b32 s7, s85, 12
  s_add_u32 s6, s6, s7
  s_add_u32 s6, s6, s83
  v_exp_f32 v160, v160
  v_exp_f32 v161, v161
  v_exp_f32 v162, v162
  v_exp_f32 v163, v163
  v_exp_f32 v164, v164
  v_exp_f32 v165, v165
  v_exp_f32 v166, v166
  v_exp_f32 v167, v167
  v_cvt_pk_bf16_f32 v32, v160, v161
  v_cvt_pk_bf16_f32 v33, v162, v163
  v_cvt_pk_bf16_f32 v34, v164, v165
  v_cvt_pk_bf16_f32 v35, v166, v167
  v_exp_f32 v168, v168
  v_exp_f32 v169, v169
  v_exp_f32 v170, v170
  v_exp_f32 v171, v171
  v_exp_f32 v172, v172
  v_exp_f32 v173, v173
  v_exp_f32 v174, v174
  v_exp_f32 v175, v175
  v_cvt_pk_bf16_f32 v36, v168, v169
  v_cvt_pk_bf16_f32 v37, v170, v171
  v_cvt_pk_bf16_f32 v38, v172, v173
  v_cvt_pk_bf16_f32 v39, v174, v175
  v_mfma_f32_16x16x32_bf16 v[128:131], v[120:123], v[32:35], 0
  v_mfma_f32_16x16x32_bf16 v[200:203], v[68:71], v[32:35], 0
  v_mfma_f32_16x16x32_bf16 v[204:207], v[78:81], v[32:35], 0
  v_exp_f32 v176, v176
  v_exp_f32 v177, v177
  v_exp_f32 v178, v178
  v_exp_f32 v179, v179
  v_exp_f32 v180, v180
  v_exp_f32 v181, v181
  v_exp_f32 v182, v182
  v_exp_f32 v183, v183
  v_cvt_pk_bf16_f32 v40, v176, v177
  v_cvt_pk_bf16_f32 v41, v178, v179
  v_cvt_pk_bf16_f32 v42, v180, v181
  v_cvt_pk_bf16_f32 v43, v182, v183
  v_mfma_f32_16x16x32_bf16 v[132:135], v[120:123], v[36:39], 0
  v_mfma_f32_16x16x32_bf16 v[208:211], v[70:73], v[36:39], 0
  v_mfma_f32_16x16x32_bf16 v[212:215], v[80:83], v[36:39], 0
  v_exp_f32 v184, v184
  v_exp_f32 v185, v185
  v_exp_f32 v186, v186
  v_exp_f32 v187, v187
  v_exp_f32 v188, v188
  v_exp_f32 v189, v189
  v_exp_f32 v190, v190
  v_exp_f32 v191, v191
  v_cvt_pk_bf16_f32 v44, v184, v185
  v_cvt_pk_bf16_f32 v45, v186, v187
  v_cvt_pk_bf16_f32 v46, v188, v189
  v_cvt_pk_bf16_f32 v47, v190, v191
  v_mfma_f32_16x16x32_bf16 v[136:139], v[120:123], v[40:43], 0
  v_mfma_f32_16x16x32_bf16 v[216:219], v[72:75], v[40:43], 0
  v_mfma_f32_16x16x32_bf16 v[220:223], v[82:85], v[40:43], 0
  v_mfma_f32_16x16x32_bf16 v[140:143], v[120:123], v[44:47], 0
  v_mfma_f32_16x16x32_bf16 v[224:227], v[74:77], v[44:47], 0
  v_mfma_f32_16x16x32_bf16 v[228:231], v[84:87], v[44:47], 0
  v_rcp_f32 v128, v128
  s_nop 0
  v_pk_mul_f32 v[200:201], v[200:201], v[128:129] op_sel_hi:[1,0]
  v_pk_mul_f32 v[202:203], v[202:203], v[128:129] op_sel_hi:[1,0]
  v_pk_mul_f32 v[204:205], v[204:205], v[128:129] op_sel_hi:[1,0]
  v_pk_mul_f32 v[206:207], v[206:207], v[128:129] op_sel_hi:[1,0]
  v_cvt_pk_bf16_f32 v48, v200, v201
  v_cvt_pk_bf16_f32 v49, v202, v203
  v_cvt_pk_bf16_f32 v50, v204, v205
  v_cvt_pk_bf16_f32 v51, v206, v207
  buffer_store_dwordx4 v[48:51], v11, s[40:43], s6 offen offset:0 sc0 sc1
  v_rcp_f32 v132, v132
  s_nop 0
  v_pk_mul_f32 v[208:209], v[208:209], v[132:133] op_sel_hi:[1,0]
  v_pk_mul_f32 v[210:211], v[210:211], v[132:133] op_sel_hi:[1,0]
  v_pk_mul_f32 v[212:213], v[212:213], v[132:133] op_sel_hi:[1,0]
  v_pk_mul_f32 v[214:215], v[214:215], v[132:133] op_sel_hi:[1,0]
  v_cvt_pk_bf16_f32 v52, v208, v209
  v_cvt_pk_bf16_f32 v53, v210, v211
  v_cvt_pk_bf16_f32 v54, v212, v213
  v_cvt_pk_bf16_f32 v55, v214, v215
  buffer_store_dwordx4 v[52:55], v11, s[40:43], s6 offen offset:1024 sc0 sc1
  v_rcp_f32 v136, v136
  s_nop 0
  v_pk_mul_f32 v[216:217], v[216:217], v[136:137] op_sel_hi:[1,0]
  v_pk_mul_f32 v[218:219], v[218:219], v[136:137] op_sel_hi:[1,0]
  v_pk_mul_f32 v[220:221], v[220:221], v[136:137] op_sel_hi:[1,0]
  v_pk_mul_f32 v[222:223], v[222:223], v[136:137] op_sel_hi:[1,0]
  v_cvt_pk_bf16_f32 v56, v216, v217
  v_cvt_pk_bf16_f32 v57, v218, v219
  v_cvt_pk_bf16_f32 v58, v220, v221
  v_cvt_pk_bf16_f32 v59, v222, v223
  buffer_store_dwordx4 v[56:59], v11, s[40:43], s6 offen offset:2048 sc0 sc1
  v_rcp_f32 v140, v140
  s_nop 0
  v_pk_mul_f32 v[224:225], v[224:225], v[140:141] op_sel_hi:[1,0]
  v_pk_mul_f32 v[226:227], v[226:227], v[140:141] op_sel_hi:[1,0]
  v_pk_mul_f32 v[228:229], v[228:229], v[140:141] op_sel_hi:[1,0]
  v_pk_mul_f32 v[230:231], v[230:231], v[140:141] op_sel_hi:[1,0]
  v_cvt_pk_bf16_f32 v60, v224, v225
  v_cvt_pk_bf16_f32 v61, v226, v227
  v_cvt_pk_bf16_f32 v62, v228, v229
  v_cvt_pk_bf16_f32 v63, v230, v231
  buffer_store_dwordx4 v[60:63], v11, s[40:43], s6 offen offset:3072 sc0 sc1
  s_add_u32 s5, s87, 0
  s_waitcnt vmcnt(0)
  s_mov_b64 exec, 1
  ds_add_rtn_u32 v2, v28, v27 offset:0
  s_waitcnt lgkmcnt(0)
  v_readfirstlane_b32 s4, v2
  s_and_b32 s4, s4, 3
  s_cmp_lg_u32 s4, 3
  s_cbranch_scc1 Ls_5
  s_mov_b32 exec_lo, 0xffff
  buffer_store_dword v27, v24, s[40:43], s5 offen sc0 sc1
Ls_5:
  s_mov_b64 exec, -1
  s_cmp_lg_u32 s82, 0
  s_cbranch_scc1 L_6
  v_permlane16_swap_b32 v240, v242
  v_permlane16_swap_b32 v241, v243
  v_permlane16_swap_b32 v244, v246
  v_permlane16_swap_b32 v245, v247
  v_permlane16_swap_b32 v248, v250
  v_permlane16_swap_b32 v249, v251
  v_permlane16_swap_b32 v252, v254
  v_permlane16_swap_b32 v253, v255
L_6:
  s_mov_b32 s16, 0
  s_mov_b32 s17, 16384
  s_mov_b32 s18, 0xffff4000
  s_mov_b32 s19, 32768
  s_mov_b32 s20, 8192
  s_mov_b32 s21, 0xfffee000
  s_mul_i32 s4, s85, 8192
  v_add_u32 v4, s4, v11
  v_add_u32 v5, 1024, v4
  s_lshl_b32 s4, s86, 1
  v_xor_b32 v2, s4, v26
  v_lshl_add_u32 v6, v2, 5, v25
  v_add_u32 v6, s19, v6
  s_add_u32 s4, s4, 1
  v_xor_b32 v2, s4, v26
  v_lshl_add_u32 v7, v2, 5, v25
  v_add_u32 v7, s19, v7
  s_mov_b32 s4, 0xffff0000
  v_lshlrev_b32 v128, 16, v240
  v_and_b32 v129, s4, v240
  v_lshlrev_b32 v130, 16, v241
  v_and_b32 v131, s4, v241
  v_lshlrev_b32 v132, 16, v242
  v_and_b32 v133, s4, v242
  v_lshlrev_b32 v134, 16, v243
  v_and_b32 v135, s4, v243
  v_lshlrev_b32 v136, 16, v244
  v_and_b32 v137, s4, v244
  v_lshlrev_b32 v138, 16, v245
  v_and_b32 v139, s4, v245
  v_lshlrev_b32 v140, 16, v246
  v_and_b32 v141, s4, v246
  v_lshlrev_b32 v142, 16, v247
  v_and_b32 v143, s4, v247
  v_lshlrev_b32 v144, 16, v248
  v_and_b32 v145, s4, v248
  v_lshlrev_b32 v146, 16, v249
  v_and_b32 v147, s4, v249
  v_lshlrev_b32 v148, 16, v250
  v_and_b32 v149, s4, v250
  v_lshlrev_b32 v150, 16, v251
  v_and_b32 v151, s4, v251
  v_lshlrev_b32 v152, 16, v252
  v_and_b32 v153, s4, v252
  v_lshlrev_b32 v154, 16, v253
  v_and_b32 v155, s4, v253
  v_lshlrev_b32 v156, 16, v254
  v_and_b32 v157, s4, v254
  v_lshlrev_b32 v158, 16, v255
  v_and_b32 v159, s4, v255
  s_mov_b32 s22, 8
  s_barrier
  ds_read_b64_tr_b16 v[48:49], v6 offset:0
  ds_read_b64_tr_b16 v[50:51], v6 offset:2048
  ds_read_b128 v[32:35], v4 offset:0
  ds_read_b128 v[36:39], v4 offset:2048
  ds_read_b128 v[40:43], v4 offset:4096
  ds_read_b128 v[44:47], v4 offset:6144
  ds_read_b64_tr_b16 v[52:53], v7 offset:0
  ds_read_b64_tr_b16 v[54:55], v7 offset:2048
  ds_read_b64_tr_b16 v[80:81], v6 offset:4096
  ds_read_b64_tr_b16 v[82:83], v6 offset:6144
  ds_read_b128 v[64:67], v5 offset:0
  ds_read_b128 v[68:71], v5 offset:2048
  ds_read_b128 v[72:75], v5 offset:4096
  s_waitcnt lgkmcnt(4)
  ds_read_b128 v[76:79], v5 offset:6144
  ds_read_b64_tr_b16 v[84:85], v7 offset:4096
  ds_read_b64_tr_b16 v[86:87], v7 offset:6144
  s_add_u32 s16, s16, s17
  s_cmp_eq_u32 s16, 65536
  s_cselect_b32 s23, s18, s17
  s_cselect_b32 s16, 0, s16
  v_add_u32 v4, s23, v4
  v_add_u32 v5, s23, v5
  s_add_u32 s19, s19, s20
  s_cmp_eq_u32 s19, 81920
  s_cselect_b32 s23, s21, s20
  s_cselect_b32 s19, 0, s19
  v_add_u32 v6, s23, v6
  v_add_u32 v7, s23, v7
  s_waitcnt lgkmcnt(0)
Lk_7:
  s_barrier
  v_mfma_f32_16x16x32_bf16 v[128:131], v[48:51], v[32:35], v[128:131]
  ds_read_b64_tr_b16 v[112:113], v6 offset:0
  ds_read_b64_tr_b16 v[114:115], v6 offset:2048
  v_mfma_f32_16x16x32_bf16 v[136:139], v[48:51], v[36:39], v[136:139]
  ds_read_b128 v[96:99], v4 offset:0
  ds_read_b128 v[100:103], v4 offset:2048
  v_mfma_f32_16x16x32_bf16 v[144:147], v[48:51], v[40:43], v[144:147]
  ds_read_b128 v[104:107], v4 offset:4096
  ds_read_b128 v[108:111], v4 offset:6144
  v_mfma_f32_16x16x32_bf16 v[152:155], v[48:51], v[44:47], v[152:155]
  ds_read_b64_tr_b16 v[116:117], v7 offset:0
  ds_read_b64_tr_b16 v[118:119], v7 offset:2048
  v_mfma_f32_16x16x32_bf16 v[132:135], v[52:55], v[32:35], v[132:135]
  ds_read_b64_tr_b16 v[208:209], v6 offset:4096
  ds_read_b64_tr_b16 v[210:211], v6 offset:6144
  v_mfma_f32_16x16x32_bf16 v[140:143], v[52:55], v[36:39], v[140:143]
  ds_read_b128 v[192:195], v5 offset:0
  ds_read_b128 v[196:199], v5 offset:2048
  v_mfma_f32_16x16x32_bf16 v[148:151], v[52:55], v[40:43], v[148:151]
  ds_read_b128 v[200:203], v5 offset:4096
  ds_read_b128 v[204:207], v5 offset:6144
  v_mfma_f32_16x16x32_bf16 v[156:159], v[52:55], v[44:47], v[156:159]
  ds_read_b64_tr_b16 v[212:213], v7 offset:4096
  ds_read_b64_tr_b16 v[214:215], v7 offset:6144
  v_mfma_f32_16x16x32_bf16 v[128:131], v[80:83], v[64:67], v[128:131]
  s_add_u32 s16, s16, s17
  s_cmp_eq_u32 s16, 65536
  s_cselect_b32 s23, s18, s17
  v_mfma_f32_16x16x32_bf16 v[136:139], v[80:83], v[68:71], v[136:139]
  s_cselect_b32 s16, 0, s16
  v_add_u32 v4, s23, v4
  v_add_u32 v5, s23, v5
  v_mfma_f32_16x16x32_bf16 v[144:147], v[80:83], v[72:75], v[144:147]
  s_add_u32 s19, s19, s20
  s_cmp_eq_u32 s19, 81920
  s_cselect_b32 s23, s21, s20
  v_mfma_f32_16x16x32_bf16 v[152:155], v[80:83], v[76:79], v[152:155]
  s_cselect_b32 s19, 0, s19
  v_add_u32 v6, s23, v6
  v_add_u32 v7, s23, v7
  v_mfma_f32_16x16x32_bf16 v[132:135], v[84:87], v[64:67], v[132:135]
  v_mfma_f32_16x16x32_bf16 v[140:143], v[84:87], v[68:71], v[140:143]
  v_mfma_f32_16x16x32_bf16 v[148:151], v[84:87], v[72:75], v[148:151]
  s_waitcnt lgkmcnt(0)
  v_mfma_f32_16x16x32_bf16 v[156:159], v[84:87], v[76:79], v[156:159]
  s_barrier
  v_mfma_f32_16x16x32_bf16 v[128:131], v[112:115], v[96:99], v[128:131]
  ds_read_b64_tr_b16 v[48:49], v6 offset:0
  ds_read_b64_tr_b16 v[50:51], v6 offset:2048
  v_mfma_f32_16x16x32_bf16 v[136:139], v[112:115], v[100:103], v[136:139]
  ds_read_b128 v[32:35], v4 offset:0
  ds_read_b128 v[36:39], v4 offset:2048
  v_mfma_f32_16x16x32_bf16 v[144:147], v[112:115], v[104:107], v[144:147]
  ds_read_b128 v[40:43], v4 offset:4096
  ds_read_b128 v[44:47], v4 offset:6144
  v_mfma_f32_16x16x32_bf16 v[152:155], v[112:115], v[108:111], v[152:155]
  ds_read_b64_tr_b16 v[52:53], v7 offset:0
  ds_read_b64_tr_b16 v[54:55], v7 offset:2048
  v_mfma_f32_16x16x32_bf16 v[132:135], v[116:119], v[96:99], v[132:135]
  ds_read_b64_tr_b16 v[80:81], v6 offset:4096
  ds_read_b64_tr_b16 v[82:83], v6 offset:6144
  v_mfma_f32_16x16x32_bf16 v[140:143], v[116:119], v[100:103], v[140:143]
  ds_read_b128 v[64:67], v5 offset:0
  ds_read_b128 v[68:71], v5 offset:2048
  v_mfma_f32_16x16x32_bf16 v[148:151], v[116:119], v[104:107], v[148:151]
  ds_read_b128 v[72:75], v5 offset:4096
  ds_read_b128 v[76:79], v5 offset:6144
  v_mfma_f32_16x16x32_bf16 v[156:159], v[116:119], v[108:111], v[156:159]
  ds_read_b64_tr_b16 v[84:85], v7 offset:4096
  ds_read_b64_tr_b16 v[86:87], v7 offset:6144
  v_mfma_f32_16x16x32_bf16 v[128:131], v[208:211], v[192:195], v[128:131]
  s_add_u32 s16, s16, s17
  s_cmp_eq_u32 s16, 65536
  s_cselect_b32 s23, s18, s17
  v_mfma_f32_16x16x32_bf16 v[136:139], v[208:211], v[196:199], v[136:139]
  s_cselect_b32 s16, 0, s16
  v_add_u32 v4, s23, v4
  v_add_u32 v5, s23, v5
  v_mfma_f32_16x16x32_bf16 v[144:147], v[208:211], v[200:203], v[144:147]
  s_add_u32 s19, s19, s20
  s_cmp_eq_u32 s19, 81920
  s_cselect_b32 s23, s21, s20
  v_mfma_f32_16x16x32_bf16 v[152:155], v[208:211], v[204:207], v[152:155]
  s_cselect_b32 s19, 0, s19
  v_add_u32 v6, s23, v6
  v_add_u32 v7, s23, v7
  v_mfma_f32_16x16x32_bf16 v[132:135], v[212:215], v[192:195], v[132:135]
  s_sub_u32 s22, s22, 1
  s_cmp_lg_u32 s22, 0
  v_mfma_f32_16x16x32_bf16 v[140:143], v[212:215], v[196:199], v[140:143]
  v_mfma_f32_16x16x32_bf16 v[148:151], v[212:215], v[200:203], v[148:151]
  s_waitcnt lgkmcnt(0)
  v_mfma_f32_16x16x32_bf16 v[156:159], v[212:215], v[204:207], v[156:159]
  s_cbranch_scc1 Lk_7
  s_waitcnt lgkmcnt(0)
  v_cvt_pk_bf16_f32 v240, v128, v129
  v_cvt_pk_bf16_f32 v241, v130, v131
  v_cvt_pk_bf16_f32 v242, v132, v133
  v_cvt_pk_bf16_f32 v243, v134, v135
  v_cvt_pk_bf16_f32 v244, v136, v137
  v_cvt_pk_bf16_f32 v245, v138, v139
  v_cvt_pk_bf16_f32 v246, v140, v141
  v_cvt_pk_bf16_f32 v247, v142, v143
  v_cvt_pk_bf16_f32 v248, v144, v145
  v_cvt_pk_bf16_f32 v249, v146, v147
  v_cvt_pk_bf16_f32 v250, v148, v149
  v_cvt_pk_bf16_f32 v251, v150, v151
  v_cvt_pk_bf16_f32 v252, v152, v153
  v_cvt_pk_bf16_f32 v253, v154, v155
  v_cvt_pk_bf16_f32 v254, v156, v157
  v_cvt_pk_bf16_f32 v255, v158, v159
  s_lshl_b32 s4, s76, 5
  s_lshl_b32 s5, s78, 1
  s_add_u32 s4, s4, s5
  s_add_u32 s4, s4, s86
  s_lshl_b32 s6, s4, 13
  s_lshl_b32 s7, s85, 12
  s_add_u32 s6, s6, s7
  s_add_u32 s6, s6, s83
  s_add_u32 s6, s6, 4194304
  buffer_store_dwordx4 v[240:243], v11, s[40:43], s6 offen offset:0 sc0 sc1
  buffer_store_dwordx4 v[244:247], v11, s[40:43], s6 offen offset:1024 sc0 sc1
  buffer_store_dwordx4 v[248:251], v11, s[40:43], s6 offen offset:2048 sc0 sc1
  buffer_store_dwordx4 v[252:255], v11, s[40:43], s6 offen offset:3072 sc0 sc1
  v_mov_b32 v40, 0x3f803f80
  v_dot2_f32_bf16 v32, v240, v40, 0
  v_dot2_f32_bf16 v36, v240, v240, 0
  v_dot2_f32_bf16 v33, v244, v40, 0
  v_dot2_f32_bf16 v37, v244, v244, 0
  v_dot2_f32_bf16 v34, v248, v40, 0
  v_dot2_f32_bf16 v38, v248, v248, 0
  v_dot2_f32_bf16 v35, v252, v40, 0
  v_dot2_f32_bf16 v39, v252, v252, 0
  v_dot2_f32_bf16 v32, v241, v40, v32
  v_dot2_f32_bf16 v36, v241, v241, v36
  v_dot2_f32_bf16 v33, v245, v40, v33
  v_dot2_f32_bf16 v37, v245, v245, v37
  v_dot2_f32_bf16 v34, v249, v40, v34
  v_dot2_f32_bf16 v38, v249, v249, v38
  v_dot2_f32_bf16 v35, v253, v40, v35
  v_dot2_f32_bf16 v39, v253, v253, v39
  v_dot2_f32_bf16 v32, v242, v40, v32
  v_dot2_f32_bf16 v36, v242, v242, v36
  v_dot2_f32_bf16 v33, v246, v40, v33
  v_dot2_f32_bf16 v37, v246, v246, v37
  v_dot2_f32_bf16 v34, v250, v40, v34
  v_dot2_f32_bf16 v38, v250, v250, v38
  v_dot2_f32_bf16 v35, v254, v40, v35
  v_dot2_f32_bf16 v39, v254, v254, v39
  v_dot2_f32_bf16 v32, v243, v40, v32
  v_dot2_f32_bf16 v36, v243, v243, v36
  v_dot2_f32_bf16 v33, v247, v40, v33
  v_dot2_f32_bf16 v37, v247, v247, v37
  v_dot2_f32_bf16 v34, v251, v40, v34
  v_dot2_f32_bf16 v38, v251, v251, v38
  v_dot2_f32_bf16 v35, v255, v40, v35
  v_dot2_f32_bf16 v39, v255, v255, v39
  s_lshl_b32 s6, s76, 9
  s_lshl_b32 s7, s85, 8
  s_add_u32 s6, s6, s7
  s_add_u32 s6, s6, s5
  s_add_u32 s6, s6, s86
  s_lshl_b32 s6, s6, 6
  s_add_u32 s6, s6, s83
  s_add_u32 s6, s6, 31457280
  v_permlane32_swap_b32 v32, v34
  v_permlane32_swap_b32 v33, v35
  v_permlane32_swap_b32 v36, v38
  v_permlane32_swap_b32 v37, v39
  v_add_f32 v32, v32, v34
  v_add_f32 v33, v33, v35
  v_add_f32 v36, v36, v38
  v_add_f32 v37, v37, v39
  v_permlane16_swap_b32 v32, v33
  s_nop 0
  v_permlane16_swap_b32 v36, v37
  v_add_f32 v42, v32, v33
  v_add_f32 v43, v36, v37
  buffer_store_dwordx2 v[42:43], v30, s[40:43], s6 offen sc0 sc1
  s_lshl_b32 s4, s85, 13
  s_lshl_b32 s5, s86, 10
  s_add_u32 s4, s4, s5
  v_add_u32 v3, s4, v11
  ds_write_b128 v3, v[240:243] offset:0
  ds_write_b128 v3, v[244:247] offset:2048
  ds_write_b128 v3, v[248:251] offset:4096
  ds_write_b128 v3, v[252:255] offset:6144
  s_add_u32 s5, s87, 4
  s_sub_u32 s4, s78, s77
  s_lshl_b32 s4, s4, 7
  s_add_u32 s5, s5, s4
  s_waitcnt vmcnt(0)
  s_mov_b64 exec, 1
  ds_add_rtn_u32 v2, v28, v27 offset:0
  s_waitcnt lgkmcnt(0)
  v_readfirstlane_b32 s4, v2
  s_and_b32 s4, s4, 3
  s_cmp_lg_u32 s4, 3
  s_cbranch_scc1 Ls_8
  s_mov_b32 exec_lo, 0xffff
  buffer_store_dword v27, v24, s[40:43], s5 offen sc0 sc1
Ls_8:
  s_mov_b64 exec, -1
  s_mov_b32 s16, 0
  s_mov_b32 s17, 16384
  s_mov_b32 s18, 0xffff4000
  s_mov_b32 s19, 0
  s_mov_b32 s20, 28672
  s_mov_b32 s21, 0xffff2000
  s_mul_i32 s4, s85, 8192
  v_add_u32 v4, s4, v11
  v_add_u32 v5, 1024, v4
  s_mul_i32 s4, s86, 6
  s_add_u32 s4, s4, 0
  s_lshr_b32 s5, s4, 2
  s_lshl_b32 s5, s5, 13
  s_and_b32 s4, s4, 3
  v_xor_b32 v2, s4, v26
  v_lshl_add_u32 v6, v2, 5, v25
  v_add_u32 v6, s5, v6
  s_mul_i32 s4, s86, 6
  s_add_u32 s4, s4, 1
  s_lshr_b32 s5, s4, 2
  s_lshl_b32 s5, s5, 13
  s_and_b32 s4, s4, 3
  v_xor_b32 v2, s4, v26
  v_lshl_add_u32 v7, v2, 5, v25
  v_add_u32 v7, s5, v7
  s_mul_i32 s4, s86, 6
  s_add_u32 s4, s4, 2
  s_lshr_b32 s5, s4, 2
  s_lshl_b32 s5, s5, 13
  s_and_b32 s4, s4, 3
  v_xor_b32 v2, s4, v26
  v_lshl_add_u32 v8, v2, 5, v25
  v_add_u32 v8, s5, v8
  s_mul_i32 s4, s86, 6
  s_add_u32 s4, s4, 3
  s_lshr_b32 s5, s4, 2
  s_lshl_b32 s5, s5, 13
  s_and_b32 s4, s4, 3
  v_xor_b32 v2, s4, v26
  v_lshl_add_u32 v9, v2, 5, v25
  v_add_u32 v9, s5, v9
  v_lshrrev_b32 v2, 2, v1
  v_lshlrev_b32 v3, 6, v2
  v_and_b32 v2, 3, v1
  v_lshl_add_u32 v3, v2, 3, v3
  v_bfe_u32 v2, v1, 4, 1
  v_xor_b32 v2, s86, v2
  v_lshl_add_u32 v3, v2, 5, v3
  v_add_u32 v10, 90112, v3
  v_mov_b64 v[128:129], 0
  v_mov_b64 v[130:131], 0
  v_mov_b64 v[132:133], 0
  v_mov_b64 v[134:135], 0
  v_mov_b64 v[136:137], 0
  v_mov_b64 v[138:139], 0
  v_mov_b64 v[140:141], 0
  v_mov_b64 v[142:143], 0
  v_mov_b64 v[144:145], 0
  v_mov_b64 v[146:147], 0
  v_mov_b64 v[148:149], 0
  v_mov_b64 v[150:151], 0
  v_mov_b64 v[152:153], 0
  v_mov_b64 v[154:155], 0
  v_mov_b64 v[156:157], 0
  v_mov_b64 v[158:159], 0
  v_mov_b64 v[160:161], 0
  v_mov_b64 v[162:163], 0
  v_mov_b64 v[164:165], 0
  v_mov_b64 v[166:167], 0
  v_mov_b64 v[168:169], 0
  v_mov_b64 v[170:171], 0
  v_mov_b64 v[172:173], 0
  v_mov_b64 v[174:175], 0
  v_mov_b64 v[176:177], 0
  v_mov_b64 v[178:179], 0
  v_mov_b64 v[180:181], 0
  v_mov_b64 v[182:183], 0
  v_mov_b64 v[184:185], 0
  v_mov_b64 v[186:187], 0
  v_mov_b64 v[188:189], 0
  v_mov_b64 v[190:191], 0
  v_mov_b64 v[192:193], 0
  v_mov_b64 v[194:195], 0
  v_mov_b64 v[196:197], 0
  v_mov_b64 v[198:199], 0
  v_mov_b64 v[200:201], 0
  v_mov_b64 v[202:203], 0
  v_mov_b64 v[204:205], 0
  v_mov_b64 v[206:207], 0
  v_mov_b64 v[208:209], 0
  v_mov_b64 v[210:211], 0
  v_mov_b64 v[212:213], 0
  v_mov_b64 v[214:215], 0
  v_mov_b64 v[216:217], 0
  v_mov_b64 v[218:219], 0
  v_mov_b64 v[220:221], 0
  v_mov_b64 v[222:223], 0
  v_mov_b64 v[224:225], 0
  v_mov_b64 v[226:227], 0
  v_mov_b64 v[228:229], 0
  v_mov_b64 v[230:231], 0
  v_mov_b64 v[232:233], 0
  v_mov_b64 v[234:235], 0
  v_mov_b64 v[236:237], 0
  v_mov_b64 v[238:239], 0
  s_mov_b32 s22, 16
  s_mov_b64 vcc, -1
  s_waitcnt lgkmcnt(0)
  s_barrier
  s_branch Lo_9
Lo_10:
  s_mov_b64 vcc, 0
  s_waitcnt lgkmcnt(0)
  s_barrier
Lo_9:
  ds_read_b64_tr_b16 v[48:49], v6 offset:0
  ds_read_b64_tr_b16 v[50:51], v6 offset:2048
  ds_read_b128 v[32:35], v4 offset:0
  ds_read_b128 v[36:39], v4 offset:2048
  ds_read_b128 v[40:43], v4 offset:4096
  ds_read_b128 v[44:47], v4 offset:6144
  ds_read_b64_tr_b16 v[52:53], v7 offset:0
  ds_read_b64_tr_b16 v[54:55], v7 offset:2048
  ds_read_b64_tr_b16 v[56:57], v8 offset:0
  ds_read_b64_tr_b16 v[58:59], v8 offset:2048
  ds_read_b64_tr_b16 v[60:61], v9 offset:0
  ds_read_b64_tr_b16 v[62:63], v9 offset:2048
  ds_read_b64_tr_b16 v[64:65], v6 offset:8192
  ds_read_b64_tr_b16 v[66:67], v6 offset:10240
  ds_read_b64_tr_b16 v[68:69], v7 offset:8192
  ds_read_b64_tr_b16 v[70:71], v7 offset:10240
  ds_read_b64_tr_b16 v[72:73], v10 offset:0
  ds_read_b64_tr_b16 v[74:75], v10 offset:1024
Lk_12:
  s_waitcnt lgkmcnt(0)
  v_mfma_f32_16x16x32_bf16 v[128:131], v[48:51], v[32:35], v[128:131]
  ds_read_b64_tr_b16 v[92:93], v6 offset:4096
  v_mfma_f32_16x16x32_bf16 v[132:135], v[48:51], v[36:39], v[132:135]
  ds_read_b64_tr_b16 v[94:95], v6 offset:6144
  v_mfma_f32_16x16x32_bf16 v[136:139], v[48:51], v[40:43], v[136:139]
  ds_read_b128 v[76:79], v5 offset:0
  v_mfma_f32_16x16x32_bf16 v[140:143], v[48:51], v[44:47], v[140:143]
  ds_read_b128 v[80:83], v5 offset:2048
  v_mfma_f32_16x16x32_bf16 v[144:147], v[52:55], v[32:35], v[144:147]
  ds_read_b128 v[84:87], v5 offset:4096
  v_mfma_f32_16x16x32_bf16 v[148:151], v[52:55], v[36:39], v[148:151]
  ds_read_b128 v[88:91], v5 offset:6144
  v_mfma_f32_16x16x32_bf16 v[152:155], v[52:55], v[40:43], v[152:155]
  ds_read_b64_tr_b16 v[96:97], v7 offset:4096
  v_mfma_f32_16x16x32_bf16 v[156:159], v[52:55], v[44:47], v[156:159]
  ds_read_b64_tr_b16 v[98:99], v7 offset:6144
  v_mfma_f32_16x16x32_bf16 v[160:163], v[56:59], v[32:35], v[160:163]
  ds_read_b64_tr_b16 v[100:101], v8 offset:4096
  v_mfma_f32_16x16x32_bf16 v[164:167], v[56:59], v[36:39], v[164:167]
  ds_read_b64_tr_b16 v[102:103], v8 offset:6144
  v_mfma_f32_16x16x32_bf16 v[168:171], v[56:59], v[40:43], v[168:171]
  ds_read_b64_tr_b16 v[104:105], v9 offset:4096
  v_mfma_f32_16x16x32_bf16 v[172:175], v[56:59], v[44:47], v[172:175]
  ds_read_b64_tr_b16 v[106:107], v9 offset:6144
  v_mfma_f32_16x16x32_bf16 v[176:179], v[60:63], v[32:35], v[176:179]
  ds_read_b64_tr_b16 v[108:109], v6 offset:12288
  v_mfma_f32_16x16x32_bf16 v[180:183], v[60:63], v[36:39], v[180:183]
  ds_read_b64_tr_b16 v[110:111], v6 offset:14336
  v_mfma_f32_16x16x32_bf16 v[184:187], v[60:63], v[40:43], v[184:187]
  ds_read_b64_tr_b16 v[112:113], v7 offset:12288
  v_mfma_f32_16x16x32_bf16 v[188:191], v[60:63], v[44:47], v[188:191]
  ds_read_b64_tr_b16 v[114:115], v7 offset:14336
  v_mfma_f32_16x16x32_bf16 v[192:195], v[64:67], v[32:35], v[192:195]
  ds_read_b64_tr_b16 v[116:117], v10 offset:2048
  v_mfma_f32_16x16x32_bf16 v[196:199], v[64:67], v[36:39], v[196:199]
  ds_read_b64_tr_b16 v[118:119], v10 offset:3072
  v_mfma_f32_16x16x32_bf16 v[200:203], v[64:67], v[40:43], v[200:203]
  s_add_u32 s16, s16, s17
  s_cmp_eq_u32 s16, 65536
  s_cselect_b32 s23, s18, s17
  v_mfma_f32_16x16x32_bf16 v[204:207], v[64:67], v[44:47], v[204:207]
  s_cselect_b32 s16, 0, s16
  v_add_u32 v4, s23, v4
  v_add_u32 v5, s23, v5
  v_mfma_f32_16x16x32_bf16 v[208:211], v[68:71], v[32:35], v[208:211]
  s_add_u32 s19, s19, s20
  s_cmp_eq_u32 s19, 86016
  s_cselect_b32 s23, s21, s20
  v_mfma_f32_16x16x32_bf16 v[212:215], v[68:71], v[36:39], v[212:215]
  s_cselect_b32 s19, 0, s19
  v_add_u32 v6, s23, v6
  v_add_u32 v7, s23, v7
  v_mfma_f32_16x16x32_bf16 v[216:219], v[68:71], v[40:43], v[216:219]
  v_add_u32 v8, s23, v8
  v_add_u32 v9, s23, v9
  v_add_u32 v10, s23, v10
  v_mfma_f32_16x16x32_bf16 v[220:223], v[68:71], v[44:47], v[220:223]
  v_mfma_f32_16x16x32_bf16 v[224:227], v[72:75], v[32:35], v[224:227]
  v_mfma_f32_16x16x32_bf16 v[228:231], v[72:75], v[36:39], v[228:231]
  v_mfma_f32_16x16x32_bf16 v[232:235], v[72:75], v[40:43], v[232:235]
  v_mfma_f32_16x16x32_bf16 v[236:239], v[72:75], v[44:47], v[236:239]
  s_waitcnt lgkmcnt(0)
  s_cbranch_vccnz Lo_11
  s_barrier
Lo_11:
  v_mfma_f32_16x16x32_bf16 v[128:131], v[92:95], v[76:79], v[128:131]
  ds_read_b64_tr_b16 v[48:49], v6 offset:0
  v_mfma_f32_16x16x32_bf16 v[132:135], v[92:95], v[80:83], v[132:135]
  ds_read_b64_tr_b16 v[50:51], v6 offset:2048
  v_mfma_f32_16x16x32_bf16 v[136:139], v[92:95], v[84:87], v[136:139]
  ds_read_b128 v[32:35], v4 offset:0
  v_mfma_f32_16x16x32_bf16 v[140:143], v[92:95], v[88:91], v[140:143]
  ds_read_b128 v[36:39], v4 offset:2048
  v_mfma_f32_16x16x32_bf16 v[144:147], v[96:99], v[76:79], v[144:147]
  ds_read_b128 v[40:43], v4 offset:4096
  v_mfma_f32_16x16x32_bf16 v[148:151], v[96:99], v[80:83], v[148:151]
  ds_read_b128 v[44:47], v4 offset:6144
  v_mfma_f32_16x16x32_bf16 v[152:155], v[96:99], v[84:87], v[152:155]
  ds_read_b64_tr_b16 v[52:53], v7 offset:0
  v_mfma_f32_16x16x32_bf16 v[156:159], v[96:99], v[88:91], v[156:159]
  ds_read_b64_tr_b16 v[54:55], v7 offset:2048
  v_mfma_f32_16x16x32_bf16 v[160:163], v[100:103], v[76:79], v[160:163]
  ds_read_b64_tr_b16 v[56:57], v8 offset:0
  v_mfma_f32_16x16x32_bf16 v[164:167], v[100:103], v[80:83], v[164:167]
  ds_read_b64_tr_b16 v[58:59], v8 offset:2048
  v_mfma_f32_16x16x32_bf16 v[168:171], v[100:103], v[84:87], v[168:171]
  ds_read_b64_tr_b16 v[60:61], v9 offset:0
  v_mfma_f32_16x16x32_bf16 v[172:175], v[100:103], v[88:91], v[172:175]
  ds_read_b64_tr_b16 v[62:63], v9 offset:2048
  v_mfma_f32_16x16x32_bf16 v[176:179], v[104:107], v[76:79], v[176:179]
  ds_read_b64_tr_b16 v[64:65], v6 offset:8192
  v_mfma_f32_16x16x32_bf16 v[180:183], v[104:107], v[80:83], v[180:183]
  ds_read_b64_tr_b16 v[66:67], v6 offset:10240
  v_mfma_f32_16x16x32_bf16 v[184:187], v[104:107], v[84:87], v[184:187]
  ds_read_b64_tr_b16 v[68:69], v7 offset:8192
  v_mfma_f32_16x16x32_bf16 v[188:191], v[104:107], v[88:91], v[188:191]
  ds_read_b64_tr_b16 v[70:71], v7 offset:10240
  v_mfma_f32_16x16x32_bf16 v[192:195], v[108:111], v[76:79], v[192:195]
  ds_read_b64_tr_b16 v[72:73], v10 offset:0
  v_mfma_f32_16x16x32_bf16 v[196:199], v[108:111], v[80:83], v[196:199]
  ds_read_b64_tr_b16 v[74:75], v10 offset:1024
  v_mfma_f32_16x16x32_bf16 v[200:203], v[108:111], v[84:87], v[200:203]
  s_sub_u32 s22, s22, 1
  v_mfma_f32_16x16x32_bf16 v[204:207], v[108:111], v[88:91], v[204:207]
  s_cmp_lg_u32 s22, 0
  v_mfma_f32_16x16x32_bf16 v[208:211], v[112:115], v[76:79], v[208:211]
  v_mfma_f32_16x16x32_bf16 v[212:215], v[112:115], v[80:83], v[212:215]
  v_mfma_f32_16x16x32_bf16 v[216:219], v[112:115], v[84:87], v[216:219]
  v_mfma_f32_16x16x32_bf16 v[220:223], v[112:115], v[88:91], v[220:223]
  v_mfma_f32_16x16x32_bf16 v[224:227], v[116:119], v[76:79], v[224:227]
  v_mfma_f32_16x16x32_bf16 v[228:231], v[116:119], v[80:83], v[228:231]
  v_mfma_f32_16x16x32_bf16 v[232:235], v[116:119], v[84:87], v[232:235]
  v_mfma_f32_16x16x32_bf16 v[236:239], v[116:119], v[88:91], v[236:239]
  s_cbranch_vccnz Lo_10
  s_cbranch_scc1 Lk_12
  s_waitcnt lgkmcnt(0)
  s_mul_i32 s4, s85, 320
  s_add_u32 s4, s4, 151552
  v_and_b32 v2, 15, v1
  v_lshl_add_u32 v3, v2, 2, s4
  ds_read2_b32 v[88:89], v3 offset0:0 offset1:160
  ds_read2_b32 v[90:91], v3 offset0:16 offset1:176
  ds_read2_b32 v[92:93], v3 offset0:32 offset1:192
  ds_read2_b32 v[94:95], v3 offset0:48 offset1:208
  s_mul_i32 s5, s86, 384
  s_add_u32 s5, s5, 154112
  v_add_u32 v3, s5, v29
  s_lshl_b32 s5, s86, 6
  s_add_u32 s5, s5, 154880
  v_add_u32 v2, s5, v29
  ds_read_b128 v[32:35], v3 offset:0
  ds_read_b128 v[36:39], v3 offset:1024
  ds_read_b128 v[40:43], v3 offset:64
  ds_read_b128 v[44:47], v3 offset:1088
  ds_read_b128 v[80:83], v2 offset:0
  ds_read_b128 v[84:87], v2 offset:1024
  ds_read_b128 v[48:51], v3 offset:128
  ds_read_b128 v[52:55], v3 offset:1152
  ds_read_b128 v[56:59], v3 offset:192
  ds_read_b128 v[60:63], v3 offset:1216
  v_mov_b32 v96, 0x409d30fc
  v_mov_b32 v97, 0x3eeff558
  v_and_b32 v2, 32, v1
  v_lshl_add_u32 v98, v2, 4, v11
  s_mul_i32 s4, s76, 112
  s_mul_i32 s5, s79, 56
  s_add_u32 s4, s4, s5
  s_add_u32 s7, s4, s80
  s_add_u32 s6, s7, s80
  s_add_u32 s6, s6, s86
  s_add_u32 s6, s6, 8
  s_lshl_b32 s8, s85, 12
  s_add_u32 s8, s8, s83
  s_add_u32 s8, s8, 8388608
  s_lshl_b32 s6, s6, 13
  s_add_u32 s6, s6, s8
  s_lshl_b32 s7, s7, 13
  s_add_u32 s7, s7, s8
  s_lshl_b32 s8, s86, 9
  s_add_u32 s7, s7, s8
  s_waitcnt lgkmcnt(6)
  ds_read_b128 v[64:67], v3 offset:256
  ds_read_b128 v[68:71], v3 offset:1280
  ds_read_b128 v[72:75], v3 offset:320
  ds_read_b128 v[76:79], v3 offset:1344
  v_pk_mul_f32 v[88:89], v[88:89], v[96:97] op_sel:[0,1] op_sel_hi:[1,1]
  v_pk_mul_f32 v[90:91], v[90:91], v[96:97] op_sel:[0,1] op_sel_hi:[1,1]
  v_pk_mul_f32 v[92:93], v[92:93], v[96:97] op_sel:[0,1] op_sel_hi:[1,1]
  v_pk_mul_f32 v[94:95], v[94:95], v[96:97] op_sel:[0,1] op_sel_hi:[1,1]
  s_lshl_b32 s4, s85, 13
  s_lshl_b32 s5, s86, 10
  s_add_u32 s4, s4, s5
  v_add_u32 v99, s4, v11
  s_lshl_b32 s4, s79, 3
  s_lshl_b32 s10, 0xff, s4
  v_pk_fma_f32 v[100:101], v[32:33], v[88:89], v[36:37] op_sel:[0,1,0] op_sel_hi:[1,1,1] neg_lo:[0,1,0] neg_hi:[0,1,0]
  v_pk_fma_f32 v[102:103], v[34:35], v[88:89], v[38:39] op_sel:[0,1,0] op_sel_hi:[1,1,1] neg_lo:[0,1,0] neg_hi:[0,1,0]
  v_pk_fma_f32 v[104:105], v[40:41], v[88:89], v[44:45] op_sel:[0,1,0] op_sel_hi:[1,1,1] neg_lo:[0,1,0] neg_hi:[0,1,0]
  v_pk_fma_f32 v[106:107], v[42:43], v[88:89], v[46:47] op_sel:[0,1,0] op_sel_hi:[1,1,1] neg_lo:[0,1,0] neg_hi:[0,1,0]
  v_pk_fma_f32 v[128:129], v[128:129], v[88:89], v[100:101] op_sel:[0,0,0] op_sel_hi:[1,0,1]
  v_pk_fma_f32 v[130:131], v[130:131], v[88:89], v[102:103] op_sel:[0,0,0] op_sel_hi:[1,0,1]
  v_pk_fma_f32 v[144:145], v[144:145], v[88:89], v[104:105] op_sel:[0,0,0] op_sel_hi:[1,0,1]
  v_pk_fma_f32 v[146:147], v[146:147], v[88:89], v[106:107] op_sel:[0,0,0] op_sel_hi:[1,0,1]
  v_pk_fma_f32 v[100:101], v[128:129], v[128:129], v[96:97] op_sel_hi:[1,1,0]
  v_pk_fma_f32 v[102:103], v[130:131], v[130:131], v[96:97] op_sel_hi:[1,1,0]
  v_pk_fma_f32 v[104:105], v[144:145], v[144:145], v[96:97] op_sel_hi:[1,1,0]
  v_pk_fma_f32 v[106:107], v[146:147], v[146:147], v[96:97] op_sel_hi:[1,1,0]
  v_pk_mul_f32 v[100:101], v[100:101], v[128:129] neg_lo:[0,1] neg_hi:[0,1]
  v_pk_mul_f32 v[102:103], v[102:103], v[130:131] neg_lo:[0,1] neg_hi:[0,1]
  v_pk_mul_f32 v[104:105], v[104:105], v[144:145] neg_lo:[0,1] neg_hi:[0,1]
  v_pk_mul_f32 v[106:107], v[106:107], v[146:147] neg_lo:[0,1] neg_hi:[0,1]
  v_exp_f32 v100, v100
  v_exp_f32 v101, v101
  v_exp_f32 v102, v102
  v_exp_f32 v103, v103
  v_exp_f32 v104, v104
  v_exp_f32 v105, v105
  v_exp_f32 v106, v106
  v_exp_f32 v107, v107
  v_pk_fma_f32 v[100:101], v[100:101], v[96:97], v[96:97] op_sel:[0,1,1] op_sel_hi:[1,1,1]
  v_pk_fma_f32 v[102:103], v[102:103], v[96:97], v[96:97] op_sel:[0,1,1] op_sel_hi:[1,1,1]
  v_pk_fma_f32 v[104:105], v[104:105], v[96:97], v[96:97] op_sel:[0,1,1] op_sel_hi:[1,1,1]
  v_pk_fma_f32 v[106:107], v[106:107], v[96:97], v[96:97] op_sel:[0,1,1] op_sel_hi:[1,1,1]
  v_rcp_f32 v100, v100
  v_rcp_f32 v101, v101
  v_rcp_f32 v102, v102
  v_rcp_f32 v103, v103
  v_rcp_f32 v104, v104
  v_rcp_f32 v105, v105
  v_rcp_f32 v106, v106
  v_rcp_f32 v107, v107
  v_pk_mul_f32 v[128:129], v[128:129], v[100:101]
  v_pk_mul_f32 v[130:131], v[130:131], v[102:103]
  v_pk_mul_f32 v[144:145], v[144:145], v[104:105]
  v_pk_mul_f32 v[146:147], v[146:147], v[106:107]
  v_cvt_pk_bf16_f32 v116, v128, v129
  v_cvt_pk_bf16_f32 v117, v130, v131
  v_cvt_pk_bf16_f32 v118, v144, v145
  v_cvt_pk_bf16_f32 v119, v146, v147
  buffer_store_dwordx4 v[116:119], v11, s[40:43], s6 offen offset:0 sc0 sc1
  ds_write_b128 v99, v[116:119] offset:0
  v_pk_fma_f32 v[100:101], v[32:33], v[90:91], v[36:37] op_sel:[0,1,0] op_sel_hi:[1,1,1] neg_lo:[0,1,0] neg_hi:[0,1,0]
  v_pk_fma_f32 v[102:103], v[34:35], v[90:91], v[38:39] op_sel:[0,1,0] op_sel_hi:[1,1,1] neg_lo:[0,1,0] neg_hi:[0,1,0]
  v_pk_fma_f32 v[104:105], v[40:41], v[90:91], v[44:45] op_sel:[0,1,0] op_sel_hi:[1,1,1] neg_lo:[0,1,0] neg_hi:[0,1,0]
  v_pk_fma_f32 v[106:107], v[42:43], v[90:91], v[46:47] op_sel:[0,1,0] op_sel_hi:[1,1,1] neg_lo:[0,1,0] neg_hi:[0,1,0]
  v_pk_fma_f32 v[132:133], v[132:133], v[90:91], v[100:101] op_sel:[0,0,0] op_sel_hi:[1,0,1]
  v_pk_fma_f32 v[134:135], v[134:135], v[90:91], v[102:103] op_sel:[0,0,0] op_sel_hi:[1,0,1]
  v_pk_fma_f32 v[148:149], v[148:149], v[90:91], v[104:105] op_sel:[0,0,0] op_sel_hi:[1,0,1]
  v_pk_fma_f32 v[150:151], v[150:151], v[90:91], v[106:107] op_sel:[0,0,0] op_sel_hi:[1,0,1]
  v_pk_fma_f32 v[100:101], v[132:133], v[132:133], v[96:97] op_sel_hi:[1,1,0]
  v_pk_fma_f32 v[102:103], v[134:135], v[134:135], v[96:97] op_sel_hi:[1,1,0]
  v_pk_fma_f32 v[104:105], v[148:149], v[148:149], v[96:97] op_sel_hi:[1,1,0]
  v_pk_fma_f32 v[106:107], v[150:151], v[150:151], v[96:97] op_sel_hi:[1,1,0]
  v_pk_mul_f32 v[100:101], v[100:101], v[132:133] neg_lo:[0,1] neg_hi:[0,1]
  v_pk_mul_f32 v[102:103], v[102:103], v[134:135] neg_lo:[0,1] neg_hi:[0,1]
  v_pk_mul_f32 v[104:105], v[104:105], v[148:149] neg_lo:[0,1] neg_hi:[0,1]
  v_pk_mul_f32 v[106:107], v[106:107], v[150:151] neg_lo:[0,1] neg_hi:[0,1]
  v_exp_f32 v100, v100
  v_exp_f32 v101, v101
  v_exp_f32 v102, v102
  v_exp_f32 v103, v103
  v_exp_f32 v104, v104
  v_exp_f32 v105, v105
  v_exp_f32 v106, v106
  v_exp_f32 v107, v107
  v_pk_fma_f32 v[100:101], v[100:101], v[96:97], v[96:97] op_sel:[0,1,1] op_sel_hi:[1,1,1]
  v_pk_fma_f32 v[102:103], v[102:103], v[96:97], v[96:97] op_sel:[0,1,1] op_sel_hi:[1,1,1]
  v_pk_fma_f32 v[104:105], v[104:105], v[96:97], v[96:97] op_sel:[0,1,1] op_sel_hi:[1,1,1]
  v_pk_fma_f32 v[106:107], v[106:107], v[96:97], v[96:97] op_sel:[0,1,1] op_sel_hi:[1,1,1]
  v_rcp_f32 v100, v100
  v_rcp_f32 v101, v101
  v_rcp_f32 v102, v102
  v_rcp_f32 v103, v103
  v_rcp_f32 v104, v104
  v_rcp_f32 v105, v105
  v_rcp_f32 v106, v106
  v_rcp_f32 v107, v107
  v_pk_mul_f32 v[132:133], v[132:133], v[100:101]
  v_pk_mul_f32 v[134:135], v[134:135], v[102:103]
  v_pk_mul_f32 v[148:149], v[148:149], v[104:105]
  v_pk_mul_f32 v[150:151], v[150:151], v[106:107]
  v_cvt_pk_bf16_f32 v120, v132, v133
  v_cvt_pk_bf16_f32 v121, v134, v135
  v_cvt_pk_bf16_f32 v122, v148, v149
  v_cvt_pk_bf16_f32 v123, v150, v151
  buffer_store_dwordx4 v[120:123], v11, s[40:43], s6 offen offset:1024 sc0 sc1
  ds_write_b128 v99, v[120:123] offset:2048
  v_pk_fma_f32 v[100:101], v[32:33], v[92:93], v[36:37] op_sel:[0,1,0] op_sel_hi:[1,1,1] neg_lo:[0,1,0] neg_hi:[0,1,0]
  v_pk_fma_f32 v[102:103], v[34:35], v[92:93], v[38:39] op_sel:[0,1,0] op_sel_hi:[1,1,1] neg_lo:[0,1,0] neg_hi:[0,1,0]
  v_pk_fma_f32 v[104:105], v[40:41], v[92:93], v[44:45] op_sel:[0,1,0] op_sel_hi:[1,1,1] neg_lo:[0,1,0] neg_hi:[0,1,0]
  v_pk_fma_f32 v[106:107], v[42:43], v[92:93], v[46:47] op_sel:[0,1,0] op_sel_hi:[1,1,1] neg_lo:[0,1,0] neg_hi:[0,1,0]
  v_pk_fma_f32 v[136:137], v[136:137], v[92:93], v[100:101] op_sel:[0,0,0] op_sel_hi:[1,0,1]
  v_pk_fma_f32 v[138:139], v[138:139], v[92:93], v[102:103] op_sel:[0,0,0] op_sel_hi:[1,0,1]
  v_pk_fma_f32 v[152:153], v[152:153], v[92:93], v[104:105] op_sel:[0,0,0] op_sel_hi:[1,0,1]
  v_pk_fma_f32 v[154:155], v[154:155], v[92:93], v[106:107] op_sel:[0,0,0] op_sel_hi:[1,0,1]
  v_pk_fma_f32 v[100:101], v[136:137], v[136:137], v[96:97] op_sel_hi:[1,1,0]
  v_pk_fma_f32 v[102:103], v[138:139], v[138:139], v[96:97] op_sel_hi:[1,1,0]
  v_pk_fma_f32 v[104:105], v[152:153], v[152:153], v[96:97] op_sel_hi:[1,1,0]
  v_pk_fma_f32 v[106:107], v[154:155], v[154:155], v[96:97] op_sel_hi:[1,1,0]
  v_pk_mul_f32 v[100:101], v[100:101], v[136:137] neg_lo:[0,1] neg_hi:[0,1]
  v_pk_mul_f32 v[102:103], v[102:103], v[138:139] neg_lo:[0,1] neg_hi:[0,1]
  v_pk_mul_f32 v[104:105], v[104:105], v[152:153] neg_lo:[0,1] neg_hi:[0,1]
  v_pk_mul_f32 v[106:107], v[106:107], v[154:155] neg_lo:[0,1] neg_hi:[0,1]
  v_exp_f32 v100, v100
  v_exp_f32 v101, v101
  v_exp_f32 v102, v102
  v_exp_f32 v103, v103
  v_exp_f32 v104, v104
  v_exp_f32 v105, v105
  v_exp_f32 v106, v106
  v_exp_f32 v107, v107
  v_pk_fma_f32 v[100:101], v[100:101], v[96:97], v[96:97] op_sel:[0,1,1] op_sel_hi:[1,1,1]
  v_pk_fma_f32 v[102:103], v[102:103], v[96:97], v[96:97] op_sel:[0,1,1] op_sel_hi:[1,1,1]
  v_pk_fma_f32 v[104:105], v[104:105], v[96:97], v[96:97] op_sel:[0,1,1] op_sel_hi:[1,1,1]
  v_pk_fma_f32 v[106:107], v[106:107], v[96:97], v[96:97] op_sel:[0,1,1] op_sel_hi:[1,1,1]
  v_rcp_f32 v100, v100
  v_rcp_f32 v101, v101
  v_rcp_f32 v102, v102
  v_rcp_f32 v103, v103
  v_rcp_f32 v104, v104
  v_rcp_f32 v105, v105
  v_rcp_f32 v106, v106
  v_rcp_f32 v107, v107
  v_pk_mul_f32 v[136:137], v[136:137], v[100:101]
  v_pk_mul_f32 v[138:139], v[138:139], v[102:103]
  v_pk_mul_f32 v[152:153], v[152:153], v[104:105]
  v_pk_mul_f32 v[154:155], v[154:155], v[106:107]
  v_cvt_pk_bf16_f32 v116, v136, v137
  v_cvt_pk_bf16_f32 v117, v138, v139
  v_cvt_pk_bf16_f32 v118, v152, v153
  v_cvt_pk_bf16_f32 v119, v154, v155
  buffer_store_dwordx4 v[116:119], v11, s[40:43], s6 offen offset:2048 sc0 sc1
  ds_write_b128 v99, v[116:119] offset:4096
  v_pk_fma_f32 v[100:101], v[32:33], v[94:95], v[36:37] op_sel:[0,1,0] op_sel_hi:[1,1,1] neg_lo:[0,1,0] neg_hi:[0,1,0]
  v_pk_fma_f32 v[102:103], v[34:35], v[94:95], v[38:39] op_sel:[0,1,0] op_sel_hi:[1,1,1] neg_lo:[0,1,0] neg_hi:[0,1,0]
  v_pk_fma_f32 v[104:105], v[40:41], v[94:95], v[44:45] op_sel:[0,1,0] op_sel_hi:[1,1,1] neg_lo:[0,1,0] neg_hi:[0,1,0]
  v_pk_fma_f32 v[106:107], v[42:43], v[94:95], v[46:47] op_sel:[0,1,0] op_sel_hi:[1,1,1] neg_lo:[0,1,0] neg_hi:[0,1,0]
  v_pk_fma_f32 v[140:141], v[140:141], v[94:95], v[100:101] op_sel:[0,0,0] op_sel_hi:[1,0,1]
  v_pk_fma_f32 v[142:143], v[142:143], v[94:95], v[102:103] op_sel:[0,0,0] op_sel_hi:[1,0,1]
  v_pk_fma_f32 v[156:157], v[156:157], v[94:95], v[104:105] op_sel:[0,0,0] op_sel_hi:[1,0,1]
  v_pk_fma_f32 v[158:159], v[158:159], v[94:95], v[106:107] op_sel:[0,0,0] op_sel_hi:[1,0,1]
  v_pk_fma_f32 v[100:101], v[140:141], v[140:141], v[96:97] op_sel_hi:[1,1,0]
  v_pk_fma_f32 v[102:103], v[142:143], v[142:143], v[96:97] op_sel_hi:[1,1,0]
  v_pk_fma_f32 v[104:105], v[156:157], v[156:157], v[96:97] op_sel_hi:[1,1,0]
  v_pk_fma_f32 v[106:107], v[158:159], v[158:159], v[96:97] op_sel_hi:[1,1,0]
  v_pk_mul_f32 v[100:101], v[100:101], v[140:141] neg_lo:[0,1] neg_hi:[0,1]
  v_pk_mul_f32 v[102:103], v[102:103], v[142:143] neg_lo:[0,1] neg_hi:[0,1]
  v_pk_mul_f32 v[104:105], v[104:105], v[156:157] neg_lo:[0,1] neg_hi:[0,1]
  v_pk_mul_f32 v[106:107], v[106:107], v[158:159] neg_lo:[0,1] neg_hi:[0,1]
  v_exp_f32 v100, v100
  v_exp_f32 v101, v101
  v_exp_f32 v102, v102
  v_exp_f32 v103, v103
  v_exp_f32 v104, v104
  v_exp_f32 v105, v105
  v_exp_f32 v106, v106
  v_exp_f32 v107, v107
  v_pk_fma_f32 v[100:101], v[100:101], v[96:97], v[96:97] op_sel:[0,1,1] op_sel_hi:[1,1,1]
  v_pk_fma_f32 v[102:103], v[102:103], v[96:97], v[96:97] op_sel:[0,1,1] op_sel_hi:[1,1,1]
  v_pk_fma_f32 v[104:105], v[104:105], v[96:97], v[96:97] op_sel:[0,1,1] op_sel_hi:[1,1,1]
  v_pk_fma_f32 v[106:107], v[106:107], v[96:97], v[96:97] op_sel:[0,1,1] op_sel_hi:[1,1,1]
  v_rcp_f32 v100, v100
  v_rcp_f32 v101, v101
  v_rcp_f32 v102, v102
  v_rcp_f32 v103, v103
  v_rcp_f32 v104, v104
  v_rcp_f32 v105, v105
  v_rcp_f32 v106, v106
  v_rcp_f32 v107, v107
  v_pk_mul_f32 v[140:141], v[140:141], v[100:101]
  v_pk_mul_f32 v[142:143], v[142:143], v[102:103]
  v_pk_mul_f32 v[156:157], v[156:157], v[104:105]
  v_pk_mul_f32 v[158:159], v[158:159], v[106:107]
  v_cvt_pk_bf16_f32 v120, v140, v141
  v_cvt_pk_bf16_f32 v121, v142, v143
  v_cvt_pk_bf16_f32 v122, v156, v157
  v_cvt_pk_bf16_f32 v123, v158, v159
  buffer_store_dwordx4 v[120:123], v11, s[40:43], s6 offen offset:3072 sc0 sc1
  ds_write_b128 v99, v[120:123] offset:6144
  s_add_u32 s6, s6, 0x20000
  s_waitcnt lgkmcnt(0)
  v_pk_fma_f32 v[100:101], v[80:81], v[88:89], v[84:85] op_sel:[0,1,0] op_sel_hi:[1,1,1] neg_lo:[0,1,0] neg_hi:[0,1,0]
  v_pk_fma_f32 v[102:103], v[82:83], v[88:89], v[86:87] op_sel:[0,1,0] op_sel_hi:[1,1,1] neg_lo:[0,1,0] neg_hi:[0,1,0]
  v_pk_fma_f32 v[104:105], v[80:81], v[90:91], v[84:85] op_sel:[0,1,0] op_sel_hi:[1,1,1] neg_lo:[0,1,0] neg_hi:[0,1,0]
  v_pk_fma_f32 v[106:107], v[82:83], v[90:91], v[86:87] op_sel:[0,1,0] op_sel_hi:[1,1,1] neg_lo:[0,1,0] neg_hi:[0,1,0]
  v_pk_fma_f32 v[224:225], v[224:225], v[88:89], v[100:101] op_sel:[0,0,0] op_sel_hi:[1,0,1]
  v_pk_fma_f32 v[226:227], v[226:227], v[88:89], v[102:103] op_sel:[0,0,0] op_sel_hi:[1,0,1]
  v_pk_fma_f32 v[228:229], v[228:229], v[90:91], v[104:105] op_sel:[0,0,0] op_sel_hi:[1,0,1]
  v_pk_fma_f32 v[230:231], v[230:231], v[90:91], v[106:107] op_sel:[0,0,0] op_sel_hi:[1,0,1]
  v_pk_fma_f32 v[100:101], v[224:225], v[224:225], v[96:97] op_sel_hi:[1,1,0]
  v_pk_fma_f32 v[102:103], v[226:227], v[226:227], v[96:97] op_sel_hi:[1,1,0]
  v_pk_fma_f32 v[104:105], v[228:229], v[228:229], v[96:97] op_sel_hi:[1,1,0]
  v_pk_fma_f32 v[106:107], v[230:231], v[230:231], v[96:97] op_sel_hi:[1,1,0]
  v_pk_mul_f32 v[100:101], v[100:101], v[224:225] neg_lo:[0,1] neg_hi:[0,1]
  v_pk_mul_f32 v[102:103], v[102:103], v[226:227] neg_lo:[0,1] neg_hi:[0,1]
  v_pk_mul_f32 v[104:105], v[104:105], v[228:229] neg_lo:[0,1] neg_hi:[0,1]
  v_pk_mul_f32 v[106:107], v[106:107], v[230:231] neg_lo:[0,1] neg_hi:[0,1]
  v_exp_f32 v100, v100
  v_exp_f32 v101, v101
  v_exp_f32 v102, v102
  v_exp_f32 v103, v103
  v_exp_f32 v104, v104
  v_exp_f32 v105, v105
  v_exp_f32 v106, v106
  v_exp_f32 v107, v107
  v_pk_fma_f32 v[100:101], v[100:101], v[96:97], v[96:97] op_sel:[0,1,1] op_sel_hi:[1,1,1]
  v_pk_fma_f32 v[102:103], v[102:103], v[96:97], v[96:97] op_sel:[0,1,1] op_sel_hi:[1,1,1]
  v_pk_fma_f32 v[104:105], v[104:105], v[96:97], v[96:97] op_sel:[0,1,1] op_sel_hi:[1,1,1]
  v_pk_fma_f32 v[106:107], v[106:107], v[96:97], v[96:97] op_sel:[0,1,1] op_sel_hi:[1,1,1]
  v_rcp_f32 v100, v100
  v_rcp_f32 v101, v101
  v_rcp_f32 v102, v102
  v_rcp_f32 v103, v103
  v_rcp_f32 v104, v104
  v_rcp_f32 v105, v105
  v_rcp_f32 v106, v106
  v_rcp_f32 v107, v107
  v_pk_mul_f32 v[224:225], v[224:225], v[100:101]
  v_pk_mul_f32 v[226:227], v[226:227], v[102:103]
  v_pk_mul_f32 v[228:229], v[228:229], v[104:105]
  v_pk_mul_f32 v[230:231], v[230:231], v[106:107]
  v_cvt_pk_bf16_f32 v116, v224, v225
  v_cvt_pk_bf16_f32 v117, v226, v227
  v_cvt_pk_bf16_f32 v118, v228, v229
  v_cvt_pk_bf16_f32 v119, v230, v231
  s_nop 0
  v_permlane32_swap_b32 v116, v118
  v_permlane32_swap_b32 v117, v119
  buffer_store_dwordx4 v[116:119], v98, s[40:43], s7 offen offset:0 sc0 sc1
  v_pk_fma_f32 v[100:101], v[80:81], v[92:93], v[84:85] op_sel:[0,1,0] op_sel_hi:[1,1,1] neg_lo:[0,1,0] neg_hi:[0,1,0]
  v_pk_fma_f32 v[102:103], v[82:83], v[92:93], v[86:87] op_sel:[0,1,0] op_sel_hi:[1,1,1] neg_lo:[0,1,0] neg_hi:[0,1,0]
  v_pk_fma_f32 v[104:105], v[80:81], v[94:95], v[84:85] op_sel:[0,1,0] op_sel_hi:[1,1,1] neg_lo:[0,1,0] neg_hi:[0,1,0]
  v_pk_fma_f32 v[106:107], v[82:83], v[94:95], v[86:87] op_sel:[0,1,0] op_sel_hi:[1,1,1] neg_lo:[0,1,0] neg_hi:[0,1,0]
  v_pk_fma_f32 v[232:233], v[232:233], v[92:93], v[100:101] op_sel:[0,0,0] op_sel_hi:[1,0,1]
  v_pk_fma_f32 v[234:235], v[234:235], v[92:93], v[102:103] op_sel:[0,0,0] op_sel_hi:[1,0,1]
  v_pk_fma_f32 v[236:237], v[236:237], v[94:95], v[104:105] op_sel:[0,0,0] op_sel_hi:[1,0,1]
  v_pk_fma_f32 v[238:239], v[238:239], v[94:95], v[106:107] op_sel:[0,0,0] op_sel_hi:[1,0,1]
  v_pk_fma_f32 v[100:101], v[232:233], v[232:233], v[96:97] op_sel_hi:[1,1,0]
  v_pk_fma_f32 v[102:103], v[234:235], v[234:235], v[96:97] op_sel_hi:[1,1,0]
  v_pk_fma_f32 v[104:105], v[236:237], v[236:237], v[96:97] op_sel_hi:[1,1,0]
  v_pk_fma_f32 v[106:107], v[238:239], v[238:239], v[96:97] op_sel_hi:[1,1,0]
  v_pk_mul_f32 v[100:101], v[100:101], v[232:233] neg_lo:[0,1] neg_hi:[0,1]
  v_pk_mul_f32 v[102:103], v[102:103], v[234:235] neg_lo:[0,1] neg_hi:[0,1]
  v_pk_mul_f32 v[104:105], v[104:105], v[236:237] neg_lo:[0,1] neg_hi:[0,1]
  v_pk_mul_f32 v[106:107], v[106:107], v[238:239] neg_lo:[0,1] neg_hi:[0,1]
  v_exp_f32 v100, v100
  v_exp_f32 v101, v101
  v_exp_f32 v102, v102
  v_exp_f32 v103, v103
  v_exp_f32 v104, v104
  v_exp_f32 v105, v105
  v_exp_f32 v106, v106
  v_exp_f32 v107, v107
  v_pk_fma_f32 v[100:101], v[100:101], v[96:97], v[96:97] op_sel:[0,1,1] op_sel_hi:[1,1,1]
  v_pk_fma_f32 v[102:103], v[102:103], v[96:97], v[96:97] op_sel:[0,1,1] op_sel_hi:[1,1,1]
  v_pk_fma_f32 v[104:105], v[104:105], v[96:97], v[96:97] op_sel:[0,1,1] op_sel_hi:[1,1,1]
  v_pk_fma_f32 v[106:107], v[106:107], v[96:97], v[96:97] op_sel:[0,1,1] op_sel_hi:[1,1,1]
  v_rcp_f32 v100, v100
  v_rcp_f32 v101, v101
  v_rcp_f32 v102, v102
  v_rcp_f32 v103, v103
  v_rcp_f32 v104, v104
  v_rcp_f32 v105, v105
  v_rcp_f32 v106, v106
  v_rcp_f32 v107, v107
  v_pk_mul_f32 v[232:233], v[232:233], v[100:101]
  v_pk_mul_f32 v[234:235], v[234:235], v[102:103]
  v_pk_mul_f32 v[236:237], v[236:237], v[104:105]
  v_pk_mul_f32 v[238:239], v[238:239], v[106:107]
  v_cvt_pk_bf16_f32 v120, v232, v233
  v_cvt_pk_bf16_f32 v121, v234, v235
  v_cvt_pk_bf16_f32 v122, v236, v237
  v_cvt_pk_bf16_f32 v123, v238, v239
  s_add_u32 s9, s87, 8
  s_waitcnt vmcnt(1)
  s_mov_b64 exec, 1
  ds_add_rtn_u32 v124, v28, v27 offset:0
  s_mov_b64 exec, -1
  v_permlane32_swap_b32 v120, v122
  v_permlane32_swap_b32 v121, v123
  buffer_store_dwordx4 v[120:123], v98, s[40:43], s7 offen offset:2048 sc0 sc1
  v_pk_fma_f32 v[100:101], v[48:49], v[88:89], v[52:53] op_sel:[0,1,0] op_sel_hi:[1,1,1] neg_lo:[0,1,0] neg_hi:[0,1,0]
  v_pk_fma_f32 v[102:103], v[50:51], v[88:89], v[54:55] op_sel:[0,1,0] op_sel_hi:[1,1,1] neg_lo:[0,1,0] neg_hi:[0,1,0]
  v_pk_fma_f32 v[104:105], v[56:57], v[88:89], v[60:61] op_sel:[0,1,0] op_sel_hi:[1,1,1] neg_lo:[0,1,0] neg_hi:[0,1,0]
  v_pk_fma_f32 v[106:107], v[58:59], v[88:89], v[62:63] op_sel:[0,1,0] op_sel_hi:[1,1,1] neg_lo:[0,1,0] neg_hi:[0,1,0]
  v_pk_fma_f32 v[160:161], v[160:161], v[88:89], v[100:101] op_sel:[0,0,0] op_sel_hi:[1,0,1]
  v_pk_fma_f32 v[162:163], v[162:163], v[88:89], v[102:103] op_sel:[0,0,0] op_sel_hi:[1,0,1]
  v_pk_fma_f32 v[176:177], v[176:177], v[88:89], v[104:105] op_sel:[0,0,0] op_sel_hi:[1,0,1]
  v_pk_fma_f32 v[178:179], v[178:179], v[88:89], v[106:107] op_sel:[0,0,0] op_sel_hi:[1,0,1]
  v_pk_fma_f32 v[100:101], v[160:161], v[160:161], v[96:97] op_sel_hi:[1,1,0]
  v_pk_fma_f32 v[102:103], v[162:163], v[162:163], v[96:97] op_sel_hi:[1,1,0]
  v_pk_fma_f32 v[104:105], v[176:177], v[176:177], v[96:97] op_sel_hi:[1,1,0]
  v_pk_fma_f32 v[106:107], v[178:179], v[178:179], v[96:97] op_sel_hi:[1,1,0]
  v_pk_mul_f32 v[100:101], v[100:101], v[160:161] neg_lo:[0,1] neg_hi:[0,1]
  v_pk_mul_f32 v[102:103], v[102:103], v[162:163] neg_lo:[0,1] neg_hi:[0,1]
  v_pk_mul_f32 v[104:105], v[104:105], v[176:177] neg_lo:[0,1] neg_hi:[0,1]
  v_pk_mul_f32 v[106:107], v[106:107], v[178:179] neg_lo:[0,1] neg_hi:[0,1]
  v_exp_f32 v100, v100
  v_exp_f32 v101, v101
  v_exp_f32 v102, v102
  v_exp_f32 v103, v103
  v_exp_f32 v104, v104
  v_exp_f32 v105, v105
  v_exp_f32 v106, v106
  v_exp_f32 v107, v107
  v_pk_fma_f32 v[100:101], v[100:101], v[96:97], v[96:97] op_sel:[0,1,1] op_sel_hi:[1,1,1]
  v_pk_fma_f32 v[102:103], v[102:103], v[96:97], v[96:97] op_sel:[0,1,1] op_sel_hi:[1,1,1]
  v_pk_fma_f32 v[104:105], v[104:105], v[96:97], v[96:97] op_sel:[0,1,1] op_sel_hi:[1,1,1]
  v_pk_fma_f32 v[106:107], v[106:107], v[96:97], v[96:97] op_sel:[0,1,1] op_sel_hi:[1,1,1]
  v_rcp_f32 v100, v100
  v_rcp_f32 v101, v101
  v_rcp_f32 v102, v102
  v_rcp_f32 v103, v103
  v_rcp_f32 v104, v104
  v_rcp_f32 v105, v105
  v_rcp_f32 v106, v106
  v_rcp_f32 v107, v107
  v_pk_mul_f32 v[160:161], v[160:161], v[100:101]
  v_pk_mul_f32 v[162:163], v[162:163], v[102:103]
  v_pk_mul_f32 v[176:177], v[176:177], v[104:105]
  v_pk_mul_f32 v[178:179], v[178:179], v[106:107]
  v_cvt_pk_bf16_f32 v116, v160, v161
  v_cvt_pk_bf16_f32 v117, v162, v163
  v_cvt_pk_bf16_f32 v118, v176, v177
  v_cvt_pk_bf16_f32 v119, v178, v179
  s_waitcnt lgkmcnt(0)
  v_readfirstlane_b32 s4, v124
  s_and_b32 s4, s4, 3
  s_cmp_lg_u32 s4, 3
  s_cbranch_scc1 Ls_13
  s_mov_b32 exec_lo, s10
  s_mov_b32 exec_hi, 0
  buffer_store_dword v27, v24, s[40:43], s9 offen sc0 sc1
Ls_13:
  s_mov_b64 exec, -1
  buffer_store_dwordx4 v[116:119], v11, s[40:43], s6 offen offset:0 sc0 sc1
  ds_write_b128 v99, v[116:119] offset:16384
  v_pk_fma_f32 v[100:101], v[48:49], v[90:91], v[52:53] op_sel:[0,1,0] op_sel_hi:[1,1,1] neg_lo:[0,1,0] neg_hi:[0,1,0]
  v_pk_fma_f32 v[102:103], v[50:51], v[90:91], v[54:55] op_sel:[0,1,0] op_sel_hi:[1,1,1] neg_lo:[0,1,0] neg_hi:[0,1,0]
  v_pk_fma_f32 v[104:105], v[56:57], v[90:91], v[60:61] op_sel:[0,1,0] op_sel_hi:[1,1,1] neg_lo:[0,1,0] neg_hi:[0,1,0]
  v_pk_fma_f32 v[106:107], v[58:59], v[90:91], v[62:63] op_sel:[0,1,0] op_sel_hi:[1,1,1] neg_lo:[0,1,0] neg_hi:[0,1,0]
  v_pk_fma_f32 v[164:165], v[164:165], v[90:91], v[100:101] op_sel:[0,0,0] op_sel_hi:[1,0,1]
  v_pk_fma_f32 v[166:167], v[166:167], v[90:91], v[102:103] op_sel:[0,0,0] op_sel_hi:[1,0,1]
  v_pk_fma_f32 v[180:181], v[180:181], v[90:91], v[104:105] op_sel:[0,0,0] op_sel_hi:[1,0,1]
  v_pk_fma_f32 v[182:183], v[182:183], v[90:91], v[106:107] op_sel:[0,0,0] op_sel_hi:[1,0,1]
  v_pk_fma_f32 v[100:101], v[164:165], v[164:165], v[96:97] op_sel_hi:[1,1,0]
  v_pk_fma_f32 v[102:103], v[166:167], v[166:167], v[96:97] op_sel_hi:[1,1,0]
  v_pk_fma_f32 v[104:105], v[180:181], v[180:181], v[96:97] op_sel_hi:[1,1,0]
  v_pk_fma_f32 v[106:107], v[182:183], v[182:183], v[96:97] op_sel_hi:[1,1,0]
  v_pk_mul_f32 v[100:101], v[100:101], v[164:165] neg_lo:[0,1] neg_hi:[0,1]
  v_pk_mul_f32 v[102:103], v[102:103], v[166:167] neg_lo:[0,1] neg_hi:[0,1]
  v_pk_mul_f32 v[104:105], v[104:105], v[180:181] neg_lo:[0,1] neg_hi:[0,1]
  v_pk_mul_f32 v[106:107], v[106:107], v[182:183] neg_lo:[0,1] neg_hi:[0,1]
  v_exp_f32 v100, v100
  v_exp_f32 v101, v101
  v_exp_f32 v102, v102
  v_exp_f32 v103, v103
  v_exp_f32 v104, v104
  v_exp_f32 v105, v105
  v_exp_f32 v106, v106
  v_exp_f32 v107, v107
  v_pk_fma_f32 v[100:101], v[100:101], v[96:97], v[96:97] op_sel:[0,1,1] op_sel_hi:[1,1,1]
  v_pk_fma_f32 v[102:103], v[102:103], v[96:97], v[96:97] op_sel:[0,1,1] op_sel_hi:[1,1,1]
  v_pk_fma_f32 v[104:105], v[104:105], v[96:97], v[96:97] op_sel:[0,1,1] op_sel_hi:[1,1,1]
  v_pk_fma_f32 v[106:107], v[106:107], v[96:97], v[96:97] op_sel:[0,1,1] op_sel_hi:[1,1,1]
  v_rcp_f32 v100, v100
  v_rcp_f32 v101, v101
  v_rcp_f32 v102, v102
  v_rcp_f32 v103, v103
  v_rcp_f32 v104, v104
  v_rcp_f32 v105, v105
  v_rcp_f32 v106, v106
  v_rcp_f32 v107, v107
  v_pk_mul_f32 v[164:165], v[164:165], v[100:101]
  v_pk_mul_f32 v[166:167], v[166:167], v[102:103]
  v_pk_mul_f32 v[180:181], v[180:181], v[104:105]
  v_pk_mul_f32 v[182:183], v[182:183], v[106:107]
  v_cvt_pk_bf16_f32 v120, v164, v165
  v_cvt_pk_bf16_f32 v121, v166, v167
  v_cvt_pk_bf16_f32 v122, v180, v181
  v_cvt_pk_bf16_f32 v123, v182, v183
  buffer_store_dwordx4 v[120:123], v11, s[40:43], s6 offen offset:1024 sc0 sc1
  ds_write_b128 v99, v[120:123] offset:18432
  v_pk_fma_f32 v[100:101], v[48:49], v[92:93], v[52:53] op_sel:[0,1,0] op_sel_hi:[1,1,1] neg_lo:[0,1,0] neg_hi:[0,1,0]
  v_pk_fma_f32 v[102:103], v[50:51], v[92:93], v[54:55] op_sel:[0,1,0] op_sel_hi:[1,1,1] neg_lo:[0,1,0] neg_hi:[0,1,0]
  v_pk_fma_f32 v[104:105], v[56:57], v[92:93], v[60:61] op_sel:[0,1,0] op_sel_hi:[1,1,1] neg_lo:[0,1,0] neg_hi:[0,1,0]
  v_pk_fma_f32 v[106:107], v[58:59], v[92:93], v[62:63] op_sel:[0,1,0] op_sel_hi:[1,1,1] neg_lo:[0,1,0] neg_hi:[0,1,0]
  v_pk_fma_f32 v[168:169], v[168:169], v[92:93], v[100:101] op_sel:[0,0,0] op_sel_hi:[1,0,1]
  v_pk_fma_f32 v[170:171], v[170:171], v[92:93], v[102:103] op_sel:[0,0,0] op_sel_hi:[1,0,1]
  v_pk_fma_f32 v[184:185], v[184:185], v[92:93], v[104:105] op_sel:[0,0,0] op_sel_hi:[1,0,1]
  v_pk_fma_f32 v[186:187], v[186:187], v[92:93], v[106:107] op_sel:[0,0,0] op_sel_hi:[1,0,1]
  v_pk_fma_f32 v[100:101], v[168:169], v[168:169], v[96:97] op_sel_hi:[1,1,0]
  v_pk_fma_f32 v[102:103], v[170:171], v[170:171], v[96:97] op_sel_hi:[1,1,0]
  v_pk_fma_f32 v[104:105], v[184:185], v[184:185], v[96:97] op_sel_hi:[1,1,0]
  v_pk_fma_f32 v[106:107], v[186:187], v[186:187], v[96:97] op_sel_hi:[1,1,0]
  v_pk_mul_f32 v[100:101], v[100:101], v[168:169] neg_lo:[0,1] neg_hi:[0,1]
  v_pk_mul_f32 v[102:103], v[102:103], v[170:171] neg_lo:[0,1] neg_hi:[0,1]
  v_pk_mul_f32 v[104:105], v[104:105], v[184:185] neg_lo:[0,1] neg_hi:[0,1]
  v_pk_mul_f32 v[106:107], v[106:107], v[186:187] neg_lo:[0,1] neg_hi:[0,1]
  v_exp_f32 v100, v100
  v_exp_f32 v101, v101
  v_exp_f32 v102, v102
  v_exp_f32 v103, v103
  v_exp_f32 v104, v104
  v_exp_f32 v105, v105
  v_exp_f32 v106, v106
  v_exp_f32 v107, v107
  v_pk_fma_f32 v[100:101], v[100:101], v[96:97], v[96:97] op_sel:[0,1,1] op_sel_hi:[1,1,1]
  v_pk_fma_f32 v[102:103], v[102:103], v[96:97], v[96:97] op_sel:[0,1,1] op_sel_hi:[1,1,1]
  v_pk_fma_f32 v[104:105], v[104:105], v[96:97], v[96:97] op_sel:[0,1,1] op_sel_hi:[1,1,1]
  v_pk_fma_f32 v[106:107], v[106:107], v[96:97], v[96:97] op_sel:[0,1,1] op_sel_hi:[1,1,1]
  v_rcp_f32 v100, v100
  v_rcp_f32 v101, v101
  v_rcp_f32 v102, v102
  v_rcp_f32 v103, v103
  v_rcp_f32 v104, v104
  v_rcp_f32 v105, v105
  v_rcp_f32 v106, v106
  v_rcp_f32 v107, v107
  v_pk_mul_f32 v[168:169], v[168:169], v[100:101]
  v_pk_mul_f32 v[170:171], v[170:171], v[102:103]
  v_pk_mul_f32 v[184:185], v[184:185], v[104:105]
  v_pk_mul_f32 v[186:187], v[186:187], v[106:107]
  v_cvt_pk_bf16_f32 v116, v168, v169
  v_cvt_pk_bf16_f32 v117, v170, v171
  v_cvt_pk_bf16_f32 v118, v184, v185
  v_cvt_pk_bf16_f32 v119, v186, v187
  buffer_store_dwordx4 v[116:119], v11, s[40:43], s6 offen offset:2048 sc0 sc1
  ds_write_b128 v99, v[116:119] offset:20480
  v_pk_fma_f32 v[100:101], v[48:49], v[94:95], v[52:53] op_sel:[0,1,0] op_sel_hi:[1,1,1] neg_lo:[0,1,0] neg_hi:[0,1,0]
  v_pk_fma_f32 v[102:103], v[50:51], v[94:95], v[54:55] op_sel:[0,1,0] op_sel_hi:[1,1,1] neg_lo:[0,1,0] neg_hi:[0,1,0]
  v_pk_fma_f32 v[104:105], v[56:57], v[94:95], v[60:61] op_sel:[0,1,0] op_sel_hi:[1,1,1] neg_lo:[0,1,0] neg_hi:[0,1,0]
  v_pk_fma_f32 v[106:107], v[58:59], v[94:95], v[62:63] op_sel:[0,1,0] op_sel_hi:[1,1,1] neg_lo:[0,1,0] neg_hi:[0,1,0]
  v_pk_fma_f32 v[172:173], v[172:173], v[94:95], v[100:101] op_sel:[0,0,0] op_sel_hi:[1,0,1]
  v_pk_fma_f32 v[174:175], v[174:175], v[94:95], v[102:103] op_sel:[0,0,0] op_sel_hi:[1,0,1]
  v_pk_fma_f32 v[188:189], v[188:189], v[94:95], v[104:105] op_sel:[0,0,0] op_sel_hi:[1,0,1]
  v_pk_fma_f32 v[190:191], v[190:191], v[94:95], v[106:107] op_sel:[0,0,0] op_sel_hi:[1,0,1]
  v_pk_fma_f32 v[100:101], v[172:173], v[172:173], v[96:97] op_sel_hi:[1,1,0]
  v_pk_fma_f32 v[102:103], v[174:175], v[174:175], v[96:97] op_sel_hi:[1,1,0]
  v_pk_fma_f32 v[104:105], v[188:189], v[188:189], v[96:97] op_sel_hi:[1,1,0]
  v_pk_fma_f32 v[106:107], v[190:191], v[190:191], v[96:97] op_sel_hi:[1,1,0]
  v_pk_mul_f32 v[100:101], v[100:101], v[172:173] neg_lo:[0,1] neg_hi:[0,1]
  v_pk_mul_f32 v[102:103], v[102:103], v[174:175] neg_lo:[0,1] neg_hi:[0,1]
  v_pk_mul_f32 v[104:105], v[104:105], v[188:189] neg_lo:[0,1] neg_hi:[0,1]
  v_pk_mul_f32 v[106:107], v[106:107], v[190:191] neg_lo:[0,1] neg_hi:[0,1]
  v_exp_f32 v100, v100
  v_exp_f32 v101, v101
  v_exp_f32 v102, v102
  v_exp_f32 v103, v103
  v_exp_f32 v104, v104
  v_exp_f32 v105, v105
  v_exp_f32 v106, v106
  v_exp_f32 v107, v107
  v_pk_fma_f32 v[100:101], v[100:101], v[96:97], v[96:97] op_sel:[0,1,1] op_sel_hi:[1,1,1]
  v_pk_fma_f32 v[102:103], v[102:103], v[96:97], v[96:97] op_sel:[0,1,1] op_sel_hi:[1,1,1]
  v_pk_fma_f32 v[104:105], v[104:105], v[96:97], v[96:97] op_sel:[0,1,1] op_sel_hi:[1,1,1]
  v_pk_fma_f32 v[106:107], v[106:107], v[96:97], v[96:97] op_sel:[0,1,1] op_sel_hi:[1,1,1]
  v_rcp_f32 v100, v100
  v_rcp_f32 v101, v101
  v_rcp_f32 v102, v102
  v_rcp_f32 v103, v103
  v_rcp_f32 v104, v104
  v_rcp_f32 v105, v105
  v_rcp_f32 v106, v106
  v_rcp_f32 v107, v107
  v_pk_mul_f32 v[172:173], v[172:173], v[100:101]
  v_pk_mul_f32 v[174:175], v[174:175], v[102:103]
  v_pk_mul_f32 v[188:189], v[188:189], v[104:105]
  v_pk_mul_f32 v[190:191], v[190:191], v[106:107]
  v_cvt_pk_bf16_f32 v120, v172, v173
  v_cvt_pk_bf16_f32 v121, v174, v175
  v_cvt_pk_bf16_f32 v122, v188, v189
  v_cvt_pk_bf16_f32 v123, v190, v191
  buffer_store_dwordx4 v[120:123], v11, s[40:43], s6 offen offset:3072 sc0 sc1
  ds_write_b128 v99, v[120:123] offset:22528
  s_add_u32 s6, s6, 0x20000
  v_pk_fma_f32 v[100:101], v[64:65], v[88:89], v[68:69] op_sel:[0,1,0] op_sel_hi:[1,1,1] neg_lo:[0,1,0] neg_hi:[0,1,0]
  v_pk_fma_f32 v[102:103], v[66:67], v[88:89], v[70:71] op_sel:[0,1,0] op_sel_hi:[1,1,1] neg_lo:[0,1,0] neg_hi:[0,1,0]
  v_pk_fma_f32 v[104:105], v[72:73], v[88:89], v[76:77] op_sel:[0,1,0] op_sel_hi:[1,1,1] neg_lo:[0,1,0] neg_hi:[0,1,0]
  v_pk_fma_f32 v[106:107], v[74:75], v[88:89], v[78:79] op_sel:[0,1,0] op_sel_hi:[1,1,1] neg_lo:[0,1,0] neg_hi:[0,1,0]
  v_pk_fma_f32 v[192:193], v[192:193], v[88:89], v[100:101] op_sel:[0,0,0] op_sel_hi:[1,0,1]
  v_pk_fma_f32 v[194:195], v[194:195], v[88:89], v[102:103] op_sel:[0,0,0] op_sel_hi:[1,0,1]
  v_pk_fma_f32 v[208:209], v[208:209], v[88:89], v[104:105] op_sel:[0,0,0] op_sel_hi:[1,0,1]
  v_pk_fma_f32 v[210:211], v[210:211], v[88:89], v[106:107] op_sel:[0,0,0] op_sel_hi:[1,0,1]
  v_pk_fma_f32 v[100:101], v[192:193], v[192:193], v[96:97] op_sel_hi:[1,1,0]
  v_pk_fma_f32 v[102:103], v[194:195], v[194:195], v[96:97] op_sel_hi:[1,1,0]
  v_pk_fma_f32 v[104:105], v[208:209], v[208:209], v[96:97] op_sel_hi:[1,1,0]
  v_pk_fma_f32 v[106:107], v[210:211], v[210:211], v[96:97] op_sel_hi:[1,1,0]
  v_pk_mul_f32 v[100:101], v[100:101], v[192:193] neg_lo:[0,1] neg_hi:[0,1]
  v_pk_mul_f32 v[102:103], v[102:103], v[194:195] neg_lo:[0,1] neg_hi:[0,1]
  v_pk_mul_f32 v[104:105], v[104:105], v[208:209] neg_lo:[0,1] neg_hi:[0,1]
  v_pk_mul_f32 v[106:107], v[106:107], v[210:211] neg_lo:[0,1] neg_hi:[0,1]
  v_exp_f32 v100, v100
  v_exp_f32 v101, v101
  v_exp_f32 v102, v102
  v_exp_f32 v103, v103
  v_exp_f32 v104, v104
  v_exp_f32 v105, v105
  v_exp_f32 v106, v106
  v_exp_f32 v107, v107
  v_pk_fma_f32 v[100:101], v[100:101], v[96:97], v[96:97] op_sel:[0,1,1] op_sel_hi:[1,1,1]
  v_pk_fma_f32 v[102:103], v[102:103], v[96:97], v[96:97] op_sel:[0,1,1] op_sel_hi:[1,1,1]
  v_pk_fma_f32 v[104:105], v[104:105], v[96:97], v[96:97] op_sel:[0,1,1] op_sel_hi:[1,1,1]
  v_pk_fma_f32 v[106:107], v[106:107], v[96:97], v[96:97] op_sel:[0,1,1] op_sel_hi:[1,1,1]
  v_rcp_f32 v100, v100
  v_rcp_f32 v101, v101
  v_rcp_f32 v102, v102
  v_rcp_f32 v103, v103
  v_rcp_f32 v104, v104
  v_rcp_f32 v105, v105
  v_rcp_f32 v106, v106
  v_rcp_f32 v107, v107
  v_pk_mul_f32 v[192:193], v[192:193], v[100:101]
  v_pk_mul_f32 v[194:195], v[194:195], v[102:103]
  v_pk_mul_f32 v[208:209], v[208:209], v[104:105]
  v_pk_mul_f32 v[210:211], v[210:211], v[106:107]
  v_cvt_pk_bf16_f32 v116, v192, v193
  v_cvt_pk_bf16_f32 v117, v194, v195
  v_cvt_pk_bf16_f32 v118, v208, v209
  v_cvt_pk_bf16_f32 v119, v210, v211
  buffer_store_dwordx4 v[116:119], v11, s[40:43], s6 offen offset:0 sc0 sc1
  ds_write_b128 v99, v[116:119] offset:32768
  v_pk_fma_f32 v[100:101], v[64:65], v[90:91], v[68:69] op_sel:[0,1,0] op_sel_hi:[1,1,1] neg_lo:[0,1,0] neg_hi:[0,1,0]
  v_pk_fma_f32 v[102:103], v[66:67], v[90:91], v[70:71] op_sel:[0,1,0] op_sel_hi:[1,1,1] neg_lo:[0,1,0] neg_hi:[0,1,0]
  v_pk_fma_f32 v[104:105], v[72:73], v[90:91], v[76:77] op_sel:[0,1,0] op_sel_hi:[1,1,1] neg_lo:[0,1,0] neg_hi:[0,1,0]
  v_pk_fma_f32 v[106:107], v[74:75], v[90:91], v[78:79] op_sel:[0,1,0] op_sel_hi:[1,1,1] neg_lo:[0,1,0] neg_hi:[0,1,0]
  v_pk_fma_f32 v[196:197], v[196:197], v[90:91], v[100:101] op_sel:[0,0,0] op_sel_hi:[1,0,1]
  v_pk_fma_f32 v[198:199], v[198:199], v[90:91], v[102:103] op_sel:[0,0,0] op_sel_hi:[1,0,1]
  v_pk_fma_f32 v[212:213], v[212:213], v[90:91], v[104:105] op_sel:[0,0,0] op_sel_hi:[1,0,1]
  v_pk_fma_f32 v[214:215], v[214:215], v[90:91], v[106:107] op_sel:[0,0,0] op_sel_hi:[1,0,1]
  v_pk_fma_f32 v[100:101], v[196:197], v[196:197], v[96:97] op_sel_hi:[1,1,0]
  v_pk_fma_f32 v[102:103], v[198:199], v[198:199], v[96:97] op_sel_hi:[1,1,0]
  v_pk_fma_f32 v[104:105], v[212:213], v[212:213], v[96:97] op_sel_hi:[1,1,0]
  v_pk_fma_f32 v[106:107], v[214:215], v[214:215], v[96:97] op_sel_hi:[1,1,0]
  v_pk_mul_f32 v[100:101], v[100:101], v[196:197] neg_lo:[0,1] neg_hi:[0,1]
  v_pk_mul_f32 v[102:103], v[102:103], v[198:199] neg_lo:[0,1] neg_hi:[0,1]
  v_pk_mul_f32 v[104:105], v[104:105], v[212:213] neg_lo:[0,1] neg_hi:[0,1]
  v_pk_mul_f32 v[106:107], v[106:107], v[214:215] neg_lo:[0,1] neg_hi:[0,1]
  v_exp_f32 v100, v100
  v_exp_f32 v101, v101
  v_exp_f32 v102, v102
  v_exp_f32 v103, v103
  v_exp_f32 v104, v104
  v_exp_f32 v105, v105
  v_exp_f32 v106, v106
  v_exp_f32 v107, v107
  v_pk_fma_f32 v[100:101], v[100:101], v[96:97], v[96:97] op_sel:[0,1,1] op_sel_hi:[1,1,1]
  v_pk_fma_f32 v[102:103], v[102:103], v[96:97], v[96:97] op_sel:[0,1,1] op_sel_hi:[1,1,1]
  v_pk_fma_f32 v[104:105], v[104:105], v[96:97], v[96:97] op_sel:[0,1,1] op_sel_hi:[1,1,1]
  v_pk_fma_f32 v[106:107], v[106:107], v[96:97], v[96:97] op_sel:[0,1,1] op_sel_hi:[1,1,1]
  v_rcp_f32 v100, v100
  v_rcp_f32 v101, v101
  v_rcp_f32 v102, v102
  v_rcp_f32 v103, v103
  v_rcp_f32 v104, v104
  v_rcp_f32 v105, v105
  v_rcp_f32 v106, v106
  v_rcp_f32 v107, v107
  v_pk_mul_f32 v[196:197], v[196:197], v[100:101]
  v_pk_mul_f32 v[198:199], v[198:199], v[102:103]
  v_pk_mul_f32 v[212:213], v[212:213], v[104:105]
  v_pk_mul_f32 v[214:215], v[214:215], v[106:107]
  v_cvt_pk_bf16_f32 v120, v196, v197
  v_cvt_pk_bf16_f32 v121, v198, v199
  v_cvt_pk_bf16_f32 v122, v212, v213
  v_cvt_pk_bf16_f32 v123, v214, v215
  buffer_store_dwordx4 v[120:123], v11, s[40:43], s6 offen offset:1024 sc0 sc1
  ds_write_b128 v99, v[120:123] offset:34816
  v_pk_fma_f32 v[100:101], v[64:65], v[92:93], v[68:69] op_sel:[0,1,0] op_sel_hi:[1,1,1] neg_lo:[0,1,0] neg_hi:[0,1,0]
  v_pk_fma_f32 v[102:103], v[66:67], v[92:93], v[70:71] op_sel:[0,1,0] op_sel_hi:[1,1,1] neg_lo:[0,1,0] neg_hi:[0,1,0]
  v_pk_fma_f32 v[104:105], v[72:73], v[92:93], v[76:77] op_sel:[0,1,0] op_sel_hi:[1,1,1] neg_lo:[0,1,0] neg_hi:[0,1,0]
  v_pk_fma_f32 v[106:107], v[74:75], v[92:93], v[78:79] op_sel:[0,1,0] op_sel_hi:[1,1,1] neg_lo:[0,1,0] neg_hi:[0,1,0]
  v_pk_fma_f32 v[200:201], v[200:201], v[92:93], v[100:101] op_sel:[0,0,0] op_sel_hi:[1,0,1]
  v_pk_fma_f32 v[202:203], v[202:203], v[92:93], v[102:103] op_sel:[0,0,0] op_sel_hi:[1,0,1]
  v_pk_fma_f32 v[216:217], v[216:217], v[92:93], v[104:105] op_sel:[0,0,0] op_sel_hi:[1,0,1]
  v_pk_fma_f32 v[218:219], v[218:219], v[92:93], v[106:107] op_sel:[0,0,0] op_sel_hi:[1,0,1]
  v_pk_fma_f32 v[100:101], v[200:201], v[200:201], v[96:97] op_sel_hi:[1,1,0]
  v_pk_fma_f32 v[102:103], v[202:203], v[202:203], v[96:97] op_sel_hi:[1,1,0]
  v_pk_fma_f32 v[104:105], v[216:217], v[216:217], v[96:97] op_sel_hi:[1,1,0]
  v_pk_fma_f32 v[106:107], v[218:219], v[218:219], v[96:97] op_sel_hi:[1,1,0]
  v_pk_mul_f32 v[100:101], v[100:101], v[200:201] neg_lo:[0,1] neg_hi:[0,1]
  v_pk_mul_f32 v[102:103], v[102:103], v[202:203] neg_lo:[0,1] neg_hi:[0,1]
  v_pk_mul_f32 v[104:105], v[104:105], v[216:217] neg_lo:[0,1] neg_hi:[0,1]
  v_pk_mul_f32 v[106:107], v[106:107], v[218:219] neg_lo:[0,1] neg_hi:[0,1]
  v_exp_f32 v100, v100
  v_exp_f32 v101, v101
  v_exp_f32 v102, v102
  v_exp_f32 v103, v103
  v_exp_f32 v104, v104
  v_exp_f32 v105, v105
  v_exp_f32 v106, v106
  v_exp_f32 v107, v107
  v_pk_fma_f32 v[100:101], v[100:101], v[96:97], v[96:97] op_sel:[0,1,1] op_sel_hi:[1,1,1]
  v_pk_fma_f32 v[102:103], v[102:103], v[96:97], v[96:97] op_sel:[0,1,1] op_sel_hi:[1,1,1]
  v_pk_fma_f32 v[104:105], v[104:105], v[96:97], v[96:97] op_sel:[0,1,1] op_sel_hi:[1,1,1]
  v_pk_fma_f32 v[106:107], v[106:107], v[96:97], v[96:97] op_sel:[0,1,1] op_sel_hi:[1,1,1]
  v_rcp_f32 v100, v100
  v_rcp_f32 v101, v101
  v_rcp_f32 v102, v102
  v_rcp_f32 v103, v103
  v_rcp_f32 v104, v104
  v_rcp_f32 v105, v105
  v_rcp_f32 v106, v106
  v_rcp_f32 v107, v107
  v_pk_mul_f32 v[200:201], v[200:201], v[100:101]
  v_pk_mul_f32 v[202:203], v[202:203], v[102:103]
  v_pk_mul_f32 v[216:217], v[216:217], v[104:105]
  v_pk_mul_f32 v[218:219], v[218:219], v[106:107]
  v_cvt_pk_bf16_f32 v116, v200, v201
  v_cvt_pk_bf16_f32 v117, v202, v203
  v_cvt_pk_bf16_f32 v118, v216, v217
  v_cvt_pk_bf16_f32 v119, v218, v219
  buffer_store_dwordx4 v[116:119], v11, s[40:43], s6 offen offset:2048 sc0 sc1
  ds_write_b128 v99, v[116:119] offset:36864
  v_pk_fma_f32 v[100:101], v[64:65], v[94:95], v[68:69] op_sel:[0,1,0] op_sel_hi:[1,1,1] neg_lo:[0,1,0] neg_hi:[0,1,0]
  v_pk_fma_f32 v[102:103], v[66:67], v[94:95], v[70:71] op_sel:[0,1,0] op_sel_hi:[1,1,1] neg_lo:[0,1,0] neg_hi:[0,1,0]
  v_pk_fma_f32 v[104:105], v[72:73], v[94:95], v[76:77] op_sel:[0,1,0] op_sel_hi:[1,1,1] neg_lo:[0,1,0] neg_hi:[0,1,0]
  v_pk_fma_f32 v[106:107], v[74:75], v[94:95], v[78:79] op_sel:[0,1,0] op_sel_hi:[1,1,1] neg_lo:[0,1,0] neg_hi:[0,1,0]
  v_pk_fma_f32 v[204:205], v[204:205], v[94:95], v[100:101] op_sel:[0,0,0] op_sel_hi:[1,0,1]
  v_pk_fma_f32 v[206:207], v[206:207], v[94:95], v[102:103] op_sel:[0,0,0] op_sel_hi:[1,0,1]
  v_pk_fma_f32 v[220:221], v[220:221], v[94:95], v[104:105] op_sel:[0,0,0] op_sel_hi:[1,0,1]
  v_pk_fma_f32 v[222:223], v[222:223], v[94:95], v[106:107] op_sel:[0,0,0] op_sel_hi:[1,0,1]
  v_pk_fma_f32 v[100:101], v[204:205], v[204:205], v[96:97] op_sel_hi:[1,1,0]
  v_pk_fma_f32 v[102:103], v[206:207], v[206:207], v[96:97] op_sel_hi:[1,1,0]
  v_pk_fma_f32 v[104:105], v[220:221], v[220:221], v[96:97] op_sel_hi:[1,1,0]
  v_pk_fma_f32 v[106:107], v[222:223], v[222:223], v[96:97] op_sel_hi:[1,1,0]
  v_pk_mul_f32 v[100:101], v[100:101], v[204:205] neg_lo:[0,1] neg_hi:[0,1]
  v_pk_mul_f32 v[102:103], v[102:103], v[206:207] neg_lo:[0,1] neg_hi:[0,1]
  v_pk_mul_f32 v[104:105], v[104:105], v[220:221] neg_lo:[0,1] neg_hi:[0,1]
  v_pk_mul_f32 v[106:107], v[106:107], v[222:223] neg_lo:[0,1] neg_hi:[0,1]
  v_exp_f32 v100, v100
  v_exp_f32 v101, v101
  v_exp_f32 v102, v102
  v_exp_f32 v103, v103
  v_exp_f32 v104, v104
  v_exp_f32 v105, v105
  v_exp_f32 v106, v106
  v_exp_f32 v107, v107
  v_pk_fma_f32 v[100:101], v[100:101], v[96:97], v[96:97] op_sel:[0,1,1] op_sel_hi:[1,1,1]
  v_pk_fma_f32 v[102:103], v[102:103], v[96:97], v[96:97] op_sel:[0,1,1] op_sel_hi:[1,1,1]
  v_pk_fma_f32 v[104:105], v[104:105], v[96:97], v[96:97] op_sel:[0,1,1] op_sel_hi:[1,1,1]
  v_pk_fma_f32 v[106:107], v[106:107], v[96:97], v[96:97] op_sel:[0,1,1] op_sel_hi:[1,1,1]
  v_rcp_f32 v100, v100
  v_rcp_f32 v101, v101
  v_rcp_f32 v102, v102
  v_rcp_f32 v103, v103
  v_rcp_f32 v104, v104
  v_rcp_f32 v105, v105
  v_rcp_f32 v106, v106
  v_rcp_f32 v107, v107
  v_pk_mul_f32 v[204:205], v[204:205], v[100:101]
  v_pk_mul_f32 v[206:207], v[206:207], v[102:103]
  v_pk_mul_f32 v[220:221], v[220:221], v[104:105]
  v_pk_mul_f32 v[222:223], v[222:223], v[106:107]
  v_cvt_pk_bf16_f32 v120, v204, v205
  v_cvt_pk_bf16_f32 v121, v206, v207
  v_cvt_pk_bf16_f32 v122, v220, v221
  v_cvt_pk_bf16_f32 v123, v222, v223
  buffer_store_dwordx4 v[120:123], v11, s[40:43], s6 offen offset:3072 sc0 sc1
  ds_write_b128 v99, v[120:123] offset:38912
  s_mov_b32 s16, 0
  s_mov_b32 s17, 16384
  s_mov_b32 s18, 0xffff4000
  s_mov_b32 s19, 32768
  s_mov_b32 s20, 16384
  s_mov_b32 s21, 0xffff0000
  s_mul_i32 s4, s85, 8192
  v_add_u32 v4, s4, v11
  v_add_u32 v5, 1024, v4
  s_lshl_b32 s4, s86, 1
  v_xor_b32 v2, s4, v26
  v_lshl_add_u32 v6, v2, 5, v25
  v_add_u32 v6, s19, v6
  s_add_u32 s4, s4, 1
  v_xor_b32 v2, s4, v26
  v_lshl_add_u32 v7, v2, 5, v25
  v_add_u32 v7, s19, v7
  s_mov_b32 s4, 0xffff0000
  v_lshlrev_b32 v128, 16, v240
  v_and_b32 v129, s4, v240
  v_lshlrev_b32 v130, 16, v241
  v_and_b32 v131, s4, v241
  v_lshlrev_b32 v132, 16, v242
  v_and_b32 v133, s4, v242
  v_lshlrev_b32 v134, 16, v243
  v_and_b32 v135, s4, v243
  v_lshlrev_b32 v136, 16, v244
  v_and_b32 v137, s4, v244
  v_lshlrev_b32 v138, 16, v245
  v_and_b32 v139, s4, v245
  v_lshlrev_b32 v140, 16, v246
  v_and_b32 v141, s4, v246
  v_lshlrev_b32 v142, 16, v247
  v_and_b32 v143, s4, v247
  v_lshlrev_b32 v144, 16, v248
  v_and_b32 v145, s4, v248
  v_lshlrev_b32 v146, 16, v249
  v_and_b32 v147, s4, v249
  v_lshlrev_b32 v148, 16, v250
  v_and_b32 v149, s4, v250
  v_lshlrev_b32 v150, 16, v251
  v_and_b32 v151, s4, v251
  v_lshlrev_b32 v152, 16, v252
  v_and_b32 v153, s4, v252
  v_lshlrev_b32 v154, 16, v253
  v_and_b32 v155, s4, v253
  v_lshlrev_b32 v156, 16, v254
  v_and_b32 v157, s4, v254
  v_lshlrev_b32 v158, 16, v255
  v_and_b32 v159, s4, v255
  s_lshl_b32 s5, s86, 7
  s_add_u32 s5, s5, 156160
  v_add_u32 v3, s5, v29
  ds_read_b128 v[32:35], v3
  ds_read_b128 v[36:39], v3 offset:64
  v_mov_b64 v[160:161], 0
  v_mov_b64 v[162:163], 0
  v_mov_b64 v[164:165], 0
  v_mov_b64 v[166:167], 0
  v_mov_b64 v[168:169], 0
  v_mov_b64 v[170:171], 0
  v_mov_b64 v[172:173], 0
  v_mov_b64 v[174:175], 0
  v_mov_b64 v[176:177], 0
  v_mov_b64 v[178:179], 0
  v_mov_b64 v[180:181], 0
  v_mov_b64 v[182:183], 0
  v_mov_b64 v[184:185], 0
  v_mov_b64 v[186:187], 0
  v_mov_b64 v[188:189], 0
  v_mov_b64 v[190:191], 0
  s_waitcnt lgkmcnt(0)
  v_pk_add_f32 v[128:129], v[128:129], v[32:33]
  v_pk_add_f32 v[130:131], v[130:131], v[34:35]
  v_pk_add_f32 v[132:133], v[132:133], v[36:37]
  v_pk_add_f32 v[134:135], v[134:135], v[38:39]
  v_pk_add_f32 v[136:137], v[136:137], v[32:33]
  v_pk_add_f32 v[138:139], v[138:139], v[34:35]
  v_pk_add_f32 v[140:141], v[140:141], v[36:37]
  v_pk_add_f32 v[142:143], v[142:143], v[38:39]
  v_pk_add_f32 v[144:145], v[144:145], v[32:33]
  v_pk_add_f32 v[146:147], v[146:147], v[34:35]
  v_pk_add_f32 v[148:149], v[148:149], v[36:37]
  v_pk_add_f32 v[150:151], v[150:151], v[38:39]
  v_pk_add_f32 v[152:153], v[152:153], v[32:33]
  v_pk_add_f32 v[154:155], v[154:155], v[34:35]
  v_pk_add_f32 v[156:157], v[156:157], v[36:37]
  v_pk_add_f32 v[158:159], v[158:159], v[38:39]
  s_xor_b32 s8, s84, 16384
  s_lshl_b32 s6, s8, 4
  s_lshl_b32 s7, s81, 13
  s_add_u32 s7, s7, s83
  s_add_u32 s7, s7, 23068672
  s_add_u32 s6, s6, s7
  s_add_u32 s9, s6, 4096
  s_lshl_b32 s8, s84, 4
  s_add_u32 s8, s8, s7
  s_add_u32 s10, s8, 4096
  s_mov_b32 s22, 12
  s_barrier
  ds_read_b64_tr_b16 v[48:49], v6 offset:0
  ds_read_b64_tr_b16 v[50:51], v6 offset:2048
  ds_read_b128 v[32:35], v4 offset:0
  ds_read_b128 v[36:39], v4 offset:2048
  ds_read_b128 v[40:43], v4 offset:4096
  ds_read_b128 v[44:47], v4 offset:6144
  ds_read_b64_tr_b16 v[52:53], v7 offset:0
  ds_read_b64_tr_b16 v[54:55], v7 offset:2048
  ds_read_b64_tr_b16 v[56:57], v6 offset:8192
  ds_read_b64_tr_b16 v[58:59], v6 offset:10240
  ds_read_b64_tr_b16 v[60:61], v7 offset:8192
  ds_read_b64_tr_b16 v[62:63], v7 offset:10240
  ds_read_b64_tr_b16 v[80:81], v6 offset:4096
  s_waitcnt lgkmcnt(4)
  ds_read_b64_tr_b16 v[82:83], v6 offset:6144
  ds_read_b128 v[64:67], v5 offset:0
  ds_read_b128 v[68:71], v5 offset:2048
  ds_read_b128 v[72:75], v5 offset:4096
  ds_read_b128 v[76:79], v5 offset:6144
  ds_read_b64_tr_b16 v[84:85], v7 offset:4096
  ds_read_b64_tr_b16 v[86:87], v7 offset:6144
  ds_read_b64_tr_b16 v[88:89], v6 offset:12288
  ds_read_b64_tr_b16 v[90:91], v6 offset:14336
  ds_read_b64_tr_b16 v[92:93], v7 offset:12288
  ds_read_b64_tr_b16 v[94:95], v7 offset:14336
  s_add_u32 s16, s16, s17
  s_cmp_eq_u32 s16, 65536
  s_cselect_b32 s23, s18, s17
  s_cselect_b32 s16, 0, s16
  v_add_u32 v4, s23, v4
  v_add_u32 v5, s23, v5
  s_add_u32 s19, s19, s20
  s_cmp_eq_u32 s19, 81920
  s_cselect_b32 s23, s21, s20
  s_cselect_b32 s19, 0, s19
  v_add_u32 v6, s23, v6
  v_add_u32 v7, s23, v7
  s_waitcnt lgkmcnt(0)
Lk_14:
  s_barrier
  v_mfma_f32_16x16x32_bf16 v[128:131], v[48:51], v[32:35], v[128:131]
  ds_read_b64_tr_b16 v[112:113], v6 offset:0
  v_mfma_f32_16x16x32_bf16 v[136:139], v[48:51], v[36:39], v[136:139]
  ds_read_b64_tr_b16 v[114:115], v6 offset:2048
  v_mfma_f32_16x16x32_bf16 v[144:147], v[48:51], v[40:43], v[144:147]
  ds_read_b128 v[96:99], v4 offset:0
  v_mfma_f32_16x16x32_bf16 v[152:155], v[48:51], v[44:47], v[152:155]
  ds_read_b128 v[100:103], v4 offset:2048
  v_mfma_f32_16x16x32_bf16 v[132:135], v[52:55], v[32:35], v[132:135]
  ds_read_b128 v[104:107], v4 offset:4096
  v_mfma_f32_16x16x32_bf16 v[140:143], v[52:55], v[36:39], v[140:143]
  ds_read_b128 v[108:111], v4 offset:6144
  v_mfma_f32_16x16x32_bf16 v[148:151], v[52:55], v[40:43], v[148:151]
  ds_read_b64_tr_b16 v[116:117], v7 offset:0
  v_mfma_f32_16x16x32_bf16 v[156:159], v[52:55], v[44:47], v[156:159]
  ds_read_b64_tr_b16 v[118:119], v7 offset:2048
  v_mfma_f32_16x16x32_bf16 v[160:163], v[56:59], v[32:35], v[160:163]
  ds_read_b64_tr_b16 v[120:121], v6 offset:8192
  v_mfma_f32_16x16x32_bf16 v[168:171], v[56:59], v[36:39], v[168:171]
  ds_read_b64_tr_b16 v[122:123], v6 offset:10240
  v_mfma_f32_16x16x32_bf16 v[176:179], v[56:59], v[40:43], v[176:179]
  ds_read_b64_tr_b16 v[124:125], v7 offset:8192
  v_mfma_f32_16x16x32_bf16 v[184:187], v[56:59], v[44:47], v[184:187]
  ds_read_b64_tr_b16 v[126:127], v7 offset:10240
  v_mfma_f32_16x16x32_bf16 v[164:167], v[60:63], v[32:35], v[164:167]
  ds_read_b64_tr_b16 v[208:209], v6 offset:4096
  v_mfma_f32_16x16x32_bf16 v[172:175], v[60:63], v[36:39], v[172:175]
  ds_read_b64_tr_b16 v[210:211], v6 offset:6144
  v_mfma_f32_16x16x32_bf16 v[180:183], v[60:63], v[40:43], v[180:183]
  ds_read_b128 v[192:195], v5 offset:0
  v_mfma_f32_16x16x32_bf16 v[188:191], v[60:63], v[44:47], v[188:191]
  ds_read_b128 v[196:199], v5 offset:2048
  v_mfma_f32_16x16x32_bf16 v[128:131], v[80:83], v[64:67], v[128:131]
  ds_read_b128 v[200:203], v5 offset:4096
  v_mfma_f32_16x16x32_bf16 v[136:139], v[80:83], v[68:71], v[136:139]
  ds_read_b128 v[204:207], v5 offset:6144
  v_mfma_f32_16x16x32_bf16 v[144:147], v[80:83], v[72:75], v[144:147]
  ds_read_b64_tr_b16 v[212:213], v7 offset:4096
  v_mfma_f32_16x16x32_bf16 v[152:155], v[80:83], v[76:79], v[152:155]
  ds_read_b64_tr_b16 v[214:215], v7 offset:6144
  v_mfma_f32_16x16x32_bf16 v[132:135], v[84:87], v[64:67], v[132:135]
  ds_read_b64_tr_b16 v[216:217], v6 offset:12288
  v_mfma_f32_16x16x32_bf16 v[140:143], v[84:87], v[68:71], v[140:143]
  ds_read_b64_tr_b16 v[218:219], v6 offset:14336
  v_mfma_f32_16x16x32_bf16 v[148:151], v[84:87], v[72:75], v[148:151]
  ds_read_b64_tr_b16 v[220:221], v7 offset:12288
  v_mfma_f32_16x16x32_bf16 v[156:159], v[84:87], v[76:79], v[156:159]
  ds_read_b64_tr_b16 v[222:223], v7 offset:14336
  v_mfma_f32_16x16x32_bf16 v[160:163], v[88:91], v[64:67], v[160:163]
  s_add_u32 s16, s16, s17
  s_cmp_eq_u32 s16, 65536
  s_cselect_b32 s23, s18, s17
  v_mfma_f32_16x16x32_bf16 v[168:171], v[88:91], v[68:71], v[168:171]
  s_cselect_b32 s16, 0, s16
  v_add_u32 v4, s23, v4
  v_add_u32 v5, s23, v5
  v_mfma_f32_16x16x32_bf16 v[176:179], v[88:91], v[72:75], v[176:179]
  s_add_u32 s19, s19, s20
  s_cmp_eq_u32 s19, 81920
  s_cselect_b32 s23, s21, s20
  v_mfma_f32_16x16x32_bf16 v[184:187], v[88:91], v[76:79], v[184:187]
  s_cselect_b32 s19, 0, s19
  v_add_u32 v6, s23, v6
  v_add_u32 v7, s23, v7
  v_mfma_f32_16x16x32_bf16 v[164:167], v[92:95], v[64:67], v[164:167]
  v_mfma_f32_16x16x32_bf16 v[172:175], v[92:95], v[68:71], v[172:175]
  v_mfma_f32_16x16x32_bf16 v[180:183], v[92:95], v[72:75], v[180:183]
  s_waitcnt lgkmcnt(0)
  v_mfma_f32_16x16x32_bf16 v[188:191], v[92:95], v[76:79], v[188:191]
  s_waitcnt vmcnt(0)
  s_barrier
  v_mfma_f32_16x16x32_bf16 v[128:131], v[112:115], v[96:99], v[128:131]
  ds_read_b64_tr_b16 v[48:49], v6 offset:0
  v_mfma_f32_16x16x32_bf16 v[136:139], v[112:115], v[100:103], v[136:139]
  ds_read_b64_tr_b16 v[50:51], v6 offset:2048
  v_mfma_f32_16x16x32_bf16 v[144:147], v[112:115], v[104:107], v[144:147]
  ds_read_b128 v[32:35], v4 offset:0
  v_mfma_f32_16x16x32_bf16 v[152:155], v[112:115], v[108:111], v[152:155]
  ds_read_b128 v[36:39], v4 offset:2048
  v_mfma_f32_16x16x32_bf16 v[132:135], v[116:119], v[96:99], v[132:135]
  ds_read_b128 v[40:43], v4 offset:4096
  v_mfma_f32_16x16x32_bf16 v[140:143], v[116:119], v[100:103], v[140:143]
  ds_read_b128 v[44:47], v4 offset:6144
  v_mfma_f32_16x16x32_bf16 v[148:151], v[116:119], v[104:107], v[148:151]
  ds_read_b64_tr_b16 v[52:53], v7 offset:0
  v_mfma_f32_16x16x32_bf16 v[156:159], v[116:119], v[108:111], v[156:159]
  ds_read_b64_tr_b16 v[54:55], v7 offset:2048
  v_mfma_f32_16x16x32_bf16 v[160:163], v[120:123], v[96:99], v[160:163]
  ds_read_b64_tr_b16 v[56:57], v6 offset:8192
  v_mfma_f32_16x16x32_bf16 v[168:171], v[120:123], v[100:103], v[168:171]
  ds_read_b64_tr_b16 v[58:59], v6 offset:10240
  v_mfma_f32_16x16x32_bf16 v[176:179], v[120:123], v[104:107], v[176:179]
  ds_read_b64_tr_b16 v[60:61], v7 offset:8192
  v_mfma_f32_16x16x32_bf16 v[184:187], v[120:123], v[108:111], v[184:187]
  ds_read_b64_tr_b16 v[62:63], v7 offset:10240
  v_mfma_f32_16x16x32_bf16 v[164:167], v[124:127], v[96:99], v[164:167]
  ds_read_b64_tr_b16 v[80:81], v6 offset:4096
  v_mfma_f32_16x16x32_bf16 v[172:175], v[124:127], v[100:103], v[172:175]
  ds_read_b64_tr_b16 v[82:83], v6 offset:6144
  v_mfma_f32_16x16x32_bf16 v[180:183], v[124:127], v[104:107], v[180:183]
  ds_read_b128 v[64:67], v5 offset:0
  v_mfma_f32_16x16x32_bf16 v[188:191], v[124:127], v[108:111], v[188:191]
  ds_read_b128 v[68:71], v5 offset:2048
  v_mfma_f32_16x16x32_bf16 v[128:131], v[208:211], v[192:195], v[128:131]
  ds_read_b128 v[72:75], v5 offset:4096
  v_mfma_f32_16x16x32_bf16 v[136:139], v[208:211], v[196:199], v[136:139]
  ds_read_b128 v[76:79], v5 offset:6144
  v_mfma_f32_16x16x32_bf16 v[144:147], v[208:211], v[200:203], v[144:147]
  ds_read_b64_tr_b16 v[84:85], v7 offset:4096
  v_mfma_f32_16x16x32_bf16 v[152:155], v[208:211], v[204:207], v[152:155]
  ds_read_b64_tr_b16 v[86:87], v7 offset:6144
  v_mfma_f32_16x16x32_bf16 v[132:135], v[212:215], v[192:195], v[132:135]
  ds_read_b64_tr_b16 v[88:89], v6 offset:12288
  v_mfma_f32_16x16x32_bf16 v[140:143], v[212:215], v[196:199], v[140:143]
  ds_read_b64_tr_b16 v[90:91], v6 offset:14336
  v_mfma_f32_16x16x32_bf16 v[148:151], v[212:215], v[200:203], v[148:151]
  ds_read_b64_tr_b16 v[92:93], v7 offset:12288
  v_mfma_f32_16x16x32_bf16 v[156:159], v[212:215], v[204:207], v[156:159]
  ds_read_b64_tr_b16 v[94:95], v7 offset:14336
  v_mfma_f32_16x16x32_bf16 v[160:163], v[216:219], v[192:195], v[160:163]
  s_add_u32 s16, s16, s17
  s_cmp_eq_u32 s16, 65536
  s_cselect_b32 s23, s18, s17
  v_mfma_f32_16x16x32_bf16 v[168:171], v[216:219], v[196:199], v[168:171]
  s_cselect_b32 s16, 0, s16
  v_add_u32 v4, s23, v4
  v_add_u32 v5, s23, v5
  v_mfma_f32_16x16x32_bf16 v[176:179], v[216:219], v[200:203], v[176:179]
  s_add_u32 s19, s19, s20
  s_cmp_eq_u32 s19, 81920
  s_cselect_b32 s23, s21, s20
  v_mfma_f32_16x16x32_bf16 v[184:187], v[216:219], v[204:207], v[184:187]
  s_cselect_b32 s19, 0, s19
  v_add_u32 v6, s23, v6
  v_add_u32 v7, s23, v7
  v_mfma_f32_16x16x32_bf16 v[164:167], v[220:223], v[192:195], v[164:167]
  s_sub_u32 s22, s22, 1
  s_cmp_lg_u32 s22, 0
  v_mfma_f32_16x16x32_bf16 v[172:175], v[220:223], v[196:199], v[172:175]
  v_mfma_f32_16x16x32_bf16 v[180:183], v[220:223], v[200:203], v[180:183]
  s_waitcnt lgkmcnt(0)
  v_mfma_f32_16x16x32_bf16 v[188:191], v[220:223], v[204:207], v[188:191]
  s_cbranch_scc1 Lk_14
  v_cvt_pk_bf16_f32 v160, v160, v161
  v_cvt_pk_bf16_f32 v161, v162, v163
  v_cvt_pk_bf16_f32 v162, v164, v165
  v_cvt_pk_bf16_f32 v163, v166, v167
  buffer_store_dwordx4 v[160:163], v11, s[40:43], s6 offen offset:0 sc0 sc1
  v_cvt_pk_bf16_f32 v164, v168, v169
  v_cvt_pk_bf16_f32 v165, v170, v171
  v_cvt_pk_bf16_f32 v166, v172, v173
  v_cvt_pk_bf16_f32 v167, v174, v175
  buffer_store_dwordx4 v[164:167], v11, s[40:43], s6 offen offset:1024 sc0 sc1
  v_cvt_pk_bf16_f32 v168, v176, v177
  v_cvt_pk_bf16_f32 v169, v178, v179
  v_cvt_pk_bf16_f32 v170, v180, v181
  v_cvt_pk_bf16_f32 v171, v182, v183
  buffer_store_dwordx4 v[168:171], v11, s[40:43], s6 offen offset:2048 sc0 sc1
  v_cvt_pk_bf16_f32 v172, v184, v185
  v_cvt_pk_bf16_f32 v173, v186, v187
  v_cvt_pk_bf16_f32 v174, v188, v189
  v_cvt_pk_bf16_f32 v175, v190, v191
  buffer_store_dwordx4 v[172:175], v11, s[40:43], s6 offen offset:3072 sc0 sc1
  s_barrier
  v_mfma_f32_16x16x32_bf16 v[128:131], v[48:51], v[32:35], v[128:131]
  ds_read_b64_tr_b16 v[112:113], v6 offset:0
  ds_read_b64_tr_b16 v[114:115], v6 offset:2048
  v_mfma_f32_16x16x32_bf16 v[136:139], v[48:51], v[36:39], v[136:139]
  ds_read_b128 v[96:99], v4 offset:0
  ds_read_b128 v[100:103], v4 offset:2048
  v_mfma_f32_16x16x32_bf16 v[144:147], v[48:51], v[40:43], v[144:147]
  ds_read_b128 v[104:107], v4 offset:4096
  ds_read_b128 v[108:111], v4 offset:6144
  v_mfma_f32_16x16x32_bf16 v[152:155], v[48:51], v[44:47], v[152:155]
  ds_read_b64_tr_b16 v[116:117], v7 offset:0
  ds_read_b64_tr_b16 v[118:119], v7 offset:2048
  v_mfma_f32_16x16x32_bf16 v[132:135], v[52:55], v[32:35], v[132:135]
  ds_read_b64_tr_b16 v[208:209], v6 offset:4096
  ds_read_b64_tr_b16 v[210:211], v6 offset:6144
  v_mfma_f32_16x16x32_bf16 v[140:143], v[52:55], v[36:39], v[140:143]
  ds_read_b128 v[192:195], v5 offset:0
  ds_read_b128 v[196:199], v5 offset:2048
  v_mfma_f32_16x16x32_bf16 v[148:151], v[52:55], v[40:43], v[148:151]
  ds_read_b128 v[200:203], v5 offset:4096
  ds_read_b128 v[204:207], v5 offset:6144
  v_mfma_f32_16x16x32_bf16 v[156:159], v[52:55], v[44:47], v[156:159]
  ds_read_b64_tr_b16 v[212:213], v7 offset:4096
  ds_read_b64_tr_b16 v[214:215], v7 offset:6144
  v_mfma_f32_16x16x32_bf16 v[128:131], v[80:83], v[64:67], v[128:131]
  s_add_u32 s16, s16, s17
  s_cmp_eq_u32 s16, 65536
  v_mfma_f32_16x16x32_bf16 v[136:139], v[80:83], v[68:71], v[136:139]
  s_cselect_b32 s23, s18, s17
  s_cselect_b32 s16, 0, s16
  v_mfma_f32_16x16x32_bf16 v[144:147], v[80:83], v[72:75], v[144:147]
  v_add_u32 v4, s23, v4
  v_add_u32 v5, s23, v5
  v_mfma_f32_16x16x32_bf16 v[152:155], v[80:83], v[76:79], v[152:155]
  s_add_u32 s19, s19, s20
  s_cmp_eq_u32 s19, 81920
  v_mfma_f32_16x16x32_bf16 v[132:135], v[84:87], v[64:67], v[132:135]
  s_cselect_b32 s23, s21, s20
  s_cselect_b32 s19, 0, s19
  v_mfma_f32_16x16x32_bf16 v[140:143], v[84:87], v[68:71], v[140:143]
  v_add_u32 v6, s23, v6
  v_add_u32 v7, s23, v7
  v_mfma_f32_16x16x32_bf16 v[148:151], v[84:87], v[72:75], v[148:151]
  s_waitcnt lgkmcnt(0)
  v_mfma_f32_16x16x32_bf16 v[156:159], v[84:87], v[76:79], v[156:159]
  s_barrier
  v_mfma_f32_16x16x32_bf16 v[128:131], v[112:115], v[96:99], v[128:131]
  ds_read_b64_tr_b16 v[48:49], v6 offset:0
  ds_read_b64_tr_b16 v[50:51], v6 offset:2048
  v_mfma_f32_16x16x32_bf16 v[136:139], v[112:115], v[100:103], v[136:139]
  ds_read_b128 v[32:35], v4 offset:0
  ds_read_b128 v[36:39], v4 offset:2048
  v_mfma_f32_16x16x32_bf16 v[144:147], v[112:115], v[104:107], v[144:147]
  ds_read_b128 v[40:43], v4 offset:4096
  ds_read_b128 v[44:47], v4 offset:6144
  v_mfma_f32_16x16x32_bf16 v[152:155], v[112:115], v[108:111], v[152:155]
  ds_read_b64_tr_b16 v[52:53], v7 offset:0
  ds_read_b64_tr_b16 v[54:55], v7 offset:2048
  v_mfma_f32_16x16x32_bf16 v[132:135], v[116:119], v[96:99], v[132:135]
  ds_read_b64_tr_b16 v[80:81], v6 offset:4096
  ds_read_b64_tr_b16 v[82:83], v6 offset:6144
  v_mfma_f32_16x16x32_bf16 v[140:143], v[116:119], v[100:103], v[140:143]
  ds_read_b128 v[64:67], v5 offset:0
  ds_read_b128 v[68:71], v5 offset:2048
  v_mfma_f32_16x16x32_bf16 v[148:151], v[116:119], v[104:107], v[148:151]
  ds_read_b128 v[72:75], v5 offset:4096
  ds_read_b128 v[76:79], v5 offset:6144
  v_mfma_f32_16x16x32_bf16 v[156:159], v[116:119], v[108:111], v[156:159]
  ds_read_b64_tr_b16 v[84:85], v7 offset:4096
  ds_read_b64_tr_b16 v[86:87], v7 offset:6144
  v_mfma_f32_16x16x32_bf16 v[128:131], v[208:211], v[192:195], v[128:131]
  s_add_u32 s16, s16, s17
  s_cmp_eq_u32 s16, 65536
  v_mfma_f32_16x16x32_bf16 v[136:139], v[208:211], v[196:199], v[136:139]
  s_cselect_b32 s23, s18, s17
  s_cselect_b32 s16, 0, s16
  v_mfma_f32_16x16x32_bf16 v[144:147], v[208:211], v[200:203], v[144:147]
  v_add_u32 v4, s23, v4
  v_add_u32 v5, s23, v5
  v_mfma_f32_16x16x32_bf16 v[152:155], v[208:211], v[204:207], v[152:155]
  s_add_u32 s19, s19, s20
  s_cmp_eq_u32 s19, 81920
  v_mfma_f32_16x16x32_bf16 v[132:135], v[212:215], v[192:195], v[132:135]
  s_cselect_b32 s23, s21, s20
  s_cselect_b32 s19, 0, s19
  v_mfma_f32_16x16x32_bf16 v[140:143], v[212:215], v[196:199], v[140:143]
  v_add_u32 v6, s23, v6
  v_add_u32 v7, s23, v7
  v_mfma_f32_16x16x32_bf16 v[148:151], v[212:215], v[200:203], v[148:151]
  s_waitcnt lgkmcnt(0)
  v_mfma_f32_16x16x32_bf16 v[156:159], v[212:215], v[204:207], v[156:159]
  s_waitcnt vmcnt(0)
  s_barrier
  v_mfma_f32_16x16x32_bf16 v[128:131], v[48:51], v[32:35], v[128:131]
  ds_read_b64_tr_b16 v[112:113], v6 offset:0
  ds_read_b64_tr_b16 v[114:115], v6 offset:2048
  v_mfma_f32_16x16x32_bf16 v[136:139], v[48:51], v[36:39], v[136:139]
  ds_read_b128 v[96:99], v4 offset:0
  ds_read_b128 v[100:103], v4 offset:2048
  v_mfma_f32_16x16x32_bf16 v[144:147], v[48:51], v[40:43], v[144:147]
  ds_read_b128 v[104:107], v4 offset:4096
  ds_read_b128 v[108:111], v4 offset:6144
  v_mfma_f32_16x16x32_bf16 v[152:155], v[48:51], v[44:47], v[152:155]
  ds_read_b64_tr_b16 v[116:117], v7 offset:0
  ds_read_b64_tr_b16 v[118:119], v7 offset:2048
  v_mfma_f32_16x16x32_bf16 v[132:135], v[52:55], v[32:35], v[132:135]
  ds_read_b64_tr_b16 v[208:209], v6 offset:4096
  ds_read_b64_tr_b16 v[210:211], v6 offset:6144
  v_mfma_f32_16x16x32_bf16 v[140:143], v[52:55], v[36:39], v[140:143]
  ds_read_b128 v[192:195], v5 offset:0
  ds_read_b128 v[196:199], v5 offset:2048
  v_mfma_f32_16x16x32_bf16 v[148:151], v[52:55], v[40:43], v[148:151]
  ds_read_b128 v[200:203], v5 offset:4096
  ds_read_b128 v[204:207], v5 offset:6144
  v_mfma_f32_16x16x32_bf16 v[156:159], v[52:55], v[44:47], v[156:159]
  ds_read_b64_tr_b16 v[212:213], v7 offset:4096
  ds_read_b64_tr_b16 v[214:215], v7 offset:6144
  v_mfma_f32_16x16x32_bf16 v[128:131], v[80:83], v[64:67], v[128:131]
  s_add_u32 s16, s16, s17
  s_cmp_eq_u32 s16, 65536
  v_mfma_f32_16x16x32_bf16 v[136:139], v[80:83], v[68:71], v[136:139]
  s_cselect_b32 s23, s18, s17
  s_cselect_b32 s16, 0, s16
  v_mfma_f32_16x16x32_bf16 v[144:147], v[80:83], v[72:75], v[144:147]
  v_add_u32 v4, s23, v4
  v_add_u32 v5, s23, v5
  v_mfma_f32_16x16x32_bf16 v[152:155], v[80:83], v[76:79], v[152:155]
  s_add_u32 s19, s19, s20
  s_cmp_eq_u32 s19, 81920
  v_mfma_f32_16x16x32_bf16 v[132:135], v[84:87], v[64:67], v[132:135]
  s_cselect_b32 s23, s21, s20
  s_cselect_b32 s19, 0, s19
  v_mfma_f32_16x16x32_bf16 v[140:143], v[84:87], v[68:71], v[140:143]
  v_add_u32 v6, s23, v6
  v_add_u32 v7, s23, v7
  v_mfma_f32_16x16x32_bf16 v[148:151], v[84:87], v[72:75], v[148:151]
  s_waitcnt lgkmcnt(0)
  v_mfma_f32_16x16x32_bf16 v[156:159], v[84:87], v[76:79], v[156:159]
  s_barrier
  v_mfma_f32_16x16x32_bf16 v[128:131], v[112:115], v[96:99], v[128:131]
  ds_read_b64_tr_b16 v[48:49], v6 offset:0
  ds_read_b64_tr_b16 v[50:51], v6 offset:2048
  v_mfma_f32_16x16x32_bf16 v[136:139], v[112:115], v[100:103], v[136:139]
  ds_read_b128 v[32:35], v4 offset:0
  ds_read_b128 v[36:39], v4 offset:2048
  v_mfma_f32_16x16x32_bf16 v[144:147], v[112:115], v[104:107], v[144:147]
  ds_read_b128 v[40:43], v4 offset:4096
  ds_read_b128 v[44:47], v4 offset:6144
  v_mfma_f32_16x16x32_bf16 v[152:155], v[112:115], v[108:111], v[152:155]
  ds_read_b64_tr_b16 v[52:53], v7 offset:0
  ds_read_b64_tr_b16 v[54:55], v7 offset:2048
  v_mfma_f32_16x16x32_bf16 v[132:135], v[116:119], v[96:99], v[132:135]
  ds_read_b64_tr_b16 v[80:81], v6 offset:4096
  ds_read_b64_tr_b16 v[82:83], v6 offset:6144
  v_mfma_f32_16x16x32_bf16 v[140:143], v[116:119], v[100:103], v[140:143]
  ds_read_b128 v[64:67], v5 offset:0
  ds_read_b128 v[68:71], v5 offset:2048
  v_mfma_f32_16x16x32_bf16 v[148:151], v[116:119], v[104:107], v[148:151]
  ds_read_b128 v[72:75], v5 offset:4096
  ds_read_b128 v[76:79], v5 offset:6144
  v_mfma_f32_16x16x32_bf16 v[156:159], v[116:119], v[108:111], v[156:159]
  ds_read_b64_tr_b16 v[84:85], v7 offset:4096
  ds_read_b64_tr_b16 v[86:87], v7 offset:6144
  v_mfma_f32_16x16x32_bf16 v[128:131], v[208:211], v[192:195], v[128:131]
  s_add_u32 s16, s16, s17
  s_cmp_eq_u32 s16, 65536
  v_mfma_f32_16x16x32_bf16 v[136:139], v[208:211], v[196:199], v[136:139]
  s_cselect_b32 s23, s18, s17
  s_cselect_b32 s16, 0, s16
  v_mfma_f32_16x16x32_bf16 v[144:147], v[208:211], v[200:203], v[144:147]
  v_add_u32 v4, s23, v4
  v_add_u32 v5, s23, v5
  v_mfma_f32_16x16x32_bf16 v[152:155], v[208:211], v[204:207], v[152:155]
  s_add_u32 s19, s19, s20
  s_cmp_eq_u32 s19, 81920
  v_mfma_f32_16x16x32_bf16 v[132:135], v[212:215], v[192:195], v[132:135]
  s_cselect_b32 s23, s21, s20
  s_cselect_b32 s19, 0, s19
  v_mfma_f32_16x16x32_bf16 v[140:143], v[212:215], v[196:199], v[140:143]
  v_add_u32 v6, s23, v6
  v_add_u32 v7, s23, v7
  v_mfma_f32_16x16x32_bf16 v[148:151], v[212:215], v[200:203], v[148:151]
  s_waitcnt lgkmcnt(0)
  v_mfma_f32_16x16x32_bf16 v[156:159], v[212:215], v[204:207], v[156:159]
  s_barrier
  v_mfma_f32_16x16x32_bf16 v[128:131], v[48:51], v[32:35], v[128:131]
  ds_read_b64_tr_b16 v[112:113], v6 offset:0
  ds_read_b64_tr_b16 v[114:115], v6 offset:2048
  v_mfma_f32_16x16x32_bf16 v[136:139], v[48:51], v[36:39], v[136:139]
  ds_read_b128 v[96:99], v4 offset:0
  ds_read_b128 v[100:103], v4 offset:2048
  v_mfma_f32_16x16x32_bf16 v[144:147], v[48:51], v[40:43], v[144:147]
  ds_read_b128 v[104:107], v4 offset:4096
  ds_read_b128 v[108:111], v4 offset:6144
  v_mfma_f32_16x16x32_bf16 v[152:155], v[48:51], v[44:47], v[152:155]
  ds_read_b64_tr_b16 v[116:117], v7 offset:0
  ds_read_b64_tr_b16 v[118:119], v7 offset:2048
  v_mfma_f32_16x16x32_bf16 v[132:135], v[52:55], v[32:35], v[132:135]
  ds_read_b64_tr_b16 v[208:209], v6 offset:4096
  ds_read_b64_tr_b16 v[210:211], v6 offset:6144
  v_mfma_f32_16x16x32_bf16 v[140:143], v[52:55], v[36:39], v[140:143]
  ds_read_b128 v[192:195], v5 offset:0
  ds_read_b128 v[196:199], v5 offset:2048
  v_mfma_f32_16x16x32_bf16 v[148:151], v[52:55], v[40:43], v[148:151]
  ds_read_b128 v[200:203], v5 offset:4096
  ds_read_b128 v[204:207], v5 offset:6144
  v_mfma_f32_16x16x32_bf16 v[156:159], v[52:55], v[44:47], v[156:159]
  ds_read_b64_tr_b16 v[212:213], v7 offset:4096
  ds_read_b64_tr_b16 v[214:215], v7 offset:6144
  v_mfma_f32_16x16x32_bf16 v[128:131], v[80:83], v[64:67], v[128:131]
  s_add_u32 s16, s16, s17
  s_cmp_eq_u32 s16, 65536
  v_mfma_f32_16x16x32_bf16 v[136:139], v[80:83], v[68:71], v[136:139]
  s_cselect_b32 s23, s18, s17
  s_cselect_b32 s16, 0, s16
  v_mfma_f32_16x16x32_bf16 v[144:147], v[80:83], v[72:75], v[144:147]
  v_add_u32 v4, s23, v4
  v_add_u32 v5, s23, v5
  v_mfma_f32_16x16x32_bf16 v[152:155], v[80:83], v[76:79], v[152:155]
  s_add_u32 s19, s19, s20
  s_cmp_eq_u32 s19, 81920
  v_mfma_f32_16x16x32_bf16 v[132:135], v[84:87], v[64:67], v[132:135]
  s_cselect_b32 s23, s21, s20
  s_cselect_b32 s19, 0, s19
  v_mfma_f32_16x16x32_bf16 v[140:143], v[84:87], v[68:71], v[140:143]
  v_add_u32 v6, s23, v6
  v_add_u32 v7, s23, v7
  v_mfma_f32_16x16x32_bf16 v[148:151], v[84:87], v[72:75], v[148:151]
  s_waitcnt lgkmcnt(0)
  v_mfma_f32_16x16x32_bf16 v[156:159], v[84:87], v[76:79], v[156:159]
  s_barrier
  v_mfma_f32_16x16x32_bf16 v[128:131], v[112:115], v[96:99], v[128:131]
  ds_read_b64_tr_b16 v[48:49], v6 offset:0
  ds_read_b64_tr_b16 v[50:51], v6 offset:2048
  v_mfma_f32_16x16x32_bf16 v[136:139], v[112:115], v[100:103], v[136:139]
  ds_read_b128 v[32:35], v4 offset:0
  ds_read_b128 v[36:39], v4 offset:2048
  v_mfma_f32_16x16x32_bf16 v[144:147], v[112:115], v[104:107], v[144:147]
  ds_read_b128 v[40:43], v4 offset:4096
  ds_read_b128 v[44:47], v4 offset:6144
  v_mfma_f32_16x16x32_bf16 v[152:155], v[112:115], v[108:111], v[152:155]
  ds_read_b64_tr_b16 v[52:53], v7 offset:0
  ds_read_b64_tr_b16 v[54:55], v7 offset:2048
  v_mfma_f32_16x16x32_bf16 v[132:135], v[116:119], v[96:99], v[132:135]
  ds_read_b64_tr_b16 v[80:81], v6 offset:4096
  ds_read_b64_tr_b16 v[82:83], v6 offset:6144
  v_mfma_f32_16x16x32_bf16 v[140:143], v[116:119], v[100:103], v[140:143]
  ds_read_b128 v[64:67], v5 offset:0
  ds_read_b128 v[68:71], v5 offset:2048
  v_mfma_f32_16x16x32_bf16 v[148:151], v[116:119], v[104:107], v[148:151]
  ds_read_b128 v[72:75], v5 offset:4096
  ds_read_b128 v[76:79], v5 offset:6144
  v_mfma_f32_16x16x32_bf16 v[156:159], v[116:119], v[108:111], v[156:159]
  ds_read_b64_tr_b16 v[84:85], v7 offset:4096
  ds_read_b64_tr_b16 v[86:87], v7 offset:6144
  v_mfma_f32_16x16x32_bf16 v[128:131], v[208:211], v[192:195], v[128:131]
  s_add_u32 s16, s16, s17
  s_cmp_eq_u32 s16, 65536
  v_mfma_f32_16x16x32_bf16 v[136:139], v[208:211], v[196:199], v[136:139]
  s_cselect_b32 s23, s18, s17
  s_cselect_b32 s16, 0, s16
  v_mfma_f32_16x16x32_bf16 v[144:147], v[208:211], v[200:203], v[144:147]
  v_add_u32 v4, s23, v4
  v_add_u32 v5, s23, v5
  v_mfma_f32_16x16x32_bf16 v[152:155], v[208:211], v[204:207], v[152:155]
  s_add_u32 s19, s19, s20
  s_cmp_eq_u32 s19, 81920
  v_mfma_f32_16x16x32_bf16 v[132:135], v[212:215], v[192:195], v[132:135]
  s_cselect_b32 s23, s21, s20
  s_cselect_b32 s19, 0, s19
  v_mfma_f32_16x16x32_bf16 v[140:143], v[212:215], v[196:199], v[140:143]
  v_add_u32 v6, s23, v6
  v_add_u32 v7, s23, v7
  v_mfma_f32_16x16x32_bf16 v[148:151], v[212:215], v[200:203], v[148:151]
  s_waitcnt lgkmcnt(0)
  v_mfma_f32_16x16x32_bf16 v[156:159], v[212:215], v[204:207], v[156:159]
  s_barrier
  v_mfma_f32_16x16x32_bf16 v[128:131], v[48:51], v[32:35], v[128:131]
  ds_read_b64_tr_b16 v[112:113], v6 offset:0
  ds_read_b64_tr_b16 v[114:115], v6 offset:2048
  v_mfma_f32_16x16x32_bf16 v[136:139], v[48:51], v[36:39], v[136:139]
  ds_read_b128 v[96:99], v4 offset:0
  ds_read_b128 v[100:103], v4 offset:2048
  v_mfma_f32_16x16x32_bf16 v[144:147], v[48:51], v[40:43], v[144:147]
  ds_read_b128 v[104:107], v4 offset:4096
  ds_read_b128 v[108:111], v4 offset:6144
  v_mfma_f32_16x16x32_bf16 v[152:155], v[48:51], v[44:47], v[152:155]
  ds_read_b64_tr_b16 v[116:117], v7 offset:0
  ds_read_b64_tr_b16 v[118:119], v7 offset:2048
  v_mfma_f32_16x16x32_bf16 v[132:135], v[52:55], v[32:35], v[132:135]
  ds_read_b64_tr_b16 v[208:209], v6 offset:4096
  ds_read_b64_tr_b16 v[210:211], v6 offset:6144
  v_mfma_f32_16x16x32_bf16 v[140:143], v[52:55], v[36:39], v[140:143]
  ds_read_b128 v[192:195], v5 offset:0
  ds_read_b128 v[196:199], v5 offset:2048
  v_mfma_f32_16x16x32_bf16 v[148:151], v[52:55], v[40:43], v[148:151]
  ds_read_b128 v[200:203], v5 offset:4096
  ds_read_b128 v[204:207], v5 offset:6144
  v_mfma_f32_16x16x32_bf16 v[156:159], v[52:55], v[44:47], v[156:159]
  ds_read_b64_tr_b16 v[212:213], v7 offset:4096
  ds_read_b64_tr_b16 v[214:215], v7 offset:6144
  v_mfma_f32_16x16x32_bf16 v[128:131], v[80:83], v[64:67], v[128:131]
  buffer_load_dwordx4 v[160:163], v11, s[40:43], s8 offen offset:0 sc0 sc1
  v_mfma_f32_16x16x32_bf16 v[136:139], v[80:83], v[68:71], v[136:139]
  buffer_load_dwordx4 v[164:167], v11, s[40:43], s8 offen offset:1024 sc0 sc1
  v_mfma_f32_16x16x32_bf16 v[144:147], v[80:83], v[72:75], v[144:147]
  buffer_load_dwordx4 v[168:171], v11, s[40:43], s8 offen offset:2048 sc0 sc1
  v_mfma_f32_16x16x32_bf16 v[152:155], v[80:83], v[76:79], v[152:155]
  buffer_load_dwordx4 v[172:175], v11, s[40:43], s8 offen offset:3072 sc0 sc1
  v_mfma_f32_16x16x32_bf16 v[132:135], v[84:87], v[64:67], v[132:135]
  v_mfma_f32_16x16x32_bf16 v[140:143], v[84:87], v[68:71], v[140:143]
  v_mfma_f32_16x16x32_bf16 v[148:151], v[84:87], v[72:75], v[148:151]
  s_waitcnt lgkmcnt(0)
  v_mfma_f32_16x16x32_bf16 v[156:159], v[84:87], v[76:79], v[156:159]
  s_barrier
  v_mfma_f32_16x16x32_bf16 v[128:131], v[112:115], v[96:99], v[128:131]
  v_mfma_f32_16x16x32_bf16 v[136:139], v[112:115], v[100:103], v[136:139]
  v_mfma_f32_16x16x32_bf16 v[144:147], v[112:115], v[104:107], v[144:147]
  v_mfma_f32_16x16x32_bf16 v[152:155], v[112:115], v[108:111], v[152:155]
  v_mfma_f32_16x16x32_bf16 v[132:135], v[116:119], v[96:99], v[132:135]
  v_mfma_f32_16x16x32_bf16 v[140:143], v[116:119], v[100:103], v[140:143]
  v_mfma_f32_16x16x32_bf16 v[148:151], v[116:119], v[104:107], v[148:151]
  v_mfma_f32_16x16x32_bf16 v[156:159], v[116:119], v[108:111], v[156:159]
  v_mfma_f32_16x16x32_bf16 v[128:131], v[208:211], v[192:195], v[128:131]
  v_mfma_f32_16x16x32_bf16 v[136:139], v[208:211], v[196:199], v[136:139]
  v_mfma_f32_16x16x32_bf16 v[144:147], v[208:211], v[200:203], v[144:147]
  v_mfma_f32_16x16x32_bf16 v[152:155], v[208:211], v[204:207], v[152:155]
  v_mfma_f32_16x16x32_bf16 v[132:135], v[212:215], v[192:195], v[132:135]
  v_mfma_f32_16x16x32_bf16 v[140:143], v[212:215], v[196:199], v[140:143]
  v_mfma_f32_16x16x32_bf16 v[148:151], v[212:215], v[200:203], v[148:151]
  s_waitcnt lgkmcnt(0)
  v_mfma_f32_16x16x32_bf16 v[156:159], v[212:215], v[204:207], v[156:159]
  s_mov_b32 s4, 0xffff0000
  s_waitcnt vmcnt(3)
  v_lshlrev_b32 v32, 16, v160
  v_and_b32 v33, s4, v160
  v_lshlrev_b32 v34, 16, v161
  v_and_b32 v35, s4, v161
  v_lshlrev_b32 v36, 16, v162
  v_and_b32 v37, s4, v162
  v_lshlrev_b32 v38, 16, v163
  v_and_b32 v39, s4, v163
  v_pk_add_f32 v[128:129], v[128:129], v[32:33]
  v_pk_add_f32 v[130:131], v[130:131], v[34:35]
  v_pk_add_f32 v[132:133], v[132:133], v[36:37]
  v_pk_add_f32 v[134:135], v[134:135], v[38:39]
  s_waitcnt vmcnt(2)
  v_lshlrev_b32 v32, 16, v164
  v_and_b32 v33, s4, v164
  v_lshlrev_b32 v34, 16, v165
  v_and_b32 v35, s4, v165
  v_lshlrev_b32 v36, 16, v166
  v_and_b32 v37, s4, v166
  v_lshlrev_b32 v38, 16, v167
  v_and_b32 v39, s4, v167
  v_pk_add_f32 v[136:137], v[136:137], v[32:33]
  v_pk_add_f32 v[138:139], v[138:139], v[34:35]
  v_pk_add_f32 v[140:141], v[140:141], v[36:37]
  v_pk_add_f32 v[142:143], v[142:143], v[38:39]
  s_waitcnt vmcnt(1)
  v_lshlrev_b32 v32, 16, v168
  v_and_b32 v33, s4, v168
  v_lshlrev_b32 v34, 16, v169
  v_and_b32 v35, s4, v169
  v_lshlrev_b32 v36, 16, v170
  v_and_b32 v37, s4, v170
  v_lshlrev_b32 v38, 16, v171
  v_and_b32 v39, s4, v171
  v_pk_add_f32 v[144:145], v[144:145], v[32:33]
  v_pk_add_f32 v[146:147], v[146:147], v[34:35]
  v_pk_add_f32 v[148:149], v[148:149], v[36:37]
  v_pk_add_f32 v[150:151], v[150:151], v[38:39]
  s_waitcnt vmcnt(0)
  v_lshlrev_b32 v32, 16, v172
  v_and_b32 v33, s4, v172
  v_lshlrev_b32 v34, 16, v173
  v_and_b32 v35, s4, v173
  v_lshlrev_b32 v36, 16, v174
  v_and_b32 v37, s4, v174
  v_lshlrev_b32 v38, 16, v175
  v_and_b32 v39, s4, v175
  v_pk_add_f32 v[152:153], v[152:153], v[32:33]
  v_pk_add_f32 v[154:155], v[154:155], v[34:35]
  v_pk_add_f32 v[156:157], v[156:157], v[36:37]
  v_pk_add_f32 v[158:159], v[158:159], v[38:39]
  v_cvt_pk_bf16_f32 v240, v128, v129
  v_cvt_pk_bf16_f32 v241, v130, v131
  v_cvt_pk_bf16_f32 v242, v132, v133
  v_cvt_pk_bf16_f32 v243, v134, v135
  v_cvt_pk_bf16_f32 v244, v136, v137
  v_cvt_pk_bf16_f32 v245, v138, v139
  v_cvt_pk_bf16_f32 v246, v140, v141
  v_cvt_pk_bf16_f32 v247, v142, v143
  v_cvt_pk_bf16_f32 v248, v144, v145
  v_cvt_pk_bf16_f32 v249, v146, v147
  v_cvt_pk_bf16_f32 v250, v148, v149
  v_cvt_pk_bf16_f32 v251, v150, v151
  v_cvt_pk_bf16_f32 v252, v152, v153
  v_cvt_pk_bf16_f32 v253, v154, v155
  v_cvt_pk_bf16_f32 v254, v156, v157
  v_cvt_pk_bf16_f32 v255, v158, v159
  s_cmp_lg_u32 s82, 0
  s_cbranch_scc1 L_cfinal
  s_lshl_b32 s4, s76, 5
  s_lshl_b32 s5, s78, 1
  s_add_u32 s4, s4, s5
  s_add_u32 s4, s4, s86
  s_lshl_b32 s6, s4, 13
  s_lshl_b32 s7, s85, 12
  s_add_u32 s6, s6, s7
  s_add_u32 s6, s6, s83
  s_add_u32 s6, s6, 32505856
  buffer_store_dwordx4 v[240:243], v11, s[40:43], s6 offen offset:0 sc0 sc1
  buffer_store_dwordx4 v[244:247], v11, s[40:43], s6 offen offset:1024 sc0 sc1
  buffer_store_dwordx4 v[248:251], v11, s[40:43], s6 offen offset:2048 sc0 sc1
  buffer_store_dwordx4 v[252:255], v11, s[40:43], s6 offen offset:3072 sc0 sc1
  v_mov_b32 v40, 0x3f803f80
  v_dot2_f32_bf16 v32, v240, v40, 0
  v_dot2_f32_bf16 v36, v240, v240, 0
  v_dot2_f32_bf16 v33, v244, v40, 0
  v_dot2_f32_bf16 v37, v244, v244, 0
  v_dot2_f32_bf16 v34, v248, v40, 0
  v_dot2_f32_bf16 v38, v248, v248, 0
  v_dot2_f32_bf16 v35, v252, v40, 0
  v_dot2_f32_bf16 v39, v252, v252, 0
  v_dot2_f32_bf16 v32, v241, v40, v32
  v_dot2_f32_bf16 v36, v241, v241, v36
  v_dot2_f32_bf16 v33, v245, v40, v33
  v_dot2_f32_bf16 v37, v245, v245, v37
  v_dot2_f32_bf16 v34, v249, v40, v34
  v_dot2_f32_bf16 v38, v249, v249, v38
  v_dot2_f32_bf16 v35, v253, v40, v35
  v_dot2_f32_bf16 v39, v253, v253, v39
  v_dot2_f32_bf16 v32, v242, v40, v32
  v_dot2_f32_bf16 v36, v242, v242, v36
  v_dot2_f32_bf16 v33, v246, v40, v33
  v_dot2_f32_bf16 v37, v246, v246, v37
  v_dot2_f32_bf16 v34, v250, v40, v34
  v_dot2_f32_bf16 v38, v250, v250, v38
  v_dot2_f32_bf16 v35, v254, v40, v35
  v_dot2_f32_bf16 v39, v254, v254, v39
  v_dot2_f32_bf16 v32, v243, v40, v32
  v_dot2_f32_bf16 v36, v243, v243, v36
  v_dot2_f32_bf16 v33, v247, v40, v33
  v_dot2_f32_bf16 v37, v247, v247, v37
  v_dot2_f32_bf16 v34, v251, v40, v34
  v_dot2_f32_bf16 v38, v251, v251, v38
  v_dot2_f32_bf16 v35, v255, v40, v35
  v_dot2_f32_bf16 v39, v255, v255, v39
  s_lshl_b32 s6, s76, 9
  s_lshl_b32 s7, s85, 8
  s_add_u32 s6, s6, s7
  s_add_u32 s6, s6, s5
  s_add_u32 s6, s6, s86
  s_lshl_b32 s6, s6, 6
  s_add_u32 s6, s6, s83
  s_add_u32 s6, s6, 36700160
  v_permlane32_swap_b32 v32, v34
  v_permlane32_swap_b32 v33, v35
  v_permlane32_swap_b32 v36, v38
  v_permlane32_swap_b32 v37, v39
  v_add_f32 v32, v32, v34
  v_add_f32 v33, v33, v35
  v_add_f32 v36, v36, v38
  v_add_f32 v37, v37, v39
  v_permlane16_swap_b32 v32, v33
  s_nop 0
  v_permlane16_swap_b32 v36, v37
  v_add_f32 v42, v32, v33
  v_add_f32 v43, v36, v37
  buffer_store_dwordx2 v[42:43], v30, s[40:43], s6 offen sc0 sc1
  s_add_u32 s5, s87, 16
  s_sub_u32 s4, s78, s77
  s_lshl_b32 s4, s4, 7
  s_add_u32 s5, s5, s4
  s_waitcnt vmcnt(0)
  s_mov_b64 exec, 1
  ds_add_rtn_u32 v2, v28, v27 offset:0
  s_waitcnt lgkmcnt(0)
  v_readfirstlane_b32 s4, v2
  s_and_b32 s4, s4, 3
  s_cmp_lg_u32 s4, 3
  s_cbranch_scc1 Ls_15
  s_mov_b32 exec_lo, 0xffffffff
  buffer_store_dword v27, v24, s[40:43], s5 offen sc0 sc1
Ls_15:
  s_mov_b64 exec, -1
  s_mov_b32 s82, 1
  s_add_u32 s83, s83, 0
  s_add_u32 s87, s87, 32
  s_branch L_clayer
L_cfinal:
  s_nop 1
  v_permlane16_swap_b32 v240, v242
  v_permlane16_swap_b32 v241, v243
  v_permlane16_swap_b32 v244, v246
  v_permlane16_swap_b32 v245, v247
  v_permlane16_swap_b32 v248, v250
  v_permlane16_swap_b32 v249, v251
  v_permlane16_swap_b32 v252, v254
  v_permlane16_swap_b32 v253, v255
  v_and_b32 v2, 15, v1
  v_lshlrev_b32 v3, 12, v2
  v_and_b32 v2, 16, v1
  v_lshl_add_u32 v3, v2, 1, v3
  v_and_b32 v2, 32, v1
  v_lshrrev_b32 v2, 1, v2
  v_add_u32 v3, v2, v3
  s_lshl_b32 s5, s76, 18
  s_lshl_b32 s4, s85, 11
  s_add_u32 s5, s5, s4
  s_lshl_b32 s4, s78, 7
  s_add_u32 s5, s5, s4
  s_lshl_b32 s4, s86, 6
  s_add_u32 s5, s5, s4
  buffer_store_dwordx4 v[240:243], v3, s[64:67], s5 offen
  s_add_u32 s5, s5, 0x10000
  buffer_store_dwordx4 v[244:247], v3, s[64:67], s5 offen
  s_add_u32 s5, s5, 0x10000
  buffer_store_dwordx4 v[248:251], v3, s[64:67], s5 offen
  s_add_u32 s5, s5, 0x10000
  buffer_store_dwordx4 v[252:255], v3, s[64:67], s5 offen
  s_endpgm
L_w1:
  s_and_b32 s80, s77, 7
  s_lshr_b32 s79, s77, 3
  s_lshl_b32 s78, s80, 1
  s_add_u32 s78, s78, s79
  s_lshl_b32 s5, s76, 4
  s_add_u32 s5, s5, s77
  s_lshl_b32 s84, s5, 11
  s_mov_b32 s83, 3145728
  s_mov_b32 s87, 1835016
  s_lshr_b32 s86, s81, 1
  s_mov_b32 s40, s38
  s_and_b32 s41, s39, 0xffff
  s_mov_b32 s42, 100663296
  s_mov_b32 s43, 0x00020000
  s_mov_b32 s52, s20
  s_and_b32 s53, s21, 0xffff
  s_mov_b32 s54, 2097152
  s_mov_b32 s55, 0x00020000
  s_mov_b32 s56, s24
  s_and_b32 s57, s25, 0xffff
  s_mov_b32 s58, 7340032
  s_mov_b32 s59, 0x00020000
  s_mov_b32 s60, s28
  s_and_b32 s61, s29, 0xffff
  s_mov_b32 s62, 7340032
  s_mov_b32 s63, 0x00020000
  v_lshrrev_b32 v2, 3, v1
  s_movk_i32 s4, 2048
  v_mad_u32_u24 v4, v2, s4, v10
  v_add_u32 v5, 15360, v4
  v_add_u32 v6, 30720, v4
  v_add_u32 v7, 46080, v4
  s_lshl_b32 s5, s78, 7
  s_mul_i32 s4, s85, 65536
  s_add_u32 s5, s5, s4
  s_mov_b32 s8, 131072
  s_mov_b32 s10, 2097152
  s_add_u32 s9, s5, s10
  s_mul_i32 s6, s76, s8
  s_add_u32 s7, s5, s6
  s_lshl_b32 s11, s85, 12
  s_add_u32 s11, s11, 65536
  s_add_u32 s15, s11, 81920
  s_add_u32 s11, s11, 32768
  s_mov_b32 s12, 0
  s_mov_b32 m0, s11
  s_waitcnt vmcnt(12)
  s_barrier
  s_branch Ll_26
Lt_32:
  s_cmp_lg_u32 s12, 2
  s_cbranch_scc1 Lt_30
  s_waitcnt vmcnt(8)
  s_barrier
  s_branch Ll_26
Lt_30:
  s_cmp_lg_u32 s12, 6
  s_cbranch_scc1 Ll_26
  s_barrier
Ll_26:
  buffer_load_dwordx4 v4, s[52:55], s7 offen offset:0 lds
  s_mov_b32 s5, s7
  buffer_load_dwordx4 v5, s[52:55], s5 offen offset:1024 lds
  s_add_u32 s7, s7, s8
  s_cmp_eq_u32 s7, s9
  s_cselect_b32 s4, s10, 0
  s_sub_u32 s7, s7, s4
  s_add_u32 s11, s11, 8192
  buffer_load_dwordx4 v6, s[52:55], s5 offen offset:2048 lds
  s_cmp_eq_u32 s11, s15
  s_cselect_b32 s4, 81920, 0
  s_sub_u32 s11, s11, s4
  s_add_u32 s12, s12, 1
  s_cmp_lg_u32 s12, 10
  buffer_load_dwordx4 v7, s[52:55], s5 offen offset:3072 lds
  s_mov_b32 m0, s11
  s_cbranch_scc1 Lt_32
Lt_33:
  s_waitcnt vmcnt(36)
  s_barrier
  s_waitcnt vmcnt(32)
  s_barrier
  buffer_load_dwordx4 v4, s[52:55], s7 offen offset:0 lds
Ll_34:
  s_mov_b32 s5, s7
  buffer_load_dwordx4 v5, s[52:55], s5 offen offset:1024 lds
  s_add_u32 s7, s7, s8
  s_cmp_eq_u32 s7, s9
  s_cselect_b32 s4, s10, 0
  s_sub_u32 s7, s7, s4
  s_add_u32 s11, s11, 8192
  buffer_load_dwordx4 v6, s[52:55], s5 offen offset:2048 lds
  s_cmp_eq_u32 s11, s15
  s_cselect_b32 s4, 81920, 0
  s_sub_u32 s11, s11, s4
  s_add_u32 s12, s12, 1
  s_cmp_eq_u32 s12, 16
  buffer_load_dwordx4 v7, s[52:55], s5 offen offset:3072 lds
  s_mov_b32 m0, s11
  s_cbranch_scc1 Ll_35
  s_waitcnt vmcnt(32)
  s_barrier
  buffer_load_dwordx4 v4, s[52:55], s7 offen offset:0 lds
  s_branch Ll_34
Ll_35:
  v_lshrrev_b32 v2, 3, v1
  s_movk_i32 s4, 7168
  v_mad_u32_u24 v4, v2, s4, v10
  v_add_u32 v5, 56320, v4
  v_add_u32 v6, 112640, v4
  v_add_u32 v7, 168960, v4
  v_lshrrev_b32 v2, 2, v1
  s_movk_i32 s4, 7168
  v_mul_u32_u24 v2, s4, v2
  v_bfe_u32 v3, v10, 5, 1
  v_lshl_add_u32 v2, v3, 4, v2
  v_and_b32 v3, 1, v1
  v_lshlrev_b32 v3, 5, v3
  v_add_u32 v8, v2, v3
  v_add_u32 v9, 113664, v8
  s_mul_i32 s5, s77, 448
  s_and_b32 s4, s77, 1
  s_mul_i32 s94, s4, 448
  s_sub_u32 s94, 384, s94
  s_lshl_b32 s4, s4, 6
  s_add_u32 s5, s5, s4
  s_mul_i32 s4, s85, 229376
  s_add_u32 s5, s5, s4
  v_add_u32 v12, s76, v1
  v_and_b32 v12, 15, v12
  v_mov_b32 v2, s76
  v_cmp_eq_u32 vcc, s78, v12
  s_nop 1
  v_cndmask_b32 v12, v12, v2, vcc
  v_writelane_b32 v12, s78, 0
  s_mov_b32 s4, 458752
  v_mul_u32_u24 v12, s4, v12
  v_add_u32 v12, s5, v12
  s_nop 0
  v_readfirstlane_b32 s7, v12
  s_lshl_b32 s11, s85, 12
  s_add_u32 s11, s11, 65536
  s_add_u32 s15, s11, 86016
  s_lshl_b32 s4, s85, 11
  s_sub_u32 s13, 24576, s4
  s_mov_b32 s12, 0
  s_mov_b32 m0, s11
  s_waitcnt vmcnt(32)
  s_barrier
  s_waitcnt vmcnt(28)
  s_barrier
  s_waitcnt vmcnt(24)
  s_barrier
  s_waitcnt vmcnt(20)
  s_barrier
  s_waitcnt vmcnt(16)
  s_barrier
  s_waitcnt vmcnt(12)
  s_barrier
  s_branch Ll_36
Lt_42:
  s_cmp_lg_u32 s12, 1
  s_cbranch_scc1 Lt_40
  s_waitcnt vmcnt(22)
  s_barrier
  s_waitcnt vmcnt(18)
  s_barrier
  s_branch Ll_36
Lt_40:
  s_cmp_lg_u32 s12, 2
  s_cbranch_scc1 Ll_36
  s_waitcnt vmcnt(28)
  s_barrier
  s_barrier
Ll_36:
  buffer_load_dwordx4 v4, s[56:59], s7 offen offset:0 lds
  buffer_load_dwordx4 v5, s[56:59], s7 offen offset:1024 lds
  buffer_load_dwordx4 v6, s[56:59], s7 offen offset:2048 lds
  buffer_load_dwordx4 v7, s[56:59], s7 offen offset:3072 lds
  s_add_u32 m0, s11, s13
  s_add_u32 s5, s7, s94
  buffer_load_dwordx4 v8, s[56:59], s5 offen offset:0 lds
  buffer_load_dwordx4 v9, s[56:59], s5 offen offset:1024 lds
  s_add_u32 m0, s11, 8192
  s_add_u32 s5, s7, 128
  buffer_load_dwordx4 v4, s[56:59], s5 offen offset:0 lds
  buffer_load_dwordx4 v5, s[56:59], s5 offen offset:1024 lds
  buffer_load_dwordx4 v6, s[56:59], s5 offen offset:2048 lds
  buffer_load_dwordx4 v7, s[56:59], s5 offen offset:3072 lds
  s_add_u32 m0, s11, 16384
  s_add_u32 s5, s7, 256
  buffer_load_dwordx4 v4, s[56:59], s5 offen offset:0 lds
  s_add_u32 s12, s12, 1
  v_readlane_b32 s7, v12, s12
  s_add_u32 s11, s11, 28672
  buffer_load_dwordx4 v5, s[56:59], s5 offen offset:1024 lds
  s_cmp_eq_u32 s11, s15
  s_cselect_b32 s4, 86016, 0
  s_sub_u32 s11, s11, s4
  buffer_load_dwordx4 v6, s[56:59], s5 offen offset:2048 lds
  s_cmp_lg_u32 s12, 3
  buffer_load_dwordx4 v7, s[56:59], s5 offen offset:3072 lds
  s_mov_b32 m0, s11
  s_cbranch_scc1 Lt_42
Lt_43:
  s_waitcnt vmcnt(28)
  s_barrier
  s_waitcnt vmcnt(14)
  s_barrier
  buffer_load_dwordx4 v4, s[56:59], s7 offen offset:0 lds
  buffer_load_dwordx4 v5, s[56:59], s7 offen offset:1024 lds
  buffer_load_dwordx4 v6, s[56:59], s7 offen offset:2048 lds
  buffer_load_dwordx4 v7, s[56:59], s7 offen offset:3072 lds
Ll_44:
  s_add_u32 m0, s11, s13
  s_add_u32 s5, s7, s94
  buffer_load_dwordx4 v8, s[56:59], s5 offen offset:0 lds
  buffer_load_dwordx4 v9, s[56:59], s5 offen offset:1024 lds
  s_add_u32 m0, s11, 8192
  s_add_u32 s5, s7, 128
  buffer_load_dwordx4 v4, s[56:59], s5 offen offset:0 lds
  buffer_load_dwordx4 v5, s[56:59], s5 offen offset:1024 lds
  buffer_load_dwordx4 v6, s[56:59], s5 offen offset:2048 lds
  buffer_load_dwordx4 v7, s[56:59], s5 offen offset:3072 lds
  s_add_u32 m0, s11, 16384
  s_add_u32 s5, s7, 256
  buffer_load_dwordx4 v4, s[56:59], s5 offen offset:0 lds
  s_add_u32 s12, s12, 1
  v_readlane_b32 s7, v12, s12
  s_add_u32 s11, s11, 28672
  buffer_load_dwordx4 v5, s[56:59], s5 offen offset:1024 lds
  s_cmp_eq_u32 s11, s15
  s_cselect_b32 s4, 86016, 0
  s_sub_u32 s11, s11, s4
  buffer_load_dwordx4 v6, s[56:59], s5 offen offset:2048 lds
  s_cmp_eq_u32 s12, 16
  buffer_load_dwordx4 v7, s[56:59], s5 offen offset:3072 lds
  s_mov_b32 m0, s11
  s_cbranch_scc1 Ll_45
  s_waitcnt vmcnt(14)
  s_barrier
  buffer_load_dwordx4 v4, s[56:59], s7 offen offset:0 lds
  buffer_load_dwordx4 v5, s[56:59], s7 offen offset:1024 lds
  buffer_load_dwordx4 v6, s[56:59], s7 offen offset:2048 lds
  buffer_load_dwordx4 v7, s[56:59], s7 offen offset:3072 lds
  s_branch Ll_44
Ll_45:
  v_lshrrev_b32 v2, 3, v1
  s_movk_i32 s4, 2048
  v_mad_u32_u24 v4, v2, s4, v10
  v_add_u32 v5, 15360, v4
  v_add_u32 v6, 30720, v4
  v_add_u32 v7, 46080, v4
  s_lshl_b32 s5, s78, 7
  s_mul_i32 s4, s79, 3670016
  s_add_u32 s5, s5, s4
  s_lshl_b32 s94, s79, 8
  s_sub_u32 s94, 128, s94
  v_subrev_u32 v2, 4, v1
  v_cmp_le_u32 vcc, 28, v1
  s_nop 1
  v_cndmask_b32 v13, v1, v2, vcc
  v_subrev_u32 v3, 3, v13
  v_mov_b32 v12, 4
  v_cmp_le_u32 vcc, 14, v13
  v_subrev_u32 v2, 14, v13
  s_nop 0
  v_cndmask_b32 v3, v3, v2, vcc
  v_cndmask_b32_e64 v12, v12, 12, vcc
  v_cmp_le_u32 vcc, 21, v13
  v_subrev_u32 v2, 21, v13
  s_nop 0
  v_cndmask_b32 v3, v3, v2, vcc
  v_cndmask_b32_e64 v12, v12, 20, vcc
  s_sub_u32 s4, s80, s76
  s_and_b32 s4, s4, 7
  v_cmp_le_u32 vcc, s4, v3
  v_mov_b32 v2, s76
  s_nop 0
  v_addc_co_u32 v3, vcc, v3, v2, vcc
  v_and_b32 v3, 7, v3
  v_add_u32 v12, v12, v3
  v_add_u32 v2, v2, v1
  v_and_b32 v2, 3, v2
  v_subrev_u32 v3, 10, v1
  v_cmp_gt_u32 vcc, 4, v3
  s_nop 1
  v_cndmask_b32 v12, v12, v2, vcc
  s_add_u32 s4, s80, 4
  v_lshl_add_u32 v2, v1, 3, s4
  v_cmp_gt_u32 vcc, 3, v1
  s_nop 1
  v_cndmask_b32 v12, v12, v2, vcc
  v_subrev_u32 v2, 4, v12
  v_and_b32 v3, 7, v2
  v_lshrrev_b32 v2, 3, v2
  v_mad_u32_u24 v2, v3, 7, v2
  v_and_b32 v3, 1, v3
  v_add_u32 v2, v2, v3
  s_mul_i32 s4, s85, 3
  v_add_u32 v2, s4, v2
  s_add_u32 s4, s85, 6
  v_mad_u32_u24 v3, v12, 14, s4
  v_cmp_gt_u32 vcc, 4, v12
  s_nop 1
  v_cndmask_b32 v2, v2, v3, vcc
  v_lshl_add_u32 v12, v2, 16, s5
  s_mul_i32 s4, s79, 7340032
  s_sub_u32 s4, 3670016, s4
  v_add_u32 v2, s4, v12
  v_cmp_le_u32 vcc, 28, v1
  s_nop 1
  v_cndmask_b32 v12, v12, v2, vcc
  s_lshl_b32 s11, s85, 12
  s_add_u32 s11, s11, 65536
  s_add_u32 s15, s11, 81920
  s_add_u32 s11, s11, 32768
  v_readfirstlane_b32 s7, v12
  s_mov_b32 s12, 0
  s_mov_b32 m0, s11
  s_waitcnt vmcnt(14)
  s_barrier
  s_branch Ll_46
Lt_52:
  s_cmp_lg_u32 s12, 1
  s_cbranch_scc1 Lt_50
  s_waitcnt vmcnt(8)
  s_barrier
  s_branch Ll_46
Lt_50:
  s_cmp_lg_u32 s12, 3
  s_cbranch_scc1 Ll_46
  s_barrier
Ll_46:
  buffer_load_dwordx4 v4, s[60:63], s7 offen offset:0 lds
  buffer_load_dwordx4 v5, s[60:63], s7 offen offset:1024 lds
  buffer_load_dwordx4 v6, s[60:63], s7 offen offset:2048 lds
  buffer_load_dwordx4 v7, s[60:63], s7 offen offset:3072 lds
  s_add_u32 m0, s11, 8192
  s_add_u32 s5, s7, s94
  buffer_load_dwordx4 v4, s[60:63], s5 offen offset:0 lds
  s_add_u32 s12, s12, 1
  v_readlane_b32 s7, v12, s12
  s_add_u32 s11, s11, 16384
  buffer_load_dwordx4 v5, s[60:63], s5 offen offset:1024 lds
  s_cmp_eq_u32 s11, s15
  s_cselect_b32 s4, 81920, 0
  s_sub_u32 s11, s11, s4
  buffer_load_dwordx4 v6, s[60:63], s5 offen offset:2048 lds
  s_cmp_lg_u32 s12, 5
  buffer_load_dwordx4 v7, s[60:63], s5 offen offset:3072 lds
  s_mov_b32 m0, s11
  s_cbranch_scc1 Lt_52
Lt_53:
  s_waitcnt vmcnt(32)
  s_barrier
  s_waitcnt vmcnt(24)
  s_barrier
  buffer_load_dwordx4 v4, s[60:63], s7 offen offset:0 lds
  buffer_load_dwordx4 v5, s[60:63], s7 offen offset:1024 lds
  buffer_load_dwordx4 v6, s[60:63], s7 offen offset:2048 lds
  buffer_load_dwordx4 v7, s[60:63], s7 offen offset:3072 lds
Ll_54:
  s_add_u32 m0, s11, 8192
  s_add_u32 s5, s7, s94
  buffer_load_dwordx4 v4, s[60:63], s5 offen offset:0 lds
  s_add_u32 s12, s12, 1
  v_readlane_b32 s7, v12, s12
  s_add_u32 s11, s11, 16384
  buffer_load_dwordx4 v5, s[60:63], s5 offen offset:1024 lds
  s_cmp_eq_u32 s11, s15
  s_cselect_b32 s4, 81920, 0
  s_sub_u32 s11, s11, s4
  buffer_load_dwordx4 v6, s[60:63], s5 offen offset:2048 lds
  s_cmp_eq_u32 s12, 24
  buffer_load_dwordx4 v7, s[60:63], s5 offen offset:3072 lds
  s_mov_b32 m0, s11
  s_cbranch_scc1 Ll_55
  s_waitcnt vmcnt(24)
  s_barrier
  buffer_load_dwordx4 v4, s[60:63], s7 offen offset:0 lds
  buffer_load_dwordx4 v5, s[60:63], s7 offen offset:1024 lds
  buffer_load_dwordx4 v6, s[60:63], s7 offen offset:2048 lds
  buffer_load_dwordx4 v7, s[60:63], s7 offen offset:3072 lds
  s_branch Ll_54
Ll_55:
  s_waitcnt vmcnt(24)
  s_barrier
  buffer_load_dwordx4 v4, s[60:63], s7 offen offset:0 lds
Ll_56:
  s_mov_b32 s5, s7
  buffer_load_dwordx4 v5, s[60:63], s5 offen offset:1024 lds
  s_add_u32 s12, s12, 1
  v_readlane_b32 s7, v12, s12
  s_add_u32 s11, s11, 16384
  s_cmp_eq_u32 s11, s15
  buffer_load_dwordx4 v6, s[60:63], s5 offen offset:2048 lds
  s_cselect_b32 s4, 81920, 0
  s_sub_u32 s11, s11, s4
  s_cmp_eq_u32 s12, 32
  buffer_load_dwordx4 v7, s[60:63], s5 offen offset:3072 lds
  s_mov_b32 m0, s11
  s_cbranch_scc1 Ll_57
  s_waitcnt vmcnt(12)
  s_barrier
  buffer_load_dwordx4 v4, s[60:63], s7 offen offset:0 lds
  s_branch Ll_56
Ll_57:
  v_lshrrev_b32 v2, 3, v1
  s_movk_i32 s4, 6144
  v_mad_u32_u24 v4, v2, s4, v10
  v_add_u32 v5, 48128, v4
  v_add_u32 v6, 96256, v4
  v_add_u32 v7, 144384, v4
  s_cmp_eq_u32 s82, 0
  s_mov_b32 s82, 1
  s_cbranch_scc1 L_wlayer
  s_waitcnt vmcnt(12)
  s_barrier
  s_waitcnt vmcnt(8)
  s_barrier
  s_waitcnt vmcnt(4)
  s_barrier
  s_waitcnt vmcnt(0)
  s_barrier
  s_barrier
  s_branch L_lend
L_x1:
  s_cmp_lg_u32 s82, 0
  s_cbranch_scc1 L_64
  s_and_b32 s80, s77, 7
  s_lshr_b32 s79, s77, 3
  s_lshl_b32 s78, s80, 1
  s_add_u32 s78, s78, s79
  s_lshl_b32 s5, s76, 4
  s_add_u32 s5, s5, s77
  s_lshl_b32 s84, s5, 11
  s_mov_b32 s83, 3145728
  s_mov_b32 s87, 1835016
  s_lshr_b32 s86, s81, 1
  v_lshlrev_b32 v2, 4, v1
  v_add_u32 v4, 4096, v2
  v_add_u32 v5, 11264, v2
  v_add_u32 v6, 3072, v2
  v_add_u32 v7, 10240, v2
  s_movk_i32 s13, 2048
  s_movk_i32 s95, 4096
  v_and_b32 v2, 31, v1
  v_lshlrev_b32 v8, 7, v2
L_64:
  s_mov_b32 s40, s38
  s_and_b32 s41, s39, 0xffff
  s_mov_b32 s42, 100663296
  s_mov_b32 s43, 0x00020000
  s_mov_b32 s11, 0
  s_mov_b32 s15, 65536
  s_mul_i32 s5, s76, 32
  s_lshl_b32 s5, s5, 13
  s_add_u32 s5, s5, s83
  s_add_u32 s5, s5, 0xfffff000
  s_mov_b32 s8, 16384
  s_mov_b32 s10, 262144
  s_add_u32 s9, s5, s10
  s_mul_i32 s6, s76, s8
  s_add_u32 s7, s5, s6
  s_lshr_b32 s6, s6, 14
  s_lshl_b32 s90, 0x7f, s6
  s_lshr_b32 s4, s90, 16
  s_or_b32 s90, s90, s4
  s_and_b32 s90, s90, 0xffff
  s_lshl_b32 s91, s84, 1
  s_add_u32 s91, s91, s87
  s_mov_b32 s89, 200000
  s_mov_b32 exec_lo, s90
  s_mov_b32 exec_hi, 0
  buffer_load_dword v12, v8, s[40:43], s91 offen sc0 sc1
Lp_65:
  s_waitcnt vmcnt(0)
  v_cmp_ne_u32 vcc, 0, v12
  s_andn2_b32 s3, exec_lo, vcc_lo
  s_cbranch_scc0 Lp_66
  s_mov_b32 exec_lo, s3
  s_sleep 1
  buffer_load_dword v12, v8, s[40:43], s91 offen sc0 sc1
  s_sub_u32 s89, s89, 1
  s_cbranch_scc0 Lp_65
Lp_66:
  s_mov_b64 exec, -1
  s_mov_b32 s12, 0
  s_mov_b32 m0, s11
Ll_67:
  s_nop 0
  buffer_load_dwordx4 v4, s[40:43], s7 offen offset:0 sc1 lds
  buffer_load_dwordx4 v5, s[40:43], s7 offen offset:1024 sc1 lds
  buffer_load_dwordx4 v6, s[40:43], s7 offen offset:2048 sc1 lds
  buffer_load_dwordx4 v7, s[40:43], s7 offen offset:3072 sc1 lds
  s_add_u32 m0, s11, 4096
  s_add_u32 s5, s7, s13
  buffer_load_dwordx4 v4, s[40:43], s5 offen offset:0 sc1 lds
  buffer_load_dwordx4 v5, s[40:43], s5 offen offset:1024 sc1 lds
  buffer_load_dwordx4 v6, s[40:43], s5 offen offset:2048 sc1 lds
  buffer_load_dwordx4 v7, s[40:43], s5 offen offset:3072 sc1 lds
  s_add_u32 m0, s11, 8192
  s_add_u32 s3, s7, s95
  buffer_load_dwordx4 v4, s[40:43], s3 offen offset:0 sc1 lds
  buffer_load_dwordx4 v5, s[40:43], s3 offen offset:1024 sc1 lds
  buffer_load_dwordx4 v6, s[40:43], s3 offen offset:2048 sc1 lds
  buffer_load_dwordx4 v7, s[40:43], s3 offen offset:3072 sc1 lds
  s_add_u32 m0, s11, 12288
  s_add_u32 s5, s3, s13
  buffer_load_dwordx4 v4, s[40:43], s5 offen offset:0 sc1 lds
  s_add_u32 s7, s7, s8
  s_cmp_eq_u32 s7, s9
  s_cselect_b32 s4, s10, 0
  s_sub_u32 s7, s7, s4
  buffer_load_dwordx4 v5, s[40:43], s5 offen offset:1024 sc1 lds
  s_add_u32 s11, s11, 16384
  s_cmp_eq_u32 s11, s15
  s_cselect_b32 s4, 65536, 0
  s_sub_u32 s11, s11, s4
  buffer_load_dwordx4 v6, s[40:43], s5 offen offset:2048 sc1 lds
  s_add_u32 s12, s12, 1
  s_cmp_lg_u32 s12, 3
  buffer_load_dwordx4 v7, s[40:43], s5 offen offset:3072 sc1 lds
  s_mov_b32 m0, s11
  s_cbranch_scc1 Ll_68
  s_waitcnt vmcnt(32)
  s_barrier
Ll_68:
  s_cmp_lt_u32 s12, 4
  s_cbranch_scc1 Ll_67
  s_waitcnt vmcnt(32)
  s_barrier
  buffer_load_dwordx4 v4, s[40:43], s7 offen offset:0 sc1 lds
  buffer_load_dwordx4 v5, s[40:43], s7 offen offset:1024 sc1 lds
  buffer_load_dwordx4 v6, s[40:43], s7 offen offset:2048 sc1 lds
  buffer_load_dwordx4 v7, s[40:43], s7 offen offset:3072 sc1 lds
Ll_71:
  s_add_u32 m0, s11, 4096
  s_add_u32 s5, s7, s13
  buffer_load_dwordx4 v4, s[40:43], s5 offen offset:0 sc1 lds
  buffer_load_dwordx4 v5, s[40:43], s5 offen offset:1024 sc1 lds
  buffer_load_dwordx4 v6, s[40:43], s5 offen offset:2048 sc1 lds
  buffer_load_dwordx4 v7, s[40:43], s5 offen offset:3072 sc1 lds
  s_add_u32 m0, s11, 8192
  s_add_u32 s3, s7, s95
  buffer_load_dwordx4 v4, s[40:43], s3 offen offset:0 sc1 lds
  buffer_load_dwordx4 v5, s[40:43], s3 offen offset:1024 sc1 lds
  buffer_load_dwordx4 v6, s[40:43], s3 offen offset:2048 sc1 lds
  buffer_load_dwordx4 v7, s[40:43], s3 offen offset:3072 sc1 lds
  s_add_u32 m0, s11, 12288
  s_add_u32 s5, s3, s13
  buffer_load_dwordx4 v4, s[40:43], s5 offen offset:0 sc1 lds
  s_add_u32 s7, s7, s8
  s_cmp_eq_u32 s7, s9
  s_cselect_b32 s4, s10, 0
  s_sub_u32 s7, s7, s4
  buffer_load_dwordx4 v5, s[40:43], s5 offen offset:1024 sc1 lds
  s_add_u32 s11, s11, 16384
  s_cmp_eq_u32 s11, s15
  s_cselect_b32 s4, 65536, 0
  s_sub_u32 s11, s11, s4
  buffer_load_dwordx4 v6, s[40:43], s5 offen offset:2048 sc1 lds
  s_add_u32 s12, s12, 1
  s_cmp_eq_u32 s12, 16
  buffer_load_dwordx4 v7, s[40:43], s5 offen offset:3072 sc1 lds
  s_mov_b32 m0, s11
  s_cbranch_scc1 Ll_72
  s_waitcnt vmcnt(32)
  s_barrier
  buffer_load_dwordx4 v4, s[40:43], s7 offen offset:0 sc1 lds
  buffer_load_dwordx4 v5, s[40:43], s7 offen offset:1024 sc1 lds
  buffer_load_dwordx4 v6, s[40:43], s7 offen offset:2048 sc1 lds
  buffer_load_dwordx4 v7, s[40:43], s7 offen offset:3072 sc1 lds
  s_branch Ll_71
Ll_72:
  s_waitcnt vmcnt(32)
  s_barrier
  s_waitcnt vmcnt(16)
  s_barrier
  s_waitcnt vmcnt(0)
  s_barrier
  s_barrier
  s_mov_b32 s11, 0
  s_mov_b32 s15, 65536
  s_mul_i32 s5, s76, 32
  s_lshl_b32 s5, s5, 13
  s_add_u32 s5, s5, s83
  s_add_u32 s5, s5, 0x3ff000
  v_add_u32 v9, s76, v1
  v_and_b32 v9, 15, v9
  v_mov_b32 v2, s76
  v_cmp_eq_u32 vcc, s78, v9
  s_nop 1
  v_cndmask_b32 v9, v9, v2, vcc
  v_writelane_b32 v9, s78, 0
  v_lshl_add_u32 v9, v9, 14, s5
  s_lshl_b32 s6, s76, 14
  v_readlane_b32 s7, v9, 1
  s_mov_b32 s11, 16384
  s_lshr_b32 s6, s6, 14
  s_lshl_b32 s90, 0x3f, s6
  s_lshr_b32 s4, s90, 16
  s_or_b32 s90, s90, s4
  s_and_b32 s90, s90, 0xffff
  s_add_u32 s91, s91, 4
  s_bitset0_b32 s90, s78
  s_barrier
  s_mov_b32 s89, 200000
  s_mov_b32 exec_lo, s90
  s_mov_b32 exec_hi, 0
  buffer_load_dword v12, v8, s[40:43], s91 offen sc0 sc1
Lp_73:
  s_waitcnt vmcnt(0)
  v_cmp_ne_u32 vcc, 0, v12
  s_andn2_b32 s3, exec_lo, vcc_lo
  s_cbranch_scc0 Lp_74
  s_mov_b32 exec_lo, s3
  s_sleep 1
  buffer_load_dword v12, v8, s[40:43], s91 offen sc0 sc1
  s_sub_u32 s89, s89, 1
  s_cbranch_scc0 Lp_73
Lp_74:
  s_mov_b64 exec, -1
  s_mov_b32 s12, 1
  s_mov_b32 m0, s11
Ll_75:
  s_nop 0
  buffer_load_dwordx4 v4, s[40:43], s7 offen offset:0 sc1 lds
  buffer_load_dwordx4 v5, s[40:43], s7 offen offset:1024 sc1 lds
  buffer_load_dwordx4 v6, s[40:43], s7 offen offset:2048 sc1 lds
  buffer_load_dwordx4 v7, s[40:43], s7 offen offset:3072 sc1 lds
  s_add_u32 m0, s11, 4096
  s_add_u32 s5, s7, s13
  buffer_load_dwordx4 v4, s[40:43], s5 offen offset:0 sc1 lds
  buffer_load_dwordx4 v5, s[40:43], s5 offen offset:1024 sc1 lds
  buffer_load_dwordx4 v6, s[40:43], s5 offen offset:2048 sc1 lds
  buffer_load_dwordx4 v7, s[40:43], s5 offen offset:3072 sc1 lds
  s_add_u32 m0, s11, 8192
  s_add_u32 s3, s7, s95
  buffer_load_dwordx4 v4, s[40:43], s3 offen offset:0 sc1 lds
  buffer_load_dwordx4 v5, s[40:43], s3 offen offset:1024 sc1 lds
  buffer_load_dwordx4 v6, s[40:43], s3 offen offset:2048 sc1 lds
  buffer_load_dwordx4 v7, s[40:43], s3 offen offset:3072 sc1 lds
  s_add_u32 m0, s11, 12288
  s_add_u32 s5, s3, s13
  buffer_load_dwordx4 v4, s[40:43], s5 offen offset:0 sc1 lds
  s_add_u32 s12, s12, 1
  v_readlane_b32 s7, v9, s12
  s_add_u32 s11, s11, 16384
  buffer_load_dwordx4 v5, s[40:43], s5 offen offset:1024 sc1 lds
  s_cmp_eq_u32 s11, s15
  s_cselect_b32 s4, 65536, 0
  s_sub_u32 s11, s11, s4
  buffer_load_dwordx4 v6, s[40:43], s5 offen offset:2048 sc1 lds
  s_cmp_lg_u32 s12, 4
  buffer_load_dwordx4 v7, s[40:43], s5 offen offset:3072 sc1 lds
  s_mov_b32 m0, s11
  s_cbranch_scc1 Ll_75
  s_waitcnt vmcnt(32)
  s_barrier
  buffer_load_dwordx4 v4, s[40:43], s7 offen offset:0 sc1 lds
  buffer_load_dwordx4 v5, s[40:43], s7 offen offset:1024 sc1 lds
  buffer_load_dwordx4 v6, s[40:43], s7 offen offset:2048 sc1 lds
  buffer_load_dwordx4 v7, s[40:43], s7 offen offset:3072 sc1 lds
Ll_79:
  s_add_u32 m0, s11, 4096
  s_add_u32 s5, s7, s13
  buffer_load_dwordx4 v4, s[40:43], s5 offen offset:0 sc1 lds
  buffer_load_dwordx4 v5, s[40:43], s5 offen offset:1024 sc1 lds
  buffer_load_dwordx4 v6, s[40:43], s5 offen offset:2048 sc1 lds
  buffer_load_dwordx4 v7, s[40:43], s5 offen offset:3072 sc1 lds
  s_add_u32 m0, s11, 8192
  s_add_u32 s3, s7, s95
  buffer_load_dwordx4 v4, s[40:43], s3 offen offset:0 sc1 lds
  buffer_load_dwordx4 v5, s[40:43], s3 offen offset:1024 sc1 lds
  buffer_load_dwordx4 v6, s[40:43], s3 offen offset:2048 sc1 lds
  buffer_load_dwordx4 v7, s[40:43], s3 offen offset:3072 sc1 lds
  s_add_u32 m0, s11, 12288
  s_add_u32 s5, s3, s13
  buffer_load_dwordx4 v4, s[40:43], s5 offen offset:0 sc1 lds
  s_add_u32 s12, s12, 1
  v_readlane_b32 s7, v9, s12
  s_add_u32 s11, s11, 16384
  buffer_load_dwordx4 v5, s[40:43], s5 offen offset:1024 sc1 lds
  s_cmp_eq_u32 s11, s15
  s_cselect_b32 s4, 65536, 0
  s_sub_u32 s11, s11, s4
  buffer_load_dwordx4 v6, s[40:43], s5 offen offset:2048 sc1 lds
  s_cmp_eq_u32 s12, 16
  buffer_load_dwordx4 v7, s[40:43], s5 offen offset:3072 sc1 lds
  s_mov_b32 m0, s11
  s_cbranch_scc1 Ll_80
  s_waitcnt vmcnt(32)
  s_barrier
  buffer_load_dwordx4 v4, s[40:43], s7 offen offset:0 sc1 lds
  buffer_load_dwordx4 v5, s[40:43], s7 offen offset:1024 sc1 lds
  buffer_load_dwordx4 v6, s[40:43], s7 offen offset:2048 sc1 lds
  buffer_load_dwordx4 v7, s[40:43], s7 offen offset:3072 sc1 lds
  s_branch Ll_79
Ll_80:
  s_waitcnt vmcnt(32)
  s_barrier
  s_waitcnt vmcnt(16)
  s_barrier
  s_waitcnt vmcnt(0)
  s_barrier
  s_barrier
  s_mov_b32 s11, 0
  s_mov_b32 s15, 65536
  s_mul_i32 s5, s76, 112
  s_mul_i32 s4, s79, 56
  s_add_u32 s5, s5, s4
  s_lshl_b32 s5, s5, 13
  s_add_u32 s5, s5, s83
  s_add_u32 s5, s5, 0x7ff000
  v_subrev_u32 v2, 4, v1
  v_cmp_le_u32 vcc, 28, v1
  s_nop 1
  v_cndmask_b32 v10, v1, v2, vcc
  v_subrev_u32 v3, 3, v10
  v_mov_b32 v9, 4
  v_cmp_le_u32 vcc, 14, v10
  v_subrev_u32 v2, 14, v10
  s_nop 0
  v_cndmask_b32 v3, v3, v2, vcc
  v_cndmask_b32_e64 v9, v9, 12, vcc
  v_cmp_le_u32 vcc, 21, v10
  v_subrev_u32 v2, 21, v10
  s_nop 0
  v_cndmask_b32 v3, v3, v2, vcc
  v_cndmask_b32_e64 v9, v9, 20, vcc
  s_sub_u32 s4, s80, s76
  s_and_b32 s4, s4, 7
  v_cmp_le_u32 vcc, s4, v3
  v_mov_b32 v2, s76
  s_nop 0
  v_addc_co_u32 v3, vcc, v3, v2, vcc
  v_and_b32 v3, 7, v3
  v_add_u32 v9, v9, v3
  v_add_u32 v2, v2, v1
  v_and_b32 v2, 3, v2
  v_subrev_u32 v3, 10, v1
  v_cmp_gt_u32 vcc, 4, v3
  s_nop 1
  v_cndmask_b32 v9, v9, v2, vcc
  s_add_u32 s4, s80, 4
  v_lshl_add_u32 v2, v1, 3, s4
  v_cmp_gt_u32 vcc, 3, v1
  s_nop 1
  v_cndmask_b32 v9, v9, v2, vcc
  v_lshl_add_u32 v9, v9, 14, s5
  s_mul_i32 s4, s79, 917504
  s_sub_u32 s4, 458752, s4
  v_add_u32 v2, s4, v9
  v_cmp_le_u32 vcc, 28, v1
  s_nop 1
  v_cndmask_b32 v9, v9, v2, vcc
  s_nop 0
  v_readlane_b32 s7, v9, 3
  s_mov_b32 s11, 49152
  s_add_u32 s91, s91, 4
  s_lshl_b32 s4, s79, 3
  s_lshl_b32 s90, 0xff, s4
  s_bitset0_b32 s90, s77
  s_mov_b32 s89, 200000
  s_mov_b32 exec_lo, s90
  s_mov_b32 exec_hi, 0
  buffer_load_dword v12, v8, s[40:43], s91 offen sc0 sc1
Lp_81:
  s_waitcnt vmcnt(0)
  v_cmp_ne_u32 vcc, 0, v12
  s_andn2_b32 s3, exec_lo, vcc_lo
  s_cbranch_scc0 Lp_82
  s_mov_b32 exec_lo, s3
  s_sleep 1
  buffer_load_dword v12, v8, s[40:43], s91 offen sc0 sc1
  s_sub_u32 s89, s89, 1
  s_cbranch_scc0 Lp_81
Lp_82:
  s_mov_b64 exec, -1
  s_mov_b32 s12, 3
  s_mov_b32 m0, s11
Ll_83:
  s_nop 0
  buffer_load_dwordx4 v4, s[40:43], s7 offen offset:0 sc1 lds
  buffer_load_dwordx4 v5, s[40:43], s7 offen offset:1024 sc1 lds
  buffer_load_dwordx4 v6, s[40:43], s7 offen offset:2048 sc1 lds
  buffer_load_dwordx4 v7, s[40:43], s7 offen offset:3072 sc1 lds
  s_add_u32 m0, s11, 4096
  s_add_u32 s5, s7, s13
  buffer_load_dwordx4 v4, s[40:43], s5 offen offset:0 sc1 lds
  buffer_load_dwordx4 v5, s[40:43], s5 offen offset:1024 sc1 lds
  buffer_load_dwordx4 v6, s[40:43], s5 offen offset:2048 sc1 lds
  buffer_load_dwordx4 v7, s[40:43], s5 offen offset:3072 sc1 lds
  s_add_u32 m0, s11, 8192
  s_add_u32 s3, s7, s95
  buffer_load_dwordx4 v4, s[40:43], s3 offen offset:0 sc1 lds
  buffer_load_dwordx4 v5, s[40:43], s3 offen offset:1024 sc1 lds
  buffer_load_dwordx4 v6, s[40:43], s3 offen offset:2048 sc1 lds
  buffer_load_dwordx4 v7, s[40:43], s3 offen offset:3072 sc1 lds
  s_add_u32 m0, s11, 12288
  s_add_u32 s5, s3, s13
  buffer_load_dwordx4 v4, s[40:43], s5 offen offset:0 sc1 lds
  s_add_u32 s12, s12, 1
  v_readlane_b32 s7, v9, s12
  s_add_u32 s11, s11, 16384
  buffer_load_dwordx4 v5, s[40:43], s5 offen offset:1024 sc1 lds
  s_cmp_eq_u32 s11, s15
  s_cselect_b32 s4, 65536, 0
  s_sub_u32 s11, s11, s4
  buffer_load_dwordx4 v6, s[40:43], s5 offen offset:2048 sc1 lds
  s_cmp_lg_u32 s12, 4
  buffer_load_dwordx4 v7, s[40:43], s5 offen offset:3072 sc1 lds
  s_mov_b32 m0, s11
  s_cbranch_scc1 Ll_83
  s_waitcnt vmcnt(48)
  s_barrier
  s_waitcnt vmcnt(32)
  s_barrier
  buffer_load_dwordx4 v4, s[40:43], s7 offen offset:0 sc1 lds
  buffer_load_dwordx4 v5, s[40:43], s7 offen offset:1024 sc1 lds
  buffer_load_dwordx4 v6, s[40:43], s7 offen offset:2048 sc1 lds
  buffer_load_dwordx4 v7, s[40:43], s7 offen offset:3072 sc1 lds
Ll_87:
  s_add_u32 m0, s11, 4096
  s_add_u32 s5, s7, s13
  buffer_load_dwordx4 v4, s[40:43], s5 offen offset:0 sc1 lds
  buffer_load_dwordx4 v5, s[40:43], s5 offen offset:1024 sc1 lds
  buffer_load_dwordx4 v6, s[40:43], s5 offen offset:2048 sc1 lds
  buffer_load_dwordx4 v7, s[40:43], s5 offen offset:3072 sc1 lds
  s_add_u32 m0, s11, 8192
  s_add_u32 s3, s7, s95
  buffer_load_dwordx4 v4, s[40:43], s3 offen offset:0 sc1 lds
  buffer_load_dwordx4 v5, s[40:43], s3 offen offset:1024 sc1 lds
  buffer_load_dwordx4 v6, s[40:43], s3 offen offset:2048 sc1 lds
  buffer_load_dwordx4 v7, s[40:43], s3 offen offset:3072 sc1 lds
  s_add_u32 m0, s11, 12288
  s_add_u32 s5, s3, s13
  buffer_load_dwordx4 v4, s[40:43], s5 offen offset:0 sc1 lds
  s_add_u32 s12, s12, 1
  v_readlane_b32 s7, v9, s12
  s_add_u32 s11, s11, 16384
  buffer_load_dwordx4 v5, s[40:43], s5 offen offset:1024 sc1 lds
  s_cmp_eq_u32 s11, s15
  s_cselect_b32 s4, 65536, 0
  s_sub_u32 s11, s11, s4
  buffer_load_dwordx4 v6, s[40:43], s5 offen offset:2048 sc1 lds
  s_cmp_eq_u32 s12, 32
  buffer_load_dwordx4 v7, s[40:43], s5 offen offset:3072 sc1 lds
  s_mov_b32 m0, s11
  s_cbranch_scc1 Ll_88
  s_waitcnt vmcnt(32)
  s_barrier
  buffer_load_dwordx4 v4, s[40:43], s7 offen offset:0 sc1 lds
  buffer_load_dwordx4 v5, s[40:43], s7 offen offset:1024 sc1 lds
  buffer_load_dwordx4 v6, s[40:43], s7 offen offset:2048 sc1 lds
  buffer_load_dwordx4 v7, s[40:43], s7 offen offset:3072 sc1 lds
  s_branch Ll_87
Ll_88:
  s_waitcnt vmcnt(32)
  s_barrier
  s_waitcnt vmcnt(16)
  s_barrier
  s_waitcnt vmcnt(0)
  s_barrier
  s_barrier
  s_cmp_lg_u32 s82, 0
  s_cbranch_scc1 L_lend
  s_mov_b32 s72, s40
  s_mov_b32 s73, s41
  s_mov_b32 s74, s42
  s_mul_i32 s5, s76, 32
  s_lshl_b32 s5, s5, 13
  s_add_u32 s5, s5, s83
  s_add_u32 s5, s5, 0x1eff000
  s_mov_b32 s8, 16384
  s_mov_b32 s10, 262144
  s_add_u32 s9, s5, s10
  s_mul_i32 s6, s76, 11
  s_lshr_b32 s6, s6, 5
  s_mul_i32 s6, s6, 49152
  s_add_u32 s7, s5, s6
  s_mov_b32 s14, 0xfffc0c00
  s_add_u32 s91, s91, 8
  s_lshr_b32 s6, s6, 14
  s_lshl_b32 s90, 0xf, s6
  s_lshr_b32 s4, s90, 16
  s_or_b32 s90, s90, s4
  s_and_b32 s90, s90, 0xffff
  s_lshl_b32 s4, s90, 16
  s_cmp_eq_u32 s76, 0
  s_cselect_b32 s4, 0, s4
  s_or_b32 s90, s90, s4
  s_mov_b32 s82, 1
  s_add_u32 s83, s83, 0
  s_add_u32 s87, s87, 32
  s_mov_b32 s89, 200000
  s_mov_b32 exec_lo, s90
  s_mov_b32 exec_hi, 0
  buffer_load_dword v12, v8, s[40:43], s91 offen sc0 sc1
Lp_89:
  s_waitcnt vmcnt(0)
  v_cmp_ne_u32 vcc, 0, v12
  s_andn2_b32 s3, exec_lo, vcc_lo
  s_cbranch_scc0 Lp_90
  s_mov_b32 exec_lo, s3
  s_sleep 1
  buffer_load_dword v12, v8, s[40:43], s91 offen sc0 sc1
  s_sub_u32 s89, s89, 1
  s_cbranch_scc0 Lp_89
Lp_90:
  s_mov_b64 exec, -1
  s_branch L_xlayer
L_s1:
  v_mov_b32 v11, 1
  v_and_b32 v2, 31, v1
  v_lshlrev_b32 v5, 7, v2
  v_lshlrev_b32 v10, 3, v2
  v_lshrrev_b32 v3, 5, v1
  v_mul_u32_u24 v3, 320, v3
  v_add_u32 v10, v3, v10
  v_add_u32 v10, 151552, v10
  v_bfe_u32 v3, v1, 3, 1
  v_and_b32 v2, 7, v1
  v_lshlrev_b32 v12, 9, v3
  v_lshl_add_u32 v12, v2, 4, v12
  v_mul_u32_u24 v3, 320, v3
  v_lshl_add_u32 v13, v2, 3, v3
  v_add_u32 v13, 151808, v13
  v_and_b32 v2, 15, v1
  v_lshlrev_b32 v8, 4, v2
  v_lshlrev_b32 v15, 6, v2
  v_and_b32 v3, 48, v1
  v_add_u32 v15, v15, v3
  v_and_b32 v2, 14, v1
  v_lshlrev_b32 v6, 2, v2
  v_lshlrev_b32 v14, 16, v1
  s_lshl_b32 s4, s77, 12
  s_lshl_b32 s5, s76, 7
  s_add_u32 s4, s4, s5
  v_add_u32 v14, s4, v14
  v_lshrrev_b32 v2, 2, v1
  v_lshlrev_b32 v22, 7, v2
  v_lshlrev_b32 v96, 6, v2
  v_and_b32 v2, 3, v1
  v_lshl_add_u32 v22, v2, 3, v22
  v_lshl_add_u32 v96, v2, 3, v96
  v_add_u32 v22, 65536, v22
  v_add_u32 v96, 90112, v96
  v_bfe_u32 v3, v1, 3, 2
  v_xor_b32 v2, 0, v3
  v_lshl_add_u32 v16, v2, 5, v22
  v_xor_b32 v2, 1, v3
  v_lshl_add_u32 v17, v2, 5, v22
  v_xor_b32 v2, 2, v3
  v_lshl_add_u32 v18, v2, 5, v22
  v_xor_b32 v2, 3, v3
  v_lshl_add_u32 v19, v2, 5, v22
  v_bfe_u32 v3, v1, 4, 1
  v_xor_b32 v2, 0, v3
  v_lshl_add_u32 v20, v2, 5, v96
  v_xor_b32 v2, 1, v3
  v_lshl_add_u32 v21, v2, 5, v96
  v_mov_b32 v22, 0x3f803f80
  s_mul_i32 s4, s76, 11
  s_lshr_b32 s4, s4, 5
  s_mul_i32 s4, s4, 3
  s_sub_u32 s14, s76, s4
  s_mov_b32 s15, 32768
  s_mul_i32 s4, s14, 24576
  v_add_u32 v16, s4, v16
  v_add_u32 v17, s4, v17
  v_add_u32 v18, s4, v18
  v_add_u32 v19, s4, v19
  s_mov_b32 s98, 0x00010001
  s_mov_b32 s99, 0x00010001
  v_cndmask_b32_e64 v200, 0, v22, s[98:99]
  v_cndmask_b32_e64 v201, 0, v22, s[98:99]
  v_cndmask_b32_e64 v202, 0, v22, s[98:99]
  v_cndmask_b32_e64 v203, 0, v22, s[98:99]
  s_lshl_b64 s[98:99], s[98:99], 1
  v_cndmask_b32_e64 v204, 0, v22, s[98:99]
  v_cndmask_b32_e64 v205, 0, v22, s[98:99]
  v_cndmask_b32_e64 v206, 0, v22, s[98:99]
  v_cndmask_b32_e64 v207, 0, v22, s[98:99]
  s_lshl_b64 s[98:99], s[98:99], 1
  v_cndmask_b32_e64 v208, 0, v22, s[98:99]
  v_cndmask_b32_e64 v209, 0, v22, s[98:99]
  v_cndmask_b32_e64 v210, 0, v22, s[98:99]
  v_cndmask_b32_e64 v211, 0, v22, s[98:99]
  s_lshl_b64 s[98:99], s[98:99], 1
  v_cndmask_b32_e64 v212, 0, v22, s[98:99]
  v_cndmask_b32_e64 v213, 0, v22, s[98:99]
  v_cndmask_b32_e64 v214, 0, v22, s[98:99]
  v_cndmask_b32_e64 v215, 0, v22, s[98:99]
  s_lshl_b64 s[98:99], s[98:99], 1
  v_cndmask_b32_e64 v216, 0, v22, s[98:99]
  v_cndmask_b32_e64 v217, 0, v22, s[98:99]
  v_cndmask_b32_e64 v218, 0, v22, s[98:99]
  v_cndmask_b32_e64 v219, 0, v22, s[98:99]
  s_lshl_b64 s[98:99], s[98:99], 1
  v_cndmask_b32_e64 v220, 0, v22, s[98:99]
  v_cndmask_b32_e64 v221, 0, v22, s[98:99]
  v_cndmask_b32_e64 v222, 0, v22, s[98:99]
  v_cndmask_b32_e64 v223, 0, v22, s[98:99]
  s_lshl_b64 s[98:99], s[98:99], 1
  v_cndmask_b32_e64 v224, 0, v22, s[98:99]
  v_cndmask_b32_e64 v225, 0, v22, s[98:99]
  v_cndmask_b32_e64 v226, 0, v22, s[98:99]
  v_cndmask_b32_e64 v227, 0, v22, s[98:99]
  s_lshl_b64 s[98:99], s[98:99], 1
  v_cndmask_b32_e64 v228, 0, v22, s[98:99]
  v_cndmask_b32_e64 v229, 0, v22, s[98:99]
  v_cndmask_b32_e64 v230, 0, v22, s[98:99]
  v_cndmask_b32_e64 v231, 0, v22, s[98:99]
  s_lshl_b64 s[98:99], s[98:99], 1
  v_cndmask_b32_e64 v232, 0, v22, s[98:99]
  v_cndmask_b32_e64 v233, 0, v22, s[98:99]
  v_cndmask_b32_e64 v234, 0, v22, s[98:99]
  v_cndmask_b32_e64 v235, 0, v22, s[98:99]
  s_lshl_b64 s[98:99], s[98:99], 1
  v_cndmask_b32_e64 v236, 0, v22, s[98:99]
  v_cndmask_b32_e64 v237, 0, v22, s[98:99]
  v_cndmask_b32_e64 v238, 0, v22, s[98:99]
  v_cndmask_b32_e64 v239, 0, v22, s[98:99]
  s_lshl_b64 s[98:99], s[98:99], 1
  v_cndmask_b32_e64 v240, 0, v22, s[98:99]
  v_cndmask_b32_e64 v241, 0, v22, s[98:99]
  v_cndmask_b32_e64 v242, 0, v22, s[98:99]
  v_cndmask_b32_e64 v243, 0, v22, s[98:99]
  s_lshl_b64 s[98:99], s[98:99], 1
  v_cndmask_b32_e64 v244, 0, v22, s[98:99]
  v_cndmask_b32_e64 v245, 0, v22, s[98:99]
  v_cndmask_b32_e64 v246, 0, v22, s[98:99]
  v_cndmask_b32_e64 v247, 0, v22, s[98:99]
  s_lshl_b64 s[98:99], s[98:99], 1
  s_mov_b32 s56, s24
  s_and_b32 s57, s25, 0xffff
  s_mov_b32 s58, 7340032
  s_mov_b32 s59, 0x00020000
  s_mov_b32 s60, s28
  s_and_b32 s61, s29, 0xffff
  s_mov_b32 s62, 7340032
  s_mov_b32 s63, 0x00020000
  s_mul_i32 s12, s76, 458752
  s_mul_i32 s5, s77, 448
  s_andn2_b32 s5, s5, 127
  s_add_u32 s12, s12, s5
  v_lshrrev_b32 v2, 2, v1
  v_mul_u32_u24 v2, 7168, v2
  v_and_b32 v3, 3, v1
  v_lshl_add_u32 v110, v3, 7, v2
  s_mul_i32 s4, s76, 112
  s_mul_i32 s5, s79, 1792
  s_add_u32 s4, s4, s5
  s_lshl_b32 s4, s4, 11
  s_lshl_b32 s5, s80, 8
  s_add_u32 s13, s4, s5
  v_lshrrev_b32 v2, 1, v1
  v_lshlrev_b32 v2, 11, v2
  v_and_b32 v3, 1, v1
  v_lshl_add_u32 v111, v3, 7, v2
  s_mov_b32 s8, 0x00500005
  s_mov_b32 s9, 0x50000500
L_slayer:
  s_cmp_eq_u32 s76, 0
  s_mov_b32 s11, 0xfffffd80
  s_cselect_b32 s11, 0x70000000, s11
  s_cselect_b32 s90, 1, 0
  s_barrier
  s_cmp_lg_u32 s82, 0
  s_cbranch_scc1 L_91
  buffer_load_dwordx4 v[128:131], v108, s[44:47], s7 offen offset:0
  buffer_load_dwordx4 v[132:135], v108, s[44:47], s7 offen offset:128
  buffer_load_dwordx4 v[136:139], v108, s[44:47], s7 offen offset:256
  buffer_load_dwordx4 v[140:143], v108, s[44:47], s7 offen offset:384
  buffer_load_dwordx4 v[144:147], v108, s[44:47], s7 offen offset:512
  buffer_load_dwordx4 v[148:151], v108, s[44:47], s7 offen offset:640
  buffer_load_dwordx4 v[152:155], v108, s[44:47], s7 offen offset:768
  buffer_load_dwordx4 v[156:159], v108, s[44:47], s7 offen offset:896
  buffer_load_dwordx4 v[160:163], v108, s[44:47], s7 offen offset:1024
  buffer_load_dwordx4 v[164:167], v108, s[44:47], s7 offen offset:1152
  buffer_load_dwordx4 v[168:171], v108, s[44:47], s7 offen offset:1280
  buffer_load_dwordx4 v[172:175], v108, s[44:47], s7 offen offset:1408
  buffer_load_dwordx4 v[176:179], v108, s[44:47], s7 offen offset:1536
  buffer_load_dwordx4 v[180:183], v108, s[44:47], s7 offen offset:1664
  buffer_load_dwordx4 v[184:187], v108, s[44:47], s7 offen offset:1792
  buffer_load_dwordx4 v[188:191], v108, s[44:47], s7 offen offset:1920
  s_waitcnt vmcnt(16)
  s_lshl_b32 s4, s76, 4
  s_mov_b64 exec, 1
  buffer_atomic_add v11, v24, s[68:71], s4 offen sc1
  s_mov_b64 exec, -1
  s_branch L_92
L_91:
  s_lshl_b32 s91, s84, 1
  s_add_u32 s91, s91, s87
  s_sub_u32 s91, s91, 16
  s_cmp_eq_u32 s76, 0
  s_cselect_b32 s16, 0xffff, -1
  s_mov_b32 exec_lo, s16
  s_mov_b32 exec_hi, 0
  buffer_load_dword v7, v5, s[40:43], s91 offen sc0 sc1
  s_mov_b64 exec, -1
L_92:
  s_cmp_le_u32 s14, 0
  s_cbranch_scc1 L_93
  s_barrier
L_93:
  s_cmp_le_u32 s14, 1
  s_cbranch_scc1 L_94
  s_barrier
L_94:
  s_cmp_lg_u32 s82, 0
  s_cbranch_scc1 L_95
  ds_read_b64_tr_b16 v[32:33], v16 offset:0
  ds_read_b64_tr_b16 v[34:35], v16 offset:2048
  ds_read_b64_tr_b16 v[36:37], v17 offset:0
  ds_read_b64_tr_b16 v[38:39], v17 offset:2048
  ds_read_b64_tr_b16 v[40:41], v18 offset:0
  ds_read_b64_tr_b16 v[42:43], v18 offset:2048
  ds_read_b64_tr_b16 v[44:45], v19 offset:0
  ds_read_b64_tr_b16 v[46:47], v19 offset:2048
  ds_read_b64_tr_b16 v[48:49], v16 offset:4096
  ds_read_b64_tr_b16 v[50:51], v16 offset:6144
  ds_read_b64_tr_b16 v[52:53], v17 offset:4096
  ds_read_b64_tr_b16 v[54:55], v17 offset:6144
  s_waitcnt lgkmcnt(4)
  ds_read_b64_tr_b16 v[56:57], v18 offset:4096
  ds_read_b64_tr_b16 v[58:59], v18 offset:6144
  ds_read_b64_tr_b16 v[60:61], v19 offset:4096
  ds_read_b64_tr_b16 v[62:63], v19 offset:6144
  s_cmp_eq_u32 s14, 2
  s_cselect_b32 s4, 0xffff6000, s15
  v_add_u32 v16, s4, v16
  v_add_u32 v17, s4, v17
  v_add_u32 v18, s4, v18
  v_add_u32 v19, s4, v19
  s_waitcnt lgkmcnt(0)
L_95:
  s_barrier
  s_cmp_lg_u32 s82, 0
  s_cbranch_scc1 L_97
  ds_read_b64_tr_b16 v[64:65], v16 offset:0
  ds_read_b64_tr_b16 v[66:67], v16 offset:2048
  ds_read_b64_tr_b16 v[68:69], v17 offset:0
  ds_read_b64_tr_b16 v[70:71], v17 offset:2048
  ds_read_b64_tr_b16 v[72:73], v18 offset:0
  ds_read_b64_tr_b16 v[74:75], v18 offset:2048
  ds_read_b64_tr_b16 v[76:77], v19 offset:0
  ds_read_b64_tr_b16 v[78:79], v19 offset:2048
  ds_read_b64_tr_b16 v[80:81], v16 offset:4096
  ds_read_b64_tr_b16 v[82:83], v16 offset:6144
  ds_read_b64_tr_b16 v[84:85], v17 offset:4096
  ds_read_b64_tr_b16 v[86:87], v17 offset:6144
  s_waitcnt lgkmcnt(4)
  ds_read_b64_tr_b16 v[88:89], v18 offset:4096
  ds_read_b64_tr_b16 v[90:91], v18 offset:6144
  ds_read_b64_tr_b16 v[92:93], v19 offset:4096
  ds_read_b64_tr_b16 v[94:95], v19 offset:6144
  s_cmp_eq_u32 s14, 1
  s_cselect_b32 s4, 0xffff6000, s15
  v_add_u32 v16, s4, v16
  v_add_u32 v17, s4, v17
  v_add_u32 v18, s4, v18
  v_add_u32 v19, s4, v19
  v_mfma_f32_16x16x32_bf16 v[28:31], v[32:35], v[200:203], 0
  v_mfma_f32_16x16x32_bf16 v[28:31], v[36:39], v[204:207], v[28:31]
  v_mfma_f32_16x16x32_bf16 v[28:31], v[40:43], v[208:211], v[28:31]
  v_mfma_f32_16x16x32_bf16 v[28:31], v[44:47], v[212:215], v[28:31]
  v_mfma_f32_16x16x32_bf16 v[28:31], v[48:51], v[200:203], v[28:31]
  v_mfma_f32_16x16x32_bf16 v[28:31], v[52:55], v[204:207], v[28:31]
  v_mfma_f32_16x16x32_bf16 v[28:31], v[56:59], v[208:211], v[28:31]
  v_mfma_f32_16x16x32_bf16 v[28:31], v[60:63], v[212:215], v[28:31]
  s_waitcnt lgkmcnt(0)
  s_branch L_98
L_97:
  s_waitcnt vmcnt(0)
  s_mov_b32 s89, 200000
  s_mov_b32 exec_lo, s16
  s_mov_b32 exec_hi, 0
  s_branch Lp_100
Lp_99:
  buffer_load_dword v7, v5, s[40:43], s91 offen sc0 sc1
  s_waitcnt vmcnt(0)
Lp_100:
  v_cmp_ne_u32 vcc, 0, v7
  s_andn2_b32 s3, s16, vcc_lo
  s_cbranch_scc0 Lp_101
  s_sleep 1
  s_sub_u32 s89, s89, 1
  s_cbranch_scc0 Lp_99
Lp_101:
  s_mov_b64 exec, -1
  s_add_u32 s5, s84, s92
  buffer_load_dwordx2 v[96:97], v6, s[40:43], s5 offen offset:0 sc1
  buffer_load_dwordx2 v[98:99], v6, s[40:43], s5 offen offset:512 sc1
  buffer_load_dwordx2 v[100:101], v6, s[40:43], s5 offen offset:1024 sc1
  buffer_load_dwordx2 v[102:103], v6, s[40:43], s5 offen offset:1536 sc1
L_98:
  s_barrier
  s_cmp_lg_u32 s82, 0
  s_cbranch_scc1 L_102
  ds_read_b64_tr_b16 v[32:33], v16 offset:0
  ds_read_b64_tr_b16 v[34:35], v16 offset:2048
  ds_read_b64_tr_b16 v[36:37], v17 offset:0
  ds_read_b64_tr_b16 v[38:39], v17 offset:2048
  ds_read_b64_tr_b16 v[40:41], v18 offset:0
  ds_read_b64_tr_b16 v[42:43], v18 offset:2048
  ds_read_b64_tr_b16 v[44:45], v19 offset:0
  ds_read_b64_tr_b16 v[46:47], v19 offset:2048
  ds_read_b64_tr_b16 v[48:49], v16 offset:4096
  ds_read_b64_tr_b16 v[50:51], v16 offset:6144
  ds_read_b64_tr_b16 v[52:53], v17 offset:4096
  ds_read_b64_tr_b16 v[54:55], v17 offset:6144
  s_waitcnt lgkmcnt(4)
  ds_read_b64_tr_b16 v[56:57], v18 offset:4096
  ds_read_b64_tr_b16 v[58:59], v18 offset:6144
  ds_read_b64_tr_b16 v[60:61], v19 offset:4096
  ds_read_b64_tr_b16 v[62:63], v19 offset:6144
  v_mfma_f32_16x16x32_bf16 v[28:31], v[64:67], v[216:219], v[28:31]
  v_mfma_f32_16x16x32_bf16 v[28:31], v[68:71], v[220:223], v[28:31]
  v_mfma_f32_16x16x32_bf16 v[28:31], v[72:75], v[224:227], v[28:31]
  v_mfma_f32_16x16x32_bf16 v[28:31], v[76:79], v[228:231], v[28:31]
  v_mfma_f32_16x16x32_bf16 v[28:31], v[80:83], v[216:219], v[28:31]
  v_mfma_f32_16x16x32_bf16 v[28:31], v[84:87], v[220:223], v[28:31]
  v_mfma_f32_16x16x32_bf16 v[28:31], v[88:91], v[224:227], v[28:31]
  v_mfma_f32_16x16x32_bf16 v[28:31], v[92:95], v[228:231], v[28:31]
  s_waitcnt lgkmcnt(0)
L_102:
  s_barrier
  s_cmp_lg_u32 s82, 0
  s_cbranch_scc1 L_104
  v_mfma_f32_16x16x32_bf16 v[28:31], v[32:35], v[232:235], v[28:31]
  v_mfma_f32_16x16x32_bf16 v[28:31], v[36:39], v[236:239], v[28:31]
  v_mfma_f32_16x16x32_bf16 v[28:31], v[40:43], v[240:243], v[28:31]
  v_mfma_f32_16x16x32_bf16 v[28:31], v[44:47], v[244:247], v[28:31]
  v_mfma_f32_16x16x32_bf16 v[28:31], v[48:51], v[232:235], v[28:31]
  v_mfma_f32_16x16x32_bf16 v[28:31], v[52:55], v[236:239], v[28:31]
  v_mfma_f32_16x16x32_bf16 v[28:31], v[56:59], v[240:243], v[28:31]
  v_mfma_f32_16x16x32_bf16 v[28:31], v[60:63], v[244:247], v[28:31]
  s_lshl_b32 s5, s77, 14
  s_lshl_b32 s4, s76, 10
  s_add_u32 s5, s5, s4
  s_add_u32 s5, s5, 589824
  s_nop 3
  buffer_store_dwordx4 v[28:31], v15, s[40:43], s5 offen sc0 sc1
L_104:
  s_cmp_gt_u32 s14, 0
  s_cbranch_scc1 L_106
  s_barrier
L_106:
  s_cmp_gt_u32 s14, 1
  s_cbranch_scc1 L_107
  s_barrier
L_107:
  s_cmp_lg_u32 s82, 0
  s_cbranch_scc1 L_108
  s_waitcnt vmcnt(2)
  buffer_load_dword v9, v8, s[68:71], 0 offen sc0 sc1
  s_mov_b32 s72, s26
  s_and_b32 s73, s27, 0xffff
  s_mov_b32 s74, 7168
  s_mov_b32 s75, 0x00020000
  s_mul_i32 s4, s77, 448
  s_and_b32 s5, s77, 1
  s_lshl_b32 s6, s5, 6
  s_add_u32 s6, s6, s4
  s_mul_i32 s5, s5, 384
  s_sub_u32 s5, s4, s5
  v_lshlrev_b32 v2, 1, v1
  v_lshrrev_b32 v3, 1, v2
  v_xor_b32 v3, v3, v2
  v_and_b32 v3, 16, v3
  v_mul_u32_u24 v3, 3, v3
  v_xor_b32 v3, v3, v2
  buffer_load_ushort v104, v2, s[72:75], s6 offen offset:0
  buffer_load_ushort v105, v2, s[72:75], s6 offen offset:128
  buffer_load_ushort v106, v2, s[72:75], s6 offen offset:256
  buffer_load_ushort v107, v3, s[72:75], s5 offen offset:384
  s_mov_b32 s64, s30
  s_and_b32 s65, s31, 0xffff
  s_mov_b32 s66, 2048
  s_mov_b32 s67, 0x00020000
  s_lshl_b32 s4, s78, 7
  buffer_load_ushort v108, v2, s[64:67], s4 offen
  s_mov_b32 s52, s20
  s_and_b32 s53, s21, 0xffff
  s_mov_b32 s54, 2097152
  s_mov_b32 s55, 0x00020000
  s_lshl_b32 s4, s76, 17
  s_lshl_b32 s5, s78, 7
  s_add_u32 s4, s4, s5
  v_lshlrev_b32 v2, 11, v1
  buffer_load_dword v109, v2, s[52:55], s4 offen
  v_mov_b32 v32, v22
  v_mov_b32 v33, v22
  v_mov_b32 v34, v22
  v_mov_b32 v35, v22
  s_nop 1
  v_mfma_f32_16x16x32_bf16 v[96:99], v[32:35], v[128:131], 0
  v_mfma_f32_16x16x32_bf16 v[100:103], v[128:131], v[128:131], 0
  v_mfma_f32_16x16x32_bf16 v[96:99], v[32:35], v[132:135], v[96:99]
  v_mfma_f32_16x16x32_bf16 v[100:103], v[132:135], v[132:135], v[100:103]
  v_mfma_f32_16x16x32_bf16 v[96:99], v[32:35], v[136:139], v[96:99]
  v_mfma_f32_16x16x32_bf16 v[100:103], v[136:139], v[136:139], v[100:103]
  v_mfma_f32_16x16x32_bf16 v[96:99], v[32:35], v[140:143], v[96:99]
  v_mfma_f32_16x16x32_bf16 v[100:103], v[140:143], v[140:143], v[100:103]
L_108:
  s_barrier
  s_cmp_lg_u32 s82, 0
  s_cbranch_scc1 L_110
  v_mfma_f32_16x16x32_bf16 v[96:99], v[32:35], v[144:147], v[96:99]
  v_mfma_f32_16x16x32_bf16 v[100:103], v[144:147], v[144:147], v[100:103]
  v_mfma_f32_16x16x32_bf16 v[96:99], v[32:35], v[148:151], v[96:99]
  v_mfma_f32_16x16x32_bf16 v[100:103], v[148:151], v[148:151], v[100:103]
  v_mfma_f32_16x16x32_bf16 v[96:99], v[32:35], v[152:155], v[96:99]
  v_mfma_f32_16x16x32_bf16 v[100:103], v[152:155], v[152:155], v[100:103]
  v_mfma_f32_16x16x32_bf16 v[96:99], v[32:35], v[156:159], v[96:99]
  v_mfma_f32_16x16x32_bf16 v[100:103], v[156:159], v[156:159], v[100:103]
L_110:
  s_barrier
  s_cmp_lg_u32 s82, 0
  s_cbranch_scc1 L_112
  v_mfma_f32_16x16x32_bf16 v[96:99], v[32:35], v[160:163], v[96:99]
  v_mfma_f32_16x16x32_bf16 v[100:103], v[160:163], v[160:163], v[100:103]
  v_mfma_f32_16x16x32_bf16 v[96:99], v[32:35], v[164:167], v[96:99]
  v_mfma_f32_16x16x32_bf16 v[100:103], v[164:167], v[164:167], v[100:103]
  v_mfma_f32_16x16x32_bf16 v[96:99], v[32:35], v[168:171], v[96:99]
  v_mfma_f32_16x16x32_bf16 v[100:103], v[168:171], v[168:171], v[100:103]
  v_mfma_f32_16x16x32_bf16 v[96:99], v[32:35], v[172:175], v[96:99]
  v_mfma_f32_16x16x32_bf16 v[100:103], v[172:175], v[172:175], v[100:103]
  s_waitcnt vmcnt(0)
  v_lshlrev_b32 v2, 2, v1
  v_add_u32 v2, 155136, v2
  v_lshlrev_b32 v104, 16, v104
  v_mul_f32 v104, 0x3eeff558, v104
  ds_write_b32 v2, v104 offset:0
  v_lshlrev_b32 v105, 16, v105
  v_mul_f32 v105, 0x3eeff558, v105
  ds_write_b32 v2, v105 offset:256
  v_lshlrev_b32 v106, 16, v106
  v_mul_f32 v106, 0x3eeff558, v106
  ds_write_b32 v2, v106 offset:512
  v_lshlrev_b32 v107, 16, v107
  v_mul_f32 v107, 0x3eeff558, v107
  ds_write_b32 v2, v107 offset:768
  v_lshlrev_b32 v108, 16, v108
  ds_write_b32 v2, v108 offset:1024
  v_mov_b32 v2, 156416
  ds_write_b64 v2, v[24:25]
  s_mov_b32 s89, 200000
  s_branch Lg_115
Lg_114:
  buffer_load_dword v9, v8, s[68:71], 0 offen sc0 sc1
  s_waitcnt vmcnt(0)
Lg_115:
  v_cmp_eq_u32 vcc, 16, v9
  s_andn2_b32 s3, 0xffff, vcc_lo
  s_cbranch_scc0 Lg_116
  s_sleep 2
  s_sub_u32 s89, s89, 1
  s_cbranch_scc0 Lg_114
Lg_116:
  s_mov_b32 s5, 1835008
  s_mov_b64 exec, 0xffff
  buffer_store_dword v11, v14, s[40:43], s5 offen sc0 sc1
  s_mov_b64 exec, -1
  s_getpc_b64 s[4:5]
L_pc0:
  s_sub_u32 s4, s4, L_pc0-mega_kernel
  s_subb_u32 s5, s5, 0
  s_bfe_u32 s6, s2, 0x20003
  s_lshl_b32 s6, s6, 13
  v_lshl_add_u32 v3, v1, 4, s6
  v_mov_b32 v119, s5
  v_min_u32 v118, L_end-mega_kernel-16, v3
  v_add_co_u32 v116, vcc, s4, v118
  v_add_u32 v3, 0x400, v3
  s_nop 0
  v_addc_co_u32 v117, vcc, 0, v119, vcc
  global_load_dwordx4 v[112:115], v[116:117], off
  v_min_u32 v118, L_end-mega_kernel-16, v3
  v_add_co_u32 v116, vcc, s4, v118
  v_add_u32 v3, 0x400, v3
  s_nop 0
  v_addc_co_u32 v117, vcc, 0, v119, vcc
  global_load_dwordx4 v[112:115], v[116:117], off
  v_min_u32 v118, L_end-mega_kernel-16, v3
  v_add_co_u32 v116, vcc, s4, v118
  v_add_u32 v3, 0x400, v3
  s_nop 0
  v_addc_co_u32 v117, vcc, 0, v119, vcc
  global_load_dwordx4 v[112:115], v[116:117], off
  v_min_u32 v118, L_end-mega_kernel-16, v3
  v_add_co_u32 v116, vcc, s4, v118
  s_nop 1
  v_addc_co_u32 v117, vcc, 0, v119, vcc
  global_load_dwordx4 v[112:115], v[116:117], off
L_112:
  s_cmp_lg_u32 s82, 0
  s_cbranch_scc1 L_117
  buffer_load_dword v109, v110, s[56:59], s12 offen
  s_add_u32 s12, s12, 114688
L_117:
  s_barrier
  s_cmp_lg_u32 s82, 0
  s_cbranch_scc1 L_119
  v_mfma_f32_16x16x32_bf16 v[96:99], v[32:35], v[176:179], v[96:99]
  v_mfma_f32_16x16x32_bf16 v[100:103], v[176:179], v[176:179], v[100:103]
  v_mfma_f32_16x16x32_bf16 v[96:99], v[32:35], v[180:183], v[96:99]
  v_mfma_f32_16x16x32_bf16 v[100:103], v[180:183], v[180:183], v[100:103]
  v_mfma_f32_16x16x32_bf16 v[96:99], v[32:35], v[184:187], v[96:99]
  v_mfma_f32_16x16x32_bf16 v[100:103], v[184:187], v[184:187], v[100:103]
  v_mfma_f32_16x16x32_bf16 v[96:99], v[32:35], v[188:191], v[96:99]
  v_mfma_f32_16x16x32_bf16 v[100:103], v[188:191], v[188:191], v[100:103]
  s_getpc_b64 s[4:5]
L_pc1:
  s_sub_u32 s4, s4, L_pc1-mega_kernel
  s_subb_u32 s5, s5, 0
  s_bfe_u32 s6, s2, 0x20003
  s_lshl_b32 s6, s6, 13
  s_add_u32 s6, s6, 4096
  v_lshl_add_u32 v3, v1, 4, s6
  v_mov_b32 v119, s5
  v_min_u32 v118, L_end-mega_kernel-16, v3
  v_add_co_u32 v116, vcc, s4, v118
  v_add_u32 v3, 0x400, v3
  s_nop 0
  v_addc_co_u32 v117, vcc, 0, v119, vcc
  global_load_dwordx4 v[112:115], v[116:117], off
  v_min_u32 v118, L_end-mega_kernel-16, v3
  v_add_co_u32 v116, vcc, s4, v118
  v_add_u32 v3, 0x400, v3
  s_nop 0
  v_addc_co_u32 v117, vcc, 0, v119, vcc
  global_load_dwordx4 v[112:115], v[116:117], off
  v_min_u32 v118, L_end-mega_kernel-16, v3
  v_add_co_u32 v116, vcc, s4, v118
  v_add_u32 v3, 0x400, v3
  s_nop 0
  v_addc_co_u32 v117, vcc, 0, v119, vcc
  global_load_dwordx4 v[112:115], v[116:117], off
  v_min_u32 v118, L_end-mega_kernel-16, v3
  v_add_co_u32 v116, vcc, s4, v118
  s_nop 1
  v_addc_co_u32 v117, vcc, 0, v119, vcc
  global_load_dwordx4 v[112:115], v[116:117], off
  s_mov_b32 s98, 0xaaaaaaaa
  s_mov_b32 s99, 0xaaaaaaaa
  v_cndmask_b32_e64 v100, v100, v101, s[98:99]
  v_cndmask_b32_e64 v102, v102, v103, s[98:99]
  s_mov_b32 s98, 0xcccccccc
  s_mov_b32 s99, 0xcccccccc
  v_cndmask_b32_e64 v97, v100, v102, s[98:99]
  v_add_f32_dpp v96, v96, v96 quad_perm:[1,0,3,2] row_mask:0xf bank_mask:0xf
  s_nop 0
  v_add_f32_dpp v97, v97, v97 quad_perm:[1,0,3,2] row_mask:0xf bank_mask:0xf
  s_branch L_120
L_119:
  s_waitcnt vmcnt(0)
  v_add_f32 v96, v96, v100
  v_add_f32 v97, v97, v101
  v_add_f32 v98, v98, v102
  v_add_f32 v99, v99, v103
  v_add_f32 v96, v96, v98
  v_add_f32 v97, v97, v99
  s_nop 0
  v_add_f32_dpp v96, v96, v96 row_ror:8 row_mask:0xf bank_mask:0xf
  v_add_f32_dpp v97, v97, v97 row_ror:8 row_mask:0xf bank_mask:0xf
  v_mov_b32 v98, v96
  v_mov_b32 v99, v97
  s_nop 0
  v_permlane16_swap_b32 v96, v98
  v_permlane16_swap_b32 v97, v99
  v_add_f32 v96, v96, v98
  v_add_f32 v97, v97, v99
  v_mov_b32 v98, v96
  v_mov_b32 v99, v97
  s_nop 0
  v_permlane32_swap_b32 v96, v98
  v_permlane32_swap_b32 v97, v99
  v_add_f32 v96, v96, v98
  v_add_f32 v97, v97, v99
L_120:
  v_mul_f32 v96, 0x3a800000, v96
  v_mul_f32 v97, 0x3a800000, v97
  v_fma_f32 v98, -v96, v96, v97
  v_max_f32 v98, 0, v98
  v_add_f32 v98, 0x3727c5ac, v98
  v_rsq_f32 v98, v98
  s_nop 0
  v_mul_f32 v99, v96, v98
  s_mov_b64 exec, s[8:9]
  buffer_store_dwordx2 v[98:99], v6, s[40:43], s10 offen sc0 sc1
  s_mov_b64 exec, -1
  s_cmp_lg_u32 s82, 0
  s_cbranch_scc1 L_121
  buffer_load_dword v109, v110, s[56:59], s12 offen
  s_add_u32 s12, s12, 114688
L_121:
  s_barrier
  s_cmp_lg_u32 s82, 0
  s_cbranch_scc1 L_123
  v_lshlrev_b32 v6, 3, v1
  s_mov_b64 s[8:9], 0xff
  s_lshl_b32 s91, s84, 1
  s_add_u32 s91, s91, 1835008
  s_mov_b32 exec_lo, 0xffff
  s_mov_b32 exec_hi, 0
  buffer_load_dword v7, v5, s[40:43], s91 offen sc0 sc1
  s_mov_b64 exec, -1
L_123:
  s_barrier
  s_barrier
  s_waitcnt vmcnt(0)
  s_and_b32 s5, s10, 0xfffffc00
  buffer_load_dwordx4 v[120:123], v4, s[40:43], s5 offen sc1
  s_add_u32 s5, s5, s11
  buffer_load_dwordx4 v[124:127], v12, s[40:43], s5 offen sc1
  s_cmp_lg_u32 s82, 0
  s_cbranch_scc1 L_125
  s_mov_b32 s89, 200000
  s_mov_b32 exec_lo, 0xffff
  s_mov_b32 exec_hi, 0
  s_branch Lp_128
Lp_127:
  buffer_load_dword v7, v5, s[40:43], s91 offen sc0 sc1
  s_waitcnt vmcnt(0)
Lp_128:
  v_cmp_ne_u32 vcc, 0, v7
  s_andn2_b32 s3, 0xffff, vcc_lo
  s_cbranch_scc0 Lp_129
  s_sleep 1
  s_sub_u32 s89, s89, 1
  s_cbranch_scc0 Lp_127
Lp_129:
  s_mov_b64 exec, -1
  s_lshl_b32 s5, s77, 14
  s_add_u32 s5, s5, 589824
  buffer_load_dwordx4 v[192:195], v4, s[40:43], s5 offen offset:0 sc1
  buffer_load_dwordx4 v[196:199], v4, s[40:43], s5 offen offset:1024 sc1
  buffer_load_dwordx4 v[200:203], v4, s[40:43], s5 offen offset:2048 sc1
  buffer_load_dwordx4 v[204:207], v4, s[40:43], s5 offen offset:3072 sc1
  s_add_u32 s5, s5, 4096
  buffer_load_dwordx4 v[208:211], v4, s[40:43], s5 offen offset:0 sc1
  buffer_load_dwordx4 v[212:215], v4, s[40:43], s5 offen offset:1024 sc1
  buffer_load_dwordx4 v[216:219], v4, s[40:43], s5 offen offset:2048 sc1
  buffer_load_dwordx4 v[220:223], v4, s[40:43], s5 offen offset:3072 sc1
L_125:
  s_barrier
  s_cmp_lg_u32 s82, 0
  s_cbranch_scc1 L_130
  s_lshl_b32 s5, s77, 14
  s_add_u32 s5, s5, 598016
  buffer_load_dwordx4 v[224:227], v4, s[40:43], s5 offen offset:0 sc1
  buffer_load_dwordx4 v[228:231], v4, s[40:43], s5 offen offset:1024 sc1
  buffer_load_dwordx4 v[232:235], v4, s[40:43], s5 offen offset:2048 sc1
  buffer_load_dwordx4 v[236:239], v4, s[40:43], s5 offen offset:3072 sc1
  s_add_u32 s5, s5, 4096
  buffer_load_dwordx4 v[240:243], v4, s[40:43], s5 offen offset:0 sc1
  buffer_load_dwordx4 v[244:247], v4, s[40:43], s5 offen offset:1024 sc1
  buffer_load_dwordx4 v[248:251], v4, s[40:43], s5 offen offset:2048 sc1
  buffer_load_dwordx4 v[252:255], v4, s[40:43], s5 offen offset:3072 sc1
L_130:
  s_barrier
  s_cmp_lg_u32 s82, 0
  s_cbranch_scc1 L_132
  s_waitcnt vmcnt(16)
  s_branch L_133
L_132:
  s_waitcnt vmcnt(0)
L_133:
  s_mov_b32 s89, 200000
  s_branch Lp_135
Lp_134:
  s_and_b32 s5, s10, 0xfffffc00
  buffer_load_dwordx4 v[120:123], v4, s[40:43], s5 offen sc1
  s_add_u32 s5, s5, s11
  buffer_load_dwordx4 v[124:127], v12, s[40:43], s5 offen sc1
  s_waitcnt vmcnt(0)
Lp_135:
  v_min_u32 v2, v120, v122
  v_min_u32 v3, v124, v126
  v_or_b32 v3, s90, v3
  v_min_u32 v2, v2, v3
  v_cmp_eq_u32 vcc, 0, v2
  s_cmp_eq_u64 vcc, 0
  s_cbranch_scc1 Lp_136
  s_sleep 1
  s_sub_u32 s89, s89, 1
  s_cbranch_scc0 Lp_134
Lp_136:
  ds_write2_b32 v10, v120, v122 offset0:0 offset1:1
  ds_write2_b32 v10, v121, v123 offset0:160 offset1:161
  ds_write2_b32 v13, v124, v126 offset0:0 offset1:1
  ds_write2_b32 v13, v125, v127 offset0:160 offset1:161
  s_add_u32 s10, s10, 16384
  s_barrier
  s_cmp_lg_u32 s82, 0
  s_cbranch_scc1 L_137
  s_waitcnt vmcnt(0)
  v_add_f32 v192, v192, v224
  v_add_f32 v193, v193, v225
  v_add_f32 v194, v194, v226
  v_add_f32 v195, v195, v227
  v_add_f32 v196, v196, v228
  v_add_f32 v197, v197, v229
  v_add_f32 v198, v198, v230
  v_add_f32 v199, v199, v231
  v_add_f32 v200, v200, v232
  v_add_f32 v201, v201, v233
  v_add_f32 v202, v202, v234
  v_add_f32 v203, v203, v235
  v_add_f32 v204, v204, v236
  v_add_f32 v205, v205, v237
  v_add_f32 v206, v206, v238
  v_add_f32 v207, v207, v239
  v_add_f32 v208, v208, v240
  v_add_f32 v209, v209, v241
  v_add_f32 v210, v210, v242
  v_add_f32 v211, v211, v243
  v_add_f32 v212, v212, v244
  v_add_f32 v213, v213, v245
  v_add_f32 v214, v214, v246
  v_add_f32 v215, v215, v247
  v_add_f32 v216, v216, v248
  v_add_f32 v217, v217, v249
  v_add_f32 v218, v218, v250
  v_add_f32 v219, v219, v251
  v_add_f32 v220, v220, v252
  v_add_f32 v221, v221, v253
  v_add_f32 v222, v222, v254
  v_add_f32 v223, v223, v255
  v_add_f32 v192, v192, v208
  v_add_f32 v193, v193, v209
  v_add_f32 v194, v194, v210
  v_add_f32 v195, v195, v211
  v_add_f32 v196, v196, v212
  v_add_f32 v197, v197, v213
  v_add_f32 v198, v198, v214
  v_add_f32 v199, v199, v215
  v_add_f32 v200, v200, v216
  v_add_f32 v201, v201, v217
  v_add_f32 v202, v202, v218
  v_add_f32 v203, v203, v219
  v_add_f32 v204, v204, v220
  v_add_f32 v205, v205, v221
  v_add_f32 v206, v206, v222
  v_add_f32 v207, v207, v223
  v_add_f32 v192, v192, v200
  v_add_f32 v193, v193, v201
  v_add_f32 v194, v194, v202
  v_add_f32 v195, v195, v203
  v_add_f32 v196, v196, v204
  v_add_f32 v197, v197, v205
  v_add_f32 v198, v198, v206
  v_add_f32 v199, v199, v207
  v_add_f32 v192, v192, v196
  v_add_f32 v193, v193, v197
  v_add_f32 v194, v194, v198
  v_add_f32 v195, v195, v199
  v_add_u32 v2, 153088, v4
  ds_write_b128 v2, v[192:195]
L_137:
  s_cmp_lg_u32 s82, 0
  s_cbranch_scc1 L_139
  buffer_load_dword v109, v110, s[56:59], s12 offen
  s_add_u32 s12, s12, 114688
L_139:
  s_barrier
  s_waitcnt lgkmcnt(0)
  s_cmp_lg_u32 s82, 0
  s_cbranch_scc1 L_141
  buffer_load_dword v109, v110, s[56:59], s12 offen
  s_add_u32 s12, s12, 114688
L_141:
  s_barrier
  s_cmp_lg_u32 s82, 0
  s_cbranch_scc1 L_143
  v_lshrrev_b32 v2, 2, v1
  v_lshlrev_b32 v22, 7, v2
  v_lshlrev_b32 v96, 6, v2
  v_and_b32 v2, 3, v1
  v_lshl_add_u32 v22, v2, 3, v22
  v_lshl_add_u32 v96, v2, 3, v96
  v_add_u32 v22, 65536, v22
  v_add_u32 v96, 90112, v96
  v_bfe_u32 v3, v1, 3, 2
  v_xor_b32 v2, 0, v3
  v_lshl_add_u32 v16, v2, 5, v22
  v_xor_b32 v2, 1, v3
  v_lshl_add_u32 v17, v2, 5, v22
  v_xor_b32 v2, 2, v3
  v_lshl_add_u32 v18, v2, 5, v22
  v_xor_b32 v2, 3, v3
  v_lshl_add_u32 v19, v2, 5, v22
  v_bfe_u32 v3, v1, 4, 1
  v_xor_b32 v2, 0, v3
  v_lshl_add_u32 v20, v2, 5, v96
  v_xor_b32 v2, 1, v3
  v_lshl_add_u32 v21, v2, 5, v96
  v_mov_b32 v22, 0x3f803f80
  s_mov_b32 s98, 0x00010001
  s_mov_b32 s99, 0x00010001
  v_cndmask_b32_e64 v200, 0, v22, s[98:99]
  v_cndmask_b32_e64 v201, 0, v22, s[98:99]
  v_cndmask_b32_e64 v202, 0, v22, s[98:99]
  v_cndmask_b32_e64 v203, 0, v22, s[98:99]
  s_lshl_b64 s[98:99], s[98:99], 1
  v_cndmask_b32_e64 v204, 0, v22, s[98:99]
  v_cndmask_b32_e64 v205, 0, v22, s[98:99]
  v_cndmask_b32_e64 v206, 0, v22, s[98:99]
  v_cndmask_b32_e64 v207, 0, v22, s[98:99]
  s_lshl_b64 s[98:99], s[98:99], 1
  v_cndmask_b32_e64 v208, 0, v22, s[98:99]
  v_cndmask_b32_e64 v209, 0, v22, s[98:99]
  v_cndmask_b32_e64 v210, 0, v22, s[98:99]
  v_cndmask_b32_e64 v211, 0, v22, s[98:99]
  s_lshl_b64 s[98:99], s[98:99], 1
  v_cndmask_b32_e64 v212, 0, v22, s[98:99]
  v_cndmask_b32_e64 v213, 0, v22, s[98:99]
  v_cndmask_b32_e64 v214, 0, v22, s[98:99]
  v_cndmask_b32_e64 v215, 0, v22, s[98:99]
  s_lshl_b64 s[98:99], s[98:99], 1
  v_cndmask_b32_e64 v216, 0, v22, s[98:99]
  v_cndmask_b32_e64 v217, 0, v22, s[98:99]
  v_cndmask_b32_e64 v218, 0, v22, s[98:99]
  v_cndmask_b32_e64 v219, 0, v22, s[98:99]
  s_lshl_b64 s[98:99], s[98:99], 1
  v_cndmask_b32_e64 v220, 0, v22, s[98:99]
  v_cndmask_b32_e64 v221, 0, v22, s[98:99]
  v_cndmask_b32_e64 v222, 0, v22, s[98:99]
  v_cndmask_b32_e64 v223, 0, v22, s[98:99]
  s_lshl_b64 s[98:99], s[98:99], 1
  v_cndmask_b32_e64 v224, 0, v22, s[98:99]
  v_cndmask_b32_e64 v225, 0, v22, s[98:99]
  v_cndmask_b32_e64 v226, 0, v22, s[98:99]
  v_cndmask_b32_e64 v227, 0, v22, s[98:99]
  s_lshl_b64 s[98:99], s[98:99], 1
  v_cndmask_b32_e64 v228, 0, v22, s[98:99]
  v_cndmask_b32_e64 v229, 0, v22, s[98:99]
  v_cndmask_b32_e64 v230, 0, v22, s[98:99]
  v_cndmask_b32_e64 v231, 0, v22, s[98:99]
  s_lshl_b64 s[98:99], s[98:99], 1
  v_cndmask_b32_e64 v232, 0, v22, s[98:99]
  v_cndmask_b32_e64 v233, 0, v22, s[98:99]
  v_cndmask_b32_e64 v234, 0, v22, s[98:99]
  v_cndmask_b32_e64 v235, 0, v22, s[98:99]
  s_lshl_b64 s[98:99], s[98:99], 1
  v_cndmask_b32_e64 v236, 0, v22, s[98:99]
  v_cndmask_b32_e64 v237, 0, v22, s[98:99]
  v_cndmask_b32_e64 v238, 0, v22, s[98:99]
  v_cndmask_b32_e64 v239, 0, v22, s[98:99]
  s_lshl_b64 s[98:99], s[98:99], 1
  v_cndmask_b32_e64 v240, 0, v22, s[98:99]
  v_cndmask_b32_e64 v241, 0, v22, s[98:99]
  v_cndmask_b32_e64 v242, 0, v22, s[98:99]
  v_cndmask_b32_e64 v243, 0, v22, s[98:99]
  s_lshl_b64 s[98:99], s[98:99], 1
  v_cndmask_b32_e64 v244, 0, v22, s[98:99]
  v_cndmask_b32_e64 v245, 0, v22, s[98:99]
  v_cndmask_b32_e64 v246, 0, v22, s[98:99]
  v_cndmask_b32_e64 v247, 0, v22, s[98:99]
  s_lshl_b64 s[98:99], s[98:99], 1
  v_cndmask_b32_e64 v248, 0, v22, s[98:99]
  v_cndmask_b32_e64 v249, 0, v22, s[98:99]
  v_cndmask_b32_e64 v250, 0, v22, s[98:99]
  v_cndmask_b32_e64 v251, 0, v22, s[98:99]
  s_lshl_b64 s[98:99], s[98:99], 1
  v_cndmask_b32_e64 v252, 0, v22, s[98:99]
  v_cndmask_b32_e64 v253, 0, v22, s[98:99]
  v_cndmask_b32_e64 v254, 0, v22, s[98:99]
  v_cndmask_b32_e64 v255, 0, v22, s[98:99]
  s_lshl_b64 s[98:99], s[98:99], 1
L_143:
  s_lshl_b32 s91, s84, 1
  s_add_u32 s91, s91, s87
  s_barrier
  s_mov_b32 exec_lo, 0xffff
  s_mov_b32 exec_hi, 0
  buffer_load_dword v7, v5, s[40:43], s91 offen sc0 sc1
  s_mov_b64 exec, -1
  s_barrier
  s_barrier
  s_barrier
  s_waitcnt vmcnt(0)
  s_mov_b32 s89, 200000
  s_mov_b32 exec_lo, 0xffff
  s_mov_b32 exec_hi, 0
  s_branch Lp_146
Lp_145:
  buffer_load_dword v7, v5, s[40:43], s91 offen sc0 sc1
  s_waitcnt vmcnt(0)
Lp_146:
  v_cmp_ne_u32 vcc, 0, v7
  s_andn2_b32 s3, 0xffff, vcc_lo
  s_cbranch_scc0 Lp_147
  s_sleep 1
  s_sub_u32 s89, s89, 1
  s_cbranch_scc0 Lp_145
Lp_147:
  s_mov_b64 exec, -1
  s_barrier
  s_barrier
  s_barrier
  s_barrier
  s_barrier
  s_barrier
  s_barrier
  s_barrier
  s_barrier
  s_barrier
  s_barrier
  s_barrier
  s_barrier
  s_add_u32 s92, s83, 31457280
  s_add_u32 s91, s91, 4
  s_sub_u32 s16, s78, s76
  s_and_b32 s16, s16, 15
  s_barrier
  s_cmp_lg_u32 s82, 0
  s_cbranch_scc1 L_148
  s_cmp_lg_u32 s16, 1
  s_cbranch_scc1 L_150
  v_add_u32 v112, 0, v16
  v_add_u32 v113, 0, v17
  v_add_u32 v114, 0, v18
  v_add_u32 v115, 0, v19
  ds_read_b64_tr_b16 v[32:33], v112 offset:0
  ds_read_b64_tr_b16 v[34:35], v112 offset:2048
  ds_read_b64_tr_b16 v[36:37], v113 offset:0
  ds_read_b64_tr_b16 v[38:39], v113 offset:2048
  ds_read_b64_tr_b16 v[40:41], v114 offset:0
  ds_read_b64_tr_b16 v[42:43], v114 offset:2048
  ds_read_b64_tr_b16 v[44:45], v115 offset:0
  ds_read_b64_tr_b16 v[46:47], v115 offset:2048
  ds_read_b64_tr_b16 v[48:49], v112 offset:4096
  ds_read_b64_tr_b16 v[50:51], v112 offset:6144
  ds_read_b64_tr_b16 v[52:53], v113 offset:4096
  ds_read_b64_tr_b16 v[54:55], v113 offset:6144
  s_waitcnt lgkmcnt(4)
  ds_read_b64_tr_b16 v[56:57], v114 offset:4096
  ds_read_b64_tr_b16 v[58:59], v114 offset:6144
  ds_read_b64_tr_b16 v[60:61], v115 offset:4096
  ds_read_b64_tr_b16 v[62:63], v115 offset:6144
L_150:
  s_cmp_lg_u32 s16, 2
  s_cbranch_scc1 L_151
  v_add_u32 v112, 8192, v16
  v_add_u32 v113, 8192, v17
  v_add_u32 v114, 8192, v18
  v_add_u32 v115, 8192, v19
  ds_read_b64_tr_b16 v[64:65], v112 offset:0
  ds_read_b64_tr_b16 v[66:67], v112 offset:2048
  ds_read_b64_tr_b16 v[68:69], v113 offset:0
  ds_read_b64_tr_b16 v[70:71], v113 offset:2048
  ds_read_b64_tr_b16 v[72:73], v114 offset:0
  ds_read_b64_tr_b16 v[74:75], v114 offset:2048
  ds_read_b64_tr_b16 v[76:77], v115 offset:0
  ds_read_b64_tr_b16 v[78:79], v115 offset:2048
  ds_read_b64_tr_b16 v[80:81], v112 offset:4096
  ds_read_b64_tr_b16 v[82:83], v112 offset:6144
  ds_read_b64_tr_b16 v[84:85], v113 offset:4096
  ds_read_b64_tr_b16 v[86:87], v113 offset:6144
  s_waitcnt lgkmcnt(4)
  ds_read_b64_tr_b16 v[88:89], v114 offset:4096
  ds_read_b64_tr_b16 v[90:91], v114 offset:6144
  ds_read_b64_tr_b16 v[92:93], v115 offset:4096
  ds_read_b64_tr_b16 v[94:95], v115 offset:6144
L_151:
  s_cmp_lg_u32 s16, 3
  s_cbranch_scc1 L_152
  v_add_u32 v112, 16384, v16
  v_add_u32 v113, 16384, v17
  v_add_u32 v114, 16384, v18
  v_add_u32 v115, 16384, v19
  ds_read_b64_tr_b16 v[128:129], v112 offset:0
  ds_read_b64_tr_b16 v[130:131], v112 offset:2048
  ds_read_b64_tr_b16 v[132:133], v113 offset:0
  ds_read_b64_tr_b16 v[134:135], v113 offset:2048
  ds_read_b64_tr_b16 v[136:137], v114 offset:0
  ds_read_b64_tr_b16 v[138:139], v114 offset:2048
  ds_read_b64_tr_b16 v[140:141], v115 offset:0
  ds_read_b64_tr_b16 v[142:143], v115 offset:2048
  ds_read_b64_tr_b16 v[144:145], v112 offset:4096
  ds_read_b64_tr_b16 v[146:147], v112 offset:6144
  ds_read_b64_tr_b16 v[148:149], v113 offset:4096
  ds_read_b64_tr_b16 v[150:151], v113 offset:6144
  s_waitcnt lgkmcnt(4)
  ds_read_b64_tr_b16 v[152:153], v114 offset:4096
  ds_read_b64_tr_b16 v[154:155], v114 offset:6144
  ds_read_b64_tr_b16 v[156:157], v115 offset:4096
  ds_read_b64_tr_b16 v[158:159], v115 offset:6144
L_152:
  s_cmp_lg_u32 s16, 4
  s_cbranch_scc1 L_153
  v_add_u32 v112, 0, v20
  v_add_u32 v113, 0, v21
  ds_read_b64_tr_b16 v[160:161], v112 offset:0
  ds_read_b64_tr_b16 v[162:163], v112 offset:1024
  ds_read_b64_tr_b16 v[164:165], v113 offset:0
  ds_read_b64_tr_b16 v[166:167], v113 offset:1024
  ds_read_b64_tr_b16 v[176:177], v112 offset:2048
  ds_read_b64_tr_b16 v[178:179], v112 offset:3072
  ds_read_b64_tr_b16 v[180:181], v113 offset:2048
  ds_read_b64_tr_b16 v[182:183], v113 offset:3072
L_153:
  s_waitcnt lgkmcnt(0)
L_148:
  s_barrier
  s_mov_b32 exec_lo, 0xffff
  s_mov_b32 exec_hi, 0
  buffer_load_dword v7, v5, s[40:43], s91 offen sc0 sc1
  s_mov_b64 exec, -1
  s_cmp_lg_u32 s82, 0
  s_cbranch_scc1 L_154
  s_cmp_eq_u32 s16, 1
  s_cbranch_scc1 L_156
  v_add_u32 v112, 28672, v16
  v_add_u32 v113, 28672, v17
  v_add_u32 v114, 28672, v18
  v_add_u32 v115, 28672, v19
  ds_read_b64_tr_b16 v[32:33], v112 offset:0
  ds_read_b64_tr_b16 v[34:35], v112 offset:2048
  ds_read_b64_tr_b16 v[36:37], v113 offset:0
  ds_read_b64_tr_b16 v[38:39], v113 offset:2048
  ds_read_b64_tr_b16 v[40:41], v114 offset:0
  ds_read_b64_tr_b16 v[42:43], v114 offset:2048
  ds_read_b64_tr_b16 v[44:45], v115 offset:0
  ds_read_b64_tr_b16 v[46:47], v115 offset:2048
  ds_read_b64_tr_b16 v[48:49], v112 offset:4096
  ds_read_b64_tr_b16 v[50:51], v112 offset:6144
  ds_read_b64_tr_b16 v[52:53], v113 offset:4096
  ds_read_b64_tr_b16 v[54:55], v113 offset:6144
  s_waitcnt lgkmcnt(4)
  ds_read_b64_tr_b16 v[56:57], v114 offset:4096
  ds_read_b64_tr_b16 v[58:59], v114 offset:6144
  ds_read_b64_tr_b16 v[60:61], v115 offset:4096
  ds_read_b64_tr_b16 v[62:63], v115 offset:6144
L_156:
  s_waitcnt lgkmcnt(0)
L_154:
  s_barrier
  s_cmp_lg_u32 s82, 0
  s_cbranch_scc1 L_157
  s_cmp_eq_u32 s16, 2
  s_cbranch_scc1 L_159
  v_add_u32 v112, 65536, v16
  v_add_u32 v113, 65536, v17
  v_add_u32 v114, 65536, v18
  v_add_u32 v115, 65536, v19
  ds_read_b64_tr_b16 v[64:65], v112 offset:0
  ds_read_b64_tr_b16 v[66:67], v112 offset:2048
  ds_read_b64_tr_b16 v[68:69], v113 offset:0
  ds_read_b64_tr_b16 v[70:71], v113 offset:2048
  ds_read_b64_tr_b16 v[72:73], v114 offset:0
  ds_read_b64_tr_b16 v[74:75], v114 offset:2048
  ds_read_b64_tr_b16 v[76:77], v115 offset:0
  ds_read_b64_tr_b16 v[78:79], v115 offset:2048
  ds_read_b64_tr_b16 v[80:81], v112 offset:4096
  ds_read_b64_tr_b16 v[82:83], v112 offset:6144
  ds_read_b64_tr_b16 v[84:85], v113 offset:4096
  ds_read_b64_tr_b16 v[86:87], v113 offset:6144
  s_waitcnt lgkmcnt(4)
  ds_read_b64_tr_b16 v[88:89], v114 offset:4096
  ds_read_b64_tr_b16 v[90:91], v114 offset:6144
  ds_read_b64_tr_b16 v[92:93], v115 offset:4096
  ds_read_b64_tr_b16 v[94:95], v115 offset:6144
L_159:
  v_mfma_f32_16x16x32_bf16 v[28:31], v[32:35], v[200:203], 0
  v_mfma_f32_16x16x32_bf16 v[28:31], v[36:39], v[204:207], v[28:31]
  v_mfma_f32_16x16x32_bf16 v[28:31], v[40:43], v[208:211], v[28:31]
  v_mfma_f32_16x16x32_bf16 v[28:31], v[44:47], v[212:215], v[28:31]
  v_mfma_f32_16x16x32_bf16 v[28:31], v[48:51], v[200:203], v[28:31]
  v_mfma_f32_16x16x32_bf16 v[28:31], v[52:55], v[204:207], v[28:31]
  v_mfma_f32_16x16x32_bf16 v[28:31], v[56:59], v[208:211], v[28:31]
  v_mfma_f32_16x16x32_bf16 v[28:31], v[60:63], v[212:215], v[28:31]
L_157:
  s_waitcnt vmcnt(0)
  s_mov_b32 s89, 200000
  s_mov_b32 exec_lo, 0xffff
  s_mov_b32 exec_hi, 0
  s_branch Lp_161
Lp_160:
  buffer_load_dword v7, v5, s[40:43], s91 offen sc0 sc1
  s_waitcnt vmcnt(0)
Lp_161:
  v_cmp_ne_u32 vcc, 0, v7
  s_andn2_b32 s3, 0xffff, vcc_lo
  s_cbranch_scc0 Lp_162
  s_sleep 1
  s_sub_u32 s89, s89, 1
  s_cbranch_scc0 Lp_160
Lp_162:
  s_mov_b64 exec, -1
  s_add_u32 s5, s84, s92
  buffer_load_dwordx2 v[96:97], v6, s[40:43], s5 offen offset:0 sc1
  buffer_load_dwordx2 v[98:99], v6, s[40:43], s5 offen offset:512 sc1
  buffer_load_dwordx2 v[100:101], v6, s[40:43], s5 offen offset:1024 sc1
  buffer_load_dwordx2 v[102:103], v6, s[40:43], s5 offen offset:1536 sc1
  s_waitcnt lgkmcnt(0)
  s_cmp_lg_u32 s82, 0
  s_cbranch_scc1 L_163
  buffer_load_dword v109, v111, s[60:63], s13 offen
  s_add_u32 s13, s13, 57344
  buffer_load_dword v109, v111, s[60:63], s13 offen
  s_add_u32 s13, s13, 57344
L_163:
  s_barrier
  s_cmp_lg_u32 s82, 0
  s_cbranch_scc1 L_165
  s_cmp_eq_u32 s16, 3
  s_cbranch_scc1 L_167
  v_add_u32 v112, 16384, v16
  v_add_u32 v113, 16384, v17
  v_add_u32 v114, 16384, v18
  v_add_u32 v115, 16384, v19
  ds_read_b64_tr_b16 v[128:129], v112 offset:0
  ds_read_b64_tr_b16 v[130:131], v112 offset:2048
  ds_read_b64_tr_b16 v[132:133], v113 offset:0
  ds_read_b64_tr_b16 v[134:135], v113 offset:2048
  ds_read_b64_tr_b16 v[136:137], v114 offset:0
  ds_read_b64_tr_b16 v[138:139], v114 offset:2048
  ds_read_b64_tr_b16 v[140:141], v115 offset:0
  ds_read_b64_tr_b16 v[142:143], v115 offset:2048
  ds_read_b64_tr_b16 v[144:145], v112 offset:4096
  ds_read_b64_tr_b16 v[146:147], v112 offset:6144
  ds_read_b64_tr_b16 v[148:149], v113 offset:4096
  ds_read_b64_tr_b16 v[150:151], v113 offset:6144
  s_waitcnt lgkmcnt(4)
  ds_read_b64_tr_b16 v[152:153], v114 offset:4096
  ds_read_b64_tr_b16 v[154:155], v114 offset:6144
  ds_read_b64_tr_b16 v[156:157], v115 offset:4096
  ds_read_b64_tr_b16 v[158:159], v115 offset:6144
L_167:
  v_mfma_f32_16x16x32_bf16 v[28:31], v[64:67], v[216:219], v[28:31]
  v_mfma_f32_16x16x32_bf16 v[28:31], v[68:71], v[220:223], v[28:31]
  v_mfma_f32_16x16x32_bf16 v[28:31], v[72:75], v[224:227], v[28:31]
  v_mfma_f32_16x16x32_bf16 v[28:31], v[76:79], v[228:231], v[28:31]
  v_mfma_f32_16x16x32_bf16 v[28:31], v[80:83], v[216:219], v[28:31]
  v_mfma_f32_16x16x32_bf16 v[28:31], v[84:87], v[220:223], v[28:31]
  v_mfma_f32_16x16x32_bf16 v[28:31], v[88:91], v[224:227], v[28:31]
  v_mfma_f32_16x16x32_bf16 v[28:31], v[92:95], v[228:231], v[28:31]
  s_waitcnt lgkmcnt(0)
L_165:
  s_barrier
  s_cmp_lg_u32 s82, 0
  s_cbranch_scc1 L_168
  s_cmp_eq_u32 s16, 4
  s_cbranch_scc1 L_170
  v_add_u32 v112, 28672, v20
  v_add_u32 v113, 28672, v21
  ds_read_b64_tr_b16 v[160:161], v112 offset:0
  ds_read_b64_tr_b16 v[162:163], v112 offset:1024
  ds_read_b64_tr_b16 v[164:165], v113 offset:0
  ds_read_b64_tr_b16 v[166:167], v113 offset:1024
  ds_read_b64_tr_b16 v[176:177], v112 offset:2048
  ds_read_b64_tr_b16 v[178:179], v112 offset:3072
  ds_read_b64_tr_b16 v[180:181], v113 offset:2048
  ds_read_b64_tr_b16 v[182:183], v113 offset:3072
L_170:
  v_mfma_f32_16x16x32_bf16 v[28:31], v[128:131], v[232:235], v[28:31]
  v_mfma_f32_16x16x32_bf16 v[28:31], v[132:135], v[236:239], v[28:31]
  v_mfma_f32_16x16x32_bf16 v[28:31], v[136:139], v[240:243], v[28:31]
  v_mfma_f32_16x16x32_bf16 v[28:31], v[140:143], v[244:247], v[28:31]
  v_mfma_f32_16x16x32_bf16 v[28:31], v[144:147], v[232:235], v[28:31]
  v_mfma_f32_16x16x32_bf16 v[28:31], v[148:151], v[236:239], v[28:31]
  v_mfma_f32_16x16x32_bf16 v[28:31], v[152:155], v[240:243], v[28:31]
  v_mfma_f32_16x16x32_bf16 v[28:31], v[156:159], v[244:247], v[28:31]
  s_waitcnt lgkmcnt(0)
L_168:
  s_barrier
  s_cmp_lg_u32 s82, 0
  s_cbranch_scc1 L_171
  s_waitcnt vmcnt(2)
  s_branch L_172
L_171:
  s_waitcnt vmcnt(0)
L_172:
  v_add_f32 v96, v96, v100
  v_add_f32 v97, v97, v101
  v_add_f32 v98, v98, v102
  v_add_f32 v99, v99, v103
  v_add_f32 v96, v96, v98
  v_add_f32 v97, v97, v99
  s_nop 0
  v_add_f32_dpp v96, v96, v96 row_ror:8 row_mask:0xf bank_mask:0xf
  v_add_f32_dpp v97, v97, v97 row_ror:8 row_mask:0xf bank_mask:0xf
  v_mov_b32 v98, v96
  v_mov_b32 v99, v97
  s_nop 0
  v_permlane16_swap_b32 v96, v98
  v_permlane16_swap_b32 v97, v99
  v_add_f32 v96, v96, v98
  v_add_f32 v97, v97, v99
  v_mov_b32 v98, v96
  v_mov_b32 v99, v97
  s_nop 0
  v_permlane32_swap_b32 v96, v98
  v_permlane32_swap_b32 v97, v99
  v_add_f32 v96, v96, v98
  v_add_f32 v97, v97, v99
  v_mul_f32 v96, 0x3a800000, v96
  v_mul_f32 v97, 0x3a800000, v97
  v_fma_f32 v98, -v96, v96, v97
  v_max_f32 v98, 0, v98
  v_add_f32 v98, 0x3727c5ac, v98
  v_rsq_f32 v98, v98
  s_nop 0
  v_mul_f32 v99, v96, v98
  s_mov_b64 exec, s[8:9]
  buffer_store_dwordx2 v[98:99], v6, s[40:43], s10 offen sc0 sc1
  s_mov_b64 exec, -1
  s_cmp_lg_u32 s82, 0
  s_cbranch_scc1 L_173
  v_mfma_f32_16x16x32_bf16 v[28:31], v[160:163], v[248:251], v[28:31]
  v_mfma_f32_16x16x32_bf16 v[28:31], v[164:167], v[252:255], v[28:31]
  v_mfma_f32_16x16x32_bf16 v[28:31], v[176:179], v[248:251], v[28:31]
  v_mfma_f32_16x16x32_bf16 v[28:31], v[180:183], v[252:255], v[28:31]
  s_lshl_b32 s5, s77, 14
  s_lshl_b32 s4, s76, 10
  s_add_u32 s5, s5, s4
  s_add_u32 s5, s5, 1114112
  s_nop 3
  buffer_store_dwordx4 v[28:31], v15, s[40:43], s5 offen sc0 sc1
L_173:
  s_barrier
  s_barrier
  s_barrier
  s_cmp_lg_u32 s82, 0
  s_cbranch_scc1 L_175
  s_waitcnt vmcnt(0)
  s_mov_b32 s5, 1835012
  s_mov_b64 exec, 0xffff
  buffer_store_dword v11, v14, s[40:43], s5 offen sc0 sc1
  s_mov_b64 exec, -1
L_175:
  s_barrier
  s_barrier
  s_cmp_lg_u32 s82, 0
  s_cbranch_scc1 L_177
  s_lshl_b32 s91, s84, 1
  s_add_u32 s91, s91, 1835012
  s_mov_b32 exec_lo, 0xffff
  s_mov_b32 exec_hi, 0
  buffer_load_dword v7, v5, s[40:43], s91 offen sc0 sc1
  s_mov_b64 exec, -1
L_177:
  s_and_b32 s5, s10, 0xfffffc00
  buffer_load_dwordx4 v[120:123], v4, s[40:43], s5 offen sc1
  s_barrier
  s_barrier
  s_waitcnt vmcnt(0)
  s_mov_b32 s89, 200000
  s_branch Lp_180
Lp_179:
  s_and_b32 s5, s10, 0xfffffc00
  buffer_load_dwordx4 v[120:123], v4, s[40:43], s5 offen sc1
  s_waitcnt vmcnt(0)
Lp_180:
  v_min_u32 v2, v120, v122
  v_cmp_eq_u32 vcc, 0, v2
  s_cmp_eq_u64 vcc, 0
  s_cbranch_scc1 Lp_181
  s_sleep 1
  s_sub_u32 s89, s89, 1
  s_cbranch_scc0 Lp_179
Lp_181:
  ds_write2_b32 v10, v120, v122 offset0:0 offset1:1
  ds_write2_b32 v10, v121, v123 offset0:160 offset1:161
  s_add_u32 s10, s10, 16384
  s_cmp_lg_u32 s82, 0
  s_cbranch_scc1 L_182
  s_mov_b32 s89, 200000
  s_mov_b32 exec_lo, 0xffff
  s_mov_b32 exec_hi, 0
  s_branch Lp_185
Lp_184:
  buffer_load_dword v7, v5, s[40:43], s91 offen sc0 sc1
  s_waitcnt vmcnt(0)
Lp_185:
  v_cmp_ne_u32 vcc, 0, v7
  s_andn2_b32 s3, 0xffff, vcc_lo
  s_cbranch_scc0 Lp_186
  s_sleep 1
  s_sub_u32 s89, s89, 1
  s_cbranch_scc0 Lp_184
Lp_186:
  s_mov_b64 exec, -1
  s_lshl_b32 s5, s77, 14
  s_add_u32 s5, s5, 1114112
  buffer_load_dwordx4 v[192:195], v4, s[40:43], s5 offen offset:0 sc1
  buffer_load_dwordx4 v[196:199], v4, s[40:43], s5 offen offset:1024 sc1
  buffer_load_dwordx4 v[200:203], v4, s[40:43], s5 offen offset:2048 sc1
  buffer_load_dwordx4 v[204:207], v4, s[40:43], s5 offen offset:3072 sc1
  s_add_u32 s5, s5, 4096
  buffer_load_dwordx4 v[208:211], v4, s[40:43], s5 offen offset:0 sc1
  buffer_load_dwordx4 v[212:215], v4, s[40:43], s5 offen offset:1024 sc1
  buffer_load_dwordx4 v[216:219], v4, s[40:43], s5 offen offset:2048 sc1
  buffer_load_dwordx4 v[220:223], v4, s[40:43], s5 offen offset:3072 sc1
L_182:
  s_barrier
  s_cmp_lg_u32 s82, 0
  s_cbranch_scc1 L_187
  s_lshl_b32 s5, s77, 14
  s_add_u32 s5, s5, 1122304
  buffer_load_dwordx4 v[224:227], v4, s[40:43], s5 offen offset:0 sc1
  buffer_load_dwordx4 v[228:231], v4, s[40:43], s5 offen offset:1024 sc1
  buffer_load_dwordx4 v[232:235], v4, s[40:43], s5 offen offset:2048 sc1
  buffer_load_dwordx4 v[236:239], v4, s[40:43], s5 offen offset:3072 sc1
  s_add_u32 s5, s5, 4096
  buffer_load_dwordx4 v[240:243], v4, s[40:43], s5 offen offset:0 sc1
  buffer_load_dwordx4 v[244:247], v4, s[40:43], s5 offen offset:1024 sc1
  buffer_load_dwordx4 v[248:251], v4, s[40:43], s5 offen offset:2048 sc1
  buffer_load_dwordx4 v[252:255], v4, s[40:43], s5 offen offset:3072 sc1
L_187:
  s_barrier
  s_cmp_lg_u32 s82, 0
  s_cbranch_scc1 L_189
  buffer_load_dword v109, v111, s[60:63], s13 offen
  s_add_u32 s13, s13, 57344
  buffer_load_dword v109, v111, s[60:63], s13 offen
  s_add_u32 s13, s13, 57344
L_189:
  s_barrier
  s_cmp_lg_u32 s82, 0
  s_cbranch_scc1 L_191
  s_cmp_lg_u32 s82, 0
  s_cbranch_scc1 L_193
  s_waitcnt vmcnt(2)
  s_branch L_194
L_193:
  s_waitcnt vmcnt(0)
L_194:
  v_add_f32 v192, v192, v224
  v_add_f32 v193, v193, v225
  v_add_f32 v194, v194, v226
  v_add_f32 v195, v195, v227
  v_add_f32 v196, v196, v228
  v_add_f32 v197, v197, v229
  v_add_f32 v198, v198, v230
  v_add_f32 v199, v199, v231
  v_add_f32 v200, v200, v232
  v_add_f32 v201, v201, v233
  v_add_f32 v202, v202, v234
  v_add_f32 v203, v203, v235
  v_add_f32 v204, v204, v236
  v_add_f32 v205, v205, v237
  v_add_f32 v206, v206, v238
  v_add_f32 v207, v207, v239
  v_add_f32 v208, v208, v240
  v_add_f32 v209, v209, v241
  v_add_f32 v210, v210, v242
  v_add_f32 v211, v211, v243
  v_add_f32 v212, v212, v244
  v_add_f32 v213, v213, v245
  v_add_f32 v214, v214, v246
  v_add_f32 v215, v215, v247
  v_add_f32 v216, v216, v248
  v_add_f32 v217, v217, v249
  v_add_f32 v218, v218, v250
  v_add_f32 v219, v219, v251
  v_add_f32 v220, v220, v252
  v_add_f32 v221, v221, v253
  v_add_f32 v222, v222, v254
  v_add_f32 v223, v223, v255
  v_add_f32 v192, v192, v208
  v_add_f32 v193, v193, v209
  v_add_f32 v194, v194, v210
  v_add_f32 v195, v195, v211
  v_add_f32 v196, v196, v212
  v_add_f32 v197, v197, v213
  v_add_f32 v198, v198, v214
  v_add_f32 v199, v199, v215
  v_add_f32 v200, v200, v216
  v_add_f32 v201, v201, v217
  v_add_f32 v202, v202, v218
  v_add_f32 v203, v203, v219
  v_add_f32 v204, v204, v220
  v_add_f32 v205, v205, v221
  v_add_f32 v206, v206, v222
  v_add_f32 v207, v207, v223
  v_add_f32 v192, v192, v200
  v_add_f32 v193, v193, v201
  v_add_f32 v194, v194, v202
  v_add_f32 v195, v195, v203
  v_add_f32 v196, v196, v204
  v_add_f32 v197, v197, v205
  v_add_f32 v198, v198, v206
  v_add_f32 v199, v199, v207
  v_add_f32 v192, v192, v196
  v_add_f32 v193, v193, v197
  v_add_f32 v194, v194, v198
  v_add_f32 v195, v195, v199
  v_add_u32 v2, 154112, v4
  ds_write_b128 v2, v[192:195]
L_191:
  s_waitcnt lgkmcnt(0)
  s_barrier
  v_lshlrev_b32 v2, 12, v1
  s_lshl_b32 s4, s76, 16
  s_lshl_b32 s5, s77, 7
  s_add_u32 s4, s4, s5
  s_add_u32 s4, s4, s87
  s_add_u32 s5, s4, 24
  s_lshl_b32 s4, s79, 3
  s_lshl_b32 s90, 0xff, s4
  s_lshl_b32 s91, s84, 1
  s_add_u32 s91, s91, s87
  s_add_u32 s91, s91, 24
  s_barrier
  s_barrier
  s_barrier
  s_mov_b32 exec_lo, 0xffff
  s_mov_b32 exec_hi, 0
  buffer_store_dword v11, v2, s[40:43], s5 offen sc0 sc1
  s_mov_b64 exec, -1
  s_barrier
  s_barrier
  s_barrier
  s_mov_b32 exec_lo, s90
  s_mov_b32 exec_hi, 0
  buffer_load_dword v7, v5, s[40:43], s91 offen sc0 sc1
  s_mov_b64 exec, -1
  s_barrier
  s_waitcnt vmcnt(0)
  s_mov_b32 s89, 200000
  s_mov_b32 exec_lo, s90
  s_mov_b32 exec_hi, 0
  s_branch Lp_196
Lp_195:
  buffer_load_dword v7, v5, s[40:43], s91 offen sc0 sc1
  s_waitcnt vmcnt(0)
Lp_196:
  v_cmp_ne_u32 vcc, 0, v7
  s_andn2_b32 s3, s90, vcc_lo
  s_cbranch_scc0 Lp_197
  s_sleep 1
  s_sub_u32 s89, s89, 1
  s_cbranch_scc0 Lp_195
Lp_197:
  s_mov_b64 exec, -1
  s_xor_b32 s90, s90, 0xffff
  s_barrier
  s_barrier
  s_barrier
  s_barrier
  s_barrier
  s_barrier
  s_barrier
  s_barrier
  s_barrier
  s_barrier
  s_mov_b32 exec_lo, s90
  s_mov_b32 exec_hi, 0
  buffer_load_dword v7, v5, s[40:43], s91 offen sc0 sc1
  s_mov_b64 exec, -1
  s_barrier
  s_barrier
  s_barrier
  s_waitcnt vmcnt(0)
  s_mov_b32 s89, 200000
  s_mov_b32 exec_lo, s90
  s_mov_b32 exec_hi, 0
  s_branch Lp_199
Lp_198:
  buffer_load_dword v7, v5, s[40:43], s91 offen sc0 sc1
  s_waitcnt vmcnt(0)
Lp_199:
  v_cmp_ne_u32 vcc, 0, v7
  s_andn2_b32 s3, s90, vcc_lo
  s_cbranch_scc0 Lp_200
  s_sleep 1
  s_sub_u32 s89, s89, 1
  s_cbranch_scc0 Lp_198
Lp_200:
  s_mov_b64 exec, -1
  s_sub_u32 s91, s91, 12
  s_xor_b32 s5, s84, 16384
  s_lshl_b32 s5, s5, 1
  s_add_u32 s5, s5, s87
  s_add_u32 s5, s5, 12
  s_barrier
  s_barrier
  s_barrier
  s_barrier
  s_barrier
  s_barrier
  s_barrier
  s_barrier
  s_mov_b64 exec, 1
  buffer_store_dword v11, v5, s[40:43], s5 offen sc0 sc1
  s_mov_b64 exec, -1
  s_barrier
  s_barrier
  s_mov_b32 exec_lo, 1
  s_mov_b32 exec_hi, 0
  buffer_load_dword v7, v5, s[40:43], s91 offen sc0 sc1
  s_mov_b64 exec, -1
  s_barrier
  s_waitcnt vmcnt(0)
  s_mov_b32 s89, 200000
  s_mov_b32 exec_lo, 1
  s_mov_b32 exec_hi, 0
  s_branch Lp_202
Lp_201:
  buffer_load_dword v7, v5, s[40:43], s91 offen sc0 sc1
  s_waitcnt vmcnt(0)
Lp_202:
  v_cmp_ne_u32 vcc, 0, v7
  s_andn2_b32 s3, 1, vcc_lo
  s_cbranch_scc0 Lp_203
  s_sleep 1
  s_sub_u32 s89, s89, 1
  s_cbranch_scc0 Lp_201
Lp_203:
  s_mov_b64 exec, -1
  s_barrier
  s_barrier
  s_cmp_lg_u32 s82, 0
  s_cbranch_scc1 L_lend
  s_add_u32 s92, s83, 36700160
  s_mov_b32 s82, 1
  s_mov_b32 s14, 0
  s_add_u32 s83, s83, 0
  s_add_u32 s87, s87, 32
  s_branch L_slayer
L_lend:
L_end:
  s_endpgm
.section .rodata,"a"
.p2align 6
.amdhsa_kernel mega_kernel
  .amdhsa_next_free_vgpr 256
  .amdhsa_next_free_sgpr 102
  .amdhsa_accum_offset 256
  .amdhsa_group_segment_fixed_size 0
  .amdhsa_kernarg_size 88
  .amdhsa_user_sgpr_count 2
  .amdhsa_user_sgpr_kernarg_segment_ptr 1
  .amdhsa_system_sgpr_workgroup_id_x 1
  .amdhsa_float_denorm_mode_32 3
  .amdhsa_float_denorm_mode_16_64 3
.end_amdhsa_kernel
.text
```

```asm
; @launch kernel=mega_kernel grid=(256,1,1) block=(512,1,1) lds=156672
.amdgcn_target "amdgcn-amd-amdhsa--gfx950"
.text
.globl mega_kernel
.p2align 8
.type mega_kernel,@function
mega_kernel:
  s_cmp_ge_u32 s2, 256
  s_nop 0
  s_cbranch_scc1 L_end
  s_load_dwordx16 s[16:31], s[0:1], 0
  s_load_dwordx2 s[32:33], s[0:1], 64
  s_load_dwordx4 s[36:39], s[0:1], 72
  v_lshrrev_b32 v2, 6, v0
  v_and_b32 v1, 63, v0
  v_readfirstlane_b32 s81, v2
  s_and_b32 s3, s2, 7
  s_lshr_b32 s4, s2, 3
  s_and_b32 s5, s3, 1
  s_lshl_b32 s5, s5, 3
  s_and_b32 s6, s4, 7
  s_add_u32 s76, s5, s6
  s_lshr_b32 s5, s3, 1
  s_lshl_b32 s5, s5, 2
  s_lshr_b32 s6, s4, 3
  s_add_u32 s77, s5, s6
  s_mov_b32 s82, 0
  s_mov_b32 s88, 0
  s_and_b32 s85, s81, 1
  s_cmp_lt_u32 s81, 4
  s_cbranch_scc1 L_comp
  s_cmp_eq_u32 s81, Lz1-Lz0+5
  s_cbranch_scc1 L_serv
  s_setprio 0
  s_cmp_eq_u32 s81, 4
  s_cbranch_scc1 L_xload
  v_bfe_u32 v2, v1, 1, 2
  v_bfe_u32 v3, v1, 4, 2
  v_xor_b32 v2, v2, v3
  v_lshlrev_b32 v10, 5, v2
  v_and_b32_e64 v2, 1, v1
  v_lshl_add_u32 v10, v2, 4, v10
  v_lshrrev_b32_e64 v2, 5, v1
  v_bfe_u32 v3, v1, 3, 2
  v_lshl_add_u32 v2, v2, 3, v3
  s_mov_b32 s4, 6144
  v_mad_u32_u24 v4, v2, s4, v10
  v_add_u32 v5, 97280, v4
  v_add_u32 v6, 22528, v4
  v_add_u32 v7, 119808, v4
  s_waitcnt lgkmcnt(0)
  s_mov_b32 s48, s18
  s_and_b32 s49, s19, 0xffff
  s_mov_b32 s50, 6291456
  s_mov_b32 s51, 0x00020000
L_wlayer:
  s_lshl_b32 s5, s77, 7
  s_mul_i32 s4, s85, 196608
  s_add_u32 s5, s5, s4
  s_mov_b32 s8, 393216
  s_mov_b32 s10, 6291456
  s_add_u32 s9, s5, s10
  s_mul_i32 s6, s76, 11
  s_lshr_b32 s6, s6, Lz1-Lz0+5
  s_mul_i32 s6, s6, 1179648
  s_add_u32 s7, s5, s6
  s_lshl_b32 s11, s85, 12
  s_add_u32 s11, s11, 65536
  s_add_u32 s15, s11, 73728
  s_mov_b32 s12, 0
  s_mov_b32 m0, s11
  s_cmp_eq_u32 s82, 0
  s_cbranch_scc1 Ll_20
  s_waitcnt vmcnt(12)
  s_barrier
  s_waitcnt vmcnt(8)
  s_barrier
  s_waitcnt vmcnt(4)
  s_barrier
  s_branch Ll_20
Lt_26:
  s_cmp_lg_u32 s12, 1
  s_cbranch_scc1 Lt_24
  s_cmp_eq_u32 s82, 0
  s_cbranch_scc1 Ll_20
  s_waitcnt vmcnt(12)
  s_barrier
  s_branch Ll_20
  s_nop 0
Lt_24:
  s_cmp_lg_u32 s12, 2
  s_cbranch_scc1 Ll_20
  s_cmp_eq_u32 s82, 0
  s_cbranch_scc1 Ll_20
  s_barrier
Ll_20:
  buffer_load_dwordx4 v4, s[48:51], s7 offen offset:0 lds
  buffer_load_dwordx4 v5, s[48:51], s7 offen offset:1024 lds
  buffer_load_dwordx4 v6, s[48:51], s7 offen offset:2048 lds
  buffer_load_dwordx4 v7, s[48:51], s7 offen offset:3072 lds
  s_add_u32 m0, s11, 8192
  s_add_u32 s5, s7, 2048
  buffer_load_dwordx4 v4, s[48:51], s5 offen offset:0 lds
  buffer_load_dwordx4 v5, s[48:51], s5 offen offset:1024 lds
  buffer_load_dwordx4 v6, s[48:51], s5 offen offset:2048 lds
  buffer_load_dwordx4 v7, s[48:51], s5 offen offset:3072 lds
  s_add_u32 m0, s11, 16384
  s_add_u32 s5, s7, 4096
  buffer_load_dwordx4 v4, s[48:51], s5 offen offset:0 lds
  s_add_u32 s7, s7, s8
  s_cmp_eq_u32 s7, s9
  s_cselect_b32 s4, s10, 0
  s_sub_u32 s7, s7, s4
  buffer_load_dwordx4 v5, s[48:51], s5 offen offset:1024 lds
  s_add_u32 s11, s11, 24576
  s_cmp_eq_u32 s11, s15
  s_cselect_b32 s4, 73728, 0
  s_sub_u32 s11, s11, s4
  buffer_load_dwordx4 v6, s[48:51], s5 offen offset:2048 lds
  s_add_u32 s12, s12, 1
  s_cmp_lg_u32 s12, 3
  buffer_load_dwordx4 v7, s[48:51], s5 offen offset:3072 lds
  s_mov_b32 m0, s11
  s_cbranch_scc1 Lt_26
Lt_27:
  s_waitcnt vmcnt(24)
  s_barrier
  s_mul_i32 s5, s85, 6144
  s_nop 0
  s_mov_b32 s68, s24
  s_and_b32 s69, s25, 0xffff
  s_mov_b32 s70, 7340032
  s_mov_b32 s71, 0x00020000
  s_lshl_b32 s4, s76, Lz1-Lz0+4
  s_add_u32 s4, s4, s77
  s_mul_i32 s34, s4, 28672
  s_add_u32 s34, s34, s5
  s_waitcnt vmcnt(12)
  s_barrier
  buffer_load_dwordx4 v4, s[48:51], s7 offen offset:0 lds
  buffer_load_dwordx4 v5, s[48:51], s7 offen offset:1024 lds
  buffer_load_dwordx4 v6, s[48:51], s7 offen offset:2048 lds
  buffer_load_dwordx4 v7, s[48:51], s7 offen offset:3072 lds
Ll_28:
  s_add_u32 m0, s11, 8192
  s_add_u32 s5, s7, 2048
  buffer_load_dwordx4 v4, s[48:51], s5 offen offset:0 lds
  buffer_load_dwordx4 v5, s[48:51], s5 offen offset:1024 lds
  buffer_load_dwordx4 v6, s[48:51], s5 offen offset:2048 lds
  buffer_load_dwordx4 v7, s[48:51], s5 offen offset:3072 lds
  s_add_u32 m0, s11, 16384
  s_add_u32 s5, s7, 4096
  buffer_load_dwordx4 v4, s[48:51], s5 offen offset:0 lds
  s_add_u32 s7, s7, s8
  s_cmp_eq_u32 s7, s9
  s_cselect_b32 s4, s10, 0
  s_sub_u32 s7, s7, s4
  buffer_load_dwordx4 v5, s[48:51], s5 offen offset:1024 lds
  s_add_u32 s11, s11, 24576
  s_cmp_eq_u32 s11, s15
  s_cselect_b32 s4, 73728, 0
  s_sub_u32 s11, s11, s4
  buffer_load_dwordx4 v6, s[48:51], s5 offen offset:2048 lds
  s_add_u32 s12, s12, 1
  s_cmp_eq_u32 s12, 16
  buffer_load_dwordx4 v7, s[48:51], s5 offen offset:3072 lds
  s_mov_b32 m0, s11
  s_cbranch_scc1 Ll_29
  s_cmp_lg_u32 s82, 0
  s_cbranch_scc1 L_30
  s_buffer_load_dwordx2 s[98:99], s[68:71], s34 offset:60
  s_buffer_load_dwordx2 s[98:99], s[68:71], s34 offset:188
  s_buffer_load_dwordx2 s[98:99], s[68:71], s34 offset:316
  s_buffer_load_dwordx2 s[98:99], s[68:71], s34 offset:444
  s_add_u32 s34, s34, 512
L_30:
  s_waitcnt vmcnt(12)
  s_barrier
  buffer_load_dwordx4 v4, s[48:51], s7 offen offset:0 lds
  buffer_load_dwordx4 v5, s[48:51], s7 offen offset:1024 lds
  buffer_load_dwordx4 v6, s[48:51], s7 offen offset:2048 lds
  buffer_load_dwordx4 v7, s[48:51], s7 offen offset:3072 lds
  s_branch Ll_28
Ll_29:
  s_branch L_w1
L_xload:
  s_setprio 0
  v_lshrrev_b32 v2, 4, v1
  v_and_b32 v3, 7, v1
  v_xor_b32 v2, v2, v3
  v_lshrrev_b32 v3, 3, v1
  v_lshlrev_b32 v3, 12, v3
  v_lshl_add_u32 v4, v2, 4, v3
  v_xor_b32_e64 v5, 64, v4
  v_add_u32 v5, 31744, v5
  v_add_u32 v6, 63488, v4
  v_add_u32 v7, 63488, v5
  s_mov_b32 s13, 0x20000
  s_movk_i32 s95, 2048
  s_lshl_b32 s5, s76, 18
  s_mov_b32 s8, 128
  s_mov_b32 s10, 2048
  s_add_u32 s9, s5, s10
  s_mul_i32 s6, s76, 11
  s_lshr_b32 s6, s6, 5
  s_mul_i32 s6, s6, 384
  s_add_u32 s7, s5, s6
  s_waitcnt lgkmcnt(0)
  s_mov_b32 s72, s16
  s_and_b32 s73, s17, 0xffff
  s_mov_b32 s74, 4194304
  s_mov_b32 s75, 0x00020000
L_xlayer:
  s_mov_b32 s11, Lz1-Lz0+0
  s_mov_b32 s15, 65536
  s_mov_b32 s12, Lz1-Lz0+0
  s_mov_b32 m0, s11
Ll_64:
  s_nop 0
  buffer_load_dwordx4 v4, s[72:75], s7 offen offset:0 sc1 lds
  buffer_load_dwordx4 v5, s[72:75], s7 offen offset:1024 sc1 lds
  buffer_load_dwordx4 v6, s[72:75], s7 offen offset:2048 sc1 lds
  buffer_load_dwordx4 v7, s[72:75], s7 offen offset:3072 sc1 lds
  s_add_u32 m0, s11, 4096
  s_nop 0
  s_add_u32 s5, s7, s13
  buffer_load_dwordx4 v4, s[72:75], s5 offen offset:0 sc1 lds
  buffer_load_dwordx4 v5, s[72:75], s5 offen offset:1024 sc1 lds
  buffer_load_dwordx4 v6, s[72:75], s5 offen offset:2048 sc1 lds
  buffer_load_dwordx4 v7, s[72:75], s5 offen offset:3072 sc1 lds
  s_add_u32 m0, s11, 8192
  s_nop 0
  s_add_u32 s3, s7, s95
  buffer_load_dwordx4 v4, s[72:75], s3 offen offset:0 sc1 lds
  buffer_load_dwordx4 v5, s[72:75], s3 offen offset:1024 sc1 lds
  buffer_load_dwordx4 v6, s[72:75], s3 offen offset:2048 sc1 lds
  buffer_load_dwordx4 v7, s[72:75], s3 offen offset:3072 sc1 lds
  s_add_u32 m0, s11, 12288
  s_nop 0
  s_add_u32 s5, s3, s13
  buffer_load_dwordx4 v4, s[72:75], s5 offen offset:0 sc1 lds
  s_add_u32 s7, s7, s8
  s_cmp_eq_u32 s7, s9
  s_cselect_b32 s4, s10, 0
  s_sub_u32 s7, s7, s4
  buffer_load_dwordx4 v5, s[72:75], s5 offen offset:1024 sc1 lds
  s_add_u32 s11, s11, 16384
  s_cmp_eq_u32 s11, s15
  s_cselect_b32 s4, 65536, 0
  s_sub_u32 s11, s11, s4
  buffer_load_dwordx4 v6, s[72:75], s5 offen offset:2048 sc1 lds
  s_add_u32 s12, s12, 1
  s_cmp_lg_u32 s12, 3
  buffer_load_dwordx4 v7, s[72:75], s5 offen offset:3072 sc1 lds
  s_mov_b32 m0, s11
  s_cbranch_scc1 Ll_65
  s_waitcnt vmcnt(32)
  s_barrier
Ll_65:
  s_cmp_lt_u32 s12, Lz1-Lz0+4
  s_cbranch_scc1 Ll_64
  s_mov_b32 s68, s20
  s_and_b32 s69, s21, 0xffff
  s_mov_b32 s70, 2097152
  s_mov_b32 s71, 0x00020000
  s_lshl_b32 s4, s76, 4
  s_add_u32 s4, s4, s77
  s_mul_i32 s34, s4, 8192
  s_waitcnt vmcnt(32)
  s_barrier
  buffer_load_dwordx4 v4, s[72:75], s7 offen offset:0 sc1 lds
  buffer_load_dwordx4 v5, s[72:75], s7 offen offset:1024 sc1 lds
  buffer_load_dwordx4 v6, s[72:75], s7 offen offset:2048 sc1 lds
  buffer_load_dwordx4 v7, s[72:75], s7 offen offset:3072 sc1 lds
Ll_68:
  s_add_u32 m0, s11, 4096
  s_nop 0
  s_add_u32 s5, s7, s13
  buffer_load_dwordx4 v4, s[72:75], s5 offen offset:0 sc1 lds
  buffer_load_dwordx4 v5, s[72:75], s5 offen offset:1024 sc1 lds
  buffer_load_dwordx4 v6, s[72:75], s5 offen offset:2048 sc1 lds
  buffer_load_dwordx4 v7, s[72:75], s5 offen offset:3072 sc1 lds
  s_add_u32 m0, s11, 8192
  s_nop 0
  s_add_u32 s3, s7, s95
  buffer_load_dwordx4 v4, s[72:75], s3 offen offset:0 sc1 lds
  buffer_load_dwordx4 v5, s[72:75], s3 offen offset:1024 sc1 lds
  buffer_load_dwordx4 v6, s[72:75], s3 offen offset:2048 sc1 lds
  buffer_load_dwordx4 v7, s[72:75], s3 offen offset:3072 sc1 lds
  s_add_u32 m0, s11, 12288
  s_nop 0
  s_add_u32 s5, s3, s13
  buffer_load_dwordx4 v4, s[72:75], s5 offen offset:0 sc1 lds
  s_add_u32 s7, s7, s8
  s_cmp_eq_u32 s7, s9
  s_cselect_b32 s4, s10, 0
  s_sub_u32 s7, s7, s4
  buffer_load_dwordx4 v5, s[72:75], s5 offen offset:1024 sc1 lds
  s_add_u32 s11, s11, 16384
  s_cmp_eq_u32 s11, s15
  s_cselect_b32 s4, 65536, 0
  s_sub_u32 s11, s11, s4
  buffer_load_dwordx4 v6, s[72:75], s5 offen offset:2048 sc1 lds
  s_add_u32 s12, s12, 1
  s_cmp_eq_u32 s12, 16
  buffer_load_dwordx4 v7, s[72:75], s5 offen offset:3072 sc1 lds
  s_mov_b32 m0, s11
  s_cbranch_scc1 Ll_69
  s_cmp_lg_u32 s82, 0
  s_cbranch_scc1 L_70
  s_buffer_load_dwordx2 s[98:99], s[68:71], s34 offset:60
  s_buffer_load_dwordx2 s[98:99], s[68:71], s34 offset:188
  s_buffer_load_dwordx2 s[98:99], s[68:71], s34 offset:316
  s_buffer_load_dwordx2 s[98:99], s[68:71], s34 offset:444
  s_buffer_load_dwordx2 s[98:99], s[68:71], s34 offset:572
  s_add_u32 s34, s34, 640
L_70:
  s_waitcnt vmcnt(32)
  s_barrier
  buffer_load_dwordx4 v4, s[72:75], s7 offen offset:0 sc1 lds
  buffer_load_dwordx4 v5, s[72:75], s7 offen offset:1024 sc1 lds
  buffer_load_dwordx4 v6, s[72:75], s7 offen offset:2048 sc1 lds
  buffer_load_dwordx4 v7, s[72:75], s7 offen offset:3072 sc1 lds
  s_branch Ll_68
  s_nop 0
Ll_69:
  s_waitcnt vmcnt(32)
  s_barrier
  s_waitcnt vmcnt(16)
  s_barrier
  s_waitcnt vmcnt(0)
  s_barrier
  s_barrier
  s_branch L_x1
L_serv:
  s_setprio 3
  s_and_b32 s80, s77, 7
  s_lshr_b32 s79, s77, 3
  s_lshl_b32 s78, s80, 1
  s_add_u32 s78, s78, s79
  s_lshl_b32 s5, s76, 4
  s_add_u32 s5, s5, s77
  s_lshl_b32 s84, s5, 11
  s_mov_b32 s83, 3145728
  s_mov_b32 s87, 1835016
  s_lshr_b32 s86, s81, 1
  v_lshlrev_b32 v4, 4, v1
  v_mov_b32 v24, 0
  v_mov_b32 v25, 0
  v_mov_b32 v26, 0
  v_mov_b32 v27, 0
  v_and_b32 v2, 14, v1
  v_lshlrev_b32 v3, 11, v2
  v_and_b32_e64 v2, 1, v1
  v_lshl_add_u32 v3, v2, 4, v3
  v_and_b32_e64 v2, 48, v1
  v_lshl_add_u32 v3, v2, 1, v3
  v_bfe_u32 v2, v1, 3, 2
  v_and_b32 v22, 7, v1
  v_lshlrev_b32 v2, 14, v2
  v_lshl_add_u32 v2, v22, 3, v2
  s_lshl_b32 s5, s76, 7
  s_lshl_b32 s4, s80, 4
  s_add_u32 s6, s5, s4
  s_add_u32 s6, s6, s79
  s_lshl_b32 s6, s6, 11
  s_lshr_b32 s10, s84, 5
  s_add_u32 s10, s10, 1638400
  s_waitcnt lgkmcnt(0)
  s_mov_b32 s48, s18
  s_and_b32 s49, s19, 0xffff
  s_mov_b32 s50, 6291456
  s_mov_b32 s51, 0x00020000
  s_sub_u32 s4, 384, s48
  s_and_b32 s4, s4, 1023
  s_mul_i32 s5, s84, 12
  s_add_u32 s4, s4, s5
  v_lshlrev_b32_e64 v109, 10, v1
  s_mov_b64 exec, 0xffffff
  buffer_load_dword v109, v109, s[48:51], s4 offen
  s_mov_b64 exec, -1
  s_mov_b32 s40, s38
  s_and_b32 s41, s39, 0xffff
  s_mov_b32 s42, 100663296
  s_mov_b32 s43, 0x00020000
  s_nop 0
  s_mov_b32 s44, s16
  s_and_b32 s45, s17, 0xffff
  s_mov_b32 s46, 4194304
  s_mov_b32 s47, 0x00020000
  s_nop 0
  s_mov_b32 s68, s36
  s_and_b32 s69, s37, 0xffff
  s_mov_b32 s70, 256
  s_mov_b32 s71, 0x00020000
  s_lshl_b32 s4, s84, Lz1-Lz0+1
  s_add_u32 s4, s4, 1835008
  buffer_store_dwordx4 v[24:27], v4, s[40:43], s4 offen offset:0 sc0 sc1
  buffer_store_dwordx4 v[24:27], v4, s[40:43], s4 offen offset:1024 sc0 sc1
  v_mov_b32 v28, -1
  v_mov_b32 v29, -1
  v_mov_b32 v30, -1
  v_mov_b32 v31, -1
  s_lshl_b32 s4, s84, 1
  s_add_u32 s4, s4, 0
  buffer_store_dwordx4 v[28:31], v4, s[40:43], s4 offen offset:0 sc0 sc1
  buffer_store_dwordx4 v[28:31], v4, s[40:43], s4 offen offset:1024 sc0 sc1
  buffer_store_dwordx4 v[28:31], v4, s[40:43], s4 offen offset:2048 sc0 sc1
  buffer_store_dwordx4 v[28:31], v4, s[40:43], s4 offen offset:3072 sc0 sc1
  buffer_store_dwordx2 v[24:25], v2, s[40:43], s10 offen sc0 sc1
  v_mov_b32 v108, v3
  s_mov_b32 s7, s6
  s_branch L_s1
L_comp:
  s_and_b32 s80, s77, 7
  s_lshr_b32 s79, s77, 3
  s_lshl_b32 s78, s80, 1
  s_add_u32 s78, s78, s79
  s_lshl_b32 s5, s76, 4
  s_add_u32 s5, s5, s77
  s_lshl_b32 s84, s5, 11
  s_mov_b32 s83, 3145728
  s_mov_b32 s87, 1835016
  s_lshr_b32 s86, s81, Lz1-Lz0+1
  s_waitcnt lgkmcnt(0)
  s_mov_b32 s40, s38
  s_and_b32 s41, s39, 0xffff
  s_mov_b32 s42, 100663296
  s_mov_b32 s43, 0x00020000
  s_nop 0
  s_mov_b32 s44, s16
  s_and_b32 s45, s17, 0xffff
  s_mov_b32 s46, 4194304
  s_mov_b32 s47, 0x00020000
  s_nop 0
  s_mov_b32 s64, s32
  s_and_b32 s65, s33, 0xffff
  s_mov_b32 s66, 4194304
  s_mov_b32 s67, 0x00020000
  s_setprio 1
  v_lshlrev_b32 v11, 4, v1
  v_lshrrev_b32 v2, 3, v1
  v_and_b32 v3, 7, v1
  v_lshlrev_b32_e64 v3, 3, v3
  v_lshl_add_u32 v30, v2, 11, v3
  s_lshl_b32 s4, s85, 13
  s_lshl_b32 s5, s86, 10
  s_add_u32 s4, s4, s5
  v_add_u32 v0, s4, v11
  v_mov_b32_e64 v27, 1
  v_mov_b32 v28, 156416
  v_and_b32 v29, 48, v1
  s_lshl_b32 s4, s76, 16
  s_lshl_b32 s5, s77, 7
  s_add_u32 s4, s4, s5
  v_lshlrev_b32 v24, 12, v1
  v_and_b32 v2, 16, v1
  v_lshl_add_u32 v24, v2, 7, v24
  v_add_u32 v24, s4, v24
  v_lshrrev_b32 v2, 2, v1
  v_lshlrev_b32 v25, 7, v2
  v_and_b32 v2, 3, v1
  v_lshl_add_u32 v25, v2, 3, v25
  v_add_u32 v25, 65536, v25
  v_bfe_u32 v26, v1, 3, 2
  v_and_b32 v2, 15, v1
  v_lshrrev_b32 v3, 2, v29
  v_sub_u32_e64 v2, v2, v3
  s_mov_b32 s4, 0xf149f2ca
  v_mov_b32 v32, s4
  v_subrev_u32 v3, 0, v2
  v_cmp_gt_u32 vcc, 8, v3
  s_nop 1
  v_cndmask_b32_e64 v12, v32, 0, vcc
  v_cmp_ge_i32 vcc, -9, v3
  s_nop 1
  v_cndmask_b32_e64 v16, v32, 0, vcc
  v_mov_b32 v20, v16
  v_subrev_u32 v3, 1, v2
  v_cmp_gt_u32 vcc, 8, v3
  s_nop 1
  v_cndmask_b32_e64 v13, v32, 0, vcc
  v_cmp_ge_i32 vcc, -9, v3
  s_nop 1
  v_cndmask_b32_e64 v17, v32, 0, vcc
  v_mov_b32 v21, v17
  v_subrev_u32 v3, 2, v2
  v_cmp_gt_u32 vcc, 8, v3
  s_nop 1
  v_cndmask_b32_e64 v14, v32, 0, vcc
  v_cmp_ge_i32 vcc, -9, v3
  s_nop 1
  v_cndmask_b32_e64 v18, v32, 0, vcc
  v_mov_b32 v22, v18
  v_subrev_u32 v3, 3, v2
  v_cmp_gt_u32 vcc, 8, v3
  s_nop 1
  v_cndmask_b32_e64 v15, v32, 0, vcc
  v_cmp_ge_i32 vcc, -9, v3
  s_nop 1
  v_cndmask_b32_e64 v19, v32, 0, vcc
  v_mov_b32 v23, v19
  s_cmp_lg_u32 s76, 0
  s_cbranch_scc1 L_1
  v_mov_b32 v20, v32
  v_mov_b32 v21, v32
  v_mov_b32 v22, v32
  v_mov_b32 v23, v32
L_1:
  s_lshl_b32 s11, s84, 1
  s_lshl_b32 s4, s81, 10
  s_add_u32 s11, s11, s4
L_clayer:
  s_mov_b32 s16, Lz1-Lz0+0
  s_mov_b32 s17, 16384
  s_mov_b32 s18, 0xffff4000
  s_mov_b32 s19, Lz1-Lz0+0
  s_mov_b32 s20, 24576
  s_mov_b32 s21, 0xffff4000
  s_mul_i32 s4, s85, 8192
  v_add_u32_e64 v4, s4, v11
  v_add_u32 v5, 1024, v4
  s_cmp_lg_u32 s82, 0
  s_cbranch_scc1 L_2
  v_and_b32 v2, 15, v1
  v_lshrrev_b32 v3, 1, v2
  v_lshrrev_b32 v32, 4, v1
  v_xor_b32 v3, v3, v32
  v_lshlrev_b32_e64 v3, 4, v3
  v_lshl_add_u32 v3, v2, 7, v3
  v_add_u32 v4, s4, v3
  v_xor_b32 v3, 64, v3
  v_add_u32 v5, s4, v3
L_2:
  s_lshl_b32 s4, s86, 1
  v_xor_b32_e64 v2, s4, v26
  v_lshl_add_u32 v6, v2, 5, v25
  s_add_u32 s4, s4, 1
  v_xor_b32 v2, s4, v26
  v_lshl_add_u32 v7, v2, 5, v25
  v_mov_b64 v[128:129], 0
  v_mov_b64 v[130:131], 0
  v_mov_b64 v[132:133], 0
  v_mov_b64 v[134:135], 0
  v_mov_b64 v[136:137], 0
  v_mov_b64 v[138:139], 0
  v_mov_b64 v[140:141], 0
  v_mov_b64 v[142:143], 0
  v_mov_b64 v[144:145], 0
  v_mov_b64 v[146:147], 0
  v_mov_b64 v[148:149], 0
  v_mov_b64 v[150:151], 0
  v_mov_b64 v[152:153], 0
  v_mov_b64 v[154:155], 0
  v_mov_b64 v[156:157], 0
  v_mov_b64 v[158:159], 0
  v_mov_b64 v[160:161], 0
  v_mov_b64 v[162:163], 0
  v_mov_b64 v[164:165], 0
  v_mov_b64 v[166:167], 0
  v_mov_b64 v[168:169], 0
  v_mov_b64 v[170:171], 0
  v_mov_b64 v[172:173], 0
  v_mov_b64 v[174:175], 0
  v_mov_b64 v[176:177], 0
  v_mov_b64 v[178:179], 0
  v_mov_b64 v[180:181], 0
  v_mov_b64 v[182:183], 0
  v_mov_b64 v[184:185], 0
  v_mov_b64 v[186:187], 0
  v_mov_b64 v[188:189], 0
  v_mov_b64 v[190:191], 0
  v_mov_b64 v[192:193], 0
  v_mov_b64 v[194:195], 0
  v_mov_b64 v[196:197], 0
  v_mov_b64 v[198:199], 0
  v_mov_b64 v[200:201], 0
  v_mov_b64 v[202:203], 0
  v_mov_b64 v[204:205], 0
  v_mov_b64 v[206:207], 0
  v_mov_b64 v[208:209], 0
  v_mov_b64 v[210:211], 0
  v_mov_b64 v[212:213], 0
  v_mov_b64 v[214:215], 0
  v_mov_b64 v[216:217], 0
  v_mov_b64 v[218:219], 0
  v_mov_b64 v[220:221], 0
  v_mov_b64 v[222:223], 0
  s_mov_b32 s22, 16
  s_barrier
  ds_read_b64_tr_b16 v[48:49], v6 offset:0
  ds_read_b64_tr_b16 v[50:51], v6 offset:2048
  ds_read_b128 v[32:35], v4 offset:0
  ds_read_b128 v[36:39], v4 offset:2048
  ds_read_b128 v[40:43], v4 offset:4096
  ds_read_b128 v[44:47], v4 offset:6144
  ds_read_b64_tr_b16 v[52:53], v7 offset:0
  ds_read_b64_tr_b16 v[54:55], v7 offset:2048
  ds_read_b64_tr_b16 v[56:57], v6 offset:8192
  ds_read_b64_tr_b16 v[58:59], v6 offset:10240
  ds_read_b64_tr_b16 v[60:61], v7 offset:8192
  ds_read_b64_tr_b16 v[62:63], v7 offset:10240
  ds_read_b64_tr_b16 v[64:65], v6 offset:16384
  ds_read_b64_tr_b16 v[66:67], v6 offset:18432
  ds_read_b64_tr_b16 v[68:69], v7 offset:16384
  ds_read_b64_tr_b16 v[70:71], v7 offset:18432
Lk_3:
  s_nop 0
  s_waitcnt lgkmcnt(0)
  v_mfma_f32_16x16x32_bf16 v[128:131], v[48:51], v[32:35], v[128:131]
  ds_read_b64_tr_b16 v[92:93], v6 offset:4096
  v_mfma_f32_16x16x32_bf16 v[136:139], v[48:51], v[36:39], v[136:139]
  ds_read_b64_tr_b16 v[94:95], v6 offset:6144
  v_mfma_f32_16x16x32_bf16 v[144:147], v[48:51], v[40:43], v[144:147]
  ds_read_b128 v[76:79], v5 offset:0
  v_mfma_f32_16x16x32_bf16 v[152:155], v[48:51], v[44:47], v[152:155]
  ds_read_b128 v[80:83], v5 offset:2048
  v_mfma_f32_16x16x32_bf16 v[132:135], v[52:55], v[32:35], v[132:135]
  ds_read_b128 v[84:87], v5 offset:4096
  v_mfma_f32_16x16x32_bf16 v[140:143], v[52:55], v[36:39], v[140:143]
  ds_read_b128 v[88:91], v5 offset:6144
  v_mfma_f32_16x16x32_bf16 v[148:151], v[52:55], v[40:43], v[148:151]
  ds_read_b64_tr_b16 v[96:97], v7 offset:4096
  v_mfma_f32_16x16x32_bf16 v[156:159], v[52:55], v[44:47], v[156:159]
  ds_read_b64_tr_b16 v[98:99], v7 offset:6144
  v_mfma_f32_16x16x32_bf16 v[160:163], v[56:59], v[32:35], v[160:163]
  ds_read_b64_tr_b16 v[100:101], v6 offset:12288
  v_mfma_f32_16x16x32_bf16 v[168:171], v[56:59], v[36:39], v[168:171]
  ds_read_b64_tr_b16 v[102:103], v6 offset:14336
  v_mfma_f32_16x16x32_bf16 v[176:179], v[56:59], v[40:43], v[176:179]
  ds_read_b64_tr_b16 v[104:105], v7 offset:12288
  v_mfma_f32_16x16x32_bf16 v[184:187], v[56:59], v[44:47], v[184:187]
  ds_read_b64_tr_b16 v[106:107], v7 offset:14336
  v_mfma_f32_16x16x32_bf16 v[164:167], v[60:63], v[32:35], v[164:167]
  ds_read_b64_tr_b16 v[108:109], v6 offset:20480
  v_mfma_f32_16x16x32_bf16 v[172:175], v[60:63], v[36:39], v[172:175]
  ds_read_b64_tr_b16 v[110:111], v6 offset:22528
  v_mfma_f32_16x16x32_bf16 v[180:183], v[60:63], v[40:43], v[180:183]
  ds_read_b64_tr_b16 v[112:113], v7 offset:20480
  v_mfma_f32_16x16x32_bf16 v[188:191], v[60:63], v[44:47], v[188:191]
  ds_read_b64_tr_b16 v[114:115], v7 offset:22528
  v_mfma_f32_16x16x32_bf16 v[192:195], v[32:35], v[64:67], v[192:195]
  s_add_u32 s16, s16, s17
  s_cmp_eq_u32 s16, 65536
  s_cselect_b32 s23, s18, s17
  v_mfma_f32_16x16x32_bf16 v[200:203], v[36:39], v[64:67], v[200:203]
  s_cselect_b32 s16, 0, s16
  v_add_u32 v4, s23, v4
  v_add_u32_e64 v5, s23, v5
  v_mfma_f32_16x16x32_bf16 v[208:211], v[40:43], v[64:67], v[208:211]
  s_add_u32 s19, s19, s20
  s_cmp_eq_u32 s19, 73728
  s_cselect_b32 s23, s21, s20
  v_mfma_f32_16x16x32_bf16 v[216:219], v[44:47], v[64:67], v[216:219]
  s_cselect_b32 s19, 0, s19
  v_add_u32 v6, s23, v6
  v_add_u32_e64 v7, s23, v7
  v_mfma_f32_16x16x32_bf16 v[196:199], v[32:35], v[68:71], v[196:199]
  v_mfma_f32_16x16x32_bf16 v[204:207], v[36:39], v[68:71], v[204:207]
  v_mfma_f32_16x16x32_bf16 v[212:215], v[40:43], v[68:71], v[212:215]
  v_mfma_f32_16x16x32_bf16 v[220:223], v[44:47], v[68:71], v[220:223]
  s_waitcnt lgkmcnt(0)
  s_barrier
  v_mfma_f32_16x16x32_bf16 v[128:131], v[92:95], v[76:79], v[128:131]
  ds_read_b64_tr_b16 v[48:49], v6 offset:0
  v_mfma_f32_16x16x32_bf16 v[136:139], v[92:95], v[80:83], v[136:139]
  ds_read_b64_tr_b16 v[50:51], v6 offset:2048
  v_mfma_f32_16x16x32_bf16 v[144:147], v[92:95], v[84:87], v[144:147]
  ds_read_b128 v[32:35], v4 offset:0
  v_mfma_f32_16x16x32_bf16 v[152:155], v[92:95], v[88:91], v[152:155]
  ds_read_b128 v[36:39], v4 offset:2048
  v_mfma_f32_16x16x32_bf16 v[132:135], v[96:99], v[76:79], v[132:135]
  ds_read_b128 v[40:43], v4 offset:4096
  v_mfma_f32_16x16x32_bf16 v[140:143], v[96:99], v[80:83], v[140:143]
  ds_read_b128 v[44:47], v4 offset:6144
  v_mfma_f32_16x16x32_bf16 v[148:151], v[96:99], v[84:87], v[148:151]
  ds_read_b64_tr_b16 v[52:53], v7 offset:0
  v_mfma_f32_16x16x32_bf16 v[156:159], v[96:99], v[88:91], v[156:159]
  ds_read_b64_tr_b16 v[54:55], v7 offset:2048
  v_mfma_f32_16x16x32_bf16 v[160:163], v[100:103], v[76:79], v[160:163]
  ds_read_b64_tr_b16 v[56:57], v6 offset:8192
  v_mfma_f32_16x16x32_bf16 v[168:171], v[100:103], v[80:83], v[168:171]
  ds_read_b64_tr_b16 v[58:59], v6 offset:10240
  v_mfma_f32_16x16x32_bf16 v[176:179], v[100:103], v[84:87], v[176:179]
  ds_read_b64_tr_b16 v[60:61], v7 offset:8192
  v_mfma_f32_16x16x32_bf16 v[184:187], v[100:103], v[88:91], v[184:187]
  ds_read_b64_tr_b16 v[62:63], v7 offset:10240
  v_mfma_f32_16x16x32_bf16 v[164:167], v[104:107], v[76:79], v[164:167]
  ds_read_b64_tr_b16 v[64:65], v6 offset:16384
  v_mfma_f32_16x16x32_bf16 v[172:175], v[104:107], v[80:83], v[172:175]
  ds_read_b64_tr_b16 v[66:67], v6 offset:18432
  v_mfma_f32_16x16x32_bf16 v[180:183], v[104:107], v[84:87], v[180:183]
  ds_read_b64_tr_b16 v[68:69], v7 offset:16384
  v_mfma_f32_16x16x32_bf16 v[188:191], v[104:107], v[88:91], v[188:191]
  ds_read_b64_tr_b16 v[70:71], v7 offset:18432
  v_mfma_f32_16x16x32_bf16 v[192:195], v[76:79], v[108:111], v[192:195]
  s_sub_u32 s22, s22, Lz1-Lz0+1
  v_mfma_f32_16x16x32_bf16 v[200:203], v[80:83], v[108:111], v[200:203]
  s_cmp_lg_u32 s22, Lz1-Lz0+0
  v_mfma_f32_16x16x32_bf16 v[208:211], v[84:87], v[108:111], v[208:211]
  v_mfma_f32_16x16x32_bf16 v[216:219], v[88:91], v[108:111], v[216:219]
  v_mfma_f32_16x16x32_bf16 v[196:199], v[76:79], v[112:115], v[196:199]
  v_mfma_f32_16x16x32_bf16 v[204:207], v[80:83], v[112:115], v[204:207]
  v_mfma_f32_16x16x32_bf16 v[212:215], v[84:87], v[112:115], v[212:215]
  v_mfma_f32_16x16x32_bf16 v[220:223], v[88:91], v[112:115], v[220:223]
  s_cbranch_scc1 Lk_3
  s_cmp_lg_u32 s82, 0
  s_cbranch_scc1 L_4
  v_and_b32 v2, 15, v1
  v_lshlrev_b32 v3, 12, v2
  v_and_b32 v2, 16, v1
  v_lshl_add_u32 v3, v2, 1, v3
  v_and_b32 v2, 32, v1
  v_lshrrev_b32 v2, 1, v2
  v_add_u32 v3, v2, v3
  s_lshl_b32 s5, s76, 18
  s_lshl_b32 s4, s85, 11
  s_add_u32 s5, s5, s4
  s_lshl_b32 s4, s78, 7
  s_add_u32 s5, s5, s4
  s_lshl_b32 s4, s86, 6
  s_add_u32 s5, s5, s4
  buffer_load_dwordx4 v[240:243], v3, s[44:47], s5 offen
  s_add_u32 s5, s5, 0x10000
  buffer_load_dwordx4 v[244:247], v3, s[44:47], s5 offen
  s_add_u32 s5, s5, 0x10000
  buffer_load_dwordx4 v[248:251], v3, s[44:47], s5 offen
  s_add_u32 s5, s5, 0x10000
  buffer_load_dwordx4 v[252:255], v3, s[44:47], s5 offen
L_4:
  s_nop 0
  s_waitcnt lgkmcnt(0)
  s_mul_i32 s4, s85, 320
  s_add_u32 s4, s4, 151552
  v_and_b32_e64 v2, 15, v1
  v_lshl_add_u32 v3, v2, 2, s4
  v_add_u32 v124, s4, v29
  s_lshl_b32 s5, s86, 7
  s_add_u32 s5, s5, 153088
  v_add_u32_e64 v125, s5, v29
  v_lshl_add_u32 v2, v2, 2, s5
  s_mov_b32 s10, 0x7f
  s_mov_b32 s12, 0xff00ff00
  ds_read2_b32 v[94:95], v3 offset0:48 offset1:208
  ds_read_b128 v[106:109], v125 offset:256
  ds_read_b128 v[110:113], v125 offset:320
  ds_read_b128 v[224:227], v124 offset:192
  ds_read_b128 v[228:231], v124 offset:832
  ds_read2_b32 v[114:115], v2 offset0:128 offset1:144
  ds_read2_b32 v[88:89], v3 offset0:0 offset1:160
  ds_read2_b32 v[90:91], v3 offset0:16 offset1:176
  ds_read2_b32 v[92:93], v3 offset0:32 offset1:192
  ds_read_b128 v[98:101], v125 offset:0
  ds_read_b128 v[102:105], v125 offset:64
  s_add_u32 s9, s11, 65536
  v_lshrrev_b32_e64 v126, 1, v11
  v_bfi_b32 v126, s10, v11, v126
  v_mov_b64 v[64:65], 0
  v_mov_b64 v[66:67], 0
  v_mov_b64 v[232:233], 0
  v_mov_b64 v[234:235], 0
  v_mov_b32 v120, 0x3f803f80
  v_mov_b32 v121, 0x3f803f80
  v_mov_b32 v122, 0x3f803f80
  v_mov_b32 v123, 0x3f803f80
  s_nop 0
  s_waitcnt lgkmcnt(8)
  v_pk_mul_f32 v[116:117], v[106:107], v[94:95] op_sel:[0,1] op_sel_hi:[1,1]
  v_pk_mul_f32 v[118:119], v[108:109], v[94:95] op_sel:[0,1] op_sel_hi:[1,1]
  v_pk_fma_f32 v[184:185], v[184:185], v[94:95], v[116:117] op_sel:[0,0,0] op_sel_hi:[1,0,1] neg_lo:[0,0,1] neg_hi:[0,0,1]
  v_pk_fma_f32 v[186:187], v[186:187], v[94:95], v[118:119] op_sel:[0,0,0] op_sel_hi:[1,0,1] neg_lo:[0,0,1] neg_hi:[0,0,1]
  v_cvt_pk_bf16_f32 v60, v184, v185
  v_cvt_pk_bf16_f32 v61, v186, v187
  v_pk_mul_f32 v[116:117], v[110:111], v[94:95] op_sel:[0,1] op_sel_hi:[1,1]
  v_pk_mul_f32 v[118:119], v[112:113], v[94:95] op_sel:[0,1] op_sel_hi:[1,1]
  v_pk_fma_f32 v[188:189], v[188:189], v[94:95], v[116:117] op_sel:[0,0,0] op_sel_hi:[1,0,1] neg_lo:[0,0,1] neg_hi:[0,0,1]
  v_pk_fma_f32 v[190:191], v[190:191], v[94:95], v[118:119] op_sel:[0,0,0] op_sel_hi:[1,0,1] neg_lo:[0,0,1] neg_hi:[0,0,1]
  v_cvt_pk_bf16_f32 v62, v188, v189
  v_cvt_pk_bf16_f32 v63, v190, v191
  s_mov_b32 exec_lo, s12
  s_mov_b32 exec_hi, s12
  buffer_store_dwordx4 v[60:63], v126, s[40:43], s9 offen sc0 sc1
  s_mov_b64 exec, -1
  s_waitcnt lgkmcnt(5)
  v_pk_mul_f32 v[116:117], v[228:229], v[114:115] op_sel:[0,0] op_sel_hi:[1,0]
  v_pk_mul_f32 v[118:119], v[230:231], v[114:115] op_sel:[0,0] op_sel_hi:[1,0]
  v_pk_fma_f32 v[216:217], v[216:217], v[224:225], v[116:117] neg_lo:[0,0,1] neg_hi:[0,0,1]
  v_pk_fma_f32 v[218:219], v[218:219], v[226:227], v[118:119] neg_lo:[0,0,1] neg_hi:[0,0,1]
  v_cvt_pk_bf16_f32 v76, v216, v217
  v_cvt_pk_bf16_f32 v77, v218, v219
  v_pk_mul_f32 v[116:117], v[228:229], v[114:115] op_sel:[0,1] op_sel_hi:[1,1]
  v_pk_mul_f32 v[118:119], v[230:231], v[114:115] op_sel:[0,1] op_sel_hi:[1,1]
  v_pk_fma_f32 v[220:221], v[220:221], v[224:225], v[116:117] neg_lo:[0,0,1] neg_hi:[0,0,1]
  v_pk_fma_f32 v[222:223], v[222:223], v[226:227], v[118:119] neg_lo:[0,0,1] neg_hi:[0,0,1]
  v_cvt_pk_bf16_f32 v86, v220, v221
  v_cvt_pk_bf16_f32 v87, v222, v223
  v_mov_b64 v[78:79], v[86:87]
  s_mov_b32 exec_lo, 0
  s_mov_b32 exec_hi, Lz1-Lz0-1
  buffer_store_dwordx4 v[76:79], v11, s[40:43], s9 offen sc0 sc1
  s_mov_b64 exec, -1
  s_waitcnt lgkmcnt(0)
  v_pk_mul_f32 v[116:117], v[98:99], v[88:89] op_sel:[0,1] op_sel_hi:[1,1]
  v_pk_mul_f32 v[118:119], v[100:101], v[88:89] op_sel:[0,1] op_sel_hi:[1,1]
  v_pk_fma_f32 v[128:129], v[128:129], v[88:89], v[116:117] op_sel:[0,0,0] op_sel_hi:[1,0,1] neg_lo:[0,0,1] neg_hi:[0,0,1]
  v_pk_fma_f32 v[130:131], v[130:131], v[88:89], v[118:119] op_sel:[0,0,0] op_sel_hi:[1,0,1] neg_lo:[0,0,1] neg_hi:[0,0,1]
  v_cvt_pk_bf16_f32 v32, v128, v129
  v_cvt_pk_bf16_f32 v33, v130, v131
  v_pk_mul_f32 v[116:117], v[102:103], v[88:89] op_sel:[0,1] op_sel_hi:[1,1]
  v_pk_mul_f32 v[118:119], v[104:105], v[88:89] op_sel:[0,1] op_sel_hi:[1,1]
  v_pk_fma_f32 v[132:133], v[132:133], v[88:89], v[116:117] op_sel:[0,0,0] op_sel_hi:[1,0,1] neg_lo:[0,0,1] neg_hi:[0,0,1]
  v_pk_fma_f32 v[134:135], v[134:135], v[88:89], v[118:119] op_sel:[0,0,0] op_sel_hi:[1,0,1] neg_lo:[0,0,1] neg_hi:[0,0,1]
  v_cvt_pk_bf16_f32 v34, v132, v133
  v_cvt_pk_bf16_f32 v35, v134, v135
  v_pk_mul_f32 v[116:117], v[98:99], v[90:91] op_sel:[0,1] op_sel_hi:[1,1]
  v_pk_mul_f32 v[118:119], v[100:101], v[90:91] op_sel:[0,1] op_sel_hi:[1,1]
  v_pk_fma_f32 v[136:137], v[136:137], v[90:91], v[116:117] op_sel:[0,0,0] op_sel_hi:[1,0,1] neg_lo:[0,0,1] neg_hi:[0,0,1]
  v_pk_fma_f32 v[138:139], v[138:139], v[90:91], v[118:119] op_sel:[0,0,0] op_sel_hi:[1,0,1] neg_lo:[0,0,1] neg_hi:[0,0,1]
  v_cvt_pk_bf16_f32 v36, v136, v137
  v_cvt_pk_bf16_f32 v37, v138, v139
  v_pk_mul_f32 v[116:117], v[102:103], v[90:91] op_sel:[0,1] op_sel_hi:[1,1]
  v_pk_mul_f32 v[118:119], v[104:105], v[90:91] op_sel:[0,1] op_sel_hi:[1,1]
  v_pk_fma_f32 v[140:141], v[140:141], v[90:91], v[116:117] op_sel:[0,0,0] op_sel_hi:[1,0,1] neg_lo:[0,0,1] neg_hi:[0,0,1]
  v_pk_fma_f32 v[142:143], v[142:143], v[90:91], v[118:119] op_sel:[0,0,0] op_sel_hi:[1,0,1] neg_lo:[0,0,1] neg_hi:[0,0,1]
  v_cvt_pk_bf16_f32 v38, v140, v141
  v_cvt_pk_bf16_f32 v39, v142, v143
  v_pk_mul_f32 v[116:117], v[98:99], v[92:93] op_sel:[0,1] op_sel_hi:[1,1]
  v_pk_mul_f32 v[118:119], v[100:101], v[92:93] op_sel:[0,1] op_sel_hi:[1,1]
  v_pk_fma_f32 v[144:145], v[144:145], v[92:93], v[116:117] op_sel:[0,0,0] op_sel_hi:[1,0,1] neg_lo:[0,0,1] neg_hi:[0,0,1]
  v_pk_fma_f32 v[146:147], v[146:147], v[92:93], v[118:119] op_sel:[0,0,0] op_sel_hi:[1,0,1] neg_lo:[0,0,1] neg_hi:[0,0,1]
  v_cvt_pk_bf16_f32 v40, v144, v145
  v_cvt_pk_bf16_f32 v41, v146, v147
  v_pk_mul_f32 v[116:117], v[102:103], v[92:93] op_sel:[0,1] op_sel_hi:[1,1]
  v_pk_mul_f32 v[118:119], v[104:105], v[92:93] op_sel:[0,1] op_sel_hi:[1,1]
  v_pk_fma_f32 v[148:149], v[148:149], v[92:93], v[116:117] op_sel:[0,0,0] op_sel_hi:[1,0,1] neg_lo:[0,0,1] neg_hi:[0,0,1]
  v_pk_fma_f32 v[150:151], v[150:151], v[92:93], v[118:119] op_sel:[0,0,0] op_sel_hi:[1,0,1] neg_lo:[0,0,1] neg_hi:[0,0,1]
  v_cvt_pk_bf16_f32 v42, v148, v149
  v_cvt_pk_bf16_f32 v43, v150, v151
  v_pk_mul_f32 v[116:117], v[98:99], v[94:95] op_sel:[0,1] op_sel_hi:[1,1]
  v_pk_mul_f32 v[118:119], v[100:101], v[94:95] op_sel:[0,1] op_sel_hi:[1,1]
  v_pk_fma_f32 v[152:153], v[152:153], v[94:95], v[116:117] op_sel:[0,0,0] op_sel_hi:[1,0,1] neg_lo:[0,0,1] neg_hi:[0,0,1]
  v_pk_fma_f32 v[154:155], v[154:155], v[94:95], v[118:119] op_sel:[0,0,0] op_sel_hi:[1,0,1] neg_lo:[0,0,1] neg_hi:[0,0,1]
  v_cvt_pk_bf16_f32 v44, v152, v153
  v_cvt_pk_bf16_f32 v45, v154, v155
  v_pk_mul_f32 v[116:117], v[102:103], v[94:95] op_sel:[0,1] op_sel_hi:[1,1]
  v_pk_mul_f32 v[118:119], v[104:105], v[94:95] op_sel:[0,1] op_sel_hi:[1,1]
  v_pk_fma_f32 v[156:157], v[156:157], v[94:95], v[116:117] op_sel:[0,0,0] op_sel_hi:[1,0,1] neg_lo:[0,0,1] neg_hi:[0,0,1]
  v_pk_fma_f32 v[158:159], v[158:159], v[94:95], v[118:119] op_sel:[0,0,0] op_sel_hi:[1,0,1] neg_lo:[0,0,1] neg_hi:[0,0,1]
  v_cvt_pk_bf16_f32 v46, v156, v157
  v_cvt_pk_bf16_f32 v47, v158, v159
  ds_read_b128 v[128:131], v124 offset:0
  ds_read_b128 v[132:135], v124 offset:640
  ds_read_b128 v[136:139], v124 offset:64
  ds_read_b128 v[140:143], v124 offset:704
  ds_read_b128 v[144:147], v124 offset:128
  ds_read_b128 v[148:151], v124 offset:768
  v_pk_mul_f32 v[116:117], v[106:107], v[88:89] op_sel:[0,1] op_sel_hi:[1,1]
  v_pk_mul_f32 v[118:119], v[108:109], v[88:89] op_sel:[0,1] op_sel_hi:[1,1]
  v_pk_fma_f32 v[160:161], v[160:161], v[88:89], v[116:117] op_sel:[0,0,0] op_sel_hi:[1,0,1] neg_lo:[0,0,1] neg_hi:[0,0,1]
  v_pk_fma_f32 v[162:163], v[162:163], v[88:89], v[118:119] op_sel:[0,0,0] op_sel_hi:[1,0,1] neg_lo:[0,0,1] neg_hi:[0,0,1]
  v_cvt_pk_bf16_f32 v48, v160, v161
  v_cvt_pk_bf16_f32 v49, v162, v163
  v_pk_mul_f32 v[116:117], v[110:111], v[88:89] op_sel:[0,1] op_sel_hi:[1,1]
  v_pk_mul_f32 v[118:119], v[112:113], v[88:89] op_sel:[0,1] op_sel_hi:[1,1]
  v_pk_fma_f32 v[164:165], v[164:165], v[88:89], v[116:117] op_sel:[0,0,0] op_sel_hi:[1,0,1] neg_lo:[0,0,1] neg_hi:[0,0,1]
  v_pk_fma_f32 v[166:167], v[166:167], v[88:89], v[118:119] op_sel:[0,0,0] op_sel_hi:[1,0,1] neg_lo:[0,0,1] neg_hi:[0,0,1]
  v_cvt_pk_bf16_f32 v50, v164, v165
  v_cvt_pk_bf16_f32 v51, v166, v167
  v_pk_mul_f32 v[116:117], v[106:107], v[90:91] op_sel:[0,1] op_sel_hi:[1,1]
  v_pk_mul_f32 v[118:119], v[108:109], v[90:91] op_sel:[0,1] op_sel_hi:[1,1]
  v_pk_fma_f32 v[168:169], v[168:169], v[90:91], v[116:117] op_sel:[0,0,0] op_sel_hi:[1,0,1] neg_lo:[0,0,1] neg_hi:[0,0,1]
  v_pk_fma_f32 v[170:171], v[170:171], v[90:91], v[118:119] op_sel:[0,0,0] op_sel_hi:[1,0,1] neg_lo:[0,0,1] neg_hi:[0,0,1]
  v_cvt_pk_bf16_f32 v52, v168, v169
  v_cvt_pk_bf16_f32 v53, v170, v171
  v_pk_mul_f32 v[116:117], v[110:111], v[90:91] op_sel:[0,1] op_sel_hi:[1,1]
  v_pk_mul_f32 v[118:119], v[112:113], v[90:91] op_sel:[0,1] op_sel_hi:[1,1]
  v_pk_fma_f32 v[172:173], v[172:173], v[90:91], v[116:117] op_sel:[0,0,0] op_sel_hi:[1,0,1] neg_lo:[0,0,1] neg_hi:[0,0,1]
  v_pk_fma_f32 v[174:175], v[174:175], v[90:91], v[118:119] op_sel:[0,0,0] op_sel_hi:[1,0,1] neg_lo:[0,0,1] neg_hi:[0,0,1]
  v_cvt_pk_bf16_f32 v54, v172, v173
  v_cvt_pk_bf16_f32 v55, v174, v175
  v_pk_mul_f32 v[116:117], v[106:107], v[92:93] op_sel:[0,1] op_sel_hi:[1,1]
  v_pk_mul_f32 v[118:119], v[108:109], v[92:93] op_sel:[0,1] op_sel_hi:[1,1]
  v_pk_fma_f32 v[176:177], v[176:177], v[92:93], v[116:117] op_sel:[0,0,0] op_sel_hi:[1,0,1] neg_lo:[0,0,1] neg_hi:[0,0,1]
  v_pk_fma_f32 v[178:179], v[178:179], v[92:93], v[118:119] op_sel:[0,0,0] op_sel_hi:[1,0,1] neg_lo:[0,0,1] neg_hi:[0,0,1]
  v_cvt_pk_bf16_f32 v56, v176, v177
  v_cvt_pk_bf16_f32 v57, v178, v179
  v_pk_mul_f32 v[116:117], v[110:111], v[92:93] op_sel:[0,1] op_sel_hi:[1,1]
  v_pk_mul_f32 v[118:119], v[112:113], v[92:93] op_sel:[0,1] op_sel_hi:[1,1]
  v_pk_fma_f32 v[180:181], v[180:181], v[92:93], v[116:117] op_sel:[0,0,0] op_sel_hi:[1,0,1] neg_lo:[0,0,1] neg_hi:[0,0,1]
  v_pk_fma_f32 v[182:183], v[182:183], v[92:93], v[118:119] op_sel:[0,0,0] op_sel_hi:[1,0,1] neg_lo:[0,0,1] neg_hi:[0,0,1]
  v_cvt_pk_bf16_f32 v58, v180, v181
  v_cvt_pk_bf16_f32 v59, v182, v183
  v_mfma_f32_16x16x32_bf16 v[164:167], v[48:51], v[32:35], v[12:15]
  v_mfma_f32_16x16x32_bf16 v[168:171], v[48:51], v[36:39], v[16:19]
  v_mfma_f32_16x16x32_bf16 v[172:175], v[52:55], v[36:39], v[12:15]
  v_mfma_f32_16x16x32_bf16 v[176:179], v[52:55], v[40:43], v[16:19]
  v_mfma_f32_16x16x32_bf16 v[180:183], v[56:59], v[40:43], v[12:15]
  v_mfma_f32_16x16x32_bf16 v[184:187], v[56:59], v[44:47], v[16:19]
  v_mfma_f32_16x16x32_bf16 v[188:191], v[60:63], v[44:47], v[12:15]
  s_nop 0
  s_waitcnt lgkmcnt(0)
  v_pk_mul_f32 v[116:117], v[132:133], v[114:115] op_sel:[0,0] op_sel_hi:[1,0]
  v_pk_mul_f32 v[118:119], v[134:135], v[114:115] op_sel:[0,0] op_sel_hi:[1,0]
  v_pk_fma_f32 v[192:193], v[192:193], v[128:129], v[116:117] neg_lo:[0,0,1] neg_hi:[0,0,1]
  v_pk_fma_f32 v[194:195], v[194:195], v[130:131], v[118:119] neg_lo:[0,0,1] neg_hi:[0,0,1]
  v_cvt_pk_bf16_f32 v70, v192, v193
  v_cvt_pk_bf16_f32 v71, v194, v195
  v_pk_mul_f32 v[116:117], v[132:133], v[114:115] op_sel:[0,1] op_sel_hi:[1,1]
  v_pk_mul_f32 v[118:119], v[134:135], v[114:115] op_sel:[0,1] op_sel_hi:[1,1]
  v_pk_fma_f32 v[196:197], v[196:197], v[128:129], v[116:117] neg_lo:[0,0,1] neg_hi:[0,0,1]
  v_pk_fma_f32 v[198:199], v[198:199], v[130:131], v[118:119] neg_lo:[0,0,1] neg_hi:[0,0,1]
  v_cvt_pk_bf16_f32 v80, v196, v197
  v_cvt_pk_bf16_f32 v81, v198, v199
  v_pk_mul_f32 v[116:117], v[140:141], v[114:115] op_sel:[0,0] op_sel_hi:[1,0]
  v_pk_mul_f32 v[118:119], v[142:143], v[114:115] op_sel:[0,0] op_sel_hi:[1,0]
  v_pk_fma_f32 v[200:201], v[200:201], v[136:137], v[116:117] neg_lo:[0,0,1] neg_hi:[0,0,1]
  v_pk_fma_f32 v[202:203], v[202:203], v[138:139], v[118:119] neg_lo:[0,0,1] neg_hi:[0,0,1]
  v_cvt_pk_bf16_f32 v72, v200, v201
  v_cvt_pk_bf16_f32 v73, v202, v203
  v_pk_mul_f32 v[116:117], v[140:141], v[114:115] op_sel:[0,1] op_sel_hi:[1,1]
  v_pk_mul_f32 v[118:119], v[142:143], v[114:115] op_sel:[0,1] op_sel_hi:[1,1]
  v_pk_fma_f32 v[204:205], v[204:205], v[136:137], v[116:117] neg_lo:[0,0,1] neg_hi:[0,0,1]
  v_pk_fma_f32 v[206:207], v[206:207], v[138:139], v[118:119] neg_lo:[0,0,1] neg_hi:[0,0,1]
  v_cvt_pk_bf16_f32 v82, v204, v205
  v_cvt_pk_bf16_f32 v83, v206, v207
  v_pk_mul_f32 v[116:117], v[148:149], v[114:115] op_sel:[0,0] op_sel_hi:[1,0]
  v_pk_mul_f32 v[118:119], v[150:151], v[114:115] op_sel:[0,0] op_sel_hi:[1,0]
  v_pk_fma_f32 v[208:209], v[208:209], v[144:145], v[116:117] neg_lo:[0,0,1] neg_hi:[0,0,1]
  v_pk_fma_f32 v[210:211], v[210:211], v[146:147], v[118:119] neg_lo:[0,0,1] neg_hi:[0,0,1]
  v_cvt_pk_bf16_f32 v74, v208, v209
  v_cvt_pk_bf16_f32 v75, v210, v211
  v_pk_mul_f32 v[116:117], v[148:149], v[114:115] op_sel:[0,1] op_sel_hi:[1,1]
  v_pk_mul_f32 v[118:119], v[150:151], v[114:115] op_sel:[0,1] op_sel_hi:[1,1]
  v_pk_fma_f32 v[212:213], v[212:213], v[144:145], v[116:117] neg_lo:[0,0,1] neg_hi:[0,0,1]
  v_pk_fma_f32 v[214:215], v[214:215], v[146:147], v[118:119] neg_lo:[0,0,1] neg_hi:[0,0,1]
  v_cvt_pk_bf16_f32 v84, v212, v213
  v_cvt_pk_bf16_f32 v85, v214, v215
  v_max3_f32 v90, v172, v173, v174
  v_max3_f32 v99, v175, v168, v169
  v_max3_f32 v92, v180, v181, v182
  v_max3_f32 v100, v183, v176, v177
  v_max3_f32 v94, v188, v189, v190
  v_max3_f32 v101, v191, v184, v185
  v_max3_f32 v90, v90, v170, v171
  v_max3_f32 v92, v92, v178, v179
  v_max3_f32 v94, v94, v186, v187
  v_max_f32 v90, v90, v99
  v_max_f32 v92, v92, v100
  v_max_f32 v94, v94, v101
  v_mov_b32 v99, v90
  v_mov_b32 v100, v92
  v_mov_b32 v101, v94
  v_permlane32_swap_b32 v90, v99
  v_permlane32_swap_b32 v92, v100
  v_permlane32_swap_b32 v94, v101
  v_max_f32 v90, v90, v99
  v_max_f32 v92, v92, v100
  v_max_f32 v94, v94, v101
  v_mov_b32 v99, v90
  v_mov_b32 v100, v92
  v_mov_b32 v101, v94
  v_permlane16_swap_b32 v90, v99
  v_permlane16_swap_b32 v92, v100
  v_permlane16_swap_b32 v94, v101
  v_max_f32 v90, v90, v99
  v_max_f32 v92, v92, v100
  v_max_f32_e64 v94, v94, v101
  s_mov_b32 s4, 0x3e8293ee
  v_mul_f32 v90, s4, v90
  v_mov_b32 v91, s4
  v_mul_f32 v92, s4, v92
  v_mov_b32 v93, s4
  v_mul_f32 v94, s4, v94
  v_mov_b32 v95, s4
  v_pk_fma_f32 v[168:169], v[168:169], v[90:91], v[90:91] op_sel:[0,1,0] op_sel_hi:[1,1,0] neg_lo:[0,0,1] neg_hi:[0,0,1]
  v_pk_fma_f32 v[170:171], v[170:171], v[90:91], v[90:91] op_sel:[0,1,0] op_sel_hi:[1,1,0] neg_lo:[0,0,1] neg_hi:[0,0,1]
  v_pk_fma_f32 v[172:173], v[172:173], v[90:91], v[90:91] op_sel:[0,1,0] op_sel_hi:[1,1,0] neg_lo:[0,0,1] neg_hi:[0,0,1]
  v_pk_fma_f32 v[174:175], v[174:175], v[90:91], v[90:91] op_sel:[0,1,0] op_sel_hi:[1,1,0] neg_lo:[0,0,1] neg_hi:[0,0,1]
  v_pk_fma_f32 v[176:177], v[176:177], v[92:93], v[92:93] op_sel:[0,1,0] op_sel_hi:[1,1,0] neg_lo:[0,0,1] neg_hi:[0,0,1]
  v_pk_fma_f32 v[178:179], v[178:179], v[92:93], v[92:93] op_sel:[0,1,0] op_sel_hi:[1,1,0] neg_lo:[0,0,1] neg_hi:[0,0,1]
  v_pk_fma_f32 v[180:181], v[180:181], v[92:93], v[92:93] op_sel:[0,1,0] op_sel_hi:[1,1,0] neg_lo:[0,0,1] neg_hi:[0,0,1]
  v_pk_fma_f32 v[182:183], v[182:183], v[92:93], v[92:93] op_sel:[0,1,0] op_sel_hi:[1,1,0] neg_lo:[0,0,1] neg_hi:[0,0,1]
  v_pk_fma_f32 v[184:185], v[184:185], v[94:95], v[94:95] op_sel:[0,1,0] op_sel_hi:[1,1,0] neg_lo:[0,0,1] neg_hi:[0,0,1]
  v_pk_fma_f32 v[186:187], v[186:187], v[94:95], v[94:95] op_sel:[0,1,0] op_sel_hi:[1,1,0] neg_lo:[0,0,1] neg_hi:[0,0,1]
  v_pk_fma_f32 v[188:189], v[188:189], v[94:95], v[94:95] op_sel:[0,1,0] op_sel_hi:[1,1,0] neg_lo:[0,0,1] neg_hi:[0,0,1]
  v_pk_fma_f32 v[190:191], v[190:191], v[94:95], v[94:95] op_sel:[0,1,0] op_sel_hi:[1,1,0] neg_lo:[0,0,1] neg_hi:[0,0,1]
  s_lshl_b32 s6, s84, Lz1-Lz0+3
  s_add_u32 s6, s6, 3145728
  s_add_u32 s7, s6, 4096
  s_mov_b32 exec_lo, s12
  s_mov_b32 exec_hi, s12
  buffer_load_dwordx4 v[64:67], v126, s[40:43], s11 offen sc0 sc1
  s_mov_b32 exec_lo, 0
  s_mov_b32 exec_hi, -1
  buffer_load_dwordx4 v[232:235], v11, s[40:43], s11 offen sc0 sc1
  s_mov_b64 exec, -1
  v_exp_f32 v168, v168
  v_exp_f32 v169, v169
  v_exp_f32 v170, v170
  v_exp_f32 v171, v171
  v_exp_f32 v172, v172
  v_exp_f32 v173, v173
  v_exp_f32 v174, v174
  v_exp_f32_e64 v175, v175
  v_cvt_pk_bf16_f32 v36, v168, v169
  v_cvt_pk_bf16_f32 v37, v170, v171
  v_cvt_pk_bf16_f32 v38, v172, v173
  v_cvt_pk_bf16_f32 v39, v174, v175
  v_exp_f32 v176, v176
  v_exp_f32 v177, v177
  v_exp_f32 v178, v178
  v_exp_f32 v179, v179
  v_exp_f32 v180, v180
  v_exp_f32 v181, v181
  v_exp_f32 v182, v182
  v_exp_f32 v183, v183
  v_cvt_pk_bf16_f32 v40, v176, v177
  v_cvt_pk_bf16_f32 v41, v178, v179
  v_cvt_pk_bf16_f32 v42, v180, v181
  v_cvt_pk_bf16_f32 v43, v182, v183
  v_mfma_f32_16x16x32_bf16 v[132:135], v[120:123], v[36:39], 0
  v_mfma_f32_16x16x32_bf16 v[200:203], v[70:73], v[36:39], 0
  v_mfma_f32_16x16x32_bf16 v[204:207], v[80:83], v[36:39], 0
  v_exp_f32 v184, v184
  v_exp_f32 v185, v185
  v_exp_f32 v186, v186
  v_exp_f32 v187, v187
  v_exp_f32 v188, v188
  v_exp_f32 v189, v189
  v_exp_f32 v190, v190
  v_exp_f32 v191, v191
  v_cvt_pk_bf16_f32 v44, v184, v185
  v_cvt_pk_bf16_f32 v45, v186, v187
  v_cvt_pk_bf16_f32 v46, v188, v189
  v_cvt_pk_bf16_f32 v47, v190, v191
  v_mfma_f32_16x16x32_bf16 v[136:139], v[120:123], v[40:43], 0
  v_mfma_f32_16x16x32_bf16 v[208:211], v[72:75], v[40:43], 0
  v_mfma_f32_16x16x32_bf16 v[212:215], v[82:85], v[40:43], 0
  v_mfma_f32_16x16x32_bf16 v[140:143], v[120:123], v[44:47], 0
  v_mfma_f32_16x16x32_bf16 v[216:219], v[74:77], v[44:47], 0
  v_mfma_f32_16x16x32_bf16 v[220:223], v[84:87], v[44:47], 0
  v_rcp_f32 v132, v132
  s_nop 0
  v_pk_mul_f32 v[200:201], v[200:201], v[132:133] op_sel_hi:[1,0]
  v_pk_mul_f32 v[202:203], v[202:203], v[132:133] op_sel_hi:[1,0]
  v_pk_mul_f32 v[204:205], v[204:205], v[132:133] op_sel_hi:[1,0]
  v_pk_mul_f32 v[206:207], v[206:207], v[132:133] op_sel_hi:[1,0]
  v_cvt_pk_bf16_f32 v52, v200, v201
  v_cvt_pk_bf16_f32 v53, v202, v203
  v_cvt_pk_bf16_f32 v54, v204, v205
  v_cvt_pk_bf16_f32 v55, v206, v207
  buffer_store_dwordx4 v[52:55], v0, s[40:43], s6 offen offset:2048 sc0 sc1
  v_rcp_f32 v136, v136
  s_nop 0
  v_pk_mul_f32 v[208:209], v[208:209], v[136:137] op_sel_hi:[1,0]
  v_pk_mul_f32 v[210:211], v[210:211], v[136:137] op_sel_hi:[1,0]
  v_pk_mul_f32 v[212:213], v[212:213], v[136:137] op_sel_hi:[1,0]
  v_pk_mul_f32 v[214:215], v[214:215], v[136:137] op_sel_hi:[1,0]
  v_cvt_pk_bf16_f32 v56, v208, v209
  v_cvt_pk_bf16_f32 v57, v210, v211
  v_cvt_pk_bf16_f32 v58, v212, v213
  v_cvt_pk_bf16_f32 v59, v214, v215
  buffer_store_dwordx4 v[56:59], v0, s[40:43], s7 offen offset:0 sc0 sc1
  v_rcp_f32 v140, v140
  s_nop 0
  v_pk_mul_f32 v[216:217], v[216:217], v[140:141] op_sel_hi:[1,0]
  v_pk_mul_f32 v[218:219], v[218:219], v[140:141] op_sel_hi:[1,0]
  v_pk_mul_f32 v[220:221], v[220:221], v[140:141] op_sel_hi:[1,0]
  v_pk_mul_f32 v[222:223], v[222:223], v[140:141] op_sel_hi:[1,0]
  v_cvt_pk_bf16_f32 v60, v216, v217
  v_cvt_pk_bf16_f32 v61, v218, v219
  v_cvt_pk_bf16_f32 v62, v220, v221
  v_cvt_pk_bf16_f32 v63, v222, v223
  buffer_store_dwordx4 v[60:63], v0, s[40:43], s7 offen offset:2048 sc0 sc1
  s_cmp_eq_u32 s76, Lz1-Lz0+0
  s_mov_b32 s89, 200000
  s_waitcnt vmcnt(3)
  s_cbranch_scc0 Lh_6
  v_mov_b64 v[64:65], 0
  v_mov_b64 v[66:67], 0
  v_mov_b64 v[232:233], 0
  v_mov_b64 v[234:235], 0
  s_branch Lh_7
  s_nop 0
Lh_5:
  s_mov_b32 exec_lo, s12
  s_mov_b32 exec_hi, s12
  buffer_load_dwordx4 v[64:67], v126, s[40:43], s11 offen sc0 sc1
  s_mov_b32 exec_lo, 0
  s_mov_b32 exec_hi, -1
  buffer_load_dwordx4 v[232:235], v11, s[40:43], s11 offen sc0 sc1
  s_mov_b64 exec, -1
  s_waitcnt vmcnt(0)
Lh_6:
  v_max3_u32 v2, v64, v65, v66
  v_max3_u32 v3, v232, v233, v234
  v_max3_u32 v2, v2, v67, v235
  v_max_u32_e64 v2, v2, v3
  v_cmp_eq_u32 vcc, -1, v2
  s_cbranch_vccz Lh_7
  s_sub_u32 s89, s89, 1
  s_cbranch_scc0 Lh_5
Lh_7:
  v_mfma_f32_16x16x32_bf16 v[160:163], v[64:67], v[32:35], v[20:23]
  v_mov_b64 v[68:69], v[232:233]
  v_mov_b64 v[78:79], v[234:235]
  v_mov_b64 v[236:237], -1
  v_mov_b64 v[238:239], -1
  buffer_store_dwordx4 v[236:239], v11, s[40:43], s11 offen sc0 sc1
  v_max3_f32 v88, v164, v165, v166
  s_nop 0
  s_nop 1
  v_max3_f32 v98, v167, v160, v161
  v_max3_f32 v88, v88, v162, v163
  v_max_f32 v88, v88, v98
  v_mov_b32 v98, v88
  s_nop 1
  v_permlane32_swap_b32 v88, v98
  v_max_f32 v88, v88, v98
  v_mov_b32 v98, v88
  s_nop 1
  v_permlane16_swap_b32 v88, v98
  v_max_f32_e64 v88, v88, v98
  s_mov_b32 s4, 0x3e8293ee
  v_mul_f32 v88, s4, v88
  v_mov_b32 v89, s4
  v_pk_fma_f32 v[160:161], v[160:161], v[88:89], v[88:89] op_sel:[0,1,0] op_sel_hi:[1,1,0] neg_lo:[0,0,1] neg_hi:[0,0,1]
  v_pk_fma_f32 v[162:163], v[162:163], v[88:89], v[88:89] op_sel:[0,1,0] op_sel_hi:[1,1,0] neg_lo:[0,0,1] neg_hi:[0,0,1]
  v_pk_fma_f32 v[164:165], v[164:165], v[88:89], v[88:89] op_sel:[0,1,0] op_sel_hi:[1,1,0] neg_lo:[0,0,1] neg_hi:[0,0,1]
  v_pk_fma_f32 v[166:167], v[166:167], v[88:89], v[88:89] op_sel:[0,1,0] op_sel_hi:[1,1,0] neg_lo:[0,0,1] neg_hi:[0,0,1]
  v_exp_f32 v160, v160
  v_exp_f32 v161, v161
  v_exp_f32 v162, v162
  v_exp_f32 v163, v163
  v_exp_f32 v164, v164
  v_exp_f32 v165, v165
  v_exp_f32 v166, v166
  v_exp_f32 v167, v167
  v_cvt_pk_bf16_f32 v32, v160, v161
  v_cvt_pk_bf16_f32 v33, v162, v163
  v_cvt_pk_bf16_f32 v34, v164, v165
  v_cvt_pk_bf16_f32 v35, v166, v167
  s_nop 0
  s_nop 1
  v_mfma_f32_16x16x32_bf16 v[128:131], v[120:123], v[32:35], 0
  v_mfma_f32_16x16x32_bf16 v[192:195], v[68:71], v[32:35], 0
  v_mfma_f32_16x16x32_bf16 v[196:199], v[78:81], v[32:35], 0
  s_nop 5
  v_rcp_f32_e64 v128, v128
  s_nop 0
  v_pk_mul_f32 v[192:193], v[192:193], v[128:129] op_sel_hi:[1,0]
  v_pk_mul_f32 v[194:195], v[194:195], v[128:129] op_sel_hi:[1,0]
  v_pk_mul_f32 v[196:197], v[196:197], v[128:129] op_sel_hi:[1,0]
  v_pk_mul_f32 v[198:199], v[198:199], v[128:129] op_sel_hi:[1,0]
  v_cvt_pk_bf16_f32 v48, v192, v193
  v_cvt_pk_bf16_f32 v49, v194, v195
  v_cvt_pk_bf16_f32 v50, v196, v197
  v_cvt_pk_bf16_f32 v51, v198, v199
  buffer_store_dwordx4 v[48:51], v0, s[40:43], s6 offen offset:0 sc0 sc1
  s_add_u32 s5, s87, Lz1-Lz0+0
  s_waitcnt vmcnt(0)
  s_mov_b64 exec, 1
  ds_add_rtn_u32 v2, v28, v27 offset:0
  s_waitcnt lgkmcnt(0)
  v_readfirstlane_b32 s4, v2
  s_and_b32 s4, s4, Lz1-Lz0+3
  s_cmp_lg_u32 s4, 3
  s_cbranch_scc1 Ls_9
  s_mov_b32 exec_lo, 0xffff
  buffer_store_dword v27, v24, s[40:43], s5 offen sc0 sc1
Ls_9:
  s_mov_b64 exec, -1
  s_cmp_lg_u32 s82, 0
  s_cbranch_scc1 L_10
  v_permlane16_swap_b32 v240, v242
  v_permlane16_swap_b32 v241, v243
  v_permlane16_swap_b32 v244, v246
  v_permlane16_swap_b32 v245, v247
  v_permlane16_swap_b32 v248, v250
  v_permlane16_swap_b32 v249, v251
  v_permlane16_swap_b32 v252, v254
  v_permlane16_swap_b32 v253, v255
L_10:
  s_mov_b32 s16, 0
  s_mov_b32 s17, 16384
  s_mov_b32 s18, 0xffff4000
  s_mov_b32 s19, 32768
  s_mov_b32 s20, 8192
  s_mov_b32 s21, 0xfffee000
  s_mul_i32 s4, s85, 8192
  v_add_u32_e64 v4, s4, v11
  v_add_u32 v5, 1024, v4
  s_add_u32 s5, s19, 0
  s_lshl_b32 s4, s86, 1
  v_xor_b32_e64 v2, s4, v26
  v_lshl_add_u32 v6, v2, 5, v25
  v_add_u32 v6, s5, v6
  s_add_u32 s4, s4, 1
  v_xor_b32_e64 v2, s4, v26
  v_lshl_add_u32 v7, v2, 5, v25
  v_add_u32_e64 v7, s5, v7
  s_mov_b32 s4, 0xffff0000
  v_lshlrev_b32 v128, 16, v240
  v_and_b32 v129, s4, v240
  v_lshlrev_b32 v130, 16, v241
  v_and_b32 v131, s4, v241
  v_lshlrev_b32 v132, 16, v242
  v_and_b32 v133, s4, v242
  v_lshlrev_b32 v134, 16, v243
  v_and_b32 v135, s4, v243
  v_lshlrev_b32 v136, 16, v244
  v_and_b32 v137, s4, v244
  v_lshlrev_b32 v138, 16, v245
  v_and_b32 v139, s4, v245
  v_lshlrev_b32 v140, 16, v246
  v_and_b32 v141, s4, v246
  v_lshlrev_b32 v142, 16, v247
  v_and_b32 v143, s4, v247
  v_lshlrev_b32 v144, 16, v248
  v_and_b32 v145, s4, v248
  v_lshlrev_b32 v146, 16, v249
  v_and_b32 v147, s4, v249
  v_lshlrev_b32 v148, 16, v250
  v_and_b32 v149, s4, v250
  v_lshlrev_b32 v150, 16, v251
  v_and_b32 v151, s4, v251
  v_lshlrev_b32 v152, 16, v252
  v_and_b32 v153, s4, v252
  v_lshlrev_b32 v154, 16, v253
  v_and_b32 v155, s4, v253
  v_lshlrev_b32 v156, 16, v254
  v_and_b32 v157, s4, v254
  v_lshlrev_b32 v158, 16, v255
  v_and_b32 v159, s4, v255
  s_mov_b32 s22, 8
  s_barrier
  ds_read_b64_tr_b16 v[48:49], v6 offset:0
  ds_read_b64_tr_b16 v[50:51], v6 offset:2048
  ds_read_b128 v[32:35], v4 offset:0
  ds_read_b128 v[36:39], v4 offset:2048
  ds_read_b128 v[40:43], v4 offset:4096
  ds_read_b128 v[44:47], v4 offset:6144
  ds_read_b64_tr_b16 v[52:53], v7 offset:0
  ds_read_b64_tr_b16 v[54:55], v7 offset:2048
  ds_read_b64_tr_b16 v[80:81], v6 offset:4096
  ds_read_b64_tr_b16 v[82:83], v6 offset:6144
  ds_read_b128 v[64:67], v5 offset:0
  ds_read_b128 v[68:71], v5 offset:2048
  ds_read_b128 v[72:75], v5 offset:4096
  s_nop 0
  s_waitcnt lgkmcnt(4)
  ds_read_b128 v[76:79], v5 offset:6144
  ds_read_b64_tr_b16 v[84:85], v7 offset:4096
  ds_read_b64_tr_b16 v[86:87], v7 offset:6144
  s_add_u32 s16, s16, s17
  s_cmp_eq_u32 s16, 65536
  s_cselect_b32 s23, s18, s17
  s_cselect_b32 s16, 0, s16
  v_add_u32 v4, s23, v4
  v_add_u32 v5, s23, v5
  s_add_u32 s19, s19, s20
  s_cmp_eq_u32 s19, 81920
  s_cselect_b32 s23, s21, s20
  s_cselect_b32 s19, 0, s19
  v_add_u32 v6, s23, v6
  v_add_u32 v7, s23, v7
  s_waitcnt lgkmcnt(0)
Lk_11:
  s_barrier
  v_mfma_f32_16x16x32_bf16 v[128:131], v[48:51], v[32:35], v[128:131]
  ds_read_b64_tr_b16 v[112:113], v6 offset:0
  ds_read_b64_tr_b16 v[114:115], v6 offset:2048
  v_mfma_f32_16x16x32_bf16 v[136:139], v[48:51], v[36:39], v[136:139]
  ds_read_b128 v[96:99], v4 offset:0
  ds_read_b128 v[100:103], v4 offset:2048
  v_mfma_f32_16x16x32_bf16 v[144:147], v[48:51], v[40:43], v[144:147]
  ds_read_b128 v[104:107], v4 offset:4096
  ds_read_b128 v[108:111], v4 offset:6144
  v_mfma_f32_16x16x32_bf16 v[152:155], v[48:51], v[44:47], v[152:155]
  ds_read_b64_tr_b16 v[116:117], v7 offset:0
  ds_read_b64_tr_b16 v[118:119], v7 offset:2048
  v_mfma_f32_16x16x32_bf16 v[132:135], v[52:55], v[32:35], v[132:135]
  ds_read_b64_tr_b16 v[208:209], v6 offset:4096
  ds_read_b64_tr_b16 v[210:211], v6 offset:6144
  v_mfma_f32_16x16x32_bf16 v[140:143], v[52:55], v[36:39], v[140:143]
  ds_read_b128 v[192:195], v5 offset:0
  ds_read_b128 v[196:199], v5 offset:2048
  v_mfma_f32_16x16x32_bf16 v[148:151], v[52:55], v[40:43], v[148:151]
  ds_read_b128 v[200:203], v5 offset:4096
  ds_read_b128 v[204:207], v5 offset:6144
  v_mfma_f32_16x16x32_bf16 v[156:159], v[52:55], v[44:47], v[156:159]
  ds_read_b64_tr_b16 v[212:213], v7 offset:4096
  ds_read_b64_tr_b16 v[214:215], v7 offset:6144
  v_mfma_f32_16x16x32_bf16 v[128:131], v[80:83], v[64:67], v[128:131]
  s_add_u32 s16, s16, s17
  s_cmp_eq_u32 s16, 65536
  s_cselect_b32 s23, s18, s17
  v_mfma_f32_16x16x32_bf16 v[136:139], v[80:83], v[68:71], v[136:139]
  s_cselect_b32 s16, 0, s16
  v_add_u32 v4, s23, v4
  v_add_u32_e64 v5, s23, v5
  v_mfma_f32_16x16x32_bf16 v[144:147], v[80:83], v[72:75], v[144:147]
  s_add_u32 s19, s19, s20
  s_cmp_eq_u32 s19, 81920
  s_cselect_b32 s23, s21, s20
  v_mfma_f32_16x16x32_bf16 v[152:155], v[80:83], v[76:79], v[152:155]
  s_cselect_b32 s19, 0, s19
  v_add_u32 v6, s23, v6
  v_add_u32_e64 v7, s23, v7
  v_mfma_f32_16x16x32_bf16 v[132:135], v[84:87], v[64:67], v[132:135]
  v_mfma_f32_16x16x32_bf16 v[140:143], v[84:87], v[68:71], v[140:143]
  v_mfma_f32_16x16x32_bf16 v[148:151], v[84:87], v[72:75], v[148:151]
  s_waitcnt lgkmcnt(0)
  v_mfma_f32_16x16x32_bf16 v[156:159], v[84:87], v[76:79], v[156:159]
  s_barrier
  v_mfma_f32_16x16x32_bf16 v[128:131], v[112:115], v[96:99], v[128:131]
  ds_read_b64_tr_b16 v[48:49], v6 offset:0
  ds_read_b64_tr_b16 v[50:51], v6 offset:2048
  v_mfma_f32_16x16x32_bf16 v[136:139], v[112:115], v[100:103], v[136:139]
  ds_read_b128 v[32:35], v4 offset:0
  ds_read_b128 v[36:39], v4 offset:2048
  v_mfma_f32_16x16x32_bf16 v[144:147], v[112:115], v[104:107], v[144:147]
  ds_read_b128 v[40:43], v4 offset:4096
  ds_read_b128 v[44:47], v4 offset:6144
  v_mfma_f32_16x16x32_bf16 v[152:155], v[112:115], v[108:111], v[152:155]
  ds_read_b64_tr_b16 v[52:53], v7 offset:0
  ds_read_b64_tr_b16 v[54:55], v7 offset:2048
  v_mfma_f32_16x16x32_bf16 v[132:135], v[116:119], v[96:99], v[132:135]
  ds_read_b64_tr_b16 v[80:81], v6 offset:4096
  ds_read_b64_tr_b16 v[82:83], v6 offset:6144
  v_mfma_f32_16x16x32_bf16 v[140:143], v[116:119], v[100:103], v[140:143]
  ds_read_b128 v[64:67], v5 offset:0
  ds_read_b128 v[68:71], v5 offset:2048
  v_mfma_f32_16x16x32_bf16 v[148:151], v[116:119], v[104:107], v[148:151]
  ds_read_b128 v[72:75], v5 offset:4096
  ds_read_b128 v[76:79], v5 offset:6144
  v_mfma_f32_16x16x32_bf16 v[156:159], v[116:119], v[108:111], v[156:159]
  ds_read_b64_tr_b16 v[84:85], v7 offset:4096
  ds_read_b64_tr_b16 v[86:87], v7 offset:6144
  v_mfma_f32_16x16x32_bf16 v[128:131], v[208:211], v[192:195], v[128:131]
  s_add_u32 s16, s16, s17
  s_cmp_eq_u32 s16, 65536
  s_cselect_b32 s23, s18, s17
  v_mfma_f32_16x16x32_bf16 v[136:139], v[208:211], v[196:199], v[136:139]
  s_cselect_b32 s16, 0, s16
  v_add_u32 v4, s23, v4
  v_add_u32_e64 v5, s23, v5
  v_mfma_f32_16x16x32_bf16 v[144:147], v[208:211], v[200:203], v[144:147]
  s_add_u32 s19, s19, s20
  s_cmp_eq_u32 s19, 81920
  s_cselect_b32 s23, s21, s20
  v_mfma_f32_16x16x32_bf16 v[152:155], v[208:211], v[204:207], v[152:155]
  s_cselect_b32 s19, 0, s19
  v_add_u32 v6, s23, v6
  v_add_u32_e64 v7, s23, v7
  v_mfma_f32_16x16x32_bf16 v[132:135], v[212:215], v[192:195], v[132:135]
  s_sub_u32 s22, s22, 1
  s_cmp_lg_u32 s22, 0
  v_mfma_f32_16x16x32_bf16 v[140:143], v[212:215], v[196:199], v[140:143]
  v_mfma_f32_16x16x32_bf16 v[148:151], v[212:215], v[200:203], v[148:151]
  s_nop 0
  s_waitcnt lgkmcnt(0)
  v_mfma_f32_16x16x32_bf16 v[156:159], v[212:215], v[204:207], v[156:159]
  s_cbranch_scc1 Lk_11
  s_waitcnt lgkmcnt(0)
  v_cvt_pk_bf16_f32 v240, v128, v129
  v_cvt_pk_bf16_f32 v241, v130, v131
  v_cvt_pk_bf16_f32 v242, v132, v133
  v_cvt_pk_bf16_f32 v243, v134, v135
  v_cvt_pk_bf16_f32 v244, v136, v137
  v_cvt_pk_bf16_f32 v245, v138, v139
  v_cvt_pk_bf16_f32 v246, v140, v141
  v_cvt_pk_bf16_f32 v247, v142, v143
  v_cvt_pk_bf16_f32 v248, v144, v145
  v_cvt_pk_bf16_f32 v249, v146, v147
  v_cvt_pk_bf16_f32 v250, v148, v149
  v_cvt_pk_bf16_f32 v251, v150, v151
  v_cvt_pk_bf16_f32 v252, v152, v153
  v_cvt_pk_bf16_f32 v253, v154, v155
  v_cvt_pk_bf16_f32 v254, v156, v157
  v_cvt_pk_bf16_f32 v255, v158, v159
  s_lshl_b32 s4, s76, 4
  s_add_u32 s4, s4, s78
  s_lshl_b32 s6, s4, Lz1-Lz0+14
  s_add_u32 s6, s6, 7340032
  s_add_u32 s7, s6, 4096
  s_lshl_b32 s5, s78, Lz1-Lz0+1
  buffer_store_dwordx4 v[240:243], v0, s[40:43], s6 offen offset:0 sc0 sc1
  buffer_store_dwordx4 v[244:247], v0, s[40:43], s6 offen offset:2048 sc0 sc1
  buffer_store_dwordx4 v[248:251], v0, s[40:43], s7 offen offset:0 sc0 sc1
  buffer_store_dwordx4 v[252:255], v0, s[40:43], s7 offen offset:2048 sc0 sc1
  v_mov_b32 v40, 0x3f803f80
  v_dot2_f32_bf16 v32, v240, v40, 0
  v_dot2_f32_bf16 v36, v240, v240, 0
  v_dot2_f32_bf16 v33, v244, v40, 0
  v_dot2_f32_bf16 v37, v244, v244, 0
  v_dot2_f32_bf16 v34, v248, v40, 0
  v_dot2_f32_bf16 v38, v248, v248, 0
  v_dot2_f32_bf16 v35, v252, v40, 0
  v_dot2_f32_bf16 v39, v252, v252, 0
  v_dot2_f32_bf16 v32, v241, v40, v32
  v_dot2_f32_bf16 v36, v241, v241, v36
  v_dot2_f32_bf16 v33, v245, v40, v33
  v_dot2_f32_bf16 v37, v245, v245, v37
  v_dot2_f32_bf16 v34, v249, v40, v34
  v_dot2_f32_bf16 v38, v249, v249, v38
  v_dot2_f32_bf16 v35, v253, v40, v35
  v_dot2_f32_bf16 v39, v253, v253, v39
  v_dot2_f32_bf16 v32, v242, v40, v32
  v_dot2_f32_bf16 v36, v242, v242, v36
  v_dot2_f32_bf16 v33, v246, v40, v33
  v_dot2_f32_bf16 v37, v246, v246, v37
  v_dot2_f32_bf16 v34, v250, v40, v34
  v_dot2_f32_bf16 v38, v250, v250, v38
  v_dot2_f32_bf16 v35, v254, v40, v35
  v_dot2_f32_bf16 v39, v254, v254, v39
  v_dot2_f32_bf16 v32, v243, v40, v32
  v_dot2_f32_bf16 v36, v243, v243, v36
  v_dot2_f32_bf16 v33, v247, v40, v33
  v_dot2_f32_bf16 v37, v247, v247, v37
  v_dot2_f32_bf16 v34, v251, v40, v34
  v_dot2_f32_bf16 v38, v251, v251, v38
  v_dot2_f32_bf16 v35, v255, v40, v35
  v_dot2_f32_bf16 v39, v255, v255, v39
  s_lshl_b32 s6, s76, Lz1-Lz0+9
  s_lshl_b32 s7, s85, 8
  s_add_u32 s6, s6, s7
  s_add_u32 s6, s6, s5
  s_add_u32 s6, s6, s86
  s_lshl_b32 s6, s6, 6
  s_add_u32 s6, s6, s83
  s_add_u32 s6, s6, 31457280
  v_permlane32_swap_b32 v32, v34
  v_permlane32_swap_b32 v33, v35
  v_permlane32_swap_b32 v36, v38
  v_permlane32_swap_b32 v37, v39
  v_add_f32 v32, v32, v34
  v_add_f32 v33, v33, v35
  v_add_f32 v36, v36, v38
  v_add_f32 v37, v37, v39
  v_permlane16_swap_b32 v32, v33
  s_nop 0
  v_permlane16_swap_b32 v36, v37
  v_add_f32 v42, v32, v33
  v_add_f32_e64 v43, v36, v37
  buffer_store_dwordx2 v[42:43], v30, s[40:43], s6 offen sc0 sc1
  ds_write_b128 v0, v[240:243] offset:0
  ds_write_b128 v0, v[244:247] offset:2048
  ds_write_b128 v0, v[248:251] offset:4096
  ds_write_b128 v0, v[252:255] offset:6144
  s_add_u32 s5, s87, 4
  s_sub_u32 s4, s78, s77
  s_lshl_b32 s4, s4, 7
  s_add_u32 s5, s5, s4
  s_waitcnt vmcnt(0)
  s_mov_b64 exec, 1
  ds_add_rtn_u32 v2, v28, v27 offset:0
  s_waitcnt lgkmcnt(0)
  v_readfirstlane_b32 s4, v2
  s_and_b32 s4, s4, Lz1-Lz0+3
  s_cmp_lg_u32 s4, 3
  s_cbranch_scc1 Ls_12
  s_mov_b32 exec_lo, 0xffff
  buffer_store_dword v27, v24, s[40:43], s5 offen sc0 sc1
Ls_12:
  s_mov_b64 exec, -1
  s_mov_b32 s16, 0
  s_mov_b32 s17, 16384
  s_mov_b32 s18, 0xffff4000
  s_mov_b32 s19, Lz1-Lz0+0
  s_mov_b32 s20, 28672
  s_mov_b32 s21, 0xffff2000
  s_mul_i32 s4, s85, 8192
  v_add_u32_e64 v4, s4, v11
  v_add_u32 v5, 1024, v4
  s_mul_i32 s4, s86, 6
  s_add_u32 s4, s4, 0
  s_lshr_b32 s5, s4, 2
  s_lshl_b32 s5, s5, 13
  s_and_b32 s4, s4, 3
  v_xor_b32 v2, s4, v26
  v_lshl_add_u32 v6, v2, 5, v25
  v_add_u32 v6, s5, v6
  s_mul_i32 s4, s86, 6
  s_add_u32 s4, s4, 1
  s_lshr_b32 s5, s4, 2
  s_lshl_b32 s5, s5, 13
  s_and_b32 s4, s4, 3
  v_xor_b32_e64 v2, s4, v26
  v_lshl_add_u32 v7, v2, 5, v25
  v_add_u32 v7, s5, v7
  s_mul_i32 s4, s86, 6
  s_add_u32 s4, s4, 2
  s_lshr_b32 s5, s4, 2
  s_lshl_b32 s5, s5, 13
  s_and_b32 s4, s4, 3
  v_xor_b32_e64 v2, s4, v26
  v_lshl_add_u32 v8, v2, 5, v25
  v_add_u32 v8, s5, v8
  s_mul_i32 s4, s86, 6
  s_add_u32 s4, s4, 3
  s_lshr_b32 s5, s4, 2
  s_lshl_b32 s5, s5, 13
  s_and_b32 s4, s4, 3
  v_xor_b32_e64 v2, s4, v26
  v_lshl_add_u32 v9, v2, 5, v25
  v_add_u32 v9, s5, v9
  v_lshrrev_b32 v2, 2, v1
  v_lshlrev_b32 v3, 6, v2
  v_and_b32 v2, 3, v1
  v_lshl_add_u32 v3, v2, 3, v3
  v_bfe_u32 v2, v1, 4, 1
  v_xor_b32_e64 v2, s86, v2
  v_lshl_add_u32 v3, v2, 5, v3
  v_add_u32 v10, 90112, v3
  v_mov_b64 v[128:129], 0
  v_mov_b64 v[130:131], 0
  v_mov_b64 v[132:133], 0
  v_mov_b64 v[134:135], 0
  v_mov_b64 v[136:137], 0
  v_mov_b64 v[138:139], 0
  v_mov_b64 v[140:141], 0
  v_mov_b64 v[142:143], 0
  v_mov_b64 v[144:145], 0
  v_mov_b64 v[146:147], 0
  v_mov_b64 v[148:149], 0
  v_mov_b64 v[150:151], 0
  v_mov_b64 v[152:153], 0
  v_mov_b64 v[154:155], 0
  v_mov_b64 v[156:157], 0
  v_mov_b64 v[158:159], 0
  v_mov_b64 v[160:161], 0
  v_mov_b64 v[162:163], 0
  v_mov_b64 v[164:165], 0
  v_mov_b64 v[166:167], 0
  v_mov_b64 v[168:169], 0
  v_mov_b64 v[170:171], 0
  v_mov_b64 v[172:173], 0
  v_mov_b64 v[174:175], 0
  v_mov_b64 v[176:177], 0
  v_mov_b64 v[178:179], 0
  v_mov_b64 v[180:181], 0
  v_mov_b64 v[182:183], 0
  v_mov_b64 v[184:185], 0
  v_mov_b64 v[186:187], 0
  v_mov_b64 v[188:189], 0
  v_mov_b64 v[190:191], 0
  v_mov_b64 v[192:193], 0
  v_mov_b64 v[194:195], 0
  v_mov_b64 v[196:197], 0
  v_mov_b64 v[198:199], 0
  v_mov_b64 v[200:201], 0
  v_mov_b64 v[202:203], 0
  v_mov_b64 v[204:205], 0
  v_mov_b64 v[206:207], 0
  v_mov_b64 v[208:209], 0
  v_mov_b64 v[210:211], 0
  v_mov_b64 v[212:213], 0
  v_mov_b64 v[214:215], 0
  v_mov_b64 v[216:217], 0
  v_mov_b64 v[218:219], 0
  v_mov_b64 v[220:221], 0
  v_mov_b64 v[222:223], 0
  v_mov_b64 v[224:225], 0
  v_mov_b64 v[226:227], 0
  v_mov_b64 v[228:229], 0
  v_mov_b64 v[230:231], 0
  v_mov_b64 v[232:233], 0
  v_mov_b64 v[234:235], 0
  v_mov_b64 v[236:237], 0
  v_mov_b64 v[238:239], 0
  s_mov_b32 s22, 16
  s_mov_b64 vcc, -1
  s_waitcnt lgkmcnt(0)
  s_barrier
  s_branch Lo_13
Lo_14:
  s_mov_b64 vcc, 0
  s_waitcnt lgkmcnt(0)
  s_barrier
Lo_13:
  ds_read_b64_tr_b16 v[48:49], v6 offset:0
  ds_read_b64_tr_b16 v[50:51], v6 offset:2048
  ds_read_b128 v[32:35], v4 offset:0
  ds_read_b128 v[36:39], v4 offset:2048
  ds_read_b128 v[40:43], v4 offset:4096
  ds_read_b128 v[44:47], v4 offset:6144
  ds_read_b64_tr_b16 v[52:53], v7 offset:0
  ds_read_b64_tr_b16 v[54:55], v7 offset:2048
  ds_read_b64_tr_b16 v[56:57], v8 offset:0
  ds_read_b64_tr_b16 v[58:59], v8 offset:2048
  ds_read_b64_tr_b16 v[60:61], v9 offset:0
  ds_read_b64_tr_b16 v[62:63], v9 offset:2048
  ds_read_b64_tr_b16 v[64:65], v6 offset:8192
  ds_read_b64_tr_b16 v[66:67], v6 offset:10240
  ds_read_b64_tr_b16 v[68:69], v7 offset:8192
  ds_read_b64_tr_b16 v[70:71], v7 offset:10240
  ds_read_b64_tr_b16 v[72:73], v10 offset:0
  ds_read_b64_tr_b16 v[74:75], v10 offset:1024
Lk_16:
  s_nop 0
  s_waitcnt lgkmcnt(0)
  v_mfma_f32_16x16x32_bf16 v[128:131], v[48:51], v[32:35], v[128:131]
  ds_read_b64_tr_b16 v[92:93], v6 offset:4096
  v_mfma_f32_16x16x32_bf16 v[132:135], v[48:51], v[36:39], v[132:135]
  ds_read_b64_tr_b16 v[94:95], v6 offset:6144
  v_mfma_f32_16x16x32_bf16 v[136:139], v[48:51], v[40:43], v[136:139]
  ds_read_b128 v[76:79], v5 offset:0
  v_mfma_f32_16x16x32_bf16 v[140:143], v[48:51], v[44:47], v[140:143]
  ds_read_b128 v[80:83], v5 offset:2048
  v_mfma_f32_16x16x32_bf16 v[144:147], v[52:55], v[32:35], v[144:147]
  ds_read_b128 v[84:87], v5 offset:4096
  v_mfma_f32_16x16x32_bf16 v[148:151], v[52:55], v[36:39], v[148:151]
  ds_read_b128 v[88:91], v5 offset:6144
  v_mfma_f32_16x16x32_bf16 v[152:155], v[52:55], v[40:43], v[152:155]
  ds_read_b64_tr_b16 v[96:97], v7 offset:4096
  v_mfma_f32_16x16x32_bf16 v[156:159], v[52:55], v[44:47], v[156:159]
  ds_read_b64_tr_b16 v[98:99], v7 offset:6144
  v_mfma_f32_16x16x32_bf16 v[160:163], v[56:59], v[32:35], v[160:163]
  ds_read_b64_tr_b16 v[100:101], v8 offset:4096
  v_mfma_f32_16x16x32_bf16 v[164:167], v[56:59], v[36:39], v[164:167]
  ds_read_b64_tr_b16 v[102:103], v8 offset:6144
  v_mfma_f32_16x16x32_bf16 v[168:171], v[56:59], v[40:43], v[168:171]
  ds_read_b64_tr_b16 v[104:105], v9 offset:4096
  v_mfma_f32_16x16x32_bf16 v[172:175], v[56:59], v[44:47], v[172:175]
  ds_read_b64_tr_b16 v[106:107], v9 offset:6144
  v_mfma_f32_16x16x32_bf16 v[176:179], v[60:63], v[32:35], v[176:179]
  ds_read_b64_tr_b16 v[108:109], v6 offset:12288
  v_mfma_f32_16x16x32_bf16 v[180:183], v[60:63], v[36:39], v[180:183]
  ds_read_b64_tr_b16 v[110:111], v6 offset:14336
  v_mfma_f32_16x16x32_bf16 v[184:187], v[60:63], v[40:43], v[184:187]
  ds_read_b64_tr_b16 v[112:113], v7 offset:12288
  v_mfma_f32_16x16x32_bf16 v[188:191], v[60:63], v[44:47], v[188:191]
  ds_read_b64_tr_b16 v[114:115], v7 offset:14336
  v_mfma_f32_16x16x32_bf16 v[192:195], v[64:67], v[32:35], v[192:195]
  ds_read_b64_tr_b16 v[116:117], v10 offset:2048
  v_mfma_f32_16x16x32_bf16 v[196:199], v[64:67], v[36:39], v[196:199]
  ds_read_b64_tr_b16 v[118:119], v10 offset:3072
  v_mfma_f32_16x16x32_bf16 v[200:203], v[64:67], v[40:43], v[200:203]
  s_add_u32 s16, s16, s17
  s_cmp_eq_u32 s16, 65536
  s_cselect_b32 s23, s18, s17
  v_mfma_f32_16x16x32_bf16 v[204:207], v[64:67], v[44:47], v[204:207]
  s_cselect_b32 s16, 0, s16
  v_add_u32 v4, s23, v4
  v_add_u32_e64 v5, s23, v5
  v_mfma_f32_16x16x32_bf16 v[208:211], v[68:71], v[32:35], v[208:211]
  s_add_u32 s19, s19, s20
  s_cmp_eq_u32 s19, 86016
  s_cselect_b32 s23, s21, s20
  v_mfma_f32_16x16x32_bf16 v[212:215], v[68:71], v[36:39], v[212:215]
  s_cselect_b32 s19, 0, s19
  v_add_u32 v6, s23, v6
  v_add_u32_e64 v7, s23, v7
  v_mfma_f32_16x16x32_bf16 v[216:219], v[68:71], v[40:43], v[216:219]
  v_add_u32 v8, s23, v8
  v_add_u32 v9, s23, v9
  v_add_u32_e64 v10, s23, v10
  v_mfma_f32_16x16x32_bf16 v[220:223], v[68:71], v[44:47], v[220:223]
  v_mfma_f32_16x16x32_bf16 v[224:227], v[72:75], v[32:35], v[224:227]
  v_mfma_f32_16x16x32_bf16 v[228:231], v[72:75], v[36:39], v[228:231]
  v_mfma_f32_16x16x32_bf16 v[232:235], v[72:75], v[40:43], v[232:235]
  v_mfma_f32_16x16x32_bf16 v[236:239], v[72:75], v[44:47], v[236:239]
  s_waitcnt lgkmcnt(0)
  s_cbranch_vccnz Lo_15
  s_nop 0
  s_barrier
Lo_15:
  v_mfma_f32_16x16x32_bf16 v[128:131], v[92:95], v[76:79], v[128:131]
  ds_read_b64_tr_b16 v[48:49], v6 offset:0
  v_mfma_f32_16x16x32_bf16 v[132:135], v[92:95], v[80:83], v[132:135]
  ds_read_b64_tr_b16 v[50:51], v6 offset:2048
  v_mfma_f32_16x16x32_bf16 v[136:139], v[92:95], v[84:87], v[136:139]
  ds_read_b128 v[32:35], v4 offset:0
  v_mfma_f32_16x16x32_bf16 v[140:143], v[92:95], v[88:91], v[140:143]
  ds_read_b128 v[36:39], v4 offset:2048
  v_mfma_f32_16x16x32_bf16 v[144:147], v[96:99], v[76:79], v[144:147]
  ds_read_b128 v[40:43], v4 offset:4096
  v_mfma_f32_16x16x32_bf16 v[148:151], v[96:99], v[80:83], v[148:151]
  ds_read_b128 v[44:47], v4 offset:6144
  v_mfma_f32_16x16x32_bf16 v[152:155], v[96:99], v[84:87], v[152:155]
  ds_read_b64_tr_b16 v[52:53], v7 offset:0
  v_mfma_f32_16x16x32_bf16 v[156:159], v[96:99], v[88:91], v[156:159]
  ds_read_b64_tr_b16 v[54:55], v7 offset:2048
  v_mfma_f32_16x16x32_bf16 v[160:163], v[100:103], v[76:79], v[160:163]
  ds_read_b64_tr_b16 v[56:57], v8 offset:0
  v_mfma_f32_16x16x32_bf16 v[164:167], v[100:103], v[80:83], v[164:167]
  ds_read_b64_tr_b16 v[58:59], v8 offset:2048
  v_mfma_f32_16x16x32_bf16 v[168:171], v[100:103], v[84:87], v[168:171]
  ds_read_b64_tr_b16 v[60:61], v9 offset:0
  v_mfma_f32_16x16x32_bf16 v[172:175], v[100:103], v[88:91], v[172:175]
  ds_read_b64_tr_b16 v[62:63], v9 offset:2048
  v_mfma_f32_16x16x32_bf16 v[176:179], v[104:107], v[76:79], v[176:179]
  ds_read_b64_tr_b16 v[64:65], v6 offset:8192
  v_mfma_f32_16x16x32_bf16 v[180:183], v[104:107], v[80:83], v[180:183]
  ds_read_b64_tr_b16 v[66:67], v6 offset:10240
  v_mfma_f32_16x16x32_bf16 v[184:187], v[104:107], v[84:87], v[184:187]
  ds_read_b64_tr_b16 v[68:69], v7 offset:8192
  v_mfma_f32_16x16x32_bf16 v[188:191], v[104:107], v[88:91], v[188:191]
  ds_read_b64_tr_b16 v[70:71], v7 offset:10240
  v_mfma_f32_16x16x32_bf16 v[192:195], v[108:111], v[76:79], v[192:195]
  ds_read_b64_tr_b16 v[72:73], v10 offset:0
  v_mfma_f32_16x16x32_bf16 v[196:199], v[108:111], v[80:83], v[196:199]
  ds_read_b64_tr_b16 v[74:75], v10 offset:1024
  v_mfma_f32_16x16x32_bf16 v[200:203], v[108:111], v[84:87], v[200:203]
  s_sub_u32 s22, s22, Lz1-Lz0+1
  v_mfma_f32_16x16x32_bf16 v[204:207], v[108:111], v[88:91], v[204:207]
  s_cmp_lg_u32 s22, Lz1-Lz0+0
  v_mfma_f32_16x16x32_bf16 v[208:211], v[112:115], v[76:79], v[208:211]
  v_mfma_f32_16x16x32_bf16 v[212:215], v[112:115], v[80:83], v[212:215]
  v_mfma_f32_16x16x32_bf16 v[216:219], v[112:115], v[84:87], v[216:219]
  v_mfma_f32_16x16x32_bf16 v[220:223], v[112:115], v[88:91], v[220:223]
  v_mfma_f32_16x16x32_bf16 v[224:227], v[116:119], v[76:79], v[224:227]
  v_mfma_f32_16x16x32_bf16 v[228:231], v[116:119], v[80:83], v[228:231]
  v_mfma_f32_16x16x32_bf16 v[232:235], v[116:119], v[84:87], v[232:235]
  v_mfma_f32_16x16x32_bf16 v[236:239], v[116:119], v[88:91], v[236:239]
  s_cbranch_vccnz Lo_14
  s_cbranch_scc1 Lk_16
  s_nop 0
  s_waitcnt lgkmcnt(0)
  s_mul_i32 s4, s85, 320
  s_add_u32 s4, s4, 151552
  v_and_b32_e64 v2, 15, v1
  v_lshl_add_u32 v3, v2, 2, s4
  ds_read2_b32 v[88:89], v3 offset0:0 offset1:160
  ds_read2_b32 v[90:91], v3 offset0:16 offset1:176
  ds_read2_b32 v[92:93], v3 offset0:32 offset1:192
  ds_read2_b32 v[94:95], v3 offset0:48 offset1:208
  s_mul_i32 s5, s86, 384
  s_add_u32 s5, s5, 154112
  v_add_u32 v3, s5, v29
  s_lshl_b32 s5, s86, 6
  s_add_u32 s5, s5, 154880
  v_add_u32_e64 v2, s5, v29
  ds_read_b128 v[32:35], v3 offset:0
  ds_read_b128 v[36:39], v3 offset:1024
  ds_read_b128 v[40:43], v3 offset:64
  ds_read_b128 v[44:47], v3 offset:1088
  ds_read_b128 v[80:83], v2 offset:0
  ds_read_b128 v[84:87], v2 offset:1024
  ds_read_b128 v[48:51], v3 offset:128
  ds_read_b128 v[52:55], v3 offset:1152
  ds_read_b128 v[56:59], v3 offset:192
  ds_read_b128 v[60:63], v3 offset:1216
  v_mov_b32 v96, 0x409d30fc
  v_mov_b32 v97, 0x3eeff558
  v_and_b32_e64 v2, 32, v1
  v_mad_u32_u24 v98, v2, 48, v11
  s_mul_i32 s4, s76, 56
  s_mul_i32 s5, s79, 28
  s_add_u32 s4, s4, s5
  s_add_u32 s6, s4, s80
  s_lshl_b32 s6, s6, Lz1-Lz0+14
  s_add_u32 s6, s6, 11599872
  s_add_u32 s7, s6, 4096
  s_lshr_b32 s5, s80, 1
  s_add_u32 s4, s4, s5
  s_lshl_b32 s4, s4, 1
  s_add_u32 s4, s4, s85
  s_lshl_b32 s4, s4, Lz1-Lz0+3
  s_and_b32 s5, s80, 1
  s_add_u32 s4, s4, s5
  s_lshl_b32 s4, s4, 1
  s_add_u32 s4, s4, s86
  s_lshl_b32 s8, s4, 9
  s_add_u32 s8, s8, 11534336
  s_waitcnt lgkmcnt(6)
  ds_read_b128 v[64:67], v3 offset:256
  ds_read_b128 v[68:71], v3 offset:1280
  ds_read_b128 v[72:75], v3 offset:320
  ds_read_b128 v[76:79], v3 offset:1344
  v_pk_mul_f32 v[88:89], v[88:89], v[96:97] op_sel:[0,1] op_sel_hi:[1,1]
  v_pk_mul_f32 v[90:91], v[90:91], v[96:97] op_sel:[0,1] op_sel_hi:[1,1]
  v_pk_mul_f32 v[92:93], v[92:93], v[96:97] op_sel:[0,1] op_sel_hi:[1,1]
  v_pk_mul_f32 v[94:95], v[94:95], v[96:97] op_sel:[0,1] op_sel_hi:[1,1]
  s_lshl_b32 s4, s79, Lz1-Lz0+3
  s_lshl_b32 s10, 0xff, s4
  v_pk_fma_f32 v[100:101], v[32:33], v[88:89], v[36:37] op_sel:[0,1,0] op_sel_hi:[1,1,1] neg_lo:[0,1,0] neg_hi:[0,1,0]
  v_pk_fma_f32 v[102:103], v[34:35], v[88:89], v[38:39] op_sel:[0,1,0] op_sel_hi:[1,1,1] neg_lo:[0,1,0] neg_hi:[0,1,0]
  v_pk_fma_f32 v[104:105], v[40:41], v[88:89], v[44:45] op_sel:[0,1,0] op_sel_hi:[1,1,1] neg_lo:[0,1,0] neg_hi:[0,1,0]
  v_pk_fma_f32 v[106:107], v[42:43], v[88:89], v[46:47] op_sel:[0,1,0] op_sel_hi:[1,1,1] neg_lo:[0,1,0] neg_hi:[0,1,0]
  v_pk_fma_f32 v[128:129], v[128:129], v[88:89], v[100:101] op_sel:[0,0,0] op_sel_hi:[1,0,1]
  v_pk_fma_f32 v[130:131], v[130:131], v[88:89], v[102:103] op_sel:[0,0,0] op_sel_hi:[1,0,1]
  v_pk_fma_f32 v[144:145], v[144:145], v[88:89], v[104:105] op_sel:[0,0,0] op_sel_hi:[1,0,1]
  v_pk_fma_f32 v[146:147], v[146:147], v[88:89], v[106:107] op_sel:[0,0,0] op_sel_hi:[1,0,1]
  v_pk_fma_f32 v[100:101], v[128:129], v[128:129], v[96:97] op_sel_hi:[1,1,0]
  v_pk_fma_f32 v[102:103], v[130:131], v[130:131], v[96:97] op_sel_hi:[1,1,0]
  v_pk_fma_f32 v[104:105], v[144:145], v[144:145], v[96:97] op_sel_hi:[1,1,0]
  v_pk_fma_f32 v[106:107], v[146:147], v[146:147], v[96:97] op_sel_hi:[1,1,0]
  v_pk_mul_f32 v[100:101], v[100:101], v[128:129] neg_lo:[0,1] neg_hi:[0,1]
  v_pk_mul_f32 v[102:103], v[102:103], v[130:131] neg_lo:[0,1] neg_hi:[0,1]
  v_pk_mul_f32 v[104:105], v[104:105], v[144:145] neg_lo:[0,1] neg_hi:[0,1]
  v_pk_mul_f32 v[106:107], v[106:107], v[146:147] neg_lo:[0,1] neg_hi:[0,1]
  v_exp_f32 v100, v100
  v_exp_f32 v101, v101
  v_exp_f32 v102, v102
  v_exp_f32 v103, v103
  v_exp_f32 v104, v104
  v_exp_f32 v105, v105
  v_exp_f32 v106, v106
  v_exp_f32 v107, v107
  v_pk_fma_f32 v[100:101], v[100:101], v[96:97], v[96:97] op_sel:[0,1,1] op_sel_hi:[1,1,1]
  v_pk_fma_f32 v[102:103], v[102:103], v[96:97], v[96:97] op_sel:[0,1,1] op_sel_hi:[1,1,1]
  v_pk_fma_f32 v[104:105], v[104:105], v[96:97], v[96:97] op_sel:[0,1,1] op_sel_hi:[1,1,1]
  v_pk_fma_f32 v[106:107], v[106:107], v[96:97], v[96:97] op_sel:[0,1,1] op_sel_hi:[1,1,1]
  v_rcp_f32 v100, v100
  v_rcp_f32 v101, v101
  v_rcp_f32 v102, v102
  v_rcp_f32 v103, v103
  v_rcp_f32 v104, v104
  v_rcp_f32 v105, v105
  v_rcp_f32 v106, v106
  v_rcp_f32 v107, v107
  v_pk_mul_f32 v[128:129], v[128:129], v[100:101]
  v_pk_mul_f32 v[130:131], v[130:131], v[102:103]
  v_pk_mul_f32 v[144:145], v[144:145], v[104:105]
  v_pk_mul_f32 v[146:147], v[146:147], v[106:107]
  v_cvt_pk_bf16_f32 v116, v128, v129
  v_cvt_pk_bf16_f32 v117, v130, v131
  v_cvt_pk_bf16_f32 v118, v144, v145
  v_cvt_pk_bf16_f32 v119, v146, v147
  buffer_store_dwordx4 v[116:119], v0, s[40:43], s6 offen offset:0 sc0 sc1
  ds_write_b128 v0, v[116:119] offset:0
  v_pk_fma_f32 v[100:101], v[32:33], v[90:91], v[36:37] op_sel:[0,1,0] op_sel_hi:[1,1,1] neg_lo:[0,1,0] neg_hi:[0,1,0]
  v_pk_fma_f32 v[102:103], v[34:35], v[90:91], v[38:39] op_sel:[0,1,0] op_sel_hi:[1,1,1] neg_lo:[0,1,0] neg_hi:[0,1,0]
  v_pk_fma_f32 v[104:105], v[40:41], v[90:91], v[44:45] op_sel:[0,1,0] op_sel_hi:[1,1,1] neg_lo:[0,1,0] neg_hi:[0,1,0]
  v_pk_fma_f32 v[106:107], v[42:43], v[90:91], v[46:47] op_sel:[0,1,0] op_sel_hi:[1,1,1] neg_lo:[0,1,0] neg_hi:[0,1,0]
  v_pk_fma_f32 v[132:133], v[132:133], v[90:91], v[100:101] op_sel:[0,0,0] op_sel_hi:[1,0,1]
  v_pk_fma_f32 v[134:135], v[134:135], v[90:91], v[102:103] op_sel:[0,0,0] op_sel_hi:[1,0,1]
  v_pk_fma_f32 v[148:149], v[148:149], v[90:91], v[104:105] op_sel:[0,0,0] op_sel_hi:[1,0,1]
  v_pk_fma_f32 v[150:151], v[150:151], v[90:91], v[106:107] op_sel:[0,0,0] op_sel_hi:[1,0,1]
  v_pk_fma_f32 v[100:101], v[132:133], v[132:133], v[96:97] op_sel_hi:[1,1,0]
  v_pk_fma_f32 v[102:103], v[134:135], v[134:135], v[96:97] op_sel_hi:[1,1,0]
  v_pk_fma_f32 v[104:105], v[148:149], v[148:149], v[96:97] op_sel_hi:[1,1,0]
  v_pk_fma_f32 v[106:107], v[150:151], v[150:151], v[96:97] op_sel_hi:[1,1,0]
  v_pk_mul_f32 v[100:101], v[100:101], v[132:133] neg_lo:[0,1] neg_hi:[0,1]
  v_pk_mul_f32 v[102:103], v[102:103], v[134:135] neg_lo:[0,1] neg_hi:[0,1]
  v_pk_mul_f32 v[104:105], v[104:105], v[148:149] neg_lo:[0,1] neg_hi:[0,1]
  v_pk_mul_f32 v[106:107], v[106:107], v[150:151] neg_lo:[0,1] neg_hi:[0,1]
  v_exp_f32 v100, v100
  v_exp_f32 v101, v101
  v_exp_f32 v102, v102
  v_exp_f32 v103, v103
  v_exp_f32 v104, v104
  v_exp_f32 v105, v105
  v_exp_f32 v106, v106
  v_exp_f32 v107, v107
  v_pk_fma_f32 v[100:101], v[100:101], v[96:97], v[96:97] op_sel:[0,1,1] op_sel_hi:[1,1,1]
  v_pk_fma_f32 v[102:103], v[102:103], v[96:97], v[96:97] op_sel:[0,1,1] op_sel_hi:[1,1,1]
  v_pk_fma_f32 v[104:105], v[104:105], v[96:97], v[96:97] op_sel:[0,1,1] op_sel_hi:[1,1,1]
  v_pk_fma_f32 v[106:107], v[106:107], v[96:97], v[96:97] op_sel:[0,1,1] op_sel_hi:[1,1,1]
  v_rcp_f32 v100, v100
  v_rcp_f32 v101, v101
  v_rcp_f32 v102, v102
  v_rcp_f32 v103, v103
  v_rcp_f32 v104, v104
  v_rcp_f32 v105, v105
  v_rcp_f32 v106, v106
  v_rcp_f32 v107, v107
  v_pk_mul_f32 v[132:133], v[132:133], v[100:101]
  v_pk_mul_f32 v[134:135], v[134:135], v[102:103]
  v_pk_mul_f32 v[148:149], v[148:149], v[104:105]
  v_pk_mul_f32 v[150:151], v[150:151], v[106:107]
  v_cvt_pk_bf16_f32 v120, v132, v133
  v_cvt_pk_bf16_f32 v121, v134, v135
  v_cvt_pk_bf16_f32 v122, v148, v149
  v_cvt_pk_bf16_f32 v123, v150, v151
  buffer_store_dwordx4 v[120:123], v0, s[40:43], s6 offen offset:2048 sc0 sc1
  ds_write_b128 v0, v[120:123] offset:2048
  s_add_u32 s6, s6, 0x20000
  v_pk_fma_f32 v[100:101], v[32:33], v[92:93], v[36:37] op_sel:[0,1,0] op_sel_hi:[1,1,1] neg_lo:[0,1,0] neg_hi:[0,1,0]
  v_pk_fma_f32 v[102:103], v[34:35], v[92:93], v[38:39] op_sel:[0,1,0] op_sel_hi:[1,1,1] neg_lo:[0,1,0] neg_hi:[0,1,0]
  v_pk_fma_f32 v[104:105], v[40:41], v[92:93], v[44:45] op_sel:[0,1,0] op_sel_hi:[1,1,1] neg_lo:[0,1,0] neg_hi:[0,1,0]
  v_pk_fma_f32 v[106:107], v[42:43], v[92:93], v[46:47] op_sel:[0,1,0] op_sel_hi:[1,1,1] neg_lo:[0,1,0] neg_hi:[0,1,0]
  v_pk_fma_f32 v[136:137], v[136:137], v[92:93], v[100:101] op_sel:[0,0,0] op_sel_hi:[1,0,1]
  v_pk_fma_f32 v[138:139], v[138:139], v[92:93], v[102:103] op_sel:[0,0,0] op_sel_hi:[1,0,1]
  v_pk_fma_f32 v[152:153], v[152:153], v[92:93], v[104:105] op_sel:[0,0,0] op_sel_hi:[1,0,1]
  v_pk_fma_f32 v[154:155], v[154:155], v[92:93], v[106:107] op_sel:[0,0,0] op_sel_hi:[1,0,1]
  v_pk_fma_f32 v[100:101], v[136:137], v[136:137], v[96:97] op_sel_hi:[1,1,0]
  v_pk_fma_f32 v[102:103], v[138:139], v[138:139], v[96:97] op_sel_hi:[1,1,0]
  v_pk_fma_f32 v[104:105], v[152:153], v[152:153], v[96:97] op_sel_hi:[1,1,0]
  v_pk_fma_f32 v[106:107], v[154:155], v[154:155], v[96:97] op_sel_hi:[1,1,0]
  v_pk_mul_f32 v[100:101], v[100:101], v[136:137] neg_lo:[0,1] neg_hi:[0,1]
  v_pk_mul_f32 v[102:103], v[102:103], v[138:139] neg_lo:[0,1] neg_hi:[0,1]
  v_pk_mul_f32 v[104:105], v[104:105], v[152:153] neg_lo:[0,1] neg_hi:[0,1]
  v_pk_mul_f32 v[106:107], v[106:107], v[154:155] neg_lo:[0,1] neg_hi:[0,1]
  v_exp_f32 v100, v100
  v_exp_f32 v101, v101
  v_exp_f32 v102, v102
  v_exp_f32 v103, v103
  v_exp_f32 v104, v104
  v_exp_f32 v105, v105
  v_exp_f32 v106, v106
  v_exp_f32 v107, v107
  v_pk_fma_f32 v[100:101], v[100:101], v[96:97], v[96:97] op_sel:[0,1,1] op_sel_hi:[1,1,1]
  v_pk_fma_f32 v[102:103], v[102:103], v[96:97], v[96:97] op_sel:[0,1,1] op_sel_hi:[1,1,1]
  v_pk_fma_f32 v[104:105], v[104:105], v[96:97], v[96:97] op_sel:[0,1,1] op_sel_hi:[1,1,1]
  v_pk_fma_f32 v[106:107], v[106:107], v[96:97], v[96:97] op_sel:[0,1,1] op_sel_hi:[1,1,1]
  v_rcp_f32 v100, v100
  v_rcp_f32 v101, v101
  v_rcp_f32 v102, v102
  v_rcp_f32 v103, v103
  v_rcp_f32 v104, v104
  v_rcp_f32 v105, v105
  v_rcp_f32 v106, v106
  v_rcp_f32 v107, v107
  v_pk_mul_f32 v[136:137], v[136:137], v[100:101]
  v_pk_mul_f32 v[138:139], v[138:139], v[102:103]
  v_pk_mul_f32 v[152:153], v[152:153], v[104:105]
  v_pk_mul_f32 v[154:155], v[154:155], v[106:107]
  v_cvt_pk_bf16_f32 v116, v136, v137
  v_cvt_pk_bf16_f32 v117, v138, v139
  v_cvt_pk_bf16_f32 v118, v152, v153
  v_cvt_pk_bf16_f32 v119, v154, v155
  buffer_store_dwordx4 v[116:119], v0, s[40:43], s7 offen offset:0 sc0 sc1
  ds_write_b128 v0, v[116:119] offset:4096
  v_pk_fma_f32 v[100:101], v[32:33], v[94:95], v[36:37] op_sel:[0,1,0] op_sel_hi:[1,1,1] neg_lo:[0,1,0] neg_hi:[0,1,0]
  v_pk_fma_f32 v[102:103], v[34:35], v[94:95], v[38:39] op_sel:[0,1,0] op_sel_hi:[1,1,1] neg_lo:[0,1,0] neg_hi:[0,1,0]
  v_pk_fma_f32 v[104:105], v[40:41], v[94:95], v[44:45] op_sel:[0,1,0] op_sel_hi:[1,1,1] neg_lo:[0,1,0] neg_hi:[0,1,0]
  v_pk_fma_f32 v[106:107], v[42:43], v[94:95], v[46:47] op_sel:[0,1,0] op_sel_hi:[1,1,1] neg_lo:[0,1,0] neg_hi:[0,1,0]
  v_pk_fma_f32 v[140:141], v[140:141], v[94:95], v[100:101] op_sel:[0,0,0] op_sel_hi:[1,0,1]
  v_pk_fma_f32 v[142:143], v[142:143], v[94:95], v[102:103] op_sel:[0,0,0] op_sel_hi:[1,0,1]
  v_pk_fma_f32 v[156:157], v[156:157], v[94:95], v[104:105] op_sel:[0,0,0] op_sel_hi:[1,0,1]
  v_pk_fma_f32 v[158:159], v[158:159], v[94:95], v[106:107] op_sel:[0,0,0] op_sel_hi:[1,0,1]
  v_pk_fma_f32 v[100:101], v[140:141], v[140:141], v[96:97] op_sel_hi:[1,1,0]
  v_pk_fma_f32 v[102:103], v[142:143], v[142:143], v[96:97] op_sel_hi:[1,1,0]
  v_pk_fma_f32 v[104:105], v[156:157], v[156:157], v[96:97] op_sel_hi:[1,1,0]
  v_pk_fma_f32 v[106:107], v[158:159], v[158:159], v[96:97] op_sel_hi:[1,1,0]
  v_pk_mul_f32 v[100:101], v[100:101], v[140:141] neg_lo:[0,1] neg_hi:[0,1]
  v_pk_mul_f32 v[102:103], v[102:103], v[142:143] neg_lo:[0,1] neg_hi:[0,1]
  v_pk_mul_f32 v[104:105], v[104:105], v[156:157] neg_lo:[0,1] neg_hi:[0,1]
  v_pk_mul_f32 v[106:107], v[106:107], v[158:159] neg_lo:[0,1] neg_hi:[0,1]
  v_exp_f32 v100, v100
  v_exp_f32 v101, v101
  v_exp_f32 v102, v102
  v_exp_f32 v103, v103
  v_exp_f32 v104, v104
  v_exp_f32 v105, v105
  v_exp_f32 v106, v106
  v_exp_f32 v107, v107
  v_pk_fma_f32 v[100:101], v[100:101], v[96:97], v[96:97] op_sel:[0,1,1] op_sel_hi:[1,1,1]
  v_pk_fma_f32 v[102:103], v[102:103], v[96:97], v[96:97] op_sel:[0,1,1] op_sel_hi:[1,1,1]
  v_pk_fma_f32 v[104:105], v[104:105], v[96:97], v[96:97] op_sel:[0,1,1] op_sel_hi:[1,1,1]
  v_pk_fma_f32 v[106:107], v[106:107], v[96:97], v[96:97] op_sel:[0,1,1] op_sel_hi:[1,1,1]
  v_rcp_f32 v100, v100
  v_rcp_f32 v101, v101
  v_rcp_f32 v102, v102
  v_rcp_f32 v103, v103
  v_rcp_f32 v104, v104
  v_rcp_f32 v105, v105
  v_rcp_f32 v106, v106
  v_rcp_f32 v107, v107
  v_pk_mul_f32 v[140:141], v[140:141], v[100:101]
  v_pk_mul_f32 v[142:143], v[142:143], v[102:103]
  v_pk_mul_f32 v[156:157], v[156:157], v[104:105]
  v_pk_mul_f32 v[158:159], v[158:159], v[106:107]
  v_cvt_pk_bf16_f32 v120, v140, v141
  v_cvt_pk_bf16_f32 v121, v142, v143
  v_cvt_pk_bf16_f32 v122, v156, v157
  v_cvt_pk_bf16_f32 v123, v158, v159
  buffer_store_dwordx4 v[120:123], v0, s[40:43], s7 offen offset:2048 sc0 sc1
  ds_write_b128 v0, v[120:123] offset:6144
  s_add_u32 s7, s7, 0x20000
  s_nop 0
  s_waitcnt lgkmcnt(0)
  v_pk_fma_f32 v[100:101], v[80:81], v[88:89], v[84:85] op_sel:[0,1,0] op_sel_hi:[1,1,1] neg_lo:[0,1,0] neg_hi:[0,1,0]
  v_pk_fma_f32 v[102:103], v[82:83], v[88:89], v[86:87] op_sel:[0,1,0] op_sel_hi:[1,1,1] neg_lo:[0,1,0] neg_hi:[0,1,0]
  v_pk_fma_f32 v[104:105], v[80:81], v[90:91], v[84:85] op_sel:[0,1,0] op_sel_hi:[1,1,1] neg_lo:[0,1,0] neg_hi:[0,1,0]
  v_pk_fma_f32 v[106:107], v[82:83], v[90:91], v[86:87] op_sel:[0,1,0] op_sel_hi:[1,1,1] neg_lo:[0,1,0] neg_hi:[0,1,0]
  v_pk_fma_f32 v[224:225], v[224:225], v[88:89], v[100:101] op_sel:[0,0,0] op_sel_hi:[1,0,1]
  v_pk_fma_f32 v[226:227], v[226:227], v[88:89], v[102:103] op_sel:[0,0,0] op_sel_hi:[1,0,1]
  v_pk_fma_f32 v[228:229], v[228:229], v[90:91], v[104:105] op_sel:[0,0,0] op_sel_hi:[1,0,1]
  v_pk_fma_f32 v[230:231], v[230:231], v[90:91], v[106:107] op_sel:[0,0,0] op_sel_hi:[1,0,1]
  v_pk_fma_f32 v[100:101], v[224:225], v[224:225], v[96:97] op_sel_hi:[1,1,0]
  v_pk_fma_f32 v[102:103], v[226:227], v[226:227], v[96:97] op_sel_hi:[1,1,0]
  v_pk_fma_f32 v[104:105], v[228:229], v[228:229], v[96:97] op_sel_hi:[1,1,0]
  v_pk_fma_f32 v[106:107], v[230:231], v[230:231], v[96:97] op_sel_hi:[1,1,0]
  v_pk_mul_f32 v[100:101], v[100:101], v[224:225] neg_lo:[0,1] neg_hi:[0,1]
  v_pk_mul_f32 v[102:103], v[102:103], v[226:227] neg_lo:[0,1] neg_hi:[0,1]
  v_pk_mul_f32 v[104:105], v[104:105], v[228:229] neg_lo:[0,1] neg_hi:[0,1]
  v_pk_mul_f32 v[106:107], v[106:107], v[230:231] neg_lo:[0,1] neg_hi:[0,1]
  v_exp_f32 v100, v100
  v_exp_f32 v101, v101
  v_exp_f32 v102, v102
  v_exp_f32 v103, v103
  v_exp_f32 v104, v104
  v_exp_f32 v105, v105
  v_exp_f32 v106, v106
  v_exp_f32 v107, v107
  v_pk_fma_f32 v[100:101], v[100:101], v[96:97], v[96:97] op_sel:[0,1,1] op_sel_hi:[1,1,1]
  v_pk_fma_f32 v[102:103], v[102:103], v[96:97], v[96:97] op_sel:[0,1,1] op_sel_hi:[1,1,1]
  v_pk_fma_f32 v[104:105], v[104:105], v[96:97], v[96:97] op_sel:[0,1,1] op_sel_hi:[1,1,1]
  v_pk_fma_f32 v[106:107], v[106:107], v[96:97], v[96:97] op_sel:[0,1,1] op_sel_hi:[1,1,1]
  v_rcp_f32 v100, v100
  v_rcp_f32 v101, v101
  v_rcp_f32 v102, v102
  v_rcp_f32 v103, v103
  v_rcp_f32 v104, v104
  v_rcp_f32 v105, v105
  v_rcp_f32 v106, v106
  v_rcp_f32 v107, v107
  v_pk_mul_f32 v[224:225], v[224:225], v[100:101]
  v_pk_mul_f32 v[226:227], v[226:227], v[102:103]
  v_pk_mul_f32 v[228:229], v[228:229], v[104:105]
  v_pk_mul_f32 v[230:231], v[230:231], v[106:107]
  v_cvt_pk_bf16_f32 v116, v224, v225
  v_cvt_pk_bf16_f32 v117, v226, v227
  v_cvt_pk_bf16_f32 v118, v228, v229
  v_cvt_pk_bf16_f32 v119, v230, v231
  s_nop 0
  v_permlane32_swap_b32 v116, v118
  v_permlane32_swap_b32_e64 v117, v119
  buffer_store_dwordx4 v[116:119], v98, s[40:43], s8 offen sc0 sc1
  s_add_u32 s8, s8, 4096
  v_pk_fma_f32 v[100:101], v[80:81], v[92:93], v[84:85] op_sel:[0,1,0] op_sel_hi:[1,1,1] neg_lo:[0,1,0] neg_hi:[0,1,0]
  v_pk_fma_f32 v[102:103], v[82:83], v[92:93], v[86:87] op_sel:[0,1,0] op_sel_hi:[1,1,1] neg_lo:[0,1,0] neg_hi:[0,1,0]
  v_pk_fma_f32 v[104:105], v[80:81], v[94:95], v[84:85] op_sel:[0,1,0] op_sel_hi:[1,1,1] neg_lo:[0,1,0] neg_hi:[0,1,0]
  v_pk_fma_f32 v[106:107], v[82:83], v[94:95], v[86:87] op_sel:[0,1,0] op_sel_hi:[1,1,1] neg_lo:[0,1,0] neg_hi:[0,1,0]
  v_pk_fma_f32 v[232:233], v[232:233], v[92:93], v[100:101] op_sel:[0,0,0] op_sel_hi:[1,0,1]
  v_pk_fma_f32 v[234:235], v[234:235], v[92:93], v[102:103] op_sel:[0,0,0] op_sel_hi:[1,0,1]
  v_pk_fma_f32 v[236:237], v[236:237], v[94:95], v[104:105] op_sel:[0,0,0] op_sel_hi:[1,0,1]
  v_pk_fma_f32 v[238:239], v[238:239], v[94:95], v[106:107] op_sel:[0,0,0] op_sel_hi:[1,0,1]
  v_pk_fma_f32 v[100:101], v[232:233], v[232:233], v[96:97] op_sel_hi:[1,1,0]
  v_pk_fma_f32 v[102:103], v[234:235], v[234:235], v[96:97] op_sel_hi:[1,1,0]
  v_pk_fma_f32 v[104:105], v[236:237], v[236:237], v[96:97] op_sel_hi:[1,1,0]
  v_pk_fma_f32 v[106:107], v[238:239], v[238:239], v[96:97] op_sel_hi:[1,1,0]
  v_pk_mul_f32 v[100:101], v[100:101], v[232:233] neg_lo:[0,1] neg_hi:[0,1]
  v_pk_mul_f32 v[102:103], v[102:103], v[234:235] neg_lo:[0,1] neg_hi:[0,1]
  v_pk_mul_f32 v[104:105], v[104:105], v[236:237] neg_lo:[0,1] neg_hi:[0,1]
  v_pk_mul_f32 v[106:107], v[106:107], v[238:239] neg_lo:[0,1] neg_hi:[0,1]
  v_exp_f32 v100, v100
  v_exp_f32 v101, v101
  v_exp_f32 v102, v102
  v_exp_f32 v103, v103
  v_exp_f32 v104, v104
  v_exp_f32 v105, v105
  v_exp_f32 v106, v106
  v_exp_f32 v107, v107
  v_pk_fma_f32 v[100:101], v[100:101], v[96:97], v[96:97] op_sel:[0,1,1] op_sel_hi:[1,1,1]
  v_pk_fma_f32 v[102:103], v[102:103], v[96:97], v[96:97] op_sel:[0,1,1] op_sel_hi:[1,1,1]
  v_pk_fma_f32 v[104:105], v[104:105], v[96:97], v[96:97] op_sel:[0,1,1] op_sel_hi:[1,1,1]
  v_pk_fma_f32 v[106:107], v[106:107], v[96:97], v[96:97] op_sel:[0,1,1] op_sel_hi:[1,1,1]
  v_rcp_f32 v100, v100
  v_rcp_f32 v101, v101
  v_rcp_f32 v102, v102
  v_rcp_f32 v103, v103
  v_rcp_f32 v104, v104
  v_rcp_f32 v105, v105
  v_rcp_f32 v106, v106
  v_rcp_f32 v107, v107
  v_pk_mul_f32 v[232:233], v[232:233], v[100:101]
  v_pk_mul_f32 v[234:235], v[234:235], v[102:103]
  v_pk_mul_f32 v[236:237], v[236:237], v[104:105]
  v_pk_mul_f32 v[238:239], v[238:239], v[106:107]
  v_cvt_pk_bf16_f32 v120, v232, v233
  v_cvt_pk_bf16_f32 v121, v234, v235
  v_cvt_pk_bf16_f32 v122, v236, v237
  v_cvt_pk_bf16_f32 v123, v238, v239
  s_add_u32 s9, s87, Lz1-Lz0+8
  s_waitcnt vmcnt(1)
  s_mov_b64 exec, 1
  ds_add_rtn_u32 v124, v28, v27 offset:0
  s_mov_b64 exec, -1
  v_permlane32_swap_b32 v120, v122
  v_permlane32_swap_b32_e64 v121, v123
  buffer_store_dwordx4 v[120:123], v98, s[40:43], s8 offen sc0 sc1
  v_pk_fma_f32 v[100:101], v[48:49], v[88:89], v[52:53] op_sel:[0,1,0] op_sel_hi:[1,1,1] neg_lo:[0,1,0] neg_hi:[0,1,0]
  v_pk_fma_f32 v[102:103], v[50:51], v[88:89], v[54:55] op_sel:[0,1,0] op_sel_hi:[1,1,1] neg_lo:[0,1,0] neg_hi:[0,1,0]
  v_pk_fma_f32 v[104:105], v[56:57], v[88:89], v[60:61] op_sel:[0,1,0] op_sel_hi:[1,1,1] neg_lo:[0,1,0] neg_hi:[0,1,0]
  v_pk_fma_f32 v[106:107], v[58:59], v[88:89], v[62:63] op_sel:[0,1,0] op_sel_hi:[1,1,1] neg_lo:[0,1,0] neg_hi:[0,1,0]
  v_pk_fma_f32 v[160:161], v[160:161], v[88:89], v[100:101] op_sel:[0,0,0] op_sel_hi:[1,0,1]
  v_pk_fma_f32 v[162:163], v[162:163], v[88:89], v[102:103] op_sel:[0,0,0] op_sel_hi:[1,0,1]
  v_pk_fma_f32 v[176:177], v[176:177], v[88:89], v[104:105] op_sel:[0,0,0] op_sel_hi:[1,0,1]
  v_pk_fma_f32 v[178:179], v[178:179], v[88:89], v[106:107] op_sel:[0,0,0] op_sel_hi:[1,0,1]
  v_pk_fma_f32 v[100:101], v[160:161], v[160:161], v[96:97] op_sel_hi:[1,1,0]
  v_pk_fma_f32 v[102:103], v[162:163], v[162:163], v[96:97] op_sel_hi:[1,1,0]
  v_pk_fma_f32 v[104:105], v[176:177], v[176:177], v[96:97] op_sel_hi:[1,1,0]
  v_pk_fma_f32 v[106:107], v[178:179], v[178:179], v[96:97] op_sel_hi:[1,1,0]
  v_pk_mul_f32 v[100:101], v[100:101], v[160:161] neg_lo:[0,1] neg_hi:[0,1]
  v_pk_mul_f32 v[102:103], v[102:103], v[162:163] neg_lo:[0,1] neg_hi:[0,1]
  v_pk_mul_f32 v[104:105], v[104:105], v[176:177] neg_lo:[0,1] neg_hi:[0,1]
  v_pk_mul_f32 v[106:107], v[106:107], v[178:179] neg_lo:[0,1] neg_hi:[0,1]
  v_exp_f32 v100, v100
  v_exp_f32 v101, v101
  v_exp_f32 v102, v102
  v_exp_f32 v103, v103
  v_exp_f32 v104, v104
  v_exp_f32 v105, v105
  v_exp_f32 v106, v106
  v_exp_f32 v107, v107
  v_pk_fma_f32 v[100:101], v[100:101], v[96:97], v[96:97] op_sel:[0,1,1] op_sel_hi:[1,1,1]
  v_pk_fma_f32 v[102:103], v[102:103], v[96:97], v[96:97] op_sel:[0,1,1] op_sel_hi:[1,1,1]
  v_pk_fma_f32 v[104:105], v[104:105], v[96:97], v[96:97] op_sel:[0,1,1] op_sel_hi:[1,1,1]
  v_pk_fma_f32 v[106:107], v[106:107], v[96:97], v[96:97] op_sel:[0,1,1] op_sel_hi:[1,1,1]
  v_rcp_f32 v100, v100
  v_rcp_f32 v101, v101
  v_rcp_f32 v102, v102
  v_rcp_f32 v103, v103
  v_rcp_f32 v104, v104
  v_rcp_f32 v105, v105
  v_rcp_f32 v106, v106
  v_rcp_f32 v107, v107
  v_pk_mul_f32 v[160:161], v[160:161], v[100:101]
  v_pk_mul_f32 v[162:163], v[162:163], v[102:103]
  v_pk_mul_f32 v[176:177], v[176:177], v[104:105]
  v_pk_mul_f32 v[178:179], v[178:179], v[106:107]
  v_cvt_pk_bf16_f32 v116, v160, v161
  v_cvt_pk_bf16_f32 v117, v162, v163
  v_cvt_pk_bf16_f32 v118, v176, v177
  v_cvt_pk_bf16_f32 v119, v178, v179
  s_waitcnt lgkmcnt(0)
  v_readfirstlane_b32 s4, v124
  s_and_b32 s4, s4, 3
  s_cmp_lg_u32 s4, 3
  s_cbranch_scc1 Ls_17
  s_mov_b32 exec_lo, s10
  s_mov_b32 exec_hi, 0
  buffer_store_dword v27, v24, s[40:43], s9 offen sc0 sc1
Ls_17:
  s_mov_b64 exec, -1
  buffer_store_dwordx4 v[116:119], v0, s[40:43], s6 offen offset:0 sc0 sc1
  ds_write_b128 v0, v[116:119] offset:16384
  v_pk_fma_f32 v[100:101], v[48:49], v[90:91], v[52:53] op_sel:[0,1,0] op_sel_hi:[1,1,1] neg_lo:[0,1,0] neg_hi:[0,1,0]
  v_pk_fma_f32 v[102:103], v[50:51], v[90:91], v[54:55] op_sel:[0,1,0] op_sel_hi:[1,1,1] neg_lo:[0,1,0] neg_hi:[0,1,0]
  v_pk_fma_f32 v[104:105], v[56:57], v[90:91], v[60:61] op_sel:[0,1,0] op_sel_hi:[1,1,1] neg_lo:[0,1,0] neg_hi:[0,1,0]
  v_pk_fma_f32 v[106:107], v[58:59], v[90:91], v[62:63] op_sel:[0,1,0] op_sel_hi:[1,1,1] neg_lo:[0,1,0] neg_hi:[0,1,0]
  v_pk_fma_f32 v[164:165], v[164:165], v[90:91], v[100:101] op_sel:[0,0,0] op_sel_hi:[1,0,1]
  v_pk_fma_f32 v[166:167], v[166:167], v[90:91], v[102:103] op_sel:[0,0,0] op_sel_hi:[1,0,1]
  v_pk_fma_f32 v[180:181], v[180:181], v[90:91], v[104:105] op_sel:[0,0,0] op_sel_hi:[1,0,1]
  v_pk_fma_f32 v[182:183], v[182:183], v[90:91], v[106:107] op_sel:[0,0,0] op_sel_hi:[1,0,1]
  v_pk_fma_f32 v[100:101], v[164:165], v[164:165], v[96:97] op_sel_hi:[1,1,0]
  v_pk_fma_f32 v[102:103], v[166:167], v[166:167], v[96:97] op_sel_hi:[1,1,0]
  v_pk_fma_f32 v[104:105], v[180:181], v[180:181], v[96:97] op_sel_hi:[1,1,0]
  v_pk_fma_f32 v[106:107], v[182:183], v[182:183], v[96:97] op_sel_hi:[1,1,0]
  v_pk_mul_f32 v[100:101], v[100:101], v[164:165] neg_lo:[0,1] neg_hi:[0,1]
  v_pk_mul_f32 v[102:103], v[102:103], v[166:167] neg_lo:[0,1] neg_hi:[0,1]
  v_pk_mul_f32 v[104:105], v[104:105], v[180:181] neg_lo:[0,1] neg_hi:[0,1]
  v_pk_mul_f32 v[106:107], v[106:107], v[182:183] neg_lo:[0,1] neg_hi:[0,1]
  v_exp_f32 v100, v100
  v_exp_f32 v101, v101
  v_exp_f32 v102, v102
  v_exp_f32 v103, v103
  v_exp_f32 v104, v104
  v_exp_f32 v105, v105
  v_exp_f32 v106, v106
  v_exp_f32 v107, v107
  v_pk_fma_f32 v[100:101], v[100:101], v[96:97], v[96:97] op_sel:[0,1,1] op_sel_hi:[1,1,1]
  v_pk_fma_f32 v[102:103], v[102:103], v[96:97], v[96:97] op_sel:[0,1,1] op_sel_hi:[1,1,1]
  v_pk_fma_f32 v[104:105], v[104:105], v[96:97], v[96:97] op_sel:[0,1,1] op_sel_hi:[1,1,1]
  v_pk_fma_f32 v[106:107], v[106:107], v[96:97], v[96:97] op_sel:[0,1,1] op_sel_hi:[1,1,1]
  v_rcp_f32 v100, v100
  v_rcp_f32 v101, v101
  v_rcp_f32 v102, v102
  v_rcp_f32 v103, v103
  v_rcp_f32 v104, v104
  v_rcp_f32 v105, v105
  v_rcp_f32 v106, v106
  v_rcp_f32 v107, v107
  v_pk_mul_f32 v[164:165], v[164:165], v[100:101]
  v_pk_mul_f32 v[166:167], v[166:167], v[102:103]
  v_pk_mul_f32 v[180:181], v[180:181], v[104:105]
  v_pk_mul_f32 v[182:183], v[182:183], v[106:107]
  v_cvt_pk_bf16_f32 v120, v164, v165
  v_cvt_pk_bf16_f32 v121, v166, v167
  v_cvt_pk_bf16_f32 v122, v180, v181
  v_cvt_pk_bf16_f32 v123, v182, v183
  buffer_store_dwordx4 v[120:123], v0, s[40:43], s6 offen offset:2048 sc0 sc1
  ds_write_b128 v0, v[120:123] offset:18432
  s_add_u32 s6, s6, 0x20000
  v_pk_fma_f32 v[100:101], v[48:49], v[92:93], v[52:53] op_sel:[0,1,0] op_sel_hi:[1,1,1] neg_lo:[0,1,0] neg_hi:[0,1,0]
  v_pk_fma_f32 v[102:103], v[50:51], v[92:93], v[54:55] op_sel:[0,1,0] op_sel_hi:[1,1,1] neg_lo:[0,1,0] neg_hi:[0,1,0]
  v_pk_fma_f32 v[104:105], v[56:57], v[92:93], v[60:61] op_sel:[0,1,0] op_sel_hi:[1,1,1] neg_lo:[0,1,0] neg_hi:[0,1,0]
  v_pk_fma_f32 v[106:107], v[58:59], v[92:93], v[62:63] op_sel:[0,1,0] op_sel_hi:[1,1,1] neg_lo:[0,1,0] neg_hi:[0,1,0]
  v_pk_fma_f32 v[168:169], v[168:169], v[92:93], v[100:101] op_sel:[0,0,0] op_sel_hi:[1,0,1]
  v_pk_fma_f32 v[170:171], v[170:171], v[92:93], v[102:103] op_sel:[0,0,0] op_sel_hi:[1,0,1]
  v_pk_fma_f32 v[184:185], v[184:185], v[92:93], v[104:105] op_sel:[0,0,0] op_sel_hi:[1,0,1]
  v_pk_fma_f32 v[186:187], v[186:187], v[92:93], v[106:107] op_sel:[0,0,0] op_sel_hi:[1,0,1]
  v_pk_fma_f32 v[100:101], v[168:169], v[168:169], v[96:97] op_sel_hi:[1,1,0]
  v_pk_fma_f32 v[102:103], v[170:171], v[170:171], v[96:97] op_sel_hi:[1,1,0]
  v_pk_fma_f32 v[104:105], v[184:185], v[184:185], v[96:97] op_sel_hi:[1,1,0]
  v_pk_fma_f32 v[106:107], v[186:187], v[186:187], v[96:97] op_sel_hi:[1,1,0]
  v_pk_mul_f32 v[100:101], v[100:101], v[168:169] neg_lo:[0,1] neg_hi:[0,1]
  v_pk_mul_f32 v[102:103], v[102:103], v[170:171] neg_lo:[0,1] neg_hi:[0,1]
  v_pk_mul_f32 v[104:105], v[104:105], v[184:185] neg_lo:[0,1] neg_hi:[0,1]
  v_pk_mul_f32 v[106:107], v[106:107], v[186:187] neg_lo:[0,1] neg_hi:[0,1]
  v_exp_f32 v100, v100
  v_exp_f32 v101, v101
  v_exp_f32 v102, v102
  v_exp_f32 v103, v103
  v_exp_f32 v104, v104
  v_exp_f32 v105, v105
  v_exp_f32 v106, v106
  v_exp_f32 v107, v107
  v_pk_fma_f32 v[100:101], v[100:101], v[96:97], v[96:97] op_sel:[0,1,1] op_sel_hi:[1,1,1]
  v_pk_fma_f32 v[102:103], v[102:103], v[96:97], v[96:97] op_sel:[0,1,1] op_sel_hi:[1,1,1]
  v_pk_fma_f32 v[104:105], v[104:105], v[96:97], v[96:97] op_sel:[0,1,1] op_sel_hi:[1,1,1]
  v_pk_fma_f32 v[106:107], v[106:107], v[96:97], v[96:97] op_sel:[0,1,1] op_sel_hi:[1,1,1]
  v_rcp_f32 v100, v100
  v_rcp_f32 v101, v101
  v_rcp_f32 v102, v102
  v_rcp_f32 v103, v103
  v_rcp_f32 v104, v104
  v_rcp_f32 v105, v105
  v_rcp_f32 v106, v106
  v_rcp_f32 v107, v107
  v_pk_mul_f32 v[168:169], v[168:169], v[100:101]
  v_pk_mul_f32 v[170:171], v[170:171], v[102:103]
  v_pk_mul_f32 v[184:185], v[184:185], v[104:105]
  v_pk_mul_f32 v[186:187], v[186:187], v[106:107]
  v_cvt_pk_bf16_f32 v116, v168, v169
  v_cvt_pk_bf16_f32 v117, v170, v171
  v_cvt_pk_bf16_f32 v118, v184, v185
  v_cvt_pk_bf16_f32 v119, v186, v187
  buffer_store_dwordx4 v[116:119], v0, s[40:43], s7 offen offset:0 sc0 sc1
  ds_write_b128 v0, v[116:119] offset:20480
  v_pk_fma_f32 v[100:101], v[48:49], v[94:95], v[52:53] op_sel:[0,1,0] op_sel_hi:[1,1,1] neg_lo:[0,1,0] neg_hi:[0,1,0]
  v_pk_fma_f32 v[102:103], v[50:51], v[94:95], v[54:55] op_sel:[0,1,0] op_sel_hi:[1,1,1] neg_lo:[0,1,0] neg_hi:[0,1,0]
  v_pk_fma_f32 v[104:105], v[56:57], v[94:95], v[60:61] op_sel:[0,1,0] op_sel_hi:[1,1,1] neg_lo:[0,1,0] neg_hi:[0,1,0]
  v_pk_fma_f32 v[106:107], v[58:59], v[94:95], v[62:63] op_sel:[0,1,0] op_sel_hi:[1,1,1] neg_lo:[0,1,0] neg_hi:[0,1,0]
  v_pk_fma_f32 v[172:173], v[172:173], v[94:95], v[100:101] op_sel:[0,0,0] op_sel_hi:[1,0,1]
  v_pk_fma_f32 v[174:175], v[174:175], v[94:95], v[102:103] op_sel:[0,0,0] op_sel_hi:[1,0,1]
  v_pk_fma_f32 v[188:189], v[188:189], v[94:95], v[104:105] op_sel:[0,0,0] op_sel_hi:[1,0,1]
  v_pk_fma_f32 v[190:191], v[190:191], v[94:95], v[106:107] op_sel:[0,0,0] op_sel_hi:[1,0,1]
  v_pk_fma_f32 v[100:101], v[172:173], v[172:173], v[96:97] op_sel_hi:[1,1,0]
  v_pk_fma_f32 v[102:103], v[174:175], v[174:175], v[96:97] op_sel_hi:[1,1,0]
  v_pk_fma_f32 v[104:105], v[188:189], v[188:189], v[96:97] op_sel_hi:[1,1,0]
  v_pk_fma_f32 v[106:107], v[190:191], v[190:191], v[96:97] op_sel_hi:[1,1,0]
  v_pk_mul_f32 v[100:101], v[100:101], v[172:173] neg_lo:[0,1] neg_hi:[0,1]
  v_pk_mul_f32 v[102:103], v[102:103], v[174:175] neg_lo:[0,1] neg_hi:[0,1]
  v_pk_mul_f32 v[104:105], v[104:105], v[188:189] neg_lo:[0,1] neg_hi:[0,1]
  v_pk_mul_f32 v[106:107], v[106:107], v[190:191] neg_lo:[0,1] neg_hi:[0,1]
  v_exp_f32 v100, v100
  v_exp_f32 v101, v101
  v_exp_f32 v102, v102
  v_exp_f32 v103, v103
  v_exp_f32 v104, v104
  v_exp_f32 v105, v105
  v_exp_f32 v106, v106
  v_exp_f32 v107, v107
  v_pk_fma_f32 v[100:101], v[100:101], v[96:97], v[96:97] op_sel:[0,1,1] op_sel_hi:[1,1,1]
  v_pk_fma_f32 v[102:103], v[102:103], v[96:97], v[96:97] op_sel:[0,1,1] op_sel_hi:[1,1,1]
  v_pk_fma_f32 v[104:105], v[104:105], v[96:97], v[96:97] op_sel:[0,1,1] op_sel_hi:[1,1,1]
  v_pk_fma_f32 v[106:107], v[106:107], v[96:97], v[96:97] op_sel:[0,1,1] op_sel_hi:[1,1,1]
  v_rcp_f32 v100, v100
  v_rcp_f32 v101, v101
  v_rcp_f32 v102, v102
  v_rcp_f32 v103, v103
  v_rcp_f32 v104, v104
  v_rcp_f32 v105, v105
  v_rcp_f32 v106, v106
  v_rcp_f32 v107, v107
  v_pk_mul_f32 v[172:173], v[172:173], v[100:101]
  v_pk_mul_f32 v[174:175], v[174:175], v[102:103]
  v_pk_mul_f32 v[188:189], v[188:189], v[104:105]
  v_pk_mul_f32 v[190:191], v[190:191], v[106:107]
  v_cvt_pk_bf16_f32 v120, v172, v173
  v_cvt_pk_bf16_f32 v121, v174, v175
  v_cvt_pk_bf16_f32 v122, v188, v189
  v_cvt_pk_bf16_f32 v123, v190, v191
  buffer_store_dwordx4 v[120:123], v0, s[40:43], s7 offen offset:2048 sc0 sc1
  ds_write_b128 v0, v[120:123] offset:22528
  s_add_u32 s7, s7, 0x20000
  v_pk_fma_f32 v[100:101], v[64:65], v[88:89], v[68:69] op_sel:[0,1,0] op_sel_hi:[1,1,1] neg_lo:[0,1,0] neg_hi:[0,1,0]
  v_pk_fma_f32 v[102:103], v[66:67], v[88:89], v[70:71] op_sel:[0,1,0] op_sel_hi:[1,1,1] neg_lo:[0,1,0] neg_hi:[0,1,0]
  v_pk_fma_f32 v[104:105], v[72:73], v[88:89], v[76:77] op_sel:[0,1,0] op_sel_hi:[1,1,1] neg_lo:[0,1,0] neg_hi:[0,1,0]
  v_pk_fma_f32 v[106:107], v[74:75], v[88:89], v[78:79] op_sel:[0,1,0] op_sel_hi:[1,1,1] neg_lo:[0,1,0] neg_hi:[0,1,0]
  v_pk_fma_f32 v[192:193], v[192:193], v[88:89], v[100:101] op_sel:[0,0,0] op_sel_hi:[1,0,1]
  v_pk_fma_f32 v[194:195], v[194:195], v[88:89], v[102:103] op_sel:[0,0,0] op_sel_hi:[1,0,1]
  v_pk_fma_f32 v[208:209], v[208:209], v[88:89], v[104:105] op_sel:[0,0,0] op_sel_hi:[1,0,1]
  v_pk_fma_f32 v[210:211], v[210:211], v[88:89], v[106:107] op_sel:[0,0,0] op_sel_hi:[1,0,1]
  v_pk_fma_f32 v[100:101], v[192:193], v[192:193], v[96:97] op_sel_hi:[1,1,0]
  v_pk_fma_f32 v[102:103], v[194:195], v[194:195], v[96:97] op_sel_hi:[1,1,0]
  v_pk_fma_f32 v[104:105], v[208:209], v[208:209], v[96:97] op_sel_hi:[1,1,0]
  v_pk_fma_f32 v[106:107], v[210:211], v[210:211], v[96:97] op_sel_hi:[1,1,0]
  v_pk_mul_f32 v[100:101], v[100:101], v[192:193] neg_lo:[0,1] neg_hi:[0,1]
  v_pk_mul_f32 v[102:103], v[102:103], v[194:195] neg_lo:[0,1] neg_hi:[0,1]
  v_pk_mul_f32 v[104:105], v[104:105], v[208:209] neg_lo:[0,1] neg_hi:[0,1]
  v_pk_mul_f32 v[106:107], v[106:107], v[210:211] neg_lo:[0,1] neg_hi:[0,1]
  v_exp_f32 v100, v100
  v_exp_f32 v101, v101
  v_exp_f32 v102, v102
  v_exp_f32 v103, v103
  v_exp_f32 v104, v104
  v_exp_f32 v105, v105
  v_exp_f32 v106, v106
  v_exp_f32 v107, v107
  v_pk_fma_f32 v[100:101], v[100:101], v[96:97], v[96:97] op_sel:[0,1,1] op_sel_hi:[1,1,1]
  v_pk_fma_f32 v[102:103], v[102:103], v[96:97], v[96:97] op_sel:[0,1,1] op_sel_hi:[1,1,1]
  v_pk_fma_f32 v[104:105], v[104:105], v[96:97], v[96:97] op_sel:[0,1,1] op_sel_hi:[1,1,1]
  v_pk_fma_f32 v[106:107], v[106:107], v[96:97], v[96:97] op_sel:[0,1,1] op_sel_hi:[1,1,1]
  v_rcp_f32 v100, v100
  v_rcp_f32 v101, v101
  v_rcp_f32 v102, v102
  v_rcp_f32 v103, v103
  v_rcp_f32 v104, v104
  v_rcp_f32 v105, v105
  v_rcp_f32 v106, v106
  v_rcp_f32 v107, v107
  v_pk_mul_f32 v[192:193], v[192:193], v[100:101]
  v_pk_mul_f32 v[194:195], v[194:195], v[102:103]
  v_pk_mul_f32 v[208:209], v[208:209], v[104:105]
  v_pk_mul_f32 v[210:211], v[210:211], v[106:107]
  v_cvt_pk_bf16_f32 v116, v192, v193
  v_cvt_pk_bf16_f32 v117, v194, v195
  v_cvt_pk_bf16_f32 v118, v208, v209
  v_cvt_pk_bf16_f32 v119, v210, v211
  buffer_store_dwordx4 v[116:119], v0, s[40:43], s6 offen offset:0 sc0 sc1
  ds_write_b128 v0, v[116:119] offset:32768
  v_pk_fma_f32 v[100:101], v[64:65], v[90:91], v[68:69] op_sel:[0,1,0] op_sel_hi:[1,1,1] neg_lo:[0,1,0] neg_hi:[0,1,0]
  v_pk_fma_f32 v[102:103], v[66:67], v[90:91], v[70:71] op_sel:[0,1,0] op_sel_hi:[1,1,1] neg_lo:[0,1,0] neg_hi:[0,1,0]
  v_pk_fma_f32 v[104:105], v[72:73], v[90:91], v[76:77] op_sel:[0,1,0] op_sel_hi:[1,1,1] neg_lo:[0,1,0] neg_hi:[0,1,0]
  v_pk_fma_f32 v[106:107], v[74:75], v[90:91], v[78:79] op_sel:[0,1,0] op_sel_hi:[1,1,1] neg_lo:[0,1,0] neg_hi:[0,1,0]
  v_pk_fma_f32 v[196:197], v[196:197], v[90:91], v[100:101] op_sel:[0,0,0] op_sel_hi:[1,0,1]
  v_pk_fma_f32 v[198:199], v[198:199], v[90:91], v[102:103] op_sel:[0,0,0] op_sel_hi:[1,0,1]
  v_pk_fma_f32 v[212:213], v[212:213], v[90:91], v[104:105] op_sel:[0,0,0] op_sel_hi:[1,0,1]
  v_pk_fma_f32 v[214:215], v[214:215], v[90:91], v[106:107] op_sel:[0,0,0] op_sel_hi:[1,0,1]
  v_pk_fma_f32 v[100:101], v[196:197], v[196:197], v[96:97] op_sel_hi:[1,1,0]
  v_pk_fma_f32 v[102:103], v[198:199], v[198:199], v[96:97] op_sel_hi:[1,1,0]
  v_pk_fma_f32 v[104:105], v[212:213], v[212:213], v[96:97] op_sel_hi:[1,1,0]
  v_pk_fma_f32 v[106:107], v[214:215], v[214:215], v[96:97] op_sel_hi:[1,1,0]
  v_pk_mul_f32 v[100:101], v[100:101], v[196:197] neg_lo:[0,1] neg_hi:[0,1]
  v_pk_mul_f32 v[102:103], v[102:103], v[198:199] neg_lo:[0,1] neg_hi:[0,1]
  v_pk_mul_f32 v[104:105], v[104:105], v[212:213] neg_lo:[0,1] neg_hi:[0,1]
  v_pk_mul_f32 v[106:107], v[106:107], v[214:215] neg_lo:[0,1] neg_hi:[0,1]
  v_exp_f32 v100, v100
  v_exp_f32 v101, v101
  v_exp_f32 v102, v102
  v_exp_f32 v103, v103
  v_exp_f32 v104, v104
  v_exp_f32 v105, v105
  v_exp_f32 v106, v106
  v_exp_f32 v107, v107
  v_pk_fma_f32 v[100:101], v[100:101], v[96:97], v[96:97] op_sel:[0,1,1] op_sel_hi:[1,1,1]
  v_pk_fma_f32 v[102:103], v[102:103], v[96:97], v[96:97] op_sel:[0,1,1] op_sel_hi:[1,1,1]
  v_pk_fma_f32 v[104:105], v[104:105], v[96:97], v[96:97] op_sel:[0,1,1] op_sel_hi:[1,1,1]
  v_pk_fma_f32 v[106:107], v[106:107], v[96:97], v[96:97] op_sel:[0,1,1] op_sel_hi:[1,1,1]
  v_rcp_f32 v100, v100
  v_rcp_f32 v101, v101
  v_rcp_f32 v102, v102
  v_rcp_f32 v103, v103
  v_rcp_f32 v104, v104
  v_rcp_f32 v105, v105
  v_rcp_f32 v106, v106
  v_rcp_f32 v107, v107
  v_pk_mul_f32 v[196:197], v[196:197], v[100:101]
  v_pk_mul_f32 v[198:199], v[198:199], v[102:103]
  v_pk_mul_f32 v[212:213], v[212:213], v[104:105]
  v_pk_mul_f32 v[214:215], v[214:215], v[106:107]
  v_cvt_pk_bf16_f32 v120, v196, v197
  v_cvt_pk_bf16_f32 v121, v198, v199
  v_cvt_pk_bf16_f32 v122, v212, v213
  v_cvt_pk_bf16_f32 v123, v214, v215
  buffer_store_dwordx4 v[120:123], v0, s[40:43], s6 offen offset:2048 sc0 sc1
  ds_write_b128 v0, v[120:123] offset:34816
  v_pk_fma_f32 v[100:101], v[64:65], v[92:93], v[68:69] op_sel:[0,1,0] op_sel_hi:[1,1,1] neg_lo:[0,1,0] neg_hi:[0,1,0]
  v_pk_fma_f32 v[102:103], v[66:67], v[92:93], v[70:71] op_sel:[0,1,0] op_sel_hi:[1,1,1] neg_lo:[0,1,0] neg_hi:[0,1,0]
  v_pk_fma_f32 v[104:105], v[72:73], v[92:93], v[76:77] op_sel:[0,1,0] op_sel_hi:[1,1,1] neg_lo:[0,1,0] neg_hi:[0,1,0]
  v_pk_fma_f32 v[106:107], v[74:75], v[92:93], v[78:79] op_sel:[0,1,0] op_sel_hi:[1,1,1] neg_lo:[0,1,0] neg_hi:[0,1,0]
  v_pk_fma_f32 v[200:201], v[200:201], v[92:93], v[100:101] op_sel:[0,0,0] op_sel_hi:[1,0,1]
  v_pk_fma_f32 v[202:203], v[202:203], v[92:93], v[102:103] op_sel:[0,0,0] op_sel_hi:[1,0,1]
  v_pk_fma_f32 v[216:217], v[216:217], v[92:93], v[104:105] op_sel:[0,0,0] op_sel_hi:[1,0,1]
  v_pk_fma_f32 v[218:219], v[218:219], v[92:93], v[106:107] op_sel:[0,0,0] op_sel_hi:[1,0,1]
  v_pk_fma_f32 v[100:101], v[200:201], v[200:201], v[96:97] op_sel_hi:[1,1,0]
  v_pk_fma_f32 v[102:103], v[202:203], v[202:203], v[96:97] op_sel_hi:[1,1,0]
  v_pk_fma_f32 v[104:105], v[216:217], v[216:217], v[96:97] op_sel_hi:[1,1,0]
  v_pk_fma_f32 v[106:107], v[218:219], v[218:219], v[96:97] op_sel_hi:[1,1,0]
  v_pk_mul_f32 v[100:101], v[100:101], v[200:201] neg_lo:[0,1] neg_hi:[0,1]
  v_pk_mul_f32 v[102:103], v[102:103], v[202:203] neg_lo:[0,1] neg_hi:[0,1]
  v_pk_mul_f32 v[104:105], v[104:105], v[216:217] neg_lo:[0,1] neg_hi:[0,1]
  v_pk_mul_f32 v[106:107], v[106:107], v[218:219] neg_lo:[0,1] neg_hi:[0,1]
  v_exp_f32 v100, v100
  v_exp_f32 v101, v101
  v_exp_f32 v102, v102
  v_exp_f32 v103, v103
  v_exp_f32 v104, v104
  v_exp_f32 v105, v105
  v_exp_f32 v106, v106
  v_exp_f32 v107, v107
  v_pk_fma_f32 v[100:101], v[100:101], v[96:97], v[96:97] op_sel:[0,1,1] op_sel_hi:[1,1,1]
  v_pk_fma_f32 v[102:103], v[102:103], v[96:97], v[96:97] op_sel:[0,1,1] op_sel_hi:[1,1,1]
  v_pk_fma_f32 v[104:105], v[104:105], v[96:97], v[96:97] op_sel:[0,1,1] op_sel_hi:[1,1,1]
  v_pk_fma_f32 v[106:107], v[106:107], v[96:97], v[96:97] op_sel:[0,1,1] op_sel_hi:[1,1,1]
  v_rcp_f32 v100, v100
  v_rcp_f32 v101, v101
  v_rcp_f32 v102, v102
  v_rcp_f32 v103, v103
  v_rcp_f32 v104, v104
  v_rcp_f32 v105, v105
  v_rcp_f32 v106, v106
  v_rcp_f32 v107, v107
  v_pk_mul_f32 v[200:201], v[200:201], v[100:101]
  v_pk_mul_f32 v[202:203], v[202:203], v[102:103]
  v_pk_mul_f32 v[216:217], v[216:217], v[104:105]
  v_pk_mul_f32 v[218:219], v[218:219], v[106:107]
  v_cvt_pk_bf16_f32 v116, v200, v201
  v_cvt_pk_bf16_f32 v117, v202, v203
  v_cvt_pk_bf16_f32 v118, v216, v217
  v_cvt_pk_bf16_f32 v119, v218, v219
  buffer_store_dwordx4 v[116:119], v0, s[40:43], s7 offen offset:0 sc0 sc1
  ds_write_b128 v0, v[116:119] offset:36864
  v_pk_fma_f32 v[100:101], v[64:65], v[94:95], v[68:69] op_sel:[0,1,0] op_sel_hi:[1,1,1] neg_lo:[0,1,0] neg_hi:[0,1,0]
  v_pk_fma_f32 v[102:103], v[66:67], v[94:95], v[70:71] op_sel:[0,1,0] op_sel_hi:[1,1,1] neg_lo:[0,1,0] neg_hi:[0,1,0]
  v_pk_fma_f32 v[104:105], v[72:73], v[94:95], v[76:77] op_sel:[0,1,0] op_sel_hi:[1,1,1] neg_lo:[0,1,0] neg_hi:[0,1,0]
  v_pk_fma_f32 v[106:107], v[74:75], v[94:95], v[78:79] op_sel:[0,1,0] op_sel_hi:[1,1,1] neg_lo:[0,1,0] neg_hi:[0,1,0]
  v_pk_fma_f32 v[204:205], v[204:205], v[94:95], v[100:101] op_sel:[0,0,0] op_sel_hi:[1,0,1]
  v_pk_fma_f32 v[206:207], v[206:207], v[94:95], v[102:103] op_sel:[0,0,0] op_sel_hi:[1,0,1]
  v_pk_fma_f32 v[220:221], v[220:221], v[94:95], v[104:105] op_sel:[0,0,0] op_sel_hi:[1,0,1]
  v_pk_fma_f32 v[222:223], v[222:223], v[94:95], v[106:107] op_sel:[0,0,0] op_sel_hi:[1,0,1]
  v_pk_fma_f32 v[100:101], v[204:205], v[204:205], v[96:97] op_sel_hi:[1,1,0]
  v_pk_fma_f32 v[102:103], v[206:207], v[206:207], v[96:97] op_sel_hi:[1,1,0]
  v_pk_fma_f32 v[104:105], v[220:221], v[220:221], v[96:97] op_sel_hi:[1,1,0]
  v_pk_fma_f32 v[106:107], v[222:223], v[222:223], v[96:97] op_sel_hi:[1,1,0]
  v_pk_mul_f32 v[100:101], v[100:101], v[204:205] neg_lo:[0,1] neg_hi:[0,1]
  v_pk_mul_f32 v[102:103], v[102:103], v[206:207] neg_lo:[0,1] neg_hi:[0,1]
  v_pk_mul_f32 v[104:105], v[104:105], v[220:221] neg_lo:[0,1] neg_hi:[0,1]
  v_pk_mul_f32 v[106:107], v[106:107], v[222:223] neg_lo:[0,1] neg_hi:[0,1]
  v_exp_f32 v100, v100
  v_exp_f32 v101, v101
  v_exp_f32 v102, v102
  v_exp_f32 v103, v103
  v_exp_f32 v104, v104
  v_exp_f32 v105, v105
  v_exp_f32 v106, v106
  v_exp_f32 v107, v107
  v_pk_fma_f32 v[100:101], v[100:101], v[96:97], v[96:97] op_sel:[0,1,1] op_sel_hi:[1,1,1]
  v_pk_fma_f32 v[102:103], v[102:103], v[96:97], v[96:97] op_sel:[0,1,1] op_sel_hi:[1,1,1]
  v_pk_fma_f32 v[104:105], v[104:105], v[96:97], v[96:97] op_sel:[0,1,1] op_sel_hi:[1,1,1]
  v_pk_fma_f32 v[106:107], v[106:107], v[96:97], v[96:97] op_sel:[0,1,1] op_sel_hi:[1,1,1]
  v_rcp_f32 v100, v100
  v_rcp_f32 v101, v101
  v_rcp_f32 v102, v102
  v_rcp_f32 v103, v103
  v_rcp_f32 v104, v104
  v_rcp_f32 v105, v105
  v_rcp_f32 v106, v106
  v_rcp_f32 v107, v107
  v_pk_mul_f32 v[204:205], v[204:205], v[100:101]
  v_pk_mul_f32 v[206:207], v[206:207], v[102:103]
  v_pk_mul_f32 v[220:221], v[220:221], v[104:105]
  v_pk_mul_f32 v[222:223], v[222:223], v[106:107]
  v_cvt_pk_bf16_f32 v120, v204, v205
  v_cvt_pk_bf16_f32 v121, v206, v207
  v_cvt_pk_bf16_f32 v122, v220, v221
  v_cvt_pk_bf16_f32 v123, v222, v223
  buffer_store_dwordx4 v[120:123], v0, s[40:43], s7 offen offset:2048 sc0 sc1
  ds_write_b128 v0, v[120:123] offset:38912
  s_mov_b32 s16, Lz1-Lz0+0
  s_mov_b32 s17, 16384
  s_mov_b32 s18, 0xffff4000
  s_mov_b32 s19, 32768
  s_mov_b32 s20, 16384
  s_mov_b32 s21, 0xffff0000
  s_mul_i32 s4, s85, 8192
  v_add_u32_e64 v4, s4, v11
  v_add_u32 v5, 1024, v4
  s_lshl_b32 s4, s86, 1
  v_xor_b32 v2, s4, v26
  v_lshl_add_u32 v6, v2, 5, v25
  v_add_u32 v6, s19, v6
  s_add_u32 s4, s4, 1
  v_xor_b32_e64 v2, s4, v26
  v_lshl_add_u32 v7, v2, 5, v25
  v_add_u32_e64 v7, s19, v7
  s_mov_b32 s4, 0xffff0000
  v_lshlrev_b32 v128, 16, v240
  v_and_b32 v129, s4, v240
  v_lshlrev_b32 v130, 16, v241
  v_and_b32 v131, s4, v241
  v_lshlrev_b32 v132, 16, v242
  v_and_b32 v133, s4, v242
  v_lshlrev_b32 v134, 16, v243
  v_and_b32 v135, s4, v243
  v_lshlrev_b32 v136, 16, v244
  v_and_b32 v137, s4, v244
  v_lshlrev_b32 v138, 16, v245
  v_and_b32 v139, s4, v245
  v_lshlrev_b32 v140, 16, v246
  v_and_b32 v141, s4, v246
  v_lshlrev_b32 v142, 16, v247
  v_and_b32 v143, s4, v247
  v_lshlrev_b32 v144, 16, v248
  v_and_b32 v145, s4, v248
  v_lshlrev_b32 v146, 16, v249
  v_and_b32 v147, s4, v249
  v_lshlrev_b32 v148, 16, v250
  v_and_b32 v149, s4, v250
  v_lshlrev_b32 v150, 16, v251
  v_and_b32 v151, s4, v251
  v_lshlrev_b32 v152, 16, v252
  v_and_b32 v153, s4, v252
  v_lshlrev_b32 v154, 16, v253
  v_and_b32 v155, s4, v253
  v_lshlrev_b32 v156, 16, v254
  v_and_b32 v157, s4, v254
  v_lshlrev_b32 v158, 16, v255
  v_and_b32 v159, s4, v255
  s_lshl_b32 s5, s86, Lz1-Lz0+7
  s_add_u32 s5, s5, 156160
  v_add_u32_e64 v3, s5, v29
  ds_read_b128 v[32:35], v3
  ds_read_b128 v[36:39], v3 offset:64
  v_mov_b64 v[160:161], 0
  v_mov_b64 v[162:163], 0
  v_mov_b64 v[164:165], 0
  v_mov_b64 v[166:167], 0
  v_mov_b64 v[168:169], 0
  v_mov_b64 v[170:171], 0
  v_mov_b64 v[172:173], 0
  v_mov_b64 v[174:175], 0
  v_mov_b64 v[176:177], 0
  v_mov_b64 v[178:179], 0
  v_mov_b64 v[180:181], 0
  v_mov_b64 v[182:183], 0
  v_mov_b64 v[184:185], 0
  v_mov_b64 v[186:187], 0
  v_mov_b64_e64 v[188:189], 0
  v_mov_b64 v[190:191], 0
  s_waitcnt lgkmcnt(0)
  v_pk_add_f32 v[128:129], v[128:129], v[32:33]
  v_pk_add_f32 v[130:131], v[130:131], v[34:35]
  v_pk_add_f32 v[132:133], v[132:133], v[36:37]
  v_pk_add_f32 v[134:135], v[134:135], v[38:39]
  v_pk_add_f32 v[136:137], v[136:137], v[32:33]
  v_pk_add_f32 v[138:139], v[138:139], v[34:35]
  v_pk_add_f32 v[140:141], v[140:141], v[36:37]
  v_pk_add_f32 v[142:143], v[142:143], v[38:39]
  v_pk_add_f32 v[144:145], v[144:145], v[32:33]
  v_pk_add_f32 v[146:147], v[146:147], v[34:35]
  v_pk_add_f32 v[148:149], v[148:149], v[36:37]
  v_pk_add_f32 v[150:151], v[150:151], v[38:39]
  v_pk_add_f32 v[152:153], v[152:153], v[32:33]
  v_pk_add_f32 v[154:155], v[154:155], v[34:35]
  v_pk_add_f32 v[156:157], v[156:157], v[36:37]
  v_pk_add_f32 v[158:159], v[158:159], v[38:39]
  s_lshl_b32 s8, s84, Lz1-Lz0+3
  s_lshl_b32 s7, s81, 12
  s_add_u32 s8, s8, s7
  s_xor_b32 s6, s8, 131072
  s_add_u32 s6, s6, 26214400
  s_add_u32 s8, s8, 26214400
  s_mov_b32 s22, 12
  s_barrier
  ds_read_b64_tr_b16 v[48:49], v6 offset:0
  ds_read_b64_tr_b16 v[50:51], v6 offset:2048
  ds_read_b128 v[32:35], v4 offset:0
  ds_read_b128 v[36:39], v4 offset:2048
  ds_read_b128 v[40:43], v4 offset:4096
  ds_read_b128 v[44:47], v4 offset:6144
  ds_read_b64_tr_b16 v[52:53], v7 offset:0
  ds_read_b64_tr_b16 v[54:55], v7 offset:2048
  ds_read_b64_tr_b16 v[56:57], v6 offset:8192
  ds_read_b64_tr_b16 v[58:59], v6 offset:10240
  ds_read_b64_tr_b16 v[60:61], v7 offset:8192
  ds_read_b64_tr_b16 v[62:63], v7 offset:10240
  ds_read_b64_tr_b16 v[80:81], v6 offset:4096
  s_nop 0
  s_waitcnt lgkmcnt(4)
  ds_read_b64_tr_b16 v[82:83], v6 offset:6144
  ds_read_b128 v[64:67], v5 offset:0
  ds_read_b128 v[68:71], v5 offset:2048
  ds_read_b128 v[72:75], v5 offset:4096
  ds_read_b128 v[76:79], v5 offset:6144
  ds_read_b64_tr_b16 v[84:85], v7 offset:4096
  ds_read_b64_tr_b16 v[86:87], v7 offset:6144
  ds_read_b64_tr_b16 v[88:89], v6 offset:12288
  ds_read_b64_tr_b16 v[90:91], v6 offset:14336
  ds_read_b64_tr_b16 v[92:93], v7 offset:12288
  ds_read_b64_tr_b16 v[94:95], v7 offset:14336
  s_add_u32 s16, s16, s17
  s_cmp_eq_u32 s16, 65536
  s_cselect_b32 s23, s18, s17
  s_cselect_b32 s16, 0, s16
  v_add_u32 v4, s23, v4
  v_add_u32 v5, s23, v5
  s_add_u32 s19, s19, s20
  s_cmp_eq_u32 s19, 81920
  s_cselect_b32 s23, s21, s20
  s_cselect_b32 s19, 0, s19
  v_add_u32 v6, s23, v6
  v_add_u32 v7, s23, v7
  s_waitcnt lgkmcnt(0)
Lk_18:
  s_barrier
  v_mfma_f32_16x16x32_bf16 v[128:131], v[48:51], v[32:35], v[128:131]
  ds_read_b64_tr_b16 v[112:113], v6 offset:0
  v_mfma_f32_16x16x32_bf16 v[136:139], v[48:51], v[36:39], v[136:139]
  ds_read_b64_tr_b16 v[114:115], v6 offset:2048
  v_mfma_f32_16x16x32_bf16 v[144:147], v[48:51], v[40:43], v[144:147]
  ds_read_b128 v[96:99], v4 offset:0
  v_mfma_f32_16x16x32_bf16 v[152:155], v[48:51], v[44:47], v[152:155]
  ds_read_b128 v[100:103], v4 offset:2048
  v_mfma_f32_16x16x32_bf16 v[132:135], v[52:55], v[32:35], v[132:135]
  ds_read_b128 v[104:107], v4 offset:4096
  v_mfma_f32_16x16x32_bf16 v[140:143], v[52:55], v[36:39], v[140:143]
  ds_read_b128 v[108:111], v4 offset:6144
  v_mfma_f32_16x16x32_bf16 v[148:151], v[52:55], v[40:43], v[148:151]
  ds_read_b64_tr_b16 v[116:117], v7 offset:0
  v_mfma_f32_16x16x32_bf16 v[156:159], v[52:55], v[44:47], v[156:159]
  ds_read_b64_tr_b16 v[118:119], v7 offset:2048
  v_mfma_f32_16x16x32_bf16 v[160:163], v[56:59], v[32:35], v[160:163]
  ds_read_b64_tr_b16 v[120:121], v6 offset:8192
  v_mfma_f32_16x16x32_bf16 v[168:171], v[56:59], v[36:39], v[168:171]
  ds_read_b64_tr_b16 v[122:123], v6 offset:10240
  v_mfma_f32_16x16x32_bf16 v[176:179], v[56:59], v[40:43], v[176:179]
  ds_read_b64_tr_b16 v[124:125], v7 offset:8192
  v_mfma_f32_16x16x32_bf16 v[184:187], v[56:59], v[44:47], v[184:187]
  ds_read_b64_tr_b16 v[126:127], v7 offset:10240
  v_mfma_f32_16x16x32_bf16 v[164:167], v[60:63], v[32:35], v[164:167]
  ds_read_b64_tr_b16 v[208:209], v6 offset:4096
  v_mfma_f32_16x16x32_bf16 v[172:175], v[60:63], v[36:39], v[172:175]
  ds_read_b64_tr_b16 v[210:211], v6 offset:6144
  v_mfma_f32_16x16x32_bf16 v[180:183], v[60:63], v[40:43], v[180:183]
  ds_read_b128 v[192:195], v5 offset:0
  v_mfma_f32_16x16x32_bf16 v[188:191], v[60:63], v[44:47], v[188:191]
  ds_read_b128 v[196:199], v5 offset:2048
  v_mfma_f32_16x16x32_bf16 v[128:131], v[80:83], v[64:67], v[128:131]
  ds_read_b128 v[200:203], v5 offset:4096
  v_mfma_f32_16x16x32_bf16 v[136:139], v[80:83], v[68:71], v[136:139]
  ds_read_b128 v[204:207], v5 offset:6144
  v_mfma_f32_16x16x32_bf16 v[144:147], v[80:83], v[72:75], v[144:147]
  ds_read_b64_tr_b16 v[212:213], v7 offset:4096
  v_mfma_f32_16x16x32_bf16 v[152:155], v[80:83], v[76:79], v[152:155]
  ds_read_b64_tr_b16 v[214:215], v7 offset:6144
  v_mfma_f32_16x16x32_bf16 v[132:135], v[84:87], v[64:67], v[132:135]
  ds_read_b64_tr_b16 v[216:217], v6 offset:12288
  v_mfma_f32_16x16x32_bf16 v[140:143], v[84:87], v[68:71], v[140:143]
  ds_read_b64_tr_b16 v[218:219], v6 offset:14336
  v_mfma_f32_16x16x32_bf16 v[148:151], v[84:87], v[72:75], v[148:151]
  ds_read_b64_tr_b16 v[220:221], v7 offset:12288
  v_mfma_f32_16x16x32_bf16 v[156:159], v[84:87], v[76:79], v[156:159]
  ds_read_b64_tr_b16 v[222:223], v7 offset:14336
  v_mfma_f32_16x16x32_bf16 v[160:163], v[88:91], v[64:67], v[160:163]
  s_add_u32 s16, s16, s17
  s_cmp_eq_u32 s16, 65536
  s_cselect_b32 s23, s18, s17
  v_mfma_f32_16x16x32_bf16 v[168:171], v[88:91], v[68:71], v[168:171]
  s_cselect_b32 s16, 0, s16
  v_add_u32 v4, s23, v4
  v_add_u32_e64 v5, s23, v5
  v_mfma_f32_16x16x32_bf16 v[176:179], v[88:91], v[72:75], v[176:179]
  s_add_u32 s19, s19, s20
  s_cmp_eq_u32 s19, 81920
  s_cselect_b32 s23, s21, s20
  v_mfma_f32_16x16x32_bf16 v[184:187], v[88:91], v[76:79], v[184:187]
  s_cselect_b32 s19, 0, s19
  v_add_u32 v6, s23, v6
  v_add_u32_e64 v7, s23, v7
  v_mfma_f32_16x16x32_bf16 v[164:167], v[92:95], v[64:67], v[164:167]
  v_mfma_f32_16x16x32_bf16 v[172:175], v[92:95], v[68:71], v[172:175]
  v_mfma_f32_16x16x32_bf16 v[180:183], v[92:95], v[72:75], v[180:183]
  s_nop 0
  s_waitcnt lgkmcnt(0)
  v_mfma_f32_16x16x32_bf16 v[188:191], v[92:95], v[76:79], v[188:191]
  s_waitcnt vmcnt(0)
  s_barrier
  v_mfma_f32_16x16x32_bf16 v[128:131], v[112:115], v[96:99], v[128:131]
  ds_read_b64_tr_b16 v[48:49], v6 offset:0
  v_mfma_f32_16x16x32_bf16 v[136:139], v[112:115], v[100:103], v[136:139]
  ds_read_b64_tr_b16 v[50:51], v6 offset:2048
  v_mfma_f32_16x16x32_bf16 v[144:147], v[112:115], v[104:107], v[144:147]
  ds_read_b128 v[32:35], v4 offset:0
  v_mfma_f32_16x16x32_bf16 v[152:155], v[112:115], v[108:111], v[152:155]
  ds_read_b128 v[36:39], v4 offset:2048
  v_mfma_f32_16x16x32_bf16 v[132:135], v[116:119], v[96:99], v[132:135]
  ds_read_b128 v[40:43], v4 offset:4096
  v_mfma_f32_16x16x32_bf16 v[140:143], v[116:119], v[100:103], v[140:143]
  ds_read_b128 v[44:47], v4 offset:6144
  v_mfma_f32_16x16x32_bf16 v[148:151], v[116:119], v[104:107], v[148:151]
  ds_read_b64_tr_b16 v[52:53], v7 offset:0
  v_mfma_f32_16x16x32_bf16 v[156:159], v[116:119], v[108:111], v[156:159]
  ds_read_b64_tr_b16 v[54:55], v7 offset:2048
  v_mfma_f32_16x16x32_bf16 v[160:163], v[120:123], v[96:99], v[160:163]
  ds_read_b64_tr_b16 v[56:57], v6 offset:8192
  v_mfma_f32_16x16x32_bf16 v[168:171], v[120:123], v[100:103], v[168:171]
  ds_read_b64_tr_b16 v[58:59], v6 offset:10240
  v_mfma_f32_16x16x32_bf16 v[176:179], v[120:123], v[104:107], v[176:179]
  ds_read_b64_tr_b16 v[60:61], v7 offset:8192
  v_mfma_f32_16x16x32_bf16 v[184:187], v[120:123], v[108:111], v[184:187]
  ds_read_b64_tr_b16 v[62:63], v7 offset:10240
  v_mfma_f32_16x16x32_bf16 v[164:167], v[124:127], v[96:99], v[164:167]
  ds_read_b64_tr_b16 v[80:81], v6 offset:4096
  v_mfma_f32_16x16x32_bf16 v[172:175], v[124:127], v[100:103], v[172:175]
  ds_read_b64_tr_b16 v[82:83], v6 offset:6144
  v_mfma_f32_16x16x32_bf16 v[180:183], v[124:127], v[104:107], v[180:183]
  ds_read_b128 v[64:67], v5 offset:0
  v_mfma_f32_16x16x32_bf16 v[188:191], v[124:127], v[108:111], v[188:191]
  ds_read_b128 v[68:71], v5 offset:2048
  v_mfma_f32_16x16x32_bf16 v[128:131], v[208:211], v[192:195], v[128:131]
  ds_read_b128 v[72:75], v5 offset:4096
  v_mfma_f32_16x16x32_bf16 v[136:139], v[208:211], v[196:199], v[136:139]
  ds_read_b128 v[76:79], v5 offset:6144
  v_mfma_f32_16x16x32_bf16 v[144:147], v[208:211], v[200:203], v[144:147]
  ds_read_b64_tr_b16 v[84:85], v7 offset:4096
  v_mfma_f32_16x16x32_bf16 v[152:155], v[208:211], v[204:207], v[152:155]
  ds_read_b64_tr_b16 v[86:87], v7 offset:6144
  v_mfma_f32_16x16x32_bf16 v[132:135], v[212:215], v[192:195], v[132:135]
  ds_read_b64_tr_b16 v[88:89], v6 offset:12288
  v_mfma_f32_16x16x32_bf16 v[140:143], v[212:215], v[196:199], v[140:143]
  ds_read_b64_tr_b16 v[90:91], v6 offset:14336
  v_mfma_f32_16x16x32_bf16 v[148:151], v[212:215], v[200:203], v[148:151]
  ds_read_b64_tr_b16 v[92:93], v7 offset:12288
  v_mfma_f32_16x16x32_bf16 v[156:159], v[212:215], v[204:207], v[156:159]
  ds_read_b64_tr_b16 v[94:95], v7 offset:14336
  v_mfma_f32_16x16x32_bf16 v[160:163], v[216:219], v[192:195], v[160:163]
  s_add_u32 s16, s16, s17
  s_cmp_eq_u32 s16, 65536
  s_cselect_b32 s23, s18, s17
  v_mfma_f32_16x16x32_bf16 v[168:171], v[216:219], v[196:199], v[168:171]
  s_cselect_b32 s16, 0, s16
  v_add_u32 v4, s23, v4
  v_add_u32_e64 v5, s23, v5
  v_mfma_f32_16x16x32_bf16 v[176:179], v[216:219], v[200:203], v[176:179]
  s_add_u32 s19, s19, s20
  s_cmp_eq_u32 s19, 81920
  s_cselect_b32 s23, s21, s20
  v_mfma_f32_16x16x32_bf16 v[184:187], v[216:219], v[204:207], v[184:187]
  s_cselect_b32 s19, 0, s19
  v_add_u32 v6, s23, v6
  v_add_u32_e64 v7, s23, v7
  v_mfma_f32_16x16x32_bf16 v[164:167], v[220:223], v[192:195], v[164:167]
  s_sub_u32 s22, s22, 1
  s_cmp_lg_u32 s22, 0
  v_mfma_f32_16x16x32_bf16 v[172:175], v[220:223], v[196:199], v[172:175]
  v_mfma_f32_16x16x32_bf16 v[180:183], v[220:223], v[200:203], v[180:183]
  s_waitcnt lgkmcnt(0)
  v_mfma_f32_16x16x32_bf16 v[188:191], v[220:223], v[204:207], v[188:191]
  s_cbranch_scc1 Lk_18
  v_cvt_pk_bf16_f32 v160, v160, v161
  v_cvt_pk_bf16_f32 v161, v162, v163
  v_cvt_pk_bf16_f32 v162, v164, v165
  v_cvt_pk_bf16_f32 v163, v166, v167
  buffer_store_dwordx4 v[160:163], v11, s[40:43], s6 offen offset:0 sc0 sc1
  v_cvt_pk_bf16_f32 v164, v168, v169
  v_cvt_pk_bf16_f32 v165, v170, v171
  v_cvt_pk_bf16_f32 v166, v172, v173
  v_cvt_pk_bf16_f32 v167, v174, v175
  buffer_store_dwordx4 v[164:167], v11, s[40:43], s6 offen offset:1024 sc0 sc1
  v_cvt_pk_bf16_f32 v168, v176, v177
  v_cvt_pk_bf16_f32 v169, v178, v179
  v_cvt_pk_bf16_f32 v170, v180, v181
  v_cvt_pk_bf16_f32 v171, v182, v183
  buffer_store_dwordx4 v[168:171], v11, s[40:43], s6 offen offset:2048 sc0 sc1
  v_cvt_pk_bf16_f32 v172, v184, v185
  v_cvt_pk_bf16_f32 v173, v186, v187
  v_cvt_pk_bf16_f32 v174, v188, v189
  v_cvt_pk_bf16_f32 v175, v190, v191
  buffer_store_dwordx4 v[172:175], v11, s[40:43], s6 offen offset:3072 sc0 sc1
  s_nop 0
  s_barrier
  v_mfma_f32_16x16x32_bf16 v[128:131], v[48:51], v[32:35], v[128:131]
  ds_read_b64_tr_b16 v[112:113], v6 offset:0
  ds_read_b64_tr_b16 v[114:115], v6 offset:2048
  v_mfma_f32_16x16x32_bf16 v[136:139], v[48:51], v[36:39], v[136:139]
  ds_read_b128 v[96:99], v4 offset:0
  ds_read_b128 v[100:103], v4 offset:2048
  v_mfma_f32_16x16x32_bf16 v[144:147], v[48:51], v[40:43], v[144:147]
  ds_read_b128 v[104:107], v4 offset:4096
  ds_read_b128 v[108:111], v4 offset:6144
  v_mfma_f32_16x16x32_bf16 v[152:155], v[48:51], v[44:47], v[152:155]
  ds_read_b64_tr_b16 v[116:117], v7 offset:0
  ds_read_b64_tr_b16 v[118:119], v7 offset:2048
  v_mfma_f32_16x16x32_bf16 v[132:135], v[52:55], v[32:35], v[132:135]
  ds_read_b64_tr_b16 v[208:209], v6 offset:4096
  ds_read_b64_tr_b16 v[210:211], v6 offset:6144
  v_mfma_f32_16x16x32_bf16 v[140:143], v[52:55], v[36:39], v[140:143]
  ds_read_b128 v[192:195], v5 offset:0
  ds_read_b128 v[196:199], v5 offset:2048
  v_mfma_f32_16x16x32_bf16 v[148:151], v[52:55], v[40:43], v[148:151]
  ds_read_b128 v[200:203], v5 offset:4096
  ds_read_b128 v[204:207], v5 offset:6144
  v_mfma_f32_16x16x32_bf16 v[156:159], v[52:55], v[44:47], v[156:159]
  ds_read_b64_tr_b16 v[212:213], v7 offset:4096
  ds_read_b64_tr_b16 v[214:215], v7 offset:6144
  v_mfma_f32_16x16x32_bf16 v[128:131], v[80:83], v[64:67], v[128:131]
  s_nop 0
  s_add_u32 s16, s16, s17
  s_cmp_eq_u32 s16, 65536
  v_mfma_f32_16x16x32_bf16 v[136:139], v[80:83], v[68:71], v[136:139]
  s_cselect_b32 s23, s18, s17
  s_cselect_b32 s16, 0, s16
  v_mfma_f32_16x16x32_bf16 v[144:147], v[80:83], v[72:75], v[144:147]
  v_add_u32_e64 v4, s23, v4
  v_add_u32 v5, s23, v5
  v_mfma_f32_16x16x32_bf16 v[152:155], v[80:83], v[76:79], v[152:155]
  s_add_u32 s19, s19, s20
  s_cmp_eq_u32 s19, 81920
  v_mfma_f32_16x16x32_bf16 v[132:135], v[84:87], v[64:67], v[132:135]
  s_cselect_b32 s23, s21, s20
  s_cselect_b32 s19, 0, s19
  v_mfma_f32_16x16x32_bf16 v[140:143], v[84:87], v[68:71], v[140:143]
  v_add_u32 v6, s23, v6
  v_add_u32 v7, s23, v7
  v_mfma_f32_16x16x32_bf16 v[148:151], v[84:87], v[72:75], v[148:151]
  s_waitcnt lgkmcnt(0)
  v_mfma_f32_16x16x32_bf16 v[156:159], v[84:87], v[76:79], v[156:159]
  s_barrier
  v_mfma_f32_16x16x32_bf16 v[128:131], v[112:115], v[96:99], v[128:131]
  ds_read_b64_tr_b16 v[48:49], v6 offset:0
  ds_read_b64_tr_b16 v[50:51], v6 offset:2048
  v_mfma_f32_16x16x32_bf16 v[136:139], v[112:115], v[100:103], v[136:139]
  ds_read_b128 v[32:35], v4 offset:0
  ds_read_b128 v[36:39], v4 offset:2048
  v_mfma_f32_16x16x32_bf16 v[144:147], v[112:115], v[104:107], v[144:147]
  ds_read_b128 v[40:43], v4 offset:4096
  ds_read_b128 v[44:47], v4 offset:6144
  v_mfma_f32_16x16x32_bf16 v[152:155], v[112:115], v[108:111], v[152:155]
  ds_read_b64_tr_b16 v[52:53], v7 offset:0
  ds_read_b64_tr_b16 v[54:55], v7 offset:2048
  v_mfma_f32_16x16x32_bf16 v[132:135], v[116:119], v[96:99], v[132:135]
  ds_read_b64_tr_b16 v[80:81], v6 offset:4096
  ds_read_b64_tr_b16 v[82:83], v6 offset:6144
  v_mfma_f32_16x16x32_bf16 v[140:143], v[116:119], v[100:103], v[140:143]
  ds_read_b128 v[64:67], v5 offset:0
  ds_read_b128 v[68:71], v5 offset:2048
  v_mfma_f32_16x16x32_bf16 v[148:151], v[116:119], v[104:107], v[148:151]
  ds_read_b128 v[72:75], v5 offset:4096
  ds_read_b128 v[76:79], v5 offset:6144
  v_mfma_f32_16x16x32_bf16 v[156:159], v[116:119], v[108:111], v[156:159]
  ds_read_b64_tr_b16 v[84:85], v7 offset:4096
  ds_read_b64_tr_b16 v[86:87], v7 offset:6144
  v_mfma_f32_16x16x32_bf16 v[128:131], v[208:211], v[192:195], v[128:131]
  s_nop 0
  s_add_u32 s16, s16, s17
  s_cmp_eq_u32 s16, 65536
  v_mfma_f32_16x16x32_bf16 v[136:139], v[208:211], v[196:199], v[136:139]
  s_cselect_b32 s23, s18, s17
  s_cselect_b32 s16, 0, s16
  v_mfma_f32_16x16x32_bf16 v[144:147], v[208:211], v[200:203], v[144:147]
  v_add_u32_e64 v4, s23, v4
  v_add_u32 v5, s23, v5
  v_mfma_f32_16x16x32_bf16 v[152:155], v[208:211], v[204:207], v[152:155]
  s_add_u32 s19, s19, s20
  s_cmp_eq_u32 s19, 81920
  v_mfma_f32_16x16x32_bf16 v[132:135], v[212:215], v[192:195], v[132:135]
  s_cselect_b32 s23, s21, s20
  s_cselect_b32 s19, 0, s19
  v_mfma_f32_16x16x32_bf16 v[140:143], v[212:215], v[196:199], v[140:143]
  v_add_u32_e64 v6, s23, v6
  v_add_u32 v7, s23, v7
  v_mfma_f32_16x16x32_bf16 v[148:151], v[212:215], v[200:203], v[148:151]
  s_waitcnt lgkmcnt(0)
  v_mfma_f32_16x16x32_bf16 v[156:159], v[212:215], v[204:207], v[156:159]
  s_waitcnt vmcnt(0)
  s_barrier
  v_mfma_f32_16x16x32_bf16 v[128:131], v[48:51], v[32:35], v[128:131]
  ds_read_b64_tr_b16 v[112:113], v6 offset:0
  ds_read_b64_tr_b16 v[114:115], v6 offset:2048
  v_mfma_f32_16x16x32_bf16 v[136:139], v[48:51], v[36:39], v[136:139]
  ds_read_b128 v[96:99], v4 offset:0
  ds_read_b128 v[100:103], v4 offset:2048
  v_mfma_f32_16x16x32_bf16 v[144:147], v[48:51], v[40:43], v[144:147]
  ds_read_b128 v[104:107], v4 offset:4096
  ds_read_b128 v[108:111], v4 offset:6144
  v_mfma_f32_16x16x32_bf16 v[152:155], v[48:51], v[44:47], v[152:155]
  ds_read_b64_tr_b16 v[116:117], v7 offset:0
  ds_read_b64_tr_b16 v[118:119], v7 offset:2048
  v_mfma_f32_16x16x32_bf16 v[132:135], v[52:55], v[32:35], v[132:135]
  ds_read_b64_tr_b16 v[208:209], v6 offset:4096
  ds_read_b64_tr_b16 v[210:211], v6 offset:6144
  v_mfma_f32_16x16x32_bf16 v[140:143], v[52:55], v[36:39], v[140:143]
  ds_read_b128 v[192:195], v5 offset:0
  ds_read_b128 v[196:199], v5 offset:2048
  v_mfma_f32_16x16x32_bf16 v[148:151], v[52:55], v[40:43], v[148:151]
  ds_read_b128 v[200:203], v5 offset:4096
  ds_read_b128 v[204:207], v5 offset:6144
  v_mfma_f32_16x16x32_bf16 v[156:159], v[52:55], v[44:47], v[156:159]
  ds_read_b64_tr_b16 v[212:213], v7 offset:4096
  ds_read_b64_tr_b16 v[214:215], v7 offset:6144
  v_mfma_f32_16x16x32_bf16 v[128:131], v[80:83], v[64:67], v[128:131]
  s_nop 0
  s_add_u32 s16, s16, s17
  s_cmp_eq_u32 s16, 65536
  v_mfma_f32_16x16x32_bf16 v[136:139], v[80:83], v[68:71], v[136:139]
  s_cselect_b32 s23, s18, s17
  s_cselect_b32 s16, 0, s16
  v_mfma_f32_16x16x32_bf16 v[144:147], v[80:83], v[72:75], v[144:147]
  v_add_u32_e64 v4, s23, v4
  v_add_u32 v5, s23, v5
  v_mfma_f32_16x16x32_bf16 v[152:155], v[80:83], v[76:79], v[152:155]
  s_add_u32 s19, s19, s20
  s_cmp_eq_u32 s19, 81920
  v_mfma_f32_16x16x32_bf16 v[132:135], v[84:87], v[64:67], v[132:135]
  s_cselect_b32 s23, s21, s20
  s_cselect_b32 s19, 0, s19
  v_mfma_f32_16x16x32_bf16 v[140:143], v[84:87], v[68:71], v[140:143]
  v_add_u32 v6, s23, v6
  v_add_u32 v7, s23, v7
  v_mfma_f32_16x16x32_bf16 v[148:151], v[84:87], v[72:75], v[148:151]
  s_waitcnt lgkmcnt(0)
  v_mfma_f32_16x16x32_bf16 v[156:159], v[84:87], v[76:79], v[156:159]
  s_barrier
  v_mfma_f32_16x16x32_bf16 v[128:131], v[112:115], v[96:99], v[128:131]
  ds_read_b64_tr_b16 v[48:49], v6 offset:0
  ds_read_b64_tr_b16 v[50:51], v6 offset:2048
  v_mfma_f32_16x16x32_bf16 v[136:139], v[112:115], v[100:103], v[136:139]
  ds_read_b128 v[32:35], v4 offset:0
  ds_read_b128 v[36:39], v4 offset:2048
  v_mfma_f32_16x16x32_bf16 v[144:147], v[112:115], v[104:107], v[144:147]
  ds_read_b128 v[40:43], v4 offset:4096
  ds_read_b128 v[44:47], v4 offset:6144
  v_mfma_f32_16x16x32_bf16 v[152:155], v[112:115], v[108:111], v[152:155]
  ds_read_b64_tr_b16 v[52:53], v7 offset:0
  ds_read_b64_tr_b16 v[54:55], v7 offset:2048
  v_mfma_f32_16x16x32_bf16 v[132:135], v[116:119], v[96:99], v[132:135]
  ds_read_b64_tr_b16 v[80:81], v6 offset:4096
  ds_read_b64_tr_b16 v[82:83], v6 offset:6144
  v_mfma_f32_16x16x32_bf16 v[140:143], v[116:119], v[100:103], v[140:143]
  ds_read_b128 v[64:67], v5 offset:0
  ds_read_b128 v[68:71], v5 offset:2048
  v_mfma_f32_16x16x32_bf16 v[148:151], v[116:119], v[104:107], v[148:151]
  ds_read_b128 v[72:75], v5 offset:4096
  ds_read_b128 v[76:79], v5 offset:6144
  v_mfma_f32_16x16x32_bf16 v[156:159], v[116:119], v[108:111], v[156:159]
  ds_read_b64_tr_b16 v[84:85], v7 offset:4096
  ds_read_b64_tr_b16 v[86:87], v7 offset:6144
  v_mfma_f32_16x16x32_bf16 v[128:131], v[208:211], v[192:195], v[128:131]
  s_nop 0
  s_add_u32 s16, s16, s17
  s_cmp_eq_u32 s16, 65536
  v_mfma_f32_16x16x32_bf16 v[136:139], v[208:211], v[196:199], v[136:139]
  s_cselect_b32 s23, s18, s17
  s_cselect_b32 s16, 0, s16
  v_mfma_f32_16x16x32_bf16 v[144:147], v[208:211], v[200:203], v[144:147]
  v_add_u32_e64 v4, s23, v4
  v_add_u32 v5, s23, v5
  v_mfma_f32_16x16x32_bf16 v[152:155], v[208:211], v[204:207], v[152:155]
  s_add_u32 s19, s19, s20
  s_cmp_eq_u32 s19, 81920
  v_mfma_f32_16x16x32_bf16 v[132:135], v[212:215], v[192:195], v[132:135]
  s_cselect_b32 s23, s21, s20
  s_cselect_b32 s19, 0, s19
  v_mfma_f32_16x16x32_bf16 v[140:143], v[212:215], v[196:199], v[140:143]
  v_add_u32 v6, s23, v6
  v_add_u32 v7, s23, v7
  v_mfma_f32_16x16x32_bf16 v[148:151], v[212:215], v[200:203], v[148:151]
  s_waitcnt lgkmcnt(0)
  v_mfma_f32_16x16x32_bf16 v[156:159], v[212:215], v[204:207], v[156:159]
  s_barrier
  v_mfma_f32_16x16x32_bf16 v[128:131], v[48:51], v[32:35], v[128:131]
  ds_read_b64_tr_b16 v[112:113], v6 offset:0
  ds_read_b64_tr_b16 v[114:115], v6 offset:2048
  v_mfma_f32_16x16x32_bf16 v[136:139], v[48:51], v[36:39], v[136:139]
  ds_read_b128 v[96:99], v4 offset:0
  ds_read_b128 v[100:103], v4 offset:2048
  v_mfma_f32_16x16x32_bf16 v[144:147], v[48:51], v[40:43], v[144:147]
  ds_read_b128 v[104:107], v4 offset:4096
  ds_read_b128 v[108:111], v4 offset:6144
  v_mfma_f32_16x16x32_bf16 v[152:155], v[48:51], v[44:47], v[152:155]
  ds_read_b64_tr_b16 v[116:117], v7 offset:0
  ds_read_b64_tr_b16 v[118:119], v7 offset:2048
  v_mfma_f32_16x16x32_bf16 v[132:135], v[52:55], v[32:35], v[132:135]
  ds_read_b64_tr_b16 v[208:209], v6 offset:4096
  ds_read_b64_tr_b16 v[210:211], v6 offset:6144
  v_mfma_f32_16x16x32_bf16 v[140:143], v[52:55], v[36:39], v[140:143]
  ds_read_b128 v[192:195], v5 offset:0
  ds_read_b128 v[196:199], v5 offset:2048
  v_mfma_f32_16x16x32_bf16 v[148:151], v[52:55], v[40:43], v[148:151]
  ds_read_b128 v[200:203], v5 offset:4096
  ds_read_b128 v[204:207], v5 offset:6144
  v_mfma_f32_16x16x32_bf16 v[156:159], v[52:55], v[44:47], v[156:159]
  ds_read_b64_tr_b16 v[212:213], v7 offset:4096
  ds_read_b64_tr_b16 v[214:215], v7 offset:6144
  v_mfma_f32_16x16x32_bf16 v[128:131], v[80:83], v[64:67], v[128:131]
  s_nop 0
  s_add_u32 s16, s16, s17
  s_cmp_eq_u32 s16, 65536
  v_mfma_f32_16x16x32_bf16 v[136:139], v[80:83], v[68:71], v[136:139]
  s_cselect_b32 s23, s18, s17
  s_cselect_b32 s16, 0, s16
  v_mfma_f32_16x16x32_bf16 v[144:147], v[80:83], v[72:75], v[144:147]
  v_add_u32_e64 v4, s23, v4
  v_add_u32 v5, s23, v5
  v_mfma_f32_16x16x32_bf16 v[152:155], v[80:83], v[76:79], v[152:155]
  s_add_u32 s19, s19, s20
  s_cmp_eq_u32 s19, 81920
  v_mfma_f32_16x16x32_bf16 v[132:135], v[84:87], v[64:67], v[132:135]
  s_cselect_b32 s23, s21, s20
  s_cselect_b32 s19, 0, s19
  v_mfma_f32_16x16x32_bf16 v[140:143], v[84:87], v[68:71], v[140:143]
  v_add_u32 v6, s23, v6
  v_add_u32 v7, s23, v7
  v_mfma_f32_16x16x32_bf16 v[148:151], v[84:87], v[72:75], v[148:151]
  s_waitcnt lgkmcnt(0)
  v_mfma_f32_16x16x32_bf16 v[156:159], v[84:87], v[76:79], v[156:159]
  s_barrier
  v_mfma_f32_16x16x32_bf16 v[128:131], v[112:115], v[96:99], v[128:131]
  ds_read_b64_tr_b16 v[48:49], v6 offset:0
  ds_read_b64_tr_b16 v[50:51], v6 offset:2048
  v_mfma_f32_16x16x32_bf16 v[136:139], v[112:115], v[100:103], v[136:139]
  ds_read_b128 v[32:35], v4 offset:0
  ds_read_b128 v[36:39], v4 offset:2048
  v_mfma_f32_16x16x32_bf16 v[144:147], v[112:115], v[104:107], v[144:147]
  ds_read_b128 v[40:43], v4 offset:4096
  ds_read_b128 v[44:47], v4 offset:6144
  v_mfma_f32_16x16x32_bf16 v[152:155], v[112:115], v[108:111], v[152:155]
  ds_read_b64_tr_b16 v[52:53], v7 offset:0
  ds_read_b64_tr_b16 v[54:55], v7 offset:2048
  v_mfma_f32_16x16x32_bf16 v[132:135], v[116:119], v[96:99], v[132:135]
  ds_read_b64_tr_b16 v[80:81], v6 offset:4096
  ds_read_b64_tr_b16 v[82:83], v6 offset:6144
  v_mfma_f32_16x16x32_bf16 v[140:143], v[116:119], v[100:103], v[140:143]
  ds_read_b128 v[64:67], v5 offset:0
  ds_read_b128 v[68:71], v5 offset:2048
  v_mfma_f32_16x16x32_bf16 v[148:151], v[116:119], v[104:107], v[148:151]
  ds_read_b128 v[72:75], v5 offset:4096
  ds_read_b128 v[76:79], v5 offset:6144
  v_mfma_f32_16x16x32_bf16 v[156:159], v[116:119], v[108:111], v[156:159]
  ds_read_b64_tr_b16 v[84:85], v7 offset:4096
  ds_read_b64_tr_b16 v[86:87], v7 offset:6144
  v_mfma_f32_16x16x32_bf16 v[128:131], v[208:211], v[192:195], v[128:131]
  s_nop 0
  s_add_u32 s16, s16, s17
  s_cmp_eq_u32 s16, 65536
  v_mfma_f32_16x16x32_bf16 v[136:139], v[208:211], v[196:199], v[136:139]
  s_cselect_b32 s23, s18, s17
  s_cselect_b32 s16, 0, s16
  v_mfma_f32_16x16x32_bf16 v[144:147], v[208:211], v[200:203], v[144:147]
  v_add_u32_e64 v4, s23, v4
  v_add_u32 v5, s23, v5
  v_mfma_f32_16x16x32_bf16 v[152:155], v[208:211], v[204:207], v[152:155]
  s_add_u32 s19, s19, s20
  s_cmp_eq_u32 s19, 81920
  v_mfma_f32_16x16x32_bf16 v[132:135], v[212:215], v[192:195], v[132:135]
  s_cselect_b32 s23, s21, s20
  s_cselect_b32 s19, 0, s19
  v_mfma_f32_16x16x32_bf16 v[140:143], v[212:215], v[196:199], v[140:143]
  v_add_u32 v6, s23, v6
  v_add_u32 v7, s23, v7
  v_mfma_f32_16x16x32_bf16 v[148:151], v[212:215], v[200:203], v[148:151]
  s_waitcnt lgkmcnt(0)
  v_mfma_f32_16x16x32_bf16 v[156:159], v[212:215], v[204:207], v[156:159]
  s_barrier
  v_mfma_f32_16x16x32_bf16 v[128:131], v[48:51], v[32:35], v[128:131]
  ds_read_b64_tr_b16 v[112:113], v6 offset:0
  ds_read_b64_tr_b16 v[114:115], v6 offset:2048
  v_mfma_f32_16x16x32_bf16 v[136:139], v[48:51], v[36:39], v[136:139]
  ds_read_b128 v[96:99], v4 offset:0
  ds_read_b128 v[100:103], v4 offset:2048
  v_mfma_f32_16x16x32_bf16 v[144:147], v[48:51], v[40:43], v[144:147]
  ds_read_b128 v[104:107], v4 offset:4096
  ds_read_b128 v[108:111], v4 offset:6144
  v_mfma_f32_16x16x32_bf16 v[152:155], v[48:51], v[44:47], v[152:155]
  ds_read_b64_tr_b16 v[116:117], v7 offset:0
  ds_read_b64_tr_b16 v[118:119], v7 offset:2048
  v_mfma_f32_16x16x32_bf16 v[132:135], v[52:55], v[32:35], v[132:135]
  ds_read_b64_tr_b16 v[208:209], v6 offset:4096
  ds_read_b64_tr_b16 v[210:211], v6 offset:6144
  v_mfma_f32_16x16x32_bf16 v[140:143], v[52:55], v[36:39], v[140:143]
  ds_read_b128 v[192:195], v5 offset:0
  ds_read_b128 v[196:199], v5 offset:2048
  v_mfma_f32_16x16x32_bf16 v[148:151], v[52:55], v[40:43], v[148:151]
  ds_read_b128 v[200:203], v5 offset:4096
  ds_read_b128 v[204:207], v5 offset:6144
  v_mfma_f32_16x16x32_bf16 v[156:159], v[52:55], v[44:47], v[156:159]
  ds_read_b64_tr_b16 v[212:213], v7 offset:4096
  ds_read_b64_tr_b16 v[214:215], v7 offset:6144
  v_mfma_f32_16x16x32_bf16 v[128:131], v[80:83], v[64:67], v[128:131]
  buffer_load_dwordx4 v[160:163], v11, s[40:43], s8 offen offset:0 sc0 sc1
  v_mfma_f32_16x16x32_bf16 v[136:139], v[80:83], v[68:71], v[136:139]
  buffer_load_dwordx4 v[164:167], v11, s[40:43], s8 offen offset:1024 sc0 sc1
  v_mfma_f32_16x16x32_bf16 v[144:147], v[80:83], v[72:75], v[144:147]
  buffer_load_dwordx4 v[168:171], v11, s[40:43], s8 offen offset:2048 sc0 sc1
  v_mfma_f32_16x16x32_bf16 v[152:155], v[80:83], v[76:79], v[152:155]
  buffer_load_dwordx4 v[172:175], v11, s[40:43], s8 offen offset:3072 sc0 sc1
  v_mfma_f32_16x16x32_bf16 v[132:135], v[84:87], v[64:67], v[132:135]
  v_mfma_f32_16x16x32_bf16 v[140:143], v[84:87], v[68:71], v[140:143]
  v_mfma_f32_16x16x32_bf16 v[148:151], v[84:87], v[72:75], v[148:151]
  s_waitcnt lgkmcnt(0)
  v_mfma_f32_16x16x32_bf16 v[156:159], v[84:87], v[76:79], v[156:159]
  s_barrier
  v_mfma_f32_16x16x32_bf16 v[128:131], v[112:115], v[96:99], v[128:131]
  v_mfma_f32_16x16x32_bf16 v[136:139], v[112:115], v[100:103], v[136:139]
  v_mfma_f32_16x16x32_bf16 v[144:147], v[112:115], v[104:107], v[144:147]
  v_mfma_f32_16x16x32_bf16 v[152:155], v[112:115], v[108:111], v[152:155]
  v_mfma_f32_16x16x32_bf16 v[132:135], v[116:119], v[96:99], v[132:135]
  v_mfma_f32_16x16x32_bf16 v[140:143], v[116:119], v[100:103], v[140:143]
  v_mfma_f32_16x16x32_bf16 v[148:151], v[116:119], v[104:107], v[148:151]
  v_mfma_f32_16x16x32_bf16 v[156:159], v[116:119], v[108:111], v[156:159]
  v_mfma_f32_16x16x32_bf16 v[128:131], v[208:211], v[192:195], v[128:131]
  v_mfma_f32_16x16x32_bf16 v[136:139], v[208:211], v[196:199], v[136:139]
  v_mfma_f32_16x16x32_bf16 v[144:147], v[208:211], v[200:203], v[144:147]
  v_mfma_f32_16x16x32_bf16 v[152:155], v[208:211], v[204:207], v[152:155]
  v_mfma_f32_16x16x32_bf16 v[132:135], v[212:215], v[192:195], v[132:135]
  v_mfma_f32_16x16x32_bf16 v[140:143], v[212:215], v[196:199], v[140:143]
  v_mfma_f32_16x16x32_bf16 v[148:151], v[212:215], v[200:203], v[148:151]
  s_nop 0
  s_waitcnt lgkmcnt(0)
  v_mfma_f32_16x16x32_bf16 v[156:159], v[212:215], v[204:207], v[156:159]
  s_mov_b32 s4, 0xffff0000
  s_waitcnt vmcnt(3)
  v_lshlrev_b32 v32, 16, v160
  v_and_b32 v33, s4, v160
  v_lshlrev_b32 v34, 16, v161
  v_and_b32 v35, s4, v161
  v_lshlrev_b32 v36, 16, v162
  v_and_b32 v37, s4, v162
  v_lshlrev_b32 v38, 16, v163
  v_and_b32_e64 v39, s4, v163
  v_pk_add_f32 v[128:129], v[128:129], v[32:33]
  v_pk_add_f32 v[130:131], v[130:131], v[34:35]
  v_pk_add_f32 v[132:133], v[132:133], v[36:37]
  v_pk_add_f32 v[134:135], v[134:135], v[38:39]
  s_waitcnt vmcnt(2)
  v_lshlrev_b32 v32, 16, v164
  v_and_b32 v33, s4, v164
  v_lshlrev_b32 v34, 16, v165
  v_and_b32 v35, s4, v165
  v_lshlrev_b32 v36, 16, v166
  v_and_b32 v37, s4, v166
  v_lshlrev_b32 v38, 16, v167
  v_and_b32_e64 v39, s4, v167
  v_pk_add_f32 v[136:137], v[136:137], v[32:33]
  v_pk_add_f32 v[138:139], v[138:139], v[34:35]
  v_pk_add_f32 v[140:141], v[140:141], v[36:37]
  v_pk_add_f32 v[142:143], v[142:143], v[38:39]
  s_waitcnt vmcnt(1)
  v_lshlrev_b32 v32, 16, v168
  v_and_b32 v33, s4, v168
  v_lshlrev_b32 v34, 16, v169
  v_and_b32 v35, s4, v169
  v_lshlrev_b32 v36, 16, v170
  v_and_b32 v37, s4, v170
  v_lshlrev_b32 v38, 16, v171
  v_and_b32_e64 v39, s4, v171
  v_pk_add_f32 v[144:145], v[144:145], v[32:33]
  v_pk_add_f32 v[146:147], v[146:147], v[34:35]
  v_pk_add_f32 v[148:149], v[148:149], v[36:37]
  v_pk_add_f32 v[150:151], v[150:151], v[38:39]
  s_waitcnt vmcnt(0)
  v_lshlrev_b32 v32, 16, v172
  v_and_b32 v33, s4, v172
  v_lshlrev_b32 v34, 16, v173
  v_and_b32 v35, s4, v173
  v_lshlrev_b32 v36, 16, v174
  v_and_b32 v37, s4, v174
  v_lshlrev_b32 v38, 16, v175
  v_and_b32_e64 v39, s4, v175
  v_pk_add_f32 v[152:153], v[152:153], v[32:33]
  v_pk_add_f32 v[154:155], v[154:155], v[34:35]
  v_pk_add_f32 v[156:157], v[156:157], v[36:37]
  v_pk_add_f32 v[158:159], v[158:159], v[38:39]
  v_cvt_pk_bf16_f32 v240, v128, v129
  v_cvt_pk_bf16_f32 v241, v130, v131
  v_cvt_pk_bf16_f32 v242, v132, v133
  v_cvt_pk_bf16_f32 v243, v134, v135
  v_cvt_pk_bf16_f32 v244, v136, v137
  v_cvt_pk_bf16_f32 v245, v138, v139
  v_cvt_pk_bf16_f32 v246, v140, v141
  v_cvt_pk_bf16_f32 v247, v142, v143
  v_cvt_pk_bf16_f32 v248, v144, v145
  v_cvt_pk_bf16_f32 v249, v146, v147
  v_cvt_pk_bf16_f32 v250, v148, v149
  v_cvt_pk_bf16_f32 v251, v150, v151
  v_cvt_pk_bf16_f32 v252, v152, v153
  v_cvt_pk_bf16_f32 v253, v154, v155
  v_cvt_pk_bf16_f32 v254, v156, v157
  v_cvt_pk_bf16_f32 v255, v158, v159
  s_cmp_lg_u32 s82, 0
  s_cbranch_scc1 L_cfinal
  s_lshl_b32 s4, s76, 4
  s_add_u32 s4, s4, s78
  s_lshl_b32 s6, s4, Lz1-Lz0+14
  s_add_u32 s6, s6, 35651584
  s_add_u32 s7, s6, 4096
  s_lshl_b32 s5, s78, Lz1-Lz0+1
  buffer_store_dwordx4 v[240:243], v0, s[40:43], s6 offen offset:0 sc0 sc1
  buffer_store_dwordx4 v[244:247], v0, s[40:43], s6 offen offset:2048 sc0 sc1
  buffer_store_dwordx4 v[248:251], v0, s[40:43], s7 offen offset:0 sc0 sc1
  buffer_store_dwordx4 v[252:255], v0, s[40:43], s7 offen offset:2048 sc0 sc1
  v_mov_b32 v40, 0x3f803f80
  v_dot2_f32_bf16 v32, v240, v40, 0
  v_dot2_f32_bf16 v36, v240, v240, 0
  v_dot2_f32_bf16 v33, v244, v40, 0
  v_dot2_f32_bf16 v37, v244, v244, 0
  v_dot2_f32_bf16 v34, v248, v40, 0
  v_dot2_f32_bf16 v38, v248, v248, 0
  v_dot2_f32_bf16 v35, v252, v40, 0
  v_dot2_f32_bf16 v39, v252, v252, 0
  v_dot2_f32_bf16 v32, v241, v40, v32
  v_dot2_f32_bf16 v36, v241, v241, v36
  v_dot2_f32_bf16 v33, v245, v40, v33
  v_dot2_f32_bf16 v37, v245, v245, v37
  v_dot2_f32_bf16 v34, v249, v40, v34
  v_dot2_f32_bf16 v38, v249, v249, v38
  v_dot2_f32_bf16 v35, v253, v40, v35
  v_dot2_f32_bf16 v39, v253, v253, v39
  v_dot2_f32_bf16 v32, v242, v40, v32
  v_dot2_f32_bf16 v36, v242, v242, v36
  v_dot2_f32_bf16 v33, v246, v40, v33
  v_dot2_f32_bf16 v37, v246, v246, v37
  v_dot2_f32_bf16 v34, v250, v40, v34
  v_dot2_f32_bf16 v38, v250, v250, v38
  v_dot2_f32_bf16 v35, v254, v40, v35
  v_dot2_f32_bf16 v39, v254, v254, v39
  v_dot2_f32_bf16 v32, v243, v40, v32
  v_dot2_f32_bf16 v36, v243, v243, v36
  v_dot2_f32_bf16 v33, v247, v40, v33
  v_dot2_f32_bf16 v37, v247, v247, v37
  v_dot2_f32_bf16 v34, v251, v40, v34
  v_dot2_f32_bf16 v38, v251, v251, v38
  v_dot2_f32_bf16 v35, v255, v40, v35
  v_dot2_f32_bf16 v39, v255, v255, v39
  s_lshl_b32 s6, s76, Lz1-Lz0+9
  s_lshl_b32 s7, s85, 8
  s_add_u32 s6, s6, s7
  s_add_u32 s6, s6, s5
  s_add_u32 s6, s6, s86
  s_lshl_b32 s6, s6, 6
  s_add_u32 s6, s6, s83
  s_add_u32 s6, s6, 36700160
  v_permlane32_swap_b32 v32, v34
  v_permlane32_swap_b32 v33, v35
  v_permlane32_swap_b32 v36, v38
  v_permlane32_swap_b32 v37, v39
  v_add_f32 v32, v32, v34
  v_add_f32 v33, v33, v35
  v_add_f32 v36, v36, v38
  v_add_f32 v37, v37, v39
  v_permlane16_swap_b32 v32, v33
  s_nop 0
  v_permlane16_swap_b32 v36, v37
  v_add_f32 v42, v32, v33
  v_add_f32_e64 v43, v36, v37
  buffer_store_dwordx2 v[42:43], v30, s[40:43], s6 offen sc0 sc1
  s_add_u32 s5, s87, 16
  s_sub_u32 s4, s78, s77
  s_lshl_b32 s4, s4, 7
  s_add_u32 s5, s5, s4
  s_waitcnt vmcnt(0)
  s_mov_b64 exec, 1
  ds_add_rtn_u32 v2, v28, v27 offset:0
  s_waitcnt lgkmcnt(0)
  v_readfirstlane_b32 s4, v2
  s_and_b32 s4, s4, Lz1-Lz0+3
  s_cmp_lg_u32 s4, 3
  s_cbranch_scc1 Ls_19
  s_mov_b32 exec_lo, 0xffff
  buffer_store_dword v27, v24, s[40:43], s5 offen sc0 sc1
Ls_19:
  s_mov_b64 exec, -1
  s_mov_b32 s82, 1
  s_add_u32 s83, s83, 0
  s_add_u32 s87, s87, 32
  s_branch L_clayer
  s_nop 0
L_cfinal:
  s_nop 1
  v_permlane16_swap_b32 v240, v242
  v_permlane16_swap_b32 v241, v243
  v_permlane16_swap_b32 v244, v246
  v_permlane16_swap_b32 v245, v247
  v_permlane16_swap_b32 v248, v250
  v_permlane16_swap_b32 v249, v251
  v_permlane16_swap_b32 v252, v254
  v_permlane16_swap_b32 v253, v255
  v_and_b32 v2, 15, v1
  v_lshlrev_b32 v3, 12, v2
  v_and_b32 v2, 16, v1
  v_lshl_add_u32 v3, v2, 1, v3
  v_and_b32 v2, 32, v1
  v_lshrrev_b32 v2, 1, v2
  v_add_u32 v3, v2, v3
  s_lshl_b32 s5, s76, 18
  s_lshl_b32 s4, s85, 11
  s_add_u32 s5, s5, s4
  s_lshl_b32 s4, s78, 7
  s_add_u32 s5, s5, s4
  s_lshl_b32 s4, s86, 6
  s_add_u32 s5, s5, s4
  buffer_store_dwordx4 v[240:243], v3, s[64:67], s5 offen
  s_add_u32 s5, s5, 0x10000
  buffer_store_dwordx4 v[244:247], v3, s[64:67], s5 offen
  s_add_u32 s5, s5, 0x10000
  buffer_store_dwordx4 v[248:251], v3, s[64:67], s5 offen
  s_add_u32 s5, s5, 0x10000
  buffer_store_dwordx4 v[252:255], v3, s[64:67], s5 offen
  s_endpgm
L_w1:
  s_and_b32 s80, s77, 7
  s_lshr_b32 s79, s77, 3
  s_lshl_b32 s78, s80, 1
  s_add_u32 s78, s78, s79
  s_lshl_b32 s5, s76, 4
  s_add_u32 s5, s5, s77
  s_lshl_b32 s84, s5, 11
  s_mov_b32 s83, 3145728
  s_mov_b32 s87, 1835016
  s_lshr_b32 s86, s81, 1
  s_mov_b32 s40, s38
  s_and_b32 s41, s39, 0xffff
  s_mov_b32 s42, 100663296
  s_mov_b32 s43, 0x00020000
  s_nop 0
  s_mov_b32 s52, s20
  s_and_b32 s53, s21, 0xffff
  s_mov_b32 s54, 2097152
  s_mov_b32 s55, 0x00020000
  s_nop 0
  s_mov_b32 s56, s24
  s_and_b32 s57, s25, 0xffff
  s_mov_b32 s58, 7340032
  s_mov_b32 s59, 0x00020000
  s_nop 0
  s_mov_b32 s60, s28
  s_and_b32 s61, s29, 0xffff
  s_mov_b32 s62, 7340032
  s_mov_b32 s63, 0x00020000
  v_lshrrev_b32 v2, 3, v1
  s_movk_i32 s4, 2048
  v_mad_u32_u24 v4, v2, s4, v10
  v_add_u32 v5, 15360, v4
  v_add_u32 v6, 30720, v4
  v_add_u32 v7, 46080, v4
  s_lshl_b32 s5, s78, 7
  s_mul_i32 s4, s85, 65536
  s_add_u32 s5, s5, s4
  s_mov_b32 s8, 131072
  s_mov_b32 s10, 2097152
  s_add_u32 s9, s5, s10
  s_mul_i32 s6, s76, s8
  s_add_u32 s7, s5, s6
  s_lshl_b32 s11, s85, 12
  s_add_u32 s11, s11, 65536
  s_add_u32 s15, s11, 81920
  s_add_u32 s11, s11, 32768
  s_mov_b32 s12, 0
  s_mov_b32 m0, s11
  s_waitcnt vmcnt(12)
  s_barrier
  s_branch Ll_31
Lt_37:
  s_cmp_lg_u32 s12, 2
  s_cbranch_scc1 Lt_35
  s_waitcnt vmcnt(8)
  s_barrier
  s_branch Ll_31
Lt_35:
  s_cmp_lg_u32 s12, 6
  s_cbranch_scc1 Ll_31
  s_barrier
Ll_31:
  buffer_load_dwordx4 v4, s[52:55], s7 offen offset:0 lds
  s_mov_b32 s5, s7
  buffer_load_dwordx4 v5, s[52:55], s5 offen offset:1024 lds
  s_add_u32 s7, s7, s8
  s_cmp_eq_u32 s7, s9
  s_cselect_b32 s4, s10, 0
  s_sub_u32 s7, s7, s4
  s_add_u32 s11, s11, 8192
  buffer_load_dwordx4 v6, s[52:55], s5 offen offset:2048 lds
  s_cmp_eq_u32 s11, s15
  s_cselect_b32 s4, 81920, 0
  s_sub_u32 s11, s11, s4
  s_add_u32 s12, s12, 1
  s_cmp_lg_u32 s12, 10
  buffer_load_dwordx4 v7, s[52:55], s5 offen offset:3072 lds
  s_mov_b32 m0, s11
  s_cbranch_scc1 Lt_37
Lt_38:
  s_waitcnt vmcnt(36)
  s_barrier
  s_waitcnt vmcnt(32)
  s_barrier
  buffer_load_dwordx4 v4, s[52:55], s7 offen offset:0 lds
Ll_39:
  s_nop 0
  s_mov_b32 s5, s7
  buffer_load_dwordx4 v5, s[52:55], s5 offen offset:1024 lds
  s_add_u32 s7, s7, s8
  s_cmp_eq_u32 s7, s9
  s_cselect_b32 s4, s10, 0
  s_sub_u32 s7, s7, s4
  s_add_u32 s11, s11, 8192
  buffer_load_dwordx4 v6, s[52:55], s5 offen offset:2048 lds
  s_cmp_eq_u32 s11, s15
  s_cselect_b32 s4, 81920, 0
  s_sub_u32 s11, s11, s4
  s_add_u32 s12, s12, 1
  s_cmp_eq_u32 s12, 16
  buffer_load_dwordx4 v7, s[52:55], s5 offen offset:3072 lds
  s_mov_b32 m0, s11
  s_cbranch_scc1 Ll_40
  s_waitcnt vmcnt(32)
  s_barrier
  buffer_load_dwordx4 v4, s[52:55], s7 offen offset:0 lds
  s_branch Ll_39
  s_nop 0
Ll_40:
  v_lshrrev_b32 v2, 3, v1
  s_movk_i32 s4, 7168
  v_mad_u32_u24 v4, v2, s4, v10
  v_add_u32 v5, 56320, v4
  v_add_u32 v6, 112640, v4
  v_add_u32 v7, 168960, v4
  v_lshrrev_b32 v2, 2, v1
  s_movk_i32 s4, 7168
  v_mul_u32_u24_e64 v2, s4, v2
  v_bfe_u32 v3, v10, 5, 1
  v_lshl_add_u32 v2, v3, 4, v2
  v_and_b32 v3, 1, v1
  v_lshlrev_b32 v3, 5, v3
  v_add_u32_e64 v8, v2, v3
  v_add_u32 v9, 113664, v8
  s_mul_i32 s5, s77, 448
  s_and_b32 s4, s77, Lz1-Lz0+1
  s_mul_i32 s94, s4, 448
  s_sub_u32 s94, 384, s94
  s_lshl_b32 s4, s4, 6
  s_add_u32 s5, s5, s4
  s_mul_i32 s4, s85, 229376
  s_add_u32 s5, s5, s4
  v_add_u32 v12, s76, v1
  v_and_b32 v12, 15, v12
  v_mov_b32 v2, s76
  v_cmp_eq_u32 vcc, s78, v12
  s_nop 1
  v_cndmask_b32_e64 v12, v12, v2, vcc
  v_writelane_b32 v12, s78, 0
  s_mov_b32 s4, 458752
  v_mul_u32_u24 v12, s4, v12
  v_add_u32 v12, s5, v12
  s_nop 0
  v_readfirstlane_b32 s7, v12
  s_lshl_b32 s11, s85, Lz1-Lz0+12
  s_add_u32 s11, s11, 65536
  s_add_u32 s15, s11, 86016
  s_lshl_b32 s4, s85, Lz1-Lz0+11
  s_sub_u32 s13, 24576, s4
  s_mul_i32 s5, s85, 6144
  s_nop 0
  s_mov_b32 s68, s28
  s_and_b32 s69, s29, 0xffff
  s_mov_b32 s70, 7340032
  s_mov_b32 s71, 0x00020000
  s_lshl_b32 s4, s76, 4
  s_add_u32 s4, s4, s77
  s_mul_i32 s34, s4, 28672
  s_add_u32 s34, s34, s5
  s_mov_b32 s12, 0
  s_mov_b32 m0, s11
  s_waitcnt vmcnt(32)
  s_barrier
  s_waitcnt vmcnt(28)
  s_barrier
  s_waitcnt vmcnt(24)
  s_barrier
  s_waitcnt vmcnt(20)
  s_barrier
  s_waitcnt vmcnt(16)
  s_barrier
  s_waitcnt vmcnt(12)
  s_barrier
  s_branch Ll_41
Lt_47:
  s_cmp_lg_u32 s12, 1
  s_cbranch_scc1 Lt_45
  s_waitcnt vmcnt(22)
  s_barrier
  s_waitcnt vmcnt(18)
  s_barrier
  s_branch Ll_41
Lt_45:
  s_cmp_lg_u32 s12, 2
  s_cbranch_scc1 Ll_41
  s_waitcnt vmcnt(28)
  s_barrier
  s_barrier
Ll_41:
  buffer_load_dwordx4 v4, s[56:59], s7 offen offset:0 lds
  buffer_load_dwordx4 v5, s[56:59], s7 offen offset:1024 lds
  buffer_load_dwordx4 v6, s[56:59], s7 offen offset:2048 lds
  buffer_load_dwordx4 v7, s[56:59], s7 offen offset:3072 lds
  s_add_u32 m0, s11, s13
  s_add_u32 s5, s7, s94
  buffer_load_dwordx4 v8, s[56:59], s5 offen offset:0 lds
  buffer_load_dwordx4 v9, s[56:59], s5 offen offset:1024 lds
  s_add_u32 m0, s11, 8192
  s_add_u32 s5, s7, 128
  buffer_load_dwordx4 v4, s[56:59], s5 offen offset:0 lds
  buffer_load_dwordx4 v5, s[56:59], s5 offen offset:1024 lds
  buffer_load_dwordx4 v6, s[56:59], s5 offen offset:2048 lds
  buffer_load_dwordx4 v7, s[56:59], s5 offen offset:3072 lds
  s_add_u32 m0, s11, 16384
  s_add_u32 s5, s7, 256
  buffer_load_dwordx4 v4, s[56:59], s5 offen offset:0 lds
  s_add_u32 s12, s12, Lz1-Lz0+1
  v_readlane_b32 s7, v12, s12
  s_add_u32 s11, s11, 28672
  buffer_load_dwordx4 v5, s[56:59], s5 offen offset:1024 lds
  s_cmp_eq_u32 s11, s15
  s_cselect_b32 s4, 86016, 0
  s_sub_u32 s11, s11, s4
  buffer_load_dwordx4 v6, s[56:59], s5 offen offset:2048 lds
  s_cmp_lg_u32 s12, Lz1-Lz0+3
  buffer_load_dwordx4 v7, s[56:59], s5 offen offset:3072 lds
  s_mov_b32 m0, s11
  s_cbranch_scc1 Lt_47
Lt_48:
  s_waitcnt vmcnt(28)
  s_barrier
  s_waitcnt vmcnt(14)
  s_barrier
  buffer_load_dwordx4 v4, s[56:59], s7 offen offset:0 lds
  buffer_load_dwordx4 v5, s[56:59], s7 offen offset:1024 lds
  buffer_load_dwordx4 v6, s[56:59], s7 offen offset:2048 lds
  buffer_load_dwordx4 v7, s[56:59], s7 offen offset:3072 lds
Ll_49:
  s_add_u32 m0, s11, s13
  s_add_u32 s5, s7, s94
  buffer_load_dwordx4 v8, s[56:59], s5 offen offset:0 lds
  buffer_load_dwordx4 v9, s[56:59], s5 offen offset:1024 lds
  s_add_u32 m0, s11, 8192
  s_add_u32 s5, s7, 128
  buffer_load_dwordx4 v4, s[56:59], s5 offen offset:0 lds
  buffer_load_dwordx4 v5, s[56:59], s5 offen offset:1024 lds
  buffer_load_dwordx4 v6, s[56:59], s5 offen offset:2048 lds
  buffer_load_dwordx4 v7, s[56:59], s5 offen offset:3072 lds
  s_add_u32 m0, s11, 16384
  s_add_u32 s5, s7, 256
  buffer_load_dwordx4 v4, s[56:59], s5 offen offset:0 lds
  s_add_u32 s12, s12, Lz1-Lz0+1
  v_readlane_b32 s7, v12, s12
  s_add_u32 s11, s11, 28672
  buffer_load_dwordx4 v5, s[56:59], s5 offen offset:1024 lds
  s_cmp_eq_u32 s11, s15
  s_cselect_b32 s4, 86016, 0
  s_sub_u32 s11, s11, s4
  buffer_load_dwordx4 v6, s[56:59], s5 offen offset:2048 lds
  s_cmp_eq_u32 s12, Lz1-Lz0+16
  buffer_load_dwordx4 v7, s[56:59], s5 offen offset:3072 lds
  s_mov_b32 m0, s11
  s_cbranch_scc1 Ll_50
  s_cmp_lg_u32 s82, 0
  s_cbranch_scc1 L_51
  s_buffer_load_dwordx2 s[98:99], s[68:71], s34 offset:60
  s_buffer_load_dwordx2 s[98:99], s[68:71], s34 offset:188
  s_buffer_load_dwordx2 s[98:99], s[68:71], s34 offset:316
  s_buffer_load_dwordx2 s[98:99], s[68:71], s34 offset:444
  s_add_u32 s34, s34, 512
L_51:
  s_waitcnt vmcnt(14)
  s_barrier
  buffer_load_dwordx4 v4, s[56:59], s7 offen offset:0 lds
  buffer_load_dwordx4 v5, s[56:59], s7 offen offset:1024 lds
  buffer_load_dwordx4 v6, s[56:59], s7 offen offset:2048 lds
  buffer_load_dwordx4 v7, s[56:59], s7 offen offset:3072 lds
  s_branch Ll_49
  s_nop 0
Ll_50:
  v_lshrrev_b32 v2, 3, v1
  s_movk_i32 s4, 2048
  v_mad_u32_u24 v4, v2, s4, v10
  v_add_u32 v5, 15360, v4
  v_add_u32 v6, 30720, v4
  v_add_u32 v7, 46080, v4
  s_lshl_b32 s5, s78, Lz1-Lz0+7
  s_mul_i32 s4, s79, 3670016
  s_add_u32 s5, s5, s4
  s_lshl_b32 s94, s79, 8
  s_sub_u32 s94, 128, s94
  v_subrev_u32 v2, 4, v1
  v_cmp_le_u32 vcc, 28, v1
  s_nop 1
  v_cndmask_b32 v13, v1, v2, vcc
  v_subrev_u32 v3, 3, v13
  v_mov_b32 v12, 4
  v_cmp_le_u32 vcc, 14, v13
  v_subrev_u32 v2, 14, v13
  s_nop 0
  v_cndmask_b32 v3, v3, v2, vcc
  v_cndmask_b32_e64 v12, v12, 12, vcc
  v_cmp_le_u32 vcc, 21, v13
  v_subrev_u32 v2, 21, v13
  s_nop 0
  v_cndmask_b32 v3, v3, v2, vcc
  v_cndmask_b32_e64 v12, v12, 20, vcc
  s_sub_u32 s4, s80, s76
  s_and_b32 s4, s4, 7
  v_cmp_le_u32 vcc, s4, v3
  v_mov_b32 v2, s76
  s_nop 0
  v_addc_co_u32 v3, vcc, v3, v2, vcc
  v_and_b32 v3, 7, v3
  v_add_u32 v12, v12, v3
  v_add_u32 v2, v2, v1
  v_and_b32 v2, 3, v2
  v_subrev_u32 v3, 10, v1
  v_cmp_gt_u32 vcc, 4, v3
  s_nop 1
  v_cndmask_b32 v12, v12, v2, vcc
  s_add_u32 s4, s80, Lz1-Lz0+4
  v_lshl_add_u32 v2, v1, 3, s4
  v_cmp_gt_u32 vcc, 3, v1
  s_nop 1
  v_cndmask_b32 v12, v12, v2, vcc
  v_subrev_u32 v2, 4, v12
  v_and_b32 v3, 7, v2
  v_lshrrev_b32 v2, 3, v2
  v_mad_u32_u24 v2, v3, 7, v2
  v_and_b32 v3, 1, v3
  v_add_u32 v2, v2, v3
  s_mul_i32 s4, s85, 3
  v_add_u32 v2, s4, v2
  s_add_u32 s4, s85, Lz1-Lz0+6
  v_mad_u32_u24 v3, v12, 14, s4
  v_cmp_gt_u32 vcc, 4, v12
  s_nop 1
  v_cndmask_b32_e64 v2, v2, v3, vcc
  v_lshl_add_u32 v12, v2, 16, s5
  s_mul_i32 s4, s79, 7340032
  s_sub_u32 s4, 3670016, s4
  v_add_u32 v2, s4, v12
  v_cmp_le_u32 vcc, 28, v1
  s_nop 1
  v_cndmask_b32 v12, v12, v2, vcc
  s_lshl_b32 s11, s85, Lz1-Lz0+12
  s_add_u32 s11, s11, 65536
  s_add_u32 s15, s11, 81920
  s_add_u32 s11, s11, 32768
  v_readfirstlane_b32 s7, v12
  s_mov_b32 s12, 0
  s_mov_b32 m0, s11
  s_waitcnt vmcnt(14)
  s_barrier
  s_branch Ll_52
Lt_58:
  s_cmp_lg_u32 s12, 1
  s_cbranch_scc1 Lt_56
  s_waitcnt vmcnt(8)
  s_barrier
  s_branch Ll_52
Lt_56:
  s_cmp_lg_u32 s12, 3
  s_cbranch_scc1 Ll_52
  s_barrier
Ll_52:
  buffer_load_dwordx4 v4, s[60:63], s7 offen offset:0 lds
  buffer_load_dwordx4 v5, s[60:63], s7 offen offset:1024 lds
  buffer_load_dwordx4 v6, s[60:63], s7 offen offset:2048 lds
  buffer_load_dwordx4 v7, s[60:63], s7 offen offset:3072 lds
  s_add_u32 m0, s11, 8192
  s_add_u32 s5, s7, s94
  buffer_load_dwordx4 v4, s[60:63], s5 offen offset:0 lds
  s_add_u32 s12, s12, 1
  v_readlane_b32 s7, v12, s12
  s_add_u32 s11, s11, 16384
  buffer_load_dwordx4 v5, s[60:63], s5 offen offset:1024 lds
  s_cmp_eq_u32 s11, s15
  s_cselect_b32 s4, 81920, 0
  s_sub_u32 s11, s11, s4
  buffer_load_dwordx4 v6, s[60:63], s5 offen offset:2048 lds
  s_cmp_lg_u32 s12, Lz1-Lz0+5
  buffer_load_dwordx4 v7, s[60:63], s5 offen offset:3072 lds
  s_mov_b32 m0, s11
  s_cbranch_scc1 Lt_58
Lt_59:
  s_waitcnt vmcnt(32)
  s_barrier
  s_waitcnt vmcnt(24)
  s_barrier
  buffer_load_dwordx4 v4, s[60:63], s7 offen offset:0 lds
  buffer_load_dwordx4 v5, s[60:63], s7 offen offset:1024 lds
  buffer_load_dwordx4 v6, s[60:63], s7 offen offset:2048 lds
  buffer_load_dwordx4 v7, s[60:63], s7 offen offset:3072 lds
Ll_60:
  s_add_u32 m0, s11, 8192
  s_add_u32 s5, s7, s94
  buffer_load_dwordx4 v4, s[60:63], s5 offen offset:0 lds
  s_add_u32 s12, s12, 1
  v_readlane_b32 s7, v12, s12
  s_add_u32 s11, s11, 16384
  buffer_load_dwordx4 v5, s[60:63], s5 offen offset:1024 lds
  s_cmp_eq_u32 s11, s15
  s_cselect_b32 s4, 81920, 0
  s_sub_u32 s11, s11, s4
  buffer_load_dwordx4 v6, s[60:63], s5 offen offset:2048 lds
  s_cmp_eq_u32 s12, Lz1-Lz0+24
  buffer_load_dwordx4 v7, s[60:63], s5 offen offset:3072 lds
  s_mov_b32 m0, s11
  s_cbranch_scc1 Ll_61
  s_waitcnt vmcnt(24)
  s_barrier
  buffer_load_dwordx4 v4, s[60:63], s7 offen offset:0 lds
  buffer_load_dwordx4 v5, s[60:63], s7 offen offset:1024 lds
  buffer_load_dwordx4 v6, s[60:63], s7 offen offset:2048 lds
  buffer_load_dwordx4 v7, s[60:63], s7 offen offset:3072 lds
  s_branch Ll_60
  s_nop 0
Ll_61:
  s_waitcnt vmcnt(24)
  s_barrier
  buffer_load_dwordx4 v4, s[60:63], s7 offen offset:0 lds
Ll_62:
  s_mov_b32 s5, s7
  buffer_load_dwordx4 v5, s[60:63], s5 offen offset:1024 lds
  s_add_u32 s12, s12, 1
  v_readlane_b32 s7, v12, s12
  s_add_u32 s11, s11, 16384
  s_nop 0
  s_cmp_eq_u32 s11, s15
  buffer_load_dwordx4 v6, s[60:63], s5 offen offset:2048 lds
  s_cselect_b32 s4, 81920, 0
  s_sub_u32 s11, s11, s4
  s_cmp_eq_u32 s12, 32
  buffer_load_dwordx4 v7, s[60:63], s5 offen offset:3072 lds
  s_mov_b32 m0, s11
  s_cbranch_scc1 Ll_63
  s_waitcnt vmcnt(12)
  s_barrier
  buffer_load_dwordx4 v4, s[60:63], s7 offen offset:0 lds
  s_branch Ll_62
  s_nop 0
Ll_63:
  v_lshrrev_b32 v2, 3, v1
  s_movk_i32 s4, 6144
  v_mad_u32_u24 v4, v2, s4, v10
  v_add_u32 v5, 48128, v4
  v_add_u32 v6, 96256, v4
  v_add_u32 v7, 144384, v4
  s_cmp_eq_u32 s82, 0
  s_mov_b32 s82, 1
  s_cbranch_scc1 L_wlayer
  s_waitcnt vmcnt(12)
  s_barrier
  s_waitcnt vmcnt(8)
  s_barrier
  s_waitcnt vmcnt(4)
  s_barrier
  s_waitcnt vmcnt(0)
  s_barrier
  s_barrier
  s_branch L_lend
L_x1:
  s_cmp_lg_u32 s82, 0
  s_cbranch_scc1 L_71
  s_and_b32 s80, s77, 7
  s_lshr_b32 s79, s77, 3
  s_lshl_b32 s78, s80, 1
  s_add_u32 s78, s78, s79
  s_lshl_b32 s5, s76, 4
  s_add_u32 s5, s5, s77
  s_lshl_b32 s84, s5, 11
  s_mov_b32 s83, 3145728
  s_mov_b32 s87, 1835016
  s_lshr_b32 s86, s81, 1
  v_lshlrev_b32 v4, 4, v1
  v_lshlrev_b32 v5, 4, v1
  v_lshlrev_b32 v6, 4, v1
  v_lshlrev_b32 v7, 4, v1
  s_movk_i32 s13, 4096
  s_movk_i32 s95, 8192
  v_and_b32 v2, 31, v1
  v_lshlrev_b32 v8, 7, v2
L_71:
  s_mov_b32 s40, s38
  s_and_b32 s41, s39, 0xffff
  s_mov_b32 s42, 100663296
  s_mov_b32 s43, 0x00020000
  s_mov_b32 s72, s40
  s_mov_b32 s73, s41
  s_mov_b32 s74, s42
  s_mov_b32 s11, 0
  s_mov_b32 s15, 65536
  s_mul_i32 s5, s76, 16
  s_lshl_b32 s5, s5, 14
  s_add_u32 s5, s5, 3145728
  s_mov_b32 s8, 16384
  s_mov_b32 s10, 262144
  s_add_u32 s9, s5, s10
  s_mul_i32 s6, s76, s8
  s_add_u32 s7, s5, s6
  s_lshr_b32 s6, s6, 14
  s_lshl_b32 s90, 0x7f, s6
  s_lshr_b32 s4, s90, 16
  s_or_b32 s90, s90, s4
  s_and_b32 s90, s90, 0xffff
  s_lshl_b32 s91, s84, 1
  s_add_u32 s91, s91, s87
  s_mov_b32 s89, 200000
  s_mov_b32 exec_lo, s90
  s_mov_b32 exec_hi, 0
  buffer_load_dword v12, v8, s[40:43], s91 offen sc0 sc1
Lp_72:
  s_waitcnt vmcnt(0)
  v_cmp_ne_u32 vcc, 0, v12
  s_andn2_b32 s3, exec_lo, vcc_lo
  s_cbranch_scc0 Lp_73
  s_mov_b32 exec_lo, s3
  s_sleep 1
  buffer_load_dword v12, v8, s[40:43], s91 offen sc0 sc1
  s_sub_u32 s89, s89, 1
  s_cbranch_scc0 Lp_72
Lp_73:
  s_mov_b64 exec, -1
  s_mov_b32 s12, 0
  s_mov_b32 m0, s11
Ll_74:
  s_nop 0
  buffer_load_dwordx4 v4, s[40:43], s7 offen offset:0 sc1 lds
  buffer_load_dwordx4 v5, s[40:43], s7 offen offset:1024 sc1 lds
  buffer_load_dwordx4 v6, s[40:43], s7 offen offset:2048 sc1 lds
  buffer_load_dwordx4 v7, s[40:43], s7 offen offset:3072 sc1 lds
  s_add_u32 m0, s11, 4096
  s_nop 0
  s_add_u32 s5, s7, s13
  buffer_load_dwordx4 v4, s[40:43], s5 offen offset:0 sc1 lds
  buffer_load_dwordx4 v5, s[40:43], s5 offen offset:1024 sc1 lds
  buffer_load_dwordx4 v6, s[40:43], s5 offen offset:2048 sc1 lds
  buffer_load_dwordx4 v7, s[40:43], s5 offen offset:3072 sc1 lds
  s_add_u32 m0, s11, 8192
  s_nop 0
  s_add_u32 s3, s7, s95
  buffer_load_dwordx4 v4, s[40:43], s3 offen offset:0 sc1 lds
  buffer_load_dwordx4 v5, s[40:43], s3 offen offset:1024 sc1 lds
  buffer_load_dwordx4 v6, s[40:43], s3 offen offset:2048 sc1 lds
  buffer_load_dwordx4 v7, s[40:43], s3 offen offset:3072 sc1 lds
  s_add_u32 m0, s11, 12288
  s_nop 0
  s_add_u32 s5, s3, s13
  buffer_load_dwordx4 v4, s[40:43], s5 offen offset:0 sc1 lds
  s_add_u32 s7, s7, s8
  s_cmp_eq_u32 s7, s9
  s_cselect_b32 s4, s10, 0
  s_sub_u32 s7, s7, s4
  buffer_load_dwordx4 v5, s[40:43], s5 offen offset:1024 sc1 lds
  s_add_u32 s11, s11, 16384
  s_cmp_eq_u32 s11, s15
  s_cselect_b32 s4, 65536, 0
  s_sub_u32 s11, s11, s4
  buffer_load_dwordx4 v6, s[40:43], s5 offen offset:2048 sc1 lds
  s_add_u32 s12, s12, 1
  s_cmp_lg_u32 s12, 3
  buffer_load_dwordx4 v7, s[40:43], s5 offen offset:3072 sc1 lds
  s_mov_b32 m0, s11
  s_cbranch_scc1 Ll_75
  s_waitcnt vmcnt(32)
  s_barrier
Ll_75:
  s_cmp_lt_u32 s12, 4
  s_cbranch_scc1 Ll_74
  s_waitcnt vmcnt(32)
  s_barrier
  buffer_load_dwordx4 v4, s[40:43], s7 offen offset:0 sc1 lds
  buffer_load_dwordx4 v5, s[40:43], s7 offen offset:1024 sc1 lds
  buffer_load_dwordx4 v6, s[40:43], s7 offen offset:2048 sc1 lds
  buffer_load_dwordx4 v7, s[40:43], s7 offen offset:3072 sc1 lds
Ll_78:
  s_add_u32 m0, s11, 4096
  s_nop 0
  s_add_u32 s5, s7, s13
  buffer_load_dwordx4 v4, s[40:43], s5 offen offset:0 sc1 lds
  buffer_load_dwordx4 v5, s[40:43], s5 offen offset:1024 sc1 lds
  buffer_load_dwordx4 v6, s[40:43], s5 offen offset:2048 sc1 lds
  buffer_load_dwordx4 v7, s[40:43], s5 offen offset:3072 sc1 lds
  s_add_u32 m0, s11, 8192
  s_nop 0
  s_add_u32 s3, s7, s95
  buffer_load_dwordx4 v4, s[40:43], s3 offen offset:0 sc1 lds
  buffer_load_dwordx4 v5, s[40:43], s3 offen offset:1024 sc1 lds
  buffer_load_dwordx4 v6, s[40:43], s3 offen offset:2048 sc1 lds
  buffer_load_dwordx4 v7, s[40:43], s3 offen offset:3072 sc1 lds
  s_add_u32 m0, s11, 12288
  s_nop 0
  s_add_u32 s5, s3, s13
  buffer_load_dwordx4 v4, s[40:43], s5 offen offset:0 sc1 lds
  s_add_u32 s7, s7, s8
  s_cmp_eq_u32 s7, s9
  s_cselect_b32 s4, s10, 0
  s_sub_u32 s7, s7, s4
  buffer_load_dwordx4 v5, s[40:43], s5 offen offset:1024 sc1 lds
  s_add_u32 s11, s11, 16384
  s_cmp_eq_u32 s11, s15
  s_cselect_b32 s4, 65536, 0
  s_sub_u32 s11, s11, s4
  buffer_load_dwordx4 v6, s[40:43], s5 offen offset:2048 sc1 lds
  s_add_u32 s12, s12, 1
  s_cmp_eq_u32 s12, 16
  buffer_load_dwordx4 v7, s[40:43], s5 offen offset:3072 sc1 lds
  s_mov_b32 m0, s11
  s_cbranch_scc1 Ll_79
  s_waitcnt vmcnt(32)
  s_barrier
  buffer_load_dwordx4 v4, s[40:43], s7 offen offset:0 sc1 lds
  buffer_load_dwordx4 v5, s[40:43], s7 offen offset:1024 sc1 lds
  buffer_load_dwordx4 v6, s[40:43], s7 offen offset:2048 sc1 lds
  buffer_load_dwordx4 v7, s[40:43], s7 offen offset:3072 sc1 lds
  s_branch Ll_78
  s_nop 0
Ll_79:
  s_waitcnt vmcnt(32)
  s_barrier
  s_waitcnt vmcnt(16)
  s_barrier
  s_waitcnt vmcnt(0)
  s_barrier
  s_barrier
  s_mov_b32 s11, 0
  s_mov_b32 s15, 65536
  s_mul_i32 s5, s76, 16
  s_lshl_b32 s5, s5, 14
  s_add_u32 s5, s5, 7340032
  v_add_u32 v9, s76, v1
  v_and_b32 v9, 15, v9
  v_mov_b32 v2, s76
  v_cmp_eq_u32 vcc, s78, v9
  s_nop 1
  v_cndmask_b32 v9, v9, v2, vcc
  v_writelane_b32 v9, s78, 0
  v_lshl_add_u32 v9, v9, 14, s5
  s_lshl_b32 s6, s76, Lz1-Lz0+14
  v_readlane_b32 s7, v9, 1
  s_mov_b32 s11, 16384
  s_lshr_b32 s6, s6, 14
  s_lshl_b32 s90, 0x3f, s6
  s_lshr_b32 s4, s90, 16
  s_or_b32 s90, s90, s4
  s_and_b32 s90, s90, 0xffff
  s_add_u32 s91, s91, Lz1-Lz0+4
  s_bitset0_b32 s90, s78
  s_barrier
  s_mov_b32 s89, 200000
  s_mov_b32 exec_lo, s90
  s_mov_b32 exec_hi, 0
  buffer_load_dword v12, v8, s[40:43], s91 offen sc0 sc1
Lp_80:
  s_waitcnt vmcnt(0)
  v_cmp_ne_u32 vcc, 0, v12
  s_andn2_b32 s3, exec_lo, vcc_lo
  s_cbranch_scc0 Lp_81
  s_mov_b32 exec_lo, s3
  s_sleep 1
  buffer_load_dword v12, v8, s[40:43], s91 offen sc0 sc1
  s_sub_u32 s89, s89, 1
  s_cbranch_scc0 Lp_80
Lp_81:
  s_mov_b64 exec, -1
  s_mov_b32 s12, 1
  s_mov_b32 m0, s11
Ll_82:
  s_nop 0
  buffer_load_dwordx4 v4, s[72:75], s7 offen offset:0 sc1 lds
  buffer_load_dwordx4 v5, s[72:75], s7 offen offset:1024 sc1 lds
  buffer_load_dwordx4 v6, s[72:75], s7 offen offset:2048 sc1 lds
  buffer_load_dwordx4 v7, s[72:75], s7 offen offset:3072 sc1 lds
  s_add_u32 m0, s11, 4096
  s_nop 0
  s_add_u32 s5, s7, s13
  buffer_load_dwordx4 v4, s[72:75], s5 offen offset:0 sc1 lds
  buffer_load_dwordx4 v5, s[72:75], s5 offen offset:1024 sc1 lds
  buffer_load_dwordx4 v6, s[72:75], s5 offen offset:2048 sc1 lds
  buffer_load_dwordx4 v7, s[72:75], s5 offen offset:3072 sc1 lds
  s_add_u32 m0, s11, 8192
  s_nop 0
  s_add_u32 s3, s7, s95
  buffer_load_dwordx4 v4, s[72:75], s3 offen offset:0 sc1 lds
  buffer_load_dwordx4 v5, s[72:75], s3 offen offset:1024 sc1 lds
  buffer_load_dwordx4 v6, s[72:75], s3 offen offset:2048 sc1 lds
  buffer_load_dwordx4 v7, s[72:75], s3 offen offset:3072 sc1 lds
  s_add_u32 m0, s11, 12288
  s_add_u32 s5, s3, s13
  buffer_load_dwordx4 v4, s[72:75], s5 offen offset:0 sc1 lds
  s_add_u32 s12, s12, 1
  v_readlane_b32 s7, v9, s12
  s_add_u32 s11, s11, 16384
  buffer_load_dwordx4 v5, s[72:75], s5 offen offset:1024 sc1 lds
  s_cmp_eq_u32 s11, s15
  s_cselect_b32 s4, 65536, 0
  s_sub_u32 s11, s11, s4
  buffer_load_dwordx4 v6, s[72:75], s5 offen offset:2048 sc1 lds
  s_cmp_lg_u32 s12, Lz1-Lz0+4
  buffer_load_dwordx4 v7, s[72:75], s5 offen offset:3072 sc1 lds
  s_mov_b32 m0, s11
  s_cbranch_scc1 Ll_82
  s_waitcnt vmcnt(32)
  s_barrier
  buffer_load_dwordx4 v4, s[72:75], s7 offen offset:0 sc1 lds
  buffer_load_dwordx4 v5, s[72:75], s7 offen offset:1024 sc1 lds
  buffer_load_dwordx4 v6, s[72:75], s7 offen offset:2048 sc1 lds
  buffer_load_dwordx4 v7, s[72:75], s7 offen offset:3072 sc1 lds
Ll_86:
  s_add_u32 m0, s11, 4096
  s_nop 0
  s_add_u32 s5, s7, s13
  buffer_load_dwordx4 v4, s[72:75], s5 offen offset:0 sc1 lds
  buffer_load_dwordx4 v5, s[72:75], s5 offen offset:1024 sc1 lds
  buffer_load_dwordx4 v6, s[72:75], s5 offen offset:2048 sc1 lds
  buffer_load_dwordx4 v7, s[72:75], s5 offen offset:3072 sc1 lds
  s_add_u32 m0, s11, 8192
  s_nop 0
  s_add_u32 s3, s7, s95
  buffer_load_dwordx4 v4, s[72:75], s3 offen offset:0 sc1 lds
  buffer_load_dwordx4 v5, s[72:75], s3 offen offset:1024 sc1 lds
  buffer_load_dwordx4 v6, s[72:75], s3 offen offset:2048 sc1 lds
  buffer_load_dwordx4 v7, s[72:75], s3 offen offset:3072 sc1 lds
  s_add_u32 m0, s11, 12288
  s_add_u32 s5, s3, s13
  buffer_load_dwordx4 v4, s[72:75], s5 offen offset:0 sc1 lds
  s_add_u32 s12, s12, 1
  v_readlane_b32 s7, v9, s12
  s_add_u32 s11, s11, 16384
  buffer_load_dwordx4 v5, s[72:75], s5 offen offset:1024 sc1 lds
  s_cmp_eq_u32 s11, s15
  s_cselect_b32 s4, 65536, 0
  s_sub_u32 s11, s11, s4
  buffer_load_dwordx4 v6, s[72:75], s5 offen offset:2048 sc1 lds
  s_cmp_eq_u32 s12, Lz1-Lz0+16
  buffer_load_dwordx4 v7, s[72:75], s5 offen offset:3072 sc1 lds
  s_mov_b32 m0, s11
  s_cbranch_scc1 Ll_87
  s_waitcnt vmcnt(32)
  s_barrier
  buffer_load_dwordx4 v4, s[72:75], s7 offen offset:0 sc1 lds
  buffer_load_dwordx4 v5, s[72:75], s7 offen offset:1024 sc1 lds
  buffer_load_dwordx4 v6, s[72:75], s7 offen offset:2048 sc1 lds
  buffer_load_dwordx4 v7, s[72:75], s7 offen offset:3072 sc1 lds
  s_branch Ll_86
  s_nop 0
Ll_87:
  s_waitcnt vmcnt(32)
  s_barrier
  s_waitcnt vmcnt(16)
  s_barrier
  s_waitcnt vmcnt(0)
  s_barrier
  s_barrier
  s_mov_b32 s11, 0
  s_mov_b32 s15, 65536
  s_mul_i32 s5, s76, 56
  s_mul_i32 s4, s79, 28
  s_add_u32 s5, s5, s4
  s_lshl_b32 s5, s5, 14
  s_add_u32 s5, s5, 11534336
  v_subrev_u32 v2, 4, v1
  v_cmp_le_u32 vcc, 28, v1
  s_nop 1
  v_cndmask_b32 v10, v1, v2, vcc
  v_subrev_u32 v3, 3, v10
  v_mov_b32 v9, 4
  v_cmp_le_u32 vcc, 14, v10
  v_subrev_u32 v2, 14, v10
  s_nop 0
  v_cndmask_b32 v3, v3, v2, vcc
  v_cndmask_b32_e64 v9, v9, 12, vcc
  v_cmp_le_u32 vcc, 21, v10
  v_subrev_u32 v2, 21, v10
  s_nop 0
  v_cndmask_b32 v3, v3, v2, vcc
  v_cndmask_b32_e64 v9, v9, 20, vcc
  s_sub_u32 s4, s80, s76
  s_and_b32 s4, s4, 7
  v_cmp_le_u32 vcc, s4, v3
  v_mov_b32 v2, s76
  s_nop 0
  v_addc_co_u32 v3, vcc, v3, v2, vcc
  v_and_b32 v3, 7, v3
  v_add_u32 v9, v9, v3
  v_add_u32 v2, v2, v1
  v_and_b32 v2, 3, v2
  v_subrev_u32 v3, 10, v1
  v_cmp_gt_u32 vcc, 4, v3
  s_nop 1
  v_cndmask_b32 v9, v9, v2, vcc
  s_add_u32 s4, s80, Lz1-Lz0+4
  v_lshl_add_u32 v2, v1, 3, s4
  v_cmp_gt_u32 vcc, 3, v1
  s_nop 1
  v_cndmask_b32_e64 v9, v9, v2, vcc
  v_lshl_add_u32 v9, v9, 14, s5
  s_mul_i32 s4, s79, 917504
  s_sub_u32 s4, 458752, s4
  v_add_u32_e64 v2, s4, v9
  v_cmp_le_u32 vcc, 28, v1
  s_nop 1
  v_cndmask_b32 v9, v9, v2, vcc
  s_nop 0
  v_readlane_b32 s7, v9, 3
  s_mov_b32 s11, 49152
  s_add_u32 s91, s91, 4
  s_lshl_b32 s4, s79, 3
  s_lshl_b32 s90, 0xff, s4
  s_bitset0_b32 s90, s77
  s_mov_b32 s89, 200000
  s_mov_b32 exec_lo, s90
  s_mov_b32 exec_hi, Lz1-Lz0+0
  buffer_load_dword v12, v8, s[40:43], s91 offen sc0 sc1
Lp_88:
  s_waitcnt vmcnt(0)
  v_cmp_ne_u32 vcc, 0, v12
  s_andn2_b32 s3, exec_lo, vcc_lo
  s_cbranch_scc0 Lp_89
  s_mov_b32 exec_lo, s3
  s_sleep 1
  buffer_load_dword v12, v8, s[40:43], s91 offen sc0 sc1
  s_sub_u32 s89, s89, 1
  s_cbranch_scc0 Lp_88
Lp_89:
  s_mov_b64 exec, -1
  s_mov_b32 s12, 3
  s_mov_b32 m0, s11
Ll_90:
  s_nop 0
  buffer_load_dwordx4 v4, s[40:43], s7 offen offset:0 sc1 lds
  buffer_load_dwordx4 v5, s[40:43], s7 offen offset:1024 sc1 lds
  buffer_load_dwordx4 v6, s[40:43], s7 offen offset:2048 sc1 lds
  buffer_load_dwordx4 v7, s[40:43], s7 offen offset:3072 sc1 lds
  s_add_u32 m0, s11, 4096
  s_nop 0
  s_add_u32 s5, s7, s13
  buffer_load_dwordx4 v4, s[40:43], s5 offen offset:0 sc1 lds
  buffer_load_dwordx4 v5, s[40:43], s5 offen offset:1024 sc1 lds
  buffer_load_dwordx4 v6, s[40:43], s5 offen offset:2048 sc1 lds
  buffer_load_dwordx4 v7, s[40:43], s5 offen offset:3072 sc1 lds
  s_add_u32 m0, s11, 8192
  s_nop 0
  s_add_u32 s3, s7, s95
  buffer_load_dwordx4 v4, s[40:43], s3 offen offset:0 sc1 lds
  buffer_load_dwordx4 v5, s[40:43], s3 offen offset:1024 sc1 lds
  buffer_load_dwordx4 v6, s[40:43], s3 offen offset:2048 sc1 lds
  buffer_load_dwordx4 v7, s[40:43], s3 offen offset:3072 sc1 lds
  s_add_u32 m0, s11, 12288
  s_add_u32 s5, s3, s13
  buffer_load_dwordx4 v4, s[40:43], s5 offen offset:0 sc1 lds
  s_add_u32 s12, s12, 1
  v_readlane_b32 s7, v9, s12
  s_add_u32 s11, s11, 16384
  buffer_load_dwordx4 v5, s[40:43], s5 offen offset:1024 sc1 lds
  s_cmp_eq_u32 s11, s15
  s_cselect_b32 s4, 65536, 0
  s_sub_u32 s11, s11, s4
  buffer_load_dwordx4 v6, s[40:43], s5 offen offset:2048 sc1 lds
  s_cmp_lg_u32 s12, Lz1-Lz0+4
  buffer_load_dwordx4 v7, s[40:43], s5 offen offset:3072 sc1 lds
  s_mov_b32 m0, s11
  s_cbranch_scc1 Ll_90
  s_waitcnt vmcnt(48)
  s_barrier
  s_waitcnt vmcnt(32)
  s_barrier
  buffer_load_dwordx4 v4, s[40:43], s7 offen offset:0 sc1 lds
  buffer_load_dwordx4 v5, s[40:43], s7 offen offset:1024 sc1 lds
  buffer_load_dwordx4 v6, s[40:43], s7 offen offset:2048 sc1 lds
  buffer_load_dwordx4 v7, s[40:43], s7 offen offset:3072 sc1 lds
Ll_94:
  s_add_u32 m0, s11, 4096
  s_nop 0
  s_add_u32 s5, s7, s13
  buffer_load_dwordx4 v4, s[40:43], s5 offen offset:0 sc1 lds
  buffer_load_dwordx4 v5, s[40:43], s5 offen offset:1024 sc1 lds
  buffer_load_dwordx4 v6, s[40:43], s5 offen offset:2048 sc1 lds
  buffer_load_dwordx4 v7, s[40:43], s5 offen offset:3072 sc1 lds
  s_add_u32 m0, s11, 8192
  s_nop 0
  s_add_u32 s3, s7, s95
  buffer_load_dwordx4 v4, s[40:43], s3 offen offset:0 sc1 lds
  buffer_load_dwordx4 v5, s[40:43], s3 offen offset:1024 sc1 lds
  buffer_load_dwordx4 v6, s[40:43], s3 offen offset:2048 sc1 lds
  buffer_load_dwordx4 v7, s[40:43], s3 offen offset:3072 sc1 lds
  s_add_u32 m0, s11, 12288
  s_add_u32 s5, s3, s13
  buffer_load_dwordx4 v4, s[40:43], s5 offen offset:0 sc1 lds
  s_add_u32 s12, s12, 1
  v_readlane_b32 s7, v9, s12
  s_add_u32 s11, s11, 16384
  buffer_load_dwordx4 v5, s[40:43], s5 offen offset:1024 sc1 lds
  s_cmp_eq_u32 s11, s15
  s_cselect_b32 s4, 65536, 0
  s_sub_u32 s11, s11, s4
  buffer_load_dwordx4 v6, s[40:43], s5 offen offset:2048 sc1 lds
  s_cmp_eq_u32 s12, Lz1-Lz0+32
  buffer_load_dwordx4 v7, s[40:43], s5 offen offset:3072 sc1 lds
  s_mov_b32 m0, s11
  s_cbranch_scc1 Ll_95
  s_waitcnt vmcnt(32)
  s_barrier
  buffer_load_dwordx4 v4, s[40:43], s7 offen offset:0 sc1 lds
  buffer_load_dwordx4 v5, s[40:43], s7 offen offset:1024 sc1 lds
  buffer_load_dwordx4 v6, s[40:43], s7 offen offset:2048 sc1 lds
  buffer_load_dwordx4 v7, s[40:43], s7 offen offset:3072 sc1 lds
  s_branch Ll_94
Ll_95:
  s_waitcnt vmcnt(32)
  s_barrier
  s_waitcnt vmcnt(16)
  s_barrier
  s_waitcnt vmcnt(0)
  s_barrier
  s_barrier
  s_cmp_lg_u32 s82, 0
  s_cbranch_scc1 L_lend
  s_mul_i32 s5, s76, 16
  s_lshl_b32 s5, s5, 14
  s_add_u32 s5, s5, 35651584
  s_mov_b32 s8, 16384
  s_mov_b32 s10, 262144
  s_add_u32 s9, s5, s10
  s_mul_i32 s6, s76, 11
  s_lshr_b32 s6, s6, Lz1-Lz0+5
  s_mul_i32 s6, s6, 49152
  s_add_u32 s7, s5, s6
  s_add_u32 s91, s91, 8
  s_lshr_b32 s6, s6, 14
  s_lshl_b32 s90, 0x1f, s6
  s_lshr_b32 s4, s90, 16
  s_or_b32 s90, s90, s4
  s_and_b32 s90, s90, 0xffff
  s_mov_b32 s82, 1
  s_add_u32 s83, s83, 0
  s_add_u32 s87, s87, Lz1-Lz0+32
  s_mov_b32 s89, 200000
  s_mov_b32 exec_lo, s90
  s_mov_b32 exec_hi, 0
  buffer_load_dword v12, v8, s[40:43], s91 offen sc0 sc1
Lp_96:
  s_waitcnt vmcnt(0)
  v_cmp_ne_u32 vcc, 0, v12
  s_andn2_b32 s3, exec_lo, vcc_lo
  s_cbranch_scc0 Lp_97
  s_mov_b32 exec_lo, s3
  s_sleep 1
  buffer_load_dword v12, v8, s[40:43], s91 offen sc0 sc1
  s_sub_u32 s89, s89, 1
  s_cbranch_scc0 Lp_96
Lp_97:
  s_mov_b64 exec, -1
  s_branch L_xlayer
  s_nop 0
L_s1:
  v_mov_b32 v11, 1
  v_and_b32 v2, 31, v1
  v_lshlrev_b32 v5, 7, v2
  v_lshlrev_b32 v10, 3, v2
  v_lshrrev_b32 v3, 5, v1
  v_mul_u32_u24 v3, 320, v3
  v_add_u32_e64 v10, v3, v10
  v_add_u32 v10, 151552, v10
  v_bfe_u32 v3, v1, 3, 1
  v_and_b32 v2, 7, v1
  v_lshlrev_b32 v12, 9, v3
  v_lshl_add_u32 v12, v2, 4, v12
  v_mul_u32_u24 v3, 320, v3
  v_lshl_add_u32 v13, v2, 3, v3
  v_add_u32 v13, 151808, v13
  v_and_b32 v2, 15, v1
  v_lshlrev_b32 v8, 4, v2
  v_lshlrev_b32 v15, 6, v2
  v_and_b32 v3, 48, v1
  v_add_u32 v15, v15, v3
  v_and_b32 v2, 14, v1
  v_lshlrev_b32 v6, 2, v2
  v_lshlrev_b32 v14, 16, v1
  s_lshl_b32 s4, s77, 12
  s_lshl_b32 s5, s76, 7
  s_add_u32 s4, s4, s5
  v_add_u32 v14, s4, v14
  v_lshrrev_b32 v2, 2, v1
  v_lshlrev_b32 v22, 7, v2
  v_lshlrev_b32 v96, 6, v2
  v_and_b32 v2, 3, v1
  v_lshl_add_u32 v22, v2, 3, v22
  v_lshl_add_u32 v96, v2, 3, v96
  v_add_u32 v22, 65536, v22
  v_add_u32 v96, 90112, v96
  v_bfe_u32 v3, v1, 3, 2
  v_xor_b32_e64 v2, 0, v3
  v_lshl_add_u32 v16, v2, 5, v22
  v_xor_b32_e64 v2, 1, v3
  v_lshl_add_u32 v17, v2, 5, v22
  v_xor_b32_e64 v2, 2, v3
  v_lshl_add_u32 v18, v2, 5, v22
  v_xor_b32_e64 v2, 3, v3
  v_lshl_add_u32 v19, v2, 5, v22
  v_bfe_u32 v3, v1, 4, 1
  v_xor_b32_e64 v2, 0, v3
  v_lshl_add_u32 v20, v2, 5, v96
  v_xor_b32_e64 v2, 1, v3
  v_lshl_add_u32 v21, v2, 5, v96
  v_mov_b32 v22, 0x3f803f80
  s_mul_i32 s4, s76, 11
  s_lshr_b32 s4, s4, 5
  s_mul_i32 s4, s4, 3
  s_sub_u32 s14, s76, s4
  s_mov_b32 s15, 32768
  s_mul_i32 s4, s14, 24576
  v_add_u32 v16, s4, v16
  v_add_u32 v17, s4, v17
  v_add_u32 v18, s4, v18
  v_add_u32 v19, s4, v19
  s_mov_b32 s98, 0x00010001
  s_mov_b32 s99, 0x00010001
  v_cndmask_b32_e64 v200, 0, v22, s[98:99]
  v_cndmask_b32_e64 v201, 0, v22, s[98:99]
  v_cndmask_b32_e64 v202, 0, v22, s[98:99]
  v_cndmask_b32_e64 v203, 0, v22, s[98:99]
  s_nop 0
  s_lshl_b64 s[98:99], s[98:99], 1
  v_cndmask_b32_e64 v204, 0, v22, s[98:99]
  v_cndmask_b32_e64 v205, 0, v22, s[98:99]
  v_cndmask_b32_e64 v206, 0, v22, s[98:99]
  v_cndmask_b32_e64 v207, 0, v22, s[98:99]
  s_nop 0
  s_lshl_b64 s[98:99], s[98:99], 1
  v_cndmask_b32_e64 v208, 0, v22, s[98:99]
  v_cndmask_b32_e64 v209, 0, v22, s[98:99]
  v_cndmask_b32_e64 v210, 0, v22, s[98:99]
  v_cndmask_b32_e64 v211, 0, v22, s[98:99]
  s_nop 0
  s_lshl_b64 s[98:99], s[98:99], 1
  v_cndmask_b32_e64 v212, 0, v22, s[98:99]
  v_cndmask_b32_e64 v213, 0, v22, s[98:99]
  v_cndmask_b32_e64 v214, 0, v22, s[98:99]
  v_cndmask_b32_e64 v215, 0, v22, s[98:99]
  s_nop 0
  s_lshl_b64 s[98:99], s[98:99], 1
  v_cndmask_b32_e64 v216, 0, v22, s[98:99]
  v_cndmask_b32_e64 v217, 0, v22, s[98:99]
  v_cndmask_b32_e64 v218, 0, v22, s[98:99]
  v_cndmask_b32_e64 v219, 0, v22, s[98:99]
  s_nop 0
  s_lshl_b64 s[98:99], s[98:99], 1
  v_cndmask_b32_e64 v220, 0, v22, s[98:99]
  v_cndmask_b32_e64 v221, 0, v22, s[98:99]
  v_cndmask_b32_e64 v222, 0, v22, s[98:99]
  v_cndmask_b32_e64 v223, 0, v22, s[98:99]
  s_nop 0
  s_lshl_b64 s[98:99], s[98:99], 1
  v_cndmask_b32_e64 v224, 0, v22, s[98:99]
  v_cndmask_b32_e64 v225, 0, v22, s[98:99]
  v_cndmask_b32_e64 v226, 0, v22, s[98:99]
  v_cndmask_b32_e64 v227, 0, v22, s[98:99]
  s_nop 0
  s_lshl_b64 s[98:99], s[98:99], 1
  v_cndmask_b32_e64 v228, 0, v22, s[98:99]
  v_cndmask_b32_e64 v229, 0, v22, s[98:99]
  v_cndmask_b32_e64 v230, 0, v22, s[98:99]
  v_cndmask_b32_e64 v231, 0, v22, s[98:99]
  s_nop 0
  s_lshl_b64 s[98:99], s[98:99], 1
  v_cndmask_b32_e64 v232, 0, v22, s[98:99]
  v_cndmask_b32_e64 v233, 0, v22, s[98:99]
  v_cndmask_b32_e64 v234, 0, v22, s[98:99]
  v_cndmask_b32_e64 v235, 0, v22, s[98:99]
  s_nop 0
  s_lshl_b64 s[98:99], s[98:99], 1
  v_cndmask_b32_e64 v236, 0, v22, s[98:99]
  v_cndmask_b32_e64 v237, 0, v22, s[98:99]
  v_cndmask_b32_e64 v238, 0, v22, s[98:99]
  v_cndmask_b32_e64 v239, 0, v22, s[98:99]
  s_nop 0
  s_lshl_b64 s[98:99], s[98:99], 1
  v_cndmask_b32_e64 v240, 0, v22, s[98:99]
  v_cndmask_b32_e64 v241, 0, v22, s[98:99]
  v_cndmask_b32_e64 v242, 0, v22, s[98:99]
  v_cndmask_b32_e64 v243, 0, v22, s[98:99]
  s_nop 0
  s_lshl_b64 s[98:99], s[98:99], 1
  v_cndmask_b32_e64 v244, 0, v22, s[98:99]
  v_cndmask_b32_e64 v245, 0, v22, s[98:99]
  v_cndmask_b32_e64 v246, 0, v22, s[98:99]
  v_cndmask_b32_e64 v247, 0, v22, s[98:99]
  s_lshl_b64 s[98:99], s[98:99], 1
  s_mov_b32 s56, s24
  s_and_b32 s57, s25, 0xffff
  s_mov_b32 s58, 7340032
  s_mov_b32 s59, 0x00020000
  s_nop 0
  s_mov_b32 s60, s28
  s_and_b32 s61, s29, 0xffff
  s_mov_b32 s62, 7340032
  s_mov_b32 s63, 0x00020000
  s_mul_i32 s12, s84, Lz1-Lz0+14
  s_add_u32 s12, s12, 20480
  s_mov_b32 s13, s12
  v_lshlrev_b32 v110, 7, v1
  s_mov_b32 s8, 0x00500005
  s_mov_b32 s9, 0x50000500
L_slayer:
  s_barrier
  s_cmp_lg_u32 s82, Lz1-Lz0+0
  s_cbranch_scc1 L_98
  buffer_load_dwordx4 v[128:131], v108, s[44:47], s7 offen offset:0
  buffer_load_dwordx4 v[132:135], v108, s[44:47], s7 offen offset:128
  buffer_load_dwordx4 v[136:139], v108, s[44:47], s7 offen offset:256
  buffer_load_dwordx4 v[140:143], v108, s[44:47], s7 offen offset:384
  buffer_load_dwordx4 v[144:147], v108, s[44:47], s7 offen offset:512
  buffer_load_dwordx4 v[148:151], v108, s[44:47], s7 offen offset:640
  buffer_load_dwordx4 v[152:155], v108, s[44:47], s7 offen offset:768
  buffer_load_dwordx4 v[156:159], v108, s[44:47], s7 offen offset:896
  buffer_load_dwordx4 v[160:163], v108, s[44:47], s7 offen offset:1024
  buffer_load_dwordx4 v[164:167], v108, s[44:47], s7 offen offset:1152
  buffer_load_dwordx4 v[168:171], v108, s[44:47], s7 offen offset:1280
  buffer_load_dwordx4 v[172:175], v108, s[44:47], s7 offen offset:1408
  buffer_load_dwordx4 v[176:179], v108, s[44:47], s7 offen offset:1536
  buffer_load_dwordx4 v[180:183], v108, s[44:47], s7 offen offset:1664
  buffer_load_dwordx4 v[184:187], v108, s[44:47], s7 offen offset:1792
  buffer_load_dwordx4 v[188:191], v108, s[44:47], s7 offen offset:1920
  s_waitcnt vmcnt(16)
  s_lshl_b32 s4, s76, 4
  s_mov_b64 exec, 1
  buffer_atomic_add v11, v24, s[68:71], s4 offen sc1
  s_mov_b64 exec, -1
  s_branch L_99
L_98:
  s_lshl_b32 s91, s84, 1
  s_add_u32 s91, s91, s87
  s_sub_u32 s91, s91, 16
  s_mov_b32 s16, 0xffff
  s_mov_b32 exec_lo, s16
  s_mov_b32 exec_hi, 0
  buffer_load_dword v7, v5, s[40:43], s91 offen sc0 sc1
  s_mov_b64 exec, -1
L_99:
  s_cmp_le_u32 s14, 0
  s_cbranch_scc1 L_100
  s_barrier
L_100:
  s_cmp_le_u32 s14, Lz1-Lz0+1
  s_cbranch_scc1 L_101
  s_barrier
L_101:
  s_cmp_lg_u32 s82, 0
  s_cbranch_scc1 L_102
  ds_read_b64_tr_b16 v[32:33], v16 offset:0
  ds_read_b64_tr_b16 v[34:35], v16 offset:2048
  ds_read_b64_tr_b16 v[36:37], v17 offset:0
  ds_read_b64_tr_b16 v[38:39], v17 offset:2048
  ds_read_b64_tr_b16 v[40:41], v18 offset:0
  ds_read_b64_tr_b16 v[42:43], v18 offset:2048
  ds_read_b64_tr_b16 v[44:45], v19 offset:0
  ds_read_b64_tr_b16 v[46:47], v19 offset:2048
  ds_read_b64_tr_b16 v[48:49], v16 offset:4096
  ds_read_b64_tr_b16 v[50:51], v16 offset:6144
  ds_read_b64_tr_b16 v[52:53], v17 offset:4096
  ds_read_b64_tr_b16 v[54:55], v17 offset:6144
  s_nop 0
  s_waitcnt lgkmcnt(4)
  ds_read_b64_tr_b16 v[56:57], v18 offset:4096
  ds_read_b64_tr_b16 v[58:59], v18 offset:6144
  ds_read_b64_tr_b16 v[60:61], v19 offset:4096
  ds_read_b64_tr_b16 v[62:63], v19 offset:6144
  s_cmp_eq_u32 s14, Lz1-Lz0+2
  s_cselect_b32 s4, 0xffff6000, s15
  v_add_u32 v16, s4, v16
  v_add_u32 v17, s4, v17
  v_add_u32 v18, s4, v18
  v_add_u32 v19, s4, v19
  s_waitcnt lgkmcnt(0)
L_102:
  s_barrier
  s_cmp_lg_u32 s82, 0
  s_cbranch_scc1 L_104
  ds_read_b64_tr_b16 v[64:65], v16 offset:0
  ds_read_b64_tr_b16 v[66:67], v16 offset:2048
  ds_read_b64_tr_b16 v[68:69], v17 offset:0
  ds_read_b64_tr_b16 v[70:71], v17 offset:2048
  ds_read_b64_tr_b16 v[72:73], v18 offset:0
  ds_read_b64_tr_b16 v[74:75], v18 offset:2048
  ds_read_b64_tr_b16 v[76:77], v19 offset:0
  ds_read_b64_tr_b16 v[78:79], v19 offset:2048
  ds_read_b64_tr_b16 v[80:81], v16 offset:4096
  ds_read_b64_tr_b16 v[82:83], v16 offset:6144
  ds_read_b64_tr_b16 v[84:85], v17 offset:4096
  ds_read_b64_tr_b16 v[86:87], v17 offset:6144
  s_nop 0
  s_waitcnt lgkmcnt(4)
  ds_read_b64_tr_b16 v[88:89], v18 offset:4096
  ds_read_b64_tr_b16 v[90:91], v18 offset:6144
  ds_read_b64_tr_b16 v[92:93], v19 offset:4096
  ds_read_b64_tr_b16 v[94:95], v19 offset:6144
  s_cmp_eq_u32 s14, Lz1-Lz0+1
  s_cselect_b32 s4, 0xffff6000, s15
  v_add_u32 v16, s4, v16
  v_add_u32 v17, s4, v17
  v_add_u32 v18, s4, v18
  v_add_u32 v19, s4, v19
  v_mfma_f32_16x16x32_bf16 v[28:31], v[32:35], v[200:203], 0
  v_mfma_f32_16x16x32_bf16 v[28:31], v[36:39], v[204:207], v[28:31]
  v_mfma_f32_16x16x32_bf16 v[28:31], v[40:43], v[208:211], v[28:31]
  v_mfma_f32_16x16x32_bf16 v[28:31], v[44:47], v[212:215], v[28:31]
  v_mfma_f32_16x16x32_bf16 v[28:31], v[48:51], v[200:203], v[28:31]
  v_mfma_f32_16x16x32_bf16 v[28:31], v[52:55], v[204:207], v[28:31]
  v_mfma_f32_16x16x32_bf16 v[28:31], v[56:59], v[208:211], v[28:31]
  v_mfma_f32_16x16x32_bf16 v[28:31], v[60:63], v[212:215], v[28:31]
  s_waitcnt lgkmcnt(0)
  s_branch L_105
  s_nop 0
L_104:
  s_waitcnt vmcnt(0)
  s_mov_b32 s89, 200000
  s_mov_b32 exec_lo, s16
  s_mov_b32 exec_hi, 0
  s_branch Lp_107
Lp_106:
  buffer_load_dword v7, v5, s[40:43], s91 offen sc0 sc1
  s_waitcnt vmcnt(0)
Lp_107:
  v_cmp_ne_u32 vcc, 0, v7
  s_andn2_b32 s3, s16, vcc_lo
  s_cbranch_scc0 Lp_108
  s_sleep 1
  s_sub_u32 s89, s89, 1
  s_cbranch_scc0 Lp_106
Lp_108:
  s_mov_b64 exec, -1
  s_add_u32 s5, s84, s92
  buffer_load_dwordx2 v[96:97], v6, s[40:43], s5 offen offset:0 sc1
  buffer_load_dwordx2 v[98:99], v6, s[40:43], s5 offen offset:512 sc1
  buffer_load_dwordx2 v[100:101], v6, s[40:43], s5 offen offset:1024 sc1
  buffer_load_dwordx2 v[102:103], v6, s[40:43], s5 offen offset:1536 sc1
L_105:
  s_barrier
  s_cmp_lg_u32 s82, Lz1-Lz0+0
  s_cbranch_scc1 L_109
  ds_read_b64_tr_b16 v[32:33], v16 offset:0
  ds_read_b64_tr_b16 v[34:35], v16 offset:2048
  ds_read_b64_tr_b16 v[36:37], v17 offset:0
  ds_read_b64_tr_b16 v[38:39], v17 offset:2048
  ds_read_b64_tr_b16 v[40:41], v18 offset:0
  ds_read_b64_tr_b16 v[42:43], v18 offset:2048
  ds_read_b64_tr_b16 v[44:45], v19 offset:0
  ds_read_b64_tr_b16 v[46:47], v19 offset:2048
  ds_read_b64_tr_b16 v[48:49], v16 offset:4096
  ds_read_b64_tr_b16 v[50:51], v16 offset:6144
  ds_read_b64_tr_b16 v[52:53], v17 offset:4096
  ds_read_b64_tr_b16 v[54:55], v17 offset:6144
  s_nop 0
  s_waitcnt lgkmcnt(4)
  ds_read_b64_tr_b16 v[56:57], v18 offset:4096
  ds_read_b64_tr_b16 v[58:59], v18 offset:6144
  ds_read_b64_tr_b16 v[60:61], v19 offset:4096
  ds_read_b64_tr_b16 v[62:63], v19 offset:6144
  v_mfma_f32_16x16x32_bf16 v[28:31], v[64:67], v[216:219], v[28:31]
  v_mfma_f32_16x16x32_bf16 v[28:31], v[68:71], v[220:223], v[28:31]
  v_mfma_f32_16x16x32_bf16 v[28:31], v[72:75], v[224:227], v[28:31]
  v_mfma_f32_16x16x32_bf16 v[28:31], v[76:79], v[228:231], v[28:31]
  v_mfma_f32_16x16x32_bf16 v[28:31], v[80:83], v[216:219], v[28:31]
  v_mfma_f32_16x16x32_bf16 v[28:31], v[84:87], v[220:223], v[28:31]
  v_mfma_f32_16x16x32_bf16 v[28:31], v[88:91], v[224:227], v[28:31]
  v_mfma_f32_16x16x32_bf16 v[28:31], v[92:95], v[228:231], v[28:31]
  s_waitcnt lgkmcnt(0)
L_109:
  s_barrier
  s_cmp_lg_u32 s82, 0
  s_cbranch_scc1 L_111
  v_mfma_f32_16x16x32_bf16 v[28:31], v[32:35], v[232:235], v[28:31]
  v_mfma_f32_16x16x32_bf16 v[28:31], v[36:39], v[236:239], v[28:31]
  v_mfma_f32_16x16x32_bf16 v[28:31], v[40:43], v[240:243], v[28:31]
  v_mfma_f32_16x16x32_bf16 v[28:31], v[44:47], v[244:247], v[28:31]
  v_mfma_f32_16x16x32_bf16 v[28:31], v[48:51], v[232:235], v[28:31]
  v_mfma_f32_16x16x32_bf16 v[28:31], v[52:55], v[236:239], v[28:31]
  v_mfma_f32_16x16x32_bf16 v[28:31], v[56:59], v[240:243], v[28:31]
  v_mfma_f32_16x16x32_bf16 v[28:31], v[60:63], v[244:247], v[28:31]
  s_lshl_b32 s5, s77, 14
  s_lshl_b32 s4, s76, 10
  s_add_u32 s5, s5, s4
  s_add_u32 s5, s5, 1114112
  s_nop 3
  buffer_store_dwordx4 v[28:31], v15, s[40:43], s5 offen sc0 sc1
L_111:
  s_cmp_gt_u32 s14, 0
  s_cbranch_scc1 L_113
  s_barrier
L_113:
  s_cmp_gt_u32 s14, 1
  s_cbranch_scc1 L_114
  s_barrier
L_114:
  s_cmp_lg_u32 s82, 0
  s_cbranch_scc1 L_115
  s_waitcnt vmcnt(2)
  buffer_load_dword v9, v8, s[68:71], 0 offen sc0 sc1
  s_mov_b32 s72, s26
  s_and_b32 s73, s27, 0xffff
  s_mov_b32 s74, 7168
  s_mov_b32 s75, 0x00020000
  s_mul_i32 s4, s77, 448
  s_and_b32 s5, s77, Lz1-Lz0+1
  s_lshl_b32 s6, s5, 6
  s_add_u32 s6, s6, s4
  s_mul_i32 s5, s5, 384
  s_sub_u32 s5, s4, s5
  v_lshlrev_b32 v2, 1, v1
  v_lshrrev_b32 v3, 1, v2
  v_xor_b32 v3, v3, v2
  v_and_b32 v3, 16, v3
  v_mul_u32_u24 v3, 3, v3
  v_xor_b32_e64 v3, v3, v2
  buffer_load_ushort v104, v2, s[72:75], s6 offen offset:0
  buffer_load_ushort v105, v2, s[72:75], s6 offen offset:128
  buffer_load_ushort v106, v2, s[72:75], s6 offen offset:256
  buffer_load_ushort v107, v3, s[72:75], s5 offen offset:384
  s_nop 0
  s_mov_b32 s64, s30
  s_and_b32 s65, s31, 0xffff
  s_mov_b32 s66, 2048
  s_mov_b32 s67, 0x00020000
  s_lshl_b32 s4, s78, Lz1-Lz0+7
  buffer_load_ushort v108, v2, s[64:67], s4 offen
  v_mov_b32 v32, v22
  v_mov_b32 v33, v22
  v_mov_b32_e64 v34, v22
  v_mov_b32 v35, v22
  s_nop 1
  v_mfma_f32_16x16x32_bf16 v[96:99], v[32:35], v[128:131], 0
  v_mfma_f32_16x16x32_bf16 v[100:103], v[128:131], v[128:131], 0
  v_mfma_f32_16x16x32_bf16 v[96:99], v[32:35], v[132:135], v[96:99]
  v_mfma_f32_16x16x32_bf16 v[100:103], v[132:135], v[132:135], v[100:103]
  v_mfma_f32_16x16x32_bf16 v[96:99], v[32:35], v[136:139], v[96:99]
  v_mfma_f32_16x16x32_bf16 v[100:103], v[136:139], v[136:139], v[100:103]
  v_mfma_f32_16x16x32_bf16 v[96:99], v[32:35], v[140:143], v[96:99]
  v_mfma_f32_16x16x32_bf16 v[100:103], v[140:143], v[140:143], v[100:103]
L_115:
  s_barrier
  s_cmp_lg_u32 s82, Lz1-Lz0+0
  s_cbranch_scc1 L_117
  v_mfma_f32_16x16x32_bf16 v[96:99], v[32:35], v[144:147], v[96:99]
  v_mfma_f32_16x16x32_bf16 v[100:103], v[144:147], v[144:147], v[100:103]
  v_mfma_f32_16x16x32_bf16 v[96:99], v[32:35], v[148:151], v[96:99]
  v_mfma_f32_16x16x32_bf16 v[100:103], v[148:151], v[148:151], v[100:103]
  v_mfma_f32_16x16x32_bf16 v[96:99], v[32:35], v[152:155], v[96:99]
  v_mfma_f32_16x16x32_bf16 v[100:103], v[152:155], v[152:155], v[100:103]
  v_mfma_f32_16x16x32_bf16 v[96:99], v[32:35], v[156:159], v[96:99]
  v_mfma_f32_16x16x32_bf16 v[100:103], v[156:159], v[156:159], v[100:103]
L_117:
  s_barrier
  s_cmp_lg_u32 s82, Lz1-Lz0+0
  s_cbranch_scc1 L_119
  v_mfma_f32_16x16x32_bf16 v[96:99], v[32:35], v[160:163], v[96:99]
  v_mfma_f32_16x16x32_bf16 v[100:103], v[160:163], v[160:163], v[100:103]
  v_mfma_f32_16x16x32_bf16 v[96:99], v[32:35], v[164:167], v[96:99]
  v_mfma_f32_16x16x32_bf16 v[100:103], v[164:167], v[164:167], v[100:103]
  v_mfma_f32_16x16x32_bf16 v[96:99], v[32:35], v[168:171], v[96:99]
  v_mfma_f32_16x16x32_bf16 v[100:103], v[168:171], v[168:171], v[100:103]
  v_mfma_f32_16x16x32_bf16 v[96:99], v[32:35], v[172:175], v[96:99]
  v_mfma_f32_16x16x32_bf16 v[100:103], v[172:175], v[172:175], v[100:103]
  s_waitcnt vmcnt(0)
  v_lshlrev_b32 v2, 2, v1
  v_add_u32 v2, 155136, v2
  v_lshlrev_b32_e64 v104, 16, v104
  v_mul_f32 v104, 0x3eeff558, v104
  ds_write_b32 v2, v104 offset:0
  v_lshlrev_b32_e64 v105, 16, v105
  v_mul_f32 v105, 0x3eeff558, v105
  ds_write_b32 v2, v105 offset:256
  v_lshlrev_b32_e64 v106, 16, v106
  v_mul_f32 v106, 0x3eeff558, v106
  ds_write_b32 v2, v106 offset:512
  v_lshlrev_b32_e64 v107, 16, v107
  v_mul_f32 v107, 0x3eeff558, v107
  ds_write_b32 v2, v107 offset:768
  v_lshlrev_b32_e64 v108, 16, v108
  ds_write_b32 v2, v108 offset:1024
  v_mov_b32 v2, 156416
  ds_write_b64 v2, v[24:25]
  s_mov_b32 s89, 200000
  s_branch Lg_122
  s_nop 0
Lg_121:
  buffer_load_dword v9, v8, s[68:71], 0 offen sc0 sc1
  s_waitcnt vmcnt(0)
Lg_122:
  v_cmp_eq_u32 vcc, 16, v9
  s_andn2_b32 s3, 0xffff, vcc_lo
  s_cbranch_scc0 Lg_123
  s_sleep 2
  s_sub_u32 s89, s89, 1
  s_cbranch_scc0 Lg_121
Lg_123:
  s_mov_b32 s5, 1835008
  s_mov_b64 exec, 0xffff
  buffer_store_dword v11, v14, s[40:43], s5 offen sc0 sc1
  s_mov_b64 exec, -1
  s_getpc_b64 s[4:5]
L_pc0:
  s_sub_u32 s4, s4, L_pc0-mega_kernel
  s_subb_u32 s5, s5, 0
  s_bfe_u32 s6, s2, 0x20003
  s_lshl_b32 s6, s6, 13
  v_lshl_add_u32 v3, v1, 4, s6
  v_mov_b32_e64 v119, s5
  v_min_u32 v118, L_end-mega_kernel-16, v3
  v_add_co_u32_e64 v116, vcc, s4, v118
  v_add_u32 v3, 0x400, v3
  s_nop 0
  v_addc_co_u32 v117, vcc, 0, v119, vcc
  global_load_dwordx4 v[112:115], v[116:117], off
  v_min_u32 v118, L_end-mega_kernel-16, v3
  v_add_co_u32_e64 v116, vcc, s4, v118
  v_add_u32 v3, 0x400, v3
  s_nop 0
  v_addc_co_u32 v117, vcc, 0, v119, vcc
  global_load_dwordx4 v[112:115], v[116:117], off
  v_min_u32 v118, L_end-mega_kernel-16, v3
  v_add_co_u32_e64 v116, vcc, s4, v118
  v_add_u32 v3, 0x400, v3
  s_nop 0
  v_addc_co_u32 v117, vcc, 0, v119, vcc
  global_load_dwordx4 v[112:115], v[116:117], off
  v_min_u32 v118, L_end-mega_kernel-16, v3
  v_add_co_u32 v116, vcc, s4, v118
  s_nop 1
  v_addc_co_u32 v117, vcc, 0, v119, vcc
  global_load_dwordx4 v[112:115], v[116:117], off
L_119:
  s_barrier
  s_cmp_lg_u32 s82, 0
  s_cbranch_scc1 L_124
  v_mfma_f32_16x16x32_bf16 v[96:99], v[32:35], v[176:179], v[96:99]
  v_mfma_f32_16x16x32_bf16 v[100:103], v[176:179], v[176:179], v[100:103]
  v_mfma_f32_16x16x32_bf16 v[96:99], v[32:35], v[180:183], v[96:99]
  v_mfma_f32_16x16x32_bf16 v[100:103], v[180:183], v[180:183], v[100:103]
  v_mfma_f32_16x16x32_bf16 v[96:99], v[32:35], v[184:187], v[96:99]
  v_mfma_f32_16x16x32_bf16 v[100:103], v[184:187], v[184:187], v[100:103]
  v_mfma_f32_16x16x32_bf16 v[96:99], v[32:35], v[188:191], v[96:99]
  v_mfma_f32_16x16x32_bf16 v[100:103], v[188:191], v[188:191], v[100:103]
  s_getpc_b64 s[4:5]
L_pc1:
  s_sub_u32 s4, s4, L_pc1-mega_kernel
  s_subb_u32 s5, s5, 0
  s_bfe_u32 s6, s2, 0x20003
  s_lshl_b32 s6, s6, Lz1-Lz0+13
  s_add_u32 s6, s6, 4096
  v_lshl_add_u32 v3, v1, 4, s6
  v_mov_b32_e64 v119, s5
  v_min_u32 v118, L_end-mega_kernel-16, v3
  v_add_co_u32_e64 v116, vcc, s4, v118
  v_add_u32 v3, 0x400, v3
  s_nop 0
  v_addc_co_u32 v117, vcc, 0, v119, vcc
  global_load_dwordx4 v[112:115], v[116:117], off
  v_min_u32 v118, L_end-mega_kernel-16, v3
  v_add_co_u32_e64 v116, vcc, s4, v118
  v_add_u32 v3, 0x400, v3
  s_nop 0
  v_addc_co_u32 v117, vcc, 0, v119, vcc
  global_load_dwordx4 v[112:115], v[116:117], off
  v_min_u32 v118, L_end-mega_kernel-16, v3
  v_add_co_u32_e64 v116, vcc, s4, v118
  v_add_u32 v3, 0x400, v3
  s_nop 0
  v_addc_co_u32 v117, vcc, 0, v119, vcc
  global_load_dwordx4 v[112:115], v[116:117], off
  v_min_u32 v118, L_end-mega_kernel-16, v3
  v_add_co_u32 v116, vcc, s4, v118
  s_nop 1
  v_addc_co_u32_e64 v117, vcc, 0, v119, vcc
  global_load_dwordx4 v[112:115], v[116:117], off
  s_mov_b32 s98, 0xaaaaaaaa
  s_mov_b32 s99, 0xaaaaaaaa
  v_cndmask_b32_e64 v100, v100, v101, s[98:99]
  v_cndmask_b32_e64 v102, v102, v103, s[98:99]
  s_mov_b32 s98, 0xcccccccc
  s_mov_b32 s99, 0xcccccccc
  v_cndmask_b32_e64 v97, v100, v102, s[98:99]
  v_add_f32_dpp v96, v96, v96 quad_perm:[1,0,3,2] row_mask:0xf bank_mask:0xf
  s_nop 0
  v_add_f32_dpp v97, v97, v97 quad_perm:[1,0,3,2] row_mask:0xf bank_mask:0xf
  s_branch L_125
L_124:
  s_waitcnt vmcnt(0)
  v_add_f32 v96, v96, v100
  v_add_f32 v97, v97, v101
  v_add_f32 v98, v98, v102
  v_add_f32 v99, v99, v103
  v_add_f32 v96, v96, v98
  v_add_f32 v97, v97, v99
  s_nop 0
  v_add_f32_dpp v96, v96, v96 row_ror:8 row_mask:0xf bank_mask:0xf
  v_add_f32_dpp v97, v97, v97 row_ror:8 row_mask:0xf bank_mask:0xf
  v_mov_b32 v98, v96
  v_mov_b32 v99, v97
  s_nop 0
  v_permlane16_swap_b32 v96, v98
  v_permlane16_swap_b32 v97, v99
  v_add_f32 v96, v96, v98
  v_add_f32 v97, v97, v99
  v_mov_b32 v98, v96
  v_mov_b32 v99, v97
  s_nop 0
  v_permlane32_swap_b32 v96, v98
  v_permlane32_swap_b32 v97, v99
  v_add_f32 v96, v96, v98
  v_add_f32 v97, v97, v99
L_125:
  v_mul_f32 v96, 0x3a800000, v96
  v_mul_f32 v97, 0x3a800000, v97
  v_fma_f32 v98, -v96, v96, v97
  v_max_f32_e64 v98, 0, v98
  v_add_f32 v98, 0x3727c5ac, v98
  v_rsq_f32 v98, v98
  s_nop 0
  v_mul_f32 v99, v96, v98
  s_mov_b64 exec, s[8:9]
  buffer_store_dwordx2 v[98:99], v6, s[40:43], s10 offen sc0 sc1
  s_mov_b64 exec, -1
  s_barrier
  s_cmp_lg_u32 s82, 0
  s_cbranch_scc1 L_126
  v_lshlrev_b32_e64 v6, 3, v1
  s_mov_b64 s[8:9], 0xff
  s_lshl_b32 s91, s84, Lz1-Lz0+1
  s_add_u32 s91, s91, 1835008
  s_mov_b32 exec_lo, 0xffff
  s_mov_b32 exec_hi, Lz1-Lz0+0
  buffer_load_dword v7, v5, s[40:43], s91 offen sc0 sc1
  s_mov_b64 exec, -1
L_126:
  s_barrier
  s_barrier
  s_waitcnt vmcnt(0)
  s_and_b32 s5, s10, 0xfffffc00
  buffer_load_dwordx4 v[120:123], v4, s[40:43], s5 offen sc1
  s_cmp_lg_u32 s82, 0
  s_cbranch_scc1 L_128
  s_mov_b32 s89, 200000
  s_mov_b32 exec_lo, 0xffff
  s_mov_b32 exec_hi, 0
  s_branch Lp_131
Lp_130:
  buffer_load_dword v7, v5, s[40:43], s91 offen sc0 sc1
  s_waitcnt vmcnt(0)
Lp_131:
  v_cmp_ne_u32 vcc, 0, v7
  s_andn2_b32 s3, 0xffff, vcc_lo
  s_cbranch_scc0 Lp_132
  s_sleep 1
  s_sub_u32 s89, s89, 1
  s_cbranch_scc0 Lp_130
Lp_132:
  s_mov_b64 exec, -1
  s_lshl_b32 s5, s77, 14
  s_add_u32 s5, s5, 1114112
  buffer_load_dwordx4 v[192:195], v4, s[40:43], s5 offen offset:0 sc1
  buffer_load_dwordx4 v[196:199], v4, s[40:43], s5 offen offset:1024 sc1
  buffer_load_dwordx4 v[200:203], v4, s[40:43], s5 offen offset:2048 sc1
  buffer_load_dwordx4 v[204:207], v4, s[40:43], s5 offen offset:3072 sc1
  s_add_u32 s5, s5, 4096
  buffer_load_dwordx4 v[208:211], v4, s[40:43], s5 offen offset:0 sc1
  buffer_load_dwordx4 v[212:215], v4, s[40:43], s5 offen offset:1024 sc1
  buffer_load_dwordx4 v[216:219], v4, s[40:43], s5 offen offset:2048 sc1
  buffer_load_dwordx4 v[220:223], v4, s[40:43], s5 offen offset:3072 sc1
L_128:
  s_barrier
  s_cmp_lg_u32 s82, 0
  s_cbranch_scc1 L_133
  s_lshl_b32 s5, s77, 14
  s_add_u32 s5, s5, 1122304
  buffer_load_dwordx4 v[224:227], v4, s[40:43], s5 offen offset:0 sc1
  buffer_load_dwordx4 v[228:231], v4, s[40:43], s5 offen offset:1024 sc1
  buffer_load_dwordx4 v[232:235], v4, s[40:43], s5 offen offset:2048 sc1
  buffer_load_dwordx4 v[236:239], v4, s[40:43], s5 offen offset:3072 sc1
  s_add_u32 s5, s5, 4096
  buffer_load_dwordx4 v[240:243], v4, s[40:43], s5 offen offset:0 sc1
  buffer_load_dwordx4 v[244:247], v4, s[40:43], s5 offen offset:1024 sc1
  buffer_load_dwordx4 v[248:251], v4, s[40:43], s5 offen offset:2048 sc1
  buffer_load_dwordx4 v[252:255], v4, s[40:43], s5 offen offset:3072 sc1
L_133:
  s_barrier
  s_cmp_lg_u32 s82, 0
  s_cbranch_scc1 L_135
  s_waitcnt vmcnt(16)
  s_branch L_136
L_135:
  s_waitcnt vmcnt(0)
L_136:
  s_mov_b32 s89, 200000
  s_branch Lp_138
  s_nop 0
Lp_137:
  s_and_b32 s5, s10, 0xfffffc00
  buffer_load_dwordx4 v[120:123], v4, s[40:43], s5 offen sc1
  s_waitcnt vmcnt(0)
Lp_138:
  v_min_u32 v2, v120, v122
  v_cmp_eq_u32 vcc, 0, v2
  s_cmp_eq_u64 vcc, 0
  s_cbranch_scc1 Lp_139
  s_sleep 1
  s_sub_u32 s89, s89, 1
  s_cbranch_scc0 Lp_137
Lp_139:
  ds_write2_b32 v10, v120, v122 offset0:0 offset1:1
  ds_write2_b32 v10, v121, v123 offset0:160 offset1:161
  s_add_u32 s10, s10, 16384
  s_cmp_lg_u32 s82, 0
  s_cbranch_scc1 L_140
  buffer_load_dword v109, v110, s[56:59], s12 offen
  s_sub_u32 s12, s12, 8192
L_140:
  s_barrier
  s_cmp_lg_u32 s82, 0
  s_cbranch_scc1 L_142
  s_cmp_lg_u32 s82, 0
  s_cbranch_scc1 L_144
  s_waitcnt vmcnt(1)
  s_branch L_145
L_144:
  s_waitcnt vmcnt(0)
L_145:
  v_add_f32 v192, v192, v224
  v_add_f32 v193, v193, v225
  v_add_f32 v194, v194, v226
  v_add_f32 v195, v195, v227
  v_add_f32 v196, v196, v228
  v_add_f32 v197, v197, v229
  v_add_f32 v198, v198, v230
  v_add_f32 v199, v199, v231
  v_add_f32 v200, v200, v232
  v_add_f32 v201, v201, v233
  v_add_f32 v202, v202, v234
  v_add_f32 v203, v203, v235
  v_add_f32 v204, v204, v236
  v_add_f32 v205, v205, v237
  v_add_f32 v206, v206, v238
  v_add_f32 v207, v207, v239
  v_add_f32 v208, v208, v240
  v_add_f32 v209, v209, v241
  v_add_f32 v210, v210, v242
  v_add_f32 v211, v211, v243
  v_add_f32 v212, v212, v244
  v_add_f32 v213, v213, v245
  v_add_f32 v214, v214, v246
  v_add_f32 v215, v215, v247
  v_add_f32 v216, v216, v248
  v_add_f32 v217, v217, v249
  v_add_f32 v218, v218, v250
  v_add_f32 v219, v219, v251
  v_add_f32 v220, v220, v252
  v_add_f32 v221, v221, v253
  v_add_f32 v222, v222, v254
  v_add_f32 v223, v223, v255
  v_add_f32 v192, v192, v208
  v_add_f32 v193, v193, v209
  v_add_f32 v194, v194, v210
  v_add_f32 v195, v195, v211
  v_add_f32 v196, v196, v212
  v_add_f32 v197, v197, v213
  v_add_f32 v198, v198, v214
  v_add_f32 v199, v199, v215
  v_add_f32 v200, v200, v216
  v_add_f32 v201, v201, v217
  v_add_f32 v202, v202, v218
  v_add_f32 v203, v203, v219
  v_add_f32 v204, v204, v220
  v_add_f32 v205, v205, v221
  v_add_f32 v206, v206, v222
  v_add_f32 v207, v207, v223
  v_add_f32 v192, v192, v200
  v_add_f32 v193, v193, v201
  v_add_f32 v194, v194, v202
  v_add_f32 v195, v195, v203
  v_add_f32 v196, v196, v204
  v_add_f32 v197, v197, v205
  v_add_f32 v198, v198, v206
  v_add_f32 v199, v199, v207
  v_add_f32 v192, v192, v196
  v_add_f32 v193, v193, v197
  v_add_f32 v194, v194, v198
  v_add_f32 v195, v195, v199
  v_add_u32 v2, 153088, v4
  ds_write_b128 v2, v[192:195]
L_142:
  s_cmp_lg_u32 s82, 0
  s_cbranch_scc1 L_146
  buffer_load_dword v109, v110, s[56:59], s12 offen
  s_sub_u32 s12, s12, 8192
L_146:
  s_barrier
  s_waitcnt lgkmcnt(0)
  s_barrier
  s_cmp_lg_u32 s82, 0
  s_cbranch_scc1 L_148
  v_lshrrev_b32 v2, 2, v1
  v_lshlrev_b32 v22, 7, v2
  v_lshlrev_b32 v96, 6, v2
  v_and_b32_e64 v2, 3, v1
  v_lshl_add_u32 v22, v2, 3, v22
  v_lshl_add_u32 v96, v2, 3, v96
  v_add_u32 v22, 65536, v22
  v_add_u32 v96, 90112, v96
  v_bfe_u32 v3, v1, 3, 2
  v_xor_b32_e64 v2, 0, v3
  v_lshl_add_u32 v16, v2, 5, v22
  v_xor_b32_e64 v2, 1, v3
  v_lshl_add_u32 v17, v2, 5, v22
  v_xor_b32_e64 v2, 2, v3
  v_lshl_add_u32 v18, v2, 5, v22
  v_xor_b32_e64 v2, 3, v3
  v_lshl_add_u32 v19, v2, 5, v22
  v_bfe_u32 v3, v1, 4, 1
  v_xor_b32_e64 v2, 0, v3
  v_lshl_add_u32 v20, v2, 5, v96
  v_xor_b32_e64 v2, 1, v3
  v_lshl_add_u32 v21, v2, 5, v96
  v_mov_b32 v22, 0x3f803f80
  s_mov_b32 s98, 0x00010001
  s_mov_b32 s99, 0x00010001
  v_cndmask_b32_e64 v200, 0, v22, s[98:99]
  v_cndmask_b32_e64 v201, 0, v22, s[98:99]
  v_cndmask_b32_e64 v202, 0, v22, s[98:99]
  v_cndmask_b32_e64 v203, 0, v22, s[98:99]
  s_nop 0
  s_lshl_b64 s[98:99], s[98:99], 1
  v_cndmask_b32_e64 v204, 0, v22, s[98:99]
  v_cndmask_b32_e64 v205, 0, v22, s[98:99]
  v_cndmask_b32_e64 v206, 0, v22, s[98:99]
  v_cndmask_b32_e64 v207, 0, v22, s[98:99]
  s_nop 0
  s_lshl_b64 s[98:99], s[98:99], 1
  v_cndmask_b32_e64 v208, 0, v22, s[98:99]
  v_cndmask_b32_e64 v209, 0, v22, s[98:99]
  v_cndmask_b32_e64 v210, 0, v22, s[98:99]
  v_cndmask_b32_e64 v211, 0, v22, s[98:99]
  s_nop 0
  s_lshl_b64 s[98:99], s[98:99], 1
  v_cndmask_b32_e64 v212, 0, v22, s[98:99]
  v_cndmask_b32_e64 v213, 0, v22, s[98:99]
  v_cndmask_b32_e64 v214, 0, v22, s[98:99]
  v_cndmask_b32_e64 v215, 0, v22, s[98:99]
  s_nop 0
  s_lshl_b64 s[98:99], s[98:99], 1
  v_cndmask_b32_e64 v216, 0, v22, s[98:99]
  v_cndmask_b32_e64 v217, 0, v22, s[98:99]
  v_cndmask_b32_e64 v218, 0, v22, s[98:99]
  v_cndmask_b32_e64 v219, 0, v22, s[98:99]
  s_nop 0
  s_lshl_b64 s[98:99], s[98:99], 1
  v_cndmask_b32_e64 v220, 0, v22, s[98:99]
  v_cndmask_b32_e64 v221, 0, v22, s[98:99]
  v_cndmask_b32_e64 v222, 0, v22, s[98:99]
  v_cndmask_b32_e64 v223, 0, v22, s[98:99]
  s_nop 0
  s_lshl_b64 s[98:99], s[98:99], 1
  v_cndmask_b32_e64 v224, 0, v22, s[98:99]
  v_cndmask_b32_e64 v225, 0, v22, s[98:99]
  v_cndmask_b32_e64 v226, 0, v22, s[98:99]
  v_cndmask_b32_e64 v227, 0, v22, s[98:99]
  s_nop 0
  s_lshl_b64 s[98:99], s[98:99], 1
  v_cndmask_b32_e64 v228, 0, v22, s[98:99]
  v_cndmask_b32_e64 v229, 0, v22, s[98:99]
  v_cndmask_b32_e64 v230, 0, v22, s[98:99]
  v_cndmask_b32_e64 v231, 0, v22, s[98:99]
  s_nop 0
  s_lshl_b64 s[98:99], s[98:99], 1
  v_cndmask_b32_e64 v232, 0, v22, s[98:99]
  v_cndmask_b32_e64 v233, 0, v22, s[98:99]
  v_cndmask_b32_e64 v234, 0, v22, s[98:99]
  v_cndmask_b32_e64 v235, 0, v22, s[98:99]
  s_nop 0
  s_lshl_b64 s[98:99], s[98:99], 1
  v_cndmask_b32_e64 v236, 0, v22, s[98:99]
  v_cndmask_b32_e64 v237, 0, v22, s[98:99]
  v_cndmask_b32_e64 v238, 0, v22, s[98:99]
  v_cndmask_b32_e64 v239, 0, v22, s[98:99]
  s_nop 0
  s_lshl_b64 s[98:99], s[98:99], 1
  v_cndmask_b32_e64 v240, 0, v22, s[98:99]
  v_cndmask_b32_e64 v241, 0, v22, s[98:99]
  v_cndmask_b32_e64 v242, 0, v22, s[98:99]
  v_cndmask_b32_e64 v243, 0, v22, s[98:99]
  s_nop 0
  s_lshl_b64 s[98:99], s[98:99], 1
  v_cndmask_b32_e64 v244, 0, v22, s[98:99]
  v_cndmask_b32_e64 v245, 0, v22, s[98:99]
  v_cndmask_b32_e64 v246, 0, v22, s[98:99]
  v_cndmask_b32_e64 v247, 0, v22, s[98:99]
  s_nop 0
  s_lshl_b64 s[98:99], s[98:99], 1
  v_cndmask_b32_e64 v248, 0, v22, s[98:99]
  v_cndmask_b32_e64 v249, 0, v22, s[98:99]
  v_cndmask_b32_e64 v250, 0, v22, s[98:99]
  v_cndmask_b32_e64 v251, 0, v22, s[98:99]
  s_nop 0
  s_lshl_b64 s[98:99], s[98:99], 1
  v_cndmask_b32_e64 v252, 0, v22, s[98:99]
  v_cndmask_b32_e64 v253, 0, v22, s[98:99]
  v_cndmask_b32_e64 v254, 0, v22, s[98:99]
  v_cndmask_b32_e64 v255, 0, v22, s[98:99]
  s_lshl_b64 s[98:99], s[98:99], 1
L_148:
  s_lshl_b32 s91, s84, 1
  s_add_u32 s91, s91, s87
  s_barrier
  s_mov_b32 exec_lo, 0xffff
  s_mov_b32 exec_hi, 0
  buffer_load_dword v7, v5, s[40:43], s91 offen sc0 sc1
  s_mov_b64 exec, -1
  s_barrier
  s_barrier
  s_barrier
  s_waitcnt vmcnt(0)
  s_mov_b32 s89, 200000
  s_mov_b32 exec_lo, 0xffff
  s_mov_b32 exec_hi, 0
  s_branch Lp_151
Lp_150:
  buffer_load_dword v7, v5, s[40:43], s91 offen sc0 sc1
  s_waitcnt vmcnt(0)
Lp_151:
  v_cmp_ne_u32 vcc, 0, v7
  s_andn2_b32 s3, 0xffff, vcc_lo
  s_cbranch_scc0 Lp_152
  s_sleep 1
  s_sub_u32 s89, s89, 1
  s_cbranch_scc0 Lp_150
Lp_152:
  s_mov_b64 exec, -1
  s_barrier
  s_barrier
  s_barrier
  s_barrier
  s_barrier
  s_barrier
  s_barrier
  s_barrier
  s_barrier
  s_barrier
  s_barrier
  s_barrier
  s_barrier
  s_add_u32 s92, s83, 31457280
  s_add_u32 s91, s91, 4
  s_sub_u32 s16, s78, s76
  s_and_b32 s16, s16, 15
  s_barrier
  s_cmp_lg_u32 s82, 0
  s_cbranch_scc1 L_153
  s_cmp_lg_u32 s16, 1
  s_cbranch_scc1 L_155
  v_add_u32 v112, 0, v16
  v_add_u32 v113, 0, v17
  v_add_u32 v114, 0, v18
  v_add_u32 v115, 0, v19
  ds_read_b64_tr_b16 v[32:33], v112 offset:0
  ds_read_b64_tr_b16 v[34:35], v112 offset:2048
  ds_read_b64_tr_b16 v[36:37], v113 offset:0
  ds_read_b64_tr_b16 v[38:39], v113 offset:2048
  ds_read_b64_tr_b16 v[40:41], v114 offset:0
  ds_read_b64_tr_b16 v[42:43], v114 offset:2048
  ds_read_b64_tr_b16 v[44:45], v115 offset:0
  ds_read_b64_tr_b16 v[46:47], v115 offset:2048
  ds_read_b64_tr_b16 v[48:49], v112 offset:4096
  ds_read_b64_tr_b16 v[50:51], v112 offset:6144
  ds_read_b64_tr_b16 v[52:53], v113 offset:4096
  ds_read_b64_tr_b16 v[54:55], v113 offset:6144
  s_nop 0
  s_waitcnt lgkmcnt(4)
  ds_read_b64_tr_b16 v[56:57], v114 offset:4096
  ds_read_b64_tr_b16 v[58:59], v114 offset:6144
  ds_read_b64_tr_b16 v[60:61], v115 offset:4096
  ds_read_b64_tr_b16 v[62:63], v115 offset:6144
L_155:
  s_cmp_lg_u32 s16, 2
  s_cbranch_scc1 L_156
  v_add_u32 v112, 8192, v16
  v_add_u32 v113, 8192, v17
  v_add_u32 v114, 8192, v18
  v_add_u32 v115, 8192, v19
  ds_read_b64_tr_b16 v[64:65], v112 offset:0
  ds_read_b64_tr_b16 v[66:67], v112 offset:2048
  ds_read_b64_tr_b16 v[68:69], v113 offset:0
  ds_read_b64_tr_b16 v[70:71], v113 offset:2048
  ds_read_b64_tr_b16 v[72:73], v114 offset:0
  ds_read_b64_tr_b16 v[74:75], v114 offset:2048
  ds_read_b64_tr_b16 v[76:77], v115 offset:0
  ds_read_b64_tr_b16 v[78:79], v115 offset:2048
  ds_read_b64_tr_b16 v[80:81], v112 offset:4096
  ds_read_b64_tr_b16 v[82:83], v112 offset:6144
  ds_read_b64_tr_b16 v[84:85], v113 offset:4096
  ds_read_b64_tr_b16 v[86:87], v113 offset:6144
  s_nop 0
  s_waitcnt lgkmcnt(4)
  ds_read_b64_tr_b16 v[88:89], v114 offset:4096
  ds_read_b64_tr_b16 v[90:91], v114 offset:6144
  ds_read_b64_tr_b16 v[92:93], v115 offset:4096
  ds_read_b64_tr_b16 v[94:95], v115 offset:6144
L_156:
  s_cmp_lg_u32 s16, 3
  s_cbranch_scc1 L_157
  v_add_u32 v112, 16384, v16
  v_add_u32 v113, 16384, v17
  v_add_u32 v114, 16384, v18
  v_add_u32 v115, 16384, v19
  ds_read_b64_tr_b16 v[128:129], v112 offset:0
  ds_read_b64_tr_b16 v[130:131], v112 offset:2048
  ds_read_b64_tr_b16 v[132:133], v113 offset:0
  ds_read_b64_tr_b16 v[134:135], v113 offset:2048
  ds_read_b64_tr_b16 v[136:137], v114 offset:0
  ds_read_b64_tr_b16 v[138:139], v114 offset:2048
  ds_read_b64_tr_b16 v[140:141], v115 offset:0
  ds_read_b64_tr_b16 v[142:143], v115 offset:2048
  ds_read_b64_tr_b16 v[144:145], v112 offset:4096
  ds_read_b64_tr_b16 v[146:147], v112 offset:6144
  ds_read_b64_tr_b16 v[148:149], v113 offset:4096
  ds_read_b64_tr_b16 v[150:151], v113 offset:6144
  s_nop 0
  s_waitcnt lgkmcnt(4)
  ds_read_b64_tr_b16 v[152:153], v114 offset:4096
  ds_read_b64_tr_b16 v[154:155], v114 offset:6144
  ds_read_b64_tr_b16 v[156:157], v115 offset:4096
  ds_read_b64_tr_b16 v[158:159], v115 offset:6144
L_157:
  s_cmp_lg_u32 s16, 4
  s_cbranch_scc1 L_158
  v_add_u32 v112, 0, v20
  v_add_u32 v113, 0, v21
  ds_read_b64_tr_b16 v[160:161], v112 offset:0
  ds_read_b64_tr_b16 v[162:163], v112 offset:1024
  ds_read_b64_tr_b16 v[164:165], v113 offset:0
  ds_read_b64_tr_b16 v[166:167], v113 offset:1024
  ds_read_b64_tr_b16 v[176:177], v112 offset:2048
  ds_read_b64_tr_b16 v[178:179], v112 offset:3072
  ds_read_b64_tr_b16 v[180:181], v113 offset:2048
  ds_read_b64_tr_b16 v[182:183], v113 offset:3072
L_158:
  s_waitcnt lgkmcnt(0)
L_153:
  s_barrier
  s_mov_b32 exec_lo, 0xffff
  s_mov_b32 exec_hi, 0
  buffer_load_dword v7, v5, s[40:43], s91 offen sc0 sc1
  s_mov_b64 exec, -1
  s_cmp_lg_u32 s82, 0
  s_cbranch_scc1 L_159
  s_cmp_eq_u32 s16, 1
  s_cbranch_scc1 L_161
  v_add_u32 v112, 28672, v16
  v_add_u32 v113, 28672, v17
  v_add_u32 v114, 28672, v18
  v_add_u32 v115, 28672, v19
  ds_read_b64_tr_b16 v[32:33], v112 offset:0
  ds_read_b64_tr_b16 v[34:35], v112 offset:2048
  ds_read_b64_tr_b16 v[36:37], v113 offset:0
  ds_read_b64_tr_b16 v[38:39], v113 offset:2048
  ds_read_b64_tr_b16 v[40:41], v114 offset:0
  ds_read_b64_tr_b16 v[42:43], v114 offset:2048
  ds_read_b64_tr_b16 v[44:45], v115 offset:0
  ds_read_b64_tr_b16 v[46:47], v115 offset:2048
  ds_read_b64_tr_b16 v[48:49], v112 offset:4096
  ds_read_b64_tr_b16 v[50:51], v112 offset:6144
  ds_read_b64_tr_b16 v[52:53], v113 offset:4096
  ds_read_b64_tr_b16 v[54:55], v113 offset:6144
  s_nop 0
  s_waitcnt lgkmcnt(4)
  ds_read_b64_tr_b16 v[56:57], v114 offset:4096
  ds_read_b64_tr_b16 v[58:59], v114 offset:6144
  ds_read_b64_tr_b16 v[60:61], v115 offset:4096
  ds_read_b64_tr_b16 v[62:63], v115 offset:6144
L_161:
  s_waitcnt lgkmcnt(0)
L_159:
  s_barrier
  s_cmp_lg_u32 s82, 0
  s_cbranch_scc1 L_162
  s_cmp_eq_u32 s16, 2
  s_cbranch_scc1 L_164
  v_add_u32 v112, 65536, v16
  v_add_u32 v113, 65536, v17
  v_add_u32 v114, 65536, v18
  v_add_u32 v115, 65536, v19
  ds_read_b64_tr_b16 v[64:65], v112 offset:0
  ds_read_b64_tr_b16 v[66:67], v112 offset:2048
  ds_read_b64_tr_b16 v[68:69], v113 offset:0
  ds_read_b64_tr_b16 v[70:71], v113 offset:2048
  ds_read_b64_tr_b16 v[72:73], v114 offset:0
  ds_read_b64_tr_b16 v[74:75], v114 offset:2048
  ds_read_b64_tr_b16 v[76:77], v115 offset:0
  ds_read_b64_tr_b16 v[78:79], v115 offset:2048
  ds_read_b64_tr_b16 v[80:81], v112 offset:4096
  ds_read_b64_tr_b16 v[82:83], v112 offset:6144
  ds_read_b64_tr_b16 v[84:85], v113 offset:4096
  ds_read_b64_tr_b16 v[86:87], v113 offset:6144
  s_nop 0
  s_waitcnt lgkmcnt(4)
  ds_read_b64_tr_b16 v[88:89], v114 offset:4096
  ds_read_b64_tr_b16 v[90:91], v114 offset:6144
  ds_read_b64_tr_b16 v[92:93], v115 offset:4096
  ds_read_b64_tr_b16 v[94:95], v115 offset:6144
L_164:
  v_mfma_f32_16x16x32_bf16 v[28:31], v[32:35], v[200:203], 0
  v_mfma_f32_16x16x32_bf16 v[28:31], v[36:39], v[204:207], v[28:31]
  v_mfma_f32_16x16x32_bf16 v[28:31], v[40:43], v[208:211], v[28:31]
  v_mfma_f32_16x16x32_bf16 v[28:31], v[44:47], v[212:215], v[28:31]
  v_mfma_f32_16x16x32_bf16 v[28:31], v[48:51], v[200:203], v[28:31]
  v_mfma_f32_16x16x32_bf16 v[28:31], v[52:55], v[204:207], v[28:31]
  v_mfma_f32_16x16x32_bf16 v[28:31], v[56:59], v[208:211], v[28:31]
  v_mfma_f32_16x16x32_bf16 v[28:31], v[60:63], v[212:215], v[28:31]
L_162:
  s_nop 0
  s_waitcnt vmcnt(0)
  s_mov_b32 s89, 200000
  s_mov_b32 exec_lo, 0xffff
  s_mov_b32 exec_hi, 0
  s_branch Lp_166
Lp_165:
  buffer_load_dword v7, v5, s[40:43], s91 offen sc0 sc1
  s_waitcnt vmcnt(0)
Lp_166:
  v_cmp_ne_u32 vcc, 0, v7
  s_andn2_b32 s3, 0xffff, vcc_lo
  s_cbranch_scc0 Lp_167
  s_sleep 1
  s_sub_u32 s89, s89, 1
  s_cbranch_scc0 Lp_165
Lp_167:
  s_mov_b64 exec, -1
  s_add_u32 s5, s84, s92
  buffer_load_dwordx2 v[96:97], v6, s[40:43], s5 offen offset:0 sc1
  buffer_load_dwordx2 v[98:99], v6, s[40:43], s5 offen offset:512 sc1
  buffer_load_dwordx2 v[100:101], v6, s[40:43], s5 offen offset:1024 sc1
  buffer_load_dwordx2 v[102:103], v6, s[40:43], s5 offen offset:1536 sc1
  s_waitcnt lgkmcnt(0)
  s_barrier
  s_cmp_lg_u32 s82, 0
  s_cbranch_scc1 L_168
  s_cmp_eq_u32 s16, 3
  s_cbranch_scc1 L_170
  v_add_u32 v112, 16384, v16
  v_add_u32 v113, 16384, v17
  v_add_u32 v114, 16384, v18
  v_add_u32 v115, 16384, v19
  ds_read_b64_tr_b16 v[128:129], v112 offset:0
  ds_read_b64_tr_b16 v[130:131], v112 offset:2048
  ds_read_b64_tr_b16 v[132:133], v113 offset:0
  ds_read_b64_tr_b16 v[134:135], v113 offset:2048
  ds_read_b64_tr_b16 v[136:137], v114 offset:0
  ds_read_b64_tr_b16 v[138:139], v114 offset:2048
  ds_read_b64_tr_b16 v[140:141], v115 offset:0
  ds_read_b64_tr_b16 v[142:143], v115 offset:2048
  ds_read_b64_tr_b16 v[144:145], v112 offset:4096
  ds_read_b64_tr_b16 v[146:147], v112 offset:6144
  ds_read_b64_tr_b16 v[148:149], v113 offset:4096
  ds_read_b64_tr_b16 v[150:151], v113 offset:6144
  s_nop 0
  s_waitcnt lgkmcnt(4)
  ds_read_b64_tr_b16 v[152:153], v114 offset:4096
  ds_read_b64_tr_b16 v[154:155], v114 offset:6144
  ds_read_b64_tr_b16 v[156:157], v115 offset:4096
  ds_read_b64_tr_b16 v[158:159], v115 offset:6144
L_170:
  v_mfma_f32_16x16x32_bf16 v[28:31], v[64:67], v[216:219], v[28:31]
  v_mfma_f32_16x16x32_bf16 v[28:31], v[68:71], v[220:223], v[28:31]
  v_mfma_f32_16x16x32_bf16 v[28:31], v[72:75], v[224:227], v[28:31]
  v_mfma_f32_16x16x32_bf16 v[28:31], v[76:79], v[228:231], v[28:31]
  v_mfma_f32_16x16x32_bf16 v[28:31], v[80:83], v[216:219], v[28:31]
  v_mfma_f32_16x16x32_bf16 v[28:31], v[84:87], v[220:223], v[28:31]
  v_mfma_f32_16x16x32_bf16 v[28:31], v[88:91], v[224:227], v[28:31]
  v_mfma_f32_16x16x32_bf16 v[28:31], v[92:95], v[228:231], v[28:31]
  s_waitcnt lgkmcnt(0)
L_168:
  s_barrier
  s_cmp_lg_u32 s82, 0
  s_cbranch_scc1 L_171
  s_cmp_eq_u32 s16, 4
  s_cbranch_scc1 L_173
  v_add_u32 v112, 28672, v20
  v_add_u32 v113, 28672, v21
  ds_read_b64_tr_b16 v[160:161], v112 offset:0
  ds_read_b64_tr_b16 v[162:163], v112 offset:1024
  ds_read_b64_tr_b16 v[164:165], v113 offset:0
  ds_read_b64_tr_b16 v[166:167], v113 offset:1024
  ds_read_b64_tr_b16 v[176:177], v112 offset:2048
  ds_read_b64_tr_b16 v[178:179], v112 offset:3072
  ds_read_b64_tr_b16 v[180:181], v113 offset:2048
  ds_read_b64_tr_b16 v[182:183], v113 offset:3072
L_173:
  v_mfma_f32_16x16x32_bf16 v[28:31], v[128:131], v[232:235], v[28:31]
  v_mfma_f32_16x16x32_bf16 v[28:31], v[132:135], v[236:239], v[28:31]
  v_mfma_f32_16x16x32_bf16 v[28:31], v[136:139], v[240:243], v[28:31]
  v_mfma_f32_16x16x32_bf16 v[28:31], v[140:143], v[244:247], v[28:31]
  v_mfma_f32_16x16x32_bf16 v[28:31], v[144:147], v[232:235], v[28:31]
  v_mfma_f32_16x16x32_bf16 v[28:31], v[148:151], v[236:239], v[28:31]
  v_mfma_f32_16x16x32_bf16 v[28:31], v[152:155], v[240:243], v[28:31]
  v_mfma_f32_16x16x32_bf16 v[28:31], v[156:159], v[244:247], v[28:31]
  s_waitcnt lgkmcnt(0)
L_171:
  s_barrier
  s_waitcnt vmcnt(0)
  v_add_f32 v96, v96, v100
  v_add_f32 v97, v97, v101
  v_add_f32 v98, v98, v102
  v_add_f32 v99, v99, v103
  v_add_f32 v96, v96, v98
  v_add_f32 v97, v97, v99
  s_nop 0
  v_add_f32_dpp v96, v96, v96 row_ror:8 row_mask:0xf bank_mask:0xf
  v_add_f32_dpp v97, v97, v97 row_ror:8 row_mask:0xf bank_mask:0xf
  v_mov_b32 v98, v96
  v_mov_b32 v99, v97
  s_nop 0
  v_permlane16_swap_b32 v96, v98
  v_permlane16_swap_b32 v97, v99
  v_add_f32 v96, v96, v98
  v_add_f32 v97, v97, v99
  v_mov_b32 v98, v96
  v_mov_b32 v99, v97
  s_nop 0
  v_permlane32_swap_b32 v96, v98
  v_permlane32_swap_b32 v97, v99
  v_add_f32 v96, v96, v98
  v_add_f32 v97, v97, v99
  v_mul_f32 v96, 0x3a800000, v96
  v_mul_f32 v97, 0x3a800000, v97
  v_fma_f32 v98, -v96, v96, v97
  v_max_f32_e64 v98, 0, v98
  v_add_f32 v98, 0x3727c5ac, v98
  v_rsq_f32 v98, v98
  s_nop 0
  v_mul_f32_e64 v99, v96, v98
  s_mov_b64 exec, s[8:9]
  buffer_store_dwordx2 v[98:99], v6, s[40:43], s10 offen sc0 sc1
  s_mov_b64 exec, -1
  s_cmp_lg_u32 s82, 0
  s_cbranch_scc1 L_174
  v_mfma_f32_16x16x32_bf16 v[28:31], v[160:163], v[248:251], v[28:31]
  v_mfma_f32_16x16x32_bf16 v[28:31], v[164:167], v[252:255], v[28:31]
  v_mfma_f32_16x16x32_bf16 v[28:31], v[176:179], v[248:251], v[28:31]
  v_mfma_f32_16x16x32_bf16 v[28:31], v[180:183], v[252:255], v[28:31]
  s_lshl_b32 s5, s77, 14
  s_lshl_b32 s4, s76, 10
  s_add_u32 s5, s5, s4
  s_add_u32 s5, s5, 1376256
  s_nop 3
  buffer_store_dwordx4 v[28:31], v15, s[40:43], s5 offen sc0 sc1
L_174:
  s_barrier
  s_barrier
  s_barrier
  s_cmp_lg_u32 s82, 0
  s_cbranch_scc1 L_176
  s_waitcnt vmcnt(0)
  s_mov_b32 s5, 1835012
  s_mov_b64 exec, 0xffff
  buffer_store_dword v11, v14, s[40:43], s5 offen sc0 sc1
  s_mov_b64 exec, -1
L_176:
  s_barrier
  s_barrier
  s_cmp_lg_u32 s82, 0
  s_cbranch_scc1 L_178
  s_lshl_b32 s91, s84, 1
  s_add_u32 s91, s91, 1835012
  s_mov_b32 exec_lo, 0xffff
  s_mov_b32 exec_hi, 0
  buffer_load_dword v7, v5, s[40:43], s91 offen sc0 sc1
  s_mov_b64 exec, -1
L_178:
  s_and_b32 s5, s10, 0xfffffc00
  buffer_load_dwordx4 v[120:123], v4, s[40:43], s5 offen sc1
  s_barrier
  s_barrier
  s_waitcnt vmcnt(0)
  s_mov_b32 s89, 200000
  s_branch Lp_181
Lp_180:
  s_and_b32 s5, s10, 0xfffffc00
  buffer_load_dwordx4 v[120:123], v4, s[40:43], s5 offen sc1
  s_waitcnt vmcnt(0)
Lp_181:
  v_min_u32 v2, v120, v122
  v_cmp_eq_u32 vcc, 0, v2
  s_cmp_eq_u64 vcc, 0
  s_cbranch_scc1 Lp_182
  s_sleep 1
  s_sub_u32 s89, s89, 1
  s_cbranch_scc0 Lp_180
Lp_182:
  ds_write2_b32 v10, v120, v122 offset0:0 offset1:1
  ds_write2_b32 v10, v121, v123 offset0:160 offset1:161
  s_add_u32 s10, s10, 16384
  s_cmp_lg_u32 s82, 0
  s_cbranch_scc1 L_183
  s_mov_b32 s89, 200000
  s_mov_b32 exec_lo, 0xffff
  s_mov_b32 exec_hi, 0
  s_branch Lp_186
Lp_185:
  buffer_load_dword v7, v5, s[40:43], s91 offen sc0 sc1
  s_waitcnt vmcnt(0)
Lp_186:
  v_cmp_ne_u32 vcc, 0, v7
  s_andn2_b32 s3, 0xffff, vcc_lo
  s_cbranch_scc0 Lp_187
  s_sleep 1
  s_sub_u32 s89, s89, 1
  s_cbranch_scc0 Lp_185
Lp_187:
  s_mov_b64 exec, -1
  s_lshl_b32 s5, s77, 14
  s_add_u32 s5, s5, 1376256
  buffer_load_dwordx4 v[192:195], v4, s[40:43], s5 offen offset:0 sc1
  buffer_load_dwordx4 v[196:199], v4, s[40:43], s5 offen offset:1024 sc1
  buffer_load_dwordx4 v[200:203], v4, s[40:43], s5 offen offset:2048 sc1
  buffer_load_dwordx4 v[204:207], v4, s[40:43], s5 offen offset:3072 sc1
  s_add_u32 s5, s5, 4096
  buffer_load_dwordx4 v[208:211], v4, s[40:43], s5 offen offset:0 sc1
  buffer_load_dwordx4 v[212:215], v4, s[40:43], s5 offen offset:1024 sc1
  buffer_load_dwordx4 v[216:219], v4, s[40:43], s5 offen offset:2048 sc1
  buffer_load_dwordx4 v[220:223], v4, s[40:43], s5 offen offset:3072 sc1
L_183:
  s_barrier
  s_cmp_lg_u32 s82, 0
  s_cbranch_scc1 L_188
  s_lshl_b32 s5, s77, 14
  s_add_u32 s5, s5, 1384448
  buffer_load_dwordx4 v[224:227], v4, s[40:43], s5 offen offset:0 sc1
  buffer_load_dwordx4 v[228:231], v4, s[40:43], s5 offen offset:1024 sc1
  buffer_load_dwordx4 v[232:235], v4, s[40:43], s5 offen offset:2048 sc1
  buffer_load_dwordx4 v[236:239], v4, s[40:43], s5 offen offset:3072 sc1
  s_add_u32 s5, s5, 4096
  buffer_load_dwordx4 v[240:243], v4, s[40:43], s5 offen offset:0 sc1
  buffer_load_dwordx4 v[244:247], v4, s[40:43], s5 offen offset:1024 sc1
  buffer_load_dwordx4 v[248:251], v4, s[40:43], s5 offen offset:2048 sc1
  buffer_load_dwordx4 v[252:255], v4, s[40:43], s5 offen offset:3072 sc1
L_188:
  s_cmp_lg_u32 s82, 0
  s_cbranch_scc1 L_190
  buffer_load_dword v109, v110, s[60:63], s13 offen
  s_sub_u32 s13, s13, 8192
  buffer_load_dword v109, v110, s[60:63], s13 offen
  s_sub_u32 s13, s13, 8192
L_190:
  s_barrier
  s_barrier
  s_cmp_lg_u32 s82, 0
  s_cbranch_scc1 L_192
  s_cmp_lg_u32 s82, 0
  s_cbranch_scc1 L_194
  s_waitcnt vmcnt(2)
  s_branch L_195
  s_nop 0
L_194:
  s_waitcnt vmcnt(0)
L_195:
  v_add_f32 v192, v192, v224
  v_add_f32 v193, v193, v225
  v_add_f32 v194, v194, v226
  v_add_f32 v195, v195, v227
  v_add_f32 v196, v196, v228
  v_add_f32 v197, v197, v229
  v_add_f32 v198, v198, v230
  v_add_f32 v199, v199, v231
  v_add_f32 v200, v200, v232
  v_add_f32 v201, v201, v233
  v_add_f32 v202, v202, v234
  v_add_f32 v203, v203, v235
  v_add_f32 v204, v204, v236
  v_add_f32 v205, v205, v237
  v_add_f32 v206, v206, v238
  v_add_f32 v207, v207, v239
  v_add_f32 v208, v208, v240
  v_add_f32 v209, v209, v241
  v_add_f32 v210, v210, v242
  v_add_f32 v211, v211, v243
  v_add_f32 v212, v212, v244
  v_add_f32 v213, v213, v245
  v_add_f32 v214, v214, v246
  v_add_f32 v215, v215, v247
  v_add_f32 v216, v216, v248
  v_add_f32 v217, v217, v249
  v_add_f32 v218, v218, v250
  v_add_f32 v219, v219, v251
  v_add_f32 v220, v220, v252
  v_add_f32 v221, v221, v253
  v_add_f32 v222, v222, v254
  v_add_f32 v223, v223, v255
  v_add_f32 v192, v192, v208
  v_add_f32 v193, v193, v209
  v_add_f32 v194, v194, v210
  v_add_f32 v195, v195, v211
  v_add_f32 v196, v196, v212
  v_add_f32 v197, v197, v213
  v_add_f32 v198, v198, v214
  v_add_f32 v199, v199, v215
  v_add_f32 v200, v200, v216
  v_add_f32 v201, v201, v217
  v_add_f32 v202, v202, v218
  v_add_f32 v203, v203, v219
  v_add_f32 v204, v204, v220
  v_add_f32 v205, v205, v221
  v_add_f32 v206, v206, v222
  v_add_f32 v207, v207, v223
  v_add_f32 v192, v192, v200
  v_add_f32 v193, v193, v201
  v_add_f32 v194, v194, v202
  v_add_f32 v195, v195, v203
  v_add_f32 v196, v196, v204
  v_add_f32 v197, v197, v205
  v_add_f32 v198, v198, v206
  v_add_f32 v199, v199, v207
  v_add_f32 v192, v192, v196
  v_add_f32 v193, v193, v197
  v_add_f32 v194, v194, v198
  v_add_f32 v195, v195, v199
  v_add_u32 v2, 154112, v4
  ds_write_b128 v2, v[192:195]
L_192:
  s_waitcnt lgkmcnt(0)
  s_barrier
  v_lshlrev_b32 v2, 12, v1
  s_lshl_b32 s4, s76, 16
  s_lshl_b32 s5, s77, 7
  s_add_u32 s4, s4, s5
  s_add_u32 s4, s4, s87
  s_add_u32 s5, s4, 24
  s_lshl_b32 s4, s79, Lz1-Lz0+3
  s_lshl_b32 s90, 0xff, s4
  s_lshl_b32 s91, s84, 1
  s_add_u32 s91, s91, s87
  s_add_u32 s91, s91, 24
  s_barrier
  s_barrier
  s_barrier
  s_mov_b32 exec_lo, 0xffff
  s_mov_b32 exec_hi, Lz1-Lz0+0
  buffer_store_dword v11, v2, s[40:43], s5 offen sc0 sc1
  s_mov_b64 exec, -1
  s_barrier
  s_barrier
  s_barrier
  s_mov_b32 exec_lo, s90
  s_mov_b32 exec_hi, 0
  buffer_load_dword v7, v5, s[40:43], s91 offen sc0 sc1
  s_mov_b64 exec, -1
  s_barrier
  s_waitcnt vmcnt(0)
  s_mov_b32 s89, 200000
  s_mov_b32 exec_lo, s90
  s_mov_b32 exec_hi, 0
  s_branch Lp_197
Lp_196:
  buffer_load_dword v7, v5, s[40:43], s91 offen sc0 sc1
  s_waitcnt vmcnt(0)
Lp_197:
  v_cmp_ne_u32 vcc, 0, v7
  s_andn2_b32 s3, s90, vcc_lo
  s_cbranch_scc0 Lp_198
  s_sleep 1
  s_sub_u32 s89, s89, 1
  s_cbranch_scc0 Lp_196
Lp_198:
  s_mov_b64 exec, -1
  s_xor_b32 s90, s90, 0xffff
  s_barrier
  s_barrier
  s_barrier
  s_barrier
  s_barrier
  s_barrier
  s_barrier
  s_barrier
  s_barrier
  s_barrier
  s_mov_b32 exec_lo, s90
  s_mov_b32 exec_hi, 0
  buffer_load_dword v7, v5, s[40:43], s91 offen sc0 sc1
  s_mov_b64 exec, -1
  s_barrier
  s_barrier
  s_barrier
  s_waitcnt vmcnt(0)
  s_mov_b32 s89, 200000
  s_mov_b32 exec_lo, s90
  s_mov_b32 exec_hi, 0
  s_branch Lp_200
Lp_199:
  buffer_load_dword v7, v5, s[40:43], s91 offen sc0 sc1
  s_waitcnt vmcnt(0)
Lp_200:
  v_cmp_ne_u32 vcc, 0, v7
  s_andn2_b32 s3, s90, vcc_lo
  s_cbranch_scc0 Lp_201
  s_sleep 1
  s_sub_u32 s89, s89, 1
  s_cbranch_scc0 Lp_199
Lp_201:
  s_mov_b64 exec, -1
  s_sub_u32 s91, s91, Lz1-Lz0+12
  s_xor_b32 s5, s84, 16384
  s_lshl_b32 s5, s5, 1
  s_add_u32 s5, s5, s87
  s_add_u32 s5, s5, 12
  s_barrier
  s_barrier
  s_barrier
  s_barrier
  s_barrier
  s_barrier
  s_barrier
  s_barrier
  s_mov_b64 exec, 1
  buffer_store_dword v11, v5, s[40:43], s5 offen sc0 sc1
  s_mov_b64 exec, -1
  s_barrier
  s_barrier
  s_mov_b32 exec_lo, 1
  s_mov_b32 exec_hi, 0
  buffer_load_dword v7, v5, s[40:43], s91 offen sc0 sc1
  s_mov_b64 exec, -1
  s_barrier
  s_waitcnt vmcnt(0)
  s_mov_b32 s89, 200000
  s_mov_b32 exec_lo, 1
  s_mov_b32 exec_hi, 0
  s_branch Lp_203
  s_nop 0
Lp_202:
  buffer_load_dword v7, v5, s[40:43], s91 offen sc0 sc1
  s_waitcnt vmcnt(0)
Lp_203:
  v_cmp_ne_u32 vcc, 0, v7
  s_andn2_b32 s3, 1, vcc_lo
  s_cbranch_scc0 Lp_204
  s_sleep 1
  s_sub_u32 s89, s89, 1
  s_cbranch_scc0 Lp_202
Lp_204:
  s_mov_b64 exec, -1
  s_barrier
  s_barrier
  s_cmp_lg_u32 s82, 0
  s_cbranch_scc1 L_lend
  s_add_u32 s92, s83, 36700160
  s_mov_b32 s82, 1
  s_mov_b32 s14, 0
  s_add_u32 s83, s83, 0
  s_add_u32 s87, s87, 32
  s_branch L_slayer
L_lend:
Lz0:
Lz1:
L_end:
  s_endpgm
.section .rodata,"a"
.p2align 6
.amdhsa_kernel mega_kernel
  .amdhsa_next_free_vgpr 256
  .amdhsa_next_free_sgpr 102
  .amdhsa_accum_offset 256
  .amdhsa_group_segment_fixed_size 0
  .amdhsa_kernarg_size 88
  .amdhsa_user_sgpr_count 2
  .amdhsa_user_sgpr_kernarg_segment_ptr 1
  .amdhsa_system_sgpr_workgroup_id_x 1
  .amdhsa_float_denorm_mode_32 3
  .amdhsa_float_denorm_mode_16_64 3
.end_amdhsa_kernel
.text
```

```asm
; @launch kernel=mega_kernel grid=(256,1,1) block=(512,1,1) lds=156672
.amdgcn_target "amdgcn-amd-amdhsa--gfx950"
.text
.globl mega_kernel
.p2align 8
.type mega_kernel,@function
mega_kernel:
  s_cmp_ge_u32 s2, 256
  s_nop 0
  s_cbranch_scc1 L_end
  s_load_dwordx16 s[16:31], s[0:1], 0
  s_load_dwordx2 s[32:33], s[0:1], 64
  s_load_dwordx4 s[36:39], s[0:1], 72
  v_lshrrev_b32 v2, 6, v0
  v_and_b32 v1, 63, v0
  v_readfirstlane_b32 s81, v2
  s_and_b32 s3, s2, 7
  s_lshr_b32 s4, s2, 3
  s_and_b32 s5, s3, 1
  s_lshl_b32 s5, s5, 3
  s_and_b32 s6, s4, 7
  s_add_u32 s76, s5, s6
  s_lshr_b32 s5, s3, 1
  s_lshl_b32 s5, s5, 2
  s_lshr_b32 s6, s4, 3
  s_add_u32 s77, s5, s6
  s_mov_b32 s82, 0
  s_mov_b32 s88, 0
  s_and_b32 s85, s81, 1
  s_cmp_lt_u32 s81, 4
  s_cbranch_scc1 L_comp
  s_cmp_eq_u32 s81, Lz1-Lz0+5
  s_cbranch_scc1 L_serv
  s_setprio 0
  s_cmp_eq_u32 s81, 4
  s_cbranch_scc1 L_xload
  v_bfe_u32 v2, v1, 1, 2
  v_bfe_u32 v3, v1, 4, 2
  v_xor_b32 v2, v2, v3
  v_lshlrev_b32 v10, 5, v2
  v_and_b32_e64 v2, 1, v1
  v_lshl_add_u32 v10, v2, 4, v10
  v_lshrrev_b32_e64 v2, 5, v1
  v_bfe_u32 v3, v1, 3, 2
  v_lshl_add_u32 v2, v2, 3, v3
  s_mov_b32 s4, 6144
  v_mad_u32_u24 v4, v2, s4, v10
  v_add_u32 v5, 97280, v4
  v_add_u32 v6, 22528, v4
  v_add_u32 v7, 119808, v4
  s_waitcnt lgkmcnt(0)
  s_mov_b32 s48, s18
  s_and_b32 s49, s19, 0xffff
  s_mov_b32 s50, 6291456
  s_mov_b32 s51, 0x00020000
L_wlayer:
  s_lshl_b32 s5, s77, 7
  s_mul_i32 s4, s85, 196608
  s_add_u32 s5, s5, s4
  s_mov_b32 s8, 393216
  s_mov_b32 s10, 6291456
  s_add_u32 s9, s5, s10
  s_mul_i32 s6, s76, 11
  s_lshr_b32 s6, s6, Lz1-Lz0+5
  s_mul_i32 s6, s6, 1179648
  s_add_u32 s7, s5, s6
  s_lshl_b32 s11, s85, 12
  s_add_u32 s11, s11, 65536
  s_add_u32 s15, s11, 73728
  s_mov_b32 s12, 0
  s_mov_b32 m0, s11
  s_cmp_eq_u32 s82, 0
  s_cbranch_scc1 Ll_23
  s_waitcnt vmcnt(12)
  s_barrier
  s_waitcnt vmcnt(8)
  s_barrier
  s_waitcnt vmcnt(4)
  s_barrier
  s_branch Ll_23
Lt_29:
  s_cmp_lg_u32 s12, 1
  s_cbranch_scc1 Lt_27
  s_cmp_eq_u32 s82, 0
  s_cbranch_scc1 Ll_23
  s_waitcnt vmcnt(12)
  s_barrier
  s_branch Ll_23
  s_nop 0
Lt_27:
  s_cmp_lg_u32 s12, 2
  s_cbranch_scc1 Ll_23
  s_cmp_eq_u32 s82, 0
  s_cbranch_scc1 Ll_23
  s_barrier
  v_mov_b32 v2, 156416
  s_lshl_b32 s5, s82, Lz1-Lz0+4
  s_mov_b32 s89, 1600000
Lw_30:
  ds_read_b32 v3, v2 offset:0
Lw_31:
  s_waitcnt lgkmcnt(0)
  v_readfirstlane_b32 s4, v3
  s_cmp_ge_u32 s4, s5
  s_cbranch_scc1 Lw_32
  s_sleep 1
  s_sub_u32 s89, s89, Lz1-Lz0+1
  s_cbranch_scc0 Lw_30
Lw_32:
Ll_23:
  buffer_load_dwordx4 v4, s[48:51], s7 offen offset:0 lds
  buffer_load_dwordx4 v5, s[48:51], s7 offen offset:1024 lds
  buffer_load_dwordx4 v6, s[48:51], s7 offen offset:2048 lds
  buffer_load_dwordx4 v7, s[48:51], s7 offen offset:3072 lds
  s_add_u32 m0, s11, 8192
  s_add_u32 s5, s7, 2048
  buffer_load_dwordx4 v4, s[48:51], s5 offen offset:0 lds
  buffer_load_dwordx4 v5, s[48:51], s5 offen offset:1024 lds
  buffer_load_dwordx4 v6, s[48:51], s5 offen offset:2048 lds
  buffer_load_dwordx4 v7, s[48:51], s5 offen offset:3072 lds
  s_add_u32 m0, s11, 16384
  s_add_u32 s5, s7, 4096
  buffer_load_dwordx4 v4, s[48:51], s5 offen offset:0 lds
  s_add_u32 s7, s7, s8
  s_cmp_eq_u32 s7, s9
  s_cselect_b32 s4, s10, 0
  s_sub_u32 s7, s7, s4
  buffer_load_dwordx4 v5, s[48:51], s5 offen offset:1024 lds
  s_add_u32 s11, s11, 24576
  s_cmp_eq_u32 s11, s15
  s_cselect_b32 s4, 73728, 0
  s_sub_u32 s11, s11, s4
  buffer_load_dwordx4 v6, s[48:51], s5 offen offset:2048 lds
  s_add_u32 s12, s12, 1
  s_cmp_lg_u32 s12, 3
  buffer_load_dwordx4 v7, s[48:51], s5 offen offset:3072 lds
  s_mov_b32 m0, s11
  s_cbranch_scc1 Lt_29
Lt_33:
  s_waitcnt vmcnt(24)
  s_barrier
  s_mul_i32 s5, s85, 6144
  s_nop 0
  s_mov_b32 s68, s24
  s_and_b32 s69, s25, 0xffff
  s_mov_b32 s70, 7340032
  s_mov_b32 s71, 0x00020000
  s_lshl_b32 s4, s76, Lz1-Lz0+4
  s_add_u32 s4, s4, s77
  s_mul_i32 s34, s4, 28672
  s_add_u32 s34, s34, s5
  s_waitcnt vmcnt(12)
  s_barrier
  buffer_load_dwordx4 v4, s[48:51], s7 offen offset:0 lds
  buffer_load_dwordx4 v5, s[48:51], s7 offen offset:1024 lds
  buffer_load_dwordx4 v6, s[48:51], s7 offen offset:2048 lds
  buffer_load_dwordx4 v7, s[48:51], s7 offen offset:3072 lds
Ll_34:
  s_add_u32 m0, s11, 8192
  s_add_u32 s5, s7, 2048
  buffer_load_dwordx4 v4, s[48:51], s5 offen offset:0 lds
  buffer_load_dwordx4 v5, s[48:51], s5 offen offset:1024 lds
  buffer_load_dwordx4 v6, s[48:51], s5 offen offset:2048 lds
  buffer_load_dwordx4 v7, s[48:51], s5 offen offset:3072 lds
  s_add_u32 m0, s11, 16384
  s_add_u32 s5, s7, 4096
  buffer_load_dwordx4 v4, s[48:51], s5 offen offset:0 lds
  s_add_u32 s7, s7, s8
  s_cmp_eq_u32 s7, s9
  s_cselect_b32 s4, s10, 0
  s_sub_u32 s7, s7, s4
  buffer_load_dwordx4 v5, s[48:51], s5 offen offset:1024 lds
  s_add_u32 s11, s11, 24576
  s_cmp_eq_u32 s11, s15
  s_cselect_b32 s4, 73728, 0
  s_sub_u32 s11, s11, s4
  buffer_load_dwordx4 v6, s[48:51], s5 offen offset:2048 lds
  s_add_u32 s12, s12, 1
  s_cmp_eq_u32 s12, 16
  buffer_load_dwordx4 v7, s[48:51], s5 offen offset:3072 lds
  s_mov_b32 m0, s11
  s_cbranch_scc1 Ll_35
  s_cmp_lg_u32 s82, 0
  s_cbranch_scc1 L_36
  s_buffer_load_dwordx2 s[98:99], s[68:71], s34 offset:60
  s_buffer_load_dwordx2 s[98:99], s[68:71], s34 offset:188
  s_buffer_load_dwordx2 s[98:99], s[68:71], s34 offset:316
  s_buffer_load_dwordx2 s[98:99], s[68:71], s34 offset:444
  s_add_u32 s34, s34, 512
L_36:
  s_waitcnt vmcnt(12)
  s_barrier
  buffer_load_dwordx4 v4, s[48:51], s7 offen offset:0 lds
  buffer_load_dwordx4 v5, s[48:51], s7 offen offset:1024 lds
  buffer_load_dwordx4 v6, s[48:51], s7 offen offset:2048 lds
  buffer_load_dwordx4 v7, s[48:51], s7 offen offset:3072 lds
  s_branch Ll_34
Ll_35:
  s_branch L_w1
L_xload:
  s_setprio 0
  v_lshrrev_b32 v2, 4, v1
  v_and_b32 v3, 7, v1
  v_xor_b32 v2, v2, v3
  v_lshrrev_b32 v3, 3, v1
  v_lshlrev_b32 v3, 12, v3
  v_lshl_add_u32 v4, v2, 4, v3
  v_xor_b32_e64 v5, 64, v4
  v_add_u32 v5, 31744, v5
  v_add_u32 v6, 63488, v4
  v_add_u32 v7, 63488, v5
  s_mov_b32 s13, 0x20000
  s_movk_i32 s95, 2048
  s_lshl_b32 s5, s76, 18
  s_mov_b32 s8, 128
  s_mov_b32 s10, 2048
  s_add_u32 s9, s5, s10
  s_mul_i32 s6, s76, 11
  s_lshr_b32 s6, s6, 5
  s_mul_i32 s6, s6, 384
  s_add_u32 s7, s5, s6
  s_waitcnt lgkmcnt(0)
  s_mov_b32 s72, s16
  s_and_b32 s73, s17, 0xffff
  s_mov_b32 s74, 4194304
  s_mov_b32 s75, 0x00020000
L_xlayer:
  s_mov_b32 s11, Lz1-Lz0+0
  s_mov_b32 s15, 65536
  s_mov_b32 s12, Lz1-Lz0+0
  s_mov_b32 m0, s11
Ll_75:
  s_nop 0
  buffer_load_dwordx4 v4, s[72:75], s7 offen offset:0 sc1 lds
  buffer_load_dwordx4 v5, s[72:75], s7 offen offset:1024 sc1 lds
  buffer_load_dwordx4 v6, s[72:75], s7 offen offset:2048 sc1 lds
  buffer_load_dwordx4 v7, s[72:75], s7 offen offset:3072 sc1 lds
  s_add_u32 m0, s11, 4096
  s_nop 0
  s_add_u32 s5, s7, s13
  buffer_load_dwordx4 v4, s[72:75], s5 offen offset:0 sc1 lds
  buffer_load_dwordx4 v5, s[72:75], s5 offen offset:1024 sc1 lds
  buffer_load_dwordx4 v6, s[72:75], s5 offen offset:2048 sc1 lds
  buffer_load_dwordx4 v7, s[72:75], s5 offen offset:3072 sc1 lds
  s_add_u32 m0, s11, 8192
  s_nop 0
  s_add_u32 s3, s7, s95
  buffer_load_dwordx4 v4, s[72:75], s3 offen offset:0 sc1 lds
  buffer_load_dwordx4 v5, s[72:75], s3 offen offset:1024 sc1 lds
  buffer_load_dwordx4 v6, s[72:75], s3 offen offset:2048 sc1 lds
  buffer_load_dwordx4 v7, s[72:75], s3 offen offset:3072 sc1 lds
  s_add_u32 m0, s11, 12288
  s_nop 0
  s_add_u32 s5, s3, s13
  buffer_load_dwordx4 v4, s[72:75], s5 offen offset:0 sc1 lds
  s_add_u32 s7, s7, s8
  s_cmp_eq_u32 s7, s9
  s_cselect_b32 s4, s10, 0
  s_sub_u32 s7, s7, s4
  buffer_load_dwordx4 v5, s[72:75], s5 offen offset:1024 sc1 lds
  s_add_u32 s11, s11, 16384
  s_cmp_eq_u32 s11, s15
  s_cselect_b32 s4, 65536, 0
  s_sub_u32 s11, s11, s4
  buffer_load_dwordx4 v6, s[72:75], s5 offen offset:2048 sc1 lds
  s_add_u32 s12, s12, 1
  s_cmp_lg_u32 s12, 3
  buffer_load_dwordx4 v7, s[72:75], s5 offen offset:3072 sc1 lds
  s_mov_b32 m0, s11
  s_cbranch_scc1 Ll_76
  s_waitcnt vmcnt(32)
  s_barrier
Ll_76:
  s_cmp_lt_u32 s12, Lz1-Lz0+4
  s_cbranch_scc1 Ll_75
  s_mov_b32 s68, s20
  s_and_b32 s69, s21, 0xffff
  s_mov_b32 s70, 2097152
  s_mov_b32 s71, 0x00020000
  s_lshl_b32 s4, s76, 4
  s_add_u32 s4, s4, s77
  s_mul_i32 s34, s4, 8192
  s_waitcnt vmcnt(32)
  s_barrier
  buffer_load_dwordx4 v4, s[72:75], s7 offen offset:0 sc1 lds
  buffer_load_dwordx4 v5, s[72:75], s7 offen offset:1024 sc1 lds
  buffer_load_dwordx4 v6, s[72:75], s7 offen offset:2048 sc1 lds
  buffer_load_dwordx4 v7, s[72:75], s7 offen offset:3072 sc1 lds
Ll_79:
  s_add_u32 m0, s11, 4096
  s_nop 0
  s_add_u32 s5, s7, s13
  buffer_load_dwordx4 v4, s[72:75], s5 offen offset:0 sc1 lds
  buffer_load_dwordx4 v5, s[72:75], s5 offen offset:1024 sc1 lds
  buffer_load_dwordx4 v6, s[72:75], s5 offen offset:2048 sc1 lds
  buffer_load_dwordx4 v7, s[72:75], s5 offen offset:3072 sc1 lds
  s_add_u32 m0, s11, 8192
  s_nop 0
  s_add_u32 s3, s7, s95
  buffer_load_dwordx4 v4, s[72:75], s3 offen offset:0 sc1 lds
  buffer_load_dwordx4 v5, s[72:75], s3 offen offset:1024 sc1 lds
  buffer_load_dwordx4 v6, s[72:75], s3 offen offset:2048 sc1 lds
  buffer_load_dwordx4 v7, s[72:75], s3 offen offset:3072 sc1 lds
  s_add_u32 m0, s11, 12288
  s_nop 0
  s_add_u32 s5, s3, s13
  buffer_load_dwordx4 v4, s[72:75], s5 offen offset:0 sc1 lds
  s_add_u32 s7, s7, s8
  s_cmp_eq_u32 s7, s9
  s_cselect_b32 s4, s10, 0
  s_sub_u32 s7, s7, s4
  buffer_load_dwordx4 v5, s[72:75], s5 offen offset:1024 sc1 lds
  s_add_u32 s11, s11, 16384
  s_cmp_eq_u32 s11, s15
  s_cselect_b32 s4, 65536, 0
  s_sub_u32 s11, s11, s4
  buffer_load_dwordx4 v6, s[72:75], s5 offen offset:2048 sc1 lds
  s_add_u32 s12, s12, 1
  s_cmp_eq_u32 s12, 16
  buffer_load_dwordx4 v7, s[72:75], s5 offen offset:3072 sc1 lds
  s_mov_b32 m0, s11
  s_cbranch_scc1 Ll_80
  s_cmp_lg_u32 s82, 0
  s_cbranch_scc1 L_81
  s_buffer_load_dwordx2 s[98:99], s[68:71], s34 offset:60
  s_buffer_load_dwordx2 s[98:99], s[68:71], s34 offset:188
  s_buffer_load_dwordx2 s[98:99], s[68:71], s34 offset:316
  s_buffer_load_dwordx2 s[98:99], s[68:71], s34 offset:444
  s_buffer_load_dwordx2 s[98:99], s[68:71], s34 offset:572
  s_add_u32 s34, s34, 640
L_81:
  s_waitcnt vmcnt(32)
  s_barrier
  buffer_load_dwordx4 v4, s[72:75], s7 offen offset:0 sc1 lds
  buffer_load_dwordx4 v5, s[72:75], s7 offen offset:1024 sc1 lds
  buffer_load_dwordx4 v6, s[72:75], s7 offen offset:2048 sc1 lds
  buffer_load_dwordx4 v7, s[72:75], s7 offen offset:3072 sc1 lds
  s_branch Ll_79
  s_nop 0
Ll_80:
  s_waitcnt vmcnt(32)
  s_barrier
  s_waitcnt vmcnt(16)
  s_barrier
  s_waitcnt vmcnt(0)
  s_barrier
  s_barrier
  s_branch L_x1
L_serv:
  s_setprio 3
  s_and_b32 s80, s77, 7
  s_lshr_b32 s79, s77, 3
  s_lshl_b32 s78, s80, 1
  s_add_u32 s78, s78, s79
  s_lshl_b32 s5, s76, 4
  s_add_u32 s5, s5, s77
  s_lshl_b32 s84, s5, 11
  s_mov_b32 s83, 3145728
  s_mov_b32 s87, 1835016
  s_lshr_b32 s86, s81, 1
  v_lshlrev_b32 v4, 4, v1
  v_mov_b32 v24, 0
  v_mov_b32 v25, 0
  v_mov_b32 v26, 0
  v_mov_b32 v27, 0
  v_and_b32 v2, 14, v1
  v_lshlrev_b32 v3, 11, v2
  v_and_b32_e64 v2, 1, v1
  v_lshl_add_u32 v3, v2, 4, v3
  v_and_b32_e64 v2, 48, v1
  v_lshl_add_u32 v3, v2, 1, v3
  v_bfe_u32 v2, v1, 3, 2
  v_and_b32 v22, 7, v1
  v_lshlrev_b32 v2, 14, v2
  v_lshl_add_u32 v2, v22, 3, v2
  s_lshl_b32 s5, s76, 7
  s_lshl_b32 s4, s80, 4
  s_add_u32 s6, s5, s4
  s_add_u32 s6, s6, s79
  s_lshl_b32 s6, s6, 11
  s_lshr_b32 s10, s84, 5
  s_add_u32 s10, s10, 1638400
  s_waitcnt lgkmcnt(0)
  s_mov_b32 s48, s18
  s_and_b32 s49, s19, 0xffff
  s_mov_b32 s50, 6291456
  s_mov_b32 s51, 0x00020000
  s_sub_u32 s4, 384, s48
  s_and_b32 s4, s4, 1023
  s_mul_i32 s5, s84, 12
  s_add_u32 s4, s4, s5
  v_lshlrev_b32_e64 v109, 10, v1
  s_mov_b64 exec, 0xffffff
  buffer_load_dword v109, v109, s[48:51], s4 offen
  s_mov_b64 exec, -1
  s_mov_b32 s40, s38
  s_and_b32 s41, s39, 0xffff
  s_mov_b32 s42, 100663296
  s_mov_b32 s43, 0x00020000
  s_nop 0
  s_mov_b32 s44, s16
  s_and_b32 s45, s17, 0xffff
  s_mov_b32 s46, 4194304
  s_mov_b32 s47, 0x00020000
  s_nop 0
  s_mov_b32 s68, s36
  s_and_b32 s69, s37, 0xffff
  s_mov_b32 s70, 256
  s_mov_b32 s71, 0x00020000
  s_lshl_b32 s4, s84, Lz1-Lz0+1
  s_add_u32 s4, s4, 1835008
  buffer_store_dwordx4 v[24:27], v4, s[40:43], s4 offen offset:0 sc0 sc1
  buffer_store_dwordx4 v[24:27], v4, s[40:43], s4 offen offset:1024 sc0 sc1
  v_mov_b32 v28, -1
  v_mov_b32 v29, -1
  v_mov_b32 v30, -1
  v_mov_b32 v31, -1
  s_lshl_b32 s4, s84, 1
  s_add_u32 s4, s4, 0
  buffer_store_dwordx4 v[28:31], v4, s[40:43], s4 offen offset:0 sc0 sc1
  buffer_store_dwordx4 v[28:31], v4, s[40:43], s4 offen offset:1024 sc0 sc1
  buffer_store_dwordx4 v[28:31], v4, s[40:43], s4 offen offset:2048 sc0 sc1
  buffer_store_dwordx4 v[28:31], v4, s[40:43], s4 offen offset:3072 sc0 sc1
  buffer_store_dwordx2 v[24:25], v2, s[40:43], s10 offen sc0 sc1
  v_mov_b32 v108, v3
  s_mov_b32 s7, s6
  s_branch L_s1
L_comp:
  s_and_b32 s80, s77, 7
  s_lshr_b32 s79, s77, 3
  s_lshl_b32 s78, s80, 1
  s_add_u32 s78, s78, s79
  s_lshl_b32 s5, s76, 4
  s_add_u32 s5, s5, s77
  s_lshl_b32 s84, s5, 11
  s_mov_b32 s83, 3145728
  s_mov_b32 s87, 1835016
  s_lshr_b32 s86, s81, Lz1-Lz0+1
  s_waitcnt lgkmcnt(0)
  s_mov_b32 s40, s38
  s_and_b32 s41, s39, 0xffff
  s_mov_b32 s42, 100663296
  s_mov_b32 s43, 0x00020000
  s_nop 0
  s_mov_b32 s44, s16
  s_and_b32 s45, s17, 0xffff
  s_mov_b32 s46, 4194304
  s_mov_b32 s47, 0x00020000
  s_nop 0
  s_mov_b32 s64, s32
  s_and_b32 s65, s33, 0xffff
  s_mov_b32 s66, 4194304
  s_mov_b32 s67, 0x00020000
  s_setprio 1
  v_lshlrev_b32 v11, 4, v1
  v_lshrrev_b32 v2, 3, v1
  v_and_b32 v3, 7, v1
  v_lshlrev_b32_e64 v3, 3, v3
  v_lshl_add_u32 v30, v2, 11, v3
  s_lshl_b32 s4, s85, 13
  s_lshl_b32 s5, s86, 10
  s_add_u32 s4, s4, s5
  v_add_u32 v0, s4, v11
  v_mov_b32_e64 v27, 1
  v_mov_b32 v28, 156416
  v_and_b32 v29, 48, v1
  s_lshl_b32 s4, s76, 16
  s_lshl_b32 s5, s77, 7
  s_add_u32 s4, s4, s5
  v_lshlrev_b32 v24, 12, v1
  v_and_b32 v2, 16, v1
  v_lshl_add_u32 v24, v2, 7, v24
  v_add_u32 v24, s4, v24
  v_lshrrev_b32 v2, 2, v1
  v_lshlrev_b32 v25, 7, v2
  v_and_b32 v2, 3, v1
  v_lshl_add_u32 v25, v2, 3, v25
  v_add_u32 v25, 65536, v25
  v_bfe_u32 v26, v1, 3, 2
  v_and_b32 v2, 15, v1
  v_lshrrev_b32 v3, 2, v29
  v_sub_u32_e64 v2, v2, v3
  s_mov_b32 s4, 0xf149f2ca
  v_mov_b32 v32, s4
  v_subrev_u32 v3, 0, v2
  v_cmp_gt_u32 vcc, 8, v3
  s_nop 1
  v_cndmask_b32_e64 v12, v32, 0, vcc
  v_cmp_ge_i32 vcc, -9, v3
  s_nop 1
  v_cndmask_b32_e64 v16, v32, 0, vcc
  v_mov_b32 v20, v16
  v_subrev_u32 v3, 1, v2
  v_cmp_gt_u32 vcc, 8, v3
  s_nop 1
  v_cndmask_b32_e64 v13, v32, 0, vcc
  v_cmp_ge_i32 vcc, -9, v3
  s_nop 1
  v_cndmask_b32_e64 v17, v32, 0, vcc
  v_mov_b32 v21, v17
  v_subrev_u32 v3, 2, v2
  v_cmp_gt_u32 vcc, 8, v3
  s_nop 1
  v_cndmask_b32_e64 v14, v32, 0, vcc
  v_cmp_ge_i32 vcc, -9, v3
  s_nop 1
  v_cndmask_b32_e64 v18, v32, 0, vcc
  v_mov_b32 v22, v18
  v_subrev_u32 v3, 3, v2
  v_cmp_gt_u32 vcc, 8, v3
  s_nop 1
  v_cndmask_b32_e64 v15, v32, 0, vcc
  v_cmp_ge_i32 vcc, -9, v3
  s_nop 1
  v_cndmask_b32_e64 v19, v32, 0, vcc
  v_mov_b32 v23, v19
  s_cmp_lg_u32 s76, 0
  s_cbranch_scc1 L_1
  v_mov_b32 v20, v32
  v_mov_b32 v21, v32
  v_mov_b32 v22, v32
  v_mov_b32 v23, v32
L_1:
  s_lshl_b32 s11, s84, 1
  s_lshl_b32 s4, s81, 10
  s_add_u32 s11, s11, s4
L_clayer:
  s_mov_b32 s16, Lz1-Lz0+0
  s_mov_b32 s17, 16384
  s_mov_b32 s18, 0xffff4000
  s_mov_b32 s19, Lz1-Lz0+0
  s_mov_b32 s20, 24576
  s_mov_b32 s21, 0xffff4000
  s_mul_i32 s4, s85, 8192
  v_add_u32_e64 v4, s4, v11
  v_add_u32 v5, 1024, v4
  s_cmp_lg_u32 s82, 0
  s_cbranch_scc1 L_2
  v_and_b32 v2, 15, v1
  v_lshrrev_b32 v3, 1, v2
  v_lshrrev_b32 v32, 4, v1
  v_xor_b32 v3, v3, v32
  v_lshlrev_b32_e64 v3, 4, v3
  v_lshl_add_u32 v3, v2, 7, v3
  v_add_u32 v4, s4, v3
  v_xor_b32 v3, 64, v3
  v_add_u32 v5, s4, v3
L_2:
  s_lshl_b32 s4, s86, 1
  v_xor_b32_e64 v2, s4, v26
  v_lshl_add_u32 v6, v2, 5, v25
  s_add_u32 s4, s4, 1
  v_xor_b32 v2, s4, v26
  v_lshl_add_u32 v7, v2, 5, v25
  v_mov_b64 v[128:129], 0
  v_mov_b64 v[130:131], 0
  v_mov_b64 v[132:133], 0
  v_mov_b64 v[134:135], 0
  v_mov_b64 v[136:137], 0
  v_mov_b64 v[138:139], 0
  v_mov_b64 v[140:141], 0
  v_mov_b64 v[142:143], 0
  v_mov_b64 v[144:145], 0
  v_mov_b64 v[146:147], 0
  v_mov_b64 v[148:149], 0
  v_mov_b64 v[150:151], 0
  v_mov_b64 v[152:153], 0
  v_mov_b64 v[154:155], 0
  v_mov_b64 v[156:157], 0
  v_mov_b64 v[158:159], 0
  v_mov_b64 v[160:161], 0
  v_mov_b64 v[162:163], 0
  v_mov_b64 v[164:165], 0
  v_mov_b64 v[166:167], 0
  v_mov_b64 v[168:169], 0
  v_mov_b64 v[170:171], 0
  v_mov_b64 v[172:173], 0
  v_mov_b64 v[174:175], 0
  v_mov_b64 v[176:177], 0
  v_mov_b64 v[178:179], 0
  v_mov_b64 v[180:181], 0
  v_mov_b64 v[182:183], 0
  v_mov_b64 v[184:185], 0
  v_mov_b64 v[186:187], 0
  v_mov_b64 v[188:189], 0
  v_mov_b64 v[190:191], 0
  v_mov_b64 v[192:193], 0
  v_mov_b64 v[194:195], 0
  v_mov_b64 v[196:197], 0
  v_mov_b64 v[198:199], 0
  v_mov_b64 v[200:201], 0
  v_mov_b64 v[202:203], 0
  v_mov_b64 v[204:205], 0
  v_mov_b64 v[206:207], 0
  v_mov_b64 v[208:209], 0
  v_mov_b64 v[210:211], 0
  v_mov_b64 v[212:213], 0
  v_mov_b64 v[214:215], 0
  v_mov_b64 v[216:217], 0
  v_mov_b64 v[218:219], 0
  v_mov_b64 v[220:221], 0
  v_mov_b64 v[222:223], 0
  s_mov_b32 s22, 16
  s_barrier
  ds_read_b64_tr_b16 v[48:49], v6 offset:0
  ds_read_b64_tr_b16 v[50:51], v6 offset:2048
  ds_read_b128 v[32:35], v4 offset:0
  ds_read_b128 v[36:39], v4 offset:2048
  ds_read_b128 v[40:43], v4 offset:4096
  ds_read_b128 v[44:47], v4 offset:6144
  ds_read_b64_tr_b16 v[52:53], v7 offset:0
  ds_read_b64_tr_b16 v[54:55], v7 offset:2048
  ds_read_b64_tr_b16 v[56:57], v6 offset:8192
  ds_read_b64_tr_b16 v[58:59], v6 offset:10240
  ds_read_b64_tr_b16 v[60:61], v7 offset:8192
  ds_read_b64_tr_b16 v[62:63], v7 offset:10240
  ds_read_b64_tr_b16 v[64:65], v6 offset:16384
  ds_read_b64_tr_b16 v[66:67], v6 offset:18432
  ds_read_b64_tr_b16 v[68:69], v7 offset:16384
  ds_read_b64_tr_b16 v[70:71], v7 offset:18432
Lk_3:
  s_nop 0
  s_waitcnt lgkmcnt(0)
  v_mfma_f32_16x16x32_bf16 v[128:131], v[48:51], v[32:35], v[128:131]
  ds_read_b64_tr_b16 v[92:93], v6 offset:4096
  v_mfma_f32_16x16x32_bf16 v[136:139], v[48:51], v[36:39], v[136:139]
  ds_read_b64_tr_b16 v[94:95], v6 offset:6144
  v_mfma_f32_16x16x32_bf16 v[144:147], v[48:51], v[40:43], v[144:147]
  ds_read_b128 v[76:79], v5 offset:0
  v_mfma_f32_16x16x32_bf16 v[152:155], v[48:51], v[44:47], v[152:155]
  ds_read_b128 v[80:83], v5 offset:2048
  v_mfma_f32_16x16x32_bf16 v[132:135], v[52:55], v[32:35], v[132:135]
  ds_read_b128 v[84:87], v5 offset:4096
  v_mfma_f32_16x16x32_bf16 v[140:143], v[52:55], v[36:39], v[140:143]
  ds_read_b128 v[88:91], v5 offset:6144
  v_mfma_f32_16x16x32_bf16 v[148:151], v[52:55], v[40:43], v[148:151]
  ds_read_b64_tr_b16 v[96:97], v7 offset:4096
  v_mfma_f32_16x16x32_bf16 v[156:159], v[52:55], v[44:47], v[156:159]
  ds_read_b64_tr_b16 v[98:99], v7 offset:6144
  v_mfma_f32_16x16x32_bf16 v[160:163], v[56:59], v[32:35], v[160:163]
  ds_read_b64_tr_b16 v[100:101], v6 offset:12288
  v_mfma_f32_16x16x32_bf16 v[168:171], v[56:59], v[36:39], v[168:171]
  ds_read_b64_tr_b16 v[102:103], v6 offset:14336
  v_mfma_f32_16x16x32_bf16 v[176:179], v[56:59], v[40:43], v[176:179]
  ds_read_b64_tr_b16 v[104:105], v7 offset:12288
  v_mfma_f32_16x16x32_bf16 v[184:187], v[56:59], v[44:47], v[184:187]
  ds_read_b64_tr_b16 v[106:107], v7 offset:14336
  v_mfma_f32_16x16x32_bf16 v[164:167], v[60:63], v[32:35], v[164:167]
  ds_read_b64_tr_b16 v[108:109], v6 offset:20480
  v_mfma_f32_16x16x32_bf16 v[172:175], v[60:63], v[36:39], v[172:175]
  ds_read_b64_tr_b16 v[110:111], v6 offset:22528
  v_mfma_f32_16x16x32_bf16 v[180:183], v[60:63], v[40:43], v[180:183]
  ds_read_b64_tr_b16 v[112:113], v7 offset:20480
  v_mfma_f32_16x16x32_bf16 v[188:191], v[60:63], v[44:47], v[188:191]
  ds_read_b64_tr_b16 v[114:115], v7 offset:22528
  v_mfma_f32_16x16x32_bf16 v[192:195], v[32:35], v[64:67], v[192:195]
  s_add_u32 s16, s16, s17
  s_cmp_eq_u32 s16, 65536
  s_cselect_b32 s23, s18, s17
  v_mfma_f32_16x16x32_bf16 v[200:203], v[36:39], v[64:67], v[200:203]
  s_cselect_b32 s16, 0, s16
  v_add_u32 v4, s23, v4
  v_add_u32_e64 v5, s23, v5
  v_mfma_f32_16x16x32_bf16 v[208:211], v[40:43], v[64:67], v[208:211]
  s_add_u32 s19, s19, s20
  s_cmp_eq_u32 s19, 73728
  s_cselect_b32 s23, s21, s20
  v_mfma_f32_16x16x32_bf16 v[216:219], v[44:47], v[64:67], v[216:219]
  s_cselect_b32 s19, 0, s19
  v_add_u32 v6, s23, v6
  v_add_u32_e64 v7, s23, v7
  v_mfma_f32_16x16x32_bf16 v[196:199], v[32:35], v[68:71], v[196:199]
  v_mfma_f32_16x16x32_bf16 v[204:207], v[36:39], v[68:71], v[204:207]
  v_mfma_f32_16x16x32_bf16 v[212:215], v[40:43], v[68:71], v[212:215]
  v_mfma_f32_16x16x32_bf16 v[220:223], v[44:47], v[68:71], v[220:223]
  s_waitcnt lgkmcnt(0)
  s_barrier
  v_mfma_f32_16x16x32_bf16 v[128:131], v[92:95], v[76:79], v[128:131]
  ds_read_b64_tr_b16 v[48:49], v6 offset:0
  v_mfma_f32_16x16x32_bf16 v[136:139], v[92:95], v[80:83], v[136:139]
  ds_read_b64_tr_b16 v[50:51], v6 offset:2048
  v_mfma_f32_16x16x32_bf16 v[144:147], v[92:95], v[84:87], v[144:147]
  ds_read_b128 v[32:35], v4 offset:0
  v_mfma_f32_16x16x32_bf16 v[152:155], v[92:95], v[88:91], v[152:155]
  ds_read_b128 v[36:39], v4 offset:2048
  v_mfma_f32_16x16x32_bf16 v[132:135], v[96:99], v[76:79], v[132:135]
  ds_read_b128 v[40:43], v4 offset:4096
  v_mfma_f32_16x16x32_bf16 v[140:143], v[96:99], v[80:83], v[140:143]
  ds_read_b128 v[44:47], v4 offset:6144
  v_mfma_f32_16x16x32_bf16 v[148:151], v[96:99], v[84:87], v[148:151]
  ds_read_b64_tr_b16 v[52:53], v7 offset:0
  v_mfma_f32_16x16x32_bf16 v[156:159], v[96:99], v[88:91], v[156:159]
  ds_read_b64_tr_b16 v[54:55], v7 offset:2048
  v_mfma_f32_16x16x32_bf16 v[160:163], v[100:103], v[76:79], v[160:163]
  ds_read_b64_tr_b16 v[56:57], v6 offset:8192
  v_mfma_f32_16x16x32_bf16 v[168:171], v[100:103], v[80:83], v[168:171]
  ds_read_b64_tr_b16 v[58:59], v6 offset:10240
  v_mfma_f32_16x16x32_bf16 v[176:179], v[100:103], v[84:87], v[176:179]
  ds_read_b64_tr_b16 v[60:61], v7 offset:8192
  v_mfma_f32_16x16x32_bf16 v[184:187], v[100:103], v[88:91], v[184:187]
  ds_read_b64_tr_b16 v[62:63], v7 offset:10240
  v_mfma_f32_16x16x32_bf16 v[164:167], v[104:107], v[76:79], v[164:167]
  ds_read_b64_tr_b16 v[64:65], v6 offset:16384
  v_mfma_f32_16x16x32_bf16 v[172:175], v[104:107], v[80:83], v[172:175]
  ds_read_b64_tr_b16 v[66:67], v6 offset:18432
  v_mfma_f32_16x16x32_bf16 v[180:183], v[104:107], v[84:87], v[180:183]
  ds_read_b64_tr_b16 v[68:69], v7 offset:16384
  v_mfma_f32_16x16x32_bf16 v[188:191], v[104:107], v[88:91], v[188:191]
  ds_read_b64_tr_b16 v[70:71], v7 offset:18432
  v_mfma_f32_16x16x32_bf16 v[192:195], v[76:79], v[108:111], v[192:195]
  s_sub_u32 s22, s22, Lz1-Lz0+1
  v_mfma_f32_16x16x32_bf16 v[200:203], v[80:83], v[108:111], v[200:203]
  s_cmp_lg_u32 s22, Lz1-Lz0+0
  v_mfma_f32_16x16x32_bf16 v[208:211], v[84:87], v[108:111], v[208:211]
  v_mfma_f32_16x16x32_bf16 v[216:219], v[88:91], v[108:111], v[216:219]
  v_mfma_f32_16x16x32_bf16 v[196:199], v[76:79], v[112:115], v[196:199]
  v_mfma_f32_16x16x32_bf16 v[204:207], v[80:83], v[112:115], v[204:207]
  v_mfma_f32_16x16x32_bf16 v[212:215], v[84:87], v[112:115], v[212:215]
  v_mfma_f32_16x16x32_bf16 v[220:223], v[88:91], v[112:115], v[220:223]
  s_cbranch_scc1 Lk_3
  s_cmp_lg_u32 s82, 0
  s_cbranch_scc1 L_4
  v_and_b32 v2, 15, v1
  v_lshlrev_b32 v3, 12, v2
  v_and_b32 v2, 16, v1
  v_lshl_add_u32 v3, v2, 1, v3
  v_and_b32 v2, 32, v1
  v_lshrrev_b32 v2, 1, v2
  v_add_u32 v3, v2, v3
  s_lshl_b32 s5, s76, 18
  s_lshl_b32 s4, s85, 11
  s_add_u32 s5, s5, s4
  s_lshl_b32 s4, s78, 7
  s_add_u32 s5, s5, s4
  s_lshl_b32 s4, s86, 6
  s_add_u32 s5, s5, s4
  buffer_load_dwordx4 v[240:243], v3, s[44:47], s5 offen
  s_add_u32 s5, s5, 0x10000
  buffer_load_dwordx4 v[244:247], v3, s[44:47], s5 offen
  s_add_u32 s5, s5, 0x10000
  buffer_load_dwordx4 v[248:251], v3, s[44:47], s5 offen
  s_add_u32 s5, s5, 0x10000
  buffer_load_dwordx4 v[252:255], v3, s[44:47], s5 offen
L_4:
  s_nop 0
  s_waitcnt lgkmcnt(0)
  s_mul_i32 s4, s85, 320
  s_add_u32 s4, s4, 151552
  v_and_b32_e64 v2, 15, v1
  v_lshl_add_u32 v3, v2, 2, s4
  v_add_u32 v124, s4, v29
  s_lshl_b32 s5, s86, 7
  s_add_u32 s5, s5, 153088
  v_add_u32_e64 v125, s5, v29
  v_lshl_add_u32 v2, v2, 2, s5
  s_mov_b32 s10, 0x7f
  s_mov_b32 s12, 0xff00ff00
  ds_read2_b32 v[94:95], v3 offset0:48 offset1:208
  ds_read_b128 v[106:109], v125 offset:256
  ds_read_b128 v[110:113], v125 offset:320
  ds_read_b128 v[224:227], v124 offset:192
  ds_read_b128 v[228:231], v124 offset:832
  ds_read2_b32 v[114:115], v2 offset0:128 offset1:144
  ds_read2_b32 v[88:89], v3 offset0:0 offset1:160
  ds_read2_b32 v[90:91], v3 offset0:16 offset1:176
  ds_read2_b32 v[92:93], v3 offset0:32 offset1:192
  ds_read_b128 v[98:101], v125 offset:0
  ds_read_b128 v[102:105], v125 offset:64
  s_add_u32 s9, s11, 65536
  v_lshrrev_b32_e64 v126, 1, v11
  v_bfi_b32 v126, s10, v11, v126
  v_mov_b64 v[64:65], 0
  v_mov_b64 v[66:67], 0
  v_mov_b64 v[232:233], 0
  v_mov_b64 v[234:235], 0
  v_mov_b32 v120, 0x3f803f80
  v_mov_b32 v121, 0x3f803f80
  v_mov_b32 v122, 0x3f803f80
  v_mov_b32 v123, 0x3f803f80
  s_nop 0
  s_waitcnt lgkmcnt(8)
  v_pk_mul_f32 v[116:117], v[106:107], v[94:95] op_sel:[0,1] op_sel_hi:[1,1]
  v_pk_mul_f32 v[118:119], v[108:109], v[94:95] op_sel:[0,1] op_sel_hi:[1,1]
  v_pk_fma_f32 v[184:185], v[184:185], v[94:95], v[116:117] op_sel:[0,0,0] op_sel_hi:[1,0,1] neg_lo:[0,0,1] neg_hi:[0,0,1]
  v_pk_fma_f32 v[186:187], v[186:187], v[94:95], v[118:119] op_sel:[0,0,0] op_sel_hi:[1,0,1] neg_lo:[0,0,1] neg_hi:[0,0,1]
  v_cvt_pk_bf16_f32 v60, v184, v185
  v_cvt_pk_bf16_f32 v61, v186, v187
  v_pk_mul_f32 v[116:117], v[110:111], v[94:95] op_sel:[0,1] op_sel_hi:[1,1]
  v_pk_mul_f32 v[118:119], v[112:113], v[94:95] op_sel:[0,1] op_sel_hi:[1,1]
  v_pk_fma_f32 v[188:189], v[188:189], v[94:95], v[116:117] op_sel:[0,0,0] op_sel_hi:[1,0,1] neg_lo:[0,0,1] neg_hi:[0,0,1]
  v_pk_fma_f32 v[190:191], v[190:191], v[94:95], v[118:119] op_sel:[0,0,0] op_sel_hi:[1,0,1] neg_lo:[0,0,1] neg_hi:[0,0,1]
  v_cvt_pk_bf16_f32 v62, v188, v189
  v_cvt_pk_bf16_f32 v63, v190, v191
  s_mov_b32 exec_lo, s12
  s_mov_b32 exec_hi, s12
  buffer_store_dwordx4 v[60:63], v126, s[40:43], s9 offen sc0 sc1
  s_mov_b64 exec, -1
  s_waitcnt lgkmcnt(5)
  v_pk_mul_f32 v[116:117], v[228:229], v[114:115] op_sel:[0,0] op_sel_hi:[1,0]
  v_pk_mul_f32 v[118:119], v[230:231], v[114:115] op_sel:[0,0] op_sel_hi:[1,0]
  v_pk_fma_f32 v[216:217], v[216:217], v[224:225], v[116:117] neg_lo:[0,0,1] neg_hi:[0,0,1]
  v_pk_fma_f32 v[218:219], v[218:219], v[226:227], v[118:119] neg_lo:[0,0,1] neg_hi:[0,0,1]
  v_cvt_pk_bf16_f32 v76, v216, v217
  v_cvt_pk_bf16_f32 v77, v218, v219
  v_pk_mul_f32 v[116:117], v[228:229], v[114:115] op_sel:[0,1] op_sel_hi:[1,1]
  v_pk_mul_f32 v[118:119], v[230:231], v[114:115] op_sel:[0,1] op_sel_hi:[1,1]
  v_pk_fma_f32 v[220:221], v[220:221], v[224:225], v[116:117] neg_lo:[0,0,1] neg_hi:[0,0,1]
  v_pk_fma_f32 v[222:223], v[222:223], v[226:227], v[118:119] neg_lo:[0,0,1] neg_hi:[0,0,1]
  v_cvt_pk_bf16_f32 v86, v220, v221
  v_cvt_pk_bf16_f32 v87, v222, v223
  v_mov_b64 v[78:79], v[86:87]
  s_mov_b32 exec_lo, 0
  s_mov_b32 exec_hi, Lz1-Lz0-1
  buffer_store_dwordx4 v[76:79], v11, s[40:43], s9 offen sc0 sc1
  s_mov_b64 exec, -1
  s_waitcnt lgkmcnt(0)
  v_pk_mul_f32 v[116:117], v[98:99], v[88:89] op_sel:[0,1] op_sel_hi:[1,1]
  v_pk_mul_f32 v[118:119], v[100:101], v[88:89] op_sel:[0,1] op_sel_hi:[1,1]
  v_pk_fma_f32 v[128:129], v[128:129], v[88:89], v[116:117] op_sel:[0,0,0] op_sel_hi:[1,0,1] neg_lo:[0,0,1] neg_hi:[0,0,1]
  v_pk_fma_f32 v[130:131], v[130:131], v[88:89], v[118:119] op_sel:[0,0,0] op_sel_hi:[1,0,1] neg_lo:[0,0,1] neg_hi:[0,0,1]
  v_cvt_pk_bf16_f32 v32, v128, v129
  v_cvt_pk_bf16_f32 v33, v130, v131
  v_pk_mul_f32 v[116:117], v[102:103], v[88:89] op_sel:[0,1] op_sel_hi:[1,1]
  v_pk_mul_f32 v[118:119], v[104:105], v[88:89] op_sel:[0,1] op_sel_hi:[1,1]
  v_pk_fma_f32 v[132:133], v[132:133], v[88:89], v[116:117] op_sel:[0,0,0] op_sel_hi:[1,0,1] neg_lo:[0,0,1] neg_hi:[0,0,1]
  v_pk_fma_f32 v[134:135], v[134:135], v[88:89], v[118:119] op_sel:[0,0,0] op_sel_hi:[1,0,1] neg_lo:[0,0,1] neg_hi:[0,0,1]
  v_cvt_pk_bf16_f32 v34, v132, v133
  v_cvt_pk_bf16_f32 v35, v134, v135
  v_pk_mul_f32 v[116:117], v[98:99], v[90:91] op_sel:[0,1] op_sel_hi:[1,1]
  v_pk_mul_f32 v[118:119], v[100:101], v[90:91] op_sel:[0,1] op_sel_hi:[1,1]
  v_pk_fma_f32 v[136:137], v[136:137], v[90:91], v[116:117] op_sel:[0,0,0] op_sel_hi:[1,0,1] neg_lo:[0,0,1] neg_hi:[0,0,1]
  v_pk_fma_f32 v[138:139], v[138:139], v[90:91], v[118:119] op_sel:[0,0,0] op_sel_hi:[1,0,1] neg_lo:[0,0,1] neg_hi:[0,0,1]
  v_cvt_pk_bf16_f32 v36, v136, v137
  v_cvt_pk_bf16_f32 v37, v138, v139
  v_pk_mul_f32 v[116:117], v[102:103], v[90:91] op_sel:[0,1] op_sel_hi:[1,1]
  v_pk_mul_f32 v[118:119], v[104:105], v[90:91] op_sel:[0,1] op_sel_hi:[1,1]
  v_pk_fma_f32 v[140:141], v[140:141], v[90:91], v[116:117] op_sel:[0,0,0] op_sel_hi:[1,0,1] neg_lo:[0,0,1] neg_hi:[0,0,1]
  v_pk_fma_f32 v[142:143], v[142:143], v[90:91], v[118:119] op_sel:[0,0,0] op_sel_hi:[1,0,1] neg_lo:[0,0,1] neg_hi:[0,0,1]
  v_cvt_pk_bf16_f32 v38, v140, v141
  v_cvt_pk_bf16_f32 v39, v142, v143
  v_pk_mul_f32 v[116:117], v[98:99], v[92:93] op_sel:[0,1] op_sel_hi:[1,1]
  v_pk_mul_f32 v[118:119], v[100:101], v[92:93] op_sel:[0,1] op_sel_hi:[1,1]
  v_pk_fma_f32 v[144:145], v[144:145], v[92:93], v[116:117] op_sel:[0,0,0] op_sel_hi:[1,0,1] neg_lo:[0,0,1] neg_hi:[0,0,1]
  v_pk_fma_f32 v[146:147], v[146:147], v[92:93], v[118:119] op_sel:[0,0,0] op_sel_hi:[1,0,1] neg_lo:[0,0,1] neg_hi:[0,0,1]
  v_cvt_pk_bf16_f32 v40, v144, v145
  v_cvt_pk_bf16_f32 v41, v146, v147
  v_pk_mul_f32 v[116:117], v[102:103], v[92:93] op_sel:[0,1] op_sel_hi:[1,1]
  v_pk_mul_f32 v[118:119], v[104:105], v[92:93] op_sel:[0,1] op_sel_hi:[1,1]
  v_pk_fma_f32 v[148:149], v[148:149], v[92:93], v[116:117] op_sel:[0,0,0] op_sel_hi:[1,0,1] neg_lo:[0,0,1] neg_hi:[0,0,1]
  v_pk_fma_f32 v[150:151], v[150:151], v[92:93], v[118:119] op_sel:[0,0,0] op_sel_hi:[1,0,1] neg_lo:[0,0,1] neg_hi:[0,0,1]
  v_cvt_pk_bf16_f32 v42, v148, v149
  v_cvt_pk_bf16_f32 v43, v150, v151
  v_pk_mul_f32 v[116:117], v[98:99], v[94:95] op_sel:[0,1] op_sel_hi:[1,1]
  v_pk_mul_f32 v[118:119], v[100:101], v[94:95] op_sel:[0,1] op_sel_hi:[1,1]
  v_pk_fma_f32 v[152:153], v[152:153], v[94:95], v[116:117] op_sel:[0,0,0] op_sel_hi:[1,0,1] neg_lo:[0,0,1] neg_hi:[0,0,1]
  v_pk_fma_f32 v[154:155], v[154:155], v[94:95], v[118:119] op_sel:[0,0,0] op_sel_hi:[1,0,1] neg_lo:[0,0,1] neg_hi:[0,0,1]
  v_cvt_pk_bf16_f32 v44, v152, v153
  v_cvt_pk_bf16_f32 v45, v154, v155
  v_pk_mul_f32 v[116:117], v[102:103], v[94:95] op_sel:[0,1] op_sel_hi:[1,1]
  v_pk_mul_f32 v[118:119], v[104:105], v[94:95] op_sel:[0,1] op_sel_hi:[1,1]
  v_pk_fma_f32 v[156:157], v[156:157], v[94:95], v[116:117] op_sel:[0,0,0] op_sel_hi:[1,0,1] neg_lo:[0,0,1] neg_hi:[0,0,1]
  v_pk_fma_f32 v[158:159], v[158:159], v[94:95], v[118:119] op_sel:[0,0,0] op_sel_hi:[1,0,1] neg_lo:[0,0,1] neg_hi:[0,0,1]
  v_cvt_pk_bf16_f32 v46, v156, v157
  v_cvt_pk_bf16_f32 v47, v158, v159
  ds_read_b128 v[128:131], v124 offset:0
  ds_read_b128 v[132:135], v124 offset:640
  ds_read_b128 v[136:139], v124 offset:64
  ds_read_b128 v[140:143], v124 offset:704
  ds_read_b128 v[144:147], v124 offset:128
  ds_read_b128 v[148:151], v124 offset:768
  v_pk_mul_f32 v[116:117], v[106:107], v[88:89] op_sel:[0,1] op_sel_hi:[1,1]
  v_pk_mul_f32 v[118:119], v[108:109], v[88:89] op_sel:[0,1] op_sel_hi:[1,1]
  v_pk_fma_f32 v[160:161], v[160:161], v[88:89], v[116:117] op_sel:[0,0,0] op_sel_hi:[1,0,1] neg_lo:[0,0,1] neg_hi:[0,0,1]
  v_pk_fma_f32 v[162:163], v[162:163], v[88:89], v[118:119] op_sel:[0,0,0] op_sel_hi:[1,0,1] neg_lo:[0,0,1] neg_hi:[0,0,1]
  v_cvt_pk_bf16_f32 v48, v160, v161
  v_cvt_pk_bf16_f32 v49, v162, v163
  v_pk_mul_f32 v[116:117], v[110:111], v[88:89] op_sel:[0,1] op_sel_hi:[1,1]
  v_pk_mul_f32 v[118:119], v[112:113], v[88:89] op_sel:[0,1] op_sel_hi:[1,1]
  v_pk_fma_f32 v[164:165], v[164:165], v[88:89], v[116:117] op_sel:[0,0,0] op_sel_hi:[1,0,1] neg_lo:[0,0,1] neg_hi:[0,0,1]
  v_pk_fma_f32 v[166:167], v[166:167], v[88:89], v[118:119] op_sel:[0,0,0] op_sel_hi:[1,0,1] neg_lo:[0,0,1] neg_hi:[0,0,1]
  v_cvt_pk_bf16_f32 v50, v164, v165
  v_cvt_pk_bf16_f32 v51, v166, v167
  v_pk_mul_f32 v[116:117], v[106:107], v[90:91] op_sel:[0,1] op_sel_hi:[1,1]
  v_pk_mul_f32 v[118:119], v[108:109], v[90:91] op_sel:[0,1] op_sel_hi:[1,1]
  v_pk_fma_f32 v[168:169], v[168:169], v[90:91], v[116:117] op_sel:[0,0,0] op_sel_hi:[1,0,1] neg_lo:[0,0,1] neg_hi:[0,0,1]
  v_pk_fma_f32 v[170:171], v[170:171], v[90:91], v[118:119] op_sel:[0,0,0] op_sel_hi:[1,0,1] neg_lo:[0,0,1] neg_hi:[0,0,1]
  v_cvt_pk_bf16_f32 v52, v168, v169
  v_cvt_pk_bf16_f32 v53, v170, v171
  v_pk_mul_f32 v[116:117], v[110:111], v[90:91] op_sel:[0,1] op_sel_hi:[1,1]
  v_pk_mul_f32 v[118:119], v[112:113], v[90:91] op_sel:[0,1] op_sel_hi:[1,1]
  v_pk_fma_f32 v[172:173], v[172:173], v[90:91], v[116:117] op_sel:[0,0,0] op_sel_hi:[1,0,1] neg_lo:[0,0,1] neg_hi:[0,0,1]
  v_pk_fma_f32 v[174:175], v[174:175], v[90:91], v[118:119] op_sel:[0,0,0] op_sel_hi:[1,0,1] neg_lo:[0,0,1] neg_hi:[0,0,1]
  v_cvt_pk_bf16_f32 v54, v172, v173
  v_cvt_pk_bf16_f32 v55, v174, v175
  v_pk_mul_f32 v[116:117], v[106:107], v[92:93] op_sel:[0,1] op_sel_hi:[1,1]
  v_pk_mul_f32 v[118:119], v[108:109], v[92:93] op_sel:[0,1] op_sel_hi:[1,1]
  v_pk_fma_f32 v[176:177], v[176:177], v[92:93], v[116:117] op_sel:[0,0,0] op_sel_hi:[1,0,1] neg_lo:[0,0,1] neg_hi:[0,0,1]
  v_pk_fma_f32 v[178:179], v[178:179], v[92:93], v[118:119] op_sel:[0,0,0] op_sel_hi:[1,0,1] neg_lo:[0,0,1] neg_hi:[0,0,1]
  v_cvt_pk_bf16_f32 v56, v176, v177
  v_cvt_pk_bf16_f32 v57, v178, v179
  v_pk_mul_f32 v[116:117], v[110:111], v[92:93] op_sel:[0,1] op_sel_hi:[1,1]
  v_pk_mul_f32 v[118:119], v[112:113], v[92:93] op_sel:[0,1] op_sel_hi:[1,1]
  v_pk_fma_f32 v[180:181], v[180:181], v[92:93], v[116:117] op_sel:[0,0,0] op_sel_hi:[1,0,1] neg_lo:[0,0,1] neg_hi:[0,0,1]
  v_pk_fma_f32 v[182:183], v[182:183], v[92:93], v[118:119] op_sel:[0,0,0] op_sel_hi:[1,0,1] neg_lo:[0,0,1] neg_hi:[0,0,1]
  v_cvt_pk_bf16_f32 v58, v180, v181
  v_cvt_pk_bf16_f32 v59, v182, v183
  v_mfma_f32_16x16x32_bf16 v[164:167], v[48:51], v[32:35], v[12:15]
  v_mfma_f32_16x16x32_bf16 v[168:171], v[48:51], v[36:39], v[16:19]
  v_mfma_f32_16x16x32_bf16 v[172:175], v[52:55], v[36:39], v[12:15]
  v_mfma_f32_16x16x32_bf16 v[176:179], v[52:55], v[40:43], v[16:19]
  v_mfma_f32_16x16x32_bf16 v[180:183], v[56:59], v[40:43], v[12:15]
  v_mfma_f32_16x16x32_bf16 v[184:187], v[56:59], v[44:47], v[16:19]
  v_mfma_f32_16x16x32_bf16 v[188:191], v[60:63], v[44:47], v[12:15]
  s_nop 0
  s_waitcnt lgkmcnt(0)
  v_pk_mul_f32 v[116:117], v[132:133], v[114:115] op_sel:[0,0] op_sel_hi:[1,0]
  v_pk_mul_f32 v[118:119], v[134:135], v[114:115] op_sel:[0,0] op_sel_hi:[1,0]
  v_pk_fma_f32 v[192:193], v[192:193], v[128:129], v[116:117] neg_lo:[0,0,1] neg_hi:[0,0,1]
  v_pk_fma_f32 v[194:195], v[194:195], v[130:131], v[118:119] neg_lo:[0,0,1] neg_hi:[0,0,1]
  v_cvt_pk_bf16_f32 v70, v192, v193
  v_cvt_pk_bf16_f32 v71, v194, v195
  v_pk_mul_f32 v[116:117], v[132:133], v[114:115] op_sel:[0,1] op_sel_hi:[1,1]
  v_pk_mul_f32 v[118:119], v[134:135], v[114:115] op_sel:[0,1] op_sel_hi:[1,1]
  v_pk_fma_f32 v[196:197], v[196:197], v[128:129], v[116:117] neg_lo:[0,0,1] neg_hi:[0,0,1]
  v_pk_fma_f32 v[198:199], v[198:199], v[130:131], v[118:119] neg_lo:[0,0,1] neg_hi:[0,0,1]
  v_cvt_pk_bf16_f32 v80, v196, v197
  v_cvt_pk_bf16_f32 v81, v198, v199
  v_pk_mul_f32 v[116:117], v[140:141], v[114:115] op_sel:[0,0] op_sel_hi:[1,0]
  v_pk_mul_f32 v[118:119], v[142:143], v[114:115] op_sel:[0,0] op_sel_hi:[1,0]
  v_pk_fma_f32 v[200:201], v[200:201], v[136:137], v[116:117] neg_lo:[0,0,1] neg_hi:[0,0,1]
  v_pk_fma_f32 v[202:203], v[202:203], v[138:139], v[118:119] neg_lo:[0,0,1] neg_hi:[0,0,1]
  v_cvt_pk_bf16_f32 v72, v200, v201
  v_cvt_pk_bf16_f32 v73, v202, v203
  v_pk_mul_f32 v[116:117], v[140:141], v[114:115] op_sel:[0,1] op_sel_hi:[1,1]
  v_pk_mul_f32 v[118:119], v[142:143], v[114:115] op_sel:[0,1] op_sel_hi:[1,1]
  v_pk_fma_f32 v[204:205], v[204:205], v[136:137], v[116:117] neg_lo:[0,0,1] neg_hi:[0,0,1]
  v_pk_fma_f32 v[206:207], v[206:207], v[138:139], v[118:119] neg_lo:[0,0,1] neg_hi:[0,0,1]
  v_cvt_pk_bf16_f32 v82, v204, v205
  v_cvt_pk_bf16_f32 v83, v206, v207
  v_pk_mul_f32 v[116:117], v[148:149], v[114:115] op_sel:[0,0] op_sel_hi:[1,0]
  v_pk_mul_f32 v[118:119], v[150:151], v[114:115] op_sel:[0,0] op_sel_hi:[1,0]
  v_pk_fma_f32 v[208:209], v[208:209], v[144:145], v[116:117] neg_lo:[0,0,1] neg_hi:[0,0,1]
  v_pk_fma_f32 v[210:211], v[210:211], v[146:147], v[118:119] neg_lo:[0,0,1] neg_hi:[0,0,1]
  v_cvt_pk_bf16_f32 v74, v208, v209
  v_cvt_pk_bf16_f32 v75, v210, v211
  v_pk_mul_f32 v[116:117], v[148:149], v[114:115] op_sel:[0,1] op_sel_hi:[1,1]
  v_pk_mul_f32 v[118:119], v[150:151], v[114:115] op_sel:[0,1] op_sel_hi:[1,1]
  v_pk_fma_f32 v[212:213], v[212:213], v[144:145], v[116:117] neg_lo:[0,0,1] neg_hi:[0,0,1]
  v_pk_fma_f32 v[214:215], v[214:215], v[146:147], v[118:119] neg_lo:[0,0,1] neg_hi:[0,0,1]
  v_cvt_pk_bf16_f32 v84, v212, v213
  v_cvt_pk_bf16_f32 v85, v214, v215
  v_max3_f32 v90, v172, v173, v174
  v_max3_f32 v99, v175, v168, v169
  v_max3_f32 v92, v180, v181, v182
  v_max3_f32 v100, v183, v176, v177
  v_max3_f32 v94, v188, v189, v190
  v_max3_f32 v101, v191, v184, v185
  v_max3_f32 v90, v90, v170, v171
  v_max3_f32 v92, v92, v178, v179
  v_max3_f32 v94, v94, v186, v187
  v_max_f32 v90, v90, v99
  v_max_f32 v92, v92, v100
  v_max_f32 v94, v94, v101
  v_mov_b32 v99, v90
  v_mov_b32 v100, v92
  v_mov_b32 v101, v94
  v_permlane32_swap_b32 v90, v99
  v_permlane32_swap_b32 v92, v100
  v_permlane32_swap_b32 v94, v101
  v_max_f32 v90, v90, v99
  v_max_f32 v92, v92, v100
  v_max_f32 v94, v94, v101
  v_mov_b32 v99, v90
  v_mov_b32 v100, v92
  v_mov_b32 v101, v94
  v_permlane16_swap_b32 v90, v99
  v_permlane16_swap_b32 v92, v100
  v_permlane16_swap_b32 v94, v101
  v_max_f32 v90, v90, v99
  v_max_f32 v92, v92, v100
  v_max_f32_e64 v94, v94, v101
  s_mov_b32 s4, 0x3e8293ee
  v_mul_f32 v90, s4, v90
  v_mov_b32 v91, s4
  v_mul_f32 v92, s4, v92
  v_mov_b32 v93, s4
  v_mul_f32 v94, s4, v94
  v_mov_b32 v95, s4
  v_pk_fma_f32 v[168:169], v[168:169], v[90:91], v[90:91] op_sel:[0,1,0] op_sel_hi:[1,1,0] neg_lo:[0,0,1] neg_hi:[0,0,1]
  v_pk_fma_f32 v[170:171], v[170:171], v[90:91], v[90:91] op_sel:[0,1,0] op_sel_hi:[1,1,0] neg_lo:[0,0,1] neg_hi:[0,0,1]
  v_pk_fma_f32 v[172:173], v[172:173], v[90:91], v[90:91] op_sel:[0,1,0] op_sel_hi:[1,1,0] neg_lo:[0,0,1] neg_hi:[0,0,1]
  v_pk_fma_f32 v[174:175], v[174:175], v[90:91], v[90:91] op_sel:[0,1,0] op_sel_hi:[1,1,0] neg_lo:[0,0,1] neg_hi:[0,0,1]
  v_pk_fma_f32 v[176:177], v[176:177], v[92:93], v[92:93] op_sel:[0,1,0] op_sel_hi:[1,1,0] neg_lo:[0,0,1] neg_hi:[0,0,1]
  v_pk_fma_f32 v[178:179], v[178:179], v[92:93], v[92:93] op_sel:[0,1,0] op_sel_hi:[1,1,0] neg_lo:[0,0,1] neg_hi:[0,0,1]
  v_pk_fma_f32 v[180:181], v[180:181], v[92:93], v[92:93] op_sel:[0,1,0] op_sel_hi:[1,1,0] neg_lo:[0,0,1] neg_hi:[0,0,1]
  v_pk_fma_f32 v[182:183], v[182:183], v[92:93], v[92:93] op_sel:[0,1,0] op_sel_hi:[1,1,0] neg_lo:[0,0,1] neg_hi:[0,0,1]
  v_pk_fma_f32 v[184:185], v[184:185], v[94:95], v[94:95] op_sel:[0,1,0] op_sel_hi:[1,1,0] neg_lo:[0,0,1] neg_hi:[0,0,1]
  v_pk_fma_f32 v[186:187], v[186:187], v[94:95], v[94:95] op_sel:[0,1,0] op_sel_hi:[1,1,0] neg_lo:[0,0,1] neg_hi:[0,0,1]
  v_pk_fma_f32 v[188:189], v[188:189], v[94:95], v[94:95] op_sel:[0,1,0] op_sel_hi:[1,1,0] neg_lo:[0,0,1] neg_hi:[0,0,1]
  v_pk_fma_f32 v[190:191], v[190:191], v[94:95], v[94:95] op_sel:[0,1,0] op_sel_hi:[1,1,0] neg_lo:[0,0,1] neg_hi:[0,0,1]
  s_lshl_b32 s6, s84, Lz1-Lz0+3
  s_add_u32 s6, s6, 3145728
  s_add_u32 s7, s6, 4096
  s_mov_b32 exec_lo, s12
  s_mov_b32 exec_hi, s12
  buffer_load_dwordx4 v[64:67], v126, s[40:43], s11 offen sc0 sc1
  s_mov_b32 exec_lo, 0
  s_mov_b32 exec_hi, -1
  buffer_load_dwordx4 v[232:235], v11, s[40:43], s11 offen sc0 sc1
  s_mov_b64 exec, -1
  v_exp_f32 v168, v168
  v_exp_f32 v169, v169
  v_exp_f32 v170, v170
  v_exp_f32 v171, v171
  v_exp_f32 v172, v172
  v_exp_f32 v173, v173
  v_exp_f32 v174, v174
  v_exp_f32_e64 v175, v175
  v_cvt_pk_bf16_f32 v36, v168, v169
  v_cvt_pk_bf16_f32 v37, v170, v171
  v_cvt_pk_bf16_f32 v38, v172, v173
  v_cvt_pk_bf16_f32 v39, v174, v175
  v_exp_f32 v176, v176
  v_exp_f32 v177, v177
  v_exp_f32 v178, v178
  v_exp_f32 v179, v179
  v_exp_f32 v180, v180
  v_exp_f32 v181, v181
  v_exp_f32 v182, v182
  v_exp_f32 v183, v183
  v_cvt_pk_bf16_f32 v40, v176, v177
  v_cvt_pk_bf16_f32 v41, v178, v179
  v_cvt_pk_bf16_f32 v42, v180, v181
  v_cvt_pk_bf16_f32 v43, v182, v183
  v_mfma_f32_16x16x32_bf16 v[132:135], v[120:123], v[36:39], 0
  v_mfma_f32_16x16x32_bf16 v[200:203], v[70:73], v[36:39], 0
  v_mfma_f32_16x16x32_bf16 v[204:207], v[80:83], v[36:39], 0
  v_exp_f32 v184, v184
  v_exp_f32 v185, v185
  v_exp_f32 v186, v186
  v_exp_f32 v187, v187
  v_exp_f32 v188, v188
  v_exp_f32 v189, v189
  v_exp_f32 v190, v190
  v_exp_f32 v191, v191
  v_cvt_pk_bf16_f32 v44, v184, v185
  v_cvt_pk_bf16_f32 v45, v186, v187
  v_cvt_pk_bf16_f32 v46, v188, v189
  v_cvt_pk_bf16_f32 v47, v190, v191
  v_mfma_f32_16x16x32_bf16 v[136:139], v[120:123], v[40:43], 0
  v_mfma_f32_16x16x32_bf16 v[208:211], v[72:75], v[40:43], 0
  v_mfma_f32_16x16x32_bf16 v[212:215], v[82:85], v[40:43], 0
  v_mfma_f32_16x16x32_bf16 v[140:143], v[120:123], v[44:47], 0
  v_mfma_f32_16x16x32_bf16 v[216:219], v[74:77], v[44:47], 0
  v_mfma_f32_16x16x32_bf16 v[220:223], v[84:87], v[44:47], 0
  v_rcp_f32 v132, v132
  s_nop 0
  v_pk_mul_f32 v[200:201], v[200:201], v[132:133] op_sel_hi:[1,0]
  v_pk_mul_f32 v[202:203], v[202:203], v[132:133] op_sel_hi:[1,0]
  v_pk_mul_f32 v[204:205], v[204:205], v[132:133] op_sel_hi:[1,0]
  v_pk_mul_f32 v[206:207], v[206:207], v[132:133] op_sel_hi:[1,0]
  v_cvt_pk_bf16_f32 v52, v200, v201
  v_cvt_pk_bf16_f32 v53, v202, v203
  v_cvt_pk_bf16_f32 v54, v204, v205
  v_cvt_pk_bf16_f32 v55, v206, v207
  buffer_store_dwordx4 v[52:55], v0, s[40:43], s6 offen offset:2048 sc0 sc1
  v_rcp_f32 v136, v136
  s_nop 0
  v_pk_mul_f32 v[208:209], v[208:209], v[136:137] op_sel_hi:[1,0]
  v_pk_mul_f32 v[210:211], v[210:211], v[136:137] op_sel_hi:[1,0]
  v_pk_mul_f32 v[212:213], v[212:213], v[136:137] op_sel_hi:[1,0]
  v_pk_mul_f32 v[214:215], v[214:215], v[136:137] op_sel_hi:[1,0]
  v_cvt_pk_bf16_f32 v56, v208, v209
  v_cvt_pk_bf16_f32 v57, v210, v211
  v_cvt_pk_bf16_f32 v58, v212, v213
  v_cvt_pk_bf16_f32 v59, v214, v215
  buffer_store_dwordx4 v[56:59], v0, s[40:43], s7 offen offset:0 sc0 sc1
  v_rcp_f32 v140, v140
  s_nop 0
  v_pk_mul_f32 v[216:217], v[216:217], v[140:141] op_sel_hi:[1,0]
  v_pk_mul_f32 v[218:219], v[218:219], v[140:141] op_sel_hi:[1,0]
  v_pk_mul_f32 v[220:221], v[220:221], v[140:141] op_sel_hi:[1,0]
  v_pk_mul_f32 v[222:223], v[222:223], v[140:141] op_sel_hi:[1,0]
  v_cvt_pk_bf16_f32 v60, v216, v217
  v_cvt_pk_bf16_f32 v61, v218, v219
  v_cvt_pk_bf16_f32 v62, v220, v221
  v_cvt_pk_bf16_f32 v63, v222, v223
  buffer_store_dwordx4 v[60:63], v0, s[40:43], s7 offen offset:2048 sc0 sc1
  s_cmp_eq_u32 s76, Lz1-Lz0+0
  s_mov_b32 s89, 200000
  s_waitcnt vmcnt(3)
  s_cbranch_scc0 Lh_6
  v_mov_b64 v[64:65], 0
  v_mov_b64 v[66:67], 0
  v_mov_b64 v[232:233], 0
  v_mov_b64 v[234:235], 0
  s_branch Lh_7
  s_nop 0
Lh_5:
  s_mov_b32 exec_lo, s12
  s_mov_b32 exec_hi, s12
  buffer_load_dwordx4 v[64:67], v126, s[40:43], s11 offen sc0 sc1
  s_mov_b32 exec_lo, 0
  s_mov_b32 exec_hi, -1
  buffer_load_dwordx4 v[232:235], v11, s[40:43], s11 offen sc0 sc1
  s_mov_b64 exec, -1
  s_waitcnt vmcnt(0)
Lh_6:
  v_max3_u32 v2, v64, v65, v66
  v_max3_u32 v3, v232, v233, v234
  v_max3_u32 v2, v2, v67, v235
  v_max_u32_e64 v2, v2, v3
  v_cmp_eq_u32 vcc, -1, v2
  s_cbranch_vccz Lh_7
  s_sub_u32 s89, s89, 1
  s_cbranch_scc0 Lh_5
Lh_7:
  v_mfma_f32_16x16x32_bf16 v[160:163], v[64:67], v[32:35], v[20:23]
  v_mov_b64 v[68:69], v[232:233]
  v_mov_b64 v[78:79], v[234:235]
  v_mov_b64 v[236:237], -1
  v_mov_b64 v[238:239], -1
  buffer_store_dwordx4 v[236:239], v11, s[40:43], s11 offen sc0 sc1
  v_max3_f32 v88, v164, v165, v166
  s_nop 0
  s_nop 1
  v_max3_f32 v98, v167, v160, v161
  v_max3_f32 v88, v88, v162, v163
  v_max_f32 v88, v88, v98
  v_mov_b32 v98, v88
  s_nop 1
  v_permlane32_swap_b32 v88, v98
  v_max_f32 v88, v88, v98
  v_mov_b32 v98, v88
  s_nop 1
  v_permlane16_swap_b32 v88, v98
  v_max_f32_e64 v88, v88, v98
  s_mov_b32 s4, 0x3e8293ee
  v_mul_f32 v88, s4, v88
  v_mov_b32 v89, s4
  v_pk_fma_f32 v[160:161], v[160:161], v[88:89], v[88:89] op_sel:[0,1,0] op_sel_hi:[1,1,0] neg_lo:[0,0,1] neg_hi:[0,0,1]
  v_pk_fma_f32 v[162:163], v[162:163], v[88:89], v[88:89] op_sel:[0,1,0] op_sel_hi:[1,1,0] neg_lo:[0,0,1] neg_hi:[0,0,1]
  v_pk_fma_f32 v[164:165], v[164:165], v[88:89], v[88:89] op_sel:[0,1,0] op_sel_hi:[1,1,0] neg_lo:[0,0,1] neg_hi:[0,0,1]
  v_pk_fma_f32 v[166:167], v[166:167], v[88:89], v[88:89] op_sel:[0,1,0] op_sel_hi:[1,1,0] neg_lo:[0,0,1] neg_hi:[0,0,1]
  v_exp_f32 v160, v160
  v_exp_f32 v161, v161
  v_exp_f32 v162, v162
  v_exp_f32 v163, v163
  v_exp_f32 v164, v164
  v_exp_f32 v165, v165
  v_exp_f32 v166, v166
  v_exp_f32 v167, v167
  v_cvt_pk_bf16_f32 v32, v160, v161
  v_cvt_pk_bf16_f32 v33, v162, v163
  v_cvt_pk_bf16_f32 v34, v164, v165
  v_cvt_pk_bf16_f32 v35, v166, v167
  s_nop 0
  s_nop 1
  v_mfma_f32_16x16x32_bf16 v[128:131], v[120:123], v[32:35], 0
  v_mfma_f32_16x16x32_bf16 v[192:195], v[68:71], v[32:35], 0
  v_mfma_f32_16x16x32_bf16 v[196:199], v[78:81], v[32:35], 0
  s_nop 5
  v_rcp_f32_e64 v128, v128
  s_nop 0
  v_pk_mul_f32 v[192:193], v[192:193], v[128:129] op_sel_hi:[1,0]
  v_pk_mul_f32 v[194:195], v[194:195], v[128:129] op_sel_hi:[1,0]
  v_pk_mul_f32 v[196:197], v[196:197], v[128:129] op_sel_hi:[1,0]
  v_pk_mul_f32 v[198:199], v[198:199], v[128:129] op_sel_hi:[1,0]
  v_cvt_pk_bf16_f32 v48, v192, v193
  v_cvt_pk_bf16_f32 v49, v194, v195
  v_cvt_pk_bf16_f32 v50, v196, v197
  v_cvt_pk_bf16_f32 v51, v198, v199
  buffer_store_dwordx4 v[48:51], v0, s[40:43], s6 offen offset:0 sc0 sc1
  ds_read_b32 v3, v28 offset:8
  s_cmp_lg_u32 s82, 0
  s_cbranch_scc1 L_9
  v_permlane16_swap_b32 v240, v242
  v_permlane16_swap_b32 v241, v243
  v_permlane16_swap_b32 v244, v246
  v_permlane16_swap_b32 v245, v247
  v_permlane16_swap_b32 v248, v250
  v_permlane16_swap_b32 v249, v251
  v_permlane16_swap_b32 v252, v254
  v_permlane16_swap_b32 v253, v255
L_9:
  s_mov_b32 s16, Lz1-Lz0+0
  s_mov_b32 s17, 16384
  s_mov_b32 s18, 0xffff4000
  s_mov_b32 s19, 32768
  s_mov_b32 s20, 8192
  s_mov_b32 s21, 0xfffee000
  s_mul_i32 s4, s85, 8192
  v_add_u32_e64 v4, s4, v11
  v_add_u32 v5, 1024, v4
  s_add_u32 s5, s19, 0
  s_lshl_b32 s4, s86, 1
  v_xor_b32_e64 v2, s4, v26
  v_lshl_add_u32 v6, v2, 5, v25
  v_add_u32 v6, s5, v6
  s_add_u32 s4, s4, 1
  v_xor_b32_e64 v2, s4, v26
  v_lshl_add_u32 v7, v2, 5, v25
  v_add_u32 v7, s5, v7
  s_lshl_b32 s5, s82, 1
  s_add_u32 s5, s5, Lz1-Lz0+2
  s_mov_b32 s89, 1600000
  s_branch Lw_11
Lw_10:
  ds_read_b32 v3, v28 offset:8
Lw_11:
  s_waitcnt lgkmcnt(0)
  v_readfirstlane_b32 s4, v3
  s_cmp_ge_u32 s4, s5
  s_cbranch_scc1 Lw_12
  s_sleep 1
  s_sub_u32 s89, s89, 1
  s_cbranch_scc0 Lw_10
Lw_12:
  ds_read_b64_tr_b16 v[48:49], v6 offset:0
  ds_read_b64_tr_b16 v[50:51], v6 offset:2048
  ds_read_b64_tr_b16 v[52:53], v7 offset:0
  ds_read_b64_tr_b16 v[54:55], v7 offset:2048
  ds_read_b64_tr_b16 v[80:81], v6 offset:4096
  ds_read_b64_tr_b16 v[82:83], v6 offset:6144
  ds_read_b64_tr_b16 v[84:85], v7 offset:4096
  ds_read_b64_tr_b16 v[86:87], v7 offset:6144
  ds_read_b64_tr_b16 v[112:113], v6 offset:8192
  ds_read_b64_tr_b16 v[114:115], v6 offset:10240
  ds_read_b64_tr_b16 v[116:117], v7 offset:8192
  ds_read_b64_tr_b16 v[118:119], v7 offset:10240
  s_nop 0
  s_waitcnt lgkmcnt(8)
  ds_read_b64_tr_b16 v[208:209], v6 offset:12288
  ds_read_b64_tr_b16 v[210:211], v6 offset:14336
  ds_read_b64_tr_b16 v[212:213], v7 offset:12288
  ds_read_b64_tr_b16 v[214:215], v7 offset:14336
  s_nop 0
  s_waitcnt lgkmcnt(8)
  ds_read_b64_tr_b16 v[160:161], v6 offset:16384
  ds_read_b64_tr_b16 v[162:163], v6 offset:18432
  ds_read_b64_tr_b16 v[164:165], v7 offset:16384
  ds_read_b64_tr_b16 v[166:167], v7 offset:18432
  s_nop 0
  s_waitcnt lgkmcnt(8)
  ds_read_b64_tr_b16 v[168:169], v6 offset:20480
  ds_read_b64_tr_b16 v[170:171], v6 offset:22528
  ds_read_b64_tr_b16 v[172:173], v7 offset:20480
  ds_read_b64_tr_b16 v[174:175], v7 offset:22528
  s_nop 0
  s_waitcnt lgkmcnt(8)
  ds_read_b64_tr_b16 v[176:177], v6 offset:24576
  ds_read_b64_tr_b16 v[178:179], v6 offset:26624
  ds_read_b64_tr_b16 v[180:181], v7 offset:24576
  ds_read_b64_tr_b16 v[182:183], v7 offset:26624
  s_nop 0
  s_waitcnt lgkmcnt(8)
  ds_read_b64_tr_b16 v[184:185], v6 offset:28672
  ds_read_b64_tr_b16 v[186:187], v6 offset:30720
  ds_read_b64_tr_b16 v[188:189], v7 offset:28672
  ds_read_b64_tr_b16 v[190:191], v7 offset:30720
  s_nop 0
  s_waitcnt lgkmcnt(8)
  ds_read_b64_tr_b16 v[224:225], v6 offset:32768
  ds_read_b64_tr_b16 v[226:227], v6 offset:34816
  ds_read_b64_tr_b16 v[228:229], v7 offset:32768
  ds_read_b64_tr_b16 v[230:231], v7 offset:34816
  s_nop 0
  s_waitcnt lgkmcnt(8)
  ds_read_b64_tr_b16 v[232:233], v6 offset:36864
  ds_read_b64_tr_b16 v[234:235], v6 offset:38912
  ds_read_b64_tr_b16 v[236:237], v7 offset:36864
  ds_read_b64_tr_b16 v[238:239], v7 offset:38912
  s_nop 0
  s_waitcnt lgkmcnt(8)
  ds_read_b64_tr_b16 v[56:57], v6 offset:40960
  ds_read_b64_tr_b16 v[58:59], v6 offset:43008
  ds_read_b64_tr_b16 v[60:61], v7 offset:40960
  ds_read_b64_tr_b16 v[62:63], v7 offset:43008
  s_nop 0
  s_waitcnt lgkmcnt(8)
  ds_read_b64_tr_b16 v[88:89], v6 offset:45056
  ds_read_b64_tr_b16 v[90:91], v6 offset:47104
  ds_read_b64_tr_b16 v[92:93], v7 offset:45056
  ds_read_b64_tr_b16 v[94:95], v7 offset:47104
  s_waitcnt lgkmcnt(8)
  s_mov_b32 s19, 0
  v_add_u32 v6, 0xffff8000, v6
  v_add_u32 v7, 0xffff8000, v7
  s_waitcnt lgkmcnt(0)
  s_mov_b64 exec, 1
  ds_add_u32 v28, v27 offset:12
  s_mov_b64 exec, -1
  s_add_u32 s5, s87, 0
  s_waitcnt vmcnt(0)
  s_mov_b64 exec, 1
  ds_add_rtn_u32 v2, v28, v27 offset:0
  s_waitcnt lgkmcnt(0)
  v_readfirstlane_b32 s4, v2
  s_and_b32 s4, s4, Lz1-Lz0+3
  s_cmp_lg_u32 s4, 3
  s_cbranch_scc1 Ls_13
  s_mov_b32 exec_lo, 0xffff
  buffer_store_dword v27, v24, s[40:43], s5 offen sc0 sc1
Ls_13:
  s_mov_b64 exec, -1
  s_mov_b32 s4, 0xffff0000
  v_lshlrev_b32 v128, 16, v240
  v_and_b32 v129, s4, v240
  v_lshlrev_b32 v130, 16, v241
  v_and_b32 v131, s4, v241
  v_lshlrev_b32 v132, 16, v242
  v_and_b32 v133, s4, v242
  v_lshlrev_b32 v134, 16, v243
  v_and_b32 v135, s4, v243
  v_lshlrev_b32 v136, 16, v244
  v_and_b32 v137, s4, v244
  v_lshlrev_b32 v138, 16, v245
  v_and_b32 v139, s4, v245
  v_lshlrev_b32 v140, 16, v246
  v_and_b32 v141, s4, v246
  v_lshlrev_b32 v142, 16, v247
  v_and_b32 v143, s4, v247
  v_lshlrev_b32 v144, 16, v248
  v_and_b32 v145, s4, v248
  v_lshlrev_b32 v146, 16, v249
  v_and_b32 v147, s4, v249
  v_lshlrev_b32 v148, 16, v250
  v_and_b32 v149, s4, v250
  v_lshlrev_b32 v150, 16, v251
  v_and_b32 v151, s4, v251
  v_lshlrev_b32 v152, 16, v252
  v_and_b32 v153, s4, v252
  v_lshlrev_b32 v154, 16, v253
  v_and_b32 v155, s4, v253
  v_lshlrev_b32 v156, 16, v254
  v_and_b32 v157, s4, v254
  v_lshlrev_b32 v158, 16, v255
  v_and_b32_e64 v159, s4, v255
  s_mov_b32 s22, 5
  s_barrier
  ds_read_b128 v[32:35], v4 offset:0
  ds_read_b128 v[36:39], v4 offset:2048
  ds_read_b128 v[40:43], v4 offset:4096
  ds_read_b128 v[44:47], v4 offset:6144
  ds_read_b128 v[64:67], v5 offset:0
  ds_read_b128 v[68:71], v5 offset:2048
  ds_read_b128 v[72:75], v5 offset:4096
  ds_read_b128 v[76:79], v5 offset:6144
  s_add_u32 s16, s16, s17
  s_cmp_eq_u32 s16, 65536
  s_cselect_b32 s23, s18, s17
  s_cselect_b32 s16, 0, s16
  v_add_u32 v4, s23, v4
  v_add_u32_e64 v5, s23, v5
  s_waitcnt lgkmcnt(0)
  s_barrier
  v_mfma_f32_16x16x32_bf16 v[128:131], v[48:51], v[32:35], v[128:131]
  ds_read_b128 v[96:99], v4 offset:0
  ds_read_b128 v[100:103], v4 offset:2048
  v_mfma_f32_16x16x32_bf16 v[136:139], v[48:51], v[36:39], v[136:139]
  ds_read_b128 v[104:107], v4 offset:4096
  ds_read_b128 v[108:111], v4 offset:6144
  v_mfma_f32_16x16x32_bf16 v[144:147], v[48:51], v[40:43], v[144:147]
  ds_read_b128 v[192:195], v5 offset:0
  ds_read_b128 v[196:199], v5 offset:2048
  v_mfma_f32_16x16x32_bf16 v[152:155], v[48:51], v[44:47], v[152:155]
  ds_read_b128 v[200:203], v5 offset:4096
  ds_read_b128 v[204:207], v5 offset:6144
  v_mfma_f32_16x16x32_bf16 v[132:135], v[52:55], v[32:35], v[132:135]
  s_add_u32 s16, s16, s17
  s_cmp_eq_u32 s16, 65536
  s_cselect_b32 s23, s18, s17
  v_mfma_f32_16x16x32_bf16 v[140:143], v[52:55], v[36:39], v[140:143]
  s_cselect_b32 s16, 0, s16
  v_add_u32 v4, s23, v4
  v_add_u32_e64 v5, s23, v5
  v_mfma_f32_16x16x32_bf16 v[148:151], v[52:55], v[40:43], v[148:151]
  v_mfma_f32_16x16x32_bf16 v[156:159], v[52:55], v[44:47], v[156:159]
  v_mfma_f32_16x16x32_bf16 v[128:131], v[80:83], v[64:67], v[128:131]
  v_mfma_f32_16x16x32_bf16 v[136:139], v[80:83], v[68:71], v[136:139]
  v_mfma_f32_16x16x32_bf16 v[144:147], v[80:83], v[72:75], v[144:147]
  v_mfma_f32_16x16x32_bf16 v[152:155], v[80:83], v[76:79], v[152:155]
  v_mfma_f32_16x16x32_bf16 v[132:135], v[84:87], v[64:67], v[132:135]
  v_mfma_f32_16x16x32_bf16 v[140:143], v[84:87], v[68:71], v[140:143]
  v_mfma_f32_16x16x32_bf16 v[148:151], v[84:87], v[72:75], v[148:151]
  s_waitcnt lgkmcnt(0)
  v_mfma_f32_16x16x32_bf16 v[156:159], v[84:87], v[76:79], v[156:159]
  s_barrier
  v_mfma_f32_16x16x32_bf16 v[128:131], v[112:115], v[96:99], v[128:131]
  ds_read_b128 v[32:35], v4 offset:0
  ds_read_b128 v[36:39], v4 offset:2048
  v_mfma_f32_16x16x32_bf16 v[136:139], v[112:115], v[100:103], v[136:139]
  ds_read_b128 v[40:43], v4 offset:4096
  ds_read_b128 v[44:47], v4 offset:6144
  v_mfma_f32_16x16x32_bf16 v[144:147], v[112:115], v[104:107], v[144:147]
  ds_read_b128 v[64:67], v5 offset:0
  ds_read_b128 v[68:71], v5 offset:2048
  v_mfma_f32_16x16x32_bf16 v[152:155], v[112:115], v[108:111], v[152:155]
  ds_read_b128 v[72:75], v5 offset:4096
  ds_read_b128 v[76:79], v5 offset:6144
  v_mfma_f32_16x16x32_bf16 v[132:135], v[116:119], v[96:99], v[132:135]
  s_add_u32 s16, s16, s17
  s_cmp_eq_u32 s16, 65536
  s_cselect_b32 s23, s18, s17
  v_mfma_f32_16x16x32_bf16 v[140:143], v[116:119], v[100:103], v[140:143]
  s_cselect_b32 s16, 0, s16
  v_add_u32 v4, s23, v4
  v_add_u32_e64 v5, s23, v5
  v_mfma_f32_16x16x32_bf16 v[148:151], v[116:119], v[104:107], v[148:151]
  v_mfma_f32_16x16x32_bf16 v[156:159], v[116:119], v[108:111], v[156:159]
  v_mfma_f32_16x16x32_bf16 v[128:131], v[208:211], v[192:195], v[128:131]
  v_mfma_f32_16x16x32_bf16 v[136:139], v[208:211], v[196:199], v[136:139]
  v_mfma_f32_16x16x32_bf16 v[144:147], v[208:211], v[200:203], v[144:147]
  v_mfma_f32_16x16x32_bf16 v[152:155], v[208:211], v[204:207], v[152:155]
  v_mfma_f32_16x16x32_bf16 v[132:135], v[212:215], v[192:195], v[132:135]
  v_mfma_f32_16x16x32_bf16 v[140:143], v[212:215], v[196:199], v[140:143]
  v_mfma_f32_16x16x32_bf16 v[148:151], v[212:215], v[200:203], v[148:151]
  s_waitcnt lgkmcnt(0)
  v_mfma_f32_16x16x32_bf16 v[156:159], v[212:215], v[204:207], v[156:159]
  s_barrier
  v_mfma_f32_16x16x32_bf16 v[128:131], v[160:163], v[32:35], v[128:131]
  ds_read_b128 v[96:99], v4 offset:0
  ds_read_b128 v[100:103], v4 offset:2048
  v_mfma_f32_16x16x32_bf16 v[136:139], v[160:163], v[36:39], v[136:139]
  ds_read_b128 v[104:107], v4 offset:4096
  ds_read_b128 v[108:111], v4 offset:6144
  v_mfma_f32_16x16x32_bf16 v[144:147], v[160:163], v[40:43], v[144:147]
  ds_read_b128 v[192:195], v5 offset:0
  ds_read_b128 v[196:199], v5 offset:2048
  v_mfma_f32_16x16x32_bf16 v[152:155], v[160:163], v[44:47], v[152:155]
  ds_read_b128 v[200:203], v5 offset:4096
  ds_read_b128 v[204:207], v5 offset:6144
  v_mfma_f32_16x16x32_bf16 v[132:135], v[164:167], v[32:35], v[132:135]
  s_add_u32 s16, s16, s17
  s_cmp_eq_u32 s16, 65536
  s_cselect_b32 s23, s18, s17
  v_mfma_f32_16x16x32_bf16 v[140:143], v[164:167], v[36:39], v[140:143]
  s_cselect_b32 s16, 0, s16
  v_add_u32 v4, s23, v4
  v_add_u32_e64 v5, s23, v5
  v_mfma_f32_16x16x32_bf16 v[148:151], v[164:167], v[40:43], v[148:151]
  v_mfma_f32_16x16x32_bf16 v[156:159], v[164:167], v[44:47], v[156:159]
  v_mfma_f32_16x16x32_bf16 v[128:131], v[168:171], v[64:67], v[128:131]
  v_mfma_f32_16x16x32_bf16 v[136:139], v[168:171], v[68:71], v[136:139]
  v_mfma_f32_16x16x32_bf16 v[144:147], v[168:171], v[72:75], v[144:147]
  v_mfma_f32_16x16x32_bf16 v[152:155], v[168:171], v[76:79], v[152:155]
  v_mfma_f32_16x16x32_bf16 v[132:135], v[172:175], v[64:67], v[132:135]
  v_mfma_f32_16x16x32_bf16 v[140:143], v[172:175], v[68:71], v[140:143]
  v_mfma_f32_16x16x32_bf16 v[148:151], v[172:175], v[72:75], v[148:151]
  s_waitcnt lgkmcnt(0)
  v_mfma_f32_16x16x32_bf16 v[156:159], v[172:175], v[76:79], v[156:159]
  s_barrier
  v_mfma_f32_16x16x32_bf16 v[128:131], v[176:179], v[96:99], v[128:131]
  ds_read_b128 v[32:35], v4 offset:0
  ds_read_b128 v[36:39], v4 offset:2048
  v_mfma_f32_16x16x32_bf16 v[136:139], v[176:179], v[100:103], v[136:139]
  ds_read_b128 v[40:43], v4 offset:4096
  ds_read_b128 v[44:47], v4 offset:6144
  v_mfma_f32_16x16x32_bf16 v[144:147], v[176:179], v[104:107], v[144:147]
  ds_read_b128 v[64:67], v5 offset:0
  ds_read_b128 v[68:71], v5 offset:2048
  v_mfma_f32_16x16x32_bf16 v[152:155], v[176:179], v[108:111], v[152:155]
  ds_read_b128 v[72:75], v5 offset:4096
  ds_read_b128 v[76:79], v5 offset:6144
  v_mfma_f32_16x16x32_bf16 v[132:135], v[180:183], v[96:99], v[132:135]
  s_add_u32 s16, s16, s17
  s_cmp_eq_u32 s16, 65536
  s_cselect_b32 s23, s18, s17
  v_mfma_f32_16x16x32_bf16 v[140:143], v[180:183], v[100:103], v[140:143]
  s_cselect_b32 s16, 0, s16
  v_add_u32 v4, s23, v4
  v_add_u32_e64 v5, s23, v5
  v_mfma_f32_16x16x32_bf16 v[148:151], v[180:183], v[104:107], v[148:151]
  v_mfma_f32_16x16x32_bf16 v[156:159], v[180:183], v[108:111], v[156:159]
  v_mfma_f32_16x16x32_bf16 v[128:131], v[184:187], v[192:195], v[128:131]
  v_mfma_f32_16x16x32_bf16 v[136:139], v[184:187], v[196:199], v[136:139]
  v_mfma_f32_16x16x32_bf16 v[144:147], v[184:187], v[200:203], v[144:147]
  v_mfma_f32_16x16x32_bf16 v[152:155], v[184:187], v[204:207], v[152:155]
  v_mfma_f32_16x16x32_bf16 v[132:135], v[188:191], v[192:195], v[132:135]
  v_mfma_f32_16x16x32_bf16 v[140:143], v[188:191], v[196:199], v[140:143]
  v_mfma_f32_16x16x32_bf16 v[148:151], v[188:191], v[200:203], v[148:151]
  s_waitcnt lgkmcnt(0)
  v_mfma_f32_16x16x32_bf16 v[156:159], v[188:191], v[204:207], v[156:159]
  s_barrier
  v_mfma_f32_16x16x32_bf16 v[128:131], v[224:227], v[32:35], v[128:131]
  ds_read_b128 v[96:99], v4 offset:0
  ds_read_b128 v[100:103], v4 offset:2048
  v_mfma_f32_16x16x32_bf16 v[136:139], v[224:227], v[36:39], v[136:139]
  ds_read_b128 v[104:107], v4 offset:4096
  ds_read_b128 v[108:111], v4 offset:6144
  v_mfma_f32_16x16x32_bf16 v[144:147], v[224:227], v[40:43], v[144:147]
  ds_read_b128 v[192:195], v5 offset:0
  ds_read_b128 v[196:199], v5 offset:2048
  v_mfma_f32_16x16x32_bf16 v[152:155], v[224:227], v[44:47], v[152:155]
  ds_read_b128 v[200:203], v5 offset:4096
  ds_read_b128 v[204:207], v5 offset:6144
  v_mfma_f32_16x16x32_bf16 v[132:135], v[228:231], v[32:35], v[132:135]
  s_add_u32 s16, s16, s17
  s_cmp_eq_u32 s16, 65536
  s_cselect_b32 s23, s18, s17
  v_mfma_f32_16x16x32_bf16 v[140:143], v[228:231], v[36:39], v[140:143]
  s_cselect_b32 s16, 0, s16
  v_add_u32 v4, s23, v4
  v_add_u32_e64 v5, s23, v5
  v_mfma_f32_16x16x32_bf16 v[148:151], v[228:231], v[40:43], v[148:151]
  v_mfma_f32_16x16x32_bf16 v[156:159], v[228:231], v[44:47], v[156:159]
  v_mfma_f32_16x16x32_bf16 v[128:131], v[232:235], v[64:67], v[128:131]
  v_mfma_f32_16x16x32_bf16 v[136:139], v[232:235], v[68:71], v[136:139]
  v_mfma_f32_16x16x32_bf16 v[144:147], v[232:235], v[72:75], v[144:147]
  v_mfma_f32_16x16x32_bf16 v[152:155], v[232:235], v[76:79], v[152:155]
  v_mfma_f32_16x16x32_bf16 v[132:135], v[236:239], v[64:67], v[132:135]
  v_mfma_f32_16x16x32_bf16 v[140:143], v[236:239], v[68:71], v[140:143]
  v_mfma_f32_16x16x32_bf16 v[148:151], v[236:239], v[72:75], v[148:151]
  s_waitcnt lgkmcnt(0)
  v_mfma_f32_16x16x32_bf16 v[156:159], v[236:239], v[76:79], v[156:159]
  s_barrier
  v_mfma_f32_16x16x32_bf16 v[128:131], v[56:59], v[96:99], v[128:131]
  ds_read_b64_tr_b16 v[48:49], v6 offset:0
  ds_read_b64_tr_b16 v[50:51], v6 offset:2048
  v_mfma_f32_16x16x32_bf16 v[136:139], v[56:59], v[100:103], v[136:139]
  ds_read_b128 v[32:35], v4 offset:0
  ds_read_b128 v[36:39], v4 offset:2048
  v_mfma_f32_16x16x32_bf16 v[144:147], v[56:59], v[104:107], v[144:147]
  ds_read_b128 v[40:43], v4 offset:4096
  ds_read_b128 v[44:47], v4 offset:6144
  v_mfma_f32_16x16x32_bf16 v[152:155], v[56:59], v[108:111], v[152:155]
  ds_read_b64_tr_b16 v[52:53], v7 offset:0
  ds_read_b64_tr_b16 v[54:55], v7 offset:2048
  v_mfma_f32_16x16x32_bf16 v[132:135], v[60:63], v[96:99], v[132:135]
  ds_read_b64_tr_b16 v[80:81], v6 offset:4096
  ds_read_b64_tr_b16 v[82:83], v6 offset:6144
  v_mfma_f32_16x16x32_bf16 v[140:143], v[60:63], v[100:103], v[140:143]
  ds_read_b128 v[64:67], v5 offset:0
  ds_read_b128 v[68:71], v5 offset:2048
  v_mfma_f32_16x16x32_bf16 v[148:151], v[60:63], v[104:107], v[148:151]
  ds_read_b128 v[72:75], v5 offset:4096
  ds_read_b128 v[76:79], v5 offset:6144
  v_mfma_f32_16x16x32_bf16 v[156:159], v[60:63], v[108:111], v[156:159]
  ds_read_b64_tr_b16 v[84:85], v7 offset:4096
  ds_read_b64_tr_b16 v[86:87], v7 offset:6144
  v_mfma_f32_16x16x32_bf16 v[128:131], v[88:91], v[192:195], v[128:131]
  s_add_u32 s16, s16, s17
  s_cmp_eq_u32 s16, 65536
  s_cselect_b32 s23, s18, s17
  v_mfma_f32_16x16x32_bf16 v[136:139], v[88:91], v[196:199], v[136:139]
  s_cselect_b32 s16, 0, s16
  v_add_u32 v4, s23, v4
  v_add_u32_e64 v5, s23, v5
  v_mfma_f32_16x16x32_bf16 v[144:147], v[88:91], v[200:203], v[144:147]
  s_add_u32 s19, s19, s20
  s_cmp_eq_u32 s19, 81920
  s_cselect_b32 s23, s21, s20
  v_mfma_f32_16x16x32_bf16 v[152:155], v[88:91], v[204:207], v[152:155]
  s_cselect_b32 s19, 0, s19
  v_add_u32 v6, s23, v6
  v_add_u32_e64 v7, s23, v7
  v_mfma_f32_16x16x32_bf16 v[132:135], v[92:95], v[192:195], v[132:135]
  v_mfma_f32_16x16x32_bf16 v[140:143], v[92:95], v[196:199], v[140:143]
  v_mfma_f32_16x16x32_bf16 v[148:151], v[92:95], v[200:203], v[148:151]
  s_waitcnt lgkmcnt(0)
  v_mfma_f32_16x16x32_bf16 v[156:159], v[92:95], v[204:207], v[156:159]
Lk_14:
  s_barrier
  v_mfma_f32_16x16x32_bf16 v[128:131], v[48:51], v[32:35], v[128:131]
  ds_read_b64_tr_b16 v[112:113], v6 offset:0
  ds_read_b64_tr_b16 v[114:115], v6 offset:2048
  v_mfma_f32_16x16x32_bf16 v[136:139], v[48:51], v[36:39], v[136:139]
  ds_read_b128 v[96:99], v4 offset:0
  ds_read_b128 v[100:103], v4 offset:2048
  v_mfma_f32_16x16x32_bf16 v[144:147], v[48:51], v[40:43], v[144:147]
  ds_read_b128 v[104:107], v4 offset:4096
  ds_read_b128 v[108:111], v4 offset:6144
  v_mfma_f32_16x16x32_bf16 v[152:155], v[48:51], v[44:47], v[152:155]
  ds_read_b64_tr_b16 v[116:117], v7 offset:0
  ds_read_b64_tr_b16 v[118:119], v7 offset:2048
  v_mfma_f32_16x16x32_bf16 v[132:135], v[52:55], v[32:35], v[132:135]
  ds_read_b64_tr_b16 v[208:209], v6 offset:4096
  ds_read_b64_tr_b16 v[210:211], v6 offset:6144
  v_mfma_f32_16x16x32_bf16 v[140:143], v[52:55], v[36:39], v[140:143]
  ds_read_b128 v[192:195], v5 offset:0
  ds_read_b128 v[196:199], v5 offset:2048
  v_mfma_f32_16x16x32_bf16 v[148:151], v[52:55], v[40:43], v[148:151]
  ds_read_b128 v[200:203], v5 offset:4096
  ds_read_b128 v[204:207], v5 offset:6144
  v_mfma_f32_16x16x32_bf16 v[156:159], v[52:55], v[44:47], v[156:159]
  ds_read_b64_tr_b16 v[212:213], v7 offset:4096
  ds_read_b64_tr_b16 v[214:215], v7 offset:6144
  v_mfma_f32_16x16x32_bf16 v[128:131], v[80:83], v[64:67], v[128:131]
  s_add_u32 s16, s16, s17
  s_cmp_eq_u32 s16, 65536
  s_cselect_b32 s23, s18, s17
  v_mfma_f32_16x16x32_bf16 v[136:139], v[80:83], v[68:71], v[136:139]
  s_cselect_b32 s16, 0, s16
  v_add_u32 v4, s23, v4
  v_add_u32_e64 v5, s23, v5
  v_mfma_f32_16x16x32_bf16 v[144:147], v[80:83], v[72:75], v[144:147]
  s_add_u32 s19, s19, s20
  s_cmp_eq_u32 s19, 81920
  s_cselect_b32 s23, s21, s20
  v_mfma_f32_16x16x32_bf16 v[152:155], v[80:83], v[76:79], v[152:155]
  s_cselect_b32 s19, 0, s19
  v_add_u32 v6, s23, v6
  v_add_u32_e64 v7, s23, v7
  v_mfma_f32_16x16x32_bf16 v[132:135], v[84:87], v[64:67], v[132:135]
  v_mfma_f32_16x16x32_bf16 v[140:143], v[84:87], v[68:71], v[140:143]
  v_mfma_f32_16x16x32_bf16 v[148:151], v[84:87], v[72:75], v[148:151]
  s_waitcnt lgkmcnt(0)
  v_mfma_f32_16x16x32_bf16 v[156:159], v[84:87], v[76:79], v[156:159]
  s_barrier
  v_mfma_f32_16x16x32_bf16 v[128:131], v[112:115], v[96:99], v[128:131]
  ds_read_b64_tr_b16 v[48:49], v6 offset:0
  ds_read_b64_tr_b16 v[50:51], v6 offset:2048
  v_mfma_f32_16x16x32_bf16 v[136:139], v[112:115], v[100:103], v[136:139]
  ds_read_b128 v[32:35], v4 offset:0
  ds_read_b128 v[36:39], v4 offset:2048
  v_mfma_f32_16x16x32_bf16 v[144:147], v[112:115], v[104:107], v[144:147]
  ds_read_b128 v[40:43], v4 offset:4096
  ds_read_b128 v[44:47], v4 offset:6144
  v_mfma_f32_16x16x32_bf16 v[152:155], v[112:115], v[108:111], v[152:155]
  ds_read_b64_tr_b16 v[52:53], v7 offset:0
  ds_read_b64_tr_b16 v[54:55], v7 offset:2048
  v_mfma_f32_16x16x32_bf16 v[132:135], v[116:119], v[96:99], v[132:135]
  ds_read_b64_tr_b16 v[80:81], v6 offset:4096
  ds_read_b64_tr_b16 v[82:83], v6 offset:6144
  v_mfma_f32_16x16x32_bf16 v[140:143], v[116:119], v[100:103], v[140:143]
  ds_read_b128 v[64:67], v5 offset:0
  ds_read_b128 v[68:71], v5 offset:2048
  v_mfma_f32_16x16x32_bf16 v[148:151], v[116:119], v[104:107], v[148:151]
  ds_read_b128 v[72:75], v5 offset:4096
  ds_read_b128 v[76:79], v5 offset:6144
  v_mfma_f32_16x16x32_bf16 v[156:159], v[116:119], v[108:111], v[156:159]
  ds_read_b64_tr_b16 v[84:85], v7 offset:4096
  ds_read_b64_tr_b16 v[86:87], v7 offset:6144
  v_mfma_f32_16x16x32_bf16 v[128:131], v[208:211], v[192:195], v[128:131]
  s_add_u32 s16, s16, s17
  s_cmp_eq_u32 s16, 65536
  s_cselect_b32 s23, s18, s17
  v_mfma_f32_16x16x32_bf16 v[136:139], v[208:211], v[196:199], v[136:139]
  s_cselect_b32 s16, 0, s16
  v_add_u32 v4, s23, v4
  v_add_u32_e64 v5, s23, v5
  v_mfma_f32_16x16x32_bf16 v[144:147], v[208:211], v[200:203], v[144:147]
  s_add_u32 s19, s19, s20
  s_cmp_eq_u32 s19, 81920
  s_cselect_b32 s23, s21, s20
  v_mfma_f32_16x16x32_bf16 v[152:155], v[208:211], v[204:207], v[152:155]
  s_cselect_b32 s19, 0, s19
  v_add_u32 v6, s23, v6
  v_add_u32_e64 v7, s23, v7
  v_mfma_f32_16x16x32_bf16 v[132:135], v[212:215], v[192:195], v[132:135]
  s_sub_u32 s22, s22, 1
  s_cmp_lg_u32 s22, 0
  v_mfma_f32_16x16x32_bf16 v[140:143], v[212:215], v[196:199], v[140:143]
  v_mfma_f32_16x16x32_bf16 v[148:151], v[212:215], v[200:203], v[148:151]
  s_nop 0
  s_waitcnt lgkmcnt(0)
  v_mfma_f32_16x16x32_bf16 v[156:159], v[212:215], v[204:207], v[156:159]
  s_cbranch_scc1 Lk_14
  s_waitcnt lgkmcnt(0)
  v_cvt_pk_bf16_f32 v240, v128, v129
  v_cvt_pk_bf16_f32 v241, v130, v131
  v_cvt_pk_bf16_f32 v242, v132, v133
  v_cvt_pk_bf16_f32 v243, v134, v135
  v_cvt_pk_bf16_f32 v244, v136, v137
  v_cvt_pk_bf16_f32 v245, v138, v139
  v_cvt_pk_bf16_f32 v246, v140, v141
  v_cvt_pk_bf16_f32 v247, v142, v143
  v_cvt_pk_bf16_f32 v248, v144, v145
  v_cvt_pk_bf16_f32 v249, v146, v147
  v_cvt_pk_bf16_f32 v250, v148, v149
  v_cvt_pk_bf16_f32 v251, v150, v151
  v_cvt_pk_bf16_f32 v252, v152, v153
  v_cvt_pk_bf16_f32 v253, v154, v155
  v_cvt_pk_bf16_f32 v254, v156, v157
  v_cvt_pk_bf16_f32 v255, v158, v159
  s_lshl_b32 s4, s76, 4
  s_add_u32 s4, s4, s78
  s_lshl_b32 s6, s4, Lz1-Lz0+14
  s_add_u32 s6, s6, 7340032
  s_add_u32 s7, s6, 4096
  s_lshl_b32 s5, s78, Lz1-Lz0+1
  buffer_store_dwordx4 v[240:243], v0, s[40:43], s6 offen offset:0 sc0 sc1
  buffer_store_dwordx4 v[244:247], v0, s[40:43], s6 offen offset:2048 sc0 sc1
  buffer_store_dwordx4 v[248:251], v0, s[40:43], s7 offen offset:0 sc0 sc1
  buffer_store_dwordx4 v[252:255], v0, s[40:43], s7 offen offset:2048 sc0 sc1
  v_mov_b32 v40, 0x3f803f80
  v_dot2_f32_bf16 v32, v240, v40, 0
  v_dot2_f32_bf16 v36, v240, v240, 0
  v_dot2_f32_bf16 v33, v244, v40, 0
  v_dot2_f32_bf16 v37, v244, v244, 0
  v_dot2_f32_bf16 v34, v248, v40, 0
  v_dot2_f32_bf16 v38, v248, v248, 0
  v_dot2_f32_bf16 v35, v252, v40, 0
  v_dot2_f32_bf16 v39, v252, v252, 0
  v_dot2_f32_bf16 v32, v241, v40, v32
  v_dot2_f32_bf16 v36, v241, v241, v36
  v_dot2_f32_bf16 v33, v245, v40, v33
  v_dot2_f32_bf16 v37, v245, v245, v37
  v_dot2_f32_bf16 v34, v249, v40, v34
  v_dot2_f32_bf16 v38, v249, v249, v38
  v_dot2_f32_bf16 v35, v253, v40, v35
  v_dot2_f32_bf16 v39, v253, v253, v39
  v_dot2_f32_bf16 v32, v242, v40, v32
  v_dot2_f32_bf16 v36, v242, v242, v36
  v_dot2_f32_bf16 v33, v246, v40, v33
  v_dot2_f32_bf16 v37, v246, v246, v37
  v_dot2_f32_bf16 v34, v250, v40, v34
  v_dot2_f32_bf16 v38, v250, v250, v38
  v_dot2_f32_bf16 v35, v254, v40, v35
  v_dot2_f32_bf16 v39, v254, v254, v39
  v_dot2_f32_bf16 v32, v243, v40, v32
  v_dot2_f32_bf16 v36, v243, v243, v36
  v_dot2_f32_bf16 v33, v247, v40, v33
  v_dot2_f32_bf16 v37, v247, v247, v37
  v_dot2_f32_bf16 v34, v251, v40, v34
  v_dot2_f32_bf16 v38, v251, v251, v38
  v_dot2_f32_bf16 v35, v255, v40, v35
  v_dot2_f32_bf16 v39, v255, v255, v39
  s_lshl_b32 s6, s76, Lz1-Lz0+9
  s_lshl_b32 s7, s85, 8
  s_add_u32 s6, s6, s7
  s_add_u32 s6, s6, s5
  s_add_u32 s6, s6, s86
  s_lshl_b32 s6, s6, 6
  s_add_u32 s6, s6, s83
  s_add_u32 s6, s6, 31457280
  v_permlane32_swap_b32 v32, v34
  v_permlane32_swap_b32 v33, v35
  v_permlane32_swap_b32 v36, v38
  v_permlane32_swap_b32 v37, v39
  v_add_f32 v32, v32, v34
  v_add_f32 v33, v33, v35
  v_add_f32 v36, v36, v38
  v_add_f32 v37, v37, v39
  v_permlane16_swap_b32 v32, v33
  s_nop 0
  v_permlane16_swap_b32 v36, v37
  v_add_f32 v42, v32, v33
  v_add_f32_e64 v43, v36, v37
  buffer_store_dwordx2 v[42:43], v30, s[40:43], s6 offen sc0 sc1
  ds_write_b128 v0, v[240:243] offset:0
  ds_write_b128 v0, v[244:247] offset:2048
  ds_write_b128 v0, v[248:251] offset:4096
  ds_write_b128 v0, v[252:255] offset:6144
  s_add_u32 s5, s87, 4
  s_sub_u32 s4, s78, s77
  s_lshl_b32 s4, s4, 7
  s_add_u32 s5, s5, s4
  s_waitcnt vmcnt(0)
  s_mov_b64 exec, 1
  ds_add_rtn_u32 v2, v28, v27 offset:0
  s_waitcnt lgkmcnt(0)
  v_readfirstlane_b32 s4, v2
  s_and_b32 s4, s4, Lz1-Lz0+3
  s_cmp_lg_u32 s4, 3
  s_cbranch_scc1 Ls_15
  s_mov_b32 exec_lo, 0xffff
  buffer_store_dword v27, v24, s[40:43], s5 offen sc0 sc1
Ls_15:
  s_mov_b64 exec, -1
  s_mov_b32 s16, 0
  s_mov_b32 s17, 16384
  s_mov_b32 s18, 0xffff4000
  s_mov_b32 s19, Lz1-Lz0+0
  s_mov_b32 s20, 28672
  s_mov_b32 s21, 0xffff2000
  s_mul_i32 s4, s85, 8192
  v_add_u32_e64 v4, s4, v11
  v_add_u32 v5, 1024, v4
  s_mul_i32 s4, s86, 6
  s_add_u32 s4, s4, 0
  s_lshr_b32 s5, s4, 2
  s_lshl_b32 s5, s5, 13
  s_and_b32 s4, s4, 3
  v_xor_b32 v2, s4, v26
  v_lshl_add_u32 v6, v2, 5, v25
  v_add_u32 v6, s5, v6
  s_mul_i32 s4, s86, 6
  s_add_u32 s4, s4, 1
  s_lshr_b32 s5, s4, 2
  s_lshl_b32 s5, s5, 13
  s_and_b32 s4, s4, 3
  v_xor_b32_e64 v2, s4, v26
  v_lshl_add_u32 v7, v2, 5, v25
  v_add_u32 v7, s5, v7
  s_mul_i32 s4, s86, 6
  s_add_u32 s4, s4, 2
  s_lshr_b32 s5, s4, 2
  s_lshl_b32 s5, s5, 13
  s_and_b32 s4, s4, 3
  v_xor_b32_e64 v2, s4, v26
  v_lshl_add_u32 v8, v2, 5, v25
  v_add_u32 v8, s5, v8
  s_mul_i32 s4, s86, 6
  s_add_u32 s4, s4, 3
  s_lshr_b32 s5, s4, 2
  s_lshl_b32 s5, s5, 13
  s_and_b32 s4, s4, 3
  v_xor_b32_e64 v2, s4, v26
  v_lshl_add_u32 v9, v2, 5, v25
  v_add_u32 v9, s5, v9
  v_lshrrev_b32 v2, 2, v1
  v_lshlrev_b32 v3, 6, v2
  v_and_b32 v2, 3, v1
  v_lshl_add_u32 v3, v2, 3, v3
  v_bfe_u32 v2, v1, 4, 1
  v_xor_b32_e64 v2, s86, v2
  v_lshl_add_u32 v3, v2, 5, v3
  v_add_u32 v10, 90112, v3
  v_mov_b64 v[128:129], 0
  v_mov_b64 v[130:131], 0
  v_mov_b64 v[132:133], 0
  v_mov_b64 v[134:135], 0
  v_mov_b64 v[136:137], 0
  v_mov_b64 v[138:139], 0
  v_mov_b64 v[140:141], 0
  v_mov_b64 v[142:143], 0
  v_mov_b64 v[144:145], 0
  v_mov_b64 v[146:147], 0
  v_mov_b64 v[148:149], 0
  v_mov_b64 v[150:151], 0
  v_mov_b64 v[152:153], 0
  v_mov_b64 v[154:155], 0
  v_mov_b64 v[156:157], 0
  v_mov_b64 v[158:159], 0
  v_mov_b64 v[160:161], 0
  v_mov_b64 v[162:163], 0
  v_mov_b64 v[164:165], 0
  v_mov_b64 v[166:167], 0
  v_mov_b64 v[168:169], 0
  v_mov_b64 v[170:171], 0
  v_mov_b64 v[172:173], 0
  v_mov_b64 v[174:175], 0
  v_mov_b64 v[176:177], 0
  v_mov_b64 v[178:179], 0
  v_mov_b64 v[180:181], 0
  v_mov_b64 v[182:183], 0
  v_mov_b64 v[184:185], 0
  v_mov_b64 v[186:187], 0
  v_mov_b64 v[188:189], 0
  v_mov_b64 v[190:191], 0
  v_mov_b64 v[192:193], 0
  v_mov_b64 v[194:195], 0
  v_mov_b64 v[196:197], 0
  v_mov_b64 v[198:199], 0
  v_mov_b64 v[200:201], 0
  v_mov_b64 v[202:203], 0
  v_mov_b64 v[204:205], 0
  v_mov_b64 v[206:207], 0
  v_mov_b64 v[208:209], 0
  v_mov_b64 v[210:211], 0
  v_mov_b64 v[212:213], 0
  v_mov_b64 v[214:215], 0
  v_mov_b64 v[216:217], 0
  v_mov_b64 v[218:219], 0
  v_mov_b64 v[220:221], 0
  v_mov_b64 v[222:223], 0
  v_mov_b64 v[224:225], 0
  v_mov_b64 v[226:227], 0
  v_mov_b64 v[228:229], 0
  v_mov_b64 v[230:231], 0
  v_mov_b64 v[232:233], 0
  v_mov_b64 v[234:235], 0
  v_mov_b64 v[236:237], 0
  v_mov_b64 v[238:239], 0
  s_mov_b32 s22, 16
  s_mov_b64 vcc, -1
  s_waitcnt lgkmcnt(0)
  s_barrier
  s_branch Lo_16
Lo_17:
  s_mov_b64 vcc, 0
  s_waitcnt lgkmcnt(0)
  s_barrier
Lo_16:
  ds_read_b64_tr_b16 v[48:49], v6 offset:0
  ds_read_b64_tr_b16 v[50:51], v6 offset:2048
  ds_read_b128 v[32:35], v4 offset:0
  ds_read_b128 v[36:39], v4 offset:2048
  ds_read_b128 v[40:43], v4 offset:4096
  ds_read_b128 v[44:47], v4 offset:6144
  ds_read_b64_tr_b16 v[52:53], v7 offset:0
  ds_read_b64_tr_b16 v[54:55], v7 offset:2048
  ds_read_b64_tr_b16 v[56:57], v8 offset:0
  ds_read_b64_tr_b16 v[58:59], v8 offset:2048
  ds_read_b64_tr_b16 v[60:61], v9 offset:0
  ds_read_b64_tr_b16 v[62:63], v9 offset:2048
  ds_read_b64_tr_b16 v[64:65], v6 offset:8192
  ds_read_b64_tr_b16 v[66:67], v6 offset:10240
  ds_read_b64_tr_b16 v[68:69], v7 offset:8192
  ds_read_b64_tr_b16 v[70:71], v7 offset:10240
  ds_read_b64_tr_b16 v[72:73], v10 offset:0
  ds_read_b64_tr_b16 v[74:75], v10 offset:1024
Lk_19:
  s_nop 0
  s_waitcnt lgkmcnt(0)
  v_mfma_f32_16x16x32_bf16 v[128:131], v[48:51], v[32:35], v[128:131]
  ds_read_b64_tr_b16 v[92:93], v6 offset:4096
  v_mfma_f32_16x16x32_bf16 v[132:135], v[48:51], v[36:39], v[132:135]
  ds_read_b64_tr_b16 v[94:95], v6 offset:6144
  v_mfma_f32_16x16x32_bf16 v[136:139], v[48:51], v[40:43], v[136:139]
  ds_read_b128 v[76:79], v5 offset:0
  v_mfma_f32_16x16x32_bf16 v[140:143], v[48:51], v[44:47], v[140:143]
  ds_read_b128 v[80:83], v5 offset:2048
  v_mfma_f32_16x16x32_bf16 v[144:147], v[52:55], v[32:35], v[144:147]
  ds_read_b128 v[84:87], v5 offset:4096
  v_mfma_f32_16x16x32_bf16 v[148:151], v[52:55], v[36:39], v[148:151]
  ds_read_b128 v[88:91], v5 offset:6144
  v_mfma_f32_16x16x32_bf16 v[152:155], v[52:55], v[40:43], v[152:155]
  ds_read_b64_tr_b16 v[96:97], v7 offset:4096
  v_mfma_f32_16x16x32_bf16 v[156:159], v[52:55], v[44:47], v[156:159]
  ds_read_b64_tr_b16 v[98:99], v7 offset:6144
  v_mfma_f32_16x16x32_bf16 v[160:163], v[56:59], v[32:35], v[160:163]
  ds_read_b64_tr_b16 v[100:101], v8 offset:4096
  v_mfma_f32_16x16x32_bf16 v[164:167], v[56:59], v[36:39], v[164:167]
  ds_read_b64_tr_b16 v[102:103], v8 offset:6144
  v_mfma_f32_16x16x32_bf16 v[168:171], v[56:59], v[40:43], v[168:171]
  ds_read_b64_tr_b16 v[104:105], v9 offset:4096
  v_mfma_f32_16x16x32_bf16 v[172:175], v[56:59], v[44:47], v[172:175]
  ds_read_b64_tr_b16 v[106:107], v9 offset:6144
  v_mfma_f32_16x16x32_bf16 v[176:179], v[60:63], v[32:35], v[176:179]
  ds_read_b64_tr_b16 v[108:109], v6 offset:12288
  v_mfma_f32_16x16x32_bf16 v[180:183], v[60:63], v[36:39], v[180:183]
  ds_read_b64_tr_b16 v[110:111], v6 offset:14336
  v_mfma_f32_16x16x32_bf16 v[184:187], v[60:63], v[40:43], v[184:187]
  ds_read_b64_tr_b16 v[112:113], v7 offset:12288
  v_mfma_f32_16x16x32_bf16 v[188:191], v[60:63], v[44:47], v[188:191]
  ds_read_b64_tr_b16 v[114:115], v7 offset:14336
  v_mfma_f32_16x16x32_bf16 v[192:195], v[64:67], v[32:35], v[192:195]
  ds_read_b64_tr_b16 v[116:117], v10 offset:2048
  v_mfma_f32_16x16x32_bf16 v[196:199], v[64:67], v[36:39], v[196:199]
  ds_read_b64_tr_b16 v[118:119], v10 offset:3072
  v_mfma_f32_16x16x32_bf16 v[200:203], v[64:67], v[40:43], v[200:203]
  s_add_u32 s16, s16, s17
  s_cmp_eq_u32 s16, 65536
  s_cselect_b32 s23, s18, s17
  v_mfma_f32_16x16x32_bf16 v[204:207], v[64:67], v[44:47], v[204:207]
  s_cselect_b32 s16, 0, s16
  v_add_u32 v4, s23, v4
  v_add_u32_e64 v5, s23, v5
  v_mfma_f32_16x16x32_bf16 v[208:211], v[68:71], v[32:35], v[208:211]
  s_add_u32 s19, s19, s20
  s_cmp_eq_u32 s19, 86016
  s_cselect_b32 s23, s21, s20
  v_mfma_f32_16x16x32_bf16 v[212:215], v[68:71], v[36:39], v[212:215]
  s_cselect_b32 s19, 0, s19
  v_add_u32 v6, s23, v6
  v_add_u32_e64 v7, s23, v7
  v_mfma_f32_16x16x32_bf16 v[216:219], v[68:71], v[40:43], v[216:219]
  v_add_u32 v8, s23, v8
  v_add_u32 v9, s23, v9
  v_add_u32_e64 v10, s23, v10
  v_mfma_f32_16x16x32_bf16 v[220:223], v[68:71], v[44:47], v[220:223]
  v_mfma_f32_16x16x32_bf16 v[224:227], v[72:75], v[32:35], v[224:227]
  v_mfma_f32_16x16x32_bf16 v[228:231], v[72:75], v[36:39], v[228:231]
  v_mfma_f32_16x16x32_bf16 v[232:235], v[72:75], v[40:43], v[232:235]
  v_mfma_f32_16x16x32_bf16 v[236:239], v[72:75], v[44:47], v[236:239]
  s_waitcnt lgkmcnt(0)
  s_cbranch_vccnz Lo_18
  s_nop 0
  s_barrier
Lo_18:
  v_mfma_f32_16x16x32_bf16 v[128:131], v[92:95], v[76:79], v[128:131]
  ds_read_b64_tr_b16 v[48:49], v6 offset:0
  v_mfma_f32_16x16x32_bf16 v[132:135], v[92:95], v[80:83], v[132:135]
  ds_read_b64_tr_b16 v[50:51], v6 offset:2048
  v_mfma_f32_16x16x32_bf16 v[136:139], v[92:95], v[84:87], v[136:139]
  ds_read_b128 v[32:35], v4 offset:0
  v_mfma_f32_16x16x32_bf16 v[140:143], v[92:95], v[88:91], v[140:143]
  ds_read_b128 v[36:39], v4 offset:2048
  v_mfma_f32_16x16x32_bf16 v[144:147], v[96:99], v[76:79], v[144:147]
  ds_read_b128 v[40:43], v4 offset:4096
  v_mfma_f32_16x16x32_bf16 v[148:151], v[96:99], v[80:83], v[148:151]
  ds_read_b128 v[44:47], v4 offset:6144
  v_mfma_f32_16x16x32_bf16 v[152:155], v[96:99], v[84:87], v[152:155]
  ds_read_b64_tr_b16 v[52:53], v7 offset:0
  v_mfma_f32_16x16x32_bf16 v[156:159], v[96:99], v[88:91], v[156:159]
  ds_read_b64_tr_b16 v[54:55], v7 offset:2048
  v_mfma_f32_16x16x32_bf16 v[160:163], v[100:103], v[76:79], v[160:163]
  ds_read_b64_tr_b16 v[56:57], v8 offset:0
  v_mfma_f32_16x16x32_bf16 v[164:167], v[100:103], v[80:83], v[164:167]
  ds_read_b64_tr_b16 v[58:59], v8 offset:2048
  v_mfma_f32_16x16x32_bf16 v[168:171], v[100:103], v[84:87], v[168:171]
  ds_read_b64_tr_b16 v[60:61], v9 offset:0
  v_mfma_f32_16x16x32_bf16 v[172:175], v[100:103], v[88:91], v[172:175]
  ds_read_b64_tr_b16 v[62:63], v9 offset:2048
  v_mfma_f32_16x16x32_bf16 v[176:179], v[104:107], v[76:79], v[176:179]
  ds_read_b64_tr_b16 v[64:65], v6 offset:8192
  v_mfma_f32_16x16x32_bf16 v[180:183], v[104:107], v[80:83], v[180:183]
  ds_read_b64_tr_b16 v[66:67], v6 offset:10240
  v_mfma_f32_16x16x32_bf16 v[184:187], v[104:107], v[84:87], v[184:187]
  ds_read_b64_tr_b16 v[68:69], v7 offset:8192
  v_mfma_f32_16x16x32_bf16 v[188:191], v[104:107], v[88:91], v[188:191]
  ds_read_b64_tr_b16 v[70:71], v7 offset:10240
  v_mfma_f32_16x16x32_bf16 v[192:195], v[108:111], v[76:79], v[192:195]
  ds_read_b64_tr_b16 v[72:73], v10 offset:0
  v_mfma_f32_16x16x32_bf16 v[196:199], v[108:111], v[80:83], v[196:199]
  ds_read_b64_tr_b16 v[74:75], v10 offset:1024
  v_mfma_f32_16x16x32_bf16 v[200:203], v[108:111], v[84:87], v[200:203]
  s_sub_u32 s22, s22, Lz1-Lz0+1
  v_mfma_f32_16x16x32_bf16 v[204:207], v[108:111], v[88:91], v[204:207]
  s_cmp_lg_u32 s22, Lz1-Lz0+0
  v_mfma_f32_16x16x32_bf16 v[208:211], v[112:115], v[76:79], v[208:211]
  v_mfma_f32_16x16x32_bf16 v[212:215], v[112:115], v[80:83], v[212:215]
  v_mfma_f32_16x16x32_bf16 v[216:219], v[112:115], v[84:87], v[216:219]
  v_mfma_f32_16x16x32_bf16 v[220:223], v[112:115], v[88:91], v[220:223]
  v_mfma_f32_16x16x32_bf16 v[224:227], v[116:119], v[76:79], v[224:227]
  v_mfma_f32_16x16x32_bf16 v[228:231], v[116:119], v[80:83], v[228:231]
  v_mfma_f32_16x16x32_bf16 v[232:235], v[116:119], v[84:87], v[232:235]
  v_mfma_f32_16x16x32_bf16 v[236:239], v[116:119], v[88:91], v[236:239]
  s_cbranch_vccnz Lo_17
  s_cbranch_scc1 Lk_19
  s_nop 0
  s_waitcnt lgkmcnt(0)
  s_mul_i32 s4, s85, 320
  s_add_u32 s4, s4, 151552
  v_and_b32_e64 v2, 15, v1
  v_lshl_add_u32 v3, v2, 2, s4
  ds_read2_b32 v[88:89], v3 offset0:0 offset1:160
  ds_read2_b32 v[90:91], v3 offset0:16 offset1:176
  ds_read2_b32 v[92:93], v3 offset0:32 offset1:192
  ds_read2_b32 v[94:95], v3 offset0:48 offset1:208
  s_mul_i32 s5, s86, 384
  s_add_u32 s5, s5, 154112
  v_add_u32 v3, s5, v29
  s_lshl_b32 s5, s86, 6
  s_add_u32 s5, s5, 154880
  v_add_u32_e64 v2, s5, v29
  ds_read_b128 v[32:35], v3 offset:0
  ds_read_b128 v[36:39], v3 offset:1024
  ds_read_b128 v[40:43], v3 offset:64
  ds_read_b128 v[44:47], v3 offset:1088
  ds_read_b128 v[80:83], v2 offset:0
  ds_read_b128 v[84:87], v2 offset:1024
  ds_read_b128 v[48:51], v3 offset:128
  ds_read_b128 v[52:55], v3 offset:1152
  ds_read_b128 v[56:59], v3 offset:192
  ds_read_b128 v[60:63], v3 offset:1216
  v_mov_b32 v96, 0x409d30fc
  v_mov_b32 v97, 0x3eeff558
  v_and_b32_e64 v2, 32, v1
  v_mad_u32_u24 v98, v2, 48, v11
  s_mul_i32 s4, s76, 56
  s_mul_i32 s5, s79, 28
  s_add_u32 s4, s4, s5
  s_add_u32 s6, s4, s80
  s_lshl_b32 s6, s6, Lz1-Lz0+14
  s_add_u32 s6, s6, 11599872
  s_add_u32 s7, s6, 4096
  s_lshr_b32 s5, s80, 1
  s_add_u32 s4, s4, s5
  s_lshl_b32 s4, s4, 1
  s_add_u32 s4, s4, s85
  s_lshl_b32 s4, s4, Lz1-Lz0+3
  s_and_b32 s5, s80, 1
  s_add_u32 s4, s4, s5
  s_lshl_b32 s4, s4, 1
  s_add_u32 s4, s4, s86
  s_lshl_b32 s8, s4, 9
  s_add_u32 s8, s8, 11534336
  s_waitcnt lgkmcnt(6)
  ds_read_b128 v[64:67], v3 offset:256
  ds_read_b128 v[68:71], v3 offset:1280
  ds_read_b128 v[72:75], v3 offset:320
  ds_read_b128 v[76:79], v3 offset:1344
  v_pk_mul_f32 v[88:89], v[88:89], v[96:97] op_sel:[0,1] op_sel_hi:[1,1]
  v_pk_mul_f32 v[90:91], v[90:91], v[96:97] op_sel:[0,1] op_sel_hi:[1,1]
  v_pk_mul_f32 v[92:93], v[92:93], v[96:97] op_sel:[0,1] op_sel_hi:[1,1]
  v_pk_mul_f32 v[94:95], v[94:95], v[96:97] op_sel:[0,1] op_sel_hi:[1,1]
  s_lshl_b32 s4, s79, Lz1-Lz0+3
  s_lshl_b32 s10, 0xff, s4
  v_pk_fma_f32 v[100:101], v[32:33], v[88:89], v[36:37] op_sel:[0,1,0] op_sel_hi:[1,1,1] neg_lo:[0,1,0] neg_hi:[0,1,0]
  v_pk_fma_f32 v[102:103], v[34:35], v[88:89], v[38:39] op_sel:[0,1,0] op_sel_hi:[1,1,1] neg_lo:[0,1,0] neg_hi:[0,1,0]
  v_pk_fma_f32 v[104:105], v[40:41], v[88:89], v[44:45] op_sel:[0,1,0] op_sel_hi:[1,1,1] neg_lo:[0,1,0] neg_hi:[0,1,0]
  v_pk_fma_f32 v[106:107], v[42:43], v[88:89], v[46:47] op_sel:[0,1,0] op_sel_hi:[1,1,1] neg_lo:[0,1,0] neg_hi:[0,1,0]
  v_pk_fma_f32 v[128:129], v[128:129], v[88:89], v[100:101] op_sel:[0,0,0] op_sel_hi:[1,0,1]
  v_pk_fma_f32 v[130:131], v[130:131], v[88:89], v[102:103] op_sel:[0,0,0] op_sel_hi:[1,0,1]
  v_pk_fma_f32 v[144:145], v[144:145], v[88:89], v[104:105] op_sel:[0,0,0] op_sel_hi:[1,0,1]
  v_pk_fma_f32 v[146:147], v[146:147], v[88:89], v[106:107] op_sel:[0,0,0] op_sel_hi:[1,0,1]
  v_pk_fma_f32 v[100:101], v[128:129], v[128:129], v[96:97] op_sel_hi:[1,1,0]
  v_pk_fma_f32 v[102:103], v[130:131], v[130:131], v[96:97] op_sel_hi:[1,1,0]
  v_pk_fma_f32 v[104:105], v[144:145], v[144:145], v[96:97] op_sel_hi:[1,1,0]
  v_pk_fma_f32 v[106:107], v[146:147], v[146:147], v[96:97] op_sel_hi:[1,1,0]
  v_pk_mul_f32 v[100:101], v[100:101], v[128:129] neg_lo:[0,1] neg_hi:[0,1]
  v_pk_mul_f32 v[102:103], v[102:103], v[130:131] neg_lo:[0,1] neg_hi:[0,1]
  v_pk_mul_f32 v[104:105], v[104:105], v[144:145] neg_lo:[0,1] neg_hi:[0,1]
  v_pk_mul_f32 v[106:107], v[106:107], v[146:147] neg_lo:[0,1] neg_hi:[0,1]
  v_exp_f32 v100, v100
  v_exp_f32 v101, v101
  v_exp_f32 v102, v102
  v_exp_f32 v103, v103
  v_exp_f32 v104, v104
  v_exp_f32 v105, v105
  v_exp_f32 v106, v106
  v_exp_f32 v107, v107
  v_pk_fma_f32 v[100:101], v[100:101], v[96:97], v[96:97] op_sel:[0,1,1] op_sel_hi:[1,1,1]
  v_pk_fma_f32 v[102:103], v[102:103], v[96:97], v[96:97] op_sel:[0,1,1] op_sel_hi:[1,1,1]
  v_pk_fma_f32 v[104:105], v[104:105], v[96:97], v[96:97] op_sel:[0,1,1] op_sel_hi:[1,1,1]
  v_pk_fma_f32 v[106:107], v[106:107], v[96:97], v[96:97] op_sel:[0,1,1] op_sel_hi:[1,1,1]
  v_rcp_f32 v100, v100
  v_rcp_f32 v101, v101
  v_rcp_f32 v102, v102
  v_rcp_f32 v103, v103
  v_rcp_f32 v104, v104
  v_rcp_f32 v105, v105
  v_rcp_f32 v106, v106
  v_rcp_f32 v107, v107
  v_pk_mul_f32 v[128:129], v[128:129], v[100:101]
  v_pk_mul_f32 v[130:131], v[130:131], v[102:103]
  v_pk_mul_f32 v[144:145], v[144:145], v[104:105]
  v_pk_mul_f32 v[146:147], v[146:147], v[106:107]
  v_cvt_pk_bf16_f32 v116, v128, v129
  v_cvt_pk_bf16_f32 v117, v130, v131
  v_cvt_pk_bf16_f32 v118, v144, v145
  v_cvt_pk_bf16_f32 v119, v146, v147
  buffer_store_dwordx4 v[116:119], v0, s[40:43], s6 offen offset:0 sc0 sc1
  ds_write_b128 v0, v[116:119] offset:0
  v_pk_fma_f32 v[100:101], v[32:33], v[90:91], v[36:37] op_sel:[0,1,0] op_sel_hi:[1,1,1] neg_lo:[0,1,0] neg_hi:[0,1,0]
  v_pk_fma_f32 v[102:103], v[34:35], v[90:91], v[38:39] op_sel:[0,1,0] op_sel_hi:[1,1,1] neg_lo:[0,1,0] neg_hi:[0,1,0]
  v_pk_fma_f32 v[104:105], v[40:41], v[90:91], v[44:45] op_sel:[0,1,0] op_sel_hi:[1,1,1] neg_lo:[0,1,0] neg_hi:[0,1,0]
  v_pk_fma_f32 v[106:107], v[42:43], v[90:91], v[46:47] op_sel:[0,1,0] op_sel_hi:[1,1,1] neg_lo:[0,1,0] neg_hi:[0,1,0]
  v_pk_fma_f32 v[132:133], v[132:133], v[90:91], v[100:101] op_sel:[0,0,0] op_sel_hi:[1,0,1]
  v_pk_fma_f32 v[134:135], v[134:135], v[90:91], v[102:103] op_sel:[0,0,0] op_sel_hi:[1,0,1]
  v_pk_fma_f32 v[148:149], v[148:149], v[90:91], v[104:105] op_sel:[0,0,0] op_sel_hi:[1,0,1]
  v_pk_fma_f32 v[150:151], v[150:151], v[90:91], v[106:107] op_sel:[0,0,0] op_sel_hi:[1,0,1]
  v_pk_fma_f32 v[100:101], v[132:133], v[132:133], v[96:97] op_sel_hi:[1,1,0]
  v_pk_fma_f32 v[102:103], v[134:135], v[134:135], v[96:97] op_sel_hi:[1,1,0]
  v_pk_fma_f32 v[104:105], v[148:149], v[148:149], v[96:97] op_sel_hi:[1,1,0]
  v_pk_fma_f32 v[106:107], v[150:151], v[150:151], v[96:97] op_sel_hi:[1,1,0]
  v_pk_mul_f32 v[100:101], v[100:101], v[132:133] neg_lo:[0,1] neg_hi:[0,1]
  v_pk_mul_f32 v[102:103], v[102:103], v[134:135] neg_lo:[0,1] neg_hi:[0,1]
  v_pk_mul_f32 v[104:105], v[104:105], v[148:149] neg_lo:[0,1] neg_hi:[0,1]
  v_pk_mul_f32 v[106:107], v[106:107], v[150:151] neg_lo:[0,1] neg_hi:[0,1]
  v_exp_f32 v100, v100
  v_exp_f32 v101, v101
  v_exp_f32 v102, v102
  v_exp_f32 v103, v103
  v_exp_f32 v104, v104
  v_exp_f32 v105, v105
  v_exp_f32 v106, v106
  v_exp_f32 v107, v107
  v_pk_fma_f32 v[100:101], v[100:101], v[96:97], v[96:97] op_sel:[0,1,1] op_sel_hi:[1,1,1]
  v_pk_fma_f32 v[102:103], v[102:103], v[96:97], v[96:97] op_sel:[0,1,1] op_sel_hi:[1,1,1]
  v_pk_fma_f32 v[104:105], v[104:105], v[96:97], v[96:97] op_sel:[0,1,1] op_sel_hi:[1,1,1]
  v_pk_fma_f32 v[106:107], v[106:107], v[96:97], v[96:97] op_sel:[0,1,1] op_sel_hi:[1,1,1]
  v_rcp_f32 v100, v100
  v_rcp_f32 v101, v101
  v_rcp_f32 v102, v102
  v_rcp_f32 v103, v103
  v_rcp_f32 v104, v104
  v_rcp_f32 v105, v105
  v_rcp_f32 v106, v106
  v_rcp_f32 v107, v107
  v_pk_mul_f32 v[132:133], v[132:133], v[100:101]
  v_pk_mul_f32 v[134:135], v[134:135], v[102:103]
  v_pk_mul_f32 v[148:149], v[148:149], v[104:105]
  v_pk_mul_f32 v[150:151], v[150:151], v[106:107]
  v_cvt_pk_bf16_f32 v120, v132, v133
  v_cvt_pk_bf16_f32 v121, v134, v135
  v_cvt_pk_bf16_f32 v122, v148, v149
  v_cvt_pk_bf16_f32 v123, v150, v151
  buffer_store_dwordx4 v[120:123], v0, s[40:43], s6 offen offset:2048 sc0 sc1
  ds_write_b128 v0, v[120:123] offset:2048
  s_add_u32 s6, s6, 0x20000
  v_pk_fma_f32 v[100:101], v[32:33], v[92:93], v[36:37] op_sel:[0,1,0] op_sel_hi:[1,1,1] neg_lo:[0,1,0] neg_hi:[0,1,0]
  v_pk_fma_f32 v[102:103], v[34:35], v[92:93], v[38:39] op_sel:[0,1,0] op_sel_hi:[1,1,1] neg_lo:[0,1,0] neg_hi:[0,1,0]
  v_pk_fma_f32 v[104:105], v[40:41], v[92:93], v[44:45] op_sel:[0,1,0] op_sel_hi:[1,1,1] neg_lo:[0,1,0] neg_hi:[0,1,0]
  v_pk_fma_f32 v[106:107], v[42:43], v[92:93], v[46:47] op_sel:[0,1,0] op_sel_hi:[1,1,1] neg_lo:[0,1,0] neg_hi:[0,1,0]
  v_pk_fma_f32 v[136:137], v[136:137], v[92:93], v[100:101] op_sel:[0,0,0] op_sel_hi:[1,0,1]
  v_pk_fma_f32 v[138:139], v[138:139], v[92:93], v[102:103] op_sel:[0,0,0] op_sel_hi:[1,0,1]
  v_pk_fma_f32 v[152:153], v[152:153], v[92:93], v[104:105] op_sel:[0,0,0] op_sel_hi:[1,0,1]
  v_pk_fma_f32 v[154:155], v[154:155], v[92:93], v[106:107] op_sel:[0,0,0] op_sel_hi:[1,0,1]
  v_pk_fma_f32 v[100:101], v[136:137], v[136:137], v[96:97] op_sel_hi:[1,1,0]
  v_pk_fma_f32 v[102:103], v[138:139], v[138:139], v[96:97] op_sel_hi:[1,1,0]
  v_pk_fma_f32 v[104:105], v[152:153], v[152:153], v[96:97] op_sel_hi:[1,1,0]
  v_pk_fma_f32 v[106:107], v[154:155], v[154:155], v[96:97] op_sel_hi:[1,1,0]
  v_pk_mul_f32 v[100:101], v[100:101], v[136:137] neg_lo:[0,1] neg_hi:[0,1]
  v_pk_mul_f32 v[102:103], v[102:103], v[138:139] neg_lo:[0,1] neg_hi:[0,1]
  v_pk_mul_f32 v[104:105], v[104:105], v[152:153] neg_lo:[0,1] neg_hi:[0,1]
  v_pk_mul_f32 v[106:107], v[106:107], v[154:155] neg_lo:[0,1] neg_hi:[0,1]
  v_exp_f32 v100, v100
  v_exp_f32 v101, v101
  v_exp_f32 v102, v102
  v_exp_f32 v103, v103
  v_exp_f32 v104, v104
  v_exp_f32 v105, v105
  v_exp_f32 v106, v106
  v_exp_f32 v107, v107
  v_pk_fma_f32 v[100:101], v[100:101], v[96:97], v[96:97] op_sel:[0,1,1] op_sel_hi:[1,1,1]
  v_pk_fma_f32 v[102:103], v[102:103], v[96:97], v[96:97] op_sel:[0,1,1] op_sel_hi:[1,1,1]
  v_pk_fma_f32 v[104:105], v[104:105], v[96:97], v[96:97] op_sel:[0,1,1] op_sel_hi:[1,1,1]
  v_pk_fma_f32 v[106:107], v[106:107], v[96:97], v[96:97] op_sel:[0,1,1] op_sel_hi:[1,1,1]
  v_rcp_f32 v100, v100
  v_rcp_f32 v101, v101
  v_rcp_f32 v102, v102
  v_rcp_f32 v103, v103
  v_rcp_f32 v104, v104
  v_rcp_f32 v105, v105
  v_rcp_f32 v106, v106
  v_rcp_f32 v107, v107
  v_pk_mul_f32 v[136:137], v[136:137], v[100:101]
  v_pk_mul_f32 v[138:139], v[138:139], v[102:103]
  v_pk_mul_f32 v[152:153], v[152:153], v[104:105]
  v_pk_mul_f32 v[154:155], v[154:155], v[106:107]
  v_cvt_pk_bf16_f32 v116, v136, v137
  v_cvt_pk_bf16_f32 v117, v138, v139
  v_cvt_pk_bf16_f32 v118, v152, v153
  v_cvt_pk_bf16_f32 v119, v154, v155
  buffer_store_dwordx4 v[116:119], v0, s[40:43], s7 offen offset:0 sc0 sc1
  ds_write_b128 v0, v[116:119] offset:4096
  v_pk_fma_f32 v[100:101], v[32:33], v[94:95], v[36:37] op_sel:[0,1,0] op_sel_hi:[1,1,1] neg_lo:[0,1,0] neg_hi:[0,1,0]
  v_pk_fma_f32 v[102:103], v[34:35], v[94:95], v[38:39] op_sel:[0,1,0] op_sel_hi:[1,1,1] neg_lo:[0,1,0] neg_hi:[0,1,0]
  v_pk_fma_f32 v[104:105], v[40:41], v[94:95], v[44:45] op_sel:[0,1,0] op_sel_hi:[1,1,1] neg_lo:[0,1,0] neg_hi:[0,1,0]
  v_pk_fma_f32 v[106:107], v[42:43], v[94:95], v[46:47] op_sel:[0,1,0] op_sel_hi:[1,1,1] neg_lo:[0,1,0] neg_hi:[0,1,0]
  v_pk_fma_f32 v[140:141], v[140:141], v[94:95], v[100:101] op_sel:[0,0,0] op_sel_hi:[1,0,1]
  v_pk_fma_f32 v[142:143], v[142:143], v[94:95], v[102:103] op_sel:[0,0,0] op_sel_hi:[1,0,1]
  v_pk_fma_f32 v[156:157], v[156:157], v[94:95], v[104:105] op_sel:[0,0,0] op_sel_hi:[1,0,1]
  v_pk_fma_f32 v[158:159], v[158:159], v[94:95], v[106:107] op_sel:[0,0,0] op_sel_hi:[1,0,1]
  v_pk_fma_f32 v[100:101], v[140:141], v[140:141], v[96:97] op_sel_hi:[1,1,0]
  v_pk_fma_f32 v[102:103], v[142:143], v[142:143], v[96:97] op_sel_hi:[1,1,0]
  v_pk_fma_f32 v[104:105], v[156:157], v[156:157], v[96:97] op_sel_hi:[1,1,0]
  v_pk_fma_f32 v[106:107], v[158:159], v[158:159], v[96:97] op_sel_hi:[1,1,0]
  v_pk_mul_f32 v[100:101], v[100:101], v[140:141] neg_lo:[0,1] neg_hi:[0,1]
  v_pk_mul_f32 v[102:103], v[102:103], v[142:143] neg_lo:[0,1] neg_hi:[0,1]
  v_pk_mul_f32 v[104:105], v[104:105], v[156:157] neg_lo:[0,1] neg_hi:[0,1]
  v_pk_mul_f32 v[106:107], v[106:107], v[158:159] neg_lo:[0,1] neg_hi:[0,1]
  v_exp_f32 v100, v100
  v_exp_f32 v101, v101
  v_exp_f32 v102, v102
  v_exp_f32 v103, v103
  v_exp_f32 v104, v104
  v_exp_f32 v105, v105
  v_exp_f32 v106, v106
  v_exp_f32 v107, v107
  v_pk_fma_f32 v[100:101], v[100:101], v[96:97], v[96:97] op_sel:[0,1,1] op_sel_hi:[1,1,1]
  v_pk_fma_f32 v[102:103], v[102:103], v[96:97], v[96:97] op_sel:[0,1,1] op_sel_hi:[1,1,1]
  v_pk_fma_f32 v[104:105], v[104:105], v[96:97], v[96:97] op_sel:[0,1,1] op_sel_hi:[1,1,1]
  v_pk_fma_f32 v[106:107], v[106:107], v[96:97], v[96:97] op_sel:[0,1,1] op_sel_hi:[1,1,1]
  v_rcp_f32 v100, v100
  v_rcp_f32 v101, v101
  v_rcp_f32 v102, v102
  v_rcp_f32 v103, v103
  v_rcp_f32 v104, v104
  v_rcp_f32 v105, v105
  v_rcp_f32 v106, v106
  v_rcp_f32 v107, v107
  v_pk_mul_f32 v[140:141], v[140:141], v[100:101]
  v_pk_mul_f32 v[142:143], v[142:143], v[102:103]
  v_pk_mul_f32 v[156:157], v[156:157], v[104:105]
  v_pk_mul_f32 v[158:159], v[158:159], v[106:107]
  v_cvt_pk_bf16_f32 v120, v140, v141
  v_cvt_pk_bf16_f32 v121, v142, v143
  v_cvt_pk_bf16_f32 v122, v156, v157
  v_cvt_pk_bf16_f32 v123, v158, v159
  buffer_store_dwordx4 v[120:123], v0, s[40:43], s7 offen offset:2048 sc0 sc1
  ds_write_b128 v0, v[120:123] offset:6144
  s_add_u32 s7, s7, 0x20000
  s_nop 0
  s_waitcnt lgkmcnt(0)
  v_pk_fma_f32 v[100:101], v[80:81], v[88:89], v[84:85] op_sel:[0,1,0] op_sel_hi:[1,1,1] neg_lo:[0,1,0] neg_hi:[0,1,0]
  v_pk_fma_f32 v[102:103], v[82:83], v[88:89], v[86:87] op_sel:[0,1,0] op_sel_hi:[1,1,1] neg_lo:[0,1,0] neg_hi:[0,1,0]
  v_pk_fma_f32 v[104:105], v[80:81], v[90:91], v[84:85] op_sel:[0,1,0] op_sel_hi:[1,1,1] neg_lo:[0,1,0] neg_hi:[0,1,0]
  v_pk_fma_f32 v[106:107], v[82:83], v[90:91], v[86:87] op_sel:[0,1,0] op_sel_hi:[1,1,1] neg_lo:[0,1,0] neg_hi:[0,1,0]
  v_pk_fma_f32 v[224:225], v[224:225], v[88:89], v[100:101] op_sel:[0,0,0] op_sel_hi:[1,0,1]
  v_pk_fma_f32 v[226:227], v[226:227], v[88:89], v[102:103] op_sel:[0,0,0] op_sel_hi:[1,0,1]
  v_pk_fma_f32 v[228:229], v[228:229], v[90:91], v[104:105] op_sel:[0,0,0] op_sel_hi:[1,0,1]
  v_pk_fma_f32 v[230:231], v[230:231], v[90:91], v[106:107] op_sel:[0,0,0] op_sel_hi:[1,0,1]
  v_pk_fma_f32 v[100:101], v[224:225], v[224:225], v[96:97] op_sel_hi:[1,1,0]
  v_pk_fma_f32 v[102:103], v[226:227], v[226:227], v[96:97] op_sel_hi:[1,1,0]
  v_pk_fma_f32 v[104:105], v[228:229], v[228:229], v[96:97] op_sel_hi:[1,1,0]
  v_pk_fma_f32 v[106:107], v[230:231], v[230:231], v[96:97] op_sel_hi:[1,1,0]
  v_pk_mul_f32 v[100:101], v[100:101], v[224:225] neg_lo:[0,1] neg_hi:[0,1]
  v_pk_mul_f32 v[102:103], v[102:103], v[226:227] neg_lo:[0,1] neg_hi:[0,1]
  v_pk_mul_f32 v[104:105], v[104:105], v[228:229] neg_lo:[0,1] neg_hi:[0,1]
  v_pk_mul_f32 v[106:107], v[106:107], v[230:231] neg_lo:[0,1] neg_hi:[0,1]
  v_exp_f32 v100, v100
  v_exp_f32 v101, v101
  v_exp_f32 v102, v102
  v_exp_f32 v103, v103
  v_exp_f32 v104, v104
  v_exp_f32 v105, v105
  v_exp_f32 v106, v106
  v_exp_f32 v107, v107
  v_pk_fma_f32 v[100:101], v[100:101], v[96:97], v[96:97] op_sel:[0,1,1] op_sel_hi:[1,1,1]
  v_pk_fma_f32 v[102:103], v[102:103], v[96:97], v[96:97] op_sel:[0,1,1] op_sel_hi:[1,1,1]
  v_pk_fma_f32 v[104:105], v[104:105], v[96:97], v[96:97] op_sel:[0,1,1] op_sel_hi:[1,1,1]
  v_pk_fma_f32 v[106:107], v[106:107], v[96:97], v[96:97] op_sel:[0,1,1] op_sel_hi:[1,1,1]
  v_rcp_f32 v100, v100
  v_rcp_f32 v101, v101
  v_rcp_f32 v102, v102
  v_rcp_f32 v103, v103
  v_rcp_f32 v104, v104
  v_rcp_f32 v105, v105
  v_rcp_f32 v106, v106
  v_rcp_f32 v107, v107
  v_pk_mul_f32 v[224:225], v[224:225], v[100:101]
  v_pk_mul_f32 v[226:227], v[226:227], v[102:103]
  v_pk_mul_f32 v[228:229], v[228:229], v[104:105]
  v_pk_mul_f32 v[230:231], v[230:231], v[106:107]
  v_cvt_pk_bf16_f32 v116, v224, v225
  v_cvt_pk_bf16_f32 v117, v226, v227
  v_cvt_pk_bf16_f32 v118, v228, v229
  v_cvt_pk_bf16_f32 v119, v230, v231
  s_nop 0
  v_permlane32_swap_b32 v116, v118
  v_permlane32_swap_b32_e64 v117, v119
  buffer_store_dwordx4 v[116:119], v98, s[40:43], s8 offen sc0 sc1
  s_add_u32 s8, s8, 4096
  v_pk_fma_f32 v[100:101], v[80:81], v[92:93], v[84:85] op_sel:[0,1,0] op_sel_hi:[1,1,1] neg_lo:[0,1,0] neg_hi:[0,1,0]
  v_pk_fma_f32 v[102:103], v[82:83], v[92:93], v[86:87] op_sel:[0,1,0] op_sel_hi:[1,1,1] neg_lo:[0,1,0] neg_hi:[0,1,0]
  v_pk_fma_f32 v[104:105], v[80:81], v[94:95], v[84:85] op_sel:[0,1,0] op_sel_hi:[1,1,1] neg_lo:[0,1,0] neg_hi:[0,1,0]
  v_pk_fma_f32 v[106:107], v[82:83], v[94:95], v[86:87] op_sel:[0,1,0] op_sel_hi:[1,1,1] neg_lo:[0,1,0] neg_hi:[0,1,0]
  v_pk_fma_f32 v[232:233], v[232:233], v[92:93], v[100:101] op_sel:[0,0,0] op_sel_hi:[1,0,1]
  v_pk_fma_f32 v[234:235], v[234:235], v[92:93], v[102:103] op_sel:[0,0,0] op_sel_hi:[1,0,1]
  v_pk_fma_f32 v[236:237], v[236:237], v[94:95], v[104:105] op_sel:[0,0,0] op_sel_hi:[1,0,1]
  v_pk_fma_f32 v[238:239], v[238:239], v[94:95], v[106:107] op_sel:[0,0,0] op_sel_hi:[1,0,1]
  v_pk_fma_f32 v[100:101], v[232:233], v[232:233], v[96:97] op_sel_hi:[1,1,0]
  v_pk_fma_f32 v[102:103], v[234:235], v[234:235], v[96:97] op_sel_hi:[1,1,0]
  v_pk_fma_f32 v[104:105], v[236:237], v[236:237], v[96:97] op_sel_hi:[1,1,0]
  v_pk_fma_f32 v[106:107], v[238:239], v[238:239], v[96:97] op_sel_hi:[1,1,0]
  v_pk_mul_f32 v[100:101], v[100:101], v[232:233] neg_lo:[0,1] neg_hi:[0,1]
  v_pk_mul_f32 v[102:103], v[102:103], v[234:235] neg_lo:[0,1] neg_hi:[0,1]
  v_pk_mul_f32 v[104:105], v[104:105], v[236:237] neg_lo:[0,1] neg_hi:[0,1]
  v_pk_mul_f32 v[106:107], v[106:107], v[238:239] neg_lo:[0,1] neg_hi:[0,1]
  v_exp_f32 v100, v100
  v_exp_f32 v101, v101
  v_exp_f32 v102, v102
  v_exp_f32 v103, v103
  v_exp_f32 v104, v104
  v_exp_f32 v105, v105
  v_exp_f32 v106, v106
  v_exp_f32 v107, v107
  v_pk_fma_f32 v[100:101], v[100:101], v[96:97], v[96:97] op_sel:[0,1,1] op_sel_hi:[1,1,1]
  v_pk_fma_f32 v[102:103], v[102:103], v[96:97], v[96:97] op_sel:[0,1,1] op_sel_hi:[1,1,1]
  v_pk_fma_f32 v[104:105], v[104:105], v[96:97], v[96:97] op_sel:[0,1,1] op_sel_hi:[1,1,1]
  v_pk_fma_f32 v[106:107], v[106:107], v[96:97], v[96:97] op_sel:[0,1,1] op_sel_hi:[1,1,1]
  v_rcp_f32 v100, v100
  v_rcp_f32 v101, v101
  v_rcp_f32 v102, v102
  v_rcp_f32 v103, v103
  v_rcp_f32 v104, v104
  v_rcp_f32 v105, v105
  v_rcp_f32 v106, v106
  v_rcp_f32 v107, v107
  v_pk_mul_f32 v[232:233], v[232:233], v[100:101]
  v_pk_mul_f32 v[234:235], v[234:235], v[102:103]
  v_pk_mul_f32 v[236:237], v[236:237], v[104:105]
  v_pk_mul_f32 v[238:239], v[238:239], v[106:107]
  v_cvt_pk_bf16_f32 v120, v232, v233
  v_cvt_pk_bf16_f32 v121, v234, v235
  v_cvt_pk_bf16_f32 v122, v236, v237
  v_cvt_pk_bf16_f32 v123, v238, v239
  s_add_u32 s9, s87, Lz1-Lz0+8
  s_waitcnt vmcnt(1)
  s_mov_b64 exec, 1
  ds_add_rtn_u32 v124, v28, v27 offset:0
  s_mov_b64 exec, -1
  v_permlane32_swap_b32 v120, v122
  v_permlane32_swap_b32_e64 v121, v123
  buffer_store_dwordx4 v[120:123], v98, s[40:43], s8 offen sc0 sc1
  v_pk_fma_f32 v[100:101], v[48:49], v[88:89], v[52:53] op_sel:[0,1,0] op_sel_hi:[1,1,1] neg_lo:[0,1,0] neg_hi:[0,1,0]
  v_pk_fma_f32 v[102:103], v[50:51], v[88:89], v[54:55] op_sel:[0,1,0] op_sel_hi:[1,1,1] neg_lo:[0,1,0] neg_hi:[0,1,0]
  v_pk_fma_f32 v[104:105], v[56:57], v[88:89], v[60:61] op_sel:[0,1,0] op_sel_hi:[1,1,1] neg_lo:[0,1,0] neg_hi:[0,1,0]
  v_pk_fma_f32 v[106:107], v[58:59], v[88:89], v[62:63] op_sel:[0,1,0] op_sel_hi:[1,1,1] neg_lo:[0,1,0] neg_hi:[0,1,0]
  v_pk_fma_f32 v[160:161], v[160:161], v[88:89], v[100:101] op_sel:[0,0,0] op_sel_hi:[1,0,1]
  v_pk_fma_f32 v[162:163], v[162:163], v[88:89], v[102:103] op_sel:[0,0,0] op_sel_hi:[1,0,1]
  v_pk_fma_f32 v[176:177], v[176:177], v[88:89], v[104:105] op_sel:[0,0,0] op_sel_hi:[1,0,1]
  v_pk_fma_f32 v[178:179], v[178:179], v[88:89], v[106:107] op_sel:[0,0,0] op_sel_hi:[1,0,1]
  v_pk_fma_f32 v[100:101], v[160:161], v[160:161], v[96:97] op_sel_hi:[1,1,0]
  v_pk_fma_f32 v[102:103], v[162:163], v[162:163], v[96:97] op_sel_hi:[1,1,0]
  v_pk_fma_f32 v[104:105], v[176:177], v[176:177], v[96:97] op_sel_hi:[1,1,0]
  v_pk_fma_f32 v[106:107], v[178:179], v[178:179], v[96:97] op_sel_hi:[1,1,0]
  v_pk_mul_f32 v[100:101], v[100:101], v[160:161] neg_lo:[0,1] neg_hi:[0,1]
  v_pk_mul_f32 v[102:103], v[102:103], v[162:163] neg_lo:[0,1] neg_hi:[0,1]
  v_pk_mul_f32 v[104:105], v[104:105], v[176:177] neg_lo:[0,1] neg_hi:[0,1]
  v_pk_mul_f32 v[106:107], v[106:107], v[178:179] neg_lo:[0,1] neg_hi:[0,1]
  v_exp_f32 v100, v100
  v_exp_f32 v101, v101
  v_exp_f32 v102, v102
  v_exp_f32 v103, v103
  v_exp_f32 v104, v104
  v_exp_f32 v105, v105
  v_exp_f32 v106, v106
  v_exp_f32 v107, v107
  v_pk_fma_f32 v[100:101], v[100:101], v[96:97], v[96:97] op_sel:[0,1,1] op_sel_hi:[1,1,1]
  v_pk_fma_f32 v[102:103], v[102:103], v[96:97], v[96:97] op_sel:[0,1,1] op_sel_hi:[1,1,1]
  v_pk_fma_f32 v[104:105], v[104:105], v[96:97], v[96:97] op_sel:[0,1,1] op_sel_hi:[1,1,1]
  v_pk_fma_f32 v[106:107], v[106:107], v[96:97], v[96:97] op_sel:[0,1,1] op_sel_hi:[1,1,1]
  v_rcp_f32 v100, v100
  v_rcp_f32 v101, v101
  v_rcp_f32 v102, v102
  v_rcp_f32 v103, v103
  v_rcp_f32 v104, v104
  v_rcp_f32 v105, v105
  v_rcp_f32 v106, v106
  v_rcp_f32 v107, v107
  v_pk_mul_f32 v[160:161], v[160:161], v[100:101]
  v_pk_mul_f32 v[162:163], v[162:163], v[102:103]
  v_pk_mul_f32 v[176:177], v[176:177], v[104:105]
  v_pk_mul_f32 v[178:179], v[178:179], v[106:107]
  v_cvt_pk_bf16_f32 v116, v160, v161
  v_cvt_pk_bf16_f32 v117, v162, v163
  v_cvt_pk_bf16_f32 v118, v176, v177
  v_cvt_pk_bf16_f32 v119, v178, v179
  s_waitcnt lgkmcnt(0)
  v_readfirstlane_b32 s4, v124
  s_and_b32 s4, s4, 3
  s_cmp_lg_u32 s4, 3
  s_cbranch_scc1 Ls_20
  s_mov_b32 exec_lo, s10
  s_mov_b32 exec_hi, 0
  buffer_store_dword v27, v24, s[40:43], s9 offen sc0 sc1
Ls_20:
  s_mov_b64 exec, -1
  buffer_store_dwordx4 v[116:119], v0, s[40:43], s6 offen offset:0 sc0 sc1
  ds_write_b128 v0, v[116:119] offset:16384
  v_pk_fma_f32 v[100:101], v[48:49], v[90:91], v[52:53] op_sel:[0,1,0] op_sel_hi:[1,1,1] neg_lo:[0,1,0] neg_hi:[0,1,0]
  v_pk_fma_f32 v[102:103], v[50:51], v[90:91], v[54:55] op_sel:[0,1,0] op_sel_hi:[1,1,1] neg_lo:[0,1,0] neg_hi:[0,1,0]
  v_pk_fma_f32 v[104:105], v[56:57], v[90:91], v[60:61] op_sel:[0,1,0] op_sel_hi:[1,1,1] neg_lo:[0,1,0] neg_hi:[0,1,0]
  v_pk_fma_f32 v[106:107], v[58:59], v[90:91], v[62:63] op_sel:[0,1,0] op_sel_hi:[1,1,1] neg_lo:[0,1,0] neg_hi:[0,1,0]
  v_pk_fma_f32 v[164:165], v[164:165], v[90:91], v[100:101] op_sel:[0,0,0] op_sel_hi:[1,0,1]
  v_pk_fma_f32 v[166:167], v[166:167], v[90:91], v[102:103] op_sel:[0,0,0] op_sel_hi:[1,0,1]
  v_pk_fma_f32 v[180:181], v[180:181], v[90:91], v[104:105] op_sel:[0,0,0] op_sel_hi:[1,0,1]
  v_pk_fma_f32 v[182:183], v[182:183], v[90:91], v[106:107] op_sel:[0,0,0] op_sel_hi:[1,0,1]
  v_pk_fma_f32 v[100:101], v[164:165], v[164:165], v[96:97] op_sel_hi:[1,1,0]
  v_pk_fma_f32 v[102:103], v[166:167], v[166:167], v[96:97] op_sel_hi:[1,1,0]
  v_pk_fma_f32 v[104:105], v[180:181], v[180:181], v[96:97] op_sel_hi:[1,1,0]
  v_pk_fma_f32 v[106:107], v[182:183], v[182:183], v[96:97] op_sel_hi:[1,1,0]
  v_pk_mul_f32 v[100:101], v[100:101], v[164:165] neg_lo:[0,1] neg_hi:[0,1]
  v_pk_mul_f32 v[102:103], v[102:103], v[166:167] neg_lo:[0,1] neg_hi:[0,1]
  v_pk_mul_f32 v[104:105], v[104:105], v[180:181] neg_lo:[0,1] neg_hi:[0,1]
  v_pk_mul_f32 v[106:107], v[106:107], v[182:183] neg_lo:[0,1] neg_hi:[0,1]
  v_exp_f32 v100, v100
  v_exp_f32 v101, v101
  v_exp_f32 v102, v102
  v_exp_f32 v103, v103
  v_exp_f32 v104, v104
  v_exp_f32 v105, v105
  v_exp_f32 v106, v106
  v_exp_f32 v107, v107
  v_pk_fma_f32 v[100:101], v[100:101], v[96:97], v[96:97] op_sel:[0,1,1] op_sel_hi:[1,1,1]
  v_pk_fma_f32 v[102:103], v[102:103], v[96:97], v[96:97] op_sel:[0,1,1] op_sel_hi:[1,1,1]
  v_pk_fma_f32 v[104:105], v[104:105], v[96:97], v[96:97] op_sel:[0,1,1] op_sel_hi:[1,1,1]
  v_pk_fma_f32 v[106:107], v[106:107], v[96:97], v[96:97] op_sel:[0,1,1] op_sel_hi:[1,1,1]
  v_rcp_f32 v100, v100
  v_rcp_f32 v101, v101
  v_rcp_f32 v102, v102
  v_rcp_f32 v103, v103
  v_rcp_f32 v104, v104
  v_rcp_f32 v105, v105
  v_rcp_f32 v106, v106
  v_rcp_f32 v107, v107
  v_pk_mul_f32 v[164:165], v[164:165], v[100:101]
  v_pk_mul_f32 v[166:167], v[166:167], v[102:103]
  v_pk_mul_f32 v[180:181], v[180:181], v[104:105]
  v_pk_mul_f32 v[182:183], v[182:183], v[106:107]
  v_cvt_pk_bf16_f32 v120, v164, v165
  v_cvt_pk_bf16_f32 v121, v166, v167
  v_cvt_pk_bf16_f32 v122, v180, v181
  v_cvt_pk_bf16_f32 v123, v182, v183
  buffer_store_dwordx4 v[120:123], v0, s[40:43], s6 offen offset:2048 sc0 sc1
  ds_write_b128 v0, v[120:123] offset:18432
  s_add_u32 s6, s6, 0x20000
  v_pk_fma_f32 v[100:101], v[48:49], v[92:93], v[52:53] op_sel:[0,1,0] op_sel_hi:[1,1,1] neg_lo:[0,1,0] neg_hi:[0,1,0]
  v_pk_fma_f32 v[102:103], v[50:51], v[92:93], v[54:55] op_sel:[0,1,0] op_sel_hi:[1,1,1] neg_lo:[0,1,0] neg_hi:[0,1,0]
  v_pk_fma_f32 v[104:105], v[56:57], v[92:93], v[60:61] op_sel:[0,1,0] op_sel_hi:[1,1,1] neg_lo:[0,1,0] neg_hi:[0,1,0]
  v_pk_fma_f32 v[106:107], v[58:59], v[92:93], v[62:63] op_sel:[0,1,0] op_sel_hi:[1,1,1] neg_lo:[0,1,0] neg_hi:[0,1,0]
  v_pk_fma_f32 v[168:169], v[168:169], v[92:93], v[100:101] op_sel:[0,0,0] op_sel_hi:[1,0,1]
  v_pk_fma_f32 v[170:171], v[170:171], v[92:93], v[102:103] op_sel:[0,0,0] op_sel_hi:[1,0,1]
  v_pk_fma_f32 v[184:185], v[184:185], v[92:93], v[104:105] op_sel:[0,0,0] op_sel_hi:[1,0,1]
  v_pk_fma_f32 v[186:187], v[186:187], v[92:93], v[106:107] op_sel:[0,0,0] op_sel_hi:[1,0,1]
  v_pk_fma_f32 v[100:101], v[168:169], v[168:169], v[96:97] op_sel_hi:[1,1,0]
  v_pk_fma_f32 v[102:103], v[170:171], v[170:171], v[96:97] op_sel_hi:[1,1,0]
  v_pk_fma_f32 v[104:105], v[184:185], v[184:185], v[96:97] op_sel_hi:[1,1,0]
  v_pk_fma_f32 v[106:107], v[186:187], v[186:187], v[96:97] op_sel_hi:[1,1,0]
  v_pk_mul_f32 v[100:101], v[100:101], v[168:169] neg_lo:[0,1] neg_hi:[0,1]
  v_pk_mul_f32 v[102:103], v[102:103], v[170:171] neg_lo:[0,1] neg_hi:[0,1]
  v_pk_mul_f32 v[104:105], v[104:105], v[184:185] neg_lo:[0,1] neg_hi:[0,1]
  v_pk_mul_f32 v[106:107], v[106:107], v[186:187] neg_lo:[0,1] neg_hi:[0,1]
  v_exp_f32 v100, v100
  v_exp_f32 v101, v101
  v_exp_f32 v102, v102
  v_exp_f32 v103, v103
  v_exp_f32 v104, v104
  v_exp_f32 v105, v105
  v_exp_f32 v106, v106
  v_exp_f32 v107, v107
  v_pk_fma_f32 v[100:101], v[100:101], v[96:97], v[96:97] op_sel:[0,1,1] op_sel_hi:[1,1,1]
  v_pk_fma_f32 v[102:103], v[102:103], v[96:97], v[96:97] op_sel:[0,1,1] op_sel_hi:[1,1,1]
  v_pk_fma_f32 v[104:105], v[104:105], v[96:97], v[96:97] op_sel:[0,1,1] op_sel_hi:[1,1,1]
  v_pk_fma_f32 v[106:107], v[106:107], v[96:97], v[96:97] op_sel:[0,1,1] op_sel_hi:[1,1,1]
  v_rcp_f32 v100, v100
  v_rcp_f32 v101, v101
  v_rcp_f32 v102, v102
  v_rcp_f32 v103, v103
  v_rcp_f32 v104, v104
  v_rcp_f32 v105, v105
  v_rcp_f32 v106, v106
  v_rcp_f32 v107, v107
  v_pk_mul_f32 v[168:169], v[168:169], v[100:101]
  v_pk_mul_f32 v[170:171], v[170:171], v[102:103]
  v_pk_mul_f32 v[184:185], v[184:185], v[104:105]
  v_pk_mul_f32 v[186:187], v[186:187], v[106:107]
  v_cvt_pk_bf16_f32 v116, v168, v169
  v_cvt_pk_bf16_f32 v117, v170, v171
  v_cvt_pk_bf16_f32 v118, v184, v185
  v_cvt_pk_bf16_f32 v119, v186, v187
  buffer_store_dwordx4 v[116:119], v0, s[40:43], s7 offen offset:0 sc0 sc1
  ds_write_b128 v0, v[116:119] offset:20480
  v_pk_fma_f32 v[100:101], v[48:49], v[94:95], v[52:53] op_sel:[0,1,0] op_sel_hi:[1,1,1] neg_lo:[0,1,0] neg_hi:[0,1,0]
  v_pk_fma_f32 v[102:103], v[50:51], v[94:95], v[54:55] op_sel:[0,1,0] op_sel_hi:[1,1,1] neg_lo:[0,1,0] neg_hi:[0,1,0]
  v_pk_fma_f32 v[104:105], v[56:57], v[94:95], v[60:61] op_sel:[0,1,0] op_sel_hi:[1,1,1] neg_lo:[0,1,0] neg_hi:[0,1,0]
  v_pk_fma_f32 v[106:107], v[58:59], v[94:95], v[62:63] op_sel:[0,1,0] op_sel_hi:[1,1,1] neg_lo:[0,1,0] neg_hi:[0,1,0]
  v_pk_fma_f32 v[172:173], v[172:173], v[94:95], v[100:101] op_sel:[0,0,0] op_sel_hi:[1,0,1]
  v_pk_fma_f32 v[174:175], v[174:175], v[94:95], v[102:103] op_sel:[0,0,0] op_sel_hi:[1,0,1]
  v_pk_fma_f32 v[188:189], v[188:189], v[94:95], v[104:105] op_sel:[0,0,0] op_sel_hi:[1,0,1]
  v_pk_fma_f32 v[190:191], v[190:191], v[94:95], v[106:107] op_sel:[0,0,0] op_sel_hi:[1,0,1]
  v_pk_fma_f32 v[100:101], v[172:173], v[172:173], v[96:97] op_sel_hi:[1,1,0]
  v_pk_fma_f32 v[102:103], v[174:175], v[174:175], v[96:97] op_sel_hi:[1,1,0]
  v_pk_fma_f32 v[104:105], v[188:189], v[188:189], v[96:97] op_sel_hi:[1,1,0]
  v_pk_fma_f32 v[106:107], v[190:191], v[190:191], v[96:97] op_sel_hi:[1,1,0]
  v_pk_mul_f32 v[100:101], v[100:101], v[172:173] neg_lo:[0,1] neg_hi:[0,1]
  v_pk_mul_f32 v[102:103], v[102:103], v[174:175] neg_lo:[0,1] neg_hi:[0,1]
  v_pk_mul_f32 v[104:105], v[104:105], v[188:189] neg_lo:[0,1] neg_hi:[0,1]
  v_pk_mul_f32 v[106:107], v[106:107], v[190:191] neg_lo:[0,1] neg_hi:[0,1]
  v_exp_f32 v100, v100
  v_exp_f32 v101, v101
  v_exp_f32 v102, v102
  v_exp_f32 v103, v103
  v_exp_f32 v104, v104
  v_exp_f32 v105, v105
  v_exp_f32 v106, v106
  v_exp_f32 v107, v107
  v_pk_fma_f32 v[100:101], v[100:101], v[96:97], v[96:97] op_sel:[0,1,1] op_sel_hi:[1,1,1]
  v_pk_fma_f32 v[102:103], v[102:103], v[96:97], v[96:97] op_sel:[0,1,1] op_sel_hi:[1,1,1]
  v_pk_fma_f32 v[104:105], v[104:105], v[96:97], v[96:97] op_sel:[0,1,1] op_sel_hi:[1,1,1]
  v_pk_fma_f32 v[106:107], v[106:107], v[96:97], v[96:97] op_sel:[0,1,1] op_sel_hi:[1,1,1]
  v_rcp_f32 v100, v100
  v_rcp_f32 v101, v101
  v_rcp_f32 v102, v102
  v_rcp_f32 v103, v103
  v_rcp_f32 v104, v104
  v_rcp_f32 v105, v105
  v_rcp_f32 v106, v106
  v_rcp_f32 v107, v107
  v_pk_mul_f32 v[172:173], v[172:173], v[100:101]
  v_pk_mul_f32 v[174:175], v[174:175], v[102:103]
  v_pk_mul_f32 v[188:189], v[188:189], v[104:105]
  v_pk_mul_f32 v[190:191], v[190:191], v[106:107]
  v_cvt_pk_bf16_f32 v120, v172, v173
  v_cvt_pk_bf16_f32 v121, v174, v175
  v_cvt_pk_bf16_f32 v122, v188, v189
  v_cvt_pk_bf16_f32 v123, v190, v191
  buffer_store_dwordx4 v[120:123], v0, s[40:43], s7 offen offset:2048 sc0 sc1
  ds_write_b128 v0, v[120:123] offset:22528
  s_add_u32 s7, s7, 0x20000
  v_pk_fma_f32 v[100:101], v[64:65], v[88:89], v[68:69] op_sel:[0,1,0] op_sel_hi:[1,1,1] neg_lo:[0,1,0] neg_hi:[0,1,0]
  v_pk_fma_f32 v[102:103], v[66:67], v[88:89], v[70:71] op_sel:[0,1,0] op_sel_hi:[1,1,1] neg_lo:[0,1,0] neg_hi:[0,1,0]
  v_pk_fma_f32 v[104:105], v[72:73], v[88:89], v[76:77] op_sel:[0,1,0] op_sel_hi:[1,1,1] neg_lo:[0,1,0] neg_hi:[0,1,0]
  v_pk_fma_f32 v[106:107], v[74:75], v[88:89], v[78:79] op_sel:[0,1,0] op_sel_hi:[1,1,1] neg_lo:[0,1,0] neg_hi:[0,1,0]
  v_pk_fma_f32 v[192:193], v[192:193], v[88:89], v[100:101] op_sel:[0,0,0] op_sel_hi:[1,0,1]
  v_pk_fma_f32 v[194:195], v[194:195], v[88:89], v[102:103] op_sel:[0,0,0] op_sel_hi:[1,0,1]
  v_pk_fma_f32 v[208:209], v[208:209], v[88:89], v[104:105] op_sel:[0,0,0] op_sel_hi:[1,0,1]
  v_pk_fma_f32 v[210:211], v[210:211], v[88:89], v[106:107] op_sel:[0,0,0] op_sel_hi:[1,0,1]
  v_pk_fma_f32 v[100:101], v[192:193], v[192:193], v[96:97] op_sel_hi:[1,1,0]
  v_pk_fma_f32 v[102:103], v[194:195], v[194:195], v[96:97] op_sel_hi:[1,1,0]
  v_pk_fma_f32 v[104:105], v[208:209], v[208:209], v[96:97] op_sel_hi:[1,1,0]
  v_pk_fma_f32 v[106:107], v[210:211], v[210:211], v[96:97] op_sel_hi:[1,1,0]
  v_pk_mul_f32 v[100:101], v[100:101], v[192:193] neg_lo:[0,1] neg_hi:[0,1]
  v_pk_mul_f32 v[102:103], v[102:103], v[194:195] neg_lo:[0,1] neg_hi:[0,1]
  v_pk_mul_f32 v[104:105], v[104:105], v[208:209] neg_lo:[0,1] neg_hi:[0,1]
  v_pk_mul_f32 v[106:107], v[106:107], v[210:211] neg_lo:[0,1] neg_hi:[0,1]
  v_exp_f32 v100, v100
  v_exp_f32 v101, v101
  v_exp_f32 v102, v102
  v_exp_f32 v103, v103
  v_exp_f32 v104, v104
  v_exp_f32 v105, v105
  v_exp_f32 v106, v106
  v_exp_f32 v107, v107
  v_pk_fma_f32 v[100:101], v[100:101], v[96:97], v[96:97] op_sel:[0,1,1] op_sel_hi:[1,1,1]
  v_pk_fma_f32 v[102:103], v[102:103], v[96:97], v[96:97] op_sel:[0,1,1] op_sel_hi:[1,1,1]
  v_pk_fma_f32 v[104:105], v[104:105], v[96:97], v[96:97] op_sel:[0,1,1] op_sel_hi:[1,1,1]
  v_pk_fma_f32 v[106:107], v[106:107], v[96:97], v[96:97] op_sel:[0,1,1] op_sel_hi:[1,1,1]
  v_rcp_f32 v100, v100
  v_rcp_f32 v101, v101
  v_rcp_f32 v102, v102
  v_rcp_f32 v103, v103
  v_rcp_f32 v104, v104
  v_rcp_f32 v105, v105
  v_rcp_f32 v106, v106
  v_rcp_f32 v107, v107
  v_pk_mul_f32 v[192:193], v[192:193], v[100:101]
  v_pk_mul_f32 v[194:195], v[194:195], v[102:103]
  v_pk_mul_f32 v[208:209], v[208:209], v[104:105]
  v_pk_mul_f32 v[210:211], v[210:211], v[106:107]
  v_cvt_pk_bf16_f32 v116, v192, v193
  v_cvt_pk_bf16_f32 v117, v194, v195
  v_cvt_pk_bf16_f32 v118, v208, v209
  v_cvt_pk_bf16_f32 v119, v210, v211
  buffer_store_dwordx4 v[116:119], v0, s[40:43], s6 offen offset:0 sc0 sc1
  ds_write_b128 v0, v[116:119] offset:32768
  v_pk_fma_f32 v[100:101], v[64:65], v[90:91], v[68:69] op_sel:[0,1,0] op_sel_hi:[1,1,1] neg_lo:[0,1,0] neg_hi:[0,1,0]
  v_pk_fma_f32 v[102:103], v[66:67], v[90:91], v[70:71] op_sel:[0,1,0] op_sel_hi:[1,1,1] neg_lo:[0,1,0] neg_hi:[0,1,0]
  v_pk_fma_f32 v[104:105], v[72:73], v[90:91], v[76:77] op_sel:[0,1,0] op_sel_hi:[1,1,1] neg_lo:[0,1,0] neg_hi:[0,1,0]
  v_pk_fma_f32 v[106:107], v[74:75], v[90:91], v[78:79] op_sel:[0,1,0] op_sel_hi:[1,1,1] neg_lo:[0,1,0] neg_hi:[0,1,0]
  v_pk_fma_f32 v[196:197], v[196:197], v[90:91], v[100:101] op_sel:[0,0,0] op_sel_hi:[1,0,1]
  v_pk_fma_f32 v[198:199], v[198:199], v[90:91], v[102:103] op_sel:[0,0,0] op_sel_hi:[1,0,1]
  v_pk_fma_f32 v[212:213], v[212:213], v[90:91], v[104:105] op_sel:[0,0,0] op_sel_hi:[1,0,1]
  v_pk_fma_f32 v[214:215], v[214:215], v[90:91], v[106:107] op_sel:[0,0,0] op_sel_hi:[1,0,1]
  v_pk_fma_f32 v[100:101], v[196:197], v[196:197], v[96:97] op_sel_hi:[1,1,0]
  v_pk_fma_f32 v[102:103], v[198:199], v[198:199], v[96:97] op_sel_hi:[1,1,0]
  v_pk_fma_f32 v[104:105], v[212:213], v[212:213], v[96:97] op_sel_hi:[1,1,0]
  v_pk_fma_f32 v[106:107], v[214:215], v[214:215], v[96:97] op_sel_hi:[1,1,0]
  v_pk_mul_f32 v[100:101], v[100:101], v[196:197] neg_lo:[0,1] neg_hi:[0,1]
  v_pk_mul_f32 v[102:103], v[102:103], v[198:199] neg_lo:[0,1] neg_hi:[0,1]
  v_pk_mul_f32 v[104:105], v[104:105], v[212:213] neg_lo:[0,1] neg_hi:[0,1]
  v_pk_mul_f32 v[106:107], v[106:107], v[214:215] neg_lo:[0,1] neg_hi:[0,1]
  v_exp_f32 v100, v100
  v_exp_f32 v101, v101
  v_exp_f32 v102, v102
  v_exp_f32 v103, v103
  v_exp_f32 v104, v104
  v_exp_f32 v105, v105
  v_exp_f32 v106, v106
  v_exp_f32 v107, v107
  v_pk_fma_f32 v[100:101], v[100:101], v[96:97], v[96:97] op_sel:[0,1,1] op_sel_hi:[1,1,1]
  v_pk_fma_f32 v[102:103], v[102:103], v[96:97], v[96:97] op_sel:[0,1,1] op_sel_hi:[1,1,1]
  v_pk_fma_f32 v[104:105], v[104:105], v[96:97], v[96:97] op_sel:[0,1,1] op_sel_hi:[1,1,1]
  v_pk_fma_f32 v[106:107], v[106:107], v[96:97], v[96:97] op_sel:[0,1,1] op_sel_hi:[1,1,1]
  v_rcp_f32 v100, v100
  v_rcp_f32 v101, v101
  v_rcp_f32 v102, v102
  v_rcp_f32 v103, v103
  v_rcp_f32 v104, v104
  v_rcp_f32 v105, v105
  v_rcp_f32 v106, v106
  v_rcp_f32 v107, v107
  v_pk_mul_f32 v[196:197], v[196:197], v[100:101]
  v_pk_mul_f32 v[198:199], v[198:199], v[102:103]
  v_pk_mul_f32 v[212:213], v[212:213], v[104:105]
  v_pk_mul_f32 v[214:215], v[214:215], v[106:107]
  v_cvt_pk_bf16_f32 v120, v196, v197
  v_cvt_pk_bf16_f32 v121, v198, v199
  v_cvt_pk_bf16_f32 v122, v212, v213
  v_cvt_pk_bf16_f32 v123, v214, v215
  buffer_store_dwordx4 v[120:123], v0, s[40:43], s6 offen offset:2048 sc0 sc1
  ds_write_b128 v0, v[120:123] offset:34816
  v_pk_fma_f32 v[100:101], v[64:65], v[92:93], v[68:69] op_sel:[0,1,0] op_sel_hi:[1,1,1] neg_lo:[0,1,0] neg_hi:[0,1,0]
  v_pk_fma_f32 v[102:103], v[66:67], v[92:93], v[70:71] op_sel:[0,1,0] op_sel_hi:[1,1,1] neg_lo:[0,1,0] neg_hi:[0,1,0]
  v_pk_fma_f32 v[104:105], v[72:73], v[92:93], v[76:77] op_sel:[0,1,0] op_sel_hi:[1,1,1] neg_lo:[0,1,0] neg_hi:[0,1,0]
  v_pk_fma_f32 v[106:107], v[74:75], v[92:93], v[78:79] op_sel:[0,1,0] op_sel_hi:[1,1,1] neg_lo:[0,1,0] neg_hi:[0,1,0]
  v_pk_fma_f32 v[200:201], v[200:201], v[92:93], v[100:101] op_sel:[0,0,0] op_sel_hi:[1,0,1]
  v_pk_fma_f32 v[202:203], v[202:203], v[92:93], v[102:103] op_sel:[0,0,0] op_sel_hi:[1,0,1]
  v_pk_fma_f32 v[216:217], v[216:217], v[92:93], v[104:105] op_sel:[0,0,0] op_sel_hi:[1,0,1]
  v_pk_fma_f32 v[218:219], v[218:219], v[92:93], v[106:107] op_sel:[0,0,0] op_sel_hi:[1,0,1]
  v_pk_fma_f32 v[100:101], v[200:201], v[200:201], v[96:97] op_sel_hi:[1,1,0]
  v_pk_fma_f32 v[102:103], v[202:203], v[202:203], v[96:97] op_sel_hi:[1,1,0]
  v_pk_fma_f32 v[104:105], v[216:217], v[216:217], v[96:97] op_sel_hi:[1,1,0]
  v_pk_fma_f32 v[106:107], v[218:219], v[218:219], v[96:97] op_sel_hi:[1,1,0]
  v_pk_mul_f32 v[100:101], v[100:101], v[200:201] neg_lo:[0,1] neg_hi:[0,1]
  v_pk_mul_f32 v[102:103], v[102:103], v[202:203] neg_lo:[0,1] neg_hi:[0,1]
  v_pk_mul_f32 v[104:105], v[104:105], v[216:217] neg_lo:[0,1] neg_hi:[0,1]
  v_pk_mul_f32 v[106:107], v[106:107], v[218:219] neg_lo:[0,1] neg_hi:[0,1]
  v_exp_f32 v100, v100
  v_exp_f32 v101, v101
  v_exp_f32 v102, v102
  v_exp_f32 v103, v103
  v_exp_f32 v104, v104
  v_exp_f32 v105, v105
  v_exp_f32 v106, v106
  v_exp_f32 v107, v107
  v_pk_fma_f32 v[100:101], v[100:101], v[96:97], v[96:97] op_sel:[0,1,1] op_sel_hi:[1,1,1]
  v_pk_fma_f32 v[102:103], v[102:103], v[96:97], v[96:97] op_sel:[0,1,1] op_sel_hi:[1,1,1]
  v_pk_fma_f32 v[104:105], v[104:105], v[96:97], v[96:97] op_sel:[0,1,1] op_sel_hi:[1,1,1]
  v_pk_fma_f32 v[106:107], v[106:107], v[96:97], v[96:97] op_sel:[0,1,1] op_sel_hi:[1,1,1]
  v_rcp_f32 v100, v100
  v_rcp_f32 v101, v101
  v_rcp_f32 v102, v102
  v_rcp_f32 v103, v103
  v_rcp_f32 v104, v104
  v_rcp_f32 v105, v105
  v_rcp_f32 v106, v106
  v_rcp_f32 v107, v107
  v_pk_mul_f32 v[200:201], v[200:201], v[100:101]
  v_pk_mul_f32 v[202:203], v[202:203], v[102:103]
  v_pk_mul_f32 v[216:217], v[216:217], v[104:105]
  v_pk_mul_f32 v[218:219], v[218:219], v[106:107]
  v_cvt_pk_bf16_f32 v116, v200, v201
  v_cvt_pk_bf16_f32 v117, v202, v203
  v_cvt_pk_bf16_f32 v118, v216, v217
  v_cvt_pk_bf16_f32 v119, v218, v219
  buffer_store_dwordx4 v[116:119], v0, s[40:43], s7 offen offset:0 sc0 sc1
  ds_write_b128 v0, v[116:119] offset:36864
  v_pk_fma_f32 v[100:101], v[64:65], v[94:95], v[68:69] op_sel:[0,1,0] op_sel_hi:[1,1,1] neg_lo:[0,1,0] neg_hi:[0,1,0]
  v_pk_fma_f32 v[102:103], v[66:67], v[94:95], v[70:71] op_sel:[0,1,0] op_sel_hi:[1,1,1] neg_lo:[0,1,0] neg_hi:[0,1,0]
  v_pk_fma_f32 v[104:105], v[72:73], v[94:95], v[76:77] op_sel:[0,1,0] op_sel_hi:[1,1,1] neg_lo:[0,1,0] neg_hi:[0,1,0]
  v_pk_fma_f32 v[106:107], v[74:75], v[94:95], v[78:79] op_sel:[0,1,0] op_sel_hi:[1,1,1] neg_lo:[0,1,0] neg_hi:[0,1,0]
  v_pk_fma_f32 v[204:205], v[204:205], v[94:95], v[100:101] op_sel:[0,0,0] op_sel_hi:[1,0,1]
  v_pk_fma_f32 v[206:207], v[206:207], v[94:95], v[102:103] op_sel:[0,0,0] op_sel_hi:[1,0,1]
  v_pk_fma_f32 v[220:221], v[220:221], v[94:95], v[104:105] op_sel:[0,0,0] op_sel_hi:[1,0,1]
  v_pk_fma_f32 v[222:223], v[222:223], v[94:95], v[106:107] op_sel:[0,0,0] op_sel_hi:[1,0,1]
  v_pk_fma_f32 v[100:101], v[204:205], v[204:205], v[96:97] op_sel_hi:[1,1,0]
  v_pk_fma_f32 v[102:103], v[206:207], v[206:207], v[96:97] op_sel_hi:[1,1,0]
  v_pk_fma_f32 v[104:105], v[220:221], v[220:221], v[96:97] op_sel_hi:[1,1,0]
  v_pk_fma_f32 v[106:107], v[222:223], v[222:223], v[96:97] op_sel_hi:[1,1,0]
  v_pk_mul_f32 v[100:101], v[100:101], v[204:205] neg_lo:[0,1] neg_hi:[0,1]
  v_pk_mul_f32 v[102:103], v[102:103], v[206:207] neg_lo:[0,1] neg_hi:[0,1]
  v_pk_mul_f32 v[104:105], v[104:105], v[220:221] neg_lo:[0,1] neg_hi:[0,1]
  v_pk_mul_f32 v[106:107], v[106:107], v[222:223] neg_lo:[0,1] neg_hi:[0,1]
  v_exp_f32 v100, v100
  v_exp_f32 v101, v101
  v_exp_f32 v102, v102
  v_exp_f32 v103, v103
  v_exp_f32 v104, v104
  v_exp_f32 v105, v105
  v_exp_f32 v106, v106
  v_exp_f32 v107, v107
  v_pk_fma_f32 v[100:101], v[100:101], v[96:97], v[96:97] op_sel:[0,1,1] op_sel_hi:[1,1,1]
  v_pk_fma_f32 v[102:103], v[102:103], v[96:97], v[96:97] op_sel:[0,1,1] op_sel_hi:[1,1,1]
  v_pk_fma_f32 v[104:105], v[104:105], v[96:97], v[96:97] op_sel:[0,1,1] op_sel_hi:[1,1,1]
  v_pk_fma_f32 v[106:107], v[106:107], v[96:97], v[96:97] op_sel:[0,1,1] op_sel_hi:[1,1,1]
  v_rcp_f32 v100, v100
  v_rcp_f32 v101, v101
  v_rcp_f32 v102, v102
  v_rcp_f32 v103, v103
  v_rcp_f32 v104, v104
  v_rcp_f32 v105, v105
  v_rcp_f32 v106, v106
  v_rcp_f32 v107, v107
  v_pk_mul_f32 v[204:205], v[204:205], v[100:101]
  v_pk_mul_f32 v[206:207], v[206:207], v[102:103]
  v_pk_mul_f32 v[220:221], v[220:221], v[104:105]
  v_pk_mul_f32 v[222:223], v[222:223], v[106:107]
  v_cvt_pk_bf16_f32 v120, v204, v205
  v_cvt_pk_bf16_f32 v121, v206, v207
  v_cvt_pk_bf16_f32 v122, v220, v221
  v_cvt_pk_bf16_f32 v123, v222, v223
  buffer_store_dwordx4 v[120:123], v0, s[40:43], s7 offen offset:2048 sc0 sc1
  ds_write_b128 v0, v[120:123] offset:38912
  s_mov_b32 s16, Lz1-Lz0+0
  s_mov_b32 s17, 16384
  s_mov_b32 s18, 0xffff4000
  s_mov_b32 s19, 32768
  s_mov_b32 s20, 16384
  s_mov_b32 s21, 0xffff0000
  s_mul_i32 s4, s85, 8192
  v_add_u32_e64 v4, s4, v11
  v_add_u32 v5, 1024, v4
  s_lshl_b32 s4, s86, 1
  v_xor_b32 v2, s4, v26
  v_lshl_add_u32 v6, v2, 5, v25
  v_add_u32 v6, s19, v6
  s_add_u32 s4, s4, 1
  v_xor_b32_e64 v2, s4, v26
  v_lshl_add_u32 v7, v2, 5, v25
  v_add_u32_e64 v7, s19, v7
  s_mov_b32 s4, 0xffff0000
  v_lshlrev_b32 v128, 16, v240
  v_and_b32 v129, s4, v240
  v_lshlrev_b32 v130, 16, v241
  v_and_b32 v131, s4, v241
  v_lshlrev_b32 v132, 16, v242
  v_and_b32 v133, s4, v242
  v_lshlrev_b32 v134, 16, v243
  v_and_b32 v135, s4, v243
  v_lshlrev_b32 v136, 16, v244
  v_and_b32 v137, s4, v244
  v_lshlrev_b32 v138, 16, v245
  v_and_b32 v139, s4, v245
  v_lshlrev_b32 v140, 16, v246
  v_and_b32 v141, s4, v246
  v_lshlrev_b32 v142, 16, v247
  v_and_b32 v143, s4, v247
  v_lshlrev_b32 v144, 16, v248
  v_and_b32 v145, s4, v248
  v_lshlrev_b32 v146, 16, v249
  v_and_b32 v147, s4, v249
  v_lshlrev_b32 v148, 16, v250
  v_and_b32 v149, s4, v250
  v_lshlrev_b32 v150, 16, v251
  v_and_b32 v151, s4, v251
  v_lshlrev_b32 v152, 16, v252
  v_and_b32 v153, s4, v252
  v_lshlrev_b32 v154, 16, v253
  v_and_b32 v155, s4, v253
  v_lshlrev_b32 v156, 16, v254
  v_and_b32 v157, s4, v254
  v_lshlrev_b32 v158, 16, v255
  v_and_b32 v159, s4, v255
  s_lshl_b32 s5, s86, Lz1-Lz0+7
  s_add_u32 s5, s5, 156160
  v_add_u32_e64 v3, s5, v29
  ds_read_b128 v[32:35], v3
  ds_read_b128 v[36:39], v3 offset:64
  v_mov_b64 v[160:161], 0
  v_mov_b64 v[162:163], 0
  v_mov_b64 v[164:165], 0
  v_mov_b64 v[166:167], 0
  v_mov_b64 v[168:169], 0
  v_mov_b64 v[170:171], 0
  v_mov_b64 v[172:173], 0
  v_mov_b64 v[174:175], 0
  v_mov_b64 v[176:177], 0
  v_mov_b64 v[178:179], 0
  v_mov_b64 v[180:181], 0
  v_mov_b64 v[182:183], 0
  v_mov_b64 v[184:185], 0
  v_mov_b64 v[186:187], 0
  v_mov_b64_e64 v[188:189], 0
  v_mov_b64 v[190:191], 0
  s_waitcnt lgkmcnt(0)
  v_pk_add_f32 v[128:129], v[128:129], v[32:33]
  v_pk_add_f32 v[130:131], v[130:131], v[34:35]
  v_pk_add_f32 v[132:133], v[132:133], v[36:37]
  v_pk_add_f32 v[134:135], v[134:135], v[38:39]
  v_pk_add_f32 v[136:137], v[136:137], v[32:33]
  v_pk_add_f32 v[138:139], v[138:139], v[34:35]
  v_pk_add_f32 v[140:141], v[140:141], v[36:37]
  v_pk_add_f32 v[142:143], v[142:143], v[38:39]
  v_pk_add_f32 v[144:145], v[144:145], v[32:33]
  v_pk_add_f32 v[146:147], v[146:147], v[34:35]
  v_pk_add_f32 v[148:149], v[148:149], v[36:37]
  v_pk_add_f32 v[150:151], v[150:151], v[38:39]
  v_pk_add_f32 v[152:153], v[152:153], v[32:33]
  v_pk_add_f32 v[154:155], v[154:155], v[34:35]
  v_pk_add_f32 v[156:157], v[156:157], v[36:37]
  v_pk_add_f32 v[158:159], v[158:159], v[38:39]
  s_lshl_b32 s8, s84, Lz1-Lz0+3
  s_lshl_b32 s7, s81, 12
  s_add_u32 s8, s8, s7
  s_xor_b32 s6, s8, 131072
  s_add_u32 s6, s6, 26214400
  s_add_u32 s8, s8, 26214400
  s_mov_b32 s22, 12
  s_barrier
  ds_read_b64_tr_b16 v[48:49], v6 offset:0
  ds_read_b64_tr_b16 v[50:51], v6 offset:2048
  ds_read_b128 v[32:35], v4 offset:0
  ds_read_b128 v[36:39], v4 offset:2048
  ds_read_b128 v[40:43], v4 offset:4096
  ds_read_b128 v[44:47], v4 offset:6144
  ds_read_b64_tr_b16 v[52:53], v7 offset:0
  ds_read_b64_tr_b16 v[54:55], v7 offset:2048
  ds_read_b64_tr_b16 v[56:57], v6 offset:8192
  ds_read_b64_tr_b16 v[58:59], v6 offset:10240
  ds_read_b64_tr_b16 v[60:61], v7 offset:8192
  ds_read_b64_tr_b16 v[62:63], v7 offset:10240
  ds_read_b64_tr_b16 v[80:81], v6 offset:4096
  s_nop 0
  s_waitcnt lgkmcnt(4)
  ds_read_b64_tr_b16 v[82:83], v6 offset:6144
  ds_read_b128 v[64:67], v5 offset:0
  ds_read_b128 v[68:71], v5 offset:2048
  ds_read_b128 v[72:75], v5 offset:4096
  ds_read_b128 v[76:79], v5 offset:6144
  ds_read_b64_tr_b16 v[84:85], v7 offset:4096
  ds_read_b64_tr_b16 v[86:87], v7 offset:6144
  ds_read_b64_tr_b16 v[88:89], v6 offset:12288
  ds_read_b64_tr_b16 v[90:91], v6 offset:14336
  ds_read_b64_tr_b16 v[92:93], v7 offset:12288
  ds_read_b64_tr_b16 v[94:95], v7 offset:14336
  s_add_u32 s16, s16, s17
  s_cmp_eq_u32 s16, 65536
  s_cselect_b32 s23, s18, s17
  s_cselect_b32 s16, 0, s16
  v_add_u32 v4, s23, v4
  v_add_u32 v5, s23, v5
  s_add_u32 s19, s19, s20
  s_cmp_eq_u32 s19, 81920
  s_cselect_b32 s23, s21, s20
  s_cselect_b32 s19, 0, s19
  v_add_u32 v6, s23, v6
  v_add_u32 v7, s23, v7
  s_waitcnt lgkmcnt(0)
Lk_21:
  s_barrier
  v_mfma_f32_16x16x32_bf16 v[128:131], v[48:51], v[32:35], v[128:131]
  ds_read_b64_tr_b16 v[112:113], v6 offset:0
  v_mfma_f32_16x16x32_bf16 v[136:139], v[48:51], v[36:39], v[136:139]
  ds_read_b64_tr_b16 v[114:115], v6 offset:2048
  v_mfma_f32_16x16x32_bf16 v[144:147], v[48:51], v[40:43], v[144:147]
  ds_read_b128 v[96:99], v4 offset:0
  v_mfma_f32_16x16x32_bf16 v[152:155], v[48:51], v[44:47], v[152:155]
  ds_read_b128 v[100:103], v4 offset:2048
  v_mfma_f32_16x16x32_bf16 v[132:135], v[52:55], v[32:35], v[132:135]
  ds_read_b128 v[104:107], v4 offset:4096
  v_mfma_f32_16x16x32_bf16 v[140:143], v[52:55], v[36:39], v[140:143]
  ds_read_b128 v[108:111], v4 offset:6144
  v_mfma_f32_16x16x32_bf16 v[148:151], v[52:55], v[40:43], v[148:151]
  ds_read_b64_tr_b16 v[116:117], v7 offset:0
  v_mfma_f32_16x16x32_bf16 v[156:159], v[52:55], v[44:47], v[156:159]
  ds_read_b64_tr_b16 v[118:119], v7 offset:2048
  v_mfma_f32_16x16x32_bf16 v[160:163], v[56:59], v[32:35], v[160:163]
  ds_read_b64_tr_b16 v[120:121], v6 offset:8192
  v_mfma_f32_16x16x32_bf16 v[168:171], v[56:59], v[36:39], v[168:171]
  ds_read_b64_tr_b16 v[122:123], v6 offset:10240
  v_mfma_f32_16x16x32_bf16 v[176:179], v[56:59], v[40:43], v[176:179]
  ds_read_b64_tr_b16 v[124:125], v7 offset:8192
  v_mfma_f32_16x16x32_bf16 v[184:187], v[56:59], v[44:47], v[184:187]
  ds_read_b64_tr_b16 v[126:127], v7 offset:10240
  v_mfma_f32_16x16x32_bf16 v[164:167], v[60:63], v[32:35], v[164:167]
  ds_read_b64_tr_b16 v[208:209], v6 offset:4096
  v_mfma_f32_16x16x32_bf16 v[172:175], v[60:63], v[36:39], v[172:175]
  ds_read_b64_tr_b16 v[210:211], v6 offset:6144
  v_mfma_f32_16x16x32_bf16 v[180:183], v[60:63], v[40:43], v[180:183]
  ds_read_b128 v[192:195], v5 offset:0
  v_mfma_f32_16x16x32_bf16 v[188:191], v[60:63], v[44:47], v[188:191]
  ds_read_b128 v[196:199], v5 offset:2048
  v_mfma_f32_16x16x32_bf16 v[128:131], v[80:83], v[64:67], v[128:131]
  ds_read_b128 v[200:203], v5 offset:4096
  v_mfma_f32_16x16x32_bf16 v[136:139], v[80:83], v[68:71], v[136:139]
  ds_read_b128 v[204:207], v5 offset:6144
  v_mfma_f32_16x16x32_bf16 v[144:147], v[80:83], v[72:75], v[144:147]
  ds_read_b64_tr_b16 v[212:213], v7 offset:4096
  v_mfma_f32_16x16x32_bf16 v[152:155], v[80:83], v[76:79], v[152:155]
  ds_read_b64_tr_b16 v[214:215], v7 offset:6144
  v_mfma_f32_16x16x32_bf16 v[132:135], v[84:87], v[64:67], v[132:135]
  ds_read_b64_tr_b16 v[216:217], v6 offset:12288
  v_mfma_f32_16x16x32_bf16 v[140:143], v[84:87], v[68:71], v[140:143]
  ds_read_b64_tr_b16 v[218:219], v6 offset:14336
  v_mfma_f32_16x16x32_bf16 v[148:151], v[84:87], v[72:75], v[148:151]
  ds_read_b64_tr_b16 v[220:221], v7 offset:12288
  v_mfma_f32_16x16x32_bf16 v[156:159], v[84:87], v[76:79], v[156:159]
  ds_read_b64_tr_b16 v[222:223], v7 offset:14336
  v_mfma_f32_16x16x32_bf16 v[160:163], v[88:91], v[64:67], v[160:163]
  s_add_u32 s16, s16, s17
  s_cmp_eq_u32 s16, 65536
  s_cselect_b32 s23, s18, s17
  v_mfma_f32_16x16x32_bf16 v[168:171], v[88:91], v[68:71], v[168:171]
  s_cselect_b32 s16, 0, s16
  v_add_u32 v4, s23, v4
  v_add_u32_e64 v5, s23, v5
  v_mfma_f32_16x16x32_bf16 v[176:179], v[88:91], v[72:75], v[176:179]
  s_add_u32 s19, s19, s20
  s_cmp_eq_u32 s19, 81920
  s_cselect_b32 s23, s21, s20
  v_mfma_f32_16x16x32_bf16 v[184:187], v[88:91], v[76:79], v[184:187]
  s_cselect_b32 s19, 0, s19
  v_add_u32 v6, s23, v6
  v_add_u32_e64 v7, s23, v7
  v_mfma_f32_16x16x32_bf16 v[164:167], v[92:95], v[64:67], v[164:167]
  v_mfma_f32_16x16x32_bf16 v[172:175], v[92:95], v[68:71], v[172:175]
  v_mfma_f32_16x16x32_bf16 v[180:183], v[92:95], v[72:75], v[180:183]
  s_nop 0
  s_waitcnt lgkmcnt(0)
  v_mfma_f32_16x16x32_bf16 v[188:191], v[92:95], v[76:79], v[188:191]
  s_waitcnt vmcnt(0)
  s_barrier
  v_mfma_f32_16x16x32_bf16 v[128:131], v[112:115], v[96:99], v[128:131]
  ds_read_b64_tr_b16 v[48:49], v6 offset:0
  v_mfma_f32_16x16x32_bf16 v[136:139], v[112:115], v[100:103], v[136:139]
  ds_read_b64_tr_b16 v[50:51], v6 offset:2048
  v_mfma_f32_16x16x32_bf16 v[144:147], v[112:115], v[104:107], v[144:147]
  ds_read_b128 v[32:35], v4 offset:0
  v_mfma_f32_16x16x32_bf16 v[152:155], v[112:115], v[108:111], v[152:155]
  ds_read_b128 v[36:39], v4 offset:2048
  v_mfma_f32_16x16x32_bf16 v[132:135], v[116:119], v[96:99], v[132:135]
  ds_read_b128 v[40:43], v4 offset:4096
  v_mfma_f32_16x16x32_bf16 v[140:143], v[116:119], v[100:103], v[140:143]
  ds_read_b128 v[44:47], v4 offset:6144
  v_mfma_f32_16x16x32_bf16 v[148:151], v[116:119], v[104:107], v[148:151]
  ds_read_b64_tr_b16 v[52:53], v7 offset:0
  v_mfma_f32_16x16x32_bf16 v[156:159], v[116:119], v[108:111], v[156:159]
  ds_read_b64_tr_b16 v[54:55], v7 offset:2048
  v_mfma_f32_16x16x32_bf16 v[160:163], v[120:123], v[96:99], v[160:163]
  ds_read_b64_tr_b16 v[56:57], v6 offset:8192
  v_mfma_f32_16x16x32_bf16 v[168:171], v[120:123], v[100:103], v[168:171]
  ds_read_b64_tr_b16 v[58:59], v6 offset:10240
  v_mfma_f32_16x16x32_bf16 v[176:179], v[120:123], v[104:107], v[176:179]
  ds_read_b64_tr_b16 v[60:61], v7 offset:8192
  v_mfma_f32_16x16x32_bf16 v[184:187], v[120:123], v[108:111], v[184:187]
  ds_read_b64_tr_b16 v[62:63], v7 offset:10240
  v_mfma_f32_16x16x32_bf16 v[164:167], v[124:127], v[96:99], v[164:167]
  ds_read_b64_tr_b16 v[80:81], v6 offset:4096
  v_mfma_f32_16x16x32_bf16 v[172:175], v[124:127], v[100:103], v[172:175]
  ds_read_b64_tr_b16 v[82:83], v6 offset:6144
  v_mfma_f32_16x16x32_bf16 v[180:183], v[124:127], v[104:107], v[180:183]
  ds_read_b128 v[64:67], v5 offset:0
  v_mfma_f32_16x16x32_bf16 v[188:191], v[124:127], v[108:111], v[188:191]
  ds_read_b128 v[68:71], v5 offset:2048
  v_mfma_f32_16x16x32_bf16 v[128:131], v[208:211], v[192:195], v[128:131]
  ds_read_b128 v[72:75], v5 offset:4096
  v_mfma_f32_16x16x32_bf16 v[136:139], v[208:211], v[196:199], v[136:139]
  ds_read_b128 v[76:79], v5 offset:6144
  v_mfma_f32_16x16x32_bf16 v[144:147], v[208:211], v[200:203], v[144:147]
  ds_read_b64_tr_b16 v[84:85], v7 offset:4096
  v_mfma_f32_16x16x32_bf16 v[152:155], v[208:211], v[204:207], v[152:155]
  ds_read_b64_tr_b16 v[86:87], v7 offset:6144
  v_mfma_f32_16x16x32_bf16 v[132:135], v[212:215], v[192:195], v[132:135]
  ds_read_b64_tr_b16 v[88:89], v6 offset:12288
  v_mfma_f32_16x16x32_bf16 v[140:143], v[212:215], v[196:199], v[140:143]
  ds_read_b64_tr_b16 v[90:91], v6 offset:14336
  v_mfma_f32_16x16x32_bf16 v[148:151], v[212:215], v[200:203], v[148:151]
  ds_read_b64_tr_b16 v[92:93], v7 offset:12288
  v_mfma_f32_16x16x32_bf16 v[156:159], v[212:215], v[204:207], v[156:159]
  ds_read_b64_tr_b16 v[94:95], v7 offset:14336
  v_mfma_f32_16x16x32_bf16 v[160:163], v[216:219], v[192:195], v[160:163]
  s_add_u32 s16, s16, s17
  s_cmp_eq_u32 s16, 65536
  s_cselect_b32 s23, s18, s17
  v_mfma_f32_16x16x32_bf16 v[168:171], v[216:219], v[196:199], v[168:171]
  s_cselect_b32 s16, 0, s16
  v_add_u32 v4, s23, v4
  v_add_u32_e64 v5, s23, v5
  v_mfma_f32_16x16x32_bf16 v[176:179], v[216:219], v[200:203], v[176:179]
  s_add_u32 s19, s19, s20
  s_cmp_eq_u32 s19, 81920
  s_cselect_b32 s23, s21, s20
  v_mfma_f32_16x16x32_bf16 v[184:187], v[216:219], v[204:207], v[184:187]
  s_cselect_b32 s19, 0, s19
  v_add_u32 v6, s23, v6
  v_add_u32_e64 v7, s23, v7
  v_mfma_f32_16x16x32_bf16 v[164:167], v[220:223], v[192:195], v[164:167]
  s_sub_u32 s22, s22, 1
  s_cmp_lg_u32 s22, 0
  v_mfma_f32_16x16x32_bf16 v[172:175], v[220:223], v[196:199], v[172:175]
  v_mfma_f32_16x16x32_bf16 v[180:183], v[220:223], v[200:203], v[180:183]
  s_waitcnt lgkmcnt(0)
  v_mfma_f32_16x16x32_bf16 v[188:191], v[220:223], v[204:207], v[188:191]
  s_cbranch_scc1 Lk_21
  v_cvt_pk_bf16_f32 v160, v160, v161
  v_cvt_pk_bf16_f32 v161, v162, v163
  v_cvt_pk_bf16_f32 v162, v164, v165
  v_cvt_pk_bf16_f32 v163, v166, v167
  buffer_store_dwordx4 v[160:163], v11, s[40:43], s6 offen offset:0 sc0 sc1
  v_cvt_pk_bf16_f32 v164, v168, v169
  v_cvt_pk_bf16_f32 v165, v170, v171
  v_cvt_pk_bf16_f32 v166, v172, v173
  v_cvt_pk_bf16_f32 v167, v174, v175
  buffer_store_dwordx4 v[164:167], v11, s[40:43], s6 offen offset:1024 sc0 sc1
  v_cvt_pk_bf16_f32 v168, v176, v177
  v_cvt_pk_bf16_f32 v169, v178, v179
  v_cvt_pk_bf16_f32 v170, v180, v181
  v_cvt_pk_bf16_f32 v171, v182, v183
  buffer_store_dwordx4 v[168:171], v11, s[40:43], s6 offen offset:2048 sc0 sc1
  v_cvt_pk_bf16_f32 v172, v184, v185
  v_cvt_pk_bf16_f32 v173, v186, v187
  v_cvt_pk_bf16_f32 v174, v188, v189
  v_cvt_pk_bf16_f32 v175, v190, v191
  buffer_store_dwordx4 v[172:175], v11, s[40:43], s6 offen offset:3072 sc0 sc1
  s_nop 0
  s_barrier
  v_mfma_f32_16x16x32_bf16 v[128:131], v[48:51], v[32:35], v[128:131]
  ds_read_b64_tr_b16 v[112:113], v6 offset:0
  ds_read_b64_tr_b16 v[114:115], v6 offset:2048
  v_mfma_f32_16x16x32_bf16 v[136:139], v[48:51], v[36:39], v[136:139]
  ds_read_b128 v[96:99], v4 offset:0
  ds_read_b128 v[100:103], v4 offset:2048
  v_mfma_f32_16x16x32_bf16 v[144:147], v[48:51], v[40:43], v[144:147]
  ds_read_b128 v[104:107], v4 offset:4096
  ds_read_b128 v[108:111], v4 offset:6144
  v_mfma_f32_16x16x32_bf16 v[152:155], v[48:51], v[44:47], v[152:155]
  ds_read_b64_tr_b16 v[116:117], v7 offset:0
  ds_read_b64_tr_b16 v[118:119], v7 offset:2048
  v_mfma_f32_16x16x32_bf16 v[132:135], v[52:55], v[32:35], v[132:135]
  ds_read_b64_tr_b16 v[208:209], v6 offset:4096
  ds_read_b64_tr_b16 v[210:211], v6 offset:6144
  v_mfma_f32_16x16x32_bf16 v[140:143], v[52:55], v[36:39], v[140:143]
  ds_read_b128 v[192:195], v5 offset:0
  ds_read_b128 v[196:199], v5 offset:2048
  v_mfma_f32_16x16x32_bf16 v[148:151], v[52:55], v[40:43], v[148:151]
  ds_read_b128 v[200:203], v5 offset:4096
  ds_read_b128 v[204:207], v5 offset:6144
  v_mfma_f32_16x16x32_bf16 v[156:159], v[52:55], v[44:47], v[156:159]
  ds_read_b64_tr_b16 v[212:213], v7 offset:4096
  ds_read_b64_tr_b16 v[214:215], v7 offset:6144
  v_mfma_f32_16x16x32_bf16 v[128:131], v[80:83], v[64:67], v[128:131]
  s_nop 0
  s_add_u32 s16, s16, s17
  s_cmp_eq_u32 s16, 65536
  v_mfma_f32_16x16x32_bf16 v[136:139], v[80:83], v[68:71], v[136:139]
  s_cselect_b32 s23, s18, s17
  s_cselect_b32 s16, 0, s16
  v_mfma_f32_16x16x32_bf16 v[144:147], v[80:83], v[72:75], v[144:147]
  v_add_u32_e64 v4, s23, v4
  v_add_u32 v5, s23, v5
  v_mfma_f32_16x16x32_bf16 v[152:155], v[80:83], v[76:79], v[152:155]
  s_add_u32 s19, s19, s20
  s_cmp_eq_u32 s19, 81920
  v_mfma_f32_16x16x32_bf16 v[132:135], v[84:87], v[64:67], v[132:135]
  s_cselect_b32 s23, s21, s20
  s_cselect_b32 s19, 0, s19
  v_mfma_f32_16x16x32_bf16 v[140:143], v[84:87], v[68:71], v[140:143]
  v_add_u32 v6, s23, v6
  v_add_u32 v7, s23, v7
  v_mfma_f32_16x16x32_bf16 v[148:151], v[84:87], v[72:75], v[148:151]
  s_waitcnt lgkmcnt(0)
  v_mfma_f32_16x16x32_bf16 v[156:159], v[84:87], v[76:79], v[156:159]
  s_barrier
  v_mfma_f32_16x16x32_bf16 v[128:131], v[112:115], v[96:99], v[128:131]
  ds_read_b64_tr_b16 v[48:49], v6 offset:0
  ds_read_b64_tr_b16 v[50:51], v6 offset:2048
  v_mfma_f32_16x16x32_bf16 v[136:139], v[112:115], v[100:103], v[136:139]
  ds_read_b128 v[32:35], v4 offset:0
  ds_read_b128 v[36:39], v4 offset:2048
  v_mfma_f32_16x16x32_bf16 v[144:147], v[112:115], v[104:107], v[144:147]
  ds_read_b128 v[40:43], v4 offset:4096
  ds_read_b128 v[44:47], v4 offset:6144
  v_mfma_f32_16x16x32_bf16 v[152:155], v[112:115], v[108:111], v[152:155]
  ds_read_b64_tr_b16 v[52:53], v7 offset:0
  ds_read_b64_tr_b16 v[54:55], v7 offset:2048
  v_mfma_f32_16x16x32_bf16 v[132:135], v[116:119], v[96:99], v[132:135]
  ds_read_b64_tr_b16 v[80:81], v6 offset:4096
  ds_read_b64_tr_b16 v[82:83], v6 offset:6144
  v_mfma_f32_16x16x32_bf16 v[140:143], v[116:119], v[100:103], v[140:143]
  ds_read_b128 v[64:67], v5 offset:0
  ds_read_b128 v[68:71], v5 offset:2048
  v_mfma_f32_16x16x32_bf16 v[148:151], v[116:119], v[104:107], v[148:151]
  ds_read_b128 v[72:75], v5 offset:4096
  ds_read_b128 v[76:79], v5 offset:6144
  v_mfma_f32_16x16x32_bf16 v[156:159], v[116:119], v[108:111], v[156:159]
  ds_read_b64_tr_b16 v[84:85], v7 offset:4096
  ds_read_b64_tr_b16 v[86:87], v7 offset:6144
  v_mfma_f32_16x16x32_bf16 v[128:131], v[208:211], v[192:195], v[128:131]
  s_nop 0
  s_add_u32 s16, s16, s17
  s_cmp_eq_u32 s16, 65536
  v_mfma_f32_16x16x32_bf16 v[136:139], v[208:211], v[196:199], v[136:139]
  s_cselect_b32 s23, s18, s17
  s_cselect_b32 s16, 0, s16
  v_mfma_f32_16x16x32_bf16 v[144:147], v[208:211], v[200:203], v[144:147]
  v_add_u32_e64 v4, s23, v4
  v_add_u32 v5, s23, v5
  v_mfma_f32_16x16x32_bf16 v[152:155], v[208:211], v[204:207], v[152:155]
  s_add_u32 s19, s19, s20
  s_cmp_eq_u32 s19, 81920
  v_mfma_f32_16x16x32_bf16 v[132:135], v[212:215], v[192:195], v[132:135]
  s_cselect_b32 s23, s21, s20
  s_cselect_b32 s19, 0, s19
  v_mfma_f32_16x16x32_bf16 v[140:143], v[212:215], v[196:199], v[140:143]
  v_add_u32_e64 v6, s23, v6
  v_add_u32 v7, s23, v7
  v_mfma_f32_16x16x32_bf16 v[148:151], v[212:215], v[200:203], v[148:151]
  s_waitcnt lgkmcnt(0)
  v_mfma_f32_16x16x32_bf16 v[156:159], v[212:215], v[204:207], v[156:159]
  s_waitcnt vmcnt(0)
  s_barrier
  v_mfma_f32_16x16x32_bf16 v[128:131], v[48:51], v[32:35], v[128:131]
  ds_read_b64_tr_b16 v[112:113], v6 offset:0
  ds_read_b64_tr_b16 v[114:115], v6 offset:2048
  v_mfma_f32_16x16x32_bf16 v[136:139], v[48:51], v[36:39], v[136:139]
  ds_read_b128 v[96:99], v4 offset:0
  ds_read_b128 v[100:103], v4 offset:2048
  v_mfma_f32_16x16x32_bf16 v[144:147], v[48:51], v[40:43], v[144:147]
  ds_read_b128 v[104:107], v4 offset:4096
  ds_read_b128 v[108:111], v4 offset:6144
  v_mfma_f32_16x16x32_bf16 v[152:155], v[48:51], v[44:47], v[152:155]
  ds_read_b64_tr_b16 v[116:117], v7 offset:0
  ds_read_b64_tr_b16 v[118:119], v7 offset:2048
  v_mfma_f32_16x16x32_bf16 v[132:135], v[52:55], v[32:35], v[132:135]
  ds_read_b64_tr_b16 v[208:209], v6 offset:4096
  ds_read_b64_tr_b16 v[210:211], v6 offset:6144
  v_mfma_f32_16x16x32_bf16 v[140:143], v[52:55], v[36:39], v[140:143]
  ds_read_b128 v[192:195], v5 offset:0
  ds_read_b128 v[196:199], v5 offset:2048
  v_mfma_f32_16x16x32_bf16 v[148:151], v[52:55], v[40:43], v[148:151]
  ds_read_b128 v[200:203], v5 offset:4096
  ds_read_b128 v[204:207], v5 offset:6144
  v_mfma_f32_16x16x32_bf16 v[156:159], v[52:55], v[44:47], v[156:159]
  ds_read_b64_tr_b16 v[212:213], v7 offset:4096
  ds_read_b64_tr_b16 v[214:215], v7 offset:6144
  v_mfma_f32_16x16x32_bf16 v[128:131], v[80:83], v[64:67], v[128:131]
  s_nop 0
  s_add_u32 s16, s16, s17
  s_cmp_eq_u32 s16, 65536
  v_mfma_f32_16x16x32_bf16 v[136:139], v[80:83], v[68:71], v[136:139]
  s_cselect_b32 s23, s18, s17
  s_cselect_b32 s16, 0, s16
  v_mfma_f32_16x16x32_bf16 v[144:147], v[80:83], v[72:75], v[144:147]
  v_add_u32_e64 v4, s23, v4
  v_add_u32 v5, s23, v5
  v_mfma_f32_16x16x32_bf16 v[152:155], v[80:83], v[76:79], v[152:155]
  s_add_u32 s19, s19, s20
  s_cmp_eq_u32 s19, 81920
  v_mfma_f32_16x16x32_bf16 v[132:135], v[84:87], v[64:67], v[132:135]
  s_cselect_b32 s23, s21, s20
  s_cselect_b32 s19, 0, s19
  v_mfma_f32_16x16x32_bf16 v[140:143], v[84:87], v[68:71], v[140:143]
  v_add_u32 v6, s23, v6
  v_add_u32 v7, s23, v7
  v_mfma_f32_16x16x32_bf16 v[148:151], v[84:87], v[72:75], v[148:151]
  s_waitcnt lgkmcnt(0)
  v_mfma_f32_16x16x32_bf16 v[156:159], v[84:87], v[76:79], v[156:159]
  s_barrier
  v_mfma_f32_16x16x32_bf16 v[128:131], v[112:115], v[96:99], v[128:131]
  ds_read_b64_tr_b16 v[48:49], v6 offset:0
  ds_read_b64_tr_b16 v[50:51], v6 offset:2048
  v_mfma_f32_16x16x32_bf16 v[136:139], v[112:115], v[100:103], v[136:139]
  ds_read_b128 v[32:35], v4 offset:0
  ds_read_b128 v[36:39], v4 offset:2048
  v_mfma_f32_16x16x32_bf16 v[144:147], v[112:115], v[104:107], v[144:147]
  ds_read_b128 v[40:43], v4 offset:4096
  ds_read_b128 v[44:47], v4 offset:6144
  v_mfma_f32_16x16x32_bf16 v[152:155], v[112:115], v[108:111], v[152:155]
  ds_read_b64_tr_b16 v[52:53], v7 offset:0
  ds_read_b64_tr_b16 v[54:55], v7 offset:2048
  v_mfma_f32_16x16x32_bf16 v[132:135], v[116:119], v[96:99], v[132:135]
  ds_read_b64_tr_b16 v[80:81], v6 offset:4096
  ds_read_b64_tr_b16 v[82:83], v6 offset:6144
  v_mfma_f32_16x16x32_bf16 v[140:143], v[116:119], v[100:103], v[140:143]
  ds_read_b128 v[64:67], v5 offset:0
  ds_read_b128 v[68:71], v5 offset:2048
  v_mfma_f32_16x16x32_bf16 v[148:151], v[116:119], v[104:107], v[148:151]
  ds_read_b128 v[72:75], v5 offset:4096
  ds_read_b128 v[76:79], v5 offset:6144
  v_mfma_f32_16x16x32_bf16 v[156:159], v[116:119], v[108:111], v[156:159]
  ds_read_b64_tr_b16 v[84:85], v7 offset:4096
  ds_read_b64_tr_b16 v[86:87], v7 offset:6144
  v_mfma_f32_16x16x32_bf16 v[128:131], v[208:211], v[192:195], v[128:131]
  s_nop 0
  s_add_u32 s16, s16, s17
  s_cmp_eq_u32 s16, 65536
  v_mfma_f32_16x16x32_bf16 v[136:139], v[208:211], v[196:199], v[136:139]
  s_cselect_b32 s23, s18, s17
  s_cselect_b32 s16, 0, s16
  v_mfma_f32_16x16x32_bf16 v[144:147], v[208:211], v[200:203], v[144:147]
  v_add_u32_e64 v4, s23, v4
  v_add_u32 v5, s23, v5
  v_mfma_f32_16x16x32_bf16 v[152:155], v[208:211], v[204:207], v[152:155]
  s_add_u32 s19, s19, s20
  s_cmp_eq_u32 s19, 81920
  v_mfma_f32_16x16x32_bf16 v[132:135], v[212:215], v[192:195], v[132:135]
  s_cselect_b32 s23, s21, s20
  s_cselect_b32 s19, 0, s19
  v_mfma_f32_16x16x32_bf16 v[140:143], v[212:215], v[196:199], v[140:143]
  v_add_u32 v6, s23, v6
  v_add_u32 v7, s23, v7
  v_mfma_f32_16x16x32_bf16 v[148:151], v[212:215], v[200:203], v[148:151]
  s_waitcnt lgkmcnt(0)
  v_mfma_f32_16x16x32_bf16 v[156:159], v[212:215], v[204:207], v[156:159]
  s_barrier
  v_mfma_f32_16x16x32_bf16 v[128:131], v[48:51], v[32:35], v[128:131]
  ds_read_b64_tr_b16 v[112:113], v6 offset:0
  ds_read_b64_tr_b16 v[114:115], v6 offset:2048
  v_mfma_f32_16x16x32_bf16 v[136:139], v[48:51], v[36:39], v[136:139]
  ds_read_b128 v[96:99], v4 offset:0
  ds_read_b128 v[100:103], v4 offset:2048
  v_mfma_f32_16x16x32_bf16 v[144:147], v[48:51], v[40:43], v[144:147]
  ds_read_b128 v[104:107], v4 offset:4096
  ds_read_b128 v[108:111], v4 offset:6144
  v_mfma_f32_16x16x32_bf16 v[152:155], v[48:51], v[44:47], v[152:155]
  ds_read_b64_tr_b16 v[116:117], v7 offset:0
  ds_read_b64_tr_b16 v[118:119], v7 offset:2048
  v_mfma_f32_16x16x32_bf16 v[132:135], v[52:55], v[32:35], v[132:135]
  ds_read_b64_tr_b16 v[208:209], v6 offset:4096
  ds_read_b64_tr_b16 v[210:211], v6 offset:6144
  v_mfma_f32_16x16x32_bf16 v[140:143], v[52:55], v[36:39], v[140:143]
  ds_read_b128 v[192:195], v5 offset:0
  ds_read_b128 v[196:199], v5 offset:2048
  v_mfma_f32_16x16x32_bf16 v[148:151], v[52:55], v[40:43], v[148:151]
  ds_read_b128 v[200:203], v5 offset:4096
  ds_read_b128 v[204:207], v5 offset:6144
  v_mfma_f32_16x16x32_bf16 v[156:159], v[52:55], v[44:47], v[156:159]
  ds_read_b64_tr_b16 v[212:213], v7 offset:4096
  ds_read_b64_tr_b16 v[214:215], v7 offset:6144
  v_mfma_f32_16x16x32_bf16 v[128:131], v[80:83], v[64:67], v[128:131]
  s_nop 0
  s_add_u32 s16, s16, s17
  s_cmp_eq_u32 s16, 65536
  v_mfma_f32_16x16x32_bf16 v[136:139], v[80:83], v[68:71], v[136:139]
  s_cselect_b32 s23, s18, s17
  s_cselect_b32 s16, 0, s16
  v_mfma_f32_16x16x32_bf16 v[144:147], v[80:83], v[72:75], v[144:147]
  v_add_u32_e64 v4, s23, v4
  v_add_u32 v5, s23, v5
  v_mfma_f32_16x16x32_bf16 v[152:155], v[80:83], v[76:79], v[152:155]
  s_add_u32 s19, s19, s20
  s_cmp_eq_u32 s19, 81920
  v_mfma_f32_16x16x32_bf16 v[132:135], v[84:87], v[64:67], v[132:135]
  s_cselect_b32 s23, s21, s20
  s_cselect_b32 s19, 0, s19
  v_mfma_f32_16x16x32_bf16 v[140:143], v[84:87], v[68:71], v[140:143]
  v_add_u32 v6, s23, v6
  v_add_u32 v7, s23, v7
  v_mfma_f32_16x16x32_bf16 v[148:151], v[84:87], v[72:75], v[148:151]
  s_waitcnt lgkmcnt(0)
  v_mfma_f32_16x16x32_bf16 v[156:159], v[84:87], v[76:79], v[156:159]
  s_barrier
  v_mfma_f32_16x16x32_bf16 v[128:131], v[112:115], v[96:99], v[128:131]
  ds_read_b64_tr_b16 v[48:49], v6 offset:0
  ds_read_b64_tr_b16 v[50:51], v6 offset:2048
  v_mfma_f32_16x16x32_bf16 v[136:139], v[112:115], v[100:103], v[136:139]
  ds_read_b128 v[32:35], v4 offset:0
  ds_read_b128 v[36:39], v4 offset:2048
  v_mfma_f32_16x16x32_bf16 v[144:147], v[112:115], v[104:107], v[144:147]
  ds_read_b128 v[40:43], v4 offset:4096
  ds_read_b128 v[44:47], v4 offset:6144
  v_mfma_f32_16x16x32_bf16 v[152:155], v[112:115], v[108:111], v[152:155]
  ds_read_b64_tr_b16 v[52:53], v7 offset:0
  ds_read_b64_tr_b16 v[54:55], v7 offset:2048
  v_mfma_f32_16x16x32_bf16 v[132:135], v[116:119], v[96:99], v[132:135]
  ds_read_b64_tr_b16 v[80:81], v6 offset:4096
  ds_read_b64_tr_b16 v[82:83], v6 offset:6144
  v_mfma_f32_16x16x32_bf16 v[140:143], v[116:119], v[100:103], v[140:143]
  ds_read_b128 v[64:67], v5 offset:0
  ds_read_b128 v[68:71], v5 offset:2048
  v_mfma_f32_16x16x32_bf16 v[148:151], v[116:119], v[104:107], v[148:151]
  ds_read_b128 v[72:75], v5 offset:4096
  ds_read_b128 v[76:79], v5 offset:6144
  v_mfma_f32_16x16x32_bf16 v[156:159], v[116:119], v[108:111], v[156:159]
  ds_read_b64_tr_b16 v[84:85], v7 offset:4096
  ds_read_b64_tr_b16 v[86:87], v7 offset:6144
  v_mfma_f32_16x16x32_bf16 v[128:131], v[208:211], v[192:195], v[128:131]
  s_nop 0
  s_add_u32 s16, s16, s17
  s_cmp_eq_u32 s16, 65536
  v_mfma_f32_16x16x32_bf16 v[136:139], v[208:211], v[196:199], v[136:139]
  s_cselect_b32 s23, s18, s17
  s_cselect_b32 s16, 0, s16
  v_mfma_f32_16x16x32_bf16 v[144:147], v[208:211], v[200:203], v[144:147]
  v_add_u32_e64 v4, s23, v4
  v_add_u32 v5, s23, v5
  v_mfma_f32_16x16x32_bf16 v[152:155], v[208:211], v[204:207], v[152:155]
  s_add_u32 s19, s19, s20
  s_cmp_eq_u32 s19, 81920
  v_mfma_f32_16x16x32_bf16 v[132:135], v[212:215], v[192:195], v[132:135]
  s_cselect_b32 s23, s21, s20
  s_cselect_b32 s19, 0, s19
  v_mfma_f32_16x16x32_bf16 v[140:143], v[212:215], v[196:199], v[140:143]
  v_add_u32 v6, s23, v6
  v_add_u32 v7, s23, v7
  v_mfma_f32_16x16x32_bf16 v[148:151], v[212:215], v[200:203], v[148:151]
  s_waitcnt lgkmcnt(0)
  v_mfma_f32_16x16x32_bf16 v[156:159], v[212:215], v[204:207], v[156:159]
  s_barrier
  v_mfma_f32_16x16x32_bf16 v[128:131], v[48:51], v[32:35], v[128:131]
  ds_read_b64_tr_b16 v[112:113], v6 offset:0
  ds_read_b64_tr_b16 v[114:115], v6 offset:2048
  v_mfma_f32_16x16x32_bf16 v[136:139], v[48:51], v[36:39], v[136:139]
  ds_read_b128 v[96:99], v4 offset:0
  ds_read_b128 v[100:103], v4 offset:2048
  v_mfma_f32_16x16x32_bf16 v[144:147], v[48:51], v[40:43], v[144:147]
  ds_read_b128 v[104:107], v4 offset:4096
  ds_read_b128 v[108:111], v4 offset:6144
  v_mfma_f32_16x16x32_bf16 v[152:155], v[48:51], v[44:47], v[152:155]
  ds_read_b64_tr_b16 v[116:117], v7 offset:0
  ds_read_b64_tr_b16 v[118:119], v7 offset:2048
  v_mfma_f32_16x16x32_bf16 v[132:135], v[52:55], v[32:35], v[132:135]
  ds_read_b64_tr_b16 v[208:209], v6 offset:4096
  ds_read_b64_tr_b16 v[210:211], v6 offset:6144
  v_mfma_f32_16x16x32_bf16 v[140:143], v[52:55], v[36:39], v[140:143]
  ds_read_b128 v[192:195], v5 offset:0
  ds_read_b128 v[196:199], v5 offset:2048
  v_mfma_f32_16x16x32_bf16 v[148:151], v[52:55], v[40:43], v[148:151]
  ds_read_b128 v[200:203], v5 offset:4096
  ds_read_b128 v[204:207], v5 offset:6144
  v_mfma_f32_16x16x32_bf16 v[156:159], v[52:55], v[44:47], v[156:159]
  ds_read_b64_tr_b16 v[212:213], v7 offset:4096
  ds_read_b64_tr_b16 v[214:215], v7 offset:6144
  v_mfma_f32_16x16x32_bf16 v[128:131], v[80:83], v[64:67], v[128:131]
  buffer_load_dwordx4 v[160:163], v11, s[40:43], s8 offen offset:0 sc0 sc1
  v_mfma_f32_16x16x32_bf16 v[136:139], v[80:83], v[68:71], v[136:139]
  buffer_load_dwordx4 v[164:167], v11, s[40:43], s8 offen offset:1024 sc0 sc1
  v_mfma_f32_16x16x32_bf16 v[144:147], v[80:83], v[72:75], v[144:147]
  buffer_load_dwordx4 v[168:171], v11, s[40:43], s8 offen offset:2048 sc0 sc1
  v_mfma_f32_16x16x32_bf16 v[152:155], v[80:83], v[76:79], v[152:155]
  buffer_load_dwordx4 v[172:175], v11, s[40:43], s8 offen offset:3072 sc0 sc1
  v_mfma_f32_16x16x32_bf16 v[132:135], v[84:87], v[64:67], v[132:135]
  v_mfma_f32_16x16x32_bf16 v[140:143], v[84:87], v[68:71], v[140:143]
  v_mfma_f32_16x16x32_bf16 v[148:151], v[84:87], v[72:75], v[148:151]
  s_waitcnt lgkmcnt(0)
  v_mfma_f32_16x16x32_bf16 v[156:159], v[84:87], v[76:79], v[156:159]
  s_barrier
  v_mfma_f32_16x16x32_bf16 v[128:131], v[112:115], v[96:99], v[128:131]
  v_mfma_f32_16x16x32_bf16 v[136:139], v[112:115], v[100:103], v[136:139]
  v_mfma_f32_16x16x32_bf16 v[144:147], v[112:115], v[104:107], v[144:147]
  v_mfma_f32_16x16x32_bf16 v[152:155], v[112:115], v[108:111], v[152:155]
  v_mfma_f32_16x16x32_bf16 v[132:135], v[116:119], v[96:99], v[132:135]
  v_mfma_f32_16x16x32_bf16 v[140:143], v[116:119], v[100:103], v[140:143]
  v_mfma_f32_16x16x32_bf16 v[148:151], v[116:119], v[104:107], v[148:151]
  v_mfma_f32_16x16x32_bf16 v[156:159], v[116:119], v[108:111], v[156:159]
  v_mfma_f32_16x16x32_bf16 v[128:131], v[208:211], v[192:195], v[128:131]
  v_mfma_f32_16x16x32_bf16 v[136:139], v[208:211], v[196:199], v[136:139]
  v_mfma_f32_16x16x32_bf16 v[144:147], v[208:211], v[200:203], v[144:147]
  v_mfma_f32_16x16x32_bf16 v[152:155], v[208:211], v[204:207], v[152:155]
  v_mfma_f32_16x16x32_bf16 v[132:135], v[212:215], v[192:195], v[132:135]
  v_mfma_f32_16x16x32_bf16 v[140:143], v[212:215], v[196:199], v[140:143]
  v_mfma_f32_16x16x32_bf16 v[148:151], v[212:215], v[200:203], v[148:151]
  s_nop 0
  s_waitcnt lgkmcnt(0)
  v_mfma_f32_16x16x32_bf16 v[156:159], v[212:215], v[204:207], v[156:159]
  s_mov_b32 s4, 0xffff0000
  s_waitcnt vmcnt(3)
  v_lshlrev_b32 v32, 16, v160
  v_and_b32 v33, s4, v160
  v_lshlrev_b32 v34, 16, v161
  v_and_b32 v35, s4, v161
  v_lshlrev_b32 v36, 16, v162
  v_and_b32 v37, s4, v162
  v_lshlrev_b32 v38, 16, v163
  v_and_b32_e64 v39, s4, v163
  v_pk_add_f32 v[128:129], v[128:129], v[32:33]
  v_pk_add_f32 v[130:131], v[130:131], v[34:35]
  v_pk_add_f32 v[132:133], v[132:133], v[36:37]
  v_pk_add_f32 v[134:135], v[134:135], v[38:39]
  s_waitcnt vmcnt(2)
  v_lshlrev_b32 v32, 16, v164
  v_and_b32 v33, s4, v164
  v_lshlrev_b32 v34, 16, v165
  v_and_b32 v35, s4, v165
  v_lshlrev_b32 v36, 16, v166
  v_and_b32 v37, s4, v166
  v_lshlrev_b32 v38, 16, v167
  v_and_b32_e64 v39, s4, v167
  v_pk_add_f32 v[136:137], v[136:137], v[32:33]
  v_pk_add_f32 v[138:139], v[138:139], v[34:35]
  v_pk_add_f32 v[140:141], v[140:141], v[36:37]
  v_pk_add_f32 v[142:143], v[142:143], v[38:39]
  s_waitcnt vmcnt(1)
  v_lshlrev_b32 v32, 16, v168
  v_and_b32 v33, s4, v168
  v_lshlrev_b32 v34, 16, v169
  v_and_b32 v35, s4, v169
  v_lshlrev_b32 v36, 16, v170
  v_and_b32 v37, s4, v170
  v_lshlrev_b32 v38, 16, v171
  v_and_b32_e64 v39, s4, v171
  v_pk_add_f32 v[144:145], v[144:145], v[32:33]
  v_pk_add_f32 v[146:147], v[146:147], v[34:35]
  v_pk_add_f32 v[148:149], v[148:149], v[36:37]
  v_pk_add_f32 v[150:151], v[150:151], v[38:39]
  s_waitcnt vmcnt(0)
  v_lshlrev_b32 v32, 16, v172
  v_and_b32 v33, s4, v172
  v_lshlrev_b32 v34, 16, v173
  v_and_b32 v35, s4, v173
  v_lshlrev_b32 v36, 16, v174
  v_and_b32 v37, s4, v174
  v_lshlrev_b32 v38, 16, v175
  v_and_b32_e64 v39, s4, v175
  v_pk_add_f32 v[152:153], v[152:153], v[32:33]
  v_pk_add_f32 v[154:155], v[154:155], v[34:35]
  v_pk_add_f32 v[156:157], v[156:157], v[36:37]
  v_pk_add_f32 v[158:159], v[158:159], v[38:39]
  v_cvt_pk_bf16_f32 v240, v128, v129
  v_cvt_pk_bf16_f32 v241, v130, v131
  v_cvt_pk_bf16_f32 v242, v132, v133
  v_cvt_pk_bf16_f32 v243, v134, v135
  v_cvt_pk_bf16_f32 v244, v136, v137
  v_cvt_pk_bf16_f32 v245, v138, v139
  v_cvt_pk_bf16_f32 v246, v140, v141
  v_cvt_pk_bf16_f32 v247, v142, v143
  v_cvt_pk_bf16_f32 v248, v144, v145
  v_cvt_pk_bf16_f32 v249, v146, v147
  v_cvt_pk_bf16_f32 v250, v148, v149
  v_cvt_pk_bf16_f32 v251, v150, v151
  v_cvt_pk_bf16_f32 v252, v152, v153
  v_cvt_pk_bf16_f32 v253, v154, v155
  v_cvt_pk_bf16_f32 v254, v156, v157
  v_cvt_pk_bf16_f32 v255, v158, v159
  s_cmp_lg_u32 s82, 0
  s_cbranch_scc1 L_cfinal
  s_lshl_b32 s4, s76, 4
  s_add_u32 s4, s4, s78
  s_lshl_b32 s6, s4, Lz1-Lz0+14
  s_add_u32 s6, s6, 35651584
  s_add_u32 s7, s6, 4096
  s_lshl_b32 s5, s78, Lz1-Lz0+1
  buffer_store_dwordx4 v[240:243], v0, s[40:43], s6 offen offset:0 sc0 sc1
  buffer_store_dwordx4 v[244:247], v0, s[40:43], s6 offen offset:2048 sc0 sc1
  buffer_store_dwordx4 v[248:251], v0, s[40:43], s7 offen offset:0 sc0 sc1
  buffer_store_dwordx4 v[252:255], v0, s[40:43], s7 offen offset:2048 sc0 sc1
  v_mov_b32 v40, 0x3f803f80
  v_dot2_f32_bf16 v32, v240, v40, 0
  v_dot2_f32_bf16 v36, v240, v240, 0
  v_dot2_f32_bf16 v33, v244, v40, 0
  v_dot2_f32_bf16 v37, v244, v244, 0
  v_dot2_f32_bf16 v34, v248, v40, 0
  v_dot2_f32_bf16 v38, v248, v248, 0
  v_dot2_f32_bf16 v35, v252, v40, 0
  v_dot2_f32_bf16 v39, v252, v252, 0
  v_dot2_f32_bf16 v32, v241, v40, v32
  v_dot2_f32_bf16 v36, v241, v241, v36
  v_dot2_f32_bf16 v33, v245, v40, v33
  v_dot2_f32_bf16 v37, v245, v245, v37
  v_dot2_f32_bf16 v34, v249, v40, v34
  v_dot2_f32_bf16 v38, v249, v249, v38
  v_dot2_f32_bf16 v35, v253, v40, v35
  v_dot2_f32_bf16 v39, v253, v253, v39
  v_dot2_f32_bf16 v32, v242, v40, v32
  v_dot2_f32_bf16 v36, v242, v242, v36
  v_dot2_f32_bf16 v33, v246, v40, v33
  v_dot2_f32_bf16 v37, v246, v246, v37
  v_dot2_f32_bf16 v34, v250, v40, v34
  v_dot2_f32_bf16 v38, v250, v250, v38
  v_dot2_f32_bf16 v35, v254, v40, v35
  v_dot2_f32_bf16 v39, v254, v254, v39
  v_dot2_f32_bf16 v32, v243, v40, v32
  v_dot2_f32_bf16 v36, v243, v243, v36
  v_dot2_f32_bf16 v33, v247, v40, v33
  v_dot2_f32_bf16 v37, v247, v247, v37
  v_dot2_f32_bf16 v34, v251, v40, v34
  v_dot2_f32_bf16 v38, v251, v251, v38
  v_dot2_f32_bf16 v35, v255, v40, v35
  v_dot2_f32_bf16 v39, v255, v255, v39
  s_lshl_b32 s6, s76, Lz1-Lz0+9
  s_lshl_b32 s7, s85, 8
  s_add_u32 s6, s6, s7
  s_add_u32 s6, s6, s5
  s_add_u32 s6, s6, s86
  s_lshl_b32 s6, s6, 6
  s_add_u32 s6, s6, s83
  s_add_u32 s6, s6, 36700160
  v_permlane32_swap_b32 v32, v34
  v_permlane32_swap_b32 v33, v35
  v_permlane32_swap_b32 v36, v38
  v_permlane32_swap_b32 v37, v39
  v_add_f32 v32, v32, v34
  v_add_f32 v33, v33, v35
  v_add_f32 v36, v36, v38
  v_add_f32 v37, v37, v39
  v_permlane16_swap_b32 v32, v33
  s_nop 0
  v_permlane16_swap_b32 v36, v37
  v_add_f32 v42, v32, v33
  v_add_f32_e64 v43, v36, v37
  buffer_store_dwordx2 v[42:43], v30, s[40:43], s6 offen sc0 sc1
  s_add_u32 s5, s87, 16
  s_sub_u32 s4, s78, s77
  s_lshl_b32 s4, s4, 7
  s_add_u32 s5, s5, s4
  s_waitcnt vmcnt(0)
  s_mov_b64 exec, 1
  ds_add_rtn_u32 v2, v28, v27 offset:0
  s_waitcnt lgkmcnt(0)
  v_readfirstlane_b32 s4, v2
  s_and_b32 s4, s4, Lz1-Lz0+3
  s_cmp_lg_u32 s4, 3
  s_cbranch_scc1 Ls_22
  s_mov_b32 exec_lo, 0xffff
  buffer_store_dword v27, v24, s[40:43], s5 offen sc0 sc1
Ls_22:
  s_mov_b64 exec, -1
  s_mov_b32 s82, 1
  s_add_u32 s83, s83, 0
  s_add_u32 s87, s87, 32
  s_branch L_clayer
  s_nop 0
L_cfinal:
  s_nop 1
  v_permlane16_swap_b32 v240, v242
  v_permlane16_swap_b32 v241, v243
  v_permlane16_swap_b32 v244, v246
  v_permlane16_swap_b32 v245, v247
  v_permlane16_swap_b32 v248, v250
  v_permlane16_swap_b32 v249, v251
  v_permlane16_swap_b32 v252, v254
  v_permlane16_swap_b32 v253, v255
  v_and_b32 v2, 15, v1
  v_lshlrev_b32 v3, 12, v2
  v_and_b32 v2, 16, v1
  v_lshl_add_u32 v3, v2, 1, v3
  v_and_b32 v2, 32, v1
  v_lshrrev_b32 v2, 1, v2
  v_add_u32 v3, v2, v3
  s_lshl_b32 s5, s76, 18
  s_lshl_b32 s4, s85, 11
  s_add_u32 s5, s5, s4
  s_lshl_b32 s4, s78, 7
  s_add_u32 s5, s5, s4
  s_lshl_b32 s4, s86, 6
  s_add_u32 s5, s5, s4
  buffer_store_dwordx4 v[240:243], v3, s[64:67], s5 offen
  s_add_u32 s5, s5, 0x10000
  buffer_store_dwordx4 v[244:247], v3, s[64:67], s5 offen
  s_add_u32 s5, s5, 0x10000
  buffer_store_dwordx4 v[248:251], v3, s[64:67], s5 offen
  s_add_u32 s5, s5, 0x10000
  buffer_store_dwordx4 v[252:255], v3, s[64:67], s5 offen
  s_endpgm
L_w1:
  s_and_b32 s80, s77, 7
  s_lshr_b32 s79, s77, 3
  s_lshl_b32 s78, s80, 1
  s_add_u32 s78, s78, s79
  s_lshl_b32 s5, s76, 4
  s_add_u32 s5, s5, s77
  s_lshl_b32 s84, s5, 11
  s_mov_b32 s83, 3145728
  s_mov_b32 s87, 1835016
  s_lshr_b32 s86, s81, 1
  s_mov_b32 s40, s38
  s_and_b32 s41, s39, 0xffff
  s_mov_b32 s42, 100663296
  s_mov_b32 s43, 0x00020000
  s_nop 0
  s_mov_b32 s52, s20
  s_and_b32 s53, s21, 0xffff
  s_mov_b32 s54, 2097152
  s_mov_b32 s55, 0x00020000
  s_nop 0
  s_mov_b32 s56, s24
  s_and_b32 s57, s25, 0xffff
  s_mov_b32 s58, 7340032
  s_mov_b32 s59, 0x00020000
  s_nop 0
  s_mov_b32 s60, s28
  s_and_b32 s61, s29, 0xffff
  s_mov_b32 s62, 7340032
  s_mov_b32 s63, 0x00020000
  v_lshrrev_b32 v2, 3, v1
  s_movk_i32 s4, 2048
  v_mad_u32_u24 v4, v2, s4, v10
  v_add_u32 v5, 15360, v4
  v_add_u32 v6, 30720, v4
  v_add_u32 v7, 46080, v4
  s_lshl_b32 s5, s78, 7
  s_mul_i32 s4, s85, 65536
  s_add_u32 s5, s5, s4
  s_mov_b32 s8, 131072
  s_mov_b32 s10, 2097152
  s_add_u32 s9, s5, s10
  s_mul_i32 s6, s76, s8
  s_add_u32 s7, s5, s6
  s_lshl_b32 s11, s85, 12
  s_add_u32 s11, s11, 65536
  s_add_u32 s15, s11, 81920
  s_add_u32 s11, s11, 32768
  s_mov_b32 s12, 0
  s_mov_b32 m0, s11
  s_waitcnt vmcnt(12)
  s_barrier
  s_branch Ll_37
Lt_43:
  s_cmp_lg_u32 s12, 2
  s_cbranch_scc1 Lt_41
  s_waitcnt vmcnt(8)
  s_barrier
  s_branch Ll_37
Lt_41:
  s_cmp_lg_u32 s12, 6
  s_cbranch_scc1 Ll_37
  s_barrier
Ll_37:
  buffer_load_dwordx4 v4, s[52:55], s7 offen offset:0 lds
  s_mov_b32 s5, s7
  buffer_load_dwordx4 v5, s[52:55], s5 offen offset:1024 lds
  s_add_u32 s7, s7, s8
  s_cmp_eq_u32 s7, s9
  s_cselect_b32 s4, s10, 0
  s_sub_u32 s7, s7, s4
  s_add_u32 s11, s11, 8192
  buffer_load_dwordx4 v6, s[52:55], s5 offen offset:2048 lds
  s_cmp_eq_u32 s11, s15
  s_cselect_b32 s4, 81920, 0
  s_sub_u32 s11, s11, s4
  s_add_u32 s12, s12, 1
  s_cmp_lg_u32 s12, 10
  buffer_load_dwordx4 v7, s[52:55], s5 offen offset:3072 lds
  s_mov_b32 m0, s11
  s_cbranch_scc1 Lt_43
Lt_44:
  v_mov_b32 v2, 156416
  v_mov_b32_e64 v3, 1
  s_waitcnt vmcnt(16)
  s_mov_b64 exec, 1
  ds_add_u32 v2, v3 offset:8
  s_mov_b64 exec, -1
  s_lshl_b32 s5, s82, 2
  s_add_u32 s5, s5, Lz1-Lz0+4
  s_mov_b32 s89, 1600000
Lw_45:
  ds_read_b32 v3, v2 offset:12
Lw_46:
  s_waitcnt lgkmcnt(0)
  v_readfirstlane_b32 s4, v3
  s_cmp_ge_u32 s4, s5
  s_cbranch_scc1 Lw_47
  s_sleep 1
  s_sub_u32 s89, s89, 1
  s_cbranch_scc0 Lw_45
Lw_47:
Ll_39:
  buffer_load_dwordx4 v4, s[52:55], s7 offen offset:0 lds
  s_mov_b32 s5, s7
  buffer_load_dwordx4 v5, s[52:55], s5 offen offset:1024 lds
  s_add_u32 s7, s7, s8
  s_cmp_eq_u32 s7, s9
  s_cselect_b32 s4, s10, 0
  s_sub_u32 s7, s7, s4
  s_add_u32 s11, s11, 8192
  buffer_load_dwordx4 v6, s[52:55], s5 offen offset:2048 lds
  s_cmp_eq_u32 s11, s15
  s_cselect_b32 s4, 81920, 0
  s_sub_u32 s11, s11, s4
  s_add_u32 s12, s12, 1
  s_cmp_lg_u32 s12, 16
  buffer_load_dwordx4 v7, s[52:55], s5 offen offset:3072 lds
  s_mov_b32 m0, s11
  s_cbranch_scc1 Ll_39
  s_waitcnt vmcnt(24)
  v_lshrrev_b32 v2, 3, v1
  s_mov_b32 s4, 7168
  v_mad_u32_u24 v4, v2, s4, v10
  v_add_u32 v5, 56320, v4
  v_add_u32 v6, 112640, v4
  v_add_u32 v7, 168960, v4
  v_lshrrev_b32 v2, 2, v1
  s_movk_i32 s4, 7168
  v_mul_u32_u24_e64 v2, s4, v2
  v_bfe_u32 v3, v10, 5, 1
  v_lshl_add_u32 v2, v3, 4, v2
  v_and_b32 v3, 1, v1
  v_lshlrev_b32 v3, 5, v3
  v_add_u32_e64 v8, v2, v3
  v_add_u32 v9, 113664, v8
  s_mul_i32 s5, s77, 448
  s_and_b32 s4, s77, Lz1-Lz0+1
  s_mul_i32 s94, s4, 448
  s_sub_u32 s94, 384, s94
  s_lshl_b32 s4, s4, 6
  s_add_u32 s5, s5, s4
  s_mul_i32 s4, s85, 229376
  s_add_u32 s5, s5, s4
  v_add_u32 v12, s76, v1
  v_and_b32 v12, 15, v12
  v_mov_b32 v2, s76
  v_cmp_eq_u32 vcc, s78, v12
  s_nop 1
  v_cndmask_b32_e64 v12, v12, v2, vcc
  v_writelane_b32 v12, s78, 0
  s_mov_b32 s4, 458752
  v_mul_u32_u24 v12, s4, v12
  v_add_u32 v12, s5, v12
  s_nop 0
  v_readfirstlane_b32 s7, v12
  s_lshl_b32 s11, s85, Lz1-Lz0+12
  s_add_u32 s11, s11, 65536
  s_add_u32 s15, s11, 86016
  s_lshl_b32 s4, s85, Lz1-Lz0+11
  s_sub_u32 s13, 24576, s4
  s_mul_i32 s5, s85, 6144
  s_nop 0
  s_mov_b32 s68, s28
  s_and_b32 s69, s29, 0xffff
  s_mov_b32 s70, 7340032
  s_mov_b32 s71, 0x00020000
  s_lshl_b32 s4, s76, 4
  s_add_u32 s4, s4, s77
  s_mul_i32 s34, s4, 28672
  s_add_u32 s34, s34, s5
  v_lshlrev_b32 v15, 4, v1
  s_lshl_b32 s91, s85, Lz1-Lz0+13
  s_add_u32 s91, s91, 4096
  s_lshl_b32 s9, s76, 18
  s_add_u32 s9, s9, 3145728
  s_add_u32 s9, s9, s91
  s_add_u32 s10, s91, 65536
  s_add_u32 s91, s91, 49152
  s_add_u32 s8, s76, 3
  s_lshl_b32 s8, s8, 14
  s_mov_b32 s12, Lz1-Lz0+3
Lh_48:
  s_and_b32 s8, s8, 0x3ffff
  s_add_u32 s90, s8, s9
  s_mov_b32 m0, s91
  s_cmp_lt_u32 s12, 6
  s_cbranch_scc1 Lh_49
  s_waitcnt vmcnt(8)
Lh_49:
  s_barrier
Lh_50:
  buffer_load_dwordx4 v15, s[40:43], s90 offen offset:0 sc1 lds
  s_add_u32 s8, s8, 16384
  s_add_u32 s91, s91, 16384
  s_nop 0
  s_cmp_eq_u32 s91, s10
  buffer_load_dwordx4 v15, s[40:43], s90 offen offset:1024 sc1 lds
  s_cselect_b32 s4, 65536, 0
  s_sub_u32 s91, s91, s4
  s_add_u32 s12, s12, 1
  buffer_load_dwordx4 v15, s[40:43], s90 offen offset:2048 sc1 lds
  s_cmp_lg_u32 s12, Lz1-Lz0+16
  buffer_load_dwordx4 v15, s[40:43], s90 offen offset:3072 sc1 lds
  s_cbranch_scc1 Lh_48
  s_mov_b32 s12, 0
  s_mov_b32 m0, s11
  s_branch Ll_51
Lt_56:
  s_cmp_lg_u32 s12, 1
  s_cbranch_scc1 Ll_51
  s_waitcnt vmcnt(18)
  s_barrier
Ll_51:
  buffer_load_dwordx4 v4, s[56:59], s7 offen offset:0 lds
  buffer_load_dwordx4 v5, s[56:59], s7 offen offset:1024 lds
  buffer_load_dwordx4 v6, s[56:59], s7 offen offset:2048 lds
  buffer_load_dwordx4 v7, s[56:59], s7 offen offset:3072 lds
  s_add_u32 m0, s11, s13
  s_add_u32 s5, s7, s94
  buffer_load_dwordx4 v8, s[56:59], s5 offen offset:0 lds
  buffer_load_dwordx4 v9, s[56:59], s5 offen offset:1024 lds
  s_cmp_ge_u32 s12, Lz1-Lz0+2
  s_cbranch_scc1 Lm_57
  s_waitcnt vmcnt(20)
  s_cmp_lg_u32 s12, 0
  s_cbranch_scc1 Lm_58
  s_waitcnt vmcnt(14)
Lm_58:
  s_barrier
Lm_57:
  s_add_u32 m0, s11, 8192
  s_add_u32 s5, s7, 128
  buffer_load_dwordx4 v4, s[56:59], s5 offen offset:0 lds
  buffer_load_dwordx4 v5, s[56:59], s5 offen offset:1024 lds
  buffer_load_dwordx4 v6, s[56:59], s5 offen offset:2048 lds
  buffer_load_dwordx4 v7, s[56:59], s5 offen offset:3072 lds
  s_add_u32 m0, s11, 16384
  s_add_u32 s5, s7, 256
  buffer_load_dwordx4 v4, s[56:59], s5 offen offset:0 lds
  s_add_u32 s12, s12, Lz1-Lz0+1
  v_readlane_b32 s7, v12, s12
  s_add_u32 s11, s11, 28672
  buffer_load_dwordx4 v5, s[56:59], s5 offen offset:1024 lds
  s_cmp_eq_u32 s11, s15
  s_cselect_b32 s4, 86016, 0
  s_sub_u32 s11, s11, s4
  buffer_load_dwordx4 v6, s[56:59], s5 offen offset:2048 lds
  s_cmp_lg_u32 s12, 2
  buffer_load_dwordx4 v7, s[56:59], s5 offen offset:3072 lds
  s_mov_b32 m0, s11
  s_cbranch_scc1 Ll_52
  s_barrier
Lt_59:
  s_waitcnt vmcnt(0)
  s_barrier
Ll_52:
  s_cmp_lt_u32 s12, 3
  s_cbranch_scc1 Lt_56
  s_waitcnt vmcnt(14)
  s_barrier
  buffer_load_dwordx4 v4, s[56:59], s7 offen offset:0 lds
  buffer_load_dwordx4 v5, s[56:59], s7 offen offset:1024 lds
  buffer_load_dwordx4 v6, s[56:59], s7 offen offset:2048 lds
  buffer_load_dwordx4 v7, s[56:59], s7 offen offset:3072 lds
Ll_60:
  s_add_u32 m0, s11, s13
  s_add_u32 s5, s7, s94
  buffer_load_dwordx4 v8, s[56:59], s5 offen offset:0 lds
  buffer_load_dwordx4 v9, s[56:59], s5 offen offset:1024 lds
  s_add_u32 m0, s11, 8192
  s_add_u32 s5, s7, 128
  buffer_load_dwordx4 v4, s[56:59], s5 offen offset:0 lds
  buffer_load_dwordx4 v5, s[56:59], s5 offen offset:1024 lds
  buffer_load_dwordx4 v6, s[56:59], s5 offen offset:2048 lds
  buffer_load_dwordx4 v7, s[56:59], s5 offen offset:3072 lds
  s_add_u32 m0, s11, 16384
  s_add_u32 s5, s7, 256
  buffer_load_dwordx4 v4, s[56:59], s5 offen offset:0 lds
  s_add_u32 s12, s12, Lz1-Lz0+1
  v_readlane_b32 s7, v12, s12
  s_add_u32 s11, s11, 28672
  buffer_load_dwordx4 v5, s[56:59], s5 offen offset:1024 lds
  s_cmp_eq_u32 s11, s15
  s_cselect_b32 s4, 86016, 0
  s_sub_u32 s11, s11, s4
  buffer_load_dwordx4 v6, s[56:59], s5 offen offset:2048 lds
  s_cmp_eq_u32 s12, Lz1-Lz0+16
  buffer_load_dwordx4 v7, s[56:59], s5 offen offset:3072 lds
  s_mov_b32 m0, s11
  s_cbranch_scc1 Ll_61
  s_cmp_lg_u32 s82, 0
  s_cbranch_scc1 L_62
  s_buffer_load_dwordx2 s[98:99], s[68:71], s34 offset:60
  s_buffer_load_dwordx2 s[98:99], s[68:71], s34 offset:188
  s_buffer_load_dwordx2 s[98:99], s[68:71], s34 offset:316
  s_buffer_load_dwordx2 s[98:99], s[68:71], s34 offset:444
  s_add_u32 s34, s34, 512
L_62:
  s_waitcnt vmcnt(14)
  s_barrier
  buffer_load_dwordx4 v4, s[56:59], s7 offen offset:0 lds
  buffer_load_dwordx4 v5, s[56:59], s7 offen offset:1024 lds
  buffer_load_dwordx4 v6, s[56:59], s7 offen offset:2048 lds
  buffer_load_dwordx4 v7, s[56:59], s7 offen offset:3072 lds
  s_branch Ll_60
  s_nop 0
Ll_61:
  v_lshrrev_b32 v2, 3, v1
  s_movk_i32 s4, 2048
  v_mad_u32_u24 v4, v2, s4, v10
  v_add_u32 v5, 15360, v4
  v_add_u32 v6, 30720, v4
  v_add_u32 v7, 46080, v4
  s_lshl_b32 s5, s78, Lz1-Lz0+7
  s_mul_i32 s4, s79, 3670016
  s_add_u32 s5, s5, s4
  s_lshl_b32 s94, s79, 8
  s_sub_u32 s94, 128, s94
  v_subrev_u32 v2, 4, v1
  v_cmp_le_u32 vcc, 28, v1
  s_nop 1
  v_cndmask_b32 v13, v1, v2, vcc
  v_subrev_u32 v3, 3, v13
  v_mov_b32 v12, 4
  v_cmp_le_u32 vcc, 14, v13
  v_subrev_u32 v2, 14, v13
  s_nop 0
  v_cndmask_b32 v3, v3, v2, vcc
  v_cndmask_b32_e64 v12, v12, 12, vcc
  v_cmp_le_u32 vcc, 21, v13
  v_subrev_u32 v2, 21, v13
  s_nop 0
  v_cndmask_b32 v3, v3, v2, vcc
  v_cndmask_b32_e64 v12, v12, 20, vcc
  s_sub_u32 s4, s80, s76
  s_and_b32 s4, s4, 7
  v_cmp_le_u32 vcc, s4, v3
  v_mov_b32 v2, s76
  s_nop 0
  v_addc_co_u32 v3, vcc, v3, v2, vcc
  v_and_b32 v3, 7, v3
  v_add_u32 v12, v12, v3
  v_add_u32 v2, v2, v1
  v_and_b32 v2, 3, v2
  v_subrev_u32 v3, 10, v1
  v_cmp_gt_u32 vcc, 4, v3
  s_nop 1
  v_cndmask_b32 v12, v12, v2, vcc
  s_add_u32 s4, s80, Lz1-Lz0+4
  v_lshl_add_u32 v2, v1, 3, s4
  v_cmp_gt_u32 vcc, 3, v1
  s_nop 1
  v_cndmask_b32 v12, v12, v2, vcc
  v_subrev_u32 v2, 4, v12
  v_and_b32 v3, 7, v2
  v_lshrrev_b32 v2, 3, v2
  v_mad_u32_u24 v2, v3, 7, v2
  v_and_b32 v3, 1, v3
  v_add_u32 v2, v2, v3
  s_mul_i32 s4, s85, 3
  v_add_u32 v2, s4, v2
  s_add_u32 s4, s85, Lz1-Lz0+6
  v_mad_u32_u24 v3, v12, 14, s4
  v_cmp_gt_u32 vcc, 4, v12
  s_nop 1
  v_cndmask_b32_e64 v2, v2, v3, vcc
  v_lshl_add_u32 v12, v2, 16, s5
  s_mul_i32 s4, s79, 7340032
  s_sub_u32 s4, 3670016, s4
  v_add_u32 v2, s4, v12
  v_cmp_le_u32 vcc, 28, v1
  s_nop 1
  v_cndmask_b32 v12, v12, v2, vcc
  s_lshl_b32 s11, s85, Lz1-Lz0+12
  s_add_u32 s11, s11, 65536
  s_add_u32 s15, s11, 81920
  s_add_u32 s11, s11, 32768
  v_readfirstlane_b32 s7, v12
  s_mov_b32 s12, 0
  s_mov_b32 m0, s11
  s_waitcnt vmcnt(14)
  s_barrier
  s_branch Ll_63
Lt_69:
  s_cmp_lg_u32 s12, 1
  s_cbranch_scc1 Lt_67
  s_waitcnt vmcnt(8)
  s_barrier
  s_branch Ll_63
Lt_67:
  s_cmp_lg_u32 s12, 3
  s_cbranch_scc1 Ll_63
  s_barrier
Ll_63:
  buffer_load_dwordx4 v4, s[60:63], s7 offen offset:0 lds
  buffer_load_dwordx4 v5, s[60:63], s7 offen offset:1024 lds
  buffer_load_dwordx4 v6, s[60:63], s7 offen offset:2048 lds
  buffer_load_dwordx4 v7, s[60:63], s7 offen offset:3072 lds
  s_add_u32 m0, s11, 8192
  s_add_u32 s5, s7, s94
  buffer_load_dwordx4 v4, s[60:63], s5 offen offset:0 lds
  s_add_u32 s12, s12, 1
  v_readlane_b32 s7, v12, s12
  s_add_u32 s11, s11, 16384
  buffer_load_dwordx4 v5, s[60:63], s5 offen offset:1024 lds
  s_cmp_eq_u32 s11, s15
  s_cselect_b32 s4, 81920, 0
  s_sub_u32 s11, s11, s4
  buffer_load_dwordx4 v6, s[60:63], s5 offen offset:2048 lds
  s_cmp_lg_u32 s12, Lz1-Lz0+5
  buffer_load_dwordx4 v7, s[60:63], s5 offen offset:3072 lds
  s_mov_b32 m0, s11
  s_cbranch_scc1 Lt_69
Lt_70:
  s_waitcnt vmcnt(32)
  s_barrier
  s_waitcnt vmcnt(24)
  s_barrier
  buffer_load_dwordx4 v4, s[60:63], s7 offen offset:0 lds
  buffer_load_dwordx4 v5, s[60:63], s7 offen offset:1024 lds
  buffer_load_dwordx4 v6, s[60:63], s7 offen offset:2048 lds
  buffer_load_dwordx4 v7, s[60:63], s7 offen offset:3072 lds
Ll_71:
  s_add_u32 m0, s11, 8192
  s_add_u32 s5, s7, s94
  buffer_load_dwordx4 v4, s[60:63], s5 offen offset:0 lds
  s_add_u32 s12, s12, 1
  v_readlane_b32 s7, v12, s12
  s_add_u32 s11, s11, 16384
  buffer_load_dwordx4 v5, s[60:63], s5 offen offset:1024 lds
  s_cmp_eq_u32 s11, s15
  s_cselect_b32 s4, 81920, 0
  s_sub_u32 s11, s11, s4
  buffer_load_dwordx4 v6, s[60:63], s5 offen offset:2048 lds
  s_cmp_eq_u32 s12, Lz1-Lz0+24
  buffer_load_dwordx4 v7, s[60:63], s5 offen offset:3072 lds
  s_mov_b32 m0, s11
  s_cbranch_scc1 Ll_72
  s_waitcnt vmcnt(24)
  s_barrier
  buffer_load_dwordx4 v4, s[60:63], s7 offen offset:0 lds
  buffer_load_dwordx4 v5, s[60:63], s7 offen offset:1024 lds
  buffer_load_dwordx4 v6, s[60:63], s7 offen offset:2048 lds
  buffer_load_dwordx4 v7, s[60:63], s7 offen offset:3072 lds
  s_branch Ll_71
  s_nop 0
Ll_72:
  s_waitcnt vmcnt(24)
  s_barrier
  buffer_load_dwordx4 v4, s[60:63], s7 offen offset:0 lds
Ll_73:
  s_mov_b32 s5, s7
  buffer_load_dwordx4 v5, s[60:63], s5 offen offset:1024 lds
  s_add_u32 s12, s12, 1
  v_readlane_b32 s7, v12, s12
  s_add_u32 s11, s11, 16384
  s_nop 0
  s_cmp_eq_u32 s11, s15
  buffer_load_dwordx4 v6, s[60:63], s5 offen offset:2048 lds
  s_cselect_b32 s4, 81920, 0
  s_sub_u32 s11, s11, s4
  s_cmp_eq_u32 s12, 32
  buffer_load_dwordx4 v7, s[60:63], s5 offen offset:3072 lds
  s_mov_b32 m0, s11
  s_cbranch_scc1 Ll_74
  s_waitcnt vmcnt(12)
  s_barrier
  buffer_load_dwordx4 v4, s[60:63], s7 offen offset:0 lds
  s_branch Ll_73
  s_nop 0
Ll_74:
  v_lshrrev_b32 v2, 3, v1
  s_movk_i32 s4, 6144
  v_mad_u32_u24 v4, v2, s4, v10
  v_add_u32 v5, 48128, v4
  v_add_u32 v6, 96256, v4
  v_add_u32 v7, 144384, v4
  s_cmp_eq_u32 s82, 0
  s_mov_b32 s82, 1
  s_cbranch_scc1 L_wlayer
  s_waitcnt vmcnt(12)
  s_barrier
  s_waitcnt vmcnt(8)
  s_barrier
  s_waitcnt vmcnt(4)
  s_barrier
  s_waitcnt vmcnt(0)
  s_barrier
  s_barrier
  s_branch L_lend
L_x1:
  s_cmp_lg_u32 s82, 0
  s_cbranch_scc1 L_82
  s_and_b32 s80, s77, 7
  s_lshr_b32 s79, s77, 3
  s_lshl_b32 s78, s80, 1
  s_add_u32 s78, s78, s79
  s_lshl_b32 s5, s76, 4
  s_add_u32 s5, s5, s77
  s_lshl_b32 s84, s5, 11
  s_mov_b32 s83, 3145728
  s_mov_b32 s87, 1835016
  s_lshr_b32 s86, s81, 1
  v_lshlrev_b32 v4, 4, v1
  v_lshlrev_b32 v5, 4, v1
  v_lshlrev_b32 v6, 4, v1
  v_lshlrev_b32 v7, 4, v1
  s_movk_i32 s13, 4096
  s_movk_i32 s95, 8192
  v_and_b32 v2, 31, v1
  v_lshlrev_b32 v8, 7, v2
L_82:
  s_mov_b32 s40, s38
  s_and_b32 s41, s39, 0xffff
  s_mov_b32 s42, 100663296
  s_mov_b32 s43, 0x00020000
  s_mov_b32 s72, s40
  s_mov_b32 s73, s41
  s_mov_b32 s74, s42
  s_mov_b32 s11, 0
  s_mov_b32 s15, 65536
  s_mul_i32 s5, s76, 16
  s_lshl_b32 s5, s5, 14
  s_add_u32 s5, s5, 3145728
  s_mov_b32 s8, 16384
  s_mov_b32 s10, 262144
  s_add_u32 s9, s5, s10
  s_mul_i32 s6, s76, s8
  s_add_u32 s7, s5, s6
  s_lshr_b32 s6, s6, 14
  s_lshl_b32 s90, 0x7f, s6
  s_lshr_b32 s4, s90, 16
  s_or_b32 s90, s90, s4
  s_and_b32 s90, s90, 0xffff
  s_lshl_b32 s91, s84, 1
  s_add_u32 s91, s91, s87
  s_mov_b32 s89, 200000
  s_mov_b32 exec_lo, s90
  s_mov_b32 exec_hi, 0
  buffer_load_dword v12, v8, s[40:43], s91 offen sc0 sc1
Lp_83:
  s_waitcnt vmcnt(0)
  v_cmp_ne_u32 vcc, 0, v12
  s_andn2_b32 s3, exec_lo, vcc_lo
  s_cbranch_scc0 Lp_84
  s_mov_b32 exec_lo, s3
  s_sleep 1
  buffer_load_dword v12, v8, s[40:43], s91 offen sc0 sc1
  s_sub_u32 s89, s89, 1
  s_cbranch_scc0 Lp_83
Lp_84:
  s_mov_b64 exec, -1
  s_mov_b32 s12, 0
  s_mov_b32 m0, s11
Ll_85:
  s_nop 0
  buffer_load_dwordx4 v4, s[40:43], s7 offen offset:0 sc1 lds
  buffer_load_dwordx4 v5, s[40:43], s7 offen offset:1024 sc1 lds
  buffer_load_dwordx4 v6, s[40:43], s7 offen offset:2048 sc1 lds
  buffer_load_dwordx4 v7, s[40:43], s7 offen offset:3072 sc1 lds
  s_add_u32 m0, s11, 4096
  s_nop 0
  s_add_u32 s5, s7, s13
  buffer_load_dwordx4 v4, s[40:43], s5 offen offset:0 sc1 lds
  buffer_load_dwordx4 v5, s[40:43], s5 offen offset:1024 sc1 lds
  buffer_load_dwordx4 v6, s[40:43], s5 offen offset:2048 sc1 lds
  buffer_load_dwordx4 v7, s[40:43], s5 offen offset:3072 sc1 lds
  s_add_u32 m0, s11, 8192
  s_nop 0
  s_add_u32 s3, s7, s95
  buffer_load_dwordx4 v4, s[40:43], s3 offen offset:0 sc1 lds
  buffer_load_dwordx4 v5, s[40:43], s3 offen offset:1024 sc1 lds
  buffer_load_dwordx4 v6, s[40:43], s3 offen offset:2048 sc1 lds
  buffer_load_dwordx4 v7, s[40:43], s3 offen offset:3072 sc1 lds
  s_add_u32 m0, s11, 12288
  s_nop 0
  s_add_u32 s5, s3, s13
  buffer_load_dwordx4 v4, s[40:43], s5 offen offset:0 sc1 lds
  s_add_u32 s7, s7, s8
  s_cmp_eq_u32 s7, s9
  s_cselect_b32 s4, s10, 0
  s_sub_u32 s7, s7, s4
  buffer_load_dwordx4 v5, s[40:43], s5 offen offset:1024 sc1 lds
  s_add_u32 s11, s11, 16384
  s_cmp_eq_u32 s11, s15
  s_cselect_b32 s4, 65536, 0
  s_sub_u32 s11, s11, s4
  buffer_load_dwordx4 v6, s[40:43], s5 offen offset:2048 sc1 lds
  s_add_u32 s12, s12, 1
  s_cmp_lg_u32 s12, 3
  buffer_load_dwordx4 v7, s[40:43], s5 offen offset:3072 sc1 lds
  s_mov_b32 m0, s11
  s_cbranch_scc1 Ll_85
  s_waitcnt vmcnt(32)
  s_barrier
  buffer_load_dwordx4 v4, s[40:43], s7 offen offset:0 sc1 lds
  buffer_load_dwordx4 v5, s[40:43], s7 offen offset:1024 sc1 lds
  buffer_load_dwordx4 v6, s[40:43], s7 offen offset:2048 sc1 lds
  buffer_load_dwordx4 v7, s[40:43], s7 offen offset:3072 sc1 lds
  s_add_u32 m0, s11, 8192
  s_add_u32 s3, s7, s95
  buffer_load_dwordx4 v4, s[40:43], s3 offen offset:0 sc1 lds
  s_add_u32 s7, s7, s8
  s_cmp_eq_u32 s7, s9
  s_cselect_b32 s4, s10, 0
  buffer_load_dwordx4 v5, s[40:43], s3 offen offset:1024 sc1 lds
  s_sub_u32 s7, s7, s4
  s_add_u32 s11, s11, 16384
  s_cmp_eq_u32 s11, s15
  buffer_load_dwordx4 v6, s[40:43], s3 offen offset:2048 sc1 lds
  s_cselect_b32 s4, 65536, 0
  s_sub_u32 s11, s11, s4
  s_add_u32 s12, s12, 1
  buffer_load_dwordx4 v7, s[40:43], s3 offen offset:3072 sc1 lds
  s_mov_b32 m0, s11
  s_waitcnt vmcnt(24)
  s_nop 0
  s_barrier
  buffer_load_dwordx4 v4, s[40:43], s7 offen offset:0 sc1 lds
  buffer_load_dwordx4 v5, s[40:43], s7 offen offset:1024 sc1 lds
  buffer_load_dwordx4 v6, s[40:43], s7 offen offset:2048 sc1 lds
  buffer_load_dwordx4 v7, s[40:43], s7 offen offset:3072 sc1 lds
Ll_89:
  s_add_u32 m0, s11, 8192
  s_nop 0
  s_add_u32 s3, s7, s95
  buffer_load_dwordx4 v4, s[40:43], s3 offen offset:0 sc1 lds
  s_add_u32 s7, s7, s8
  s_cmp_eq_u32 s7, s9
  s_cselect_b32 s4, s10, 0
  s_sub_u32 s7, s7, s4
  buffer_load_dwordx4 v5, s[40:43], s3 offen offset:1024 sc1 lds
  s_add_u32 s11, s11, 16384
  s_cmp_eq_u32 s11, s15
  s_cselect_b32 s4, 65536, 0
  s_sub_u32 s11, s11, s4
  buffer_load_dwordx4 v6, s[40:43], s3 offen offset:2048 sc1 lds
  s_add_u32 s12, s12, 1
  s_cmp_eq_u32 s12, 16
  buffer_load_dwordx4 v7, s[40:43], s3 offen offset:3072 sc1 lds
  s_mov_b32 m0, s11
  s_cbranch_scc1 Ll_90
  s_waitcnt vmcnt(16)
  s_barrier
  buffer_load_dwordx4 v4, s[40:43], s7 offen offset:0 sc1 lds
  buffer_load_dwordx4 v5, s[40:43], s7 offen offset:1024 sc1 lds
  buffer_load_dwordx4 v6, s[40:43], s7 offen offset:2048 sc1 lds
  buffer_load_dwordx4 v7, s[40:43], s7 offen offset:3072 sc1 lds
  s_branch Ll_89
  s_nop 0
Ll_90:
  s_waitcnt vmcnt(16)
  s_barrier
  s_waitcnt vmcnt(8)
  s_barrier
  s_waitcnt vmcnt(0)
  s_barrier
  s_barrier
  s_mov_b32 s11, 0
  s_mov_b32 s15, 65536
  s_mul_i32 s5, s76, 16
  s_lshl_b32 s5, s5, 14
  s_add_u32 s5, s5, 7340032
  v_add_u32 v9, s76, v1
  v_and_b32 v9, 15, v9
  v_mov_b32 v2, s76
  v_cmp_eq_u32 vcc, s78, v9
  s_nop 1
  v_cndmask_b32 v9, v9, v2, vcc
  v_writelane_b32 v9, s78, 0
  v_lshl_add_u32 v9, v9, 14, s5
  s_lshl_b32 s6, s76, Lz1-Lz0+14
  v_readlane_b32 s7, v9, 1
  s_mov_b32 s11, 16384
  s_lshr_b32 s6, s6, 14
  s_lshl_b32 s90, 0x3f, s6
  s_lshr_b32 s4, s90, 16
  s_or_b32 s90, s90, s4
  s_and_b32 s90, s90, 0xffff
  s_add_u32 s91, s91, Lz1-Lz0+4
  s_bitset0_b32 s90, s78
  s_barrier
  s_mov_b32 s89, 200000
  s_mov_b32 exec_lo, s90
  s_mov_b32 exec_hi, 0
  buffer_load_dword v12, v8, s[40:43], s91 offen sc0 sc1
Lp_91:
  s_waitcnt vmcnt(0)
  v_cmp_ne_u32 vcc, 0, v12
  s_andn2_b32 s3, exec_lo, vcc_lo
  s_cbranch_scc0 Lp_92
  s_mov_b32 exec_lo, s3
  s_sleep 1
  buffer_load_dword v12, v8, s[40:43], s91 offen sc0 sc1
  s_sub_u32 s89, s89, 1
  s_cbranch_scc0 Lp_91
Lp_92:
  s_mov_b64 exec, -1
  s_mov_b32 s12, 1
  s_mov_b32 m0, s11
Ll_93:
  s_nop 0
  buffer_load_dwordx4 v4, s[72:75], s7 offen offset:0 sc1 lds
  buffer_load_dwordx4 v5, s[72:75], s7 offen offset:1024 sc1 lds
  buffer_load_dwordx4 v6, s[72:75], s7 offen offset:2048 sc1 lds
  buffer_load_dwordx4 v7, s[72:75], s7 offen offset:3072 sc1 lds
  s_add_u32 m0, s11, 4096
  s_nop 0
  s_add_u32 s5, s7, s13
  buffer_load_dwordx4 v4, s[72:75], s5 offen offset:0 sc1 lds
  buffer_load_dwordx4 v5, s[72:75], s5 offen offset:1024 sc1 lds
  buffer_load_dwordx4 v6, s[72:75], s5 offen offset:2048 sc1 lds
  buffer_load_dwordx4 v7, s[72:75], s5 offen offset:3072 sc1 lds
  s_add_u32 m0, s11, 8192
  s_nop 0
  s_add_u32 s3, s7, s95
  buffer_load_dwordx4 v4, s[72:75], s3 offen offset:0 sc1 lds
  buffer_load_dwordx4 v5, s[72:75], s3 offen offset:1024 sc1 lds
  buffer_load_dwordx4 v6, s[72:75], s3 offen offset:2048 sc1 lds
  buffer_load_dwordx4 v7, s[72:75], s3 offen offset:3072 sc1 lds
  s_add_u32 m0, s11, 12288
  s_add_u32 s5, s3, s13
  buffer_load_dwordx4 v4, s[72:75], s5 offen offset:0 sc1 lds
  s_add_u32 s12, s12, 1
  v_readlane_b32 s7, v9, s12
  s_add_u32 s11, s11, 16384
  buffer_load_dwordx4 v5, s[72:75], s5 offen offset:1024 sc1 lds
  s_cmp_eq_u32 s11, s15
  s_cselect_b32 s4, 65536, 0
  s_sub_u32 s11, s11, s4
  buffer_load_dwordx4 v6, s[72:75], s5 offen offset:2048 sc1 lds
  s_cmp_lg_u32 s12, Lz1-Lz0+4
  buffer_load_dwordx4 v7, s[72:75], s5 offen offset:3072 sc1 lds
  s_mov_b32 m0, s11
  s_cbranch_scc1 Ll_93
  s_waitcnt vmcnt(32)
  s_barrier
  buffer_load_dwordx4 v4, s[72:75], s7 offen offset:0 sc1 lds
  buffer_load_dwordx4 v5, s[72:75], s7 offen offset:1024 sc1 lds
  buffer_load_dwordx4 v6, s[72:75], s7 offen offset:2048 sc1 lds
  buffer_load_dwordx4 v7, s[72:75], s7 offen offset:3072 sc1 lds
Ll_97:
  s_add_u32 m0, s11, 4096
  s_nop 0
  s_add_u32 s5, s7, s13
  buffer_load_dwordx4 v4, s[72:75], s5 offen offset:0 sc1 lds
  buffer_load_dwordx4 v5, s[72:75], s5 offen offset:1024 sc1 lds
  buffer_load_dwordx4 v6, s[72:75], s5 offen offset:2048 sc1 lds
  buffer_load_dwordx4 v7, s[72:75], s5 offen offset:3072 sc1 lds
  s_add_u32 m0, s11, 8192
  s_nop 0
  s_add_u32 s3, s7, s95
  buffer_load_dwordx4 v4, s[72:75], s3 offen offset:0 sc1 lds
  buffer_load_dwordx4 v5, s[72:75], s3 offen offset:1024 sc1 lds
  buffer_load_dwordx4 v6, s[72:75], s3 offen offset:2048 sc1 lds
  buffer_load_dwordx4 v7, s[72:75], s3 offen offset:3072 sc1 lds
  s_add_u32 m0, s11, 12288
  s_add_u32 s5, s3, s13
  buffer_load_dwordx4 v4, s[72:75], s5 offen offset:0 sc1 lds
  s_add_u32 s12, s12, 1
  v_readlane_b32 s7, v9, s12
  s_add_u32 s11, s11, 16384
  buffer_load_dwordx4 v5, s[72:75], s5 offen offset:1024 sc1 lds
  s_cmp_eq_u32 s11, s15
  s_cselect_b32 s4, 65536, 0
  s_sub_u32 s11, s11, s4
  buffer_load_dwordx4 v6, s[72:75], s5 offen offset:2048 sc1 lds
  s_cmp_eq_u32 s12, Lz1-Lz0+16
  buffer_load_dwordx4 v7, s[72:75], s5 offen offset:3072 sc1 lds
  s_mov_b32 m0, s11
  s_cbranch_scc1 Ll_98
  s_waitcnt vmcnt(32)
  s_barrier
  buffer_load_dwordx4 v4, s[72:75], s7 offen offset:0 sc1 lds
  buffer_load_dwordx4 v5, s[72:75], s7 offen offset:1024 sc1 lds
  buffer_load_dwordx4 v6, s[72:75], s7 offen offset:2048 sc1 lds
  buffer_load_dwordx4 v7, s[72:75], s7 offen offset:3072 sc1 lds
  s_branch Ll_97
  s_nop 0
Ll_98:
  s_waitcnt vmcnt(32)
  s_barrier
  s_waitcnt vmcnt(16)
  s_barrier
  s_waitcnt vmcnt(0)
  s_barrier
  s_barrier
  s_mov_b32 s11, 0
  s_mov_b32 s15, 65536
  s_mul_i32 s5, s76, 56
  s_mul_i32 s4, s79, 28
  s_add_u32 s5, s5, s4
  s_lshl_b32 s5, s5, 14
  s_add_u32 s5, s5, 11534336
  v_subrev_u32 v2, 4, v1
  v_cmp_le_u32 vcc, 28, v1
  s_nop 1
  v_cndmask_b32 v10, v1, v2, vcc
  v_subrev_u32 v3, 3, v10
  v_mov_b32 v9, 4
  v_cmp_le_u32 vcc, 14, v10
  v_subrev_u32 v2, 14, v10
  s_nop 0
  v_cndmask_b32 v3, v3, v2, vcc
  v_cndmask_b32_e64 v9, v9, 12, vcc
  v_cmp_le_u32 vcc, 21, v10
  v_subrev_u32 v2, 21, v10
  s_nop 0
  v_cndmask_b32 v3, v3, v2, vcc
  v_cndmask_b32_e64 v9, v9, 20, vcc
  s_sub_u32 s4, s80, s76
  s_and_b32 s4, s4, 7
  v_cmp_le_u32 vcc, s4, v3
  v_mov_b32 v2, s76
  s_nop 0
  v_addc_co_u32 v3, vcc, v3, v2, vcc
  v_and_b32 v3, 7, v3
  v_add_u32 v9, v9, v3
  v_add_u32 v2, v2, v1
  v_and_b32 v2, 3, v2
  v_subrev_u32 v3, 10, v1
  v_cmp_gt_u32 vcc, 4, v3
  s_nop 1
  v_cndmask_b32 v9, v9, v2, vcc
  s_add_u32 s4, s80, Lz1-Lz0+4
  v_lshl_add_u32 v2, v1, 3, s4
  v_cmp_gt_u32 vcc, 3, v1
  s_nop 1
  v_cndmask_b32_e64 v9, v9, v2, vcc
  v_lshl_add_u32 v9, v9, 14, s5
  s_mul_i32 s4, s79, 917504
  s_sub_u32 s4, 458752, s4
  v_add_u32_e64 v2, s4, v9
  v_cmp_le_u32 vcc, 28, v1
  s_nop 1
  v_cndmask_b32 v9, v9, v2, vcc
  s_nop 0
  v_readlane_b32 s7, v9, 3
  s_mov_b32 s11, 49152
  s_add_u32 s91, s91, 4
  s_lshl_b32 s4, s79, 3
  s_lshl_b32 s90, 0xff, s4
  s_bitset0_b32 s90, s77
  s_mov_b32 s89, 200000
  s_mov_b32 exec_lo, s90
  s_mov_b32 exec_hi, Lz1-Lz0+0
  buffer_load_dword v12, v8, s[40:43], s91 offen sc0 sc1
Lp_99:
  s_waitcnt vmcnt(0)
  v_cmp_ne_u32 vcc, 0, v12
  s_andn2_b32 s3, exec_lo, vcc_lo
  s_cbranch_scc0 Lp_100
  s_mov_b32 exec_lo, s3
  s_sleep 1
  buffer_load_dword v12, v8, s[40:43], s91 offen sc0 sc1
  s_sub_u32 s89, s89, 1
  s_cbranch_scc0 Lp_99
Lp_100:
  s_mov_b64 exec, -1
  s_mov_b32 s12, 3
  s_mov_b32 m0, s11
Ll_101:
  s_nop 0
  buffer_load_dwordx4 v4, s[40:43], s7 offen offset:0 sc1 lds
  buffer_load_dwordx4 v5, s[40:43], s7 offen offset:1024 sc1 lds
  buffer_load_dwordx4 v6, s[40:43], s7 offen offset:2048 sc1 lds
  buffer_load_dwordx4 v7, s[40:43], s7 offen offset:3072 sc1 lds
  s_add_u32 m0, s11, 4096
  s_nop 0
  s_add_u32 s5, s7, s13
  buffer_load_dwordx4 v4, s[40:43], s5 offen offset:0 sc1 lds
  buffer_load_dwordx4 v5, s[40:43], s5 offen offset:1024 sc1 lds
  buffer_load_dwordx4 v6, s[40:43], s5 offen offset:2048 sc1 lds
  buffer_load_dwordx4 v7, s[40:43], s5 offen offset:3072 sc1 lds
  s_add_u32 m0, s11, 8192
  s_nop 0
  s_add_u32 s3, s7, s95
  buffer_load_dwordx4 v4, s[40:43], s3 offen offset:0 sc1 lds
  buffer_load_dwordx4 v5, s[40:43], s3 offen offset:1024 sc1 lds
  buffer_load_dwordx4 v6, s[40:43], s3 offen offset:2048 sc1 lds
  buffer_load_dwordx4 v7, s[40:43], s3 offen offset:3072 sc1 lds
  s_add_u32 m0, s11, 12288
  s_add_u32 s5, s3, s13
  buffer_load_dwordx4 v4, s[40:43], s5 offen offset:0 sc1 lds
  s_add_u32 s12, s12, 1
  v_readlane_b32 s7, v9, s12
  s_add_u32 s11, s11, 16384
  buffer_load_dwordx4 v5, s[40:43], s5 offen offset:1024 sc1 lds
  s_cmp_eq_u32 s11, s15
  s_cselect_b32 s4, 65536, 0
  s_sub_u32 s11, s11, s4
  buffer_load_dwordx4 v6, s[40:43], s5 offen offset:2048 sc1 lds
  s_cmp_lg_u32 s12, Lz1-Lz0+4
  buffer_load_dwordx4 v7, s[40:43], s5 offen offset:3072 sc1 lds
  s_mov_b32 m0, s11
  s_cbranch_scc1 Ll_101
  s_waitcnt vmcnt(48)
  s_barrier
  s_waitcnt vmcnt(32)
  s_barrier
  buffer_load_dwordx4 v4, s[40:43], s7 offen offset:0 sc1 lds
  buffer_load_dwordx4 v5, s[40:43], s7 offen offset:1024 sc1 lds
  buffer_load_dwordx4 v6, s[40:43], s7 offen offset:2048 sc1 lds
  buffer_load_dwordx4 v7, s[40:43], s7 offen offset:3072 sc1 lds
Ll_105:
  s_add_u32 m0, s11, 4096
  s_nop 0
  s_add_u32 s5, s7, s13
  buffer_load_dwordx4 v4, s[40:43], s5 offen offset:0 sc1 lds
  buffer_load_dwordx4 v5, s[40:43], s5 offen offset:1024 sc1 lds
  buffer_load_dwordx4 v6, s[40:43], s5 offen offset:2048 sc1 lds
  buffer_load_dwordx4 v7, s[40:43], s5 offen offset:3072 sc1 lds
  s_add_u32 m0, s11, 8192
  s_nop 0
  s_add_u32 s3, s7, s95
  buffer_load_dwordx4 v4, s[40:43], s3 offen offset:0 sc1 lds
  buffer_load_dwordx4 v5, s[40:43], s3 offen offset:1024 sc1 lds
  buffer_load_dwordx4 v6, s[40:43], s3 offen offset:2048 sc1 lds
  buffer_load_dwordx4 v7, s[40:43], s3 offen offset:3072 sc1 lds
  s_add_u32 m0, s11, 12288
  s_add_u32 s5, s3, s13
  buffer_load_dwordx4 v4, s[40:43], s5 offen offset:0 sc1 lds
  s_add_u32 s12, s12, 1
  v_readlane_b32 s7, v9, s12
  s_add_u32 s11, s11, 16384
  buffer_load_dwordx4 v5, s[40:43], s5 offen offset:1024 sc1 lds
  s_cmp_eq_u32 s11, s15
  s_cselect_b32 s4, 65536, 0
  s_sub_u32 s11, s11, s4
  buffer_load_dwordx4 v6, s[40:43], s5 offen offset:2048 sc1 lds
  s_cmp_eq_u32 s12, Lz1-Lz0+32
  buffer_load_dwordx4 v7, s[40:43], s5 offen offset:3072 sc1 lds
  s_mov_b32 m0, s11
  s_cbranch_scc1 Ll_106
  s_waitcnt vmcnt(32)
  s_barrier
  buffer_load_dwordx4 v4, s[40:43], s7 offen offset:0 sc1 lds
  buffer_load_dwordx4 v5, s[40:43], s7 offen offset:1024 sc1 lds
  buffer_load_dwordx4 v6, s[40:43], s7 offen offset:2048 sc1 lds
  buffer_load_dwordx4 v7, s[40:43], s7 offen offset:3072 sc1 lds
  s_branch Ll_105
Ll_106:
  s_waitcnt vmcnt(32)
  s_barrier
  s_waitcnt vmcnt(16)
  s_barrier
  s_waitcnt vmcnt(0)
  s_barrier
  s_barrier
  s_cmp_lg_u32 s82, 0
  s_cbranch_scc1 L_lend
  s_mul_i32 s5, s76, 16
  s_lshl_b32 s5, s5, 14
  s_add_u32 s5, s5, 35651584
  s_mov_b32 s8, 16384
  s_mov_b32 s10, 262144
  s_add_u32 s9, s5, s10
  s_mul_i32 s6, s76, 11
  s_lshr_b32 s6, s6, Lz1-Lz0+5
  s_mul_i32 s6, s6, 49152
  s_add_u32 s7, s5, s6
  s_add_u32 s91, s91, 8
  s_lshr_b32 s6, s6, 14
  s_lshl_b32 s90, 0x1f, s6
  s_lshr_b32 s4, s90, 16
  s_or_b32 s90, s90, s4
  s_and_b32 s90, s90, 0xffff
  s_mov_b32 s82, 1
  s_add_u32 s83, s83, 0
  s_add_u32 s87, s87, Lz1-Lz0+32
  s_mov_b32 s89, 200000
  s_mov_b32 exec_lo, s90
  s_mov_b32 exec_hi, 0
  buffer_load_dword v12, v8, s[40:43], s91 offen sc0 sc1
Lp_107:
  s_waitcnt vmcnt(0)
  v_cmp_ne_u32 vcc, 0, v12
  s_andn2_b32 s3, exec_lo, vcc_lo
  s_cbranch_scc0 Lp_108
  s_mov_b32 exec_lo, s3
  s_sleep 1
  buffer_load_dword v12, v8, s[40:43], s91 offen sc0 sc1
  s_sub_u32 s89, s89, 1
  s_cbranch_scc0 Lp_107
Lp_108:
  s_mov_b64 exec, -1
  s_branch L_xlayer
  s_nop 0
L_s1:
  v_mov_b32 v11, 1
  v_mov_b32 v2, 156416
  ds_write_b128 v2, v[24:27]
  v_and_b32 v2, 31, v1
  v_lshlrev_b32 v5, 7, v2
  v_lshlrev_b32 v10, 3, v2
  v_lshrrev_b32 v3, 5, v1
  v_mul_u32_u24 v3, 320, v3
  v_add_u32_e64 v10, v3, v10
  v_add_u32 v10, 151552, v10
  v_bfe_u32 v3, v1, 3, 1
  v_and_b32 v2, 7, v1
  v_lshlrev_b32 v12, 9, v3
  v_lshl_add_u32 v12, v2, 4, v12
  v_mul_u32_u24 v3, 320, v3
  v_lshl_add_u32 v13, v2, 3, v3
  v_add_u32 v13, 151808, v13
  v_and_b32 v2, 15, v1
  v_lshlrev_b32 v8, 4, v2
  v_lshlrev_b32 v15, 6, v2
  v_and_b32 v3, 48, v1
  v_add_u32 v15, v15, v3
  v_and_b32 v2, 14, v1
  v_lshlrev_b32 v6, 2, v2
  v_lshlrev_b32 v14, 16, v1
  s_lshl_b32 s4, s77, 12
  s_lshl_b32 s5, s76, 7
  s_add_u32 s4, s4, s5
  v_add_u32 v14, s4, v14
  v_lshrrev_b32 v2, 2, v1
  v_lshlrev_b32 v22, 7, v2
  v_lshlrev_b32 v96, 6, v2
  v_and_b32 v2, 3, v1
  v_lshl_add_u32 v22, v2, 3, v22
  v_lshl_add_u32 v96, v2, 3, v96
  v_add_u32 v22, 65536, v22
  v_add_u32 v96, 90112, v96
  v_bfe_u32 v3, v1, 3, 2
  v_xor_b32_e64 v2, 0, v3
  v_lshl_add_u32 v16, v2, 5, v22
  v_xor_b32_e64 v2, 1, v3
  v_lshl_add_u32 v17, v2, 5, v22
  v_xor_b32_e64 v2, 2, v3
  v_lshl_add_u32 v18, v2, 5, v22
  v_xor_b32_e64 v2, 3, v3
  v_lshl_add_u32 v19, v2, 5, v22
  v_bfe_u32 v3, v1, 4, 1
  v_xor_b32_e64 v2, 0, v3
  v_lshl_add_u32 v20, v2, 5, v96
  v_xor_b32_e64 v2, 1, v3
  v_lshl_add_u32 v21, v2, 5, v96
  v_mov_b32 v22, 0x3f803f80
  s_mul_i32 s4, s76, 11
  s_lshr_b32 s4, s4, 5
  s_mul_i32 s4, s4, 3
  s_sub_u32 s14, s76, s4
  s_mov_b32 s15, 32768
  s_mul_i32 s4, s14, 24576
  v_add_u32 v16, s4, v16
  v_add_u32 v17, s4, v17
  v_add_u32 v18, s4, v18
  v_add_u32 v19, s4, v19
  s_mov_b32 s98, 0x00010001
  s_mov_b32 s99, 0x00010001
  v_cndmask_b32_e64 v200, 0, v22, s[98:99]
  v_cndmask_b32_e64 v201, 0, v22, s[98:99]
  v_cndmask_b32_e64 v202, 0, v22, s[98:99]
  v_cndmask_b32_e64 v203, 0, v22, s[98:99]
  s_nop 0
  s_lshl_b64 s[98:99], s[98:99], 1
  v_cndmask_b32_e64 v204, 0, v22, s[98:99]
  v_cndmask_b32_e64 v205, 0, v22, s[98:99]
  v_cndmask_b32_e64 v206, 0, v22, s[98:99]
  v_cndmask_b32_e64 v207, 0, v22, s[98:99]
  s_nop 0
  s_lshl_b64 s[98:99], s[98:99], 1
  v_cndmask_b32_e64 v208, 0, v22, s[98:99]
  v_cndmask_b32_e64 v209, 0, v22, s[98:99]
  v_cndmask_b32_e64 v210, 0, v22, s[98:99]
  v_cndmask_b32_e64 v211, 0, v22, s[98:99]
  s_nop 0
  s_lshl_b64 s[98:99], s[98:99], 1
  v_cndmask_b32_e64 v212, 0, v22, s[98:99]
  v_cndmask_b32_e64 v213, 0, v22, s[98:99]
  v_cndmask_b32_e64 v214, 0, v22, s[98:99]
  v_cndmask_b32_e64 v215, 0, v22, s[98:99]
  s_nop 0
  s_lshl_b64 s[98:99], s[98:99], 1
  v_cndmask_b32_e64 v216, 0, v22, s[98:99]
  v_cndmask_b32_e64 v217, 0, v22, s[98:99]
  v_cndmask_b32_e64 v218, 0, v22, s[98:99]
  v_cndmask_b32_e64 v219, 0, v22, s[98:99]
  s_nop 0
  s_lshl_b64 s[98:99], s[98:99], 1
  v_cndmask_b32_e64 v220, 0, v22, s[98:99]
  v_cndmask_b32_e64 v221, 0, v22, s[98:99]
  v_cndmask_b32_e64 v222, 0, v22, s[98:99]
  v_cndmask_b32_e64 v223, 0, v22, s[98:99]
  s_nop 0
  s_lshl_b64 s[98:99], s[98:99], 1
  v_cndmask_b32_e64 v224, 0, v22, s[98:99]
  v_cndmask_b32_e64 v225, 0, v22, s[98:99]
  v_cndmask_b32_e64 v226, 0, v22, s[98:99]
  v_cndmask_b32_e64 v227, 0, v22, s[98:99]
  s_nop 0
  s_lshl_b64 s[98:99], s[98:99], 1
  v_cndmask_b32_e64 v228, 0, v22, s[98:99]
  v_cndmask_b32_e64 v229, 0, v22, s[98:99]
  v_cndmask_b32_e64 v230, 0, v22, s[98:99]
  v_cndmask_b32_e64 v231, 0, v22, s[98:99]
  s_nop 0
  s_lshl_b64 s[98:99], s[98:99], 1
  v_cndmask_b32_e64 v232, 0, v22, s[98:99]
  v_cndmask_b32_e64 v233, 0, v22, s[98:99]
  v_cndmask_b32_e64 v234, 0, v22, s[98:99]
  v_cndmask_b32_e64 v235, 0, v22, s[98:99]
  s_nop 0
  s_lshl_b64 s[98:99], s[98:99], 1
  v_cndmask_b32_e64 v236, 0, v22, s[98:99]
  v_cndmask_b32_e64 v237, 0, v22, s[98:99]
  v_cndmask_b32_e64 v238, 0, v22, s[98:99]
  v_cndmask_b32_e64 v239, 0, v22, s[98:99]
  s_nop 0
  s_lshl_b64 s[98:99], s[98:99], 1
  v_cndmask_b32_e64 v240, 0, v22, s[98:99]
  v_cndmask_b32_e64 v241, 0, v22, s[98:99]
  v_cndmask_b32_e64 v242, 0, v22, s[98:99]
  v_cndmask_b32_e64 v243, 0, v22, s[98:99]
  s_nop 0
  s_lshl_b64 s[98:99], s[98:99], 1
  v_cndmask_b32_e64 v244, 0, v22, s[98:99]
  v_cndmask_b32_e64 v245, 0, v22, s[98:99]
  v_cndmask_b32_e64 v246, 0, v22, s[98:99]
  v_cndmask_b32_e64 v247, 0, v22, s[98:99]
  s_lshl_b64 s[98:99], s[98:99], 1
  s_mov_b32 s56, s24
  s_and_b32 s57, s25, 0xffff
  s_mov_b32 s58, 7340032
  s_mov_b32 s59, 0x00020000
  s_nop 0
  s_mov_b32 s60, s28
  s_and_b32 s61, s29, 0xffff
  s_mov_b32 s62, 7340032
  s_mov_b32 s63, 0x00020000
  s_mul_i32 s12, s84, Lz1-Lz0+14
  s_add_u32 s12, s12, 20480
  s_mov_b32 s13, s12
  v_lshlrev_b32 v110, 7, v1
  s_mov_b32 s8, 0x00500005
  s_mov_b32 s9, 0x50000500
L_slayer:
  s_barrier
  s_cmp_lg_u32 s82, Lz1-Lz0+0
  s_cbranch_scc1 L_109
  buffer_load_dwordx4 v[128:131], v108, s[44:47], s7 offen offset:0
  buffer_load_dwordx4 v[132:135], v108, s[44:47], s7 offen offset:128
  buffer_load_dwordx4 v[136:139], v108, s[44:47], s7 offen offset:256
  buffer_load_dwordx4 v[140:143], v108, s[44:47], s7 offen offset:384
  buffer_load_dwordx4 v[144:147], v108, s[44:47], s7 offen offset:512
  buffer_load_dwordx4 v[148:151], v108, s[44:47], s7 offen offset:640
  buffer_load_dwordx4 v[152:155], v108, s[44:47], s7 offen offset:768
  buffer_load_dwordx4 v[156:159], v108, s[44:47], s7 offen offset:896
  buffer_load_dwordx4 v[160:163], v108, s[44:47], s7 offen offset:1024
  buffer_load_dwordx4 v[164:167], v108, s[44:47], s7 offen offset:1152
  buffer_load_dwordx4 v[168:171], v108, s[44:47], s7 offen offset:1280
  buffer_load_dwordx4 v[172:175], v108, s[44:47], s7 offen offset:1408
  buffer_load_dwordx4 v[176:179], v108, s[44:47], s7 offen offset:1536
  buffer_load_dwordx4 v[180:183], v108, s[44:47], s7 offen offset:1664
  buffer_load_dwordx4 v[184:187], v108, s[44:47], s7 offen offset:1792
  buffer_load_dwordx4 v[188:191], v108, s[44:47], s7 offen offset:1920
  s_waitcnt vmcnt(16)
  s_lshl_b32 s4, s76, 4
  s_mov_b64 exec, 1
  buffer_atomic_add v11, v24, s[68:71], s4 offen sc1
  s_mov_b64 exec, -1
  s_branch L_110
L_109:
  s_lshl_b32 s91, s84, 1
  s_add_u32 s91, s91, s87
  s_sub_u32 s91, s91, 16
  s_mov_b32 s16, 0xffff
  s_mov_b32 exec_lo, s16
  s_mov_b32 exec_hi, 0
  buffer_load_dword v7, v5, s[40:43], s91 offen sc0 sc1
  s_mov_b64 exec, -1
L_110:
  s_cmp_le_u32 s14, 0
  s_cbranch_scc1 L_111
  s_barrier
L_111:
  s_cmp_le_u32 s14, Lz1-Lz0+1
  s_cbranch_scc1 L_112
  s_barrier
L_112:
  s_cmp_lg_u32 s82, 0
  s_cbranch_scc1 L_113
  ds_read_b64_tr_b16 v[32:33], v16 offset:0
  ds_read_b64_tr_b16 v[34:35], v16 offset:2048
  ds_read_b64_tr_b16 v[36:37], v17 offset:0
  ds_read_b64_tr_b16 v[38:39], v17 offset:2048
  ds_read_b64_tr_b16 v[40:41], v18 offset:0
  ds_read_b64_tr_b16 v[42:43], v18 offset:2048
  ds_read_b64_tr_b16 v[44:45], v19 offset:0
  ds_read_b64_tr_b16 v[46:47], v19 offset:2048
  ds_read_b64_tr_b16 v[48:49], v16 offset:4096
  ds_read_b64_tr_b16 v[50:51], v16 offset:6144
  ds_read_b64_tr_b16 v[52:53], v17 offset:4096
  ds_read_b64_tr_b16 v[54:55], v17 offset:6144
  s_nop 0
  s_waitcnt lgkmcnt(4)
  ds_read_b64_tr_b16 v[56:57], v18 offset:4096
  ds_read_b64_tr_b16 v[58:59], v18 offset:6144
  ds_read_b64_tr_b16 v[60:61], v19 offset:4096
  ds_read_b64_tr_b16 v[62:63], v19 offset:6144
  v_add_u32 v16, 8192, v16
  v_add_u32 v17, 8192, v17
  v_add_u32 v18, 8192, v18
  v_add_u32 v19, 8192, v19
  s_nop 0
  s_waitcnt lgkmcnt(2)
  ds_read_b64_tr_b16 v[64:65], v16 offset:0
  ds_read_b64_tr_b16 v[66:67], v16 offset:2048
  ds_read_b64_tr_b16 v[68:69], v17 offset:0
  ds_read_b64_tr_b16 v[70:71], v17 offset:2048
  ds_read_b64_tr_b16 v[72:73], v18 offset:0
  ds_read_b64_tr_b16 v[74:75], v18 offset:2048
  ds_read_b64_tr_b16 v[76:77], v19 offset:0
  ds_read_b64_tr_b16 v[78:79], v19 offset:2048
  ds_read_b64_tr_b16 v[80:81], v16 offset:4096
  ds_read_b64_tr_b16 v[82:83], v16 offset:6144
  ds_read_b64_tr_b16 v[84:85], v17 offset:4096
  ds_read_b64_tr_b16 v[86:87], v17 offset:6144
  s_nop 0
  s_waitcnt lgkmcnt(4)
  ds_read_b64_tr_b16 v[88:89], v18 offset:4096
  ds_read_b64_tr_b16 v[90:91], v18 offset:6144
  ds_read_b64_tr_b16 v[92:93], v19 offset:4096
  ds_read_b64_tr_b16 v[94:95], v19 offset:6144
  v_add_u32 v16, 8192, v16
  v_add_u32 v17, 8192, v17
  v_add_u32 v18, 8192, v18
  v_add_u32 v19, 8192, v19
  v_mfma_f32_16x16x32_bf16 v[28:31], v[32:35], v[200:203], 0
  v_mfma_f32_16x16x32_bf16 v[28:31], v[36:39], v[204:207], v[28:31]
  v_mfma_f32_16x16x32_bf16 v[28:31], v[40:43], v[208:211], v[28:31]
  v_mfma_f32_16x16x32_bf16 v[28:31], v[44:47], v[212:215], v[28:31]
  v_mfma_f32_16x16x32_bf16 v[28:31], v[48:51], v[200:203], v[28:31]
  v_mfma_f32_16x16x32_bf16 v[28:31], v[52:55], v[204:207], v[28:31]
  v_mfma_f32_16x16x32_bf16 v[28:31], v[56:59], v[208:211], v[28:31]
  v_mfma_f32_16x16x32_bf16 v[28:31], v[60:63], v[212:215], v[28:31]
  s_nop 0
  s_waitcnt lgkmcnt(2)
  ds_read_b64_tr_b16 v[32:33], v16 offset:0
  ds_read_b64_tr_b16 v[34:35], v16 offset:2048
  ds_read_b64_tr_b16 v[36:37], v17 offset:0
  ds_read_b64_tr_b16 v[38:39], v17 offset:2048
  ds_read_b64_tr_b16 v[40:41], v18 offset:0
  ds_read_b64_tr_b16 v[42:43], v18 offset:2048
  ds_read_b64_tr_b16 v[44:45], v19 offset:0
  ds_read_b64_tr_b16 v[46:47], v19 offset:2048
  ds_read_b64_tr_b16 v[48:49], v16 offset:4096
  ds_read_b64_tr_b16 v[50:51], v16 offset:6144
  ds_read_b64_tr_b16 v[52:53], v17 offset:4096
  ds_read_b64_tr_b16 v[54:55], v17 offset:6144
  s_nop 0
  s_waitcnt lgkmcnt(4)
  ds_read_b64_tr_b16 v[56:57], v18 offset:4096
  ds_read_b64_tr_b16 v[58:59], v18 offset:6144
  ds_read_b64_tr_b16 v[60:61], v19 offset:4096
  ds_read_b64_tr_b16 v[62:63], v19 offset:6144
  v_mfma_f32_16x16x32_bf16 v[28:31], v[64:67], v[216:219], v[28:31]
  v_mfma_f32_16x16x32_bf16 v[28:31], v[68:71], v[220:223], v[28:31]
  v_mfma_f32_16x16x32_bf16 v[28:31], v[72:75], v[224:227], v[28:31]
  v_mfma_f32_16x16x32_bf16 v[28:31], v[76:79], v[228:231], v[28:31]
  v_mfma_f32_16x16x32_bf16 v[28:31], v[80:83], v[216:219], v[28:31]
  v_mfma_f32_16x16x32_bf16 v[28:31], v[84:87], v[220:223], v[28:31]
  v_mfma_f32_16x16x32_bf16 v[28:31], v[88:91], v[224:227], v[28:31]
  v_mfma_f32_16x16x32_bf16 v[28:31], v[92:95], v[228:231], v[28:31]
  s_waitcnt lgkmcnt(0)
L_113:
  s_barrier
  s_cmp_lg_u32 s82, 0
  s_cbranch_scc1 L_115
  v_mfma_f32_16x16x32_bf16 v[28:31], v[32:35], v[232:235], v[28:31]
  v_mfma_f32_16x16x32_bf16 v[28:31], v[36:39], v[236:239], v[28:31]
  v_mfma_f32_16x16x32_bf16 v[28:31], v[40:43], v[240:243], v[28:31]
  v_mfma_f32_16x16x32_bf16 v[28:31], v[44:47], v[244:247], v[28:31]
  v_mfma_f32_16x16x32_bf16 v[28:31], v[48:51], v[232:235], v[28:31]
  v_mfma_f32_16x16x32_bf16 v[28:31], v[52:55], v[236:239], v[28:31]
  v_mfma_f32_16x16x32_bf16 v[28:31], v[56:59], v[240:243], v[28:31]
  v_mfma_f32_16x16x32_bf16 v[28:31], v[60:63], v[244:247], v[28:31]
  s_lshl_b32 s5, s77, 14
  s_lshl_b32 s4, s76, 10
  s_add_u32 s5, s5, s4
  s_add_u32 s5, s5, 1114112
  s_nop 3
  buffer_store_dwordx4 v[28:31], v15, s[40:43], s5 offen sc0 sc1
  s_branch L_116
L_115:
  s_waitcnt vmcnt(0)
  s_mov_b32 s89, 200000
  s_mov_b32 exec_lo, s16
  s_mov_b32 exec_hi, 0
  s_branch Lp_118
Lp_117:
  buffer_load_dword v7, v5, s[40:43], s91 offen sc0 sc1
  s_waitcnt vmcnt(0)
Lp_118:
  v_cmp_ne_u32 vcc, 0, v7
  s_andn2_b32 s3, s16, vcc_lo
  s_cbranch_scc0 Lp_119
  s_sleep 1
  s_sub_u32 s89, s89, 1
  s_cbranch_scc0 Lp_117
Lp_119:
  s_mov_b64 exec, -1
  s_add_u32 s5, s84, s92
  buffer_load_dwordx2 v[96:97], v6, s[40:43], s5 offen offset:0 sc1
  buffer_load_dwordx2 v[98:99], v6, s[40:43], s5 offen offset:512 sc1
  buffer_load_dwordx2 v[100:101], v6, s[40:43], s5 offen offset:1024 sc1
  buffer_load_dwordx2 v[102:103], v6, s[40:43], s5 offen offset:1536 sc1
L_116:
  s_barrier
  s_barrier
  s_cmp_gt_u32 s14, 0
  s_cbranch_scc1 L_120
  s_barrier
L_120:
  s_cmp_gt_u32 s14, 1
  s_cbranch_scc1 L_121
  s_barrier
L_121:
  s_cmp_lg_u32 s82, 0
  s_cbranch_scc1 L_122
  s_waitcnt vmcnt(2)
  buffer_load_dword v9, v8, s[68:71], 0 offen sc0 sc1
  s_mov_b32 s72, s26
  s_and_b32 s73, s27, 0xffff
  s_mov_b32 s74, 7168
  s_mov_b32 s75, 0x00020000
  s_mul_i32 s4, s77, 448
  s_and_b32 s5, s77, Lz1-Lz0+1
  s_lshl_b32 s6, s5, 6
  s_add_u32 s6, s6, s4
  s_mul_i32 s5, s5, 384
  s_sub_u32 s5, s4, s5
  v_lshlrev_b32 v2, 1, v1
  v_lshrrev_b32 v3, 1, v2
  v_xor_b32 v3, v3, v2
  v_and_b32 v3, 16, v3
  v_mul_u32_u24 v3, 3, v3
  v_xor_b32_e64 v3, v3, v2
  buffer_load_ushort v104, v2, s[72:75], s6 offen offset:0
  buffer_load_ushort v105, v2, s[72:75], s6 offen offset:128
  buffer_load_ushort v106, v2, s[72:75], s6 offen offset:256
  buffer_load_ushort v107, v3, s[72:75], s5 offen offset:384
  s_nop 0
  s_mov_b32 s64, s30
  s_and_b32 s65, s31, 0xffff
  s_mov_b32 s66, 2048
  s_mov_b32 s67, 0x00020000
  s_lshl_b32 s4, s78, Lz1-Lz0+7
  buffer_load_ushort v108, v2, s[64:67], s4 offen
  v_mov_b32 v32, v22
  v_mov_b32 v33, v22
  v_mov_b32_e64 v34, v22
  v_mov_b32 v35, v22
  s_nop 1
  v_mfma_f32_16x16x32_bf16 v[96:99], v[32:35], v[128:131], 0
  v_mfma_f32_16x16x32_bf16 v[100:103], v[128:131], v[128:131], 0
  v_mfma_f32_16x16x32_bf16 v[96:99], v[32:35], v[132:135], v[96:99]
  v_mfma_f32_16x16x32_bf16 v[100:103], v[132:135], v[132:135], v[100:103]
  v_mfma_f32_16x16x32_bf16 v[96:99], v[32:35], v[136:139], v[96:99]
  v_mfma_f32_16x16x32_bf16 v[100:103], v[136:139], v[136:139], v[100:103]
  v_mfma_f32_16x16x32_bf16 v[96:99], v[32:35], v[140:143], v[96:99]
  v_mfma_f32_16x16x32_bf16 v[100:103], v[140:143], v[140:143], v[100:103]
L_122:
  s_barrier
  s_cmp_lg_u32 s82, Lz1-Lz0+0
  s_cbranch_scc1 L_124
  v_mfma_f32_16x16x32_bf16 v[96:99], v[32:35], v[144:147], v[96:99]
  v_mfma_f32_16x16x32_bf16 v[100:103], v[144:147], v[144:147], v[100:103]
  v_mfma_f32_16x16x32_bf16 v[96:99], v[32:35], v[148:151], v[96:99]
  v_mfma_f32_16x16x32_bf16 v[100:103], v[148:151], v[148:151], v[100:103]
  v_mfma_f32_16x16x32_bf16 v[96:99], v[32:35], v[152:155], v[96:99]
  v_mfma_f32_16x16x32_bf16 v[100:103], v[152:155], v[152:155], v[100:103]
  v_mfma_f32_16x16x32_bf16 v[96:99], v[32:35], v[156:159], v[96:99]
  v_mfma_f32_16x16x32_bf16 v[100:103], v[156:159], v[156:159], v[100:103]
L_124:
  s_barrier
  s_cmp_lg_u32 s82, Lz1-Lz0+0
  s_cbranch_scc1 L_126
  v_mfma_f32_16x16x32_bf16 v[96:99], v[32:35], v[160:163], v[96:99]
  v_mfma_f32_16x16x32_bf16 v[100:103], v[160:163], v[160:163], v[100:103]
  v_mfma_f32_16x16x32_bf16 v[96:99], v[32:35], v[164:167], v[96:99]
  v_mfma_f32_16x16x32_bf16 v[100:103], v[164:167], v[164:167], v[100:103]
  v_mfma_f32_16x16x32_bf16 v[96:99], v[32:35], v[168:171], v[96:99]
  v_mfma_f32_16x16x32_bf16 v[100:103], v[168:171], v[168:171], v[100:103]
  v_mfma_f32_16x16x32_bf16 v[96:99], v[32:35], v[172:175], v[96:99]
  v_mfma_f32_16x16x32_bf16 v[100:103], v[172:175], v[172:175], v[100:103]
  s_waitcnt vmcnt(0)
  s_mov_b32 s89, 200000
  s_branch Lg_129
Lg_128:
  buffer_load_dword v9, v8, s[68:71], 0 offen sc0 sc1
  s_waitcnt vmcnt(0)
Lg_129:
  v_cmp_eq_u32 vcc, 16, v9
  s_andn2_b32 s3, 0xffff, vcc_lo
  s_cbranch_scc0 Lg_130
  s_sleep 2
  s_sub_u32 s89, s89, 1
  s_cbranch_scc0 Lg_128
Lg_130:
  s_mov_b32 s5, 1835008
  s_mov_b64 exec, 0xffff
  buffer_store_dword v11, v14, s[40:43], s5 offen sc0 sc1
  s_mov_b64 exec, -1
  s_getpc_b64 s[4:5]
L_pc0:
  s_sub_u32 s4, s4, L_pc0-mega_kernel
  s_nop 0
  s_subb_u32 s5, s5, 0
  s_bfe_u32 s6, s2, 0x20003
  s_mul_i32 s6, s6, 10240
  v_lshl_add_u32 v3, v1, 4, s6
  v_mov_b32_e64 v119, s5
  v_min_u32 v118, L_end-mega_kernel-16, v3
  v_add_co_u32_e64 v116, vcc, s4, v118
  v_add_u32 v3, 0x400, v3
  s_nop 0
  v_addc_co_u32 v117, vcc, 0, v119, vcc
  global_load_dwordx4 v[112:115], v[116:117], off
  v_min_u32 v118, L_end-mega_kernel-16, v3
  v_add_co_u32_e64 v116, vcc, s4, v118
  v_add_u32 v3, 0x400, v3
  s_nop 0
  v_addc_co_u32 v117, vcc, 0, v119, vcc
  global_load_dwordx4 v[112:115], v[116:117], off
  v_min_u32 v118, L_end-mega_kernel-16, v3
  v_add_co_u32_e64 v116, vcc, s4, v118
  v_add_u32 v3, 0x400, v3
  s_nop 0
  v_addc_co_u32 v117, vcc, 0, v119, vcc
  global_load_dwordx4 v[112:115], v[116:117], off
  v_min_u32 v118, L_end-mega_kernel-16, v3
  v_add_co_u32_e64 v116, vcc, s4, v118
  v_add_u32 v3, 0x400, v3
  s_nop 0
  v_addc_co_u32 v117, vcc, 0, v119, vcc
  global_load_dwordx4 v[112:115], v[116:117], off
  v_min_u32 v118, L_end-mega_kernel-16, v3
  v_add_co_u32 v116, vcc, s4, v118
  s_nop 1
  v_addc_co_u32 v117, vcc, 0, v119, vcc
  global_load_dwordx4 v[112:115], v[116:117], off
L_126:
  s_barrier
  s_cmp_lg_u32 s82, 0
  s_cbranch_scc1 L_131
  v_mfma_f32_16x16x32_bf16 v[96:99], v[32:35], v[176:179], v[96:99]
  v_mfma_f32_16x16x32_bf16 v[100:103], v[176:179], v[176:179], v[100:103]
  v_mfma_f32_16x16x32_bf16 v[96:99], v[32:35], v[180:183], v[96:99]
  v_mfma_f32_16x16x32_bf16 v[100:103], v[180:183], v[180:183], v[100:103]
  v_mfma_f32_16x16x32_bf16 v[96:99], v[32:35], v[184:187], v[96:99]
  v_mfma_f32_16x16x32_bf16 v[100:103], v[184:187], v[184:187], v[100:103]
  v_mfma_f32_16x16x32_bf16 v[96:99], v[32:35], v[188:191], v[96:99]
  v_mfma_f32_16x16x32_bf16 v[100:103], v[188:191], v[188:191], v[100:103]
  s_getpc_b64 s[4:5]
L_pc1:
  s_sub_u32 s4, s4, L_pc1-mega_kernel
  s_subb_u32 s5, s5, 0
  s_bfe_u32 s6, s2, 0x20003
  s_mul_i32 s6, s6, 10240
  s_add_u32 s6, s6, 5120
  v_lshl_add_u32 v3, v1, 4, s6
  v_mov_b32_e64 v119, s5
  v_min_u32 v118, L_end-mega_kernel-16, v3
  v_add_co_u32_e64 v116, vcc, s4, v118
  v_add_u32 v3, 0x400, v3
  s_nop 0
  v_addc_co_u32 v117, vcc, 0, v119, vcc
  global_load_dwordx4 v[112:115], v[116:117], off
  v_min_u32 v118, L_end-mega_kernel-16, v3
  v_add_co_u32_e64 v116, vcc, s4, v118
  v_add_u32 v3, 0x400, v3
  s_nop 0
  v_addc_co_u32 v117, vcc, 0, v119, vcc
  global_load_dwordx4 v[112:115], v[116:117], off
  v_min_u32 v118, L_end-mega_kernel-16, v3
  v_add_co_u32_e64 v116, vcc, s4, v118
  v_add_u32 v3, 0x400, v3
  s_nop 0
  v_addc_co_u32 v117, vcc, 0, v119, vcc
  global_load_dwordx4 v[112:115], v[116:117], off
  v_min_u32 v118, L_end-mega_kernel-16, v3
  v_add_co_u32_e64 v116, vcc, s4, v118
  v_add_u32 v3, 0x400, v3
  s_nop 0
  v_addc_co_u32 v117, vcc, 0, v119, vcc
  global_load_dwordx4 v[112:115], v[116:117], off
  v_min_u32 v118, L_end-mega_kernel-16, v3
  v_add_co_u32 v116, vcc, s4, v118
  s_nop 1
  v_addc_co_u32_e64 v117, vcc, 0, v119, vcc
  global_load_dwordx4 v[112:115], v[116:117], off
  s_mov_b32 s98, 0xaaaaaaaa
  s_mov_b32 s99, 0xaaaaaaaa
  v_cndmask_b32_e64 v100, v100, v101, s[98:99]
  v_cndmask_b32_e64 v102, v102, v103, s[98:99]
  s_mov_b32 s98, 0xcccccccc
  s_mov_b32 s99, 0xcccccccc
  v_cndmask_b32_e64 v97, v100, v102, s[98:99]
  v_add_f32_dpp v96, v96, v96 quad_perm:[1,0,3,2] row_mask:0xf bank_mask:0xf
  s_nop 0
  v_add_f32_dpp v97, v97, v97 quad_perm:[1,0,3,2] row_mask:0xf bank_mask:0xf
  s_branch L_132
L_131:
  s_waitcnt vmcnt(0)
  v_add_f32 v96, v96, v100
  v_add_f32 v97, v97, v101
  v_add_f32 v98, v98, v102
  v_add_f32 v99, v99, v103
  v_add_f32 v96, v96, v98
  v_add_f32 v97, v97, v99
  s_nop 0
  v_add_f32_dpp v96, v96, v96 row_ror:8 row_mask:0xf bank_mask:0xf
  v_add_f32_dpp v97, v97, v97 row_ror:8 row_mask:0xf bank_mask:0xf
  v_mov_b32 v98, v96
  v_mov_b32 v99, v97
  s_nop 0
  v_permlane16_swap_b32 v96, v98
  v_permlane16_swap_b32 v97, v99
  v_add_f32 v96, v96, v98
  v_add_f32 v97, v97, v99
  v_mov_b32 v98, v96
  v_mov_b32 v99, v97
  s_nop 0
  v_permlane32_swap_b32 v96, v98
  v_permlane32_swap_b32 v97, v99
  v_add_f32 v96, v96, v98
  v_add_f32 v97, v97, v99
L_132:
  v_mul_f32 v96, 0x3a800000, v96
  v_mul_f32 v97, 0x3a800000, v97
  v_fma_f32 v98, -v96, v96, v97
  v_max_f32_e64 v98, 0, v98
  v_add_f32 v98, 0x3727c5ac, v98
  v_rsq_f32 v98, v98
  s_nop 0
  v_mul_f32 v99, v96, v98
  s_mov_b64 exec, s[8:9]
  buffer_store_dwordx2 v[98:99], v6, s[40:43], s10 offen sc0 sc1
  s_mov_b64 exec, -1
  s_barrier
  s_cmp_lg_u32 s82, 0
  s_cbranch_scc1 L_133
  v_lshlrev_b32_e64 v6, 3, v1
  s_mov_b64 s[8:9], 0xff
  s_lshl_b32 s91, s84, Lz1-Lz0+1
  s_add_u32 s91, s91, 1835008
  s_mov_b32 exec_lo, 0xffff
  s_mov_b32 exec_hi, Lz1-Lz0+0
  buffer_load_dword v7, v5, s[40:43], s91 offen sc0 sc1
  s_mov_b64 exec, -1
L_133:
  s_barrier
  s_barrier
  s_waitcnt vmcnt(0)
  s_and_b32 s5, s10, 0xfffffc00
  buffer_load_dwordx4 v[120:123], v4, s[40:43], s5 offen sc1
  s_cmp_lg_u32 s82, 0
  s_cbranch_scc1 L_135
  s_mov_b32 s89, 200000
  s_mov_b32 exec_lo, 0xffff
  s_mov_b32 exec_hi, 0
  s_branch Lp_138
Lp_137:
  buffer_load_dword v7, v5, s[40:43], s91 offen sc0 sc1
  s_waitcnt vmcnt(0)
Lp_138:
  v_cmp_ne_u32 vcc, 0, v7
  s_andn2_b32 s3, 0xffff, vcc_lo
  s_cbranch_scc0 Lp_139
  s_sleep 1
  s_sub_u32 s89, s89, 1
  s_cbranch_scc0 Lp_137
Lp_139:
  s_mov_b64 exec, -1
  s_lshl_b32 s5, s77, 14
  s_add_u32 s5, s5, 1114112
  buffer_load_dwordx4 v[192:195], v4, s[40:43], s5 offen offset:0 sc1
  buffer_load_dwordx4 v[196:199], v4, s[40:43], s5 offen offset:1024 sc1
  buffer_load_dwordx4 v[200:203], v4, s[40:43], s5 offen offset:2048 sc1
  buffer_load_dwordx4 v[204:207], v4, s[40:43], s5 offen offset:3072 sc1
  s_add_u32 s5, s5, 4096
  buffer_load_dwordx4 v[208:211], v4, s[40:43], s5 offen offset:0 sc1
  buffer_load_dwordx4 v[212:215], v4, s[40:43], s5 offen offset:1024 sc1
  buffer_load_dwordx4 v[216:219], v4, s[40:43], s5 offen offset:2048 sc1
  buffer_load_dwordx4 v[220:223], v4, s[40:43], s5 offen offset:3072 sc1
L_135:
  s_barrier
  s_cmp_lg_u32 s82, 0
  s_cbranch_scc1 L_140
  s_lshl_b32 s5, s77, 14
  s_add_u32 s5, s5, 1122304
  buffer_load_dwordx4 v[224:227], v4, s[40:43], s5 offen offset:0 sc1
  buffer_load_dwordx4 v[228:231], v4, s[40:43], s5 offen offset:1024 sc1
  buffer_load_dwordx4 v[232:235], v4, s[40:43], s5 offen offset:2048 sc1
  buffer_load_dwordx4 v[236:239], v4, s[40:43], s5 offen offset:3072 sc1
  s_add_u32 s5, s5, 4096
  buffer_load_dwordx4 v[240:243], v4, s[40:43], s5 offen offset:0 sc1
  buffer_load_dwordx4 v[244:247], v4, s[40:43], s5 offen offset:1024 sc1
  buffer_load_dwordx4 v[248:251], v4, s[40:43], s5 offen offset:2048 sc1
  buffer_load_dwordx4 v[252:255], v4, s[40:43], s5 offen offset:3072 sc1
L_140:
  s_barrier
  s_cmp_lg_u32 s82, 0
  s_cbranch_scc1 L_142
  s_waitcnt vmcnt(16)
  s_branch L_143
L_142:
  s_waitcnt vmcnt(0)
L_143:
  s_mov_b32 s89, 200000
  s_branch Lp_145
  s_nop 0
Lp_144:
  s_and_b32 s5, s10, 0xfffffc00
  buffer_load_dwordx4 v[120:123], v4, s[40:43], s5 offen sc1
  s_waitcnt vmcnt(0)
Lp_145:
  v_min_u32 v2, v120, v122
  v_cmp_eq_u32 vcc, 0, v2
  s_cmp_eq_u64 vcc, 0
  s_cbranch_scc1 Lp_146
  s_sleep 1
  s_sub_u32 s89, s89, 1
  s_cbranch_scc0 Lp_144
Lp_146:
  s_and_b32 s5, s10, 0xfffffc00
  s_mov_b32 m0, 151552
  s_nop 0
  buffer_load_dword v6, s[40:43], s5 offen offset:0 sc1 lds
  s_mov_b32 m0, 152188
  s_nop 0
  buffer_load_dword v6, s[40:43], s5 offen offset:4 sc1 lds
  s_mov_b32 m0, 151360
  s_nop 0
  buffer_load_dword v6, s[40:43], s5 offen offset:512 sc1 lds
  s_mov_b32 m0, 151996
  s_nop 0
  buffer_load_dword v6, s[40:43], s5 offen offset:516 sc1 lds
  s_add_u32 s10, s10, 16384
  s_cmp_lg_u32 s82, 0
  s_cbranch_scc1 L_147
  buffer_load_dword v109, v110, s[56:59], s12 offen
  s_sub_u32 s12, s12, 8192
L_147:
  s_barrier
  s_cmp_lg_u32 s82, 0
  s_cbranch_scc1 L_149
  s_cmp_lg_u32 s82, 0
  s_cbranch_scc1 L_151
  s_waitcnt vmcnt(1)
  s_branch L_152
L_151:
  s_waitcnt vmcnt(0)
L_152:
  v_add_f32 v192, v192, v224
  v_add_f32 v193, v193, v225
  v_add_f32 v194, v194, v226
  v_add_f32 v195, v195, v227
  v_add_f32 v196, v196, v228
  v_add_f32 v197, v197, v229
  v_add_f32 v198, v198, v230
  v_add_f32 v199, v199, v231
  v_add_f32 v200, v200, v232
  v_add_f32 v201, v201, v233
  v_add_f32 v202, v202, v234
  v_add_f32 v203, v203, v235
  v_add_f32 v204, v204, v236
  v_add_f32 v205, v205, v237
  v_add_f32 v206, v206, v238
  v_add_f32 v207, v207, v239
  v_add_f32 v208, v208, v240
  v_add_f32 v209, v209, v241
  v_add_f32 v210, v210, v242
  v_add_f32 v211, v211, v243
  v_add_f32 v212, v212, v244
  v_add_f32 v213, v213, v245
  v_add_f32 v214, v214, v246
  v_add_f32 v215, v215, v247
  v_add_f32 v216, v216, v248
  v_add_f32 v217, v217, v249
  v_add_f32 v218, v218, v250
  v_add_f32 v219, v219, v251
  v_add_f32 v220, v220, v252
  v_add_f32 v221, v221, v253
  v_add_f32 v222, v222, v254
  v_add_f32 v223, v223, v255
  v_add_f32 v192, v192, v208
  v_add_f32 v193, v193, v209
  v_add_f32 v194, v194, v210
  v_add_f32 v195, v195, v211
  v_add_f32 v196, v196, v212
  v_add_f32 v197, v197, v213
  v_add_f32 v198, v198, v214
  v_add_f32 v199, v199, v215
  v_add_f32 v200, v200, v216
  v_add_f32 v201, v201, v217
  v_add_f32 v202, v202, v218
  v_add_f32 v203, v203, v219
  v_add_f32 v204, v204, v220
  v_add_f32 v205, v205, v221
  v_add_f32 v206, v206, v222
  v_add_f32 v207, v207, v223
  v_add_f32 v192, v192, v200
  v_add_f32 v193, v193, v201
  v_add_f32 v194, v194, v202
  v_add_f32 v195, v195, v203
  v_add_f32 v196, v196, v204
  v_add_f32 v197, v197, v205
  v_add_f32 v198, v198, v206
  v_add_f32 v199, v199, v207
  v_add_f32 v192, v192, v196
  v_add_f32 v193, v193, v197
  v_add_f32 v194, v194, v198
  v_add_f32 v195, v195, v199
  v_add_u32 v2, 153088, v4
  ds_write_b128 v2, v[192:195]
L_149:
  s_cmp_lg_u32 s82, 0
  s_cbranch_scc1 L_153
  buffer_load_dword v109, v110, s[56:59], s12 offen
  s_sub_u32 s12, s12, 8192
L_153:
  s_barrier
  s_cmp_lg_u32 s82, 0
  s_cbranch_scc1 L_155
  s_waitcnt vmcnt(2)
  s_branch L_156
  s_nop 0
L_155:
  s_waitcnt vmcnt(0)
L_156:
  s_waitcnt lgkmcnt(0)
  s_barrier
  s_cmp_lg_u32 s82, 0
  s_cbranch_scc1 L_157
  v_lshlrev_b32 v2, 2, v1
  v_add_u32 v2, 155136, v2
  v_lshlrev_b32_e64 v104, 16, v104
  v_mul_f32 v104, 0x3eeff558, v104
  ds_write_b32 v2, v104 offset:0
  v_lshlrev_b32_e64 v105, 16, v105
  v_mul_f32 v105, 0x3eeff558, v105
  ds_write_b32 v2, v105 offset:256
  v_lshlrev_b32_e64 v106, 16, v106
  v_mul_f32 v106, 0x3eeff558, v106
  ds_write_b32 v2, v106 offset:512
  v_lshlrev_b32_e64 v107, 16, v107
  v_mul_f32 v107, 0x3eeff558, v107
  ds_write_b32 v2, v107 offset:768
  v_lshlrev_b32_e64 v108, 16, v108
  ds_write_b32 v2, v108 offset:1024
  v_lshrrev_b32 v2, 2, v1
  v_lshlrev_b32 v22, 7, v2
  v_lshlrev_b32 v96, 6, v2
  v_and_b32 v2, 3, v1
  v_lshl_add_u32 v22, v2, 3, v22
  v_lshl_add_u32 v96, v2, 3, v96
  v_add_u32 v22, 65536, v22
  v_add_u32 v96, 90112, v96
  v_bfe_u32 v3, v1, 3, 2
  v_xor_b32_e64 v2, 0, v3
  v_lshl_add_u32 v16, v2, 5, v22
  v_xor_b32_e64 v2, 1, v3
  v_lshl_add_u32 v17, v2, 5, v22
  v_xor_b32_e64 v2, 2, v3
  v_lshl_add_u32 v18, v2, 5, v22
  v_xor_b32_e64 v2, 3, v3
  v_lshl_add_u32 v19, v2, 5, v22
  v_bfe_u32 v3, v1, 4, 1
  v_xor_b32_e64 v2, 0, v3
  v_lshl_add_u32 v20, v2, 5, v96
  v_xor_b32_e64 v2, 1, v3
  v_lshl_add_u32 v21, v2, 5, v96
  v_mov_b32 v22, 0x3f803f80
  s_mov_b32 s98, 0x00010001
  s_mov_b32 s99, 0x00010001
  v_cndmask_b32_e64 v200, 0, v22, s[98:99]
  v_cndmask_b32_e64 v201, 0, v22, s[98:99]
  v_cndmask_b32_e64 v202, 0, v22, s[98:99]
  v_cndmask_b32_e64 v203, 0, v22, s[98:99]
  s_nop 0
  s_lshl_b64 s[98:99], s[98:99], 1
  v_cndmask_b32_e64 v204, 0, v22, s[98:99]
  v_cndmask_b32_e64 v205, 0, v22, s[98:99]
  v_cndmask_b32_e64 v206, 0, v22, s[98:99]
  v_cndmask_b32_e64 v207, 0, v22, s[98:99]
  s_nop 0
  s_lshl_b64 s[98:99], s[98:99], 1
  v_cndmask_b32_e64 v208, 0, v22, s[98:99]
  v_cndmask_b32_e64 v209, 0, v22, s[98:99]
  v_cndmask_b32_e64 v210, 0, v22, s[98:99]
  v_cndmask_b32_e64 v211, 0, v22, s[98:99]
  s_nop 0
  s_lshl_b64 s[98:99], s[98:99], 1
  v_cndmask_b32_e64 v212, 0, v22, s[98:99]
  v_cndmask_b32_e64 v213, 0, v22, s[98:99]
  v_cndmask_b32_e64 v214, 0, v22, s[98:99]
  v_cndmask_b32_e64 v215, 0, v22, s[98:99]
  s_nop 0
  s_lshl_b64 s[98:99], s[98:99], 1
  v_cndmask_b32_e64 v216, 0, v22, s[98:99]
  v_cndmask_b32_e64 v217, 0, v22, s[98:99]
  v_cndmask_b32_e64 v218, 0, v22, s[98:99]
  v_cndmask_b32_e64 v219, 0, v22, s[98:99]
  s_nop 0
  s_lshl_b64 s[98:99], s[98:99], 1
  v_cndmask_b32_e64 v220, 0, v22, s[98:99]
  v_cndmask_b32_e64 v221, 0, v22, s[98:99]
  v_cndmask_b32_e64 v222, 0, v22, s[98:99]
  v_cndmask_b32_e64 v223, 0, v22, s[98:99]
  s_nop 0
  s_lshl_b64 s[98:99], s[98:99], 1
  v_cndmask_b32_e64 v224, 0, v22, s[98:99]
  v_cndmask_b32_e64 v225, 0, v22, s[98:99]
  v_cndmask_b32_e64 v226, 0, v22, s[98:99]
  v_cndmask_b32_e64 v227, 0, v22, s[98:99]
  s_nop 0
  s_lshl_b64 s[98:99], s[98:99], 1
  v_cndmask_b32_e64 v228, 0, v22, s[98:99]
  v_cndmask_b32_e64 v229, 0, v22, s[98:99]
  v_cndmask_b32_e64 v230, 0, v22, s[98:99]
  v_cndmask_b32_e64 v231, 0, v22, s[98:99]
  s_nop 0
  s_lshl_b64 s[98:99], s[98:99], 1
  v_cndmask_b32_e64 v232, 0, v22, s[98:99]
  v_cndmask_b32_e64 v233, 0, v22, s[98:99]
  v_cndmask_b32_e64 v234, 0, v22, s[98:99]
  v_cndmask_b32_e64 v235, 0, v22, s[98:99]
  s_nop 0
  s_lshl_b64 s[98:99], s[98:99], 1
  v_cndmask_b32_e64 v236, 0, v22, s[98:99]
  v_cndmask_b32_e64 v237, 0, v22, s[98:99]
  v_cndmask_b32_e64 v238, 0, v22, s[98:99]
  v_cndmask_b32_e64 v239, 0, v22, s[98:99]
  s_nop 0
  s_lshl_b64 s[98:99], s[98:99], 1
  v_cndmask_b32_e64 v240, 0, v22, s[98:99]
  v_cndmask_b32_e64 v241, 0, v22, s[98:99]
  v_cndmask_b32_e64 v242, 0, v22, s[98:99]
  v_cndmask_b32_e64 v243, 0, v22, s[98:99]
  s_nop 0
  s_lshl_b64 s[98:99], s[98:99], 1
  v_cndmask_b32_e64 v244, 0, v22, s[98:99]
  v_cndmask_b32_e64 v245, 0, v22, s[98:99]
  v_cndmask_b32_e64 v246, 0, v22, s[98:99]
  v_cndmask_b32_e64 v247, 0, v22, s[98:99]
  s_nop 0
  s_lshl_b64 s[98:99], s[98:99], 1
  v_cndmask_b32_e64 v248, 0, v22, s[98:99]
  v_cndmask_b32_e64 v249, 0, v22, s[98:99]
  v_cndmask_b32_e64 v250, 0, v22, s[98:99]
  v_cndmask_b32_e64 v251, 0, v22, s[98:99]
  s_nop 0
  s_lshl_b64 s[98:99], s[98:99], 1
  v_cndmask_b32_e64 v252, 0, v22, s[98:99]
  v_cndmask_b32_e64 v253, 0, v22, s[98:99]
  v_cndmask_b32_e64 v254, 0, v22, s[98:99]
  v_cndmask_b32_e64 v255, 0, v22, s[98:99]
  s_lshl_b64 s[98:99], s[98:99], 1
L_157:
  s_lshl_b32 s91, s84, 1
  s_add_u32 s91, s91, s87
  s_barrier
  s_mov_b32 exec_lo, 0xffff
  s_mov_b32 exec_hi, 0
  buffer_load_dword v7, v5, s[40:43], s91 offen sc0 sc1
  s_mov_b64 exec, -1
  s_barrier
  s_barrier
  s_barrier
  s_waitcnt vmcnt(0)
  s_mov_b32 s89, 200000
  s_mov_b32 exec_lo, 0xffff
  s_mov_b32 exec_hi, 0
  s_branch Lp_160
Lp_159:
  buffer_load_dword v7, v5, s[40:43], s91 offen sc0 sc1
  s_waitcnt vmcnt(0)
Lp_160:
  v_cmp_ne_u32 vcc, 0, v7
  s_andn2_b32 s3, 0xffff, vcc_lo
  s_cbranch_scc0 Lp_161
  s_sleep 1
  s_sub_u32 s89, s89, 1
  s_cbranch_scc0 Lp_159
Lp_161:
  s_mov_b64 exec, -1
  s_barrier
  s_barrier
  s_barrier
  s_barrier
  s_barrier
  s_barrier
  s_barrier
  s_barrier
  s_barrier
  s_barrier
  s_barrier
  s_barrier
  s_barrier
  s_add_u32 s92, s83, 31457280
  s_add_u32 s91, s91, 4
  s_sub_u32 s16, s78, s76
  s_and_b32 s16, s16, 15
  s_barrier
  s_cmp_lg_u32 s82, 0
  s_cbranch_scc1 L_162
  s_cmp_eq_u32 s16, Lz1-Lz0+1
  s_cselect_b32 s4, 0, 28672
  v_add_u32 v112, s4, v16
  v_add_u32 v113, s4, v17
  v_add_u32 v114, s4, v18
  v_add_u32 v115, s4, v19
  v_add_u32 v116, s4, v20
  v_add_u32 v117, s4, v21
  ds_read_b64_tr_b16 v[32:33], v112 offset:0
  ds_read_b64_tr_b16 v[34:35], v112 offset:2048
  ds_read_b64_tr_b16 v[36:37], v113 offset:0
  ds_read_b64_tr_b16 v[38:39], v113 offset:2048
  ds_read_b64_tr_b16 v[40:41], v114 offset:0
  ds_read_b64_tr_b16 v[42:43], v114 offset:2048
  ds_read_b64_tr_b16 v[44:45], v115 offset:0
  ds_read_b64_tr_b16 v[46:47], v115 offset:2048
  ds_read_b64_tr_b16 v[48:49], v112 offset:4096
  ds_read_b64_tr_b16 v[50:51], v112 offset:6144
  ds_read_b64_tr_b16 v[52:53], v113 offset:4096
  ds_read_b64_tr_b16 v[54:55], v113 offset:6144
  s_nop 0
  s_waitcnt lgkmcnt(6)
  ds_read_b64_tr_b16 v[56:57], v114 offset:4096
  ds_read_b64_tr_b16 v[58:59], v114 offset:6144
  ds_read_b64_tr_b16 v[60:61], v115 offset:4096
  ds_read_b64_tr_b16 v[62:63], v115 offset:6144
  s_nop 0
  s_waitcnt lgkmcnt(6)
  ds_read_b64_tr_b16 v[64:65], v112 offset:8192
  ds_read_b64_tr_b16 v[66:67], v112 offset:10240
  ds_read_b64_tr_b16 v[68:69], v113 offset:8192
  ds_read_b64_tr_b16 v[70:71], v113 offset:10240
  ds_read_b64_tr_b16 v[72:73], v114 offset:8192
  ds_read_b64_tr_b16 v[74:75], v114 offset:10240
  ds_read_b64_tr_b16 v[76:77], v115 offset:8192
  ds_read_b64_tr_b16 v[78:79], v115 offset:10240
  s_nop 0
  s_waitcnt lgkmcnt(8)
  v_mfma_f32_16x16x32_bf16 v[28:31], v[32:35], v[200:203], 0
  v_mfma_f32_16x16x32_bf16 v[28:31], v[36:39], v[204:207], v[28:31]
  v_mfma_f32_16x16x32_bf16 v[28:31], v[40:43], v[208:211], v[28:31]
  v_mfma_f32_16x16x32_bf16 v[28:31], v[44:47], v[212:215], v[28:31]
  v_mfma_f32_16x16x32_bf16 v[28:31], v[48:51], v[200:203], v[28:31]
  v_mfma_f32_16x16x32_bf16 v[28:31], v[52:55], v[204:207], v[28:31]
  v_mfma_f32_16x16x32_bf16 v[28:31], v[56:59], v[208:211], v[28:31]
  v_mfma_f32_16x16x32_bf16 v[28:31], v[60:63], v[212:215], v[28:31]
  s_nop 0
  s_waitcnt lgkmcnt(7)
  ds_read_b64_tr_b16 v[80:81], v112 offset:12288
  ds_read_b64_tr_b16 v[82:83], v112 offset:14336
  ds_read_b64_tr_b16 v[84:85], v113 offset:12288
  ds_read_b64_tr_b16 v[86:87], v113 offset:14336
  ds_read_b64_tr_b16 v[88:89], v114 offset:12288
  ds_read_b64_tr_b16 v[90:91], v114 offset:14336
  ds_read_b64_tr_b16 v[92:93], v115 offset:12288
  ds_read_b64_tr_b16 v[94:95], v115 offset:14336
  s_nop 0
  s_waitcnt lgkmcnt(6)
  ds_read_b64_tr_b16 v[128:129], v112 offset:16384
  ds_read_b64_tr_b16 v[130:131], v112 offset:18432
  ds_read_b64_tr_b16 v[132:133], v113 offset:16384
  ds_read_b64_tr_b16 v[134:135], v113 offset:18432
  ds_read_b64_tr_b16 v[136:137], v114 offset:16384
  ds_read_b64_tr_b16 v[138:139], v114 offset:18432
  ds_read_b64_tr_b16 v[140:141], v115 offset:16384
  ds_read_b64_tr_b16 v[142:143], v115 offset:18432
  s_nop 0
  s_waitcnt lgkmcnt(8)
  v_mfma_f32_16x16x32_bf16 v[28:31], v[64:67], v[216:219], v[28:31]
  v_mfma_f32_16x16x32_bf16 v[28:31], v[68:71], v[220:223], v[28:31]
  v_mfma_f32_16x16x32_bf16 v[28:31], v[72:75], v[224:227], v[28:31]
  v_mfma_f32_16x16x32_bf16 v[28:31], v[76:79], v[228:231], v[28:31]
  v_mfma_f32_16x16x32_bf16 v[28:31], v[80:83], v[216:219], v[28:31]
  v_mfma_f32_16x16x32_bf16 v[28:31], v[84:87], v[220:223], v[28:31]
  v_mfma_f32_16x16x32_bf16 v[28:31], v[88:91], v[224:227], v[28:31]
  v_mfma_f32_16x16x32_bf16 v[28:31], v[92:95], v[228:231], v[28:31]
  s_nop 0
  s_waitcnt lgkmcnt(7)
  ds_read_b64_tr_b16 v[144:145], v112 offset:20480
  ds_read_b64_tr_b16 v[146:147], v112 offset:22528
  ds_read_b64_tr_b16 v[148:149], v113 offset:20480
  ds_read_b64_tr_b16 v[150:151], v113 offset:22528
  ds_read_b64_tr_b16 v[152:153], v114 offset:20480
  ds_read_b64_tr_b16 v[154:155], v114 offset:22528
  ds_read_b64_tr_b16 v[156:157], v115 offset:20480
  ds_read_b64_tr_b16 v[158:159], v115 offset:22528
  s_nop 0
  s_waitcnt lgkmcnt(6)
  ds_read_b64_tr_b16 v[160:161], v116 offset:0
  ds_read_b64_tr_b16 v[162:163], v116 offset:1024
  ds_read_b64_tr_b16 v[164:165], v117 offset:0
  ds_read_b64_tr_b16 v[166:167], v117 offset:1024
  ds_read_b64_tr_b16 v[176:177], v116 offset:2048
  ds_read_b64_tr_b16 v[178:179], v116 offset:3072
  ds_read_b64_tr_b16 v[180:181], v117 offset:2048
  ds_read_b64_tr_b16 v[182:183], v117 offset:3072
  s_nop 0
  s_waitcnt lgkmcnt(8)
  v_mfma_f32_16x16x32_bf16 v[28:31], v[128:131], v[232:235], v[28:31]
  v_mfma_f32_16x16x32_bf16 v[28:31], v[132:135], v[236:239], v[28:31]
  v_mfma_f32_16x16x32_bf16 v[28:31], v[136:139], v[240:243], v[28:31]
  v_mfma_f32_16x16x32_bf16 v[28:31], v[140:143], v[244:247], v[28:31]
  v_mfma_f32_16x16x32_bf16 v[28:31], v[144:147], v[232:235], v[28:31]
  v_mfma_f32_16x16x32_bf16 v[28:31], v[148:151], v[236:239], v[28:31]
  v_mfma_f32_16x16x32_bf16 v[28:31], v[152:155], v[240:243], v[28:31]
  v_mfma_f32_16x16x32_bf16 v[28:31], v[156:159], v[244:247], v[28:31]
  s_waitcnt lgkmcnt(7)
  s_waitcnt lgkmcnt(0)
  v_mfma_f32_16x16x32_bf16 v[28:31], v[160:163], v[248:251], v[28:31]
  v_mfma_f32_16x16x32_bf16 v[28:31], v[164:167], v[252:255], v[28:31]
  v_mfma_f32_16x16x32_bf16 v[28:31], v[176:179], v[248:251], v[28:31]
  v_mfma_f32_16x16x32_bf16 v[28:31], v[180:183], v[252:255], v[28:31]
  s_lshl_b32 s5, s77, Lz1-Lz0+14
  s_lshl_b32 s4, s76, 10
  s_add_u32 s5, s5, s4
  s_add_u32 s5, s5, 1376256
  s_nop 3
  buffer_store_dwordx4 v[28:31], v15, s[40:43], s5 offen sc0 sc1
L_162:
  s_barrier
  s_mov_b32 exec_lo, 0xffff
  s_mov_b32 exec_hi, 0
  buffer_load_dword v7, v5, s[40:43], s91 offen sc0 sc1
  s_mov_b64 exec, -1
  s_barrier
  s_waitcnt vmcnt(0)
  s_mov_b32 s89, 200000
  s_mov_b32 exec_lo, 0xffff
  s_mov_b32 exec_hi, 0
  s_branch Lp_165
Lp_164:
  buffer_load_dword v7, v5, s[40:43], s91 offen sc0 sc1
  s_waitcnt vmcnt(0)
Lp_165:
  v_cmp_ne_u32 vcc, 0, v7
  s_andn2_b32 s3, 0xffff, vcc_lo
  s_cbranch_scc0 Lp_166
  s_sleep 1
  s_sub_u32 s89, s89, 1
  s_cbranch_scc0 Lp_164
Lp_166:
  s_mov_b64 exec, -1
  s_add_u32 s5, s84, s92
  buffer_load_dwordx2 v[96:97], v6, s[40:43], s5 offen offset:0 sc1
  buffer_load_dwordx2 v[98:99], v6, s[40:43], s5 offen offset:512 sc1
  buffer_load_dwordx2 v[100:101], v6, s[40:43], s5 offen offset:1024 sc1
  buffer_load_dwordx2 v[102:103], v6, s[40:43], s5 offen offset:1536 sc1
  s_barrier
  s_barrier
  s_barrier
  s_waitcnt vmcnt(0)
  v_add_f32 v96, v96, v100
  v_add_f32 v97, v97, v101
  v_add_f32 v98, v98, v102
  v_add_f32 v99, v99, v103
  v_add_f32_e64 v96, v96, v98
  v_add_f32 v97, v97, v99
  s_nop 0
  v_add_f32_dpp v96, v96, v96 row_ror:8 row_mask:0xf bank_mask:0xf
  v_add_f32_dpp v97, v97, v97 row_ror:8 row_mask:0xf bank_mask:0xf
  v_mov_b32 v98, v96
  v_mov_b32 v99, v97
  s_nop 0
  v_permlane16_swap_b32 v96, v98
  v_permlane16_swap_b32 v97, v99
  v_add_f32 v96, v96, v98
  v_add_f32 v97, v97, v99
  v_mov_b32 v98, v96
  v_mov_b32 v99, v97
  s_nop 0
  v_permlane32_swap_b32 v96, v98
  v_permlane32_swap_b32 v97, v99
  v_add_f32 v96, v96, v98
  v_add_f32 v97, v97, v99
  v_mul_f32 v96, 0x3a800000, v96
  v_mul_f32 v97, 0x3a800000, v97
  v_fma_f32 v98, -v96, v96, v97
  v_max_f32_e64 v98, 0, v98
  v_add_f32 v98, 0x3727c5ac, v98
  v_rsq_f32 v98, v98
  s_nop 0
  v_mul_f32 v99, v96, v98
  s_mov_b64 exec, s[8:9]
  buffer_store_dwordx2 v[98:99], v6, s[40:43], s10 offen sc0 sc1
  s_mov_b64 exec, -1
  s_barrier
  s_barrier
  s_barrier
  s_cmp_lg_u32 s82, Lz1-Lz0+0
  s_cbranch_scc1 L_167
  s_waitcnt vmcnt(0)
  s_mov_b32 s5, 1835012
  s_mov_b64 exec, 0xffff
  buffer_store_dword v11, v14, s[40:43], s5 offen sc0 sc1
  s_mov_b64 exec, -1
L_167:
  s_barrier
  s_barrier
  s_cmp_lg_u32 s82, 0
  s_cbranch_scc1 L_169
  s_lshl_b32 s91, s84, 1
  s_add_u32 s91, s91, 1835012
  s_mov_b32 exec_lo, 0xffff
  s_mov_b32 exec_hi, 0
  buffer_load_dword v7, v5, s[40:43], s91 offen sc0 sc1
  s_mov_b64 exec, -1
L_169:
  s_and_b32 s5, s10, 0xfffffc00
  buffer_load_dwordx4 v[120:123], v4, s[40:43], s5 offen sc1
  s_barrier
  s_barrier
  s_waitcnt vmcnt(0)
  s_mov_b32 s89, 200000
  s_branch Lp_172
Lp_171:
  s_and_b32 s5, s10, 0xfffffc00
  buffer_load_dwordx4 v[120:123], v4, s[40:43], s5 offen sc1
  s_waitcnt vmcnt(0)
Lp_172:
  v_min_u32 v2, v120, v122
  v_cmp_eq_u32 vcc, 0, v2
  s_cmp_eq_u64 vcc, 0
  s_cbranch_scc1 Lp_173
  s_sleep 1
  s_sub_u32 s89, s89, 1
  s_cbranch_scc0 Lp_171
Lp_173:
  s_and_b32 s5, s10, 0xfffffc00
  s_mov_b32 m0, 151552
  s_nop 0
  buffer_load_dword v6, s[40:43], s5 offen offset:0 sc1 lds
  s_mov_b32 m0, 152188
  s_nop 0
  buffer_load_dword v6, s[40:43], s5 offen offset:4 sc1 lds
  s_mov_b32 m0, 151360
  s_nop 0
  buffer_load_dword v6, s[40:43], s5 offen offset:512 sc1 lds
  s_mov_b32 m0, 151996
  s_nop 0
  buffer_load_dword v6, s[40:43], s5 offen offset:516 sc1 lds
  s_add_u32 s10, s10, 16384
  s_cmp_lg_u32 s82, 0
  s_cbranch_scc1 L_174
  s_mov_b32 s89, 200000
  s_mov_b32 exec_lo, 0xffff
  s_mov_b32 exec_hi, 0
  s_branch Lp_177
Lp_176:
  buffer_load_dword v7, v5, s[40:43], s91 offen sc0 sc1
  s_waitcnt vmcnt(0)
Lp_177:
  v_cmp_ne_u32 vcc, 0, v7
  s_andn2_b32 s3, 0xffff, vcc_lo
  s_cbranch_scc0 Lp_178
  s_sleep 1
  s_sub_u32 s89, s89, 1
  s_cbranch_scc0 Lp_176
Lp_178:
  s_mov_b64 exec, -1
  s_lshl_b32 s5, s77, 14
  s_add_u32 s5, s5, 1376256
  buffer_load_dwordx4 v[192:195], v4, s[40:43], s5 offen offset:0 sc1
  buffer_load_dwordx4 v[196:199], v4, s[40:43], s5 offen offset:1024 sc1
  buffer_load_dwordx4 v[200:203], v4, s[40:43], s5 offen offset:2048 sc1
  buffer_load_dwordx4 v[204:207], v4, s[40:43], s5 offen offset:3072 sc1
  s_add_u32 s5, s5, 4096
  buffer_load_dwordx4 v[208:211], v4, s[40:43], s5 offen offset:0 sc1
  buffer_load_dwordx4 v[212:215], v4, s[40:43], s5 offen offset:1024 sc1
  buffer_load_dwordx4 v[216:219], v4, s[40:43], s5 offen offset:2048 sc1
  buffer_load_dwordx4 v[220:223], v4, s[40:43], s5 offen offset:3072 sc1
L_174:
  s_barrier
  s_cmp_lg_u32 s82, 0
  s_cbranch_scc1 L_179
  s_lshl_b32 s5, s77, 14
  s_add_u32 s5, s5, 1384448
  buffer_load_dwordx4 v[224:227], v4, s[40:43], s5 offen offset:0 sc1
  buffer_load_dwordx4 v[228:231], v4, s[40:43], s5 offen offset:1024 sc1
  buffer_load_dwordx4 v[232:235], v4, s[40:43], s5 offen offset:2048 sc1
  buffer_load_dwordx4 v[236:239], v4, s[40:43], s5 offen offset:3072 sc1
  s_add_u32 s5, s5, 4096
  buffer_load_dwordx4 v[240:243], v4, s[40:43], s5 offen offset:0 sc1
  buffer_load_dwordx4 v[244:247], v4, s[40:43], s5 offen offset:1024 sc1
  buffer_load_dwordx4 v[248:251], v4, s[40:43], s5 offen offset:2048 sc1
  buffer_load_dwordx4 v[252:255], v4, s[40:43], s5 offen offset:3072 sc1
L_179:
  s_cmp_lg_u32 s82, 0
  s_cbranch_scc1 L_181
  buffer_load_dword v109, v110, s[60:63], s13 offen
  s_sub_u32 s13, s13, 8192
  buffer_load_dword v109, v110, s[60:63], s13 offen
  s_sub_u32 s13, s13, 8192
L_181:
  s_barrier
  s_barrier
  s_cmp_lg_u32 s82, 0
  s_cbranch_scc1 L_183
  s_cmp_lg_u32 s82, 0
  s_cbranch_scc1 L_185
  s_waitcnt vmcnt(2)
  s_branch L_186
  s_nop 0
L_185:
  s_waitcnt vmcnt(0)
L_186:
  v_add_f32 v192, v192, v224
  v_add_f32 v193, v193, v225
  v_add_f32 v194, v194, v226
  v_add_f32 v195, v195, v227
  v_add_f32 v196, v196, v228
  v_add_f32 v197, v197, v229
  v_add_f32 v198, v198, v230
  v_add_f32 v199, v199, v231
  v_add_f32 v200, v200, v232
  v_add_f32 v201, v201, v233
  v_add_f32 v202, v202, v234
  v_add_f32 v203, v203, v235
  v_add_f32 v204, v204, v236
  v_add_f32 v205, v205, v237
  v_add_f32 v206, v206, v238
  v_add_f32 v207, v207, v239
  v_add_f32 v208, v208, v240
  v_add_f32 v209, v209, v241
  v_add_f32 v210, v210, v242
  v_add_f32 v211, v211, v243
  v_add_f32 v212, v212, v244
  v_add_f32 v213, v213, v245
  v_add_f32 v214, v214, v246
  v_add_f32 v215, v215, v247
  v_add_f32 v216, v216, v248
  v_add_f32 v217, v217, v249
  v_add_f32 v218, v218, v250
  v_add_f32 v219, v219, v251
  v_add_f32 v220, v220, v252
  v_add_f32 v221, v221, v253
  v_add_f32 v222, v222, v254
  v_add_f32 v223, v223, v255
  v_add_f32 v192, v192, v208
  v_add_f32 v193, v193, v209
  v_add_f32 v194, v194, v210
  v_add_f32 v195, v195, v211
  v_add_f32 v196, v196, v212
  v_add_f32 v197, v197, v213
  v_add_f32 v198, v198, v214
  v_add_f32 v199, v199, v215
  v_add_f32 v200, v200, v216
  v_add_f32 v201, v201, v217
  v_add_f32 v202, v202, v218
  v_add_f32 v203, v203, v219
  v_add_f32 v204, v204, v220
  v_add_f32 v205, v205, v221
  v_add_f32 v206, v206, v222
  v_add_f32 v207, v207, v223
  v_add_f32 v192, v192, v200
  v_add_f32 v193, v193, v201
  v_add_f32 v194, v194, v202
  v_add_f32 v195, v195, v203
  v_add_f32 v196, v196, v204
  v_add_f32 v197, v197, v205
  v_add_f32 v198, v198, v206
  v_add_f32 v199, v199, v207
  v_add_f32 v192, v192, v196
  v_add_f32 v193, v193, v197
  v_add_f32 v194, v194, v198
  v_add_f32 v195, v195, v199
  v_add_u32 v2, 154112, v4
  ds_write_b128 v2, v[192:195]
  s_branch L_184
  s_nop 0
L_183:
  s_waitcnt vmcnt(0)
L_184:
  s_waitcnt lgkmcnt(0)
  s_barrier
  v_lshlrev_b32 v2, 12, v1
  s_lshl_b32 s4, s76, 16
  s_lshl_b32 s5, s77, 7
  s_add_u32 s4, s4, s5
  s_add_u32 s4, s4, s87
  s_add_u32 s5, s4, 24
  s_lshl_b32 s4, s79, 3
  s_lshl_b32 s90, 0xff, s4
  s_lshl_b32 s91, s84, 1
  s_add_u32 s91, s91, s87
  s_add_u32 s91, s91, 24
  s_barrier
  s_barrier
  s_barrier
  s_mov_b32 exec_lo, 0xffff
  s_mov_b32 exec_hi, Lz1-Lz0+0
  buffer_store_dword v11, v2, s[40:43], s5 offen sc0 sc1
  s_mov_b64 exec, -1
  s_barrier
  s_barrier
  s_barrier
  s_mov_b32 exec_lo, s90
  s_mov_b32 exec_hi, 0
  buffer_load_dword v7, v5, s[40:43], s91 offen sc0 sc1
  s_mov_b64 exec, -1
  s_barrier
  s_waitcnt vmcnt(0)
  s_mov_b32 s89, 200000
  s_mov_b32 exec_lo, s90
  s_mov_b32 exec_hi, 0
  s_branch Lp_188
Lp_187:
  buffer_load_dword v7, v5, s[40:43], s91 offen sc0 sc1
  s_waitcnt vmcnt(0)
Lp_188:
  v_cmp_ne_u32 vcc, 0, v7
  s_andn2_b32 s3, s90, vcc_lo
  s_cbranch_scc0 Lp_189
  s_sleep 1
  s_sub_u32 s89, s89, 1
  s_cbranch_scc0 Lp_187
Lp_189:
  s_mov_b64 exec, -1
  s_xor_b32 s90, s90, 0xffff
  s_barrier
  s_barrier
  s_barrier
  s_barrier
  s_barrier
  s_barrier
  s_barrier
  s_barrier
  s_barrier
  s_barrier
  s_mov_b32 exec_lo, s90
  s_mov_b32 exec_hi, 0
  buffer_load_dword v7, v5, s[40:43], s91 offen sc0 sc1
  s_mov_b64 exec, -1
  s_barrier
  s_barrier
  s_barrier
  s_waitcnt vmcnt(0)
  s_mov_b32 s89, 200000
  s_mov_b32 exec_lo, s90
  s_mov_b32 exec_hi, 0
  s_branch Lp_191
Lp_190:
  buffer_load_dword v7, v5, s[40:43], s91 offen sc0 sc1
  s_waitcnt vmcnt(0)
Lp_191:
  v_cmp_ne_u32 vcc, 0, v7
  s_andn2_b32 s3, s90, vcc_lo
  s_cbranch_scc0 Lp_192
  s_sleep 1
  s_sub_u32 s89, s89, 1
  s_cbranch_scc0 Lp_190
Lp_192:
  s_mov_b64 exec, -1
  s_sub_u32 s91, s91, Lz1-Lz0+12
  s_xor_b32 s5, s84, 16384
  s_lshl_b32 s5, s5, 1
  s_add_u32 s5, s5, s87
  s_add_u32 s5, s5, 12
  s_barrier
  s_barrier
  s_barrier
  s_barrier
  s_barrier
  s_barrier
  s_barrier
  s_barrier
  s_mov_b64 exec, 1
  buffer_store_dword v11, v5, s[40:43], s5 offen sc0 sc1
  s_mov_b64 exec, -1
  s_barrier
  s_barrier
  s_mov_b32 exec_lo, 1
  s_mov_b32 exec_hi, 0
  buffer_load_dword v7, v5, s[40:43], s91 offen sc0 sc1
  s_mov_b64 exec, -1
  s_barrier
  s_waitcnt vmcnt(0)
  s_mov_b32 s89, 200000
  s_mov_b32 exec_lo, 1
  s_mov_b32 exec_hi, 0
  s_branch Lp_194
  s_nop 0
Lp_193:
  buffer_load_dword v7, v5, s[40:43], s91 offen sc0 sc1
  s_waitcnt vmcnt(0)
Lp_194:
  v_cmp_ne_u32 vcc, 0, v7
  s_andn2_b32 s3, 1, vcc_lo
  s_cbranch_scc0 Lp_195
  s_sleep 1
  s_sub_u32 s89, s89, 1
  s_cbranch_scc0 Lp_193
Lp_195:
  s_mov_b64 exec, -1
  s_barrier
  s_barrier
  s_cmp_lg_u32 s82, 0
  s_cbranch_scc1 L_lend
  s_add_u32 s92, s83, 36700160
  s_mov_b32 s82, 1
  s_mov_b32 s14, 0
  s_add_u32 s83, s83, 0
  s_add_u32 s87, s87, 32
  s_branch L_slayer
L_lend:
Lz0:
Lz1:
L_end:
  s_endpgm
.section .rodata,"a"
.p2align 6
.amdhsa_kernel mega_kernel
  .amdhsa_next_free_vgpr 256
  .amdhsa_next_free_sgpr 102
  .amdhsa_accum_offset 256
  .amdhsa_group_segment_fixed_size 0
  .amdhsa_kernarg_size 88
  .amdhsa_user_sgpr_count 2
  .amdhsa_user_sgpr_kernarg_segment_ptr 1
  .amdhsa_system_sgpr_workgroup_id_x 1
  .amdhsa_float_denorm_mode_32 3
  .amdhsa_float_denorm_mode_16_64 3
.end_amdhsa_kernel
.text
```

```asm
; @launch kernel=mega_kernel grid=(256,1,1) block=(512,1,1) lds=156672
.amdgcn_target "amdgcn-amd-amdhsa--gfx950"
.text
.globl mega_kernel
.p2align 8
.type mega_kernel,@function
mega_kernel:
  s_cmp_ge_u32 s2, 256
  s_nop 0
  s_cbranch_scc1 L_end
  s_load_dwordx16 s[16:31], s[0:1], 0
  s_load_dwordx2 s[32:33], s[0:1], 64
  s_load_dwordx4 s[36:39], s[0:1], 72
  v_lshrrev_b32 v2, 6, v0
  v_and_b32 v1, 63, v0
  v_readfirstlane_b32 s81, v2
  s_and_b32 s3, s2, 7
  s_lshr_b32 s4, s2, 3
  s_and_b32 s5, s3, 1
  s_lshl_b32 s5, s5, 3
  s_and_b32 s6, s4, 7
  s_add_u32 s76, s5, s6
  s_lshr_b32 s5, s3, 1
  s_lshl_b32 s5, s5, 2
  s_lshr_b32 s6, s4, 3
  s_add_u32 s77, s5, s6
  s_mov_b32 s82, 0
  s_mov_b32 s88, 0
  s_and_b32 s85, s81, 1
  s_cmp_lt_u32 s81, 4
  s_cbranch_scc1 L_comp
  s_cmp_eq_u32 s81, Lz1-Lz0+5
  s_cbranch_scc1 L_serv
  s_setprio 0
  s_cmp_eq_u32 s81, 4
  s_cbranch_scc1 L_xload
  v_bfe_u32 v2, v1, 1, 2
  v_bfe_u32 v3, v1, 4, 2
  v_xor_b32 v2, v2, v3
  v_lshlrev_b32 v10, 5, v2
  v_and_b32_e64 v2, 1, v1
  v_lshl_add_u32 v10, v2, 4, v10
  v_lshrrev_b32_e64 v2, 5, v1
  v_bfe_u32 v3, v1, 3, 2
  v_lshl_add_u32 v2, v2, 3, v3
  s_mov_b32 s4, 6144
  v_mad_u32_u24 v4, v2, s4, v10
  v_add_u32 v5, 97280, v4
  v_add_u32 v6, 22528, v4
  v_add_u32 v7, 119808, v4
  s_lshl_b32 s5, s77, Lz1-Lz0+7
  s_mul_i32 s4, s85, 196608
  s_add_u32 s5, s5, s4
  s_and_b32 s6, s76, 6
  s_lshr_b32 s4, s76, 3
  s_add_u32 s6, s6, s4
  s_lshl_b32 s6, s6, 1
  v_add_u32 v12, s6, v1
  v_and_b32_e64 v12, 15, v12
  s_mov_b32 s4, 393216
  v_mul_u32_u24 v12, s4, v12
  v_add_u32 v12, s5, v12
  s_nop 0
  v_readfirstlane_b32 s7, v12
  s_lshl_b32 s11, s85, Lz1-Lz0+12
  s_add_u32 s11, s11, 65536
  s_add_u32 s15, s11, 73728
  s_waitcnt lgkmcnt(0)
  s_mov_b32 s48, s18
  s_and_b32 s49, s19, 0xffff
  s_mov_b32 s50, 6291456
  s_mov_b32 s51, 0x00020000
L_wlayer:
  s_mov_b32 s12, 0
  s_mov_b32 m0, s11
  s_cmp_eq_u32 s82, 0
  s_cbranch_scc1 Ll_28
  s_waitcnt vmcnt(12)
  s_barrier
  s_waitcnt vmcnt(8)
  s_barrier
  s_waitcnt vmcnt(4)
  s_barrier
  s_branch Ll_28
Lt_33:
  s_cmp_lg_u32 s12, 1
  s_cbranch_scc1 Ll_28
  s_cmp_eq_u32 s82, 0
  s_cbranch_scc1 Ll_28
  s_waitcnt vmcnt(12)
  s_barrier
  s_barrier
  v_mov_b32 v2, 156416
  s_lshl_b32 s5, s82, Lz1-Lz0+4
  s_mov_b32 s89, 1600000
Lw_34:
  ds_read_b32 v3, v2 offset:0
Lw_35:
  s_waitcnt lgkmcnt(0)
  v_readfirstlane_b32 s4, v3
  s_cmp_ge_u32 s4, s5
  s_cbranch_scc1 Lw_36
  s_sleep 1
  s_sub_u32 s89, s89, Lz1-Lz0+1
  s_cbranch_scc0 Lw_34
Lw_36:
Ll_28:
  buffer_load_dwordx4 v4, s[48:51], s7 offen offset:0 lds
  buffer_load_dwordx4 v5, s[48:51], s7 offen offset:1024 lds
  buffer_load_dwordx4 v6, s[48:51], s7 offen offset:2048 lds
  buffer_load_dwordx4 v7, s[48:51], s7 offen offset:3072 lds
  s_add_u32 m0, s11, 8192
  s_add_u32 s5, s7, 2048
  buffer_load_dwordx4 v4, s[48:51], s5 offen offset:0 lds
  buffer_load_dwordx4 v5, s[48:51], s5 offen offset:1024 lds
  buffer_load_dwordx4 v6, s[48:51], s5 offen offset:2048 lds
  buffer_load_dwordx4 v7, s[48:51], s5 offen offset:3072 lds
  s_add_u32 m0, s11, 16384
  s_add_u32 s5, s7, 4096
  buffer_load_dwordx4 v4, s[48:51], s5 offen offset:0 lds
  s_add_u32 s12, s12, Lz1-Lz0+1
  v_readlane_b32 s7, v12, s12
  s_add_u32 s11, s11, 24576
  buffer_load_dwordx4 v5, s[48:51], s5 offen offset:1024 lds
  s_cmp_eq_u32 s11, s15
  s_cselect_b32 s4, 73728, 0
  s_sub_u32 s11, s11, s4
  buffer_load_dwordx4 v6, s[48:51], s5 offen offset:2048 lds
  s_cmp_lg_u32 s12, Lz1-Lz0+3
  buffer_load_dwordx4 v7, s[48:51], s5 offen offset:3072 lds
  s_mov_b32 m0, s11
  s_cbranch_scc1 Lt_33
Lt_37:
  s_waitcnt vmcnt(24)
  s_barrier
  s_mul_i32 s5, s85, 6144
  s_nop 0
  s_mov_b32 s68, s24
  s_and_b32 s69, s25, 0xffff
  s_mov_b32 s70, 7340032
  s_mov_b32 s71, 0x00020000
  s_lshl_b32 s4, s76, Lz1-Lz0+4
  s_add_u32 s4, s4, s77
  s_mul_i32 s34, s4, 28672
  s_add_u32 s34, s34, s5
  s_waitcnt vmcnt(12)
  s_barrier
  buffer_load_dwordx4 v4, s[48:51], s7 offen offset:0 lds
  buffer_load_dwordx4 v5, s[48:51], s7 offen offset:1024 lds
  buffer_load_dwordx4 v6, s[48:51], s7 offen offset:2048 lds
  buffer_load_dwordx4 v7, s[48:51], s7 offen offset:3072 lds
Ll_38:
  s_add_u32 m0, s11, 8192
  s_add_u32 s5, s7, 2048
  buffer_load_dwordx4 v4, s[48:51], s5 offen offset:0 lds
  buffer_load_dwordx4 v5, s[48:51], s5 offen offset:1024 lds
  buffer_load_dwordx4 v6, s[48:51], s5 offen offset:2048 lds
  buffer_load_dwordx4 v7, s[48:51], s5 offen offset:3072 lds
  s_add_u32 m0, s11, 16384
  s_add_u32 s5, s7, 4096
  buffer_load_dwordx4 v4, s[48:51], s5 offen offset:0 lds
  s_add_u32 s12, s12, Lz1-Lz0+1
  v_readlane_b32 s7, v12, s12
  s_add_u32 s11, s11, 24576
  buffer_load_dwordx4 v5, s[48:51], s5 offen offset:1024 lds
  s_cmp_eq_u32 s11, s15
  s_cselect_b32 s4, 73728, 0
  s_sub_u32 s11, s11, s4
  buffer_load_dwordx4 v6, s[48:51], s5 offen offset:2048 lds
  s_cmp_eq_u32 s12, Lz1-Lz0+16
  buffer_load_dwordx4 v7, s[48:51], s5 offen offset:3072 lds
  s_mov_b32 m0, s11
  s_cbranch_scc1 Ll_39
  s_cmp_lg_u32 s82, 0
  s_cbranch_scc1 L_40
  s_buffer_load_dwordx2 s[98:99], s[68:71], s34 offset:60
  s_buffer_load_dwordx2 s[98:99], s[68:71], s34 offset:188
  s_buffer_load_dwordx2 s[98:99], s[68:71], s34 offset:316
  s_buffer_load_dwordx2 s[98:99], s[68:71], s34 offset:444
  s_add_u32 s34, s34, 512
L_40:
  s_waitcnt vmcnt(12)
  s_barrier
  buffer_load_dwordx4 v4, s[48:51], s7 offen offset:0 lds
  buffer_load_dwordx4 v5, s[48:51], s7 offen offset:1024 lds
  buffer_load_dwordx4 v6, s[48:51], s7 offen offset:2048 lds
  buffer_load_dwordx4 v7, s[48:51], s7 offen offset:3072 lds
  s_branch Ll_38
Ll_39:
  s_branch L_w1
L_xload:
  s_setprio 0
  v_lshrrev_b32 v2, 4, v1
  v_and_b32 v3, 7, v1
  v_xor_b32 v2, v2, v3
  v_lshrrev_b32 v3, 3, v1
  v_lshlrev_b32 v3, 12, v3
  v_lshl_add_u32 v4, v2, 4, v3
  v_xor_b32_e64 v5, 64, v4
  v_add_u32 v5, 31744, v5
  v_add_u32 v6, 63488, v4
  v_add_u32 v7, 63488, v5
  s_mov_b32 s13, 0x20000
  s_movk_i32 s95, 2048
  s_lshl_b32 s5, s76, 18
  s_and_b32 s6, s76, 6
  s_lshr_b32 s4, s76, 3
  s_add_u32 s6, s6, s4
  s_lshl_b32 s6, s6, 1
  v_add_u32 v9, s6, v1
  v_and_b32 v9, 15, v9
  v_lshl_add_u32 v9, v9, 7, s5
  s_nop 0
  v_readfirstlane_b32 s7, v9
  s_waitcnt lgkmcnt(0)
  s_mov_b32 s72, s16
  s_and_b32 s73, s17, 0xffff
  s_mov_b32 s74, 4194304
  s_mov_b32 s75, 0x00020000
  s_mov_b32 s11, 0
  s_mov_b32 s15, 65536
L_xlayer:
  s_mov_b32 s12, s82
  s_mov_b32 m0, s11
Ll_79:
  s_nop 0
  buffer_load_dwordx4 v4, s[72:75], s7 offen offset:0 sc1 lds
  buffer_load_dwordx4 v5, s[72:75], s7 offen offset:1024 sc1 lds
  buffer_load_dwordx4 v6, s[72:75], s7 offen offset:2048 sc1 lds
  buffer_load_dwordx4 v7, s[72:75], s7 offen offset:3072 sc1 lds
  s_add_u32 m0, s11, 4096
  s_nop 0
  s_add_u32 s5, s7, s13
  buffer_load_dwordx4 v4, s[72:75], s5 offen offset:0 sc1 lds
  buffer_load_dwordx4 v5, s[72:75], s5 offen offset:1024 sc1 lds
  buffer_load_dwordx4 v6, s[72:75], s5 offen offset:2048 sc1 lds
  buffer_load_dwordx4 v7, s[72:75], s5 offen offset:3072 sc1 lds
  s_add_u32 m0, s11, 8192
  s_nop 0
  s_add_u32 s3, s7, s95
  buffer_load_dwordx4 v4, s[72:75], s3 offen offset:0 sc1 lds
  buffer_load_dwordx4 v5, s[72:75], s3 offen offset:1024 sc1 lds
  buffer_load_dwordx4 v6, s[72:75], s3 offen offset:2048 sc1 lds
  buffer_load_dwordx4 v7, s[72:75], s3 offen offset:3072 sc1 lds
  s_add_u32 m0, s11, 12288
  s_add_u32 s5, s3, s13
  buffer_load_dwordx4 v4, s[72:75], s5 offen offset:0 sc1 lds
  s_add_u32 s12, s12, 1
  v_readlane_b32 s7, v9, s12
  s_add_u32 s11, s11, 16384
  buffer_load_dwordx4 v5, s[72:75], s5 offen offset:1024 sc1 lds
  s_cmp_eq_u32 s11, s15
  s_cselect_b32 s4, 65536, 0
  s_sub_u32 s11, s11, s4
  buffer_load_dwordx4 v6, s[72:75], s5 offen offset:2048 sc1 lds
  s_cmp_lg_u32 s12, Lz1-Lz0+3
  buffer_load_dwordx4 v7, s[72:75], s5 offen offset:3072 sc1 lds
  s_mov_b32 m0, s11
  s_cbranch_scc1 Ll_80
  s_cmp_lg_u32 s82, 0
  s_cbranch_scc1 Ll_80
  s_waitcnt vmcnt(32)
  s_barrier
Ll_80:
  s_cmp_lt_u32 s12, Lz1-Lz0+4
  s_cbranch_scc1 Ll_79
  s_mov_b32 s68, s20
  s_and_b32 s69, s21, 0xffff
  s_mov_b32 s70, 2097152
  s_mov_b32 s71, 0x00020000
  s_lshl_b32 s4, s76, 4
  s_add_u32 s4, s4, s77
  s_mul_i32 s34, s4, 8192
  s_waitcnt vmcnt(32)
  s_barrier
  buffer_load_dwordx4 v4, s[72:75], s7 offen offset:0 sc1 lds
  buffer_load_dwordx4 v5, s[72:75], s7 offen offset:1024 sc1 lds
  buffer_load_dwordx4 v6, s[72:75], s7 offen offset:2048 sc1 lds
  buffer_load_dwordx4 v7, s[72:75], s7 offen offset:3072 sc1 lds
Ll_83:
  s_add_u32 m0, s11, 4096
  s_nop 0
  s_add_u32 s5, s7, s13
  buffer_load_dwordx4 v4, s[72:75], s5 offen offset:0 sc1 lds
  buffer_load_dwordx4 v5, s[72:75], s5 offen offset:1024 sc1 lds
  buffer_load_dwordx4 v6, s[72:75], s5 offen offset:2048 sc1 lds
  buffer_load_dwordx4 v7, s[72:75], s5 offen offset:3072 sc1 lds
  s_add_u32 m0, s11, 8192
  s_nop 0
  s_add_u32 s3, s7, s95
  buffer_load_dwordx4 v4, s[72:75], s3 offen offset:0 sc1 lds
  buffer_load_dwordx4 v5, s[72:75], s3 offen offset:1024 sc1 lds
  buffer_load_dwordx4 v6, s[72:75], s3 offen offset:2048 sc1 lds
  buffer_load_dwordx4 v7, s[72:75], s3 offen offset:3072 sc1 lds
  s_add_u32 m0, s11, 12288
  s_add_u32 s5, s3, s13
  buffer_load_dwordx4 v4, s[72:75], s5 offen offset:0 sc1 lds
  s_add_u32 s12, s12, 1
  v_readlane_b32 s7, v9, s12
  s_add_u32 s11, s11, 16384
  buffer_load_dwordx4 v5, s[72:75], s5 offen offset:1024 sc1 lds
  s_cmp_eq_u32 s11, s15
  s_cselect_b32 s4, 65536, 0
  s_sub_u32 s11, s11, s4
  buffer_load_dwordx4 v6, s[72:75], s5 offen offset:2048 sc1 lds
  s_cmp_eq_u32 s12, Lz1-Lz0+16
  buffer_load_dwordx4 v7, s[72:75], s5 offen offset:3072 sc1 lds
  s_mov_b32 m0, s11
  s_cbranch_scc1 Ll_84
  s_cmp_lg_u32 s82, 0
  s_cbranch_scc1 L_85
  s_buffer_load_dwordx2 s[98:99], s[68:71], s34 offset:60
  s_buffer_load_dwordx2 s[98:99], s[68:71], s34 offset:188
  s_buffer_load_dwordx2 s[98:99], s[68:71], s34 offset:316
  s_buffer_load_dwordx2 s[98:99], s[68:71], s34 offset:444
  s_buffer_load_dwordx2 s[98:99], s[68:71], s34 offset:572
  s_add_u32 s34, s34, 640
L_85:
  s_waitcnt vmcnt(32)
  s_barrier
  buffer_load_dwordx4 v4, s[72:75], s7 offen offset:0 sc1 lds
  buffer_load_dwordx4 v5, s[72:75], s7 offen offset:1024 sc1 lds
  buffer_load_dwordx4 v6, s[72:75], s7 offen offset:2048 sc1 lds
  buffer_load_dwordx4 v7, s[72:75], s7 offen offset:3072 sc1 lds
  s_branch Ll_83
  s_nop 0
Ll_84:
  s_waitcnt vmcnt(32)
  s_barrier
  s_waitcnt vmcnt(16)
  s_barrier
  s_waitcnt vmcnt(0)
  s_barrier
  s_barrier
  s_branch L_x1
L_serv:
  s_setprio 3
  s_and_b32 s80, s77, 7
  s_lshr_b32 s79, s77, 3
  s_lshl_b32 s78, s80, 1
  s_add_u32 s78, s78, s79
  s_lshl_b32 s5, s76, 4
  s_add_u32 s5, s5, s77
  s_lshl_b32 s84, s5, 11
  s_mov_b32 s83, 3145728
  s_mov_b32 s87, 1835016
  s_lshr_b32 s86, s81, 1
  v_lshlrev_b32 v4, 4, v1
  v_mov_b32 v24, 0
  v_mov_b32 v25, 0
  v_mov_b32 v26, 0
  v_mov_b32 v27, 0
  v_and_b32 v2, 14, v1
  v_lshlrev_b32 v3, 11, v2
  v_and_b32_e64 v2, 1, v1
  v_lshl_add_u32 v3, v2, 4, v3
  v_and_b32_e64 v2, 48, v1
  v_lshl_add_u32 v3, v2, 1, v3
  v_bfe_u32 v2, v1, 3, 2
  v_and_b32 v22, 7, v1
  v_lshlrev_b32 v2, 14, v2
  v_lshl_add_u32 v2, v22, 3, v2
  s_lshl_b32 s5, s76, 7
  s_lshl_b32 s4, s80, 4
  s_add_u32 s6, s5, s4
  s_add_u32 s6, s6, s79
  s_lshl_b32 s6, s6, 11
  s_lshr_b32 s10, s84, 5
  s_add_u32 s10, s10, 1638400
  s_waitcnt lgkmcnt(0)
  s_mov_b32 s48, s18
  s_and_b32 s49, s19, 0xffff
  s_mov_b32 s50, 6291456
  s_mov_b32 s51, 0x00020000
  s_sub_u32 s4, 384, s48
  s_and_b32 s4, s4, 1023
  s_mul_i32 s5, s84, 12
  s_add_u32 s4, s4, s5
  v_lshlrev_b32_e64 v109, 10, v1
  s_mov_b64 exec, 0xffffff
  buffer_load_dword v109, v109, s[48:51], s4 offen
  s_mov_b64 exec, -1
  s_mov_b32 s40, s38
  s_and_b32 s41, s39, 0xffff
  s_mov_b32 s42, 100663296
  s_mov_b32 s43, 0x00020000
  s_nop 0
  s_mov_b32 s44, s16
  s_and_b32 s45, s17, 0xffff
  s_mov_b32 s46, 4194304
  s_mov_b32 s47, 0x00020000
  s_nop 0
  s_mov_b32 s68, s36
  s_and_b32 s69, s37, 0xffff
  s_mov_b32 s70, 256
  s_mov_b32 s71, 0x00020000
  s_lshl_b32 s4, s84, Lz1-Lz0+1
  s_add_u32 s4, s4, 1835008
  buffer_store_dwordx4 v[24:27], v4, s[40:43], s4 offen offset:0 sc0 sc1
  buffer_store_dwordx4 v[24:27], v4, s[40:43], s4 offen offset:1024 sc0 sc1
  v_mov_b32 v28, -1
  v_mov_b32 v29, -1
  v_mov_b32 v30, -1
  v_mov_b32 v31, -1
  s_lshl_b32 s4, s84, 1
  s_add_u32 s4, s4, 0
  buffer_store_dwordx4 v[28:31], v4, s[40:43], s4 offen offset:0 sc0 sc1
  buffer_store_dwordx4 v[28:31], v4, s[40:43], s4 offen offset:1024 sc0 sc1
  buffer_store_dwordx4 v[28:31], v4, s[40:43], s4 offen offset:2048 sc0 sc1
  buffer_store_dwordx4 v[28:31], v4, s[40:43], s4 offen offset:3072 sc0 sc1
  buffer_store_dwordx2 v[24:25], v2, s[40:43], s10 offen sc0 sc1
  v_mov_b32 v108, v3
  s_mov_b32 s7, s6
  s_branch L_s1
L_comp:
  s_and_b32 s80, s77, 7
  s_lshr_b32 s79, s77, 3
  s_lshl_b32 s78, s80, 1
  s_add_u32 s78, s78, s79
  s_lshl_b32 s5, s76, 4
  s_add_u32 s5, s5, s77
  s_lshl_b32 s84, s5, 11
  s_mov_b32 s83, 3145728
  s_mov_b32 s87, 1835016
  s_lshr_b32 s86, s81, Lz1-Lz0+1
  s_waitcnt lgkmcnt(0)
  s_mov_b32 s40, s38
  s_and_b32 s41, s39, 0xffff
  s_mov_b32 s42, 100663296
  s_mov_b32 s43, 0x00020000
  s_nop 0
  s_mov_b32 s44, s16
  s_and_b32 s45, s17, 0xffff
  s_mov_b32 s46, 4194304
  s_mov_b32 s47, 0x00020000
  s_nop 0
  s_mov_b32 s64, s32
  s_and_b32 s65, s33, 0xffff
  s_mov_b32 s66, 4194304
  s_mov_b32 s67, 0x00020000
  s_setprio 1
  v_lshlrev_b32 v11, 4, v1
  v_lshrrev_b32 v2, 3, v1
  v_and_b32 v3, 7, v1
  v_lshlrev_b32_e64 v3, 3, v3
  v_lshl_add_u32 v30, v2, 11, v3
  s_lshl_b32 s4, s85, 13
  s_lshl_b32 s5, s86, 10
  s_add_u32 s4, s4, s5
  v_add_u32 v0, s4, v11
  v_mov_b32_e64 v27, 1
  v_mov_b32 v28, 156416
  v_and_b32 v29, 48, v1
  s_lshl_b32 s4, s76, 16
  s_lshl_b32 s5, s77, 7
  s_add_u32 s4, s4, s5
  v_lshlrev_b32 v24, 12, v1
  v_and_b32 v2, 16, v1
  v_lshl_add_u32 v24, v2, 7, v24
  v_add_u32 v24, s4, v24
  v_lshrrev_b32 v2, 2, v1
  v_lshlrev_b32 v25, 7, v2
  v_and_b32 v2, 3, v1
  v_lshl_add_u32 v25, v2, 3, v25
  v_add_u32 v25, 65536, v25
  v_bfe_u32 v26, v1, 3, 2
  v_and_b32 v2, 15, v1
  v_lshrrev_b32 v3, 2, v29
  v_sub_u32_e64 v2, v2, v3
  s_mov_b32 s4, 0xf149f2ca
  v_mov_b32 v32, s4
  v_subrev_u32 v3, 0, v2
  v_cmp_gt_u32 vcc, 8, v3
  s_nop 1
  v_cndmask_b32_e64 v12, v32, 0, vcc
  v_cmp_ge_i32 vcc, -9, v3
  s_nop 1
  v_cndmask_b32_e64 v16, v32, 0, vcc
  v_mov_b32 v20, v16
  v_subrev_u32 v3, 1, v2
  v_cmp_gt_u32 vcc, 8, v3
  s_nop 1
  v_cndmask_b32_e64 v13, v32, 0, vcc
  v_cmp_ge_i32 vcc, -9, v3
  s_nop 1
  v_cndmask_b32_e64 v17, v32, 0, vcc
  v_mov_b32 v21, v17
  v_subrev_u32 v3, 2, v2
  v_cmp_gt_u32 vcc, 8, v3
  s_nop 1
  v_cndmask_b32_e64 v14, v32, 0, vcc
  v_cmp_ge_i32 vcc, -9, v3
  s_nop 1
  v_cndmask_b32_e64 v18, v32, 0, vcc
  v_mov_b32 v22, v18
  v_subrev_u32 v3, 3, v2
  v_cmp_gt_u32 vcc, 8, v3
  s_nop 1
  v_cndmask_b32_e64 v15, v32, 0, vcc
  v_cmp_ge_i32 vcc, -9, v3
  s_nop 1
  v_cndmask_b32_e64 v19, v32, 0, vcc
  v_mov_b32 v23, v19
  s_cmp_lg_u32 s76, 0
  s_cbranch_scc1 L_1
  v_mov_b32 v20, v32
  v_mov_b32 v21, v32
  v_mov_b32 v22, v32
  v_mov_b32 v23, v32
L_1:
  s_lshl_b32 s11, s84, 1
  s_lshl_b32 s4, s81, 10
  s_add_u32 s11, s11, s4
L_clayer:
  s_mov_b32 s16, Lz1-Lz0+0
  s_mov_b32 s17, 16384
  s_mov_b32 s18, 0xffff4000
  s_mov_b32 s19, Lz1-Lz0+0
  s_mov_b32 s20, 24576
  s_mov_b32 s21, 0xffff4000
  s_mul_i32 s4, s85, 8192
  v_add_u32_e64 v4, s4, v11
  v_add_u32 v5, 1024, v4
  s_cmp_lg_u32 s82, 0
  s_cbranch_scc1 L_2
  v_and_b32 v2, 15, v1
  v_lshrrev_b32 v3, 1, v2
  v_lshrrev_b32 v32, 4, v1
  v_xor_b32 v3, v3, v32
  v_lshlrev_b32_e64 v3, 4, v3
  v_lshl_add_u32 v3, v2, 7, v3
  v_add_u32 v4, s4, v3
  v_xor_b32 v3, 64, v3
  v_add_u32 v5, s4, v3
L_2:
  s_lshl_b32 s4, s86, 1
  v_xor_b32_e64 v2, s4, v26
  v_lshl_add_u32 v6, v2, 5, v25
  s_add_u32 s4, s4, 1
  v_xor_b32 v2, s4, v26
  v_lshl_add_u32 v7, v2, 5, v25
  v_mov_b64 v[128:129], 0
  v_mov_b64 v[130:131], 0
  v_mov_b64 v[132:133], 0
  v_mov_b64 v[134:135], 0
  v_mov_b64 v[136:137], 0
  v_mov_b64 v[138:139], 0
  v_mov_b64 v[140:141], 0
  v_mov_b64 v[142:143], 0
  v_mov_b64 v[144:145], 0
  v_mov_b64 v[146:147], 0
  v_mov_b64 v[148:149], 0
  v_mov_b64 v[150:151], 0
  v_mov_b64 v[152:153], 0
  v_mov_b64 v[154:155], 0
  v_mov_b64 v[156:157], 0
  v_mov_b64 v[158:159], 0
  v_mov_b64 v[160:161], 0
  v_mov_b64 v[162:163], 0
  v_mov_b64 v[164:165], 0
  v_mov_b64 v[166:167], 0
  v_mov_b64 v[168:169], 0
  v_mov_b64 v[170:171], 0
  v_mov_b64 v[172:173], 0
  v_mov_b64 v[174:175], 0
  v_mov_b64 v[176:177], 0
  v_mov_b64 v[178:179], 0
  v_mov_b64 v[180:181], 0
  v_mov_b64 v[182:183], 0
  v_mov_b64 v[184:185], 0
  v_mov_b64 v[186:187], 0
  v_mov_b64 v[188:189], 0
  v_mov_b64 v[190:191], 0
  v_mov_b64 v[192:193], 0
  v_mov_b64 v[194:195], 0
  v_mov_b64 v[196:197], 0
  v_mov_b64 v[198:199], 0
  v_mov_b64 v[200:201], 0
  v_mov_b64 v[202:203], 0
  v_mov_b64 v[204:205], 0
  v_mov_b64 v[206:207], 0
  v_mov_b64 v[208:209], 0
  v_mov_b64 v[210:211], 0
  v_mov_b64 v[212:213], 0
  v_mov_b64 v[214:215], 0
  v_mov_b64 v[216:217], 0
  v_mov_b64 v[218:219], 0
  v_mov_b64 v[220:221], 0
  v_mov_b64 v[222:223], 0
  s_mov_b32 s22, Lz1-Lz0+8
  s_cmp_lg_u32 s82, 0
  s_cselect_b64 vcc, -1, 0
  s_waitcnt lgkmcnt(0)
  s_barrier
Lo_5:
  ds_read_b128 v[32:35], v4 offset:0
  ds_read_b128 v[48:51], v5 offset:0
  ds_read_b128 v[36:39], v4 offset:2048
  ds_read_b128 v[52:55], v5 offset:2048
  ds_read_b128 v[40:43], v4 offset:4096
  ds_read_b128 v[56:59], v5 offset:4096
  ds_read_b64_tr_b16 v[96:97], v6 offset:0
  ds_read_b64_tr_b16 v[98:99], v6 offset:2048
  ds_read_b64_tr_b16 v[100:101], v6 offset:4096
  ds_read_b64_tr_b16 v[102:103], v6 offset:6144
  ds_read_b128 v[44:47], v4 offset:6144
  ds_read_b128 v[60:63], v5 offset:6144
  ds_read_b64_tr_b16 v[104:105], v7 offset:0
  s_nop 0
  s_waitcnt lgkmcnt(8)
  ds_read_b64_tr_b16 v[106:107], v7 offset:2048
  ds_read_b64_tr_b16 v[108:109], v7 offset:4096
  ds_read_b64_tr_b16 v[110:111], v7 offset:6144
Lk_3:
  s_nop 0
  s_waitcnt lgkmcnt(6)
  v_mfma_f32_16x16x32_bf16 v[128:131], v[96:99], v[32:35], v[128:131]
  ds_read_b64_tr_b16 v[112:113], v6 offset:8192
  v_mfma_f32_16x16x32_bf16 v[128:131], v[100:103], v[48:51], v[128:131]
  ds_read_b64_tr_b16 v[114:115], v6 offset:10240
  v_mfma_f32_16x16x32_bf16 v[136:139], v[96:99], v[36:39], v[136:139]
  ds_read_b64_tr_b16 v[116:117], v6 offset:12288
  v_mfma_f32_16x16x32_bf16 v[136:139], v[100:103], v[52:55], v[136:139]
  ds_read_b64_tr_b16 v[118:119], v6 offset:14336
  v_mfma_f32_16x16x32_bf16 v[144:147], v[96:99], v[40:43], v[144:147]
  s_add_u32 s16, s16, s17
  s_cmp_eq_u32 s16, 65536
  s_cselect_b32 s23, s18, s17
  s_cselect_b32 s16, Lz1-Lz0+0, s16
  v_mfma_f32_16x16x32_bf16 v[144:147], v[100:103], v[56:59], v[144:147]
  v_add_u32_e64 v4, s23, v4
  v_add_u32 v5, s23, v5
  s_add_u32 s19, s19, s20
  s_cmp_eq_u32 s19, 73728
  s_waitcnt lgkmcnt(8)
  v_mfma_f32_16x16x32_bf16 v[152:155], v[96:99], v[44:47], v[152:155]
  s_cselect_b32 s23, s21, s20
  s_cselect_b32 s19, 0, s19
  v_mfma_f32_16x16x32_bf16 v[152:155], v[100:103], v[60:63], v[152:155]
  s_waitcnt lgkmcnt(4)
  v_mfma_f32_16x16x32_bf16 v[132:135], v[104:107], v[32:35], v[132:135]
  ds_read_b64_tr_b16 v[120:121], v7 offset:8192
  v_mfma_f32_16x16x32_bf16 v[132:135], v[108:111], v[48:51], v[132:135]
  ds_read_b64_tr_b16 v[122:123], v7 offset:10240
  v_mfma_f32_16x16x32_bf16 v[140:143], v[104:107], v[36:39], v[140:143]
  ds_read_b64_tr_b16 v[124:125], v7 offset:12288
  v_mfma_f32_16x16x32_bf16 v[140:143], v[108:111], v[52:55], v[140:143]
  ds_read_b64_tr_b16 v[126:127], v7 offset:14336
  v_mfma_f32_16x16x32_bf16 v[148:151], v[104:107], v[40:43], v[148:151]
  ds_read_b64_tr_b16 v[224:225], v6 offset:16384
  v_mfma_f32_16x16x32_bf16 v[148:151], v[108:111], v[56:59], v[148:151]
  ds_read_b64_tr_b16 v[226:227], v6 offset:18432
  v_mfma_f32_16x16x32_bf16 v[156:159], v[104:107], v[44:47], v[156:159]
  ds_read_b64_tr_b16 v[228:229], v6 offset:20480
  v_mfma_f32_16x16x32_bf16 v[156:159], v[108:111], v[60:63], v[156:159]
  ds_read_b64_tr_b16 v[230:231], v6 offset:22528
  s_nop 0
  s_waitcnt lgkmcnt(8)
  v_mfma_f32_16x16x32_bf16 v[160:163], v[112:115], v[32:35], v[160:163]
  ds_read_b64_tr_b16 v[232:233], v7 offset:16384
  v_mfma_f32_16x16x32_bf16 v[160:163], v[116:119], v[48:51], v[160:163]
  ds_read_b64_tr_b16 v[234:235], v7 offset:18432
  v_mfma_f32_16x16x32_bf16 v[168:171], v[112:115], v[36:39], v[168:171]
  ds_read_b64_tr_b16 v[236:237], v7 offset:20480
  v_mfma_f32_16x16x32_bf16 v[168:171], v[116:119], v[52:55], v[168:171]
  ds_read_b64_tr_b16 v[238:239], v7 offset:22528
  v_mfma_f32_16x16x32_bf16 v[176:179], v[112:115], v[40:43], v[176:179]
  v_add_u32_e64 v6, s23, v6
  v_mfma_f32_16x16x32_bf16 v[176:179], v[116:119], v[56:59], v[176:179]
  v_add_u32_e64 v7, s23, v7
  v_mfma_f32_16x16x32_bf16 v[184:187], v[112:115], v[44:47], v[184:187]
  v_mfma_f32_16x16x32_bf16 v[184:187], v[116:119], v[60:63], v[184:187]
  s_waitcnt lgkmcnt(0)
  s_cbranch_vccnz Lo_7
  s_nop 0
  s_barrier
Lo_7:
  v_mfma_f32_16x16x32_bf16 v[164:167], v[120:123], v[32:35], v[164:167]
  ds_read_b128 v[64:67], v4 offset:0
  v_mfma_f32_16x16x32_bf16 v[164:167], v[124:127], v[48:51], v[164:167]
  ds_read_b128 v[80:83], v5 offset:0
  v_mfma_f32_16x16x32_bf16 v[172:175], v[120:123], v[36:39], v[172:175]
  v_mfma_f32_16x16x32_bf16 v[172:175], v[124:127], v[52:55], v[172:175]
  ds_read_b128 v[68:71], v4 offset:2048
  v_mfma_f32_16x16x32_bf16 v[180:183], v[120:123], v[40:43], v[180:183]
  ds_read_b128 v[84:87], v5 offset:2048
  v_mfma_f32_16x16x32_bf16 v[180:183], v[124:127], v[56:59], v[180:183]
  v_mfma_f32_16x16x32_bf16 v[188:191], v[120:123], v[44:47], v[188:191]
  ds_read_b128 v[72:75], v4 offset:4096
  v_mfma_f32_16x16x32_bf16 v[188:191], v[124:127], v[60:63], v[188:191]
  ds_read_b128 v[88:91], v5 offset:4096
  v_mfma_f32_16x16x32_bf16 v[192:195], v[32:35], v[224:227], v[192:195]
  ds_read_b64_tr_b16 v[96:97], v6 offset:0
  v_mfma_f32_16x16x32_bf16 v[192:195], v[48:51], v[228:231], v[192:195]
  ds_read_b64_tr_b16 v[98:99], v6 offset:2048
  v_mfma_f32_16x16x32_bf16 v[200:203], v[36:39], v[224:227], v[200:203]
  ds_read_b64_tr_b16 v[100:101], v6 offset:4096
  v_mfma_f32_16x16x32_bf16 v[200:203], v[52:55], v[228:231], v[200:203]
  ds_read_b64_tr_b16 v[102:103], v6 offset:6144
  v_mfma_f32_16x16x32_bf16 v[208:211], v[40:43], v[224:227], v[208:211]
  ds_read_b128 v[76:79], v4 offset:6144
  v_mfma_f32_16x16x32_bf16 v[208:211], v[56:59], v[228:231], v[208:211]
  v_mfma_f32_16x16x32_bf16 v[216:219], v[44:47], v[224:227], v[216:219]
  ds_read_b128 v[92:95], v5 offset:6144
  v_mfma_f32_16x16x32_bf16 v[216:219], v[60:63], v[228:231], v[216:219]
  v_mfma_f32_16x16x32_bf16 v[196:199], v[32:35], v[232:235], v[196:199]
  ds_read_b64_tr_b16 v[104:105], v7 offset:0
  v_mfma_f32_16x16x32_bf16 v[196:199], v[48:51], v[236:239], v[196:199]
  v_mfma_f32_16x16x32_bf16 v[204:207], v[36:39], v[232:235], v[204:207]
  ds_read_b64_tr_b16 v[106:107], v7 offset:2048
  v_mfma_f32_16x16x32_bf16 v[204:207], v[52:55], v[236:239], v[204:207]
  v_mfma_f32_16x16x32_bf16 v[212:215], v[40:43], v[232:235], v[212:215]
  ds_read_b64_tr_b16 v[108:109], v7 offset:4096
  v_mfma_f32_16x16x32_bf16 v[212:215], v[56:59], v[236:239], v[212:215]
  v_mfma_f32_16x16x32_bf16 v[220:223], v[44:47], v[232:235], v[220:223]
  ds_read_b64_tr_b16 v[110:111], v7 offset:6144
  v_mfma_f32_16x16x32_bf16 v[220:223], v[60:63], v[236:239], v[220:223]
  s_cbranch_vccnz Lo_6
Lk_4:
  s_waitcnt lgkmcnt(6)
  v_mfma_f32_16x16x32_bf16 v[128:131], v[96:99], v[64:67], v[128:131]
  ds_read_b64_tr_b16 v[112:113], v6 offset:8192
  v_mfma_f32_16x16x32_bf16 v[128:131], v[100:103], v[80:83], v[128:131]
  ds_read_b64_tr_b16 v[114:115], v6 offset:10240
  v_mfma_f32_16x16x32_bf16 v[136:139], v[96:99], v[68:71], v[136:139]
  ds_read_b64_tr_b16 v[116:117], v6 offset:12288
  v_mfma_f32_16x16x32_bf16 v[136:139], v[100:103], v[84:87], v[136:139]
  ds_read_b64_tr_b16 v[118:119], v6 offset:14336
  v_mfma_f32_16x16x32_bf16 v[144:147], v[96:99], v[72:75], v[144:147]
  s_add_u32 s16, s16, s17
  s_cmp_eq_u32 s16, 65536
  s_cselect_b32 s23, s18, s17
  s_cselect_b32 s16, Lz1-Lz0+0, s16
  v_mfma_f32_16x16x32_bf16 v[144:147], v[100:103], v[88:91], v[144:147]
  v_add_u32_e64 v4, s23, v4
  v_add_u32 v5, s23, v5
  s_add_u32 s19, s19, s20
  s_cmp_eq_u32 s19, 73728
  s_waitcnt lgkmcnt(8)
  v_mfma_f32_16x16x32_bf16 v[152:155], v[96:99], v[76:79], v[152:155]
  s_cselect_b32 s23, s21, s20
  s_cselect_b32 s19, 0, s19
  v_mfma_f32_16x16x32_bf16 v[152:155], v[100:103], v[92:95], v[152:155]
  s_waitcnt lgkmcnt(4)
  v_mfma_f32_16x16x32_bf16 v[132:135], v[104:107], v[64:67], v[132:135]
  ds_read_b64_tr_b16 v[120:121], v7 offset:8192
  v_mfma_f32_16x16x32_bf16 v[132:135], v[108:111], v[80:83], v[132:135]
  ds_read_b64_tr_b16 v[122:123], v7 offset:10240
  v_mfma_f32_16x16x32_bf16 v[140:143], v[104:107], v[68:71], v[140:143]
  ds_read_b64_tr_b16 v[124:125], v7 offset:12288
  v_mfma_f32_16x16x32_bf16 v[140:143], v[108:111], v[84:87], v[140:143]
  ds_read_b64_tr_b16 v[126:127], v7 offset:14336
  v_mfma_f32_16x16x32_bf16 v[148:151], v[104:107], v[72:75], v[148:151]
  ds_read_b64_tr_b16 v[224:225], v6 offset:16384
  v_mfma_f32_16x16x32_bf16 v[148:151], v[108:111], v[88:91], v[148:151]
  ds_read_b64_tr_b16 v[226:227], v6 offset:18432
  v_mfma_f32_16x16x32_bf16 v[156:159], v[104:107], v[76:79], v[156:159]
  ds_read_b64_tr_b16 v[228:229], v6 offset:20480
  v_mfma_f32_16x16x32_bf16 v[156:159], v[108:111], v[92:95], v[156:159]
  ds_read_b64_tr_b16 v[230:231], v6 offset:22528
  s_nop 0
  s_waitcnt lgkmcnt(8)
  v_mfma_f32_16x16x32_bf16 v[160:163], v[112:115], v[64:67], v[160:163]
  ds_read_b64_tr_b16 v[232:233], v7 offset:16384
  v_mfma_f32_16x16x32_bf16 v[160:163], v[116:119], v[80:83], v[160:163]
  ds_read_b64_tr_b16 v[234:235], v7 offset:18432
  v_mfma_f32_16x16x32_bf16 v[168:171], v[112:115], v[68:71], v[168:171]
  ds_read_b64_tr_b16 v[236:237], v7 offset:20480
  v_mfma_f32_16x16x32_bf16 v[168:171], v[116:119], v[84:87], v[168:171]
  ds_read_b64_tr_b16 v[238:239], v7 offset:22528
  v_mfma_f32_16x16x32_bf16 v[176:179], v[112:115], v[72:75], v[176:179]
  v_add_u32_e64 v6, s23, v6
  v_mfma_f32_16x16x32_bf16 v[176:179], v[116:119], v[88:91], v[176:179]
  v_add_u32_e64 v7, s23, v7
  v_mfma_f32_16x16x32_bf16 v[184:187], v[112:115], v[76:79], v[184:187]
  v_mfma_f32_16x16x32_bf16 v[184:187], v[116:119], v[92:95], v[184:187]
  s_waitcnt lgkmcnt(0)
  s_barrier
  v_mfma_f32_16x16x32_bf16 v[164:167], v[120:123], v[64:67], v[164:167]
  ds_read_b128 v[32:35], v4 offset:0
  v_mfma_f32_16x16x32_bf16 v[164:167], v[124:127], v[80:83], v[164:167]
  ds_read_b128 v[48:51], v5 offset:0
  v_mfma_f32_16x16x32_bf16 v[172:175], v[120:123], v[68:71], v[172:175]
  v_mfma_f32_16x16x32_bf16 v[172:175], v[124:127], v[84:87], v[172:175]
  ds_read_b128 v[36:39], v4 offset:2048
  v_mfma_f32_16x16x32_bf16 v[180:183], v[120:123], v[72:75], v[180:183]
  ds_read_b128 v[52:55], v5 offset:2048
  v_mfma_f32_16x16x32_bf16 v[180:183], v[124:127], v[88:91], v[180:183]
  v_mfma_f32_16x16x32_bf16 v[188:191], v[120:123], v[76:79], v[188:191]
  ds_read_b128 v[40:43], v4 offset:4096
  v_mfma_f32_16x16x32_bf16 v[188:191], v[124:127], v[92:95], v[188:191]
  ds_read_b128 v[56:59], v5 offset:4096
  v_mfma_f32_16x16x32_bf16 v[192:195], v[64:67], v[224:227], v[192:195]
  ds_read_b64_tr_b16 v[96:97], v6 offset:0
  v_mfma_f32_16x16x32_bf16 v[192:195], v[80:83], v[228:231], v[192:195]
  ds_read_b64_tr_b16 v[98:99], v6 offset:2048
  v_mfma_f32_16x16x32_bf16 v[200:203], v[68:71], v[224:227], v[200:203]
  ds_read_b64_tr_b16 v[100:101], v6 offset:4096
  v_mfma_f32_16x16x32_bf16 v[200:203], v[84:87], v[228:231], v[200:203]
  ds_read_b64_tr_b16 v[102:103], v6 offset:6144
  v_mfma_f32_16x16x32_bf16 v[208:211], v[72:75], v[224:227], v[208:211]
  ds_read_b128 v[44:47], v4 offset:6144
  v_mfma_f32_16x16x32_bf16 v[208:211], v[88:91], v[228:231], v[208:211]
  v_mfma_f32_16x16x32_bf16 v[216:219], v[76:79], v[224:227], v[216:219]
  ds_read_b128 v[60:63], v5 offset:6144
  v_mfma_f32_16x16x32_bf16 v[216:219], v[92:95], v[228:231], v[216:219]
  v_mfma_f32_16x16x32_bf16 v[196:199], v[64:67], v[232:235], v[196:199]
  ds_read_b64_tr_b16 v[104:105], v7 offset:0
  v_mfma_f32_16x16x32_bf16 v[196:199], v[80:83], v[236:239], v[196:199]
  v_mfma_f32_16x16x32_bf16 v[204:207], v[68:71], v[232:235], v[204:207]
  ds_read_b64_tr_b16 v[106:107], v7 offset:2048
  v_mfma_f32_16x16x32_bf16 v[204:207], v[84:87], v[236:239], v[204:207]
  v_mfma_f32_16x16x32_bf16 v[212:215], v[72:75], v[232:235], v[212:215]
  ds_read_b64_tr_b16 v[108:109], v7 offset:4096
  v_mfma_f32_16x16x32_bf16 v[212:215], v[88:91], v[236:239], v[212:215]
  v_mfma_f32_16x16x32_bf16 v[220:223], v[76:79], v[232:235], v[220:223]
  ds_read_b64_tr_b16 v[110:111], v7 offset:6144
  v_mfma_f32_16x16x32_bf16 v[220:223], v[92:95], v[236:239], v[220:223]
  s_sub_u32 s22, s22, 1
  s_cmp_lg_u32 s22, 0
  s_cbranch_scc1 Lk_3
  s_cmp_lg_u32 s82, 0
  s_cbranch_scc1 L_8
  v_and_b32 v2, 15, v1
  v_lshlrev_b32 v3, 12, v2
  v_and_b32 v2, 16, v1
  v_lshl_add_u32 v3, v2, 1, v3
  v_and_b32 v2, 32, v1
  v_lshrrev_b32 v2, 1, v2
  v_add_u32 v3, v2, v3
  s_lshl_b32 s5, s76, 18
  s_lshl_b32 s4, s85, 11
  s_add_u32 s5, s5, s4
  s_lshl_b32 s4, s78, 7
  s_add_u32 s5, s5, s4
  s_lshl_b32 s4, s86, 6
  s_add_u32 s5, s5, s4
  buffer_load_dwordx4 v[240:243], v3, s[44:47], s5 offen
  s_add_u32 s5, s5, 0x10000
  buffer_load_dwordx4 v[244:247], v3, s[44:47], s5 offen
  s_add_u32 s5, s5, 0x10000
  buffer_load_dwordx4 v[248:251], v3, s[44:47], s5 offen
  s_add_u32 s5, s5, 0x10000
  buffer_load_dwordx4 v[252:255], v3, s[44:47], s5 offen
L_8:
  s_nop 0
  s_waitcnt lgkmcnt(0)
  s_mul_i32 s4, s85, 320
  s_add_u32 s4, s4, 151552
  v_and_b32_e64 v2, 15, v1
  v_lshl_add_u32 v3, v2, 2, s4
  v_add_u32 v124, s4, v29
  s_lshl_b32 s5, s86, 7
  s_add_u32 s5, s5, 153088
  v_add_u32_e64 v125, s5, v29
  v_lshl_add_u32 v2, v2, 2, s5
  s_mov_b32 s10, 0x7f
  s_mov_b32 s12, 0xff00ff00
  ds_read2_b32 v[94:95], v3 offset0:48 offset1:208
  ds_read_b128 v[106:109], v125 offset:256
  ds_read_b128 v[110:113], v125 offset:320
  ds_read_b128 v[224:227], v124 offset:192
  ds_read_b128 v[228:231], v124 offset:832
  ds_read2_b32 v[114:115], v2 offset0:128 offset1:144
  ds_read2_b32 v[88:89], v3 offset0:0 offset1:160
  ds_read2_b32 v[90:91], v3 offset0:16 offset1:176
  ds_read2_b32 v[92:93], v3 offset0:32 offset1:192
  ds_read_b128 v[98:101], v125 offset:0
  ds_read_b128 v[102:105], v125 offset:64
  s_add_u32 s9, s11, 65536
  v_lshrrev_b32_e64 v126, 1, v11
  v_bfi_b32 v126, s10, v11, v126
  v_mov_b64 v[64:65], 0
  v_mov_b64 v[66:67], 0
  v_mov_b64 v[232:233], 0
  v_mov_b64 v[234:235], 0
  v_mov_b32 v120, 0x3f803f80
  v_mov_b32 v121, 0x3f803f80
  v_mov_b32 v122, 0x3f803f80
  v_mov_b32 v123, 0x3f803f80
  s_nop 0
  s_waitcnt lgkmcnt(8)
  v_pk_mul_f32 v[116:117], v[106:107], v[94:95] op_sel:[0,1] op_sel_hi:[1,1]
  v_pk_mul_f32 v[118:119], v[108:109], v[94:95] op_sel:[0,1] op_sel_hi:[1,1]
  v_pk_fma_f32 v[184:185], v[184:185], v[94:95], v[116:117] op_sel:[0,0,0] op_sel_hi:[1,0,1] neg_lo:[0,0,1] neg_hi:[0,0,1]
  v_pk_fma_f32 v[186:187], v[186:187], v[94:95], v[118:119] op_sel:[0,0,0] op_sel_hi:[1,0,1] neg_lo:[0,0,1] neg_hi:[0,0,1]
  v_cvt_pk_bf16_f32 v60, v184, v185
  v_cvt_pk_bf16_f32 v61, v186, v187
  v_pk_mul_f32 v[116:117], v[110:111], v[94:95] op_sel:[0,1] op_sel_hi:[1,1]
  v_pk_mul_f32 v[118:119], v[112:113], v[94:95] op_sel:[0,1] op_sel_hi:[1,1]
  v_pk_fma_f32 v[188:189], v[188:189], v[94:95], v[116:117] op_sel:[0,0,0] op_sel_hi:[1,0,1] neg_lo:[0,0,1] neg_hi:[0,0,1]
  v_pk_fma_f32 v[190:191], v[190:191], v[94:95], v[118:119] op_sel:[0,0,0] op_sel_hi:[1,0,1] neg_lo:[0,0,1] neg_hi:[0,0,1]
  v_cvt_pk_bf16_f32 v62, v188, v189
  v_cvt_pk_bf16_f32 v63, v190, v191
  s_mov_b32 exec_lo, s12
  s_mov_b32 exec_hi, s12
  buffer_store_dwordx4 v[60:63], v126, s[40:43], s9 offen sc0 sc1
  s_mov_b64 exec, -1
  s_waitcnt lgkmcnt(5)
  v_pk_mul_f32 v[116:117], v[228:229], v[114:115] op_sel:[0,0] op_sel_hi:[1,0]
  v_pk_mul_f32 v[118:119], v[230:231], v[114:115] op_sel:[0,0] op_sel_hi:[1,0]
  v_pk_fma_f32 v[216:217], v[216:217], v[224:225], v[116:117] neg_lo:[0,0,1] neg_hi:[0,0,1]
  v_pk_fma_f32 v[218:219], v[218:219], v[226:227], v[118:119] neg_lo:[0,0,1] neg_hi:[0,0,1]
  v_cvt_pk_bf16_f32 v76, v216, v217
  v_cvt_pk_bf16_f32 v77, v218, v219
  v_pk_mul_f32 v[116:117], v[228:229], v[114:115] op_sel:[0,1] op_sel_hi:[1,1]
  v_pk_mul_f32 v[118:119], v[230:231], v[114:115] op_sel:[0,1] op_sel_hi:[1,1]
  v_pk_fma_f32 v[220:221], v[220:221], v[224:225], v[116:117] neg_lo:[0,0,1] neg_hi:[0,0,1]
  v_pk_fma_f32 v[222:223], v[222:223], v[226:227], v[118:119] neg_lo:[0,0,1] neg_hi:[0,0,1]
  v_cvt_pk_bf16_f32 v86, v220, v221
  v_cvt_pk_bf16_f32 v87, v222, v223
  v_mov_b64 v[78:79], v[86:87]
  s_mov_b32 exec_lo, 0
  s_mov_b32 exec_hi, Lz1-Lz0-1
  buffer_store_dwordx4 v[76:79], v11, s[40:43], s9 offen sc0 sc1
  s_mov_b64 exec, -1
  s_waitcnt lgkmcnt(0)
  v_pk_mul_f32 v[116:117], v[98:99], v[88:89] op_sel:[0,1] op_sel_hi:[1,1]
  v_pk_mul_f32 v[118:119], v[100:101], v[88:89] op_sel:[0,1] op_sel_hi:[1,1]
  v_pk_fma_f32 v[128:129], v[128:129], v[88:89], v[116:117] op_sel:[0,0,0] op_sel_hi:[1,0,1] neg_lo:[0,0,1] neg_hi:[0,0,1]
  v_pk_fma_f32 v[130:131], v[130:131], v[88:89], v[118:119] op_sel:[0,0,0] op_sel_hi:[1,0,1] neg_lo:[0,0,1] neg_hi:[0,0,1]
  v_cvt_pk_bf16_f32 v32, v128, v129
  v_cvt_pk_bf16_f32 v33, v130, v131
  v_pk_mul_f32 v[116:117], v[102:103], v[88:89] op_sel:[0,1] op_sel_hi:[1,1]
  v_pk_mul_f32 v[118:119], v[104:105], v[88:89] op_sel:[0,1] op_sel_hi:[1,1]
  v_pk_fma_f32 v[132:133], v[132:133], v[88:89], v[116:117] op_sel:[0,0,0] op_sel_hi:[1,0,1] neg_lo:[0,0,1] neg_hi:[0,0,1]
  v_pk_fma_f32 v[134:135], v[134:135], v[88:89], v[118:119] op_sel:[0,0,0] op_sel_hi:[1,0,1] neg_lo:[0,0,1] neg_hi:[0,0,1]
  v_cvt_pk_bf16_f32 v34, v132, v133
  v_cvt_pk_bf16_f32 v35, v134, v135
  v_pk_mul_f32 v[116:117], v[98:99], v[90:91] op_sel:[0,1] op_sel_hi:[1,1]
  v_pk_mul_f32 v[118:119], v[100:101], v[90:91] op_sel:[0,1] op_sel_hi:[1,1]
  v_pk_fma_f32 v[136:137], v[136:137], v[90:91], v[116:117] op_sel:[0,0,0] op_sel_hi:[1,0,1] neg_lo:[0,0,1] neg_hi:[0,0,1]
  v_pk_fma_f32 v[138:139], v[138:139], v[90:91], v[118:119] op_sel:[0,0,0] op_sel_hi:[1,0,1] neg_lo:[0,0,1] neg_hi:[0,0,1]
  v_cvt_pk_bf16_f32 v36, v136, v137
  v_cvt_pk_bf16_f32 v37, v138, v139
  v_pk_mul_f32 v[116:117], v[102:103], v[90:91] op_sel:[0,1] op_sel_hi:[1,1]
  v_pk_mul_f32 v[118:119], v[104:105], v[90:91] op_sel:[0,1] op_sel_hi:[1,1]
  v_pk_fma_f32 v[140:141], v[140:141], v[90:91], v[116:117] op_sel:[0,0,0] op_sel_hi:[1,0,1] neg_lo:[0,0,1] neg_hi:[0,0,1]
  v_pk_fma_f32 v[142:143], v[142:143], v[90:91], v[118:119] op_sel:[0,0,0] op_sel_hi:[1,0,1] neg_lo:[0,0,1] neg_hi:[0,0,1]
  v_cvt_pk_bf16_f32 v38, v140, v141
  v_cvt_pk_bf16_f32 v39, v142, v143
  v_pk_mul_f32 v[116:117], v[98:99], v[92:93] op_sel:[0,1] op_sel_hi:[1,1]
  v_pk_mul_f32 v[118:119], v[100:101], v[92:93] op_sel:[0,1] op_sel_hi:[1,1]
  v_pk_fma_f32 v[144:145], v[144:145], v[92:93], v[116:117] op_sel:[0,0,0] op_sel_hi:[1,0,1] neg_lo:[0,0,1] neg_hi:[0,0,1]
  v_pk_fma_f32 v[146:147], v[146:147], v[92:93], v[118:119] op_sel:[0,0,0] op_sel_hi:[1,0,1] neg_lo:[0,0,1] neg_hi:[0,0,1]
  v_cvt_pk_bf16_f32 v40, v144, v145
  v_cvt_pk_bf16_f32 v41, v146, v147
  v_pk_mul_f32 v[116:117], v[102:103], v[92:93] op_sel:[0,1] op_sel_hi:[1,1]
  v_pk_mul_f32 v[118:119], v[104:105], v[92:93] op_sel:[0,1] op_sel_hi:[1,1]
  v_pk_fma_f32 v[148:149], v[148:149], v[92:93], v[116:117] op_sel:[0,0,0] op_sel_hi:[1,0,1] neg_lo:[0,0,1] neg_hi:[0,0,1]
  v_pk_fma_f32 v[150:151], v[150:151], v[92:93], v[118:119] op_sel:[0,0,0] op_sel_hi:[1,0,1] neg_lo:[0,0,1] neg_hi:[0,0,1]
  v_cvt_pk_bf16_f32 v42, v148, v149
  v_cvt_pk_bf16_f32 v43, v150, v151
  v_pk_mul_f32 v[116:117], v[98:99], v[94:95] op_sel:[0,1] op_sel_hi:[1,1]
  v_pk_mul_f32 v[118:119], v[100:101], v[94:95] op_sel:[0,1] op_sel_hi:[1,1]
  v_pk_fma_f32 v[152:153], v[152:153], v[94:95], v[116:117] op_sel:[0,0,0] op_sel_hi:[1,0,1] neg_lo:[0,0,1] neg_hi:[0,0,1]
  v_pk_fma_f32 v[154:155], v[154:155], v[94:95], v[118:119] op_sel:[0,0,0] op_sel_hi:[1,0,1] neg_lo:[0,0,1] neg_hi:[0,0,1]
  v_cvt_pk_bf16_f32 v44, v152, v153
  v_cvt_pk_bf16_f32 v45, v154, v155
  v_pk_mul_f32 v[116:117], v[102:103], v[94:95] op_sel:[0,1] op_sel_hi:[1,1]
  v_pk_mul_f32 v[118:119], v[104:105], v[94:95] op_sel:[0,1] op_sel_hi:[1,1]
  v_pk_fma_f32 v[156:157], v[156:157], v[94:95], v[116:117] op_sel:[0,0,0] op_sel_hi:[1,0,1] neg_lo:[0,0,1] neg_hi:[0,0,1]
  v_pk_fma_f32 v[158:159], v[158:159], v[94:95], v[118:119] op_sel:[0,0,0] op_sel_hi:[1,0,1] neg_lo:[0,0,1] neg_hi:[0,0,1]
  v_cvt_pk_bf16_f32 v46, v156, v157
  v_cvt_pk_bf16_f32 v47, v158, v159
  ds_read_b128 v[128:131], v124 offset:0
  ds_read_b128 v[132:135], v124 offset:640
  ds_read_b128 v[136:139], v124 offset:64
  ds_read_b128 v[140:143], v124 offset:704
  ds_read_b128 v[144:147], v124 offset:128
  ds_read_b128 v[148:151], v124 offset:768
  v_pk_mul_f32 v[116:117], v[106:107], v[88:89] op_sel:[0,1] op_sel_hi:[1,1]
  v_pk_mul_f32 v[118:119], v[108:109], v[88:89] op_sel:[0,1] op_sel_hi:[1,1]
  v_pk_fma_f32 v[160:161], v[160:161], v[88:89], v[116:117] op_sel:[0,0,0] op_sel_hi:[1,0,1] neg_lo:[0,0,1] neg_hi:[0,0,1]
  v_pk_fma_f32 v[162:163], v[162:163], v[88:89], v[118:119] op_sel:[0,0,0] op_sel_hi:[1,0,1] neg_lo:[0,0,1] neg_hi:[0,0,1]
  v_cvt_pk_bf16_f32 v48, v160, v161
  v_cvt_pk_bf16_f32 v49, v162, v163
  v_pk_mul_f32 v[116:117], v[110:111], v[88:89] op_sel:[0,1] op_sel_hi:[1,1]
  v_pk_mul_f32 v[118:119], v[112:113], v[88:89] op_sel:[0,1] op_sel_hi:[1,1]
  v_pk_fma_f32 v[164:165], v[164:165], v[88:89], v[116:117] op_sel:[0,0,0] op_sel_hi:[1,0,1] neg_lo:[0,0,1] neg_hi:[0,0,1]
  v_pk_fma_f32 v[166:167], v[166:167], v[88:89], v[118:119] op_sel:[0,0,0] op_sel_hi:[1,0,1] neg_lo:[0,0,1] neg_hi:[0,0,1]
  v_cvt_pk_bf16_f32 v50, v164, v165
  v_cvt_pk_bf16_f32 v51, v166, v167
  v_pk_mul_f32 v[116:117], v[106:107], v[90:91] op_sel:[0,1] op_sel_hi:[1,1]
  v_pk_mul_f32 v[118:119], v[108:109], v[90:91] op_sel:[0,1] op_sel_hi:[1,1]
  v_pk_fma_f32 v[168:169], v[168:169], v[90:91], v[116:117] op_sel:[0,0,0] op_sel_hi:[1,0,1] neg_lo:[0,0,1] neg_hi:[0,0,1]
  v_pk_fma_f32 v[170:171], v[170:171], v[90:91], v[118:119] op_sel:[0,0,0] op_sel_hi:[1,0,1] neg_lo:[0,0,1] neg_hi:[0,0,1]
  v_cvt_pk_bf16_f32 v52, v168, v169
  v_cvt_pk_bf16_f32 v53, v170, v171
  v_pk_mul_f32 v[116:117], v[110:111], v[90:91] op_sel:[0,1] op_sel_hi:[1,1]
  v_pk_mul_f32 v[118:119], v[112:113], v[90:91] op_sel:[0,1] op_sel_hi:[1,1]
  v_pk_fma_f32 v[172:173], v[172:173], v[90:91], v[116:117] op_sel:[0,0,0] op_sel_hi:[1,0,1] neg_lo:[0,0,1] neg_hi:[0,0,1]
  v_pk_fma_f32 v[174:175], v[174:175], v[90:91], v[118:119] op_sel:[0,0,0] op_sel_hi:[1,0,1] neg_lo:[0,0,1] neg_hi:[0,0,1]
  v_cvt_pk_bf16_f32 v54, v172, v173
  v_cvt_pk_bf16_f32 v55, v174, v175
  v_pk_mul_f32 v[116:117], v[106:107], v[92:93] op_sel:[0,1] op_sel_hi:[1,1]
  v_pk_mul_f32 v[118:119], v[108:109], v[92:93] op_sel:[0,1] op_sel_hi:[1,1]
  v_pk_fma_f32 v[176:177], v[176:177], v[92:93], v[116:117] op_sel:[0,0,0] op_sel_hi:[1,0,1] neg_lo:[0,0,1] neg_hi:[0,0,1]
  v_pk_fma_f32 v[178:179], v[178:179], v[92:93], v[118:119] op_sel:[0,0,0] op_sel_hi:[1,0,1] neg_lo:[0,0,1] neg_hi:[0,0,1]
  v_cvt_pk_bf16_f32 v56, v176, v177
  v_cvt_pk_bf16_f32 v57, v178, v179
  v_pk_mul_f32 v[116:117], v[110:111], v[92:93] op_sel:[0,1] op_sel_hi:[1,1]
  v_pk_mul_f32 v[118:119], v[112:113], v[92:93] op_sel:[0,1] op_sel_hi:[1,1]
  v_pk_fma_f32 v[180:181], v[180:181], v[92:93], v[116:117] op_sel:[0,0,0] op_sel_hi:[1,0,1] neg_lo:[0,0,1] neg_hi:[0,0,1]
  v_pk_fma_f32 v[182:183], v[182:183], v[92:93], v[118:119] op_sel:[0,0,0] op_sel_hi:[1,0,1] neg_lo:[0,0,1] neg_hi:[0,0,1]
  v_cvt_pk_bf16_f32 v58, v180, v181
  v_cvt_pk_bf16_f32 v59, v182, v183
  v_mfma_f32_16x16x32_bf16 v[164:167], v[48:51], v[32:35], v[12:15]
  v_mfma_f32_16x16x32_bf16 v[168:171], v[48:51], v[36:39], v[16:19]
  v_mfma_f32_16x16x32_bf16 v[172:175], v[52:55], v[36:39], v[12:15]
  v_mfma_f32_16x16x32_bf16 v[176:179], v[52:55], v[40:43], v[16:19]
  v_mfma_f32_16x16x32_bf16 v[180:183], v[56:59], v[40:43], v[12:15]
  v_mfma_f32_16x16x32_bf16 v[184:187], v[56:59], v[44:47], v[16:19]
  v_mfma_f32_16x16x32_bf16 v[188:191], v[60:63], v[44:47], v[12:15]
  s_nop 0
  s_waitcnt lgkmcnt(0)
  v_pk_mul_f32 v[116:117], v[132:133], v[114:115] op_sel:[0,0] op_sel_hi:[1,0]
  v_pk_mul_f32 v[118:119], v[134:135], v[114:115] op_sel:[0,0] op_sel_hi:[1,0]
  v_pk_fma_f32 v[192:193], v[192:193], v[128:129], v[116:117] neg_lo:[0,0,1] neg_hi:[0,0,1]
  v_pk_fma_f32 v[194:195], v[194:195], v[130:131], v[118:119] neg_lo:[0,0,1] neg_hi:[0,0,1]
  v_cvt_pk_bf16_f32 v70, v192, v193
  v_cvt_pk_bf16_f32 v71, v194, v195
  v_pk_mul_f32 v[116:117], v[132:133], v[114:115] op_sel:[0,1] op_sel_hi:[1,1]
  v_pk_mul_f32 v[118:119], v[134:135], v[114:115] op_sel:[0,1] op_sel_hi:[1,1]
  v_pk_fma_f32 v[196:197], v[196:197], v[128:129], v[116:117] neg_lo:[0,0,1] neg_hi:[0,0,1]
  v_pk_fma_f32 v[198:199], v[198:199], v[130:131], v[118:119] neg_lo:[0,0,1] neg_hi:[0,0,1]
  v_cvt_pk_bf16_f32 v80, v196, v197
  v_cvt_pk_bf16_f32 v81, v198, v199
  v_pk_mul_f32 v[116:117], v[140:141], v[114:115] op_sel:[0,0] op_sel_hi:[1,0]
  v_pk_mul_f32 v[118:119], v[142:143], v[114:115] op_sel:[0,0] op_sel_hi:[1,0]
  v_pk_fma_f32 v[200:201], v[200:201], v[136:137], v[116:117] neg_lo:[0,0,1] neg_hi:[0,0,1]
  v_pk_fma_f32 v[202:203], v[202:203], v[138:139], v[118:119] neg_lo:[0,0,1] neg_hi:[0,0,1]
  v_cvt_pk_bf16_f32 v72, v200, v201
  v_cvt_pk_bf16_f32 v73, v202, v203
  v_pk_mul_f32 v[116:117], v[140:141], v[114:115] op_sel:[0,1] op_sel_hi:[1,1]
  v_pk_mul_f32 v[118:119], v[142:143], v[114:115] op_sel:[0,1] op_sel_hi:[1,1]
  v_pk_fma_f32 v[204:205], v[204:205], v[136:137], v[116:117] neg_lo:[0,0,1] neg_hi:[0,0,1]
  v_pk_fma_f32 v[206:207], v[206:207], v[138:139], v[118:119] neg_lo:[0,0,1] neg_hi:[0,0,1]
  v_cvt_pk_bf16_f32 v82, v204, v205
  v_cvt_pk_bf16_f32 v83, v206, v207
  v_pk_mul_f32 v[116:117], v[148:149], v[114:115] op_sel:[0,0] op_sel_hi:[1,0]
  v_pk_mul_f32 v[118:119], v[150:151], v[114:115] op_sel:[0,0] op_sel_hi:[1,0]
  v_pk_fma_f32 v[208:209], v[208:209], v[144:145], v[116:117] neg_lo:[0,0,1] neg_hi:[0,0,1]
  v_pk_fma_f32 v[210:211], v[210:211], v[146:147], v[118:119] neg_lo:[0,0,1] neg_hi:[0,0,1]
  v_cvt_pk_bf16_f32 v74, v208, v209
  v_cvt_pk_bf16_f32 v75, v210, v211
  v_pk_mul_f32 v[116:117], v[148:149], v[114:115] op_sel:[0,1] op_sel_hi:[1,1]
  v_pk_mul_f32 v[118:119], v[150:151], v[114:115] op_sel:[0,1] op_sel_hi:[1,1]
  v_pk_fma_f32 v[212:213], v[212:213], v[144:145], v[116:117] neg_lo:[0,0,1] neg_hi:[0,0,1]
  v_pk_fma_f32 v[214:215], v[214:215], v[146:147], v[118:119] neg_lo:[0,0,1] neg_hi:[0,0,1]
  v_cvt_pk_bf16_f32 v84, v212, v213
  v_cvt_pk_bf16_f32 v85, v214, v215
  v_max3_f32 v90, v172, v173, v174
  v_max3_f32 v99, v175, v168, v169
  v_max3_f32 v92, v180, v181, v182
  v_max3_f32 v100, v183, v176, v177
  v_max3_f32 v94, v188, v189, v190
  v_max3_f32 v101, v191, v184, v185
  v_max3_f32 v90, v90, v170, v171
  v_max3_f32 v92, v92, v178, v179
  v_max3_f32 v94, v94, v186, v187
  v_max_f32 v90, v90, v99
  v_max_f32 v92, v92, v100
  v_max_f32 v94, v94, v101
  v_mov_b32 v99, v90
  v_mov_b32 v100, v92
  v_mov_b32 v101, v94
  v_permlane32_swap_b32 v90, v99
  v_permlane32_swap_b32 v92, v100
  v_permlane32_swap_b32 v94, v101
  v_max_f32 v90, v90, v99
  v_max_f32 v92, v92, v100
  v_max_f32 v94, v94, v101
  v_mov_b32 v99, v90
  v_mov_b32 v100, v92
  v_mov_b32 v101, v94
  v_permlane16_swap_b32 v90, v99
  v_permlane16_swap_b32 v92, v100
  v_permlane16_swap_b32 v94, v101
  v_max_f32 v90, v90, v99
  v_max_f32 v92, v92, v100
  v_max_f32_e64 v94, v94, v101
  s_mov_b32 s4, 0x3e8293ee
  v_mul_f32 v90, s4, v90
  v_mov_b32 v91, s4
  v_mul_f32 v92, s4, v92
  v_mov_b32 v93, s4
  v_mul_f32 v94, s4, v94
  v_mov_b32 v95, s4
  v_pk_fma_f32 v[168:169], v[168:169], v[90:91], v[90:91] op_sel:[0,1,0] op_sel_hi:[1,1,0] neg_lo:[0,0,1] neg_hi:[0,0,1]
  v_pk_fma_f32 v[170:171], v[170:171], v[90:91], v[90:91] op_sel:[0,1,0] op_sel_hi:[1,1,0] neg_lo:[0,0,1] neg_hi:[0,0,1]
  v_pk_fma_f32 v[172:173], v[172:173], v[90:91], v[90:91] op_sel:[0,1,0] op_sel_hi:[1,1,0] neg_lo:[0,0,1] neg_hi:[0,0,1]
  v_pk_fma_f32 v[174:175], v[174:175], v[90:91], v[90:91] op_sel:[0,1,0] op_sel_hi:[1,1,0] neg_lo:[0,0,1] neg_hi:[0,0,1]
  v_pk_fma_f32 v[176:177], v[176:177], v[92:93], v[92:93] op_sel:[0,1,0] op_sel_hi:[1,1,0] neg_lo:[0,0,1] neg_hi:[0,0,1]
  v_pk_fma_f32 v[178:179], v[178:179], v[92:93], v[92:93] op_sel:[0,1,0] op_sel_hi:[1,1,0] neg_lo:[0,0,1] neg_hi:[0,0,1]
  v_pk_fma_f32 v[180:181], v[180:181], v[92:93], v[92:93] op_sel:[0,1,0] op_sel_hi:[1,1,0] neg_lo:[0,0,1] neg_hi:[0,0,1]
  v_pk_fma_f32 v[182:183], v[182:183], v[92:93], v[92:93] op_sel:[0,1,0] op_sel_hi:[1,1,0] neg_lo:[0,0,1] neg_hi:[0,0,1]
  v_pk_fma_f32 v[184:185], v[184:185], v[94:95], v[94:95] op_sel:[0,1,0] op_sel_hi:[1,1,0] neg_lo:[0,0,1] neg_hi:[0,0,1]
  v_pk_fma_f32 v[186:187], v[186:187], v[94:95], v[94:95] op_sel:[0,1,0] op_sel_hi:[1,1,0] neg_lo:[0,0,1] neg_hi:[0,0,1]
  v_pk_fma_f32 v[188:189], v[188:189], v[94:95], v[94:95] op_sel:[0,1,0] op_sel_hi:[1,1,0] neg_lo:[0,0,1] neg_hi:[0,0,1]
  v_pk_fma_f32 v[190:191], v[190:191], v[94:95], v[94:95] op_sel:[0,1,0] op_sel_hi:[1,1,0] neg_lo:[0,0,1] neg_hi:[0,0,1]
  s_lshl_b32 s6, s84, Lz1-Lz0+3
  s_add_u32 s6, s6, 3145728
  s_add_u32 s7, s6, 4096
  s_mov_b32 exec_lo, s12
  s_mov_b32 exec_hi, s12
  buffer_load_dwordx4 v[64:67], v126, s[40:43], s11 offen sc0 sc1
  s_mov_b32 exec_lo, 0
  s_mov_b32 exec_hi, -1
  buffer_load_dwordx4 v[232:235], v11, s[40:43], s11 offen sc0 sc1
  s_mov_b64 exec, -1
  v_exp_f32 v168, v168
  v_exp_f32 v169, v169
  v_exp_f32 v170, v170
  v_exp_f32 v171, v171
  v_exp_f32 v172, v172
  v_exp_f32 v173, v173
  v_exp_f32 v174, v174
  v_exp_f32_e64 v175, v175
  v_cvt_pk_bf16_f32 v36, v168, v169
  v_cvt_pk_bf16_f32 v37, v170, v171
  v_cvt_pk_bf16_f32 v38, v172, v173
  v_cvt_pk_bf16_f32 v39, v174, v175
  v_exp_f32 v176, v176
  v_exp_f32 v177, v177
  v_exp_f32 v178, v178
  v_exp_f32 v179, v179
  v_exp_f32 v180, v180
  v_exp_f32 v181, v181
  v_exp_f32 v182, v182
  v_exp_f32 v183, v183
  v_cvt_pk_bf16_f32 v40, v176, v177
  v_cvt_pk_bf16_f32 v41, v178, v179
  v_cvt_pk_bf16_f32 v42, v180, v181
  v_cvt_pk_bf16_f32 v43, v182, v183
  v_mfma_f32_16x16x32_bf16 v[132:135], v[120:123], v[36:39], 0
  v_mfma_f32_16x16x32_bf16 v[200:203], v[70:73], v[36:39], 0
  v_mfma_f32_16x16x32_bf16 v[204:207], v[80:83], v[36:39], 0
  v_exp_f32 v184, v184
  v_exp_f32 v185, v185
  v_exp_f32 v186, v186
  v_exp_f32 v187, v187
  v_exp_f32 v188, v188
  v_exp_f32 v189, v189
  v_exp_f32 v190, v190
  v_exp_f32 v191, v191
  v_cvt_pk_bf16_f32 v44, v184, v185
  v_cvt_pk_bf16_f32 v45, v186, v187
  v_cvt_pk_bf16_f32 v46, v188, v189
  v_cvt_pk_bf16_f32 v47, v190, v191
  v_mfma_f32_16x16x32_bf16 v[136:139], v[120:123], v[40:43], 0
  v_mfma_f32_16x16x32_bf16 v[208:211], v[72:75], v[40:43], 0
  v_mfma_f32_16x16x32_bf16 v[212:215], v[82:85], v[40:43], 0
  v_mfma_f32_16x16x32_bf16 v[140:143], v[120:123], v[44:47], 0
  v_mfma_f32_16x16x32_bf16 v[216:219], v[74:77], v[44:47], 0
  v_mfma_f32_16x16x32_bf16 v[220:223], v[84:87], v[44:47], 0
  v_rcp_f32 v132, v132
  s_nop 0
  v_pk_mul_f32 v[200:201], v[200:201], v[132:133] op_sel_hi:[1,0]
  v_pk_mul_f32 v[202:203], v[202:203], v[132:133] op_sel_hi:[1,0]
  v_pk_mul_f32 v[204:205], v[204:205], v[132:133] op_sel_hi:[1,0]
  v_pk_mul_f32 v[206:207], v[206:207], v[132:133] op_sel_hi:[1,0]
  v_cvt_pk_bf16_f32 v52, v200, v201
  v_cvt_pk_bf16_f32 v53, v202, v203
  v_cvt_pk_bf16_f32 v54, v204, v205
  v_cvt_pk_bf16_f32 v55, v206, v207
  buffer_store_dwordx4 v[52:55], v0, s[40:43], s6 offen offset:2048 sc0 sc1
  v_rcp_f32 v136, v136
  s_nop 0
  v_pk_mul_f32 v[208:209], v[208:209], v[136:137] op_sel_hi:[1,0]
  v_pk_mul_f32 v[210:211], v[210:211], v[136:137] op_sel_hi:[1,0]
  v_pk_mul_f32 v[212:213], v[212:213], v[136:137] op_sel_hi:[1,0]
  v_pk_mul_f32 v[214:215], v[214:215], v[136:137] op_sel_hi:[1,0]
  v_cvt_pk_bf16_f32 v56, v208, v209
  v_cvt_pk_bf16_f32 v57, v210, v211
  v_cvt_pk_bf16_f32 v58, v212, v213
  v_cvt_pk_bf16_f32 v59, v214, v215
  buffer_store_dwordx4 v[56:59], v0, s[40:43], s7 offen offset:0 sc0 sc1
  v_rcp_f32 v140, v140
  s_nop 0
  v_pk_mul_f32 v[216:217], v[216:217], v[140:141] op_sel_hi:[1,0]
  v_pk_mul_f32 v[218:219], v[218:219], v[140:141] op_sel_hi:[1,0]
  v_pk_mul_f32 v[220:221], v[220:221], v[140:141] op_sel_hi:[1,0]
  v_pk_mul_f32 v[222:223], v[222:223], v[140:141] op_sel_hi:[1,0]
  v_cvt_pk_bf16_f32 v60, v216, v217
  v_cvt_pk_bf16_f32 v61, v218, v219
  v_cvt_pk_bf16_f32 v62, v220, v221
  v_cvt_pk_bf16_f32 v63, v222, v223
  buffer_store_dwordx4 v[60:63], v0, s[40:43], s7 offen offset:2048 sc0 sc1
  s_cmp_eq_u32 s76, Lz1-Lz0+0
  s_mov_b32 s89, 200000
  s_waitcnt vmcnt(3)
  s_cbranch_scc0 Lh_10
  v_mov_b64 v[64:65], 0
  v_mov_b64 v[66:67], 0
  v_mov_b64 v[232:233], 0
  v_mov_b64 v[234:235], 0
  s_branch Lh_11
  s_nop 0
Lh_9:
  s_mov_b32 exec_lo, s12
  s_mov_b32 exec_hi, s12
  buffer_load_dwordx4 v[64:67], v126, s[40:43], s11 offen sc0 sc1
  s_mov_b32 exec_lo, 0
  s_mov_b32 exec_hi, -1
  buffer_load_dwordx4 v[232:235], v11, s[40:43], s11 offen sc0 sc1
  s_mov_b64 exec, -1
  s_waitcnt vmcnt(0)
Lh_10:
  v_max3_u32 v2, v64, v65, v66
  v_max3_u32 v3, v232, v233, v234
  v_max3_u32 v2, v2, v67, v235
  v_max_u32_e64 v2, v2, v3
  v_cmp_eq_u32 vcc, -1, v2
  s_cbranch_vccz Lh_11
  s_sub_u32 s89, s89, 1
  s_cbranch_scc0 Lh_9
Lh_11:
  v_mfma_f32_16x16x32_bf16 v[160:163], v[64:67], v[32:35], v[20:23]
  v_mov_b64 v[68:69], v[232:233]
  v_mov_b64 v[78:79], v[234:235]
  v_mov_b64 v[236:237], -1
  v_mov_b64 v[238:239], -1
  buffer_store_dwordx4 v[236:239], v11, s[40:43], s11 offen sc0 sc1
  v_max3_f32 v88, v164, v165, v166
  s_nop 0
  s_nop 1
  v_max3_f32 v98, v167, v160, v161
  v_max3_f32 v88, v88, v162, v163
  v_max_f32 v88, v88, v98
  v_mov_b32 v98, v88
  s_nop 1
  v_permlane32_swap_b32 v88, v98
  v_max_f32 v88, v88, v98
  v_mov_b32 v98, v88
  s_nop 1
  v_permlane16_swap_b32 v88, v98
  v_max_f32_e64 v88, v88, v98
  s_mov_b32 s4, 0x3e8293ee
  v_mul_f32 v88, s4, v88
  v_mov_b32 v89, s4
  v_pk_fma_f32 v[160:161], v[160:161], v[88:89], v[88:89] op_sel:[0,1,0] op_sel_hi:[1,1,0] neg_lo:[0,0,1] neg_hi:[0,0,1]
  v_pk_fma_f32 v[162:163], v[162:163], v[88:89], v[88:89] op_sel:[0,1,0] op_sel_hi:[1,1,0] neg_lo:[0,0,1] neg_hi:[0,0,1]
  v_pk_fma_f32 v[164:165], v[164:165], v[88:89], v[88:89] op_sel:[0,1,0] op_sel_hi:[1,1,0] neg_lo:[0,0,1] neg_hi:[0,0,1]
  v_pk_fma_f32 v[166:167], v[166:167], v[88:89], v[88:89] op_sel:[0,1,0] op_sel_hi:[1,1,0] neg_lo:[0,0,1] neg_hi:[0,0,1]
  v_exp_f32 v160, v160
  v_exp_f32 v161, v161
  v_exp_f32 v162, v162
  v_exp_f32 v163, v163
  v_exp_f32 v164, v164
  v_exp_f32 v165, v165
  v_exp_f32 v166, v166
  v_exp_f32 v167, v167
  v_cvt_pk_bf16_f32 v32, v160, v161
  v_cvt_pk_bf16_f32 v33, v162, v163
  v_cvt_pk_bf16_f32 v34, v164, v165
  v_cvt_pk_bf16_f32 v35, v166, v167
  s_nop 0
  s_nop 1
  v_mfma_f32_16x16x32_bf16 v[128:131], v[120:123], v[32:35], 0
  v_mfma_f32_16x16x32_bf16 v[192:195], v[68:71], v[32:35], 0
  v_mfma_f32_16x16x32_bf16 v[196:199], v[78:81], v[32:35], 0
  s_nop 5
  v_rcp_f32_e64 v128, v128
  s_nop 0
  v_pk_mul_f32 v[192:193], v[192:193], v[128:129] op_sel_hi:[1,0]
  v_pk_mul_f32 v[194:195], v[194:195], v[128:129] op_sel_hi:[1,0]
  v_pk_mul_f32 v[196:197], v[196:197], v[128:129] op_sel_hi:[1,0]
  v_pk_mul_f32 v[198:199], v[198:199], v[128:129] op_sel_hi:[1,0]
  v_cvt_pk_bf16_f32 v48, v192, v193
  v_cvt_pk_bf16_f32 v49, v194, v195
  v_cvt_pk_bf16_f32 v50, v196, v197
  v_cvt_pk_bf16_f32 v51, v198, v199
  buffer_store_dwordx4 v[48:51], v0, s[40:43], s6 offen offset:0 sc0 sc1
  ds_read_b32 v3, v28 offset:8
  s_cmp_lg_u32 s82, 0
  s_cbranch_scc1 L_13
  v_permlane16_swap_b32 v240, v242
  v_permlane16_swap_b32 v241, v243
  v_permlane16_swap_b32 v244, v246
  v_permlane16_swap_b32 v245, v247
  v_permlane16_swap_b32 v248, v250
  v_permlane16_swap_b32 v249, v251
  v_permlane16_swap_b32 v252, v254
  v_permlane16_swap_b32 v253, v255
L_13:
  s_mov_b32 s16, Lz1-Lz0+0
  s_mov_b32 s17, 16384
  s_mov_b32 s18, 0xffff4000
  s_mov_b32 s19, 32768
  s_mov_b32 s20, 8192
  s_mov_b32 s21, 0xfffee000
  s_mul_i32 s4, s85, 8192
  v_add_u32_e64 v4, s4, v11
  v_add_u32 v5, 1024, v4
  s_add_u32 s5, s19, 0
  s_lshl_b32 s4, s86, 1
  v_xor_b32_e64 v2, s4, v26
  v_lshl_add_u32 v6, v2, 5, v25
  v_add_u32 v6, s5, v6
  s_add_u32 s4, s4, 1
  v_xor_b32_e64 v2, s4, v26
  v_lshl_add_u32 v7, v2, 5, v25
  v_add_u32 v7, s5, v7
  s_lshl_b32 s5, s82, 1
  s_add_u32 s5, s5, Lz1-Lz0+2
  s_mov_b32 s89, 1600000
  s_branch Lw_15
Lw_14:
  ds_read_b32 v3, v28 offset:8
Lw_15:
  s_waitcnt lgkmcnt(0)
  v_readfirstlane_b32 s4, v3
  s_cmp_ge_u32 s4, s5
  s_cbranch_scc1 Lw_16
  s_sleep 1
  s_sub_u32 s89, s89, 1
  s_cbranch_scc0 Lw_14
Lw_16:
  ds_read_b64_tr_b16 v[48:49], v6 offset:0
  ds_read_b64_tr_b16 v[50:51], v6 offset:2048
  ds_read_b64_tr_b16 v[52:53], v7 offset:0
  ds_read_b64_tr_b16 v[54:55], v7 offset:2048
  ds_read_b64_tr_b16 v[80:81], v6 offset:4096
  ds_read_b64_tr_b16 v[82:83], v6 offset:6144
  ds_read_b64_tr_b16 v[84:85], v7 offset:4096
  ds_read_b64_tr_b16 v[86:87], v7 offset:6144
  ds_read_b64_tr_b16 v[112:113], v6 offset:8192
  ds_read_b64_tr_b16 v[114:115], v6 offset:10240
  ds_read_b64_tr_b16 v[116:117], v7 offset:8192
  ds_read_b64_tr_b16 v[118:119], v7 offset:10240
  s_nop 0
  s_waitcnt lgkmcnt(8)
  ds_read_b64_tr_b16 v[208:209], v6 offset:12288
  ds_read_b64_tr_b16 v[210:211], v6 offset:14336
  ds_read_b64_tr_b16 v[212:213], v7 offset:12288
  ds_read_b64_tr_b16 v[214:215], v7 offset:14336
  s_nop 0
  s_waitcnt lgkmcnt(8)
  ds_read_b64_tr_b16 v[160:161], v6 offset:16384
  ds_read_b64_tr_b16 v[162:163], v6 offset:18432
  ds_read_b64_tr_b16 v[164:165], v7 offset:16384
  ds_read_b64_tr_b16 v[166:167], v7 offset:18432
  s_nop 0
  s_waitcnt lgkmcnt(8)
  ds_read_b64_tr_b16 v[168:169], v6 offset:20480
  ds_read_b64_tr_b16 v[170:171], v6 offset:22528
  ds_read_b64_tr_b16 v[172:173], v7 offset:20480
  ds_read_b64_tr_b16 v[174:175], v7 offset:22528
  s_nop 0
  s_waitcnt lgkmcnt(8)
  ds_read_b64_tr_b16 v[176:177], v6 offset:24576
  ds_read_b64_tr_b16 v[178:179], v6 offset:26624
  ds_read_b64_tr_b16 v[180:181], v7 offset:24576
  ds_read_b64_tr_b16 v[182:183], v7 offset:26624
  s_nop 0
  s_waitcnt lgkmcnt(8)
  ds_read_b64_tr_b16 v[184:185], v6 offset:28672
  ds_read_b64_tr_b16 v[186:187], v6 offset:30720
  ds_read_b64_tr_b16 v[188:189], v7 offset:28672
  ds_read_b64_tr_b16 v[190:191], v7 offset:30720
  s_nop 0
  s_waitcnt lgkmcnt(8)
  ds_read_b64_tr_b16 v[224:225], v6 offset:32768
  ds_read_b64_tr_b16 v[226:227], v6 offset:34816
  ds_read_b64_tr_b16 v[228:229], v7 offset:32768
  ds_read_b64_tr_b16 v[230:231], v7 offset:34816
  s_nop 0
  s_waitcnt lgkmcnt(8)
  ds_read_b64_tr_b16 v[232:233], v6 offset:36864
  ds_read_b64_tr_b16 v[234:235], v6 offset:38912
  ds_read_b64_tr_b16 v[236:237], v7 offset:36864
  ds_read_b64_tr_b16 v[238:239], v7 offset:38912
  s_nop 0
  s_waitcnt lgkmcnt(8)
  ds_read_b64_tr_b16 v[56:57], v6 offset:40960
  ds_read_b64_tr_b16 v[58:59], v6 offset:43008
  ds_read_b64_tr_b16 v[60:61], v7 offset:40960
  ds_read_b64_tr_b16 v[62:63], v7 offset:43008
  s_nop 0
  s_waitcnt lgkmcnt(8)
  ds_read_b64_tr_b16 v[88:89], v6 offset:45056
  ds_read_b64_tr_b16 v[90:91], v6 offset:47104
  ds_read_b64_tr_b16 v[92:93], v7 offset:45056
  ds_read_b64_tr_b16 v[94:95], v7 offset:47104
  s_waitcnt lgkmcnt(8)
  s_mov_b32 s19, 0
  v_add_u32 v6, 0xffff8000, v6
  v_add_u32 v7, 0xffff8000, v7
  s_waitcnt lgkmcnt(0)
  s_mov_b64 exec, 1
  ds_add_u32 v28, v27 offset:12
  s_mov_b64 exec, -1
  s_add_u32 s5, s87, 0
  s_waitcnt vmcnt(0)
  s_mov_b64 exec, 1
  ds_add_rtn_u32 v2, v28, v27 offset:0
  s_waitcnt lgkmcnt(0)
  v_readfirstlane_b32 s4, v2
  s_and_b32 s4, s4, Lz1-Lz0+3
  s_cmp_lg_u32 s4, 3
  s_cbranch_scc1 Ls_17
  s_mov_b32 exec_lo, 0xffff
  buffer_store_dword v27, v24, s[40:43], s5 offen sc0 sc1
Ls_17:
  s_mov_b64 exec, -1
  s_mov_b32 s4, 0xffff0000
  v_lshlrev_b32 v128, 16, v240
  v_and_b32 v129, s4, v240
  v_lshlrev_b32 v130, 16, v241
  v_and_b32 v131, s4, v241
  v_lshlrev_b32 v132, 16, v242
  v_and_b32 v133, s4, v242
  v_lshlrev_b32 v134, 16, v243
  v_and_b32 v135, s4, v243
  v_lshlrev_b32 v136, 16, v244
  v_and_b32 v137, s4, v244
  v_lshlrev_b32 v138, 16, v245
  v_and_b32 v139, s4, v245
  v_lshlrev_b32 v140, 16, v246
  v_and_b32 v141, s4, v246
  v_lshlrev_b32 v142, 16, v247
  v_and_b32 v143, s4, v247
  v_lshlrev_b32 v144, 16, v248
  v_and_b32 v145, s4, v248
  v_lshlrev_b32 v146, 16, v249
  v_and_b32 v147, s4, v249
  v_lshlrev_b32 v148, 16, v250
  v_and_b32 v149, s4, v250
  v_lshlrev_b32 v150, 16, v251
  v_and_b32 v151, s4, v251
  v_lshlrev_b32 v152, 16, v252
  v_and_b32 v153, s4, v252
  v_lshlrev_b32 v154, 16, v253
  v_and_b32 v155, s4, v253
  v_lshlrev_b32 v156, 16, v254
  v_and_b32 v157, s4, v254
  v_lshlrev_b32 v158, 16, v255
  v_and_b32_e64 v159, s4, v255
  s_mov_b32 s22, 5
  s_barrier
  ds_read_b128 v[32:35], v4 offset:0
  ds_read_b128 v[36:39], v4 offset:2048
  ds_read_b128 v[40:43], v4 offset:4096
  ds_read_b128 v[44:47], v4 offset:6144
  ds_read_b128 v[64:67], v5 offset:0
  ds_read_b128 v[68:71], v5 offset:2048
  ds_read_b128 v[72:75], v5 offset:4096
  ds_read_b128 v[76:79], v5 offset:6144
  s_add_u32 s16, s16, s17
  s_cmp_eq_u32 s16, 65536
  s_cselect_b32 s23, s18, s17
  s_cselect_b32 s16, 0, s16
  v_add_u32 v4, s23, v4
  v_add_u32_e64 v5, s23, v5
  s_waitcnt lgkmcnt(0)
  s_barrier
  v_mfma_f32_16x16x32_bf16 v[128:131], v[48:51], v[32:35], v[128:131]
  ds_read_b128 v[96:99], v4 offset:0
  ds_read_b128 v[100:103], v4 offset:2048
  v_mfma_f32_16x16x32_bf16 v[128:131], v[80:83], v[64:67], v[128:131]
  ds_read_b128 v[104:107], v4 offset:4096
  ds_read_b128 v[108:111], v4 offset:6144
  v_mfma_f32_16x16x32_bf16 v[136:139], v[48:51], v[36:39], v[136:139]
  ds_read_b128 v[192:195], v5 offset:0
  ds_read_b128 v[196:199], v5 offset:2048
  v_mfma_f32_16x16x32_bf16 v[136:139], v[80:83], v[68:71], v[136:139]
  ds_read_b128 v[200:203], v5 offset:4096
  ds_read_b128 v[204:207], v5 offset:6144
  v_mfma_f32_16x16x32_bf16 v[144:147], v[48:51], v[40:43], v[144:147]
  s_add_u32 s16, s16, s17
  s_cmp_eq_u32 s16, 65536
  s_cselect_b32 s23, s18, s17
  v_mfma_f32_16x16x32_bf16 v[144:147], v[80:83], v[72:75], v[144:147]
  s_cselect_b32 s16, 0, s16
  v_add_u32 v4, s23, v4
  v_add_u32_e64 v5, s23, v5
  v_mfma_f32_16x16x32_bf16 v[152:155], v[48:51], v[44:47], v[152:155]
  v_mfma_f32_16x16x32_bf16 v[152:155], v[80:83], v[76:79], v[152:155]
  v_mfma_f32_16x16x32_bf16 v[132:135], v[52:55], v[32:35], v[132:135]
  v_mfma_f32_16x16x32_bf16 v[132:135], v[84:87], v[64:67], v[132:135]
  v_mfma_f32_16x16x32_bf16 v[140:143], v[52:55], v[36:39], v[140:143]
  v_mfma_f32_16x16x32_bf16 v[140:143], v[84:87], v[68:71], v[140:143]
  v_mfma_f32_16x16x32_bf16 v[148:151], v[52:55], v[40:43], v[148:151]
  v_mfma_f32_16x16x32_bf16 v[148:151], v[84:87], v[72:75], v[148:151]
  v_mfma_f32_16x16x32_bf16 v[156:159], v[52:55], v[44:47], v[156:159]
  s_waitcnt lgkmcnt(0)
  v_mfma_f32_16x16x32_bf16 v[156:159], v[84:87], v[76:79], v[156:159]
  s_barrier
  v_mfma_f32_16x16x32_bf16 v[128:131], v[112:115], v[96:99], v[128:131]
  ds_read_b128 v[32:35], v4 offset:0
  ds_read_b128 v[36:39], v4 offset:2048
  v_mfma_f32_16x16x32_bf16 v[128:131], v[208:211], v[192:195], v[128:131]
  ds_read_b128 v[40:43], v4 offset:4096
  ds_read_b128 v[44:47], v4 offset:6144
  v_mfma_f32_16x16x32_bf16 v[136:139], v[112:115], v[100:103], v[136:139]
  ds_read_b128 v[64:67], v5 offset:0
  ds_read_b128 v[68:71], v5 offset:2048
  v_mfma_f32_16x16x32_bf16 v[136:139], v[208:211], v[196:199], v[136:139]
  ds_read_b128 v[72:75], v5 offset:4096
  ds_read_b128 v[76:79], v5 offset:6144
  v_mfma_f32_16x16x32_bf16 v[144:147], v[112:115], v[104:107], v[144:147]
  s_add_u32 s16, s16, s17
  s_cmp_eq_u32 s16, 65536
  s_cselect_b32 s23, s18, s17
  v_mfma_f32_16x16x32_bf16 v[144:147], v[208:211], v[200:203], v[144:147]
  s_cselect_b32 s16, 0, s16
  v_add_u32 v4, s23, v4
  v_add_u32_e64 v5, s23, v5
  v_mfma_f32_16x16x32_bf16 v[152:155], v[112:115], v[108:111], v[152:155]
  v_mfma_f32_16x16x32_bf16 v[152:155], v[208:211], v[204:207], v[152:155]
  v_mfma_f32_16x16x32_bf16 v[132:135], v[116:119], v[96:99], v[132:135]
  v_mfma_f32_16x16x32_bf16 v[132:135], v[212:215], v[192:195], v[132:135]
  v_mfma_f32_16x16x32_bf16 v[140:143], v[116:119], v[100:103], v[140:143]
  v_mfma_f32_16x16x32_bf16 v[140:143], v[212:215], v[196:199], v[140:143]
  v_mfma_f32_16x16x32_bf16 v[148:151], v[116:119], v[104:107], v[148:151]
  v_mfma_f32_16x16x32_bf16 v[148:151], v[212:215], v[200:203], v[148:151]
  v_mfma_f32_16x16x32_bf16 v[156:159], v[116:119], v[108:111], v[156:159]
  s_waitcnt lgkmcnt(0)
  v_mfma_f32_16x16x32_bf16 v[156:159], v[212:215], v[204:207], v[156:159]
  s_barrier
  v_mfma_f32_16x16x32_bf16 v[128:131], v[160:163], v[32:35], v[128:131]
  ds_read_b128 v[96:99], v4 offset:0
  ds_read_b128 v[100:103], v4 offset:2048
  v_mfma_f32_16x16x32_bf16 v[128:131], v[168:171], v[64:67], v[128:131]
  ds_read_b128 v[104:107], v4 offset:4096
  ds_read_b128 v[108:111], v4 offset:6144
  v_mfma_f32_16x16x32_bf16 v[136:139], v[160:163], v[36:39], v[136:139]
  ds_read_b128 v[192:195], v5 offset:0
  ds_read_b128 v[196:199], v5 offset:2048
  v_mfma_f32_16x16x32_bf16 v[136:139], v[168:171], v[68:71], v[136:139]
  ds_read_b128 v[200:203], v5 offset:4096
  ds_read_b128 v[204:207], v5 offset:6144
  v_mfma_f32_16x16x32_bf16 v[144:147], v[160:163], v[40:43], v[144:147]
  s_add_u32 s16, s16, s17
  s_cmp_eq_u32 s16, 65536
  s_cselect_b32 s23, s18, s17
  v_mfma_f32_16x16x32_bf16 v[144:147], v[168:171], v[72:75], v[144:147]
  s_cselect_b32 s16, 0, s16
  v_add_u32 v4, s23, v4
  v_add_u32_e64 v5, s23, v5
  v_mfma_f32_16x16x32_bf16 v[152:155], v[160:163], v[44:47], v[152:155]
  v_mfma_f32_16x16x32_bf16 v[152:155], v[168:171], v[76:79], v[152:155]
  v_mfma_f32_16x16x32_bf16 v[132:135], v[164:167], v[32:35], v[132:135]
  v_mfma_f32_16x16x32_bf16 v[132:135], v[172:175], v[64:67], v[132:135]
  v_mfma_f32_16x16x32_bf16 v[140:143], v[164:167], v[36:39], v[140:143]
  v_mfma_f32_16x16x32_bf16 v[140:143], v[172:175], v[68:71], v[140:143]
  v_mfma_f32_16x16x32_bf16 v[148:151], v[164:167], v[40:43], v[148:151]
  v_mfma_f32_16x16x32_bf16 v[148:151], v[172:175], v[72:75], v[148:151]
  v_mfma_f32_16x16x32_bf16 v[156:159], v[164:167], v[44:47], v[156:159]
  s_waitcnt lgkmcnt(0)
  v_mfma_f32_16x16x32_bf16 v[156:159], v[172:175], v[76:79], v[156:159]
  s_barrier
  v_mfma_f32_16x16x32_bf16 v[128:131], v[176:179], v[96:99], v[128:131]
  ds_read_b128 v[32:35], v4 offset:0
  ds_read_b128 v[36:39], v4 offset:2048
  v_mfma_f32_16x16x32_bf16 v[128:131], v[184:187], v[192:195], v[128:131]
  ds_read_b128 v[40:43], v4 offset:4096
  ds_read_b128 v[44:47], v4 offset:6144
  v_mfma_f32_16x16x32_bf16 v[136:139], v[176:179], v[100:103], v[136:139]
  ds_read_b128 v[64:67], v5 offset:0
  ds_read_b128 v[68:71], v5 offset:2048
  v_mfma_f32_16x16x32_bf16 v[136:139], v[184:187], v[196:199], v[136:139]
  ds_read_b128 v[72:75], v5 offset:4096
  ds_read_b128 v[76:79], v5 offset:6144
  v_mfma_f32_16x16x32_bf16 v[144:147], v[176:179], v[104:107], v[144:147]
  s_add_u32 s16, s16, s17
  s_cmp_eq_u32 s16, 65536
  s_cselect_b32 s23, s18, s17
  v_mfma_f32_16x16x32_bf16 v[144:147], v[184:187], v[200:203], v[144:147]
  s_cselect_b32 s16, 0, s16
  v_add_u32 v4, s23, v4
  v_add_u32_e64 v5, s23, v5
  v_mfma_f32_16x16x32_bf16 v[152:155], v[176:179], v[108:111], v[152:155]
  v_mfma_f32_16x16x32_bf16 v[152:155], v[184:187], v[204:207], v[152:155]
  v_mfma_f32_16x16x32_bf16 v[132:135], v[180:183], v[96:99], v[132:135]
  v_mfma_f32_16x16x32_bf16 v[132:135], v[188:191], v[192:195], v[132:135]
  v_mfma_f32_16x16x32_bf16 v[140:143], v[180:183], v[100:103], v[140:143]
  v_mfma_f32_16x16x32_bf16 v[140:143], v[188:191], v[196:199], v[140:143]
  v_mfma_f32_16x16x32_bf16 v[148:151], v[180:183], v[104:107], v[148:151]
  v_mfma_f32_16x16x32_bf16 v[148:151], v[188:191], v[200:203], v[148:151]
  v_mfma_f32_16x16x32_bf16 v[156:159], v[180:183], v[108:111], v[156:159]
  s_waitcnt lgkmcnt(0)
  v_mfma_f32_16x16x32_bf16 v[156:159], v[188:191], v[204:207], v[156:159]
  s_barrier
  v_mfma_f32_16x16x32_bf16 v[128:131], v[224:227], v[32:35], v[128:131]
  ds_read_b128 v[96:99], v4 offset:0
  ds_read_b128 v[100:103], v4 offset:2048
  v_mfma_f32_16x16x32_bf16 v[128:131], v[232:235], v[64:67], v[128:131]
  ds_read_b128 v[104:107], v4 offset:4096
  ds_read_b128 v[108:111], v4 offset:6144
  v_mfma_f32_16x16x32_bf16 v[136:139], v[224:227], v[36:39], v[136:139]
  ds_read_b128 v[192:195], v5 offset:0
  ds_read_b128 v[196:199], v5 offset:2048
  v_mfma_f32_16x16x32_bf16 v[136:139], v[232:235], v[68:71], v[136:139]
  ds_read_b128 v[200:203], v5 offset:4096
  ds_read_b128 v[204:207], v5 offset:6144
  v_mfma_f32_16x16x32_bf16 v[144:147], v[224:227], v[40:43], v[144:147]
  s_add_u32 s16, s16, s17
  s_cmp_eq_u32 s16, 65536
  s_cselect_b32 s23, s18, s17
  v_mfma_f32_16x16x32_bf16 v[144:147], v[232:235], v[72:75], v[144:147]
  s_cselect_b32 s16, 0, s16
  v_add_u32 v4, s23, v4
  v_add_u32_e64 v5, s23, v5
  v_mfma_f32_16x16x32_bf16 v[152:155], v[224:227], v[44:47], v[152:155]
  v_mfma_f32_16x16x32_bf16 v[152:155], v[232:235], v[76:79], v[152:155]
  v_mfma_f32_16x16x32_bf16 v[132:135], v[228:231], v[32:35], v[132:135]
  v_mfma_f32_16x16x32_bf16 v[132:135], v[236:239], v[64:67], v[132:135]
  v_mfma_f32_16x16x32_bf16 v[140:143], v[228:231], v[36:39], v[140:143]
  v_mfma_f32_16x16x32_bf16 v[140:143], v[236:239], v[68:71], v[140:143]
  v_mfma_f32_16x16x32_bf16 v[148:151], v[228:231], v[40:43], v[148:151]
  v_mfma_f32_16x16x32_bf16 v[148:151], v[236:239], v[72:75], v[148:151]
  v_mfma_f32_16x16x32_bf16 v[156:159], v[228:231], v[44:47], v[156:159]
  s_waitcnt lgkmcnt(0)
  v_mfma_f32_16x16x32_bf16 v[156:159], v[236:239], v[76:79], v[156:159]
  s_barrier
  v_mfma_f32_16x16x32_bf16 v[128:131], v[56:59], v[96:99], v[128:131]
  ds_read_b64_tr_b16 v[48:49], v6 offset:0
  ds_read_b64_tr_b16 v[50:51], v6 offset:2048
  v_mfma_f32_16x16x32_bf16 v[128:131], v[88:91], v[192:195], v[128:131]
  ds_read_b128 v[32:35], v4 offset:0
  ds_read_b128 v[36:39], v4 offset:2048
  v_mfma_f32_16x16x32_bf16 v[136:139], v[56:59], v[100:103], v[136:139]
  ds_read_b128 v[40:43], v4 offset:4096
  ds_read_b128 v[44:47], v4 offset:6144
  v_mfma_f32_16x16x32_bf16 v[136:139], v[88:91], v[196:199], v[136:139]
  ds_read_b64_tr_b16 v[52:53], v7 offset:0
  ds_read_b64_tr_b16 v[54:55], v7 offset:2048
  v_mfma_f32_16x16x32_bf16 v[144:147], v[56:59], v[104:107], v[144:147]
  ds_read_b64_tr_b16 v[80:81], v6 offset:4096
  ds_read_b64_tr_b16 v[82:83], v6 offset:6144
  v_mfma_f32_16x16x32_bf16 v[144:147], v[88:91], v[200:203], v[144:147]
  ds_read_b128 v[64:67], v5 offset:0
  ds_read_b128 v[68:71], v5 offset:2048
  v_mfma_f32_16x16x32_bf16 v[152:155], v[56:59], v[108:111], v[152:155]
  ds_read_b128 v[72:75], v5 offset:4096
  ds_read_b128 v[76:79], v5 offset:6144
  v_mfma_f32_16x16x32_bf16 v[152:155], v[88:91], v[204:207], v[152:155]
  ds_read_b64_tr_b16 v[84:85], v7 offset:4096
  ds_read_b64_tr_b16 v[86:87], v7 offset:6144
  v_mfma_f32_16x16x32_bf16 v[132:135], v[60:63], v[96:99], v[132:135]
  s_add_u32 s16, s16, s17
  s_cmp_eq_u32 s16, 65536
  s_cselect_b32 s23, s18, s17
  v_mfma_f32_16x16x32_bf16 v[132:135], v[92:95], v[192:195], v[132:135]
  s_cselect_b32 s16, 0, s16
  v_add_u32 v4, s23, v4
  v_add_u32_e64 v5, s23, v5
  v_mfma_f32_16x16x32_bf16 v[140:143], v[60:63], v[100:103], v[140:143]
  s_add_u32 s19, s19, s20
  s_cmp_eq_u32 s19, 81920
  s_cselect_b32 s23, s21, s20
  v_mfma_f32_16x16x32_bf16 v[140:143], v[92:95], v[196:199], v[140:143]
  s_cselect_b32 s19, 0, s19
  v_add_u32 v6, s23, v6
  v_add_u32_e64 v7, s23, v7
  v_mfma_f32_16x16x32_bf16 v[148:151], v[60:63], v[104:107], v[148:151]
  v_mfma_f32_16x16x32_bf16 v[148:151], v[92:95], v[200:203], v[148:151]
  v_mfma_f32_16x16x32_bf16 v[156:159], v[60:63], v[108:111], v[156:159]
  s_waitcnt lgkmcnt(0)
  v_mfma_f32_16x16x32_bf16 v[156:159], v[92:95], v[204:207], v[156:159]
Lk_18:
  s_barrier
  v_mfma_f32_16x16x32_bf16 v[128:131], v[48:51], v[32:35], v[128:131]
  ds_read_b64_tr_b16 v[112:113], v6 offset:0
  ds_read_b64_tr_b16 v[114:115], v6 offset:2048
  v_mfma_f32_16x16x32_bf16 v[128:131], v[80:83], v[64:67], v[128:131]
  ds_read_b128 v[96:99], v4 offset:0
  ds_read_b128 v[100:103], v4 offset:2048
  v_mfma_f32_16x16x32_bf16 v[136:139], v[48:51], v[36:39], v[136:139]
  ds_read_b128 v[104:107], v4 offset:4096
  ds_read_b128 v[108:111], v4 offset:6144
  v_mfma_f32_16x16x32_bf16 v[136:139], v[80:83], v[68:71], v[136:139]
  ds_read_b64_tr_b16 v[116:117], v7 offset:0
  ds_read_b64_tr_b16 v[118:119], v7 offset:2048
  v_mfma_f32_16x16x32_bf16 v[144:147], v[48:51], v[40:43], v[144:147]
  ds_read_b64_tr_b16 v[208:209], v6 offset:4096
  ds_read_b64_tr_b16 v[210:211], v6 offset:6144
  v_mfma_f32_16x16x32_bf16 v[144:147], v[80:83], v[72:75], v[144:147]
  ds_read_b128 v[192:195], v5 offset:0
  ds_read_b128 v[196:199], v5 offset:2048
  v_mfma_f32_16x16x32_bf16 v[152:155], v[48:51], v[44:47], v[152:155]
  ds_read_b128 v[200:203], v5 offset:4096
  ds_read_b128 v[204:207], v5 offset:6144
  v_mfma_f32_16x16x32_bf16 v[152:155], v[80:83], v[76:79], v[152:155]
  ds_read_b64_tr_b16 v[212:213], v7 offset:4096
  ds_read_b64_tr_b16 v[214:215], v7 offset:6144
  v_mfma_f32_16x16x32_bf16 v[132:135], v[52:55], v[32:35], v[132:135]
  s_add_u32 s16, s16, s17
  s_cmp_eq_u32 s16, 65536
  s_cselect_b32 s23, s18, s17
  v_mfma_f32_16x16x32_bf16 v[132:135], v[84:87], v[64:67], v[132:135]
  s_cselect_b32 s16, 0, s16
  v_add_u32 v4, s23, v4
  v_add_u32_e64 v5, s23, v5
  v_mfma_f32_16x16x32_bf16 v[140:143], v[52:55], v[36:39], v[140:143]
  s_add_u32 s19, s19, s20
  s_cmp_eq_u32 s19, 81920
  s_cselect_b32 s23, s21, s20
  v_mfma_f32_16x16x32_bf16 v[140:143], v[84:87], v[68:71], v[140:143]
  s_cselect_b32 s19, 0, s19
  v_add_u32 v6, s23, v6
  v_add_u32_e64 v7, s23, v7
  v_mfma_f32_16x16x32_bf16 v[148:151], v[52:55], v[40:43], v[148:151]
  v_mfma_f32_16x16x32_bf16 v[148:151], v[84:87], v[72:75], v[148:151]
  v_mfma_f32_16x16x32_bf16 v[156:159], v[52:55], v[44:47], v[156:159]
  s_waitcnt lgkmcnt(0)
  v_mfma_f32_16x16x32_bf16 v[156:159], v[84:87], v[76:79], v[156:159]
  s_barrier
  v_mfma_f32_16x16x32_bf16 v[128:131], v[112:115], v[96:99], v[128:131]
  ds_read_b64_tr_b16 v[48:49], v6 offset:0
  ds_read_b64_tr_b16 v[50:51], v6 offset:2048
  v_mfma_f32_16x16x32_bf16 v[128:131], v[208:211], v[192:195], v[128:131]
  ds_read_b128 v[32:35], v4 offset:0
  ds_read_b128 v[36:39], v4 offset:2048
  v_mfma_f32_16x16x32_bf16 v[136:139], v[112:115], v[100:103], v[136:139]
  ds_read_b128 v[40:43], v4 offset:4096
  ds_read_b128 v[44:47], v4 offset:6144
  v_mfma_f32_16x16x32_bf16 v[136:139], v[208:211], v[196:199], v[136:139]
  ds_read_b64_tr_b16 v[52:53], v7 offset:0
  ds_read_b64_tr_b16 v[54:55], v7 offset:2048
  v_mfma_f32_16x16x32_bf16 v[144:147], v[112:115], v[104:107], v[144:147]
  ds_read_b64_tr_b16 v[80:81], v6 offset:4096
  ds_read_b64_tr_b16 v[82:83], v6 offset:6144
  v_mfma_f32_16x16x32_bf16 v[144:147], v[208:211], v[200:203], v[144:147]
  ds_read_b128 v[64:67], v5 offset:0
  ds_read_b128 v[68:71], v5 offset:2048
  v_mfma_f32_16x16x32_bf16 v[152:155], v[112:115], v[108:111], v[152:155]
  ds_read_b128 v[72:75], v5 offset:4096
  ds_read_b128 v[76:79], v5 offset:6144
  v_mfma_f32_16x16x32_bf16 v[152:155], v[208:211], v[204:207], v[152:155]
  ds_read_b64_tr_b16 v[84:85], v7 offset:4096
  ds_read_b64_tr_b16 v[86:87], v7 offset:6144
  v_mfma_f32_16x16x32_bf16 v[132:135], v[116:119], v[96:99], v[132:135]
  s_add_u32 s16, s16, s17
  s_cmp_eq_u32 s16, 65536
  s_cselect_b32 s23, s18, s17
  v_mfma_f32_16x16x32_bf16 v[132:135], v[212:215], v[192:195], v[132:135]
  s_cselect_b32 s16, 0, s16
  v_add_u32 v4, s23, v4
  v_add_u32_e64 v5, s23, v5
  v_mfma_f32_16x16x32_bf16 v[140:143], v[116:119], v[100:103], v[140:143]
  s_add_u32 s19, s19, s20
  s_cmp_eq_u32 s19, 81920
  s_cselect_b32 s23, s21, s20
  v_mfma_f32_16x16x32_bf16 v[140:143], v[212:215], v[196:199], v[140:143]
  s_cselect_b32 s19, 0, s19
  v_add_u32 v6, s23, v6
  v_add_u32_e64 v7, s23, v7
  v_mfma_f32_16x16x32_bf16 v[148:151], v[116:119], v[104:107], v[148:151]
  s_sub_u32 s22, s22, 1
  s_cmp_lg_u32 s22, 0
  v_mfma_f32_16x16x32_bf16 v[148:151], v[212:215], v[200:203], v[148:151]
  v_mfma_f32_16x16x32_bf16 v[156:159], v[116:119], v[108:111], v[156:159]
  s_nop 0
  s_waitcnt lgkmcnt(0)
  v_mfma_f32_16x16x32_bf16 v[156:159], v[212:215], v[204:207], v[156:159]
  s_cbranch_scc1 Lk_18
  s_waitcnt lgkmcnt(0)
  v_cvt_pk_bf16_f32 v240, v128, v129
  v_cvt_pk_bf16_f32 v241, v130, v131
  v_cvt_pk_bf16_f32 v242, v132, v133
  v_cvt_pk_bf16_f32 v243, v134, v135
  v_cvt_pk_bf16_f32 v244, v136, v137
  v_cvt_pk_bf16_f32 v245, v138, v139
  v_cvt_pk_bf16_f32 v246, v140, v141
  v_cvt_pk_bf16_f32 v247, v142, v143
  v_cvt_pk_bf16_f32 v248, v144, v145
  v_cvt_pk_bf16_f32 v249, v146, v147
  v_cvt_pk_bf16_f32 v250, v148, v149
  v_cvt_pk_bf16_f32 v251, v150, v151
  v_cvt_pk_bf16_f32 v252, v152, v153
  v_cvt_pk_bf16_f32 v253, v154, v155
  v_cvt_pk_bf16_f32 v254, v156, v157
  v_cvt_pk_bf16_f32 v255, v158, v159
  s_lshl_b32 s4, s76, 4
  s_add_u32 s4, s4, s78
  s_lshl_b32 s6, s4, Lz1-Lz0+14
  s_add_u32 s6, s6, 7340032
  s_add_u32 s7, s6, 4096
  s_lshl_b32 s5, s78, Lz1-Lz0+1
  buffer_store_dwordx4 v[240:243], v0, s[40:43], s6 offen offset:0 sc0 sc1
  buffer_store_dwordx4 v[244:247], v0, s[40:43], s6 offen offset:2048 sc0 sc1
  buffer_store_dwordx4 v[248:251], v0, s[40:43], s7 offen offset:0 sc0 sc1
  buffer_store_dwordx4 v[252:255], v0, s[40:43], s7 offen offset:2048 sc0 sc1
  v_mov_b32 v40, 0x3f803f80
  v_dot2_f32_bf16 v32, v240, v40, 0
  v_dot2_f32_bf16 v36, v240, v240, 0
  v_dot2_f32_bf16 v33, v244, v40, 0
  v_dot2_f32_bf16 v37, v244, v244, 0
  v_dot2_f32_bf16 v34, v248, v40, 0
  v_dot2_f32_bf16 v38, v248, v248, 0
  v_dot2_f32_bf16 v35, v252, v40, 0
  v_dot2_f32_bf16 v39, v252, v252, 0
  v_dot2_f32_bf16 v32, v241, v40, v32
  v_dot2_f32_bf16 v36, v241, v241, v36
  v_dot2_f32_bf16 v33, v245, v40, v33
  v_dot2_f32_bf16 v37, v245, v245, v37
  v_dot2_f32_bf16 v34, v249, v40, v34
  v_dot2_f32_bf16 v38, v249, v249, v38
  v_dot2_f32_bf16 v35, v253, v40, v35
  v_dot2_f32_bf16 v39, v253, v253, v39
  v_dot2_f32_bf16 v32, v242, v40, v32
  v_dot2_f32_bf16 v36, v242, v242, v36
  v_dot2_f32_bf16 v33, v246, v40, v33
  v_dot2_f32_bf16 v37, v246, v246, v37
  v_dot2_f32_bf16 v34, v250, v40, v34
  v_dot2_f32_bf16 v38, v250, v250, v38
  v_dot2_f32_bf16 v35, v254, v40, v35
  v_dot2_f32_bf16 v39, v254, v254, v39
  v_dot2_f32_bf16 v32, v243, v40, v32
  v_dot2_f32_bf16 v36, v243, v243, v36
  v_dot2_f32_bf16 v33, v247, v40, v33
  v_dot2_f32_bf16 v37, v247, v247, v37
  v_dot2_f32_bf16 v34, v251, v40, v34
  v_dot2_f32_bf16 v38, v251, v251, v38
  v_dot2_f32_bf16 v35, v255, v40, v35
  v_dot2_f32_bf16 v39, v255, v255, v39
  s_lshl_b32 s6, s76, Lz1-Lz0+9
  s_lshl_b32 s7, s85, 8
  s_add_u32 s6, s6, s7
  s_add_u32 s6, s6, s5
  s_add_u32 s6, s6, s86
  s_lshl_b32 s6, s6, 6
  s_add_u32 s6, s6, s83
  s_add_u32 s6, s6, 31457280
  v_permlane32_swap_b32 v32, v34
  v_permlane32_swap_b32 v33, v35
  v_permlane32_swap_b32 v36, v38
  v_permlane32_swap_b32 v37, v39
  v_add_f32 v32, v32, v34
  v_add_f32 v33, v33, v35
  v_add_f32 v36, v36, v38
  v_add_f32 v37, v37, v39
  v_permlane16_swap_b32 v32, v33
  s_nop 0
  v_permlane16_swap_b32 v36, v37
  v_add_f32 v42, v32, v33
  v_add_f32_e64 v43, v36, v37
  buffer_store_dwordx2 v[42:43], v30, s[40:43], s6 offen sc0 sc1
  ds_write_b128 v0, v[240:243] offset:0
  ds_write_b128 v0, v[244:247] offset:2048
  ds_write_b128 v0, v[248:251] offset:4096
  ds_write_b128 v0, v[252:255] offset:6144
  s_add_u32 s5, s87, 4
  s_sub_u32 s4, s78, s77
  s_lshl_b32 s4, s4, 7
  s_add_u32 s5, s5, s4
  s_waitcnt vmcnt(0)
  s_mov_b64 exec, 1
  ds_add_rtn_u32 v2, v28, v27 offset:0
  s_waitcnt lgkmcnt(0)
  v_readfirstlane_b32 s4, v2
  s_and_b32 s4, s4, Lz1-Lz0+3
  s_cmp_lg_u32 s4, 3
  s_cbranch_scc1 Ls_19
  s_mov_b32 exec_lo, 0xffff
  buffer_store_dword v27, v24, s[40:43], s5 offen sc0 sc1
Ls_19:
  s_mov_b64 exec, -1
  s_mov_b32 s16, 0
  s_mov_b32 s17, 16384
  s_mov_b32 s18, 0xffff4000
  s_mov_b32 s19, Lz1-Lz0+0
  s_mov_b32 s20, 28672
  s_mov_b32 s21, 0xffff2000
  s_mul_i32 s4, s85, 8192
  v_add_u32_e64 v4, s4, v11
  v_add_u32 v5, 1024, v4
  s_mul_i32 s4, s86, 6
  s_add_u32 s4, s4, 0
  s_lshr_b32 s5, s4, 2
  s_lshl_b32 s5, s5, 13
  s_and_b32 s4, s4, 3
  v_xor_b32 v2, s4, v26
  v_lshl_add_u32 v6, v2, 5, v25
  v_add_u32 v6, s5, v6
  s_mul_i32 s4, s86, 6
  s_add_u32 s4, s4, 1
  s_lshr_b32 s5, s4, 2
  s_lshl_b32 s5, s5, 13
  s_and_b32 s4, s4, 3
  v_xor_b32_e64 v2, s4, v26
  v_lshl_add_u32 v7, v2, 5, v25
  v_add_u32 v7, s5, v7
  s_mul_i32 s4, s86, 6
  s_add_u32 s4, s4, 2
  s_lshr_b32 s5, s4, 2
  s_lshl_b32 s5, s5, 13
  s_and_b32 s4, s4, 3
  v_xor_b32_e64 v2, s4, v26
  v_lshl_add_u32 v8, v2, 5, v25
  v_add_u32 v8, s5, v8
  s_mul_i32 s4, s86, 6
  s_add_u32 s4, s4, 3
  s_lshr_b32 s5, s4, 2
  s_lshl_b32 s5, s5, 13
  s_and_b32 s4, s4, 3
  v_xor_b32_e64 v2, s4, v26
  v_lshl_add_u32 v9, v2, 5, v25
  v_add_u32 v9, s5, v9
  v_lshrrev_b32 v2, 2, v1
  v_lshlrev_b32 v3, 6, v2
  v_and_b32 v2, 3, v1
  v_lshl_add_u32 v3, v2, 3, v3
  v_bfe_u32 v2, v1, 4, 1
  v_xor_b32_e64 v2, s86, v2
  v_lshl_add_u32 v3, v2, 5, v3
  v_add_u32 v10, 90112, v3
  v_mov_b64 v[128:129], 0
  v_mov_b64 v[130:131], 0
  v_mov_b64 v[132:133], 0
  v_mov_b64 v[134:135], 0
  v_mov_b64 v[136:137], 0
  v_mov_b64 v[138:139], 0
  v_mov_b64 v[140:141], 0
  v_mov_b64 v[142:143], 0
  v_mov_b64 v[144:145], 0
  v_mov_b64 v[146:147], 0
  v_mov_b64 v[148:149], 0
  v_mov_b64 v[150:151], 0
  v_mov_b64 v[152:153], 0
  v_mov_b64 v[154:155], 0
  v_mov_b64 v[156:157], 0
  v_mov_b64 v[158:159], 0
  v_mov_b64 v[160:161], 0
  v_mov_b64 v[162:163], 0
  v_mov_b64 v[164:165], 0
  v_mov_b64 v[166:167], 0
  v_mov_b64 v[168:169], 0
  v_mov_b64 v[170:171], 0
  v_mov_b64 v[172:173], 0
  v_mov_b64 v[174:175], 0
  v_mov_b64 v[176:177], 0
  v_mov_b64 v[178:179], 0
  v_mov_b64 v[180:181], 0
  v_mov_b64 v[182:183], 0
  v_mov_b64 v[184:185], 0
  v_mov_b64 v[186:187], 0
  v_mov_b64 v[188:189], 0
  v_mov_b64 v[190:191], 0
  v_mov_b64 v[192:193], 0
  v_mov_b64 v[194:195], 0
  v_mov_b64 v[196:197], 0
  v_mov_b64 v[198:199], 0
  v_mov_b64 v[200:201], 0
  v_mov_b64 v[202:203], 0
  v_mov_b64 v[204:205], 0
  v_mov_b64 v[206:207], 0
  v_mov_b64 v[208:209], 0
  v_mov_b64 v[210:211], 0
  v_mov_b64 v[212:213], 0
  v_mov_b64 v[214:215], 0
  v_mov_b64 v[216:217], 0
  v_mov_b64 v[218:219], 0
  v_mov_b64 v[220:221], 0
  v_mov_b64 v[222:223], 0
  v_mov_b64 v[224:225], 0
  v_mov_b64 v[226:227], 0
  v_mov_b64 v[228:229], 0
  v_mov_b64 v[230:231], 0
  v_mov_b64 v[232:233], 0
  v_mov_b64 v[234:235], 0
  v_mov_b64 v[236:237], 0
  v_mov_b64 v[238:239], 0
  s_mov_b32 s22, 8
  s_mov_b64 vcc, -1
  s_waitcnt lgkmcnt(0)
  s_barrier
  s_branch Lo_22
Lo_23:
  s_mov_b64 vcc, 0
  s_waitcnt lgkmcnt(0)
  s_barrier
  ds_read_b128 v[64:67], v4 offset:0
  ds_read_b128 v[80:83], v5 offset:0
  ds_read_b128 v[68:71], v4 offset:2048
  ds_read_b128 v[84:87], v5 offset:2048
  ds_read_b128 v[72:75], v4 offset:4096
  ds_read_b128 v[88:91], v5 offset:4096
  ds_read_b64_tr_b16 v[96:97], v6 offset:0
  ds_read_b64_tr_b16 v[98:99], v6 offset:2048
  ds_read_b64_tr_b16 v[100:101], v6 offset:4096
  ds_read_b64_tr_b16 v[102:103], v6 offset:6144
  ds_read_b128 v[76:79], v4 offset:6144
  ds_read_b128 v[92:95], v5 offset:6144
  ds_read_b64_tr_b16 v[104:105], v7 offset:0
  s_nop 0
  s_waitcnt lgkmcnt(8)
  ds_read_b64_tr_b16 v[106:107], v7 offset:2048
  ds_read_b64_tr_b16 v[108:109], v7 offset:4096
  ds_read_b64_tr_b16 v[110:111], v7 offset:6144
  s_branch Lk_21
  s_nop 0
Lo_22:
  ds_read_b128 v[32:35], v4 offset:0
  ds_read_b128 v[48:51], v5 offset:0
  ds_read_b128 v[36:39], v4 offset:2048
  ds_read_b128 v[52:55], v5 offset:2048
  ds_read_b128 v[40:43], v4 offset:4096
  ds_read_b128 v[56:59], v5 offset:4096
  ds_read_b64_tr_b16 v[96:97], v6 offset:0
  ds_read_b64_tr_b16 v[98:99], v6 offset:2048
  ds_read_b64_tr_b16 v[100:101], v6 offset:4096
  ds_read_b64_tr_b16 v[102:103], v6 offset:6144
  ds_read_b128 v[44:47], v4 offset:6144
  ds_read_b128 v[60:63], v5 offset:6144
  ds_read_b64_tr_b16 v[104:105], v7 offset:0
  s_nop 0
  s_waitcnt lgkmcnt(8)
  ds_read_b64_tr_b16 v[106:107], v7 offset:2048
  ds_read_b64_tr_b16 v[108:109], v7 offset:4096
  ds_read_b64_tr_b16 v[110:111], v7 offset:6144
Lk_20:
  s_nop 0
  s_waitcnt lgkmcnt(6)
  v_mfma_f32_16x16x32_bf16 v[128:131], v[96:99], v[32:35], v[128:131]
  ds_read_b64_tr_b16 v[112:113], v8 offset:0
  v_mfma_f32_16x16x32_bf16 v[128:131], v[100:103], v[48:51], v[128:131]
  ds_read_b64_tr_b16 v[114:115], v8 offset:2048
  v_mfma_f32_16x16x32_bf16 v[132:135], v[96:99], v[36:39], v[132:135]
  ds_read_b64_tr_b16 v[116:117], v8 offset:4096
  v_mfma_f32_16x16x32_bf16 v[132:135], v[100:103], v[52:55], v[132:135]
  ds_read_b64_tr_b16 v[118:119], v8 offset:6144
  v_mfma_f32_16x16x32_bf16 v[136:139], v[96:99], v[40:43], v[136:139]
  s_add_u32 s16, s16, s17
  s_cmp_eq_u32 s16, 65536
  s_cselect_b32 s23, s18, s17
  s_cselect_b32 s16, Lz1-Lz0+0, s16
  v_mfma_f32_16x16x32_bf16 v[136:139], v[100:103], v[56:59], v[136:139]
  v_add_u32_e64 v4, s23, v4
  v_add_u32 v5, s23, v5
  s_add_u32 s19, s19, s20
  s_cmp_eq_u32 s19, 86016
  s_waitcnt lgkmcnt(8)
  v_mfma_f32_16x16x32_bf16 v[140:143], v[96:99], v[44:47], v[140:143]
  s_cselect_b32 s23, s21, s20
  s_cselect_b32 s19, 0, s19
  v_mfma_f32_16x16x32_bf16 v[140:143], v[100:103], v[60:63], v[140:143]
  s_waitcnt lgkmcnt(4)
  v_mfma_f32_16x16x32_bf16 v[144:147], v[104:107], v[32:35], v[144:147]
  ds_read_b64_tr_b16 v[120:121], v9 offset:0
  v_mfma_f32_16x16x32_bf16 v[144:147], v[108:111], v[48:51], v[144:147]
  ds_read_b64_tr_b16 v[122:123], v9 offset:2048
  v_mfma_f32_16x16x32_bf16 v[148:151], v[104:107], v[36:39], v[148:151]
  ds_read_b64_tr_b16 v[124:125], v9 offset:4096
  v_mfma_f32_16x16x32_bf16 v[148:151], v[108:111], v[52:55], v[148:151]
  ds_read_b64_tr_b16 v[126:127], v9 offset:6144
  v_mfma_f32_16x16x32_bf16 v[152:155], v[104:107], v[40:43], v[152:155]
  v_mfma_f32_16x16x32_bf16 v[152:155], v[108:111], v[56:59], v[152:155]
  v_mfma_f32_16x16x32_bf16 v[156:159], v[104:107], v[44:47], v[156:159]
  ds_read_b64_tr_b16 v[96:97], v6 offset:8192
  v_mfma_f32_16x16x32_bf16 v[156:159], v[108:111], v[60:63], v[156:159]
  ds_read_b64_tr_b16 v[98:99], v6 offset:10240
  s_nop 0
  s_waitcnt lgkmcnt(6)
  v_mfma_f32_16x16x32_bf16 v[160:163], v[112:115], v[32:35], v[160:163]
  ds_read_b64_tr_b16 v[100:101], v6 offset:12288
  v_mfma_f32_16x16x32_bf16 v[160:163], v[116:119], v[48:51], v[160:163]
  ds_read_b64_tr_b16 v[102:103], v6 offset:14336
  v_mfma_f32_16x16x32_bf16 v[164:167], v[112:115], v[36:39], v[164:167]
  v_mfma_f32_16x16x32_bf16 v[164:167], v[116:119], v[52:55], v[164:167]
  v_mfma_f32_16x16x32_bf16 v[168:171], v[112:115], v[40:43], v[168:171]
  ds_read_b64_tr_b16 v[104:105], v7 offset:8192
  v_mfma_f32_16x16x32_bf16 v[168:171], v[116:119], v[56:59], v[168:171]
  ds_read_b64_tr_b16 v[106:107], v7 offset:10240
  v_mfma_f32_16x16x32_bf16 v[172:175], v[112:115], v[44:47], v[172:175]
  ds_read_b64_tr_b16 v[108:109], v7 offset:12288
  v_mfma_f32_16x16x32_bf16 v[172:175], v[116:119], v[60:63], v[172:175]
  ds_read_b64_tr_b16 v[110:111], v7 offset:14336
  s_waitcnt lgkmcnt(8)
  v_mfma_f32_16x16x32_bf16 v[176:179], v[120:123], v[32:35], v[176:179]
  v_add_u32 v6, s23, v6
  v_add_u32_e64 v7, s23, v7
  v_mfma_f32_16x16x32_bf16 v[176:179], v[124:127], v[48:51], v[176:179]
  ds_read_b64_tr_b16 v[112:113], v10 offset:0
  v_mfma_f32_16x16x32_bf16 v[180:183], v[120:123], v[36:39], v[180:183]
  ds_read_b64_tr_b16 v[114:115], v10 offset:1024
  v_mfma_f32_16x16x32_bf16 v[180:183], v[124:127], v[52:55], v[180:183]
  ds_read_b64_tr_b16 v[116:117], v10 offset:2048
  v_mfma_f32_16x16x32_bf16 v[184:187], v[120:123], v[40:43], v[184:187]
  ds_read_b64_tr_b16 v[118:119], v10 offset:3072
  v_mfma_f32_16x16x32_bf16 v[184:187], v[124:127], v[56:59], v[184:187]
  v_add_u32 v8, s23, v8
  v_add_u32 v9, s23, v9
  v_mfma_f32_16x16x32_bf16 v[188:191], v[120:123], v[44:47], v[188:191]
  v_add_u32 v10, s23, v10
  v_mfma_f32_16x16x32_bf16 v[188:191], v[124:127], v[60:63], v[188:191]
  s_waitcnt lgkmcnt(0)
  s_cbranch_vccnz Lo_24
  s_barrier
Lo_24:
  v_mfma_f32_16x16x32_bf16 v[192:195], v[96:99], v[32:35], v[192:195]
  ds_read_b128 v[64:67], v4 offset:0
  v_mfma_f32_16x16x32_bf16 v[192:195], v[100:103], v[48:51], v[192:195]
  ds_read_b128 v[80:83], v5 offset:0
  v_mfma_f32_16x16x32_bf16 v[196:199], v[96:99], v[36:39], v[196:199]
  v_mfma_f32_16x16x32_bf16 v[196:199], v[100:103], v[52:55], v[196:199]
  ds_read_b128 v[68:71], v4 offset:2048
  v_mfma_f32_16x16x32_bf16 v[200:203], v[96:99], v[40:43], v[200:203]
  ds_read_b128 v[84:87], v5 offset:2048
  v_mfma_f32_16x16x32_bf16 v[200:203], v[100:103], v[56:59], v[200:203]
  v_mfma_f32_16x16x32_bf16 v[204:207], v[96:99], v[44:47], v[204:207]
  ds_read_b128 v[72:75], v4 offset:4096
  v_mfma_f32_16x16x32_bf16 v[204:207], v[100:103], v[60:63], v[204:207]
  ds_read_b128 v[88:91], v5 offset:4096
  v_mfma_f32_16x16x32_bf16 v[208:211], v[104:107], v[32:35], v[208:211]
  ds_read_b64_tr_b16 v[96:97], v6 offset:0
  v_mfma_f32_16x16x32_bf16 v[208:211], v[108:111], v[48:51], v[208:211]
  ds_read_b64_tr_b16 v[98:99], v6 offset:2048
  v_mfma_f32_16x16x32_bf16 v[212:215], v[104:107], v[36:39], v[212:215]
  ds_read_b64_tr_b16 v[100:101], v6 offset:4096
  v_mfma_f32_16x16x32_bf16 v[212:215], v[108:111], v[52:55], v[212:215]
  ds_read_b64_tr_b16 v[102:103], v6 offset:6144
  v_mfma_f32_16x16x32_bf16 v[216:219], v[104:107], v[40:43], v[216:219]
  ds_read_b128 v[76:79], v4 offset:6144
  v_mfma_f32_16x16x32_bf16 v[216:219], v[108:111], v[56:59], v[216:219]
  v_mfma_f32_16x16x32_bf16 v[220:223], v[104:107], v[44:47], v[220:223]
  ds_read_b128 v[92:95], v5 offset:6144
  v_mfma_f32_16x16x32_bf16 v[220:223], v[108:111], v[60:63], v[220:223]
  v_mfma_f32_16x16x32_bf16 v[224:227], v[112:115], v[32:35], v[224:227]
  ds_read_b64_tr_b16 v[104:105], v7 offset:0
  v_mfma_f32_16x16x32_bf16 v[224:227], v[116:119], v[48:51], v[224:227]
  v_mfma_f32_16x16x32_bf16 v[228:231], v[112:115], v[36:39], v[228:231]
  ds_read_b64_tr_b16 v[106:107], v7 offset:2048
  v_mfma_f32_16x16x32_bf16 v[228:231], v[116:119], v[52:55], v[228:231]
  v_mfma_f32_16x16x32_bf16 v[232:235], v[112:115], v[40:43], v[232:235]
  ds_read_b64_tr_b16 v[108:109], v7 offset:4096
  v_mfma_f32_16x16x32_bf16 v[232:235], v[116:119], v[56:59], v[232:235]
  v_mfma_f32_16x16x32_bf16 v[236:239], v[112:115], v[44:47], v[236:239]
  ds_read_b64_tr_b16 v[110:111], v7 offset:6144
  v_mfma_f32_16x16x32_bf16 v[236:239], v[116:119], v[60:63], v[236:239]
  s_cbranch_vccnz Lo_23
Lk_21:
  s_waitcnt lgkmcnt(6)
  v_mfma_f32_16x16x32_bf16 v[128:131], v[96:99], v[64:67], v[128:131]
  ds_read_b64_tr_b16 v[112:113], v8 offset:0
  v_mfma_f32_16x16x32_bf16 v[128:131], v[100:103], v[80:83], v[128:131]
  ds_read_b64_tr_b16 v[114:115], v8 offset:2048
  v_mfma_f32_16x16x32_bf16 v[132:135], v[96:99], v[68:71], v[132:135]
  ds_read_b64_tr_b16 v[116:117], v8 offset:4096
  v_mfma_f32_16x16x32_bf16 v[132:135], v[100:103], v[84:87], v[132:135]
  ds_read_b64_tr_b16 v[118:119], v8 offset:6144
  v_mfma_f32_16x16x32_bf16 v[136:139], v[96:99], v[72:75], v[136:139]
  s_add_u32 s16, s16, s17
  s_cmp_eq_u32 s16, 65536
  s_cselect_b32 s23, s18, s17
  s_cselect_b32 s16, Lz1-Lz0+0, s16
  v_mfma_f32_16x16x32_bf16 v[136:139], v[100:103], v[88:91], v[136:139]
  v_add_u32_e64 v4, s23, v4
  v_add_u32 v5, s23, v5
  s_add_u32 s19, s19, s20
  s_cmp_eq_u32 s19, 86016
  s_waitcnt lgkmcnt(8)
  v_mfma_f32_16x16x32_bf16 v[140:143], v[96:99], v[76:79], v[140:143]
  s_cselect_b32 s23, s21, s20
  s_cselect_b32 s19, 0, s19
  v_mfma_f32_16x16x32_bf16 v[140:143], v[100:103], v[92:95], v[140:143]
  s_waitcnt lgkmcnt(4)
  v_mfma_f32_16x16x32_bf16 v[144:147], v[104:107], v[64:67], v[144:147]
  ds_read_b64_tr_b16 v[120:121], v9 offset:0
  v_mfma_f32_16x16x32_bf16 v[144:147], v[108:111], v[80:83], v[144:147]
  ds_read_b64_tr_b16 v[122:123], v9 offset:2048
  v_mfma_f32_16x16x32_bf16 v[148:151], v[104:107], v[68:71], v[148:151]
  ds_read_b64_tr_b16 v[124:125], v9 offset:4096
  v_mfma_f32_16x16x32_bf16 v[148:151], v[108:111], v[84:87], v[148:151]
  ds_read_b64_tr_b16 v[126:127], v9 offset:6144
  v_mfma_f32_16x16x32_bf16 v[152:155], v[104:107], v[72:75], v[152:155]
  v_mfma_f32_16x16x32_bf16 v[152:155], v[108:111], v[88:91], v[152:155]
  v_mfma_f32_16x16x32_bf16 v[156:159], v[104:107], v[76:79], v[156:159]
  ds_read_b64_tr_b16 v[96:97], v6 offset:8192
  v_mfma_f32_16x16x32_bf16 v[156:159], v[108:111], v[92:95], v[156:159]
  ds_read_b64_tr_b16 v[98:99], v6 offset:10240
  s_nop 0
  s_waitcnt lgkmcnt(6)
  v_mfma_f32_16x16x32_bf16 v[160:163], v[112:115], v[64:67], v[160:163]
  ds_read_b64_tr_b16 v[100:101], v6 offset:12288
  v_mfma_f32_16x16x32_bf16 v[160:163], v[116:119], v[80:83], v[160:163]
  ds_read_b64_tr_b16 v[102:103], v6 offset:14336
  v_mfma_f32_16x16x32_bf16 v[164:167], v[112:115], v[68:71], v[164:167]
  v_mfma_f32_16x16x32_bf16 v[164:167], v[116:119], v[84:87], v[164:167]
  v_mfma_f32_16x16x32_bf16 v[168:171], v[112:115], v[72:75], v[168:171]
  ds_read_b64_tr_b16 v[104:105], v7 offset:8192
  v_mfma_f32_16x16x32_bf16 v[168:171], v[116:119], v[88:91], v[168:171]
  ds_read_b64_tr_b16 v[106:107], v7 offset:10240
  v_mfma_f32_16x16x32_bf16 v[172:175], v[112:115], v[76:79], v[172:175]
  ds_read_b64_tr_b16 v[108:109], v7 offset:12288
  v_mfma_f32_16x16x32_bf16 v[172:175], v[116:119], v[92:95], v[172:175]
  ds_read_b64_tr_b16 v[110:111], v7 offset:14336
  s_waitcnt lgkmcnt(8)
  v_mfma_f32_16x16x32_bf16 v[176:179], v[120:123], v[64:67], v[176:179]
  v_add_u32 v6, s23, v6
  v_add_u32_e64 v7, s23, v7
  v_mfma_f32_16x16x32_bf16 v[176:179], v[124:127], v[80:83], v[176:179]
  ds_read_b64_tr_b16 v[112:113], v10 offset:0
  v_mfma_f32_16x16x32_bf16 v[180:183], v[120:123], v[68:71], v[180:183]
  ds_read_b64_tr_b16 v[114:115], v10 offset:1024
  v_mfma_f32_16x16x32_bf16 v[180:183], v[124:127], v[84:87], v[180:183]
  ds_read_b64_tr_b16 v[116:117], v10 offset:2048
  v_mfma_f32_16x16x32_bf16 v[184:187], v[120:123], v[72:75], v[184:187]
  ds_read_b64_tr_b16 v[118:119], v10 offset:3072
  v_mfma_f32_16x16x32_bf16 v[184:187], v[124:127], v[88:91], v[184:187]
  v_add_u32 v8, s23, v8
  v_add_u32 v9, s23, v9
  v_mfma_f32_16x16x32_bf16 v[188:191], v[120:123], v[76:79], v[188:191]
  v_add_u32_e64 v10, s23, v10
  v_mfma_f32_16x16x32_bf16 v[188:191], v[124:127], v[92:95], v[188:191]
  s_waitcnt lgkmcnt(0)
  s_barrier
  v_mfma_f32_16x16x32_bf16 v[192:195], v[96:99], v[64:67], v[192:195]
  ds_read_b128 v[32:35], v4 offset:0
  v_mfma_f32_16x16x32_bf16 v[192:195], v[100:103], v[80:83], v[192:195]
  ds_read_b128 v[48:51], v5 offset:0
  v_mfma_f32_16x16x32_bf16 v[196:199], v[96:99], v[68:71], v[196:199]
  v_mfma_f32_16x16x32_bf16 v[196:199], v[100:103], v[84:87], v[196:199]
  ds_read_b128 v[36:39], v4 offset:2048
  v_mfma_f32_16x16x32_bf16 v[200:203], v[96:99], v[72:75], v[200:203]
  ds_read_b128 v[52:55], v5 offset:2048
  v_mfma_f32_16x16x32_bf16 v[200:203], v[100:103], v[88:91], v[200:203]
  v_mfma_f32_16x16x32_bf16 v[204:207], v[96:99], v[76:79], v[204:207]
  ds_read_b128 v[40:43], v4 offset:4096
  v_mfma_f32_16x16x32_bf16 v[204:207], v[100:103], v[92:95], v[204:207]
  ds_read_b128 v[56:59], v5 offset:4096
  v_mfma_f32_16x16x32_bf16 v[208:211], v[104:107], v[64:67], v[208:211]
  ds_read_b64_tr_b16 v[96:97], v6 offset:0
  v_mfma_f32_16x16x32_bf16 v[208:211], v[108:111], v[80:83], v[208:211]
  ds_read_b64_tr_b16 v[98:99], v6 offset:2048
  v_mfma_f32_16x16x32_bf16 v[212:215], v[104:107], v[68:71], v[212:215]
  ds_read_b64_tr_b16 v[100:101], v6 offset:4096
  v_mfma_f32_16x16x32_bf16 v[212:215], v[108:111], v[84:87], v[212:215]
  ds_read_b64_tr_b16 v[102:103], v6 offset:6144
  v_mfma_f32_16x16x32_bf16 v[216:219], v[104:107], v[72:75], v[216:219]
  ds_read_b128 v[44:47], v4 offset:6144
  v_mfma_f32_16x16x32_bf16 v[216:219], v[108:111], v[88:91], v[216:219]
  v_mfma_f32_16x16x32_bf16 v[220:223], v[104:107], v[76:79], v[220:223]
  ds_read_b128 v[60:63], v5 offset:6144
  v_mfma_f32_16x16x32_bf16 v[220:223], v[108:111], v[92:95], v[220:223]
  v_mfma_f32_16x16x32_bf16 v[224:227], v[112:115], v[64:67], v[224:227]
  ds_read_b64_tr_b16 v[104:105], v7 offset:0
  v_mfma_f32_16x16x32_bf16 v[224:227], v[116:119], v[80:83], v[224:227]
  v_mfma_f32_16x16x32_bf16 v[228:231], v[112:115], v[68:71], v[228:231]
  ds_read_b64_tr_b16 v[106:107], v7 offset:2048
  v_mfma_f32_16x16x32_bf16 v[228:231], v[116:119], v[84:87], v[228:231]
  v_mfma_f32_16x16x32_bf16 v[232:235], v[112:115], v[72:75], v[232:235]
  ds_read_b64_tr_b16 v[108:109], v7 offset:4096
  v_mfma_f32_16x16x32_bf16 v[232:235], v[116:119], v[88:91], v[232:235]
  v_mfma_f32_16x16x32_bf16 v[236:239], v[112:115], v[76:79], v[236:239]
  ds_read_b64_tr_b16 v[110:111], v7 offset:6144
  v_mfma_f32_16x16x32_bf16 v[236:239], v[116:119], v[92:95], v[236:239]
  s_sub_u32 s22, s22, 1
  s_cmp_lg_u32 s22, 0
  s_cbranch_scc1 Lk_20
  s_waitcnt lgkmcnt(0)
  s_mul_i32 s4, s85, 320
  s_add_u32 s4, s4, 151552
  v_and_b32_e64 v2, 15, v1
  v_lshl_add_u32 v3, v2, 2, s4
  ds_read2_b32 v[88:89], v3 offset0:0 offset1:160
  ds_read2_b32 v[90:91], v3 offset0:16 offset1:176
  ds_read2_b32 v[92:93], v3 offset0:32 offset1:192
  ds_read2_b32 v[94:95], v3 offset0:48 offset1:208
  s_mul_i32 s5, s86, 384
  s_add_u32 s5, s5, 154112
  v_add_u32 v3, s5, v29
  s_lshl_b32 s5, s86, 6
  s_add_u32 s5, s5, 154880
  v_add_u32_e64 v2, s5, v29
  ds_read_b128 v[32:35], v3 offset:0
  ds_read_b128 v[36:39], v3 offset:1024
  ds_read_b128 v[40:43], v3 offset:64
  ds_read_b128 v[44:47], v3 offset:1088
  ds_read_b128 v[80:83], v2 offset:0
  ds_read_b128 v[84:87], v2 offset:1024
  ds_read_b128 v[48:51], v3 offset:128
  ds_read_b128 v[52:55], v3 offset:1152
  ds_read_b128 v[56:59], v3 offset:192
  ds_read_b128 v[60:63], v3 offset:1216
  v_mov_b32 v96, 0x409d30fc
  v_mov_b32 v97, 0x3eeff558
  v_and_b32_e64 v2, 32, v1
  v_mad_u32_u24 v98, v2, 48, v11
  s_mul_i32 s4, s76, 56
  s_mul_i32 s5, s79, 28
  s_add_u32 s4, s4, s5
  s_add_u32 s6, s4, s80
  s_lshl_b32 s6, s6, Lz1-Lz0+14
  s_add_u32 s6, s6, 11599872
  s_add_u32 s7, s6, 4096
  s_lshr_b32 s5, s80, 1
  s_add_u32 s4, s4, s5
  s_lshl_b32 s4, s4, 1
  s_add_u32 s4, s4, s85
  s_lshl_b32 s4, s4, Lz1-Lz0+3
  s_and_b32 s5, s80, 1
  s_add_u32 s4, s4, s5
  s_lshl_b32 s4, s4, 1
  s_add_u32 s4, s4, s86
  s_lshl_b32 s8, s4, 9
  s_add_u32 s8, s8, 11534336
  s_waitcnt lgkmcnt(6)
  ds_read_b128 v[64:67], v3 offset:256
  ds_read_b128 v[68:71], v3 offset:1280
  ds_read_b128 v[72:75], v3 offset:320
  ds_read_b128 v[76:79], v3 offset:1344
  v_pk_mul_f32 v[88:89], v[88:89], v[96:97] op_sel:[0,1] op_sel_hi:[1,1]
  v_pk_mul_f32 v[90:91], v[90:91], v[96:97] op_sel:[0,1] op_sel_hi:[1,1]
  v_pk_mul_f32 v[92:93], v[92:93], v[96:97] op_sel:[0,1] op_sel_hi:[1,1]
  v_pk_mul_f32 v[94:95], v[94:95], v[96:97] op_sel:[0,1] op_sel_hi:[1,1]
  s_lshl_b32 s4, s79, Lz1-Lz0+3
  s_lshl_b32 s10, 0xff, s4
  v_pk_fma_f32 v[100:101], v[32:33], v[88:89], v[36:37] op_sel:[0,1,0] op_sel_hi:[1,1,1] neg_lo:[0,1,0] neg_hi:[0,1,0]
  v_pk_fma_f32 v[102:103], v[34:35], v[88:89], v[38:39] op_sel:[0,1,0] op_sel_hi:[1,1,1] neg_lo:[0,1,0] neg_hi:[0,1,0]
  v_pk_fma_f32 v[104:105], v[40:41], v[88:89], v[44:45] op_sel:[0,1,0] op_sel_hi:[1,1,1] neg_lo:[0,1,0] neg_hi:[0,1,0]
  v_pk_fma_f32 v[106:107], v[42:43], v[88:89], v[46:47] op_sel:[0,1,0] op_sel_hi:[1,1,1] neg_lo:[0,1,0] neg_hi:[0,1,0]
  v_pk_fma_f32 v[128:129], v[128:129], v[88:89], v[100:101] op_sel:[0,0,0] op_sel_hi:[1,0,1]
  v_pk_fma_f32 v[130:131], v[130:131], v[88:89], v[102:103] op_sel:[0,0,0] op_sel_hi:[1,0,1]
  v_pk_fma_f32 v[144:145], v[144:145], v[88:89], v[104:105] op_sel:[0,0,0] op_sel_hi:[1,0,1]
  v_pk_fma_f32 v[146:147], v[146:147], v[88:89], v[106:107] op_sel:[0,0,0] op_sel_hi:[1,0,1]
  v_pk_fma_f32 v[100:101], v[128:129], v[128:129], v[96:97] op_sel_hi:[1,1,0]
  v_pk_fma_f32 v[102:103], v[130:131], v[130:131], v[96:97] op_sel_hi:[1,1,0]
  v_pk_fma_f32 v[104:105], v[144:145], v[144:145], v[96:97] op_sel_hi:[1,1,0]
  v_pk_fma_f32 v[106:107], v[146:147], v[146:147], v[96:97] op_sel_hi:[1,1,0]
  v_pk_mul_f32 v[100:101], v[100:101], v[128:129] neg_lo:[0,1] neg_hi:[0,1]
  v_pk_mul_f32 v[102:103], v[102:103], v[130:131] neg_lo:[0,1] neg_hi:[0,1]
  v_pk_mul_f32 v[104:105], v[104:105], v[144:145] neg_lo:[0,1] neg_hi:[0,1]
  v_pk_mul_f32 v[106:107], v[106:107], v[146:147] neg_lo:[0,1] neg_hi:[0,1]
  v_exp_f32 v100, v100
  v_exp_f32 v101, v101
  v_exp_f32 v102, v102
  v_exp_f32 v103, v103
  v_exp_f32 v104, v104
  v_exp_f32 v105, v105
  v_exp_f32 v106, v106
  v_exp_f32 v107, v107
  v_pk_fma_f32 v[100:101], v[100:101], v[96:97], v[96:97] op_sel:[0,1,1] op_sel_hi:[1,1,1]
  v_pk_fma_f32 v[102:103], v[102:103], v[96:97], v[96:97] op_sel:[0,1,1] op_sel_hi:[1,1,1]
  v_pk_fma_f32 v[104:105], v[104:105], v[96:97], v[96:97] op_sel:[0,1,1] op_sel_hi:[1,1,1]
  v_pk_fma_f32 v[106:107], v[106:107], v[96:97], v[96:97] op_sel:[0,1,1] op_sel_hi:[1,1,1]
  v_rcp_f32 v100, v100
  v_rcp_f32 v101, v101
  v_rcp_f32 v102, v102
  v_rcp_f32 v103, v103
  v_rcp_f32 v104, v104
  v_rcp_f32 v105, v105
  v_rcp_f32 v106, v106
  v_rcp_f32 v107, v107
  v_pk_mul_f32 v[128:129], v[128:129], v[100:101]
  v_pk_mul_f32 v[130:131], v[130:131], v[102:103]
  v_pk_mul_f32 v[144:145], v[144:145], v[104:105]
  v_pk_mul_f32 v[146:147], v[146:147], v[106:107]
  v_cvt_pk_bf16_f32 v116, v128, v129
  v_cvt_pk_bf16_f32 v117, v130, v131
  v_cvt_pk_bf16_f32 v118, v144, v145
  v_cvt_pk_bf16_f32 v119, v146, v147
  buffer_store_dwordx4 v[116:119], v0, s[40:43], s6 offen offset:0 sc0 sc1
  ds_write_b128 v0, v[116:119] offset:0
  v_pk_fma_f32 v[100:101], v[32:33], v[90:91], v[36:37] op_sel:[0,1,0] op_sel_hi:[1,1,1] neg_lo:[0,1,0] neg_hi:[0,1,0]
  v_pk_fma_f32 v[102:103], v[34:35], v[90:91], v[38:39] op_sel:[0,1,0] op_sel_hi:[1,1,1] neg_lo:[0,1,0] neg_hi:[0,1,0]
  v_pk_fma_f32 v[104:105], v[40:41], v[90:91], v[44:45] op_sel:[0,1,0] op_sel_hi:[1,1,1] neg_lo:[0,1,0] neg_hi:[0,1,0]
  v_pk_fma_f32 v[106:107], v[42:43], v[90:91], v[46:47] op_sel:[0,1,0] op_sel_hi:[1,1,1] neg_lo:[0,1,0] neg_hi:[0,1,0]
  v_pk_fma_f32 v[132:133], v[132:133], v[90:91], v[100:101] op_sel:[0,0,0] op_sel_hi:[1,0,1]
  v_pk_fma_f32 v[134:135], v[134:135], v[90:91], v[102:103] op_sel:[0,0,0] op_sel_hi:[1,0,1]
  v_pk_fma_f32 v[148:149], v[148:149], v[90:91], v[104:105] op_sel:[0,0,0] op_sel_hi:[1,0,1]
  v_pk_fma_f32 v[150:151], v[150:151], v[90:91], v[106:107] op_sel:[0,0,0] op_sel_hi:[1,0,1]
  v_pk_fma_f32 v[100:101], v[132:133], v[132:133], v[96:97] op_sel_hi:[1,1,0]
  v_pk_fma_f32 v[102:103], v[134:135], v[134:135], v[96:97] op_sel_hi:[1,1,0]
  v_pk_fma_f32 v[104:105], v[148:149], v[148:149], v[96:97] op_sel_hi:[1,1,0]
  v_pk_fma_f32 v[106:107], v[150:151], v[150:151], v[96:97] op_sel_hi:[1,1,0]
  v_pk_mul_f32 v[100:101], v[100:101], v[132:133] neg_lo:[0,1] neg_hi:[0,1]
  v_pk_mul_f32 v[102:103], v[102:103], v[134:135] neg_lo:[0,1] neg_hi:[0,1]
  v_pk_mul_f32 v[104:105], v[104:105], v[148:149] neg_lo:[0,1] neg_hi:[0,1]
  v_pk_mul_f32 v[106:107], v[106:107], v[150:151] neg_lo:[0,1] neg_hi:[0,1]
  v_exp_f32 v100, v100
  v_exp_f32 v101, v101
  v_exp_f32 v102, v102
  v_exp_f32 v103, v103
  v_exp_f32 v104, v104
  v_exp_f32 v105, v105
  v_exp_f32 v106, v106
  v_exp_f32 v107, v107
  v_pk_fma_f32 v[100:101], v[100:101], v[96:97], v[96:97] op_sel:[0,1,1] op_sel_hi:[1,1,1]
  v_pk_fma_f32 v[102:103], v[102:103], v[96:97], v[96:97] op_sel:[0,1,1] op_sel_hi:[1,1,1]
  v_pk_fma_f32 v[104:105], v[104:105], v[96:97], v[96:97] op_sel:[0,1,1] op_sel_hi:[1,1,1]
  v_pk_fma_f32 v[106:107], v[106:107], v[96:97], v[96:97] op_sel:[0,1,1] op_sel_hi:[1,1,1]
  v_rcp_f32 v100, v100
  v_rcp_f32 v101, v101
  v_rcp_f32 v102, v102
  v_rcp_f32 v103, v103
  v_rcp_f32 v104, v104
  v_rcp_f32 v105, v105
  v_rcp_f32 v106, v106
  v_rcp_f32 v107, v107
  v_pk_mul_f32 v[132:133], v[132:133], v[100:101]
  v_pk_mul_f32 v[134:135], v[134:135], v[102:103]
  v_pk_mul_f32 v[148:149], v[148:149], v[104:105]
  v_pk_mul_f32 v[150:151], v[150:151], v[106:107]
  v_cvt_pk_bf16_f32 v120, v132, v133
  v_cvt_pk_bf16_f32 v121, v134, v135
  v_cvt_pk_bf16_f32 v122, v148, v149
  v_cvt_pk_bf16_f32 v123, v150, v151
  buffer_store_dwordx4 v[120:123], v0, s[40:43], s6 offen offset:2048 sc0 sc1
  ds_write_b128 v0, v[120:123] offset:2048
  s_add_u32 s6, s6, 0x20000
  v_pk_fma_f32 v[100:101], v[32:33], v[92:93], v[36:37] op_sel:[0,1,0] op_sel_hi:[1,1,1] neg_lo:[0,1,0] neg_hi:[0,1,0]
  v_pk_fma_f32 v[102:103], v[34:35], v[92:93], v[38:39] op_sel:[0,1,0] op_sel_hi:[1,1,1] neg_lo:[0,1,0] neg_hi:[0,1,0]
  v_pk_fma_f32 v[104:105], v[40:41], v[92:93], v[44:45] op_sel:[0,1,0] op_sel_hi:[1,1,1] neg_lo:[0,1,0] neg_hi:[0,1,0]
  v_pk_fma_f32 v[106:107], v[42:43], v[92:93], v[46:47] op_sel:[0,1,0] op_sel_hi:[1,1,1] neg_lo:[0,1,0] neg_hi:[0,1,0]
  v_pk_fma_f32 v[136:137], v[136:137], v[92:93], v[100:101] op_sel:[0,0,0] op_sel_hi:[1,0,1]
  v_pk_fma_f32 v[138:139], v[138:139], v[92:93], v[102:103] op_sel:[0,0,0] op_sel_hi:[1,0,1]
  v_pk_fma_f32 v[152:153], v[152:153], v[92:93], v[104:105] op_sel:[0,0,0] op_sel_hi:[1,0,1]
  v_pk_fma_f32 v[154:155], v[154:155], v[92:93], v[106:107] op_sel:[0,0,0] op_sel_hi:[1,0,1]
  v_pk_fma_f32 v[100:101], v[136:137], v[136:137], v[96:97] op_sel_hi:[1,1,0]
  v_pk_fma_f32 v[102:103], v[138:139], v[138:139], v[96:97] op_sel_hi:[1,1,0]
  v_pk_fma_f32 v[104:105], v[152:153], v[152:153], v[96:97] op_sel_hi:[1,1,0]
  v_pk_fma_f32 v[106:107], v[154:155], v[154:155], v[96:97] op_sel_hi:[1,1,0]
  v_pk_mul_f32 v[100:101], v[100:101], v[136:137] neg_lo:[0,1] neg_hi:[0,1]
  v_pk_mul_f32 v[102:103], v[102:103], v[138:139] neg_lo:[0,1] neg_hi:[0,1]
  v_pk_mul_f32 v[104:105], v[104:105], v[152:153] neg_lo:[0,1] neg_hi:[0,1]
  v_pk_mul_f32 v[106:107], v[106:107], v[154:155] neg_lo:[0,1] neg_hi:[0,1]
  v_exp_f32 v100, v100
  v_exp_f32 v101, v101
  v_exp_f32 v102, v102
  v_exp_f32 v103, v103
  v_exp_f32 v104, v104
  v_exp_f32 v105, v105
  v_exp_f32 v106, v106
  v_exp_f32 v107, v107
  v_pk_fma_f32 v[100:101], v[100:101], v[96:97], v[96:97] op_sel:[0,1,1] op_sel_hi:[1,1,1]
  v_pk_fma_f32 v[102:103], v[102:103], v[96:97], v[96:97] op_sel:[0,1,1] op_sel_hi:[1,1,1]
  v_pk_fma_f32 v[104:105], v[104:105], v[96:97], v[96:97] op_sel:[0,1,1] op_sel_hi:[1,1,1]
  v_pk_fma_f32 v[106:107], v[106:107], v[96:97], v[96:97] op_sel:[0,1,1] op_sel_hi:[1,1,1]
  v_rcp_f32 v100, v100
  v_rcp_f32 v101, v101
  v_rcp_f32 v102, v102
  v_rcp_f32 v103, v103
  v_rcp_f32 v104, v104
  v_rcp_f32 v105, v105
  v_rcp_f32 v106, v106
  v_rcp_f32 v107, v107
  v_pk_mul_f32 v[136:137], v[136:137], v[100:101]
  v_pk_mul_f32 v[138:139], v[138:139], v[102:103]
  v_pk_mul_f32 v[152:153], v[152:153], v[104:105]
  v_pk_mul_f32 v[154:155], v[154:155], v[106:107]
  v_cvt_pk_bf16_f32 v116, v136, v137
  v_cvt_pk_bf16_f32 v117, v138, v139
  v_cvt_pk_bf16_f32 v118, v152, v153
  v_cvt_pk_bf16_f32 v119, v154, v155
  buffer_store_dwordx4 v[116:119], v0, s[40:43], s7 offen offset:0 sc0 sc1
  ds_write_b128 v0, v[116:119] offset:4096
  v_pk_fma_f32 v[100:101], v[32:33], v[94:95], v[36:37] op_sel:[0,1,0] op_sel_hi:[1,1,1] neg_lo:[0,1,0] neg_hi:[0,1,0]
  v_pk_fma_f32 v[102:103], v[34:35], v[94:95], v[38:39] op_sel:[0,1,0] op_sel_hi:[1,1,1] neg_lo:[0,1,0] neg_hi:[0,1,0]
  v_pk_fma_f32 v[104:105], v[40:41], v[94:95], v[44:45] op_sel:[0,1,0] op_sel_hi:[1,1,1] neg_lo:[0,1,0] neg_hi:[0,1,0]
  v_pk_fma_f32 v[106:107], v[42:43], v[94:95], v[46:47] op_sel:[0,1,0] op_sel_hi:[1,1,1] neg_lo:[0,1,0] neg_hi:[0,1,0]
  v_pk_fma_f32 v[140:141], v[140:141], v[94:95], v[100:101] op_sel:[0,0,0] op_sel_hi:[1,0,1]
  v_pk_fma_f32 v[142:143], v[142:143], v[94:95], v[102:103] op_sel:[0,0,0] op_sel_hi:[1,0,1]
  v_pk_fma_f32 v[156:157], v[156:157], v[94:95], v[104:105] op_sel:[0,0,0] op_sel_hi:[1,0,1]
  v_pk_fma_f32 v[158:159], v[158:159], v[94:95], v[106:107] op_sel:[0,0,0] op_sel_hi:[1,0,1]
  v_pk_fma_f32 v[100:101], v[140:141], v[140:141], v[96:97] op_sel_hi:[1,1,0]
  v_pk_fma_f32 v[102:103], v[142:143], v[142:143], v[96:97] op_sel_hi:[1,1,0]
  v_pk_fma_f32 v[104:105], v[156:157], v[156:157], v[96:97] op_sel_hi:[1,1,0]
  v_pk_fma_f32 v[106:107], v[158:159], v[158:159], v[96:97] op_sel_hi:[1,1,0]
  v_pk_mul_f32 v[100:101], v[100:101], v[140:141] neg_lo:[0,1] neg_hi:[0,1]
  v_pk_mul_f32 v[102:103], v[102:103], v[142:143] neg_lo:[0,1] neg_hi:[0,1]
  v_pk_mul_f32 v[104:105], v[104:105], v[156:157] neg_lo:[0,1] neg_hi:[0,1]
  v_pk_mul_f32 v[106:107], v[106:107], v[158:159] neg_lo:[0,1] neg_hi:[0,1]
  v_exp_f32 v100, v100
  v_exp_f32 v101, v101
  v_exp_f32 v102, v102
  v_exp_f32 v103, v103
  v_exp_f32 v104, v104
  v_exp_f32 v105, v105
  v_exp_f32 v106, v106
  v_exp_f32 v107, v107
  v_pk_fma_f32 v[100:101], v[100:101], v[96:97], v[96:97] op_sel:[0,1,1] op_sel_hi:[1,1,1]
  v_pk_fma_f32 v[102:103], v[102:103], v[96:97], v[96:97] op_sel:[0,1,1] op_sel_hi:[1,1,1]
  v_pk_fma_f32 v[104:105], v[104:105], v[96:97], v[96:97] op_sel:[0,1,1] op_sel_hi:[1,1,1]
  v_pk_fma_f32 v[106:107], v[106:107], v[96:97], v[96:97] op_sel:[0,1,1] op_sel_hi:[1,1,1]
  v_rcp_f32 v100, v100
  v_rcp_f32 v101, v101
  v_rcp_f32 v102, v102
  v_rcp_f32 v103, v103
  v_rcp_f32 v104, v104
  v_rcp_f32 v105, v105
  v_rcp_f32 v106, v106
  v_rcp_f32 v107, v107
  v_pk_mul_f32 v[140:141], v[140:141], v[100:101]
  v_pk_mul_f32 v[142:143], v[142:143], v[102:103]
  v_pk_mul_f32 v[156:157], v[156:157], v[104:105]
  v_pk_mul_f32 v[158:159], v[158:159], v[106:107]
  v_cvt_pk_bf16_f32 v120, v140, v141
  v_cvt_pk_bf16_f32 v121, v142, v143
  v_cvt_pk_bf16_f32 v122, v156, v157
  v_cvt_pk_bf16_f32 v123, v158, v159
  buffer_store_dwordx4 v[120:123], v0, s[40:43], s7 offen offset:2048 sc0 sc1
  ds_write_b128 v0, v[120:123] offset:6144
  s_add_u32 s7, s7, 0x20000
  s_nop 0
  s_waitcnt lgkmcnt(0)
  v_pk_fma_f32 v[100:101], v[80:81], v[88:89], v[84:85] op_sel:[0,1,0] op_sel_hi:[1,1,1] neg_lo:[0,1,0] neg_hi:[0,1,0]
  v_pk_fma_f32 v[102:103], v[82:83], v[88:89], v[86:87] op_sel:[0,1,0] op_sel_hi:[1,1,1] neg_lo:[0,1,0] neg_hi:[0,1,0]
  v_pk_fma_f32 v[104:105], v[80:81], v[90:91], v[84:85] op_sel:[0,1,0] op_sel_hi:[1,1,1] neg_lo:[0,1,0] neg_hi:[0,1,0]
  v_pk_fma_f32 v[106:107], v[82:83], v[90:91], v[86:87] op_sel:[0,1,0] op_sel_hi:[1,1,1] neg_lo:[0,1,0] neg_hi:[0,1,0]
  v_pk_fma_f32 v[224:225], v[224:225], v[88:89], v[100:101] op_sel:[0,0,0] op_sel_hi:[1,0,1]
  v_pk_fma_f32 v[226:227], v[226:227], v[88:89], v[102:103] op_sel:[0,0,0] op_sel_hi:[1,0,1]
  v_pk_fma_f32 v[228:229], v[228:229], v[90:91], v[104:105] op_sel:[0,0,0] op_sel_hi:[1,0,1]
  v_pk_fma_f32 v[230:231], v[230:231], v[90:91], v[106:107] op_sel:[0,0,0] op_sel_hi:[1,0,1]
  v_pk_fma_f32 v[100:101], v[224:225], v[224:225], v[96:97] op_sel_hi:[1,1,0]
  v_pk_fma_f32 v[102:103], v[226:227], v[226:227], v[96:97] op_sel_hi:[1,1,0]
  v_pk_fma_f32 v[104:105], v[228:229], v[228:229], v[96:97] op_sel_hi:[1,1,0]
  v_pk_fma_f32 v[106:107], v[230:231], v[230:231], v[96:97] op_sel_hi:[1,1,0]
  v_pk_mul_f32 v[100:101], v[100:101], v[224:225] neg_lo:[0,1] neg_hi:[0,1]
  v_pk_mul_f32 v[102:103], v[102:103], v[226:227] neg_lo:[0,1] neg_hi:[0,1]
  v_pk_mul_f32 v[104:105], v[104:105], v[228:229] neg_lo:[0,1] neg_hi:[0,1]
  v_pk_mul_f32 v[106:107], v[106:107], v[230:231] neg_lo:[0,1] neg_hi:[0,1]
  v_exp_f32 v100, v100
  v_exp_f32 v101, v101
  v_exp_f32 v102, v102
  v_exp_f32 v103, v103
  v_exp_f32 v104, v104
  v_exp_f32 v105, v105
  v_exp_f32 v106, v106
  v_exp_f32 v107, v107
  v_pk_fma_f32 v[100:101], v[100:101], v[96:97], v[96:97] op_sel:[0,1,1] op_sel_hi:[1,1,1]
  v_pk_fma_f32 v[102:103], v[102:103], v[96:97], v[96:97] op_sel:[0,1,1] op_sel_hi:[1,1,1]
  v_pk_fma_f32 v[104:105], v[104:105], v[96:97], v[96:97] op_sel:[0,1,1] op_sel_hi:[1,1,1]
  v_pk_fma_f32 v[106:107], v[106:107], v[96:97], v[96:97] op_sel:[0,1,1] op_sel_hi:[1,1,1]
  v_rcp_f32 v100, v100
  v_rcp_f32 v101, v101
  v_rcp_f32 v102, v102
  v_rcp_f32 v103, v103
  v_rcp_f32 v104, v104
  v_rcp_f32 v105, v105
  v_rcp_f32 v106, v106
  v_rcp_f32 v107, v107
  v_pk_mul_f32 v[224:225], v[224:225], v[100:101]
  v_pk_mul_f32 v[226:227], v[226:227], v[102:103]
  v_pk_mul_f32 v[228:229], v[228:229], v[104:105]
  v_pk_mul_f32 v[230:231], v[230:231], v[106:107]
  v_cvt_pk_bf16_f32 v116, v224, v225
  v_cvt_pk_bf16_f32 v117, v226, v227
  v_cvt_pk_bf16_f32 v118, v228, v229
  v_cvt_pk_bf16_f32 v119, v230, v231
  s_nop 0
  v_permlane32_swap_b32 v116, v118
  v_permlane32_swap_b32_e64 v117, v119
  buffer_store_dwordx4 v[116:119], v98, s[40:43], s8 offen sc0 sc1
  s_add_u32 s8, s8, 4096
  v_pk_fma_f32 v[100:101], v[80:81], v[92:93], v[84:85] op_sel:[0,1,0] op_sel_hi:[1,1,1] neg_lo:[0,1,0] neg_hi:[0,1,0]
  v_pk_fma_f32 v[102:103], v[82:83], v[92:93], v[86:87] op_sel:[0,1,0] op_sel_hi:[1,1,1] neg_lo:[0,1,0] neg_hi:[0,1,0]
  v_pk_fma_f32 v[104:105], v[80:81], v[94:95], v[84:85] op_sel:[0,1,0] op_sel_hi:[1,1,1] neg_lo:[0,1,0] neg_hi:[0,1,0]
  v_pk_fma_f32 v[106:107], v[82:83], v[94:95], v[86:87] op_sel:[0,1,0] op_sel_hi:[1,1,1] neg_lo:[0,1,0] neg_hi:[0,1,0]
  v_pk_fma_f32 v[232:233], v[232:233], v[92:93], v[100:101] op_sel:[0,0,0] op_sel_hi:[1,0,1]
  v_pk_fma_f32 v[234:235], v[234:235], v[92:93], v[102:103] op_sel:[0,0,0] op_sel_hi:[1,0,1]
  v_pk_fma_f32 v[236:237], v[236:237], v[94:95], v[104:105] op_sel:[0,0,0] op_sel_hi:[1,0,1]
  v_pk_fma_f32 v[238:239], v[238:239], v[94:95], v[106:107] op_sel:[0,0,0] op_sel_hi:[1,0,1]
  v_pk_fma_f32 v[100:101], v[232:233], v[232:233], v[96:97] op_sel_hi:[1,1,0]
  v_pk_fma_f32 v[102:103], v[234:235], v[234:235], v[96:97] op_sel_hi:[1,1,0]
  v_pk_fma_f32 v[104:105], v[236:237], v[236:237], v[96:97] op_sel_hi:[1,1,0]
  v_pk_fma_f32 v[106:107], v[238:239], v[238:239], v[96:97] op_sel_hi:[1,1,0]
  v_pk_mul_f32 v[100:101], v[100:101], v[232:233] neg_lo:[0,1] neg_hi:[0,1]
  v_pk_mul_f32 v[102:103], v[102:103], v[234:235] neg_lo:[0,1] neg_hi:[0,1]
  v_pk_mul_f32 v[104:105], v[104:105], v[236:237] neg_lo:[0,1] neg_hi:[0,1]
  v_pk_mul_f32 v[106:107], v[106:107], v[238:239] neg_lo:[0,1] neg_hi:[0,1]
  v_exp_f32 v100, v100
  v_exp_f32 v101, v101
  v_exp_f32 v102, v102
  v_exp_f32 v103, v103
  v_exp_f32 v104, v104
  v_exp_f32 v105, v105
  v_exp_f32 v106, v106
  v_exp_f32 v107, v107
  v_pk_fma_f32 v[100:101], v[100:101], v[96:97], v[96:97] op_sel:[0,1,1] op_sel_hi:[1,1,1]
  v_pk_fma_f32 v[102:103], v[102:103], v[96:97], v[96:97] op_sel:[0,1,1] op_sel_hi:[1,1,1]
  v_pk_fma_f32 v[104:105], v[104:105], v[96:97], v[96:97] op_sel:[0,1,1] op_sel_hi:[1,1,1]
  v_pk_fma_f32 v[106:107], v[106:107], v[96:97], v[96:97] op_sel:[0,1,1] op_sel_hi:[1,1,1]
  v_rcp_f32 v100, v100
  v_rcp_f32 v101, v101
  v_rcp_f32 v102, v102
  v_rcp_f32 v103, v103
  v_rcp_f32 v104, v104
  v_rcp_f32 v105, v105
  v_rcp_f32 v106, v106
  v_rcp_f32 v107, v107
  v_pk_mul_f32 v[232:233], v[232:233], v[100:101]
  v_pk_mul_f32 v[234:235], v[234:235], v[102:103]
  v_pk_mul_f32 v[236:237], v[236:237], v[104:105]
  v_pk_mul_f32 v[238:239], v[238:239], v[106:107]
  v_cvt_pk_bf16_f32 v120, v232, v233
  v_cvt_pk_bf16_f32 v121, v234, v235
  v_cvt_pk_bf16_f32 v122, v236, v237
  v_cvt_pk_bf16_f32 v123, v238, v239
  s_add_u32 s9, s87, Lz1-Lz0+8
  s_waitcnt vmcnt(1)
  s_mov_b64 exec, 1
  ds_add_rtn_u32 v124, v28, v27 offset:0
  s_mov_b64 exec, -1
  v_permlane32_swap_b32 v120, v122
  v_permlane32_swap_b32_e64 v121, v123
  buffer_store_dwordx4 v[120:123], v98, s[40:43], s8 offen sc0 sc1
  v_pk_fma_f32 v[100:101], v[48:49], v[88:89], v[52:53] op_sel:[0,1,0] op_sel_hi:[1,1,1] neg_lo:[0,1,0] neg_hi:[0,1,0]
  v_pk_fma_f32 v[102:103], v[50:51], v[88:89], v[54:55] op_sel:[0,1,0] op_sel_hi:[1,1,1] neg_lo:[0,1,0] neg_hi:[0,1,0]
  v_pk_fma_f32 v[104:105], v[56:57], v[88:89], v[60:61] op_sel:[0,1,0] op_sel_hi:[1,1,1] neg_lo:[0,1,0] neg_hi:[0,1,0]
  v_pk_fma_f32 v[106:107], v[58:59], v[88:89], v[62:63] op_sel:[0,1,0] op_sel_hi:[1,1,1] neg_lo:[0,1,0] neg_hi:[0,1,0]
  v_pk_fma_f32 v[160:161], v[160:161], v[88:89], v[100:101] op_sel:[0,0,0] op_sel_hi:[1,0,1]
  v_pk_fma_f32 v[162:163], v[162:163], v[88:89], v[102:103] op_sel:[0,0,0] op_sel_hi:[1,0,1]
  v_pk_fma_f32 v[176:177], v[176:177], v[88:89], v[104:105] op_sel:[0,0,0] op_sel_hi:[1,0,1]
  v_pk_fma_f32 v[178:179], v[178:179], v[88:89], v[106:107] op_sel:[0,0,0] op_sel_hi:[1,0,1]
  v_pk_fma_f32 v[100:101], v[160:161], v[160:161], v[96:97] op_sel_hi:[1,1,0]
  v_pk_fma_f32 v[102:103], v[162:163], v[162:163], v[96:97] op_sel_hi:[1,1,0]
  v_pk_fma_f32 v[104:105], v[176:177], v[176:177], v[96:97] op_sel_hi:[1,1,0]
  v_pk_fma_f32 v[106:107], v[178:179], v[178:179], v[96:97] op_sel_hi:[1,1,0]
  v_pk_mul_f32 v[100:101], v[100:101], v[160:161] neg_lo:[0,1] neg_hi:[0,1]
  v_pk_mul_f32 v[102:103], v[102:103], v[162:163] neg_lo:[0,1] neg_hi:[0,1]
  v_pk_mul_f32 v[104:105], v[104:105], v[176:177] neg_lo:[0,1] neg_hi:[0,1]
  v_pk_mul_f32 v[106:107], v[106:107], v[178:179] neg_lo:[0,1] neg_hi:[0,1]
  v_exp_f32 v100, v100
  v_exp_f32 v101, v101
  v_exp_f32 v102, v102
  v_exp_f32 v103, v103
  v_exp_f32 v104, v104
  v_exp_f32 v105, v105
  v_exp_f32 v106, v106
  v_exp_f32 v107, v107
  v_pk_fma_f32 v[100:101], v[100:101], v[96:97], v[96:97] op_sel:[0,1,1] op_sel_hi:[1,1,1]
  v_pk_fma_f32 v[102:103], v[102:103], v[96:97], v[96:97] op_sel:[0,1,1] op_sel_hi:[1,1,1]
  v_pk_fma_f32 v[104:105], v[104:105], v[96:97], v[96:97] op_sel:[0,1,1] op_sel_hi:[1,1,1]
  v_pk_fma_f32 v[106:107], v[106:107], v[96:97], v[96:97] op_sel:[0,1,1] op_sel_hi:[1,1,1]
  v_rcp_f32 v100, v100
  v_rcp_f32 v101, v101
  v_rcp_f32 v102, v102
  v_rcp_f32 v103, v103
  v_rcp_f32 v104, v104
  v_rcp_f32 v105, v105
  v_rcp_f32 v106, v106
  v_rcp_f32 v107, v107
  v_pk_mul_f32 v[160:161], v[160:161], v[100:101]
  v_pk_mul_f32 v[162:163], v[162:163], v[102:103]
  v_pk_mul_f32 v[176:177], v[176:177], v[104:105]
  v_pk_mul_f32 v[178:179], v[178:179], v[106:107]
  v_cvt_pk_bf16_f32 v116, v160, v161
  v_cvt_pk_bf16_f32 v117, v162, v163
  v_cvt_pk_bf16_f32 v118, v176, v177
  v_cvt_pk_bf16_f32 v119, v178, v179
  s_waitcnt lgkmcnt(0)
  v_readfirstlane_b32 s4, v124
  s_and_b32 s4, s4, 3
  s_cmp_lg_u32 s4, 3
  s_cbranch_scc1 Ls_25
  s_mov_b32 exec_lo, s10
  s_mov_b32 exec_hi, 0
  buffer_store_dword v27, v24, s[40:43], s9 offen sc0 sc1
Ls_25:
  s_mov_b64 exec, -1
  buffer_store_dwordx4 v[116:119], v0, s[40:43], s6 offen offset:0 sc0 sc1
  ds_write_b128 v0, v[116:119] offset:16384
  v_pk_fma_f32 v[100:101], v[48:49], v[90:91], v[52:53] op_sel:[0,1,0] op_sel_hi:[1,1,1] neg_lo:[0,1,0] neg_hi:[0,1,0]
  v_pk_fma_f32 v[102:103], v[50:51], v[90:91], v[54:55] op_sel:[0,1,0] op_sel_hi:[1,1,1] neg_lo:[0,1,0] neg_hi:[0,1,0]
  v_pk_fma_f32 v[104:105], v[56:57], v[90:91], v[60:61] op_sel:[0,1,0] op_sel_hi:[1,1,1] neg_lo:[0,1,0] neg_hi:[0,1,0]
  v_pk_fma_f32 v[106:107], v[58:59], v[90:91], v[62:63] op_sel:[0,1,0] op_sel_hi:[1,1,1] neg_lo:[0,1,0] neg_hi:[0,1,0]
  v_pk_fma_f32 v[164:165], v[164:165], v[90:91], v[100:101] op_sel:[0,0,0] op_sel_hi:[1,0,1]
  v_pk_fma_f32 v[166:167], v[166:167], v[90:91], v[102:103] op_sel:[0,0,0] op_sel_hi:[1,0,1]
  v_pk_fma_f32 v[180:181], v[180:181], v[90:91], v[104:105] op_sel:[0,0,0] op_sel_hi:[1,0,1]
  v_pk_fma_f32 v[182:183], v[182:183], v[90:91], v[106:107] op_sel:[0,0,0] op_sel_hi:[1,0,1]
  v_pk_fma_f32 v[100:101], v[164:165], v[164:165], v[96:97] op_sel_hi:[1,1,0]
  v_pk_fma_f32 v[102:103], v[166:167], v[166:167], v[96:97] op_sel_hi:[1,1,0]
  v_pk_fma_f32 v[104:105], v[180:181], v[180:181], v[96:97] op_sel_hi:[1,1,0]
  v_pk_fma_f32 v[106:107], v[182:183], v[182:183], v[96:97] op_sel_hi:[1,1,0]
  v_pk_mul_f32 v[100:101], v[100:101], v[164:165] neg_lo:[0,1] neg_hi:[0,1]
  v_pk_mul_f32 v[102:103], v[102:103], v[166:167] neg_lo:[0,1] neg_hi:[0,1]
  v_pk_mul_f32 v[104:105], v[104:105], v[180:181] neg_lo:[0,1] neg_hi:[0,1]
  v_pk_mul_f32 v[106:107], v[106:107], v[182:183] neg_lo:[0,1] neg_hi:[0,1]
  v_exp_f32 v100, v100
  v_exp_f32 v101, v101
  v_exp_f32 v102, v102
  v_exp_f32 v103, v103
  v_exp_f32 v104, v104
  v_exp_f32 v105, v105
  v_exp_f32 v106, v106
  v_exp_f32 v107, v107
  v_pk_fma_f32 v[100:101], v[100:101], v[96:97], v[96:97] op_sel:[0,1,1] op_sel_hi:[1,1,1]
  v_pk_fma_f32 v[102:103], v[102:103], v[96:97], v[96:97] op_sel:[0,1,1] op_sel_hi:[1,1,1]
  v_pk_fma_f32 v[104:105], v[104:105], v[96:97], v[96:97] op_sel:[0,1,1] op_sel_hi:[1,1,1]
  v_pk_fma_f32 v[106:107], v[106:107], v[96:97], v[96:97] op_sel:[0,1,1] op_sel_hi:[1,1,1]
  v_rcp_f32 v100, v100
  v_rcp_f32 v101, v101
  v_rcp_f32 v102, v102
  v_rcp_f32 v103, v103
  v_rcp_f32 v104, v104
  v_rcp_f32 v105, v105
  v_rcp_f32 v106, v106
  v_rcp_f32 v107, v107
  v_pk_mul_f32 v[164:165], v[164:165], v[100:101]
  v_pk_mul_f32 v[166:167], v[166:167], v[102:103]
  v_pk_mul_f32 v[180:181], v[180:181], v[104:105]
  v_pk_mul_f32 v[182:183], v[182:183], v[106:107]
  v_cvt_pk_bf16_f32 v120, v164, v165
  v_cvt_pk_bf16_f32 v121, v166, v167
  v_cvt_pk_bf16_f32 v122, v180, v181
  v_cvt_pk_bf16_f32 v123, v182, v183
  buffer_store_dwordx4 v[120:123], v0, s[40:43], s6 offen offset:2048 sc0 sc1
  ds_write_b128 v0, v[120:123] offset:18432
  s_add_u32 s6, s6, 0x20000
  v_pk_fma_f32 v[100:101], v[48:49], v[92:93], v[52:53] op_sel:[0,1,0] op_sel_hi:[1,1,1] neg_lo:[0,1,0] neg_hi:[0,1,0]
  v_pk_fma_f32 v[102:103], v[50:51], v[92:93], v[54:55] op_sel:[0,1,0] op_sel_hi:[1,1,1] neg_lo:[0,1,0] neg_hi:[0,1,0]
  v_pk_fma_f32 v[104:105], v[56:57], v[92:93], v[60:61] op_sel:[0,1,0] op_sel_hi:[1,1,1] neg_lo:[0,1,0] neg_hi:[0,1,0]
  v_pk_fma_f32 v[106:107], v[58:59], v[92:93], v[62:63] op_sel:[0,1,0] op_sel_hi:[1,1,1] neg_lo:[0,1,0] neg_hi:[0,1,0]
  v_pk_fma_f32 v[168:169], v[168:169], v[92:93], v[100:101] op_sel:[0,0,0] op_sel_hi:[1,0,1]
  v_pk_fma_f32 v[170:171], v[170:171], v[92:93], v[102:103] op_sel:[0,0,0] op_sel_hi:[1,0,1]
  v_pk_fma_f32 v[184:185], v[184:185], v[92:93], v[104:105] op_sel:[0,0,0] op_sel_hi:[1,0,1]
  v_pk_fma_f32 v[186:187], v[186:187], v[92:93], v[106:107] op_sel:[0,0,0] op_sel_hi:[1,0,1]
  v_pk_fma_f32 v[100:101], v[168:169], v[168:169], v[96:97] op_sel_hi:[1,1,0]
  v_pk_fma_f32 v[102:103], v[170:171], v[170:171], v[96:97] op_sel_hi:[1,1,0]
  v_pk_fma_f32 v[104:105], v[184:185], v[184:185], v[96:97] op_sel_hi:[1,1,0]
  v_pk_fma_f32 v[106:107], v[186:187], v[186:187], v[96:97] op_sel_hi:[1,1,0]
  v_pk_mul_f32 v[100:101], v[100:101], v[168:169] neg_lo:[0,1] neg_hi:[0,1]
  v_pk_mul_f32 v[102:103], v[102:103], v[170:171] neg_lo:[0,1] neg_hi:[0,1]
  v_pk_mul_f32 v[104:105], v[104:105], v[184:185] neg_lo:[0,1] neg_hi:[0,1]
  v_pk_mul_f32 v[106:107], v[106:107], v[186:187] neg_lo:[0,1] neg_hi:[0,1]
  v_exp_f32 v100, v100
  v_exp_f32 v101, v101
  v_exp_f32 v102, v102
  v_exp_f32 v103, v103
  v_exp_f32 v104, v104
  v_exp_f32 v105, v105
  v_exp_f32 v106, v106
  v_exp_f32 v107, v107
  v_pk_fma_f32 v[100:101], v[100:101], v[96:97], v[96:97] op_sel:[0,1,1] op_sel_hi:[1,1,1]
  v_pk_fma_f32 v[102:103], v[102:103], v[96:97], v[96:97] op_sel:[0,1,1] op_sel_hi:[1,1,1]
  v_pk_fma_f32 v[104:105], v[104:105], v[96:97], v[96:97] op_sel:[0,1,1] op_sel_hi:[1,1,1]
  v_pk_fma_f32 v[106:107], v[106:107], v[96:97], v[96:97] op_sel:[0,1,1] op_sel_hi:[1,1,1]
  v_rcp_f32 v100, v100
  v_rcp_f32 v101, v101
  v_rcp_f32 v102, v102
  v_rcp_f32 v103, v103
  v_rcp_f32 v104, v104
  v_rcp_f32 v105, v105
  v_rcp_f32 v106, v106
  v_rcp_f32 v107, v107
  v_pk_mul_f32 v[168:169], v[168:169], v[100:101]
  v_pk_mul_f32 v[170:171], v[170:171], v[102:103]
  v_pk_mul_f32 v[184:185], v[184:185], v[104:105]
  v_pk_mul_f32 v[186:187], v[186:187], v[106:107]
  v_cvt_pk_bf16_f32 v116, v168, v169
  v_cvt_pk_bf16_f32 v117, v170, v171
  v_cvt_pk_bf16_f32 v118, v184, v185
  v_cvt_pk_bf16_f32 v119, v186, v187
  buffer_store_dwordx4 v[116:119], v0, s[40:43], s7 offen offset:0 sc0 sc1
  ds_write_b128 v0, v[116:119] offset:20480
  v_pk_fma_f32 v[100:101], v[48:49], v[94:95], v[52:53] op_sel:[0,1,0] op_sel_hi:[1,1,1] neg_lo:[0,1,0] neg_hi:[0,1,0]
  v_pk_fma_f32 v[102:103], v[50:51], v[94:95], v[54:55] op_sel:[0,1,0] op_sel_hi:[1,1,1] neg_lo:[0,1,0] neg_hi:[0,1,0]
  v_pk_fma_f32 v[104:105], v[56:57], v[94:95], v[60:61] op_sel:[0,1,0] op_sel_hi:[1,1,1] neg_lo:[0,1,0] neg_hi:[0,1,0]
  v_pk_fma_f32 v[106:107], v[58:59], v[94:95], v[62:63] op_sel:[0,1,0] op_sel_hi:[1,1,1] neg_lo:[0,1,0] neg_hi:[0,1,0]
  v_pk_fma_f32 v[172:173], v[172:173], v[94:95], v[100:101] op_sel:[0,0,0] op_sel_hi:[1,0,1]
  v_pk_fma_f32 v[174:175], v[174:175], v[94:95], v[102:103] op_sel:[0,0,0] op_sel_hi:[1,0,1]
  v_pk_fma_f32 v[188:189], v[188:189], v[94:95], v[104:105] op_sel:[0,0,0] op_sel_hi:[1,0,1]
  v_pk_fma_f32 v[190:191], v[190:191], v[94:95], v[106:107] op_sel:[0,0,0] op_sel_hi:[1,0,1]
  v_pk_fma_f32 v[100:101], v[172:173], v[172:173], v[96:97] op_sel_hi:[1,1,0]
  v_pk_fma_f32 v[102:103], v[174:175], v[174:175], v[96:97] op_sel_hi:[1,1,0]
  v_pk_fma_f32 v[104:105], v[188:189], v[188:189], v[96:97] op_sel_hi:[1,1,0]
  v_pk_fma_f32 v[106:107], v[190:191], v[190:191], v[96:97] op_sel_hi:[1,1,0]
  v_pk_mul_f32 v[100:101], v[100:101], v[172:173] neg_lo:[0,1] neg_hi:[0,1]
  v_pk_mul_f32 v[102:103], v[102:103], v[174:175] neg_lo:[0,1] neg_hi:[0,1]
  v_pk_mul_f32 v[104:105], v[104:105], v[188:189] neg_lo:[0,1] neg_hi:[0,1]
  v_pk_mul_f32 v[106:107], v[106:107], v[190:191] neg_lo:[0,1] neg_hi:[0,1]
  v_exp_f32 v100, v100
  v_exp_f32 v101, v101
  v_exp_f32 v102, v102
  v_exp_f32 v103, v103
  v_exp_f32 v104, v104
  v_exp_f32 v105, v105
  v_exp_f32 v106, v106
  v_exp_f32 v107, v107
  v_pk_fma_f32 v[100:101], v[100:101], v[96:97], v[96:97] op_sel:[0,1,1] op_sel_hi:[1,1,1]
  v_pk_fma_f32 v[102:103], v[102:103], v[96:97], v[96:97] op_sel:[0,1,1] op_sel_hi:[1,1,1]
  v_pk_fma_f32 v[104:105], v[104:105], v[96:97], v[96:97] op_sel:[0,1,1] op_sel_hi:[1,1,1]
  v_pk_fma_f32 v[106:107], v[106:107], v[96:97], v[96:97] op_sel:[0,1,1] op_sel_hi:[1,1,1]
  v_rcp_f32 v100, v100
  v_rcp_f32 v101, v101
  v_rcp_f32 v102, v102
  v_rcp_f32 v103, v103
  v_rcp_f32 v104, v104
  v_rcp_f32 v105, v105
  v_rcp_f32 v106, v106
  v_rcp_f32 v107, v107
  v_pk_mul_f32 v[172:173], v[172:173], v[100:101]
  v_pk_mul_f32 v[174:175], v[174:175], v[102:103]
  v_pk_mul_f32 v[188:189], v[188:189], v[104:105]
  v_pk_mul_f32 v[190:191], v[190:191], v[106:107]
  v_cvt_pk_bf16_f32 v120, v172, v173
  v_cvt_pk_bf16_f32 v121, v174, v175
  v_cvt_pk_bf16_f32 v122, v188, v189
  v_cvt_pk_bf16_f32 v123, v190, v191
  buffer_store_dwordx4 v[120:123], v0, s[40:43], s7 offen offset:2048 sc0 sc1
  ds_write_b128 v0, v[120:123] offset:22528
  s_add_u32 s7, s7, 0x20000
  v_pk_fma_f32 v[100:101], v[64:65], v[88:89], v[68:69] op_sel:[0,1,0] op_sel_hi:[1,1,1] neg_lo:[0,1,0] neg_hi:[0,1,0]
  v_pk_fma_f32 v[102:103], v[66:67], v[88:89], v[70:71] op_sel:[0,1,0] op_sel_hi:[1,1,1] neg_lo:[0,1,0] neg_hi:[0,1,0]
  v_pk_fma_f32 v[104:105], v[72:73], v[88:89], v[76:77] op_sel:[0,1,0] op_sel_hi:[1,1,1] neg_lo:[0,1,0] neg_hi:[0,1,0]
  v_pk_fma_f32 v[106:107], v[74:75], v[88:89], v[78:79] op_sel:[0,1,0] op_sel_hi:[1,1,1] neg_lo:[0,1,0] neg_hi:[0,1,0]
  v_pk_fma_f32 v[192:193], v[192:193], v[88:89], v[100:101] op_sel:[0,0,0] op_sel_hi:[1,0,1]
  v_pk_fma_f32 v[194:195], v[194:195], v[88:89], v[102:103] op_sel:[0,0,0] op_sel_hi:[1,0,1]
  v_pk_fma_f32 v[208:209], v[208:209], v[88:89], v[104:105] op_sel:[0,0,0] op_sel_hi:[1,0,1]
  v_pk_fma_f32 v[210:211], v[210:211], v[88:89], v[106:107] op_sel:[0,0,0] op_sel_hi:[1,0,1]
  v_pk_fma_f32 v[100:101], v[192:193], v[192:193], v[96:97] op_sel_hi:[1,1,0]
  v_pk_fma_f32 v[102:103], v[194:195], v[194:195], v[96:97] op_sel_hi:[1,1,0]
  v_pk_fma_f32 v[104:105], v[208:209], v[208:209], v[96:97] op_sel_hi:[1,1,0]
  v_pk_fma_f32 v[106:107], v[210:211], v[210:211], v[96:97] op_sel_hi:[1,1,0]
  v_pk_mul_f32 v[100:101], v[100:101], v[192:193] neg_lo:[0,1] neg_hi:[0,1]
  v_pk_mul_f32 v[102:103], v[102:103], v[194:195] neg_lo:[0,1] neg_hi:[0,1]
  v_pk_mul_f32 v[104:105], v[104:105], v[208:209] neg_lo:[0,1] neg_hi:[0,1]
  v_pk_mul_f32 v[106:107], v[106:107], v[210:211] neg_lo:[0,1] neg_hi:[0,1]
  v_exp_f32 v100, v100
  v_exp_f32 v101, v101
  v_exp_f32 v102, v102
  v_exp_f32 v103, v103
  v_exp_f32 v104, v104
  v_exp_f32 v105, v105
  v_exp_f32 v106, v106
  v_exp_f32 v107, v107
  v_pk_fma_f32 v[100:101], v[100:101], v[96:97], v[96:97] op_sel:[0,1,1] op_sel_hi:[1,1,1]
  v_pk_fma_f32 v[102:103], v[102:103], v[96:97], v[96:97] op_sel:[0,1,1] op_sel_hi:[1,1,1]
  v_pk_fma_f32 v[104:105], v[104:105], v[96:97], v[96:97] op_sel:[0,1,1] op_sel_hi:[1,1,1]
  v_pk_fma_f32 v[106:107], v[106:107], v[96:97], v[96:97] op_sel:[0,1,1] op_sel_hi:[1,1,1]
  v_rcp_f32 v100, v100
  v_rcp_f32 v101, v101
  v_rcp_f32 v102, v102
  v_rcp_f32 v103, v103
  v_rcp_f32 v104, v104
  v_rcp_f32 v105, v105
  v_rcp_f32 v106, v106
  v_rcp_f32 v107, v107
  v_pk_mul_f32 v[192:193], v[192:193], v[100:101]
  v_pk_mul_f32 v[194:195], v[194:195], v[102:103]
  v_pk_mul_f32 v[208:209], v[208:209], v[104:105]
  v_pk_mul_f32 v[210:211], v[210:211], v[106:107]
  v_cvt_pk_bf16_f32 v116, v192, v193
  v_cvt_pk_bf16_f32 v117, v194, v195
  v_cvt_pk_bf16_f32 v118, v208, v209
  v_cvt_pk_bf16_f32 v119, v210, v211
  buffer_store_dwordx4 v[116:119], v0, s[40:43], s6 offen offset:0 sc0 sc1
  ds_write_b128 v0, v[116:119] offset:32768
  v_pk_fma_f32 v[100:101], v[64:65], v[90:91], v[68:69] op_sel:[0,1,0] op_sel_hi:[1,1,1] neg_lo:[0,1,0] neg_hi:[0,1,0]
  v_pk_fma_f32 v[102:103], v[66:67], v[90:91], v[70:71] op_sel:[0,1,0] op_sel_hi:[1,1,1] neg_lo:[0,1,0] neg_hi:[0,1,0]
  v_pk_fma_f32 v[104:105], v[72:73], v[90:91], v[76:77] op_sel:[0,1,0] op_sel_hi:[1,1,1] neg_lo:[0,1,0] neg_hi:[0,1,0]
  v_pk_fma_f32 v[106:107], v[74:75], v[90:91], v[78:79] op_sel:[0,1,0] op_sel_hi:[1,1,1] neg_lo:[0,1,0] neg_hi:[0,1,0]
  v_pk_fma_f32 v[196:197], v[196:197], v[90:91], v[100:101] op_sel:[0,0,0] op_sel_hi:[1,0,1]
  v_pk_fma_f32 v[198:199], v[198:199], v[90:91], v[102:103] op_sel:[0,0,0] op_sel_hi:[1,0,1]
  v_pk_fma_f32 v[212:213], v[212:213], v[90:91], v[104:105] op_sel:[0,0,0] op_sel_hi:[1,0,1]
  v_pk_fma_f32 v[214:215], v[214:215], v[90:91], v[106:107] op_sel:[0,0,0] op_sel_hi:[1,0,1]
  v_pk_fma_f32 v[100:101], v[196:197], v[196:197], v[96:97] op_sel_hi:[1,1,0]
  v_pk_fma_f32 v[102:103], v[198:199], v[198:199], v[96:97] op_sel_hi:[1,1,0]
  v_pk_fma_f32 v[104:105], v[212:213], v[212:213], v[96:97] op_sel_hi:[1,1,0]
  v_pk_fma_f32 v[106:107], v[214:215], v[214:215], v[96:97] op_sel_hi:[1,1,0]
  v_pk_mul_f32 v[100:101], v[100:101], v[196:197] neg_lo:[0,1] neg_hi:[0,1]
  v_pk_mul_f32 v[102:103], v[102:103], v[198:199] neg_lo:[0,1] neg_hi:[0,1]
  v_pk_mul_f32 v[104:105], v[104:105], v[212:213] neg_lo:[0,1] neg_hi:[0,1]
  v_pk_mul_f32 v[106:107], v[106:107], v[214:215] neg_lo:[0,1] neg_hi:[0,1]
  v_exp_f32 v100, v100
  v_exp_f32 v101, v101
  v_exp_f32 v102, v102
  v_exp_f32 v103, v103
  v_exp_f32 v104, v104
  v_exp_f32 v105, v105
  v_exp_f32 v106, v106
  v_exp_f32 v107, v107
  v_pk_fma_f32 v[100:101], v[100:101], v[96:97], v[96:97] op_sel:[0,1,1] op_sel_hi:[1,1,1]
  v_pk_fma_f32 v[102:103], v[102:103], v[96:97], v[96:97] op_sel:[0,1,1] op_sel_hi:[1,1,1]
  v_pk_fma_f32 v[104:105], v[104:105], v[96:97], v[96:97] op_sel:[0,1,1] op_sel_hi:[1,1,1]
  v_pk_fma_f32 v[106:107], v[106:107], v[96:97], v[96:97] op_sel:[0,1,1] op_sel_hi:[1,1,1]
  v_rcp_f32 v100, v100
  v_rcp_f32 v101, v101
  v_rcp_f32 v102, v102
  v_rcp_f32 v103, v103
  v_rcp_f32 v104, v104
  v_rcp_f32 v105, v105
  v_rcp_f32 v106, v106
  v_rcp_f32 v107, v107
  v_pk_mul_f32 v[196:197], v[196:197], v[100:101]
  v_pk_mul_f32 v[198:199], v[198:199], v[102:103]
  v_pk_mul_f32 v[212:213], v[212:213], v[104:105]
  v_pk_mul_f32 v[214:215], v[214:215], v[106:107]
  v_cvt_pk_bf16_f32 v120, v196, v197
  v_cvt_pk_bf16_f32 v121, v198, v199
  v_cvt_pk_bf16_f32 v122, v212, v213
  v_cvt_pk_bf16_f32 v123, v214, v215
  buffer_store_dwordx4 v[120:123], v0, s[40:43], s6 offen offset:2048 sc0 sc1
  ds_write_b128 v0, v[120:123] offset:34816
  v_pk_fma_f32 v[100:101], v[64:65], v[92:93], v[68:69] op_sel:[0,1,0] op_sel_hi:[1,1,1] neg_lo:[0,1,0] neg_hi:[0,1,0]
  v_pk_fma_f32 v[102:103], v[66:67], v[92:93], v[70:71] op_sel:[0,1,0] op_sel_hi:[1,1,1] neg_lo:[0,1,0] neg_hi:[0,1,0]
  v_pk_fma_f32 v[104:105], v[72:73], v[92:93], v[76:77] op_sel:[0,1,0] op_sel_hi:[1,1,1] neg_lo:[0,1,0] neg_hi:[0,1,0]
  v_pk_fma_f32 v[106:107], v[74:75], v[92:93], v[78:79] op_sel:[0,1,0] op_sel_hi:[1,1,1] neg_lo:[0,1,0] neg_hi:[0,1,0]
  v_pk_fma_f32 v[200:201], v[200:201], v[92:93], v[100:101] op_sel:[0,0,0] op_sel_hi:[1,0,1]
  v_pk_fma_f32 v[202:203], v[202:203], v[92:93], v[102:103] op_sel:[0,0,0] op_sel_hi:[1,0,1]
  v_pk_fma_f32 v[216:217], v[216:217], v[92:93], v[104:105] op_sel:[0,0,0] op_sel_hi:[1,0,1]
  v_pk_fma_f32 v[218:219], v[218:219], v[92:93], v[106:107] op_sel:[0,0,0] op_sel_hi:[1,0,1]
  v_pk_fma_f32 v[100:101], v[200:201], v[200:201], v[96:97] op_sel_hi:[1,1,0]
  v_pk_fma_f32 v[102:103], v[202:203], v[202:203], v[96:97] op_sel_hi:[1,1,0]
  v_pk_fma_f32 v[104:105], v[216:217], v[216:217], v[96:97] op_sel_hi:[1,1,0]
  v_pk_fma_f32 v[106:107], v[218:219], v[218:219], v[96:97] op_sel_hi:[1,1,0]
  v_pk_mul_f32 v[100:101], v[100:101], v[200:201] neg_lo:[0,1] neg_hi:[0,1]
  v_pk_mul_f32 v[102:103], v[102:103], v[202:203] neg_lo:[0,1] neg_hi:[0,1]
  v_pk_mul_f32 v[104:105], v[104:105], v[216:217] neg_lo:[0,1] neg_hi:[0,1]
  v_pk_mul_f32 v[106:107], v[106:107], v[218:219] neg_lo:[0,1] neg_hi:[0,1]
  v_exp_f32 v100, v100
  v_exp_f32 v101, v101
  v_exp_f32 v102, v102
  v_exp_f32 v103, v103
  v_exp_f32 v104, v104
  v_exp_f32 v105, v105
  v_exp_f32 v106, v106
  v_exp_f32 v107, v107
  v_pk_fma_f32 v[100:101], v[100:101], v[96:97], v[96:97] op_sel:[0,1,1] op_sel_hi:[1,1,1]
  v_pk_fma_f32 v[102:103], v[102:103], v[96:97], v[96:97] op_sel:[0,1,1] op_sel_hi:[1,1,1]
  v_pk_fma_f32 v[104:105], v[104:105], v[96:97], v[96:97] op_sel:[0,1,1] op_sel_hi:[1,1,1]
  v_pk_fma_f32 v[106:107], v[106:107], v[96:97], v[96:97] op_sel:[0,1,1] op_sel_hi:[1,1,1]
  v_rcp_f32 v100, v100
  v_rcp_f32 v101, v101
  v_rcp_f32 v102, v102
  v_rcp_f32 v103, v103
  v_rcp_f32 v104, v104
  v_rcp_f32 v105, v105
  v_rcp_f32 v106, v106
  v_rcp_f32 v107, v107
  v_pk_mul_f32 v[200:201], v[200:201], v[100:101]
  v_pk_mul_f32 v[202:203], v[202:203], v[102:103]
  v_pk_mul_f32 v[216:217], v[216:217], v[104:105]
  v_pk_mul_f32 v[218:219], v[218:219], v[106:107]
  v_cvt_pk_bf16_f32 v116, v200, v201
  v_cvt_pk_bf16_f32 v117, v202, v203
  v_cvt_pk_bf16_f32 v118, v216, v217
  v_cvt_pk_bf16_f32 v119, v218, v219
  buffer_store_dwordx4 v[116:119], v0, s[40:43], s7 offen offset:0 sc0 sc1
  ds_write_b128 v0, v[116:119] offset:36864
  v_pk_fma_f32 v[100:101], v[64:65], v[94:95], v[68:69] op_sel:[0,1,0] op_sel_hi:[1,1,1] neg_lo:[0,1,0] neg_hi:[0,1,0]
  v_pk_fma_f32 v[102:103], v[66:67], v[94:95], v[70:71] op_sel:[0,1,0] op_sel_hi:[1,1,1] neg_lo:[0,1,0] neg_hi:[0,1,0]
  v_pk_fma_f32 v[104:105], v[72:73], v[94:95], v[76:77] op_sel:[0,1,0] op_sel_hi:[1,1,1] neg_lo:[0,1,0] neg_hi:[0,1,0]
  v_pk_fma_f32 v[106:107], v[74:75], v[94:95], v[78:79] op_sel:[0,1,0] op_sel_hi:[1,1,1] neg_lo:[0,1,0] neg_hi:[0,1,0]
  v_pk_fma_f32 v[204:205], v[204:205], v[94:95], v[100:101] op_sel:[0,0,0] op_sel_hi:[1,0,1]
  v_pk_fma_f32 v[206:207], v[206:207], v[94:95], v[102:103] op_sel:[0,0,0] op_sel_hi:[1,0,1]
  v_pk_fma_f32 v[220:221], v[220:221], v[94:95], v[104:105] op_sel:[0,0,0] op_sel_hi:[1,0,1]
  v_pk_fma_f32 v[222:223], v[222:223], v[94:95], v[106:107] op_sel:[0,0,0] op_sel_hi:[1,0,1]
  v_pk_fma_f32 v[100:101], v[204:205], v[204:205], v[96:97] op_sel_hi:[1,1,0]
  v_pk_fma_f32 v[102:103], v[206:207], v[206:207], v[96:97] op_sel_hi:[1,1,0]
  v_pk_fma_f32 v[104:105], v[220:221], v[220:221], v[96:97] op_sel_hi:[1,1,0]
  v_pk_fma_f32 v[106:107], v[222:223], v[222:223], v[96:97] op_sel_hi:[1,1,0]
  v_pk_mul_f32 v[100:101], v[100:101], v[204:205] neg_lo:[0,1] neg_hi:[0,1]
  v_pk_mul_f32 v[102:103], v[102:103], v[206:207] neg_lo:[0,1] neg_hi:[0,1]
  v_pk_mul_f32 v[104:105], v[104:105], v[220:221] neg_lo:[0,1] neg_hi:[0,1]
  v_pk_mul_f32 v[106:107], v[106:107], v[222:223] neg_lo:[0,1] neg_hi:[0,1]
  v_exp_f32 v100, v100
  v_exp_f32 v101, v101
  v_exp_f32 v102, v102
  v_exp_f32 v103, v103
  v_exp_f32 v104, v104
  v_exp_f32 v105, v105
  v_exp_f32 v106, v106
  v_exp_f32 v107, v107
  v_pk_fma_f32 v[100:101], v[100:101], v[96:97], v[96:97] op_sel:[0,1,1] op_sel_hi:[1,1,1]
  v_pk_fma_f32 v[102:103], v[102:103], v[96:97], v[96:97] op_sel:[0,1,1] op_sel_hi:[1,1,1]
  v_pk_fma_f32 v[104:105], v[104:105], v[96:97], v[96:97] op_sel:[0,1,1] op_sel_hi:[1,1,1]
  v_pk_fma_f32 v[106:107], v[106:107], v[96:97], v[96:97] op_sel:[0,1,1] op_sel_hi:[1,1,1]
  v_rcp_f32 v100, v100
  v_rcp_f32 v101, v101
  v_rcp_f32 v102, v102
  v_rcp_f32 v103, v103
  v_rcp_f32 v104, v104
  v_rcp_f32 v105, v105
  v_rcp_f32 v106, v106
  v_rcp_f32 v107, v107
  v_pk_mul_f32 v[204:205], v[204:205], v[100:101]
  v_pk_mul_f32 v[206:207], v[206:207], v[102:103]
  v_pk_mul_f32 v[220:221], v[220:221], v[104:105]
  v_pk_mul_f32 v[222:223], v[222:223], v[106:107]
  v_cvt_pk_bf16_f32 v120, v204, v205
  v_cvt_pk_bf16_f32 v121, v206, v207
  v_cvt_pk_bf16_f32 v122, v220, v221
  v_cvt_pk_bf16_f32 v123, v222, v223
  buffer_store_dwordx4 v[120:123], v0, s[40:43], s7 offen offset:2048 sc0 sc1
  ds_write_b128 v0, v[120:123] offset:38912
  s_mov_b32 s16, Lz1-Lz0+0
  s_mov_b32 s17, 16384
  s_mov_b32 s18, 0xffff4000
  s_mov_b32 s19, 32768
  s_mov_b32 s20, 16384
  s_mov_b32 s21, 0xffff0000
  s_mul_i32 s4, s85, 8192
  v_add_u32_e64 v4, s4, v11
  v_add_u32 v5, 1024, v4
  s_lshl_b32 s4, s86, 1
  v_xor_b32 v2, s4, v26
  v_lshl_add_u32 v6, v2, 5, v25
  v_add_u32 v6, s19, v6
  s_add_u32 s4, s4, 1
  v_xor_b32_e64 v2, s4, v26
  v_lshl_add_u32 v7, v2, 5, v25
  v_add_u32_e64 v7, s19, v7
  s_mov_b32 s4, 0xffff0000
  v_lshlrev_b32 v128, 16, v240
  v_and_b32 v129, s4, v240
  v_lshlrev_b32 v130, 16, v241
  v_and_b32 v131, s4, v241
  v_lshlrev_b32 v132, 16, v242
  v_and_b32 v133, s4, v242
  v_lshlrev_b32 v134, 16, v243
  v_and_b32 v135, s4, v243
  v_lshlrev_b32 v136, 16, v244
  v_and_b32 v137, s4, v244
  v_lshlrev_b32 v138, 16, v245
  v_and_b32 v139, s4, v245
  v_lshlrev_b32 v140, 16, v246
  v_and_b32 v141, s4, v246
  v_lshlrev_b32 v142, 16, v247
  v_and_b32 v143, s4, v247
  v_lshlrev_b32 v144, 16, v248
  v_and_b32 v145, s4, v248
  v_lshlrev_b32 v146, 16, v249
  v_and_b32 v147, s4, v249
  v_lshlrev_b32 v148, 16, v250
  v_and_b32 v149, s4, v250
  v_lshlrev_b32 v150, 16, v251
  v_and_b32 v151, s4, v251
  v_lshlrev_b32 v152, 16, v252
  v_and_b32 v153, s4, v252
  v_lshlrev_b32 v154, 16, v253
  v_and_b32 v155, s4, v253
  v_lshlrev_b32 v156, 16, v254
  v_and_b32 v157, s4, v254
  v_lshlrev_b32 v158, 16, v255
  v_and_b32 v159, s4, v255
  s_lshl_b32 s5, s86, Lz1-Lz0+7
  s_add_u32 s5, s5, 156160
  v_add_u32_e64 v3, s5, v29
  ds_read_b128 v[32:35], v3
  ds_read_b128 v[36:39], v3 offset:64
  v_mov_b64 v[160:161], 0
  v_mov_b64 v[162:163], 0
  v_mov_b64 v[164:165], 0
  v_mov_b64 v[166:167], 0
  v_mov_b64 v[168:169], 0
  v_mov_b64 v[170:171], 0
  v_mov_b64 v[172:173], 0
  v_mov_b64 v[174:175], 0
  v_mov_b64 v[176:177], 0
  v_mov_b64 v[178:179], 0
  v_mov_b64 v[180:181], 0
  v_mov_b64 v[182:183], 0
  v_mov_b64 v[184:185], 0
  v_mov_b64 v[186:187], 0
  v_mov_b64_e64 v[188:189], 0
  v_mov_b64 v[190:191], 0
  s_waitcnt lgkmcnt(0)
  v_pk_add_f32 v[128:129], v[128:129], v[32:33]
  v_pk_add_f32 v[130:131], v[130:131], v[34:35]
  v_pk_add_f32 v[132:133], v[132:133], v[36:37]
  v_pk_add_f32 v[134:135], v[134:135], v[38:39]
  v_pk_add_f32 v[136:137], v[136:137], v[32:33]
  v_pk_add_f32 v[138:139], v[138:139], v[34:35]
  v_pk_add_f32 v[140:141], v[140:141], v[36:37]
  v_pk_add_f32 v[142:143], v[142:143], v[38:39]
  v_pk_add_f32 v[144:145], v[144:145], v[32:33]
  v_pk_add_f32 v[146:147], v[146:147], v[34:35]
  v_pk_add_f32 v[148:149], v[148:149], v[36:37]
  v_pk_add_f32 v[150:151], v[150:151], v[38:39]
  v_pk_add_f32 v[152:153], v[152:153], v[32:33]
  v_pk_add_f32 v[154:155], v[154:155], v[34:35]
  v_pk_add_f32 v[156:157], v[156:157], v[36:37]
  v_pk_add_f32 v[158:159], v[158:159], v[38:39]
  s_lshl_b32 s8, s84, Lz1-Lz0+3
  s_lshl_b32 s7, s81, 12
  s_add_u32 s8, s8, s7
  s_xor_b32 s6, s8, 131072
  s_add_u32 s6, s6, 26214400
  s_add_u32 s8, s8, 26214400
  s_mov_b32 s22, 12
  s_barrier
  ds_read_b64_tr_b16 v[48:49], v6 offset:0
  ds_read_b64_tr_b16 v[50:51], v6 offset:2048
  ds_read_b128 v[32:35], v4 offset:0
  ds_read_b128 v[36:39], v4 offset:2048
  ds_read_b128 v[40:43], v4 offset:4096
  ds_read_b128 v[44:47], v4 offset:6144
  ds_read_b64_tr_b16 v[52:53], v7 offset:0
  ds_read_b64_tr_b16 v[54:55], v7 offset:2048
  ds_read_b64_tr_b16 v[56:57], v6 offset:8192
  ds_read_b64_tr_b16 v[58:59], v6 offset:10240
  ds_read_b64_tr_b16 v[60:61], v7 offset:8192
  ds_read_b64_tr_b16 v[62:63], v7 offset:10240
  ds_read_b64_tr_b16 v[80:81], v6 offset:4096
  s_nop 0
  s_waitcnt lgkmcnt(4)
  ds_read_b64_tr_b16 v[82:83], v6 offset:6144
  ds_read_b128 v[64:67], v5 offset:0
  ds_read_b128 v[68:71], v5 offset:2048
  ds_read_b128 v[72:75], v5 offset:4096
  ds_read_b128 v[76:79], v5 offset:6144
  ds_read_b64_tr_b16 v[84:85], v7 offset:4096
  ds_read_b64_tr_b16 v[86:87], v7 offset:6144
  ds_read_b64_tr_b16 v[88:89], v6 offset:12288
  ds_read_b64_tr_b16 v[90:91], v6 offset:14336
  ds_read_b64_tr_b16 v[92:93], v7 offset:12288
  ds_read_b64_tr_b16 v[94:95], v7 offset:14336
  s_add_u32 s16, s16, s17
  s_cmp_eq_u32 s16, 65536
  s_cselect_b32 s23, s18, s17
  s_cselect_b32 s16, 0, s16
  v_add_u32 v4, s23, v4
  v_add_u32 v5, s23, v5
  s_add_u32 s19, s19, s20
  s_cmp_eq_u32 s19, 81920
  s_cselect_b32 s23, s21, s20
  s_cselect_b32 s19, 0, s19
  v_add_u32 v6, s23, v6
  v_add_u32 v7, s23, v7
  s_waitcnt lgkmcnt(0)
Lk_26:
  s_barrier
  v_mfma_f32_16x16x32_bf16 v[128:131], v[48:51], v[32:35], v[128:131]
  ds_read_b64_tr_b16 v[112:113], v6 offset:0
  v_mfma_f32_16x16x32_bf16 v[128:131], v[80:83], v[64:67], v[128:131]
  ds_read_b64_tr_b16 v[114:115], v6 offset:2048
  v_mfma_f32_16x16x32_bf16 v[136:139], v[48:51], v[36:39], v[136:139]
  ds_read_b128 v[96:99], v4 offset:0
  v_mfma_f32_16x16x32_bf16 v[136:139], v[80:83], v[68:71], v[136:139]
  ds_read_b128 v[100:103], v4 offset:2048
  v_mfma_f32_16x16x32_bf16 v[144:147], v[48:51], v[40:43], v[144:147]
  ds_read_b128 v[104:107], v4 offset:4096
  v_mfma_f32_16x16x32_bf16 v[144:147], v[80:83], v[72:75], v[144:147]
  ds_read_b128 v[108:111], v4 offset:6144
  v_mfma_f32_16x16x32_bf16 v[152:155], v[48:51], v[44:47], v[152:155]
  ds_read_b64_tr_b16 v[116:117], v7 offset:0
  v_mfma_f32_16x16x32_bf16 v[152:155], v[80:83], v[76:79], v[152:155]
  ds_read_b64_tr_b16 v[118:119], v7 offset:2048
  v_mfma_f32_16x16x32_bf16 v[132:135], v[52:55], v[32:35], v[132:135]
  ds_read_b64_tr_b16 v[120:121], v6 offset:8192
  v_mfma_f32_16x16x32_bf16 v[132:135], v[84:87], v[64:67], v[132:135]
  ds_read_b64_tr_b16 v[122:123], v6 offset:10240
  v_mfma_f32_16x16x32_bf16 v[140:143], v[52:55], v[36:39], v[140:143]
  ds_read_b64_tr_b16 v[124:125], v7 offset:8192
  v_mfma_f32_16x16x32_bf16 v[140:143], v[84:87], v[68:71], v[140:143]
  ds_read_b64_tr_b16 v[126:127], v7 offset:10240
  v_mfma_f32_16x16x32_bf16 v[148:151], v[52:55], v[40:43], v[148:151]
  ds_read_b64_tr_b16 v[208:209], v6 offset:4096
  v_mfma_f32_16x16x32_bf16 v[148:151], v[84:87], v[72:75], v[148:151]
  ds_read_b64_tr_b16 v[210:211], v6 offset:6144
  v_mfma_f32_16x16x32_bf16 v[156:159], v[52:55], v[44:47], v[156:159]
  ds_read_b128 v[192:195], v5 offset:0
  v_mfma_f32_16x16x32_bf16 v[156:159], v[84:87], v[76:79], v[156:159]
  ds_read_b128 v[196:199], v5 offset:2048
  v_mfma_f32_16x16x32_bf16 v[160:163], v[56:59], v[32:35], v[160:163]
  ds_read_b128 v[200:203], v5 offset:4096
  v_mfma_f32_16x16x32_bf16 v[160:163], v[88:91], v[64:67], v[160:163]
  ds_read_b128 v[204:207], v5 offset:6144
  v_mfma_f32_16x16x32_bf16 v[168:171], v[56:59], v[36:39], v[168:171]
  ds_read_b64_tr_b16 v[212:213], v7 offset:4096
  v_mfma_f32_16x16x32_bf16 v[168:171], v[88:91], v[68:71], v[168:171]
  ds_read_b64_tr_b16 v[214:215], v7 offset:6144
  v_mfma_f32_16x16x32_bf16 v[176:179], v[56:59], v[40:43], v[176:179]
  ds_read_b64_tr_b16 v[216:217], v6 offset:12288
  v_mfma_f32_16x16x32_bf16 v[176:179], v[88:91], v[72:75], v[176:179]
  ds_read_b64_tr_b16 v[218:219], v6 offset:14336
  v_mfma_f32_16x16x32_bf16 v[184:187], v[56:59], v[44:47], v[184:187]
  ds_read_b64_tr_b16 v[220:221], v7 offset:12288
  v_mfma_f32_16x16x32_bf16 v[184:187], v[88:91], v[76:79], v[184:187]
  ds_read_b64_tr_b16 v[222:223], v7 offset:14336
  v_mfma_f32_16x16x32_bf16 v[164:167], v[60:63], v[32:35], v[164:167]
  s_add_u32 s16, s16, s17
  s_cmp_eq_u32 s16, 65536
  s_cselect_b32 s23, s18, s17
  v_mfma_f32_16x16x32_bf16 v[164:167], v[92:95], v[64:67], v[164:167]
  s_cselect_b32 s16, 0, s16
  v_add_u32 v4, s23, v4
  v_add_u32_e64 v5, s23, v5
  v_mfma_f32_16x16x32_bf16 v[172:175], v[60:63], v[36:39], v[172:175]
  s_add_u32 s19, s19, s20
  s_cmp_eq_u32 s19, 81920
  s_cselect_b32 s23, s21, s20
  v_mfma_f32_16x16x32_bf16 v[172:175], v[92:95], v[68:71], v[172:175]
  s_cselect_b32 s19, 0, s19
  v_add_u32 v6, s23, v6
  v_add_u32_e64 v7, s23, v7
  v_mfma_f32_16x16x32_bf16 v[180:183], v[60:63], v[40:43], v[180:183]
  v_mfma_f32_16x16x32_bf16 v[180:183], v[92:95], v[72:75], v[180:183]
  v_mfma_f32_16x16x32_bf16 v[188:191], v[60:63], v[44:47], v[188:191]
  s_nop 0
  s_waitcnt lgkmcnt(0)
  v_mfma_f32_16x16x32_bf16 v[188:191], v[92:95], v[76:79], v[188:191]
  s_waitcnt vmcnt(0)
  s_barrier
  v_mfma_f32_16x16x32_bf16 v[128:131], v[112:115], v[96:99], v[128:131]
  ds_read_b64_tr_b16 v[48:49], v6 offset:0
  v_mfma_f32_16x16x32_bf16 v[128:131], v[208:211], v[192:195], v[128:131]
  ds_read_b64_tr_b16 v[50:51], v6 offset:2048
  v_mfma_f32_16x16x32_bf16 v[136:139], v[112:115], v[100:103], v[136:139]
  ds_read_b128 v[32:35], v4 offset:0
  v_mfma_f32_16x16x32_bf16 v[136:139], v[208:211], v[196:199], v[136:139]
  ds_read_b128 v[36:39], v4 offset:2048
  v_mfma_f32_16x16x32_bf16 v[144:147], v[112:115], v[104:107], v[144:147]
  ds_read_b128 v[40:43], v4 offset:4096
  v_mfma_f32_16x16x32_bf16 v[144:147], v[208:211], v[200:203], v[144:147]
  ds_read_b128 v[44:47], v4 offset:6144
  v_mfma_f32_16x16x32_bf16 v[152:155], v[112:115], v[108:111], v[152:155]
  ds_read_b64_tr_b16 v[52:53], v7 offset:0
  v_mfma_f32_16x16x32_bf16 v[152:155], v[208:211], v[204:207], v[152:155]
  ds_read_b64_tr_b16 v[54:55], v7 offset:2048
  v_mfma_f32_16x16x32_bf16 v[132:135], v[116:119], v[96:99], v[132:135]
  ds_read_b64_tr_b16 v[56:57], v6 offset:8192
  v_mfma_f32_16x16x32_bf16 v[132:135], v[212:215], v[192:195], v[132:135]
  ds_read_b64_tr_b16 v[58:59], v6 offset:10240
  v_mfma_f32_16x16x32_bf16 v[140:143], v[116:119], v[100:103], v[140:143]
  ds_read_b64_tr_b16 v[60:61], v7 offset:8192
  v_mfma_f32_16x16x32_bf16 v[140:143], v[212:215], v[196:199], v[140:143]
  ds_read_b64_tr_b16 v[62:63], v7 offset:10240
  v_mfma_f32_16x16x32_bf16 v[148:151], v[116:119], v[104:107], v[148:151]
  ds_read_b64_tr_b16 v[80:81], v6 offset:4096
  v_mfma_f32_16x16x32_bf16 v[148:151], v[212:215], v[200:203], v[148:151]
  ds_read_b64_tr_b16 v[82:83], v6 offset:6144
  v_mfma_f32_16x16x32_bf16 v[156:159], v[116:119], v[108:111], v[156:159]
  ds_read_b128 v[64:67], v5 offset:0
  v_mfma_f32_16x16x32_bf16 v[156:159], v[212:215], v[204:207], v[156:159]
  ds_read_b128 v[68:71], v5 offset:2048
  v_mfma_f32_16x16x32_bf16 v[160:163], v[120:123], v[96:99], v[160:163]
  ds_read_b128 v[72:75], v5 offset:4096
  v_mfma_f32_16x16x32_bf16 v[160:163], v[216:219], v[192:195], v[160:163]
  ds_read_b128 v[76:79], v5 offset:6144
  v_mfma_f32_16x16x32_bf16 v[168:171], v[120:123], v[100:103], v[168:171]
  ds_read_b64_tr_b16 v[84:85], v7 offset:4096
  v_mfma_f32_16x16x32_bf16 v[168:171], v[216:219], v[196:199], v[168:171]
  ds_read_b64_tr_b16 v[86:87], v7 offset:6144
  v_mfma_f32_16x16x32_bf16 v[176:179], v[120:123], v[104:107], v[176:179]
  ds_read_b64_tr_b16 v[88:89], v6 offset:12288
  v_mfma_f32_16x16x32_bf16 v[176:179], v[216:219], v[200:203], v[176:179]
  ds_read_b64_tr_b16 v[90:91], v6 offset:14336
  v_mfma_f32_16x16x32_bf16 v[184:187], v[120:123], v[108:111], v[184:187]
  ds_read_b64_tr_b16 v[92:93], v7 offset:12288
  v_mfma_f32_16x16x32_bf16 v[184:187], v[216:219], v[204:207], v[184:187]
  ds_read_b64_tr_b16 v[94:95], v7 offset:14336
  v_mfma_f32_16x16x32_bf16 v[164:167], v[124:127], v[96:99], v[164:167]
  s_add_u32 s16, s16, s17
  s_cmp_eq_u32 s16, 65536
  s_cselect_b32 s23, s18, s17
  v_mfma_f32_16x16x32_bf16 v[164:167], v[220:223], v[192:195], v[164:167]
  s_cselect_b32 s16, 0, s16
  v_add_u32 v4, s23, v4
  v_add_u32_e64 v5, s23, v5
  v_mfma_f32_16x16x32_bf16 v[172:175], v[124:127], v[100:103], v[172:175]
  s_add_u32 s19, s19, s20
  s_cmp_eq_u32 s19, 81920
  s_cselect_b32 s23, s21, s20
  v_mfma_f32_16x16x32_bf16 v[172:175], v[220:223], v[196:199], v[172:175]
  s_cselect_b32 s19, 0, s19
  v_add_u32 v6, s23, v6
  v_add_u32_e64 v7, s23, v7
  v_mfma_f32_16x16x32_bf16 v[180:183], v[124:127], v[104:107], v[180:183]
  s_sub_u32 s22, s22, 1
  s_cmp_lg_u32 s22, 0
  v_mfma_f32_16x16x32_bf16 v[180:183], v[220:223], v[200:203], v[180:183]
  v_mfma_f32_16x16x32_bf16 v[188:191], v[124:127], v[108:111], v[188:191]
  s_waitcnt lgkmcnt(0)
  v_mfma_f32_16x16x32_bf16 v[188:191], v[220:223], v[204:207], v[188:191]
  s_cbranch_scc1 Lk_26
  v_cvt_pk_bf16_f32 v160, v160, v161
  v_cvt_pk_bf16_f32 v161, v162, v163
  v_cvt_pk_bf16_f32 v162, v164, v165
  v_cvt_pk_bf16_f32 v163, v166, v167
  buffer_store_dwordx4 v[160:163], v11, s[40:43], s6 offen offset:0 sc0 sc1
  v_cvt_pk_bf16_f32 v164, v168, v169
  v_cvt_pk_bf16_f32 v165, v170, v171
  v_cvt_pk_bf16_f32 v166, v172, v173
  v_cvt_pk_bf16_f32 v167, v174, v175
  buffer_store_dwordx4 v[164:167], v11, s[40:43], s6 offen offset:1024 sc0 sc1
  v_cvt_pk_bf16_f32 v168, v176, v177
  v_cvt_pk_bf16_f32 v169, v178, v179
  v_cvt_pk_bf16_f32 v170, v180, v181
  v_cvt_pk_bf16_f32 v171, v182, v183
  buffer_store_dwordx4 v[168:171], v11, s[40:43], s6 offen offset:2048 sc0 sc1
  v_cvt_pk_bf16_f32 v172, v184, v185
  v_cvt_pk_bf16_f32 v173, v186, v187
  v_cvt_pk_bf16_f32 v174, v188, v189
  v_cvt_pk_bf16_f32 v175, v190, v191
  buffer_store_dwordx4 v[172:175], v11, s[40:43], s6 offen offset:3072 sc0 sc1
  s_nop 0
  s_barrier
  v_mfma_f32_16x16x32_bf16 v[128:131], v[48:51], v[32:35], v[128:131]
  ds_read_b64_tr_b16 v[112:113], v6 offset:0
  ds_read_b64_tr_b16 v[114:115], v6 offset:2048
  v_mfma_f32_16x16x32_bf16 v[128:131], v[80:83], v[64:67], v[128:131]
  ds_read_b128 v[96:99], v4 offset:0
  ds_read_b128 v[100:103], v4 offset:2048
  v_mfma_f32_16x16x32_bf16 v[136:139], v[48:51], v[36:39], v[136:139]
  ds_read_b128 v[104:107], v4 offset:4096
  ds_read_b128 v[108:111], v4 offset:6144
  v_mfma_f32_16x16x32_bf16 v[136:139], v[80:83], v[68:71], v[136:139]
  ds_read_b64_tr_b16 v[116:117], v7 offset:0
  ds_read_b64_tr_b16 v[118:119], v7 offset:2048
  v_mfma_f32_16x16x32_bf16 v[144:147], v[48:51], v[40:43], v[144:147]
  ds_read_b64_tr_b16 v[208:209], v6 offset:4096
  ds_read_b64_tr_b16 v[210:211], v6 offset:6144
  v_mfma_f32_16x16x32_bf16 v[144:147], v[80:83], v[72:75], v[144:147]
  ds_read_b128 v[192:195], v5 offset:0
  ds_read_b128 v[196:199], v5 offset:2048
  v_mfma_f32_16x16x32_bf16 v[152:155], v[48:51], v[44:47], v[152:155]
  ds_read_b128 v[200:203], v5 offset:4096
  ds_read_b128 v[204:207], v5 offset:6144
  v_mfma_f32_16x16x32_bf16 v[152:155], v[80:83], v[76:79], v[152:155]
  ds_read_b64_tr_b16 v[212:213], v7 offset:4096
  ds_read_b64_tr_b16 v[214:215], v7 offset:6144
  v_mfma_f32_16x16x32_bf16 v[132:135], v[52:55], v[32:35], v[132:135]
  s_nop 0
  s_add_u32 s16, s16, s17
  s_cmp_eq_u32 s16, 65536
  v_mfma_f32_16x16x32_bf16 v[132:135], v[84:87], v[64:67], v[132:135]
  s_cselect_b32 s23, s18, s17
  s_cselect_b32 s16, 0, s16
  v_mfma_f32_16x16x32_bf16 v[140:143], v[52:55], v[36:39], v[140:143]
  v_add_u32_e64 v4, s23, v4
  v_add_u32 v5, s23, v5
  v_mfma_f32_16x16x32_bf16 v[140:143], v[84:87], v[68:71], v[140:143]
  s_add_u32 s19, s19, s20
  s_cmp_eq_u32 s19, 81920
  v_mfma_f32_16x16x32_bf16 v[148:151], v[52:55], v[40:43], v[148:151]
  s_cselect_b32 s23, s21, s20
  s_cselect_b32 s19, 0, s19
  v_mfma_f32_16x16x32_bf16 v[148:151], v[84:87], v[72:75], v[148:151]
  v_add_u32 v6, s23, v6
  v_add_u32 v7, s23, v7
  v_mfma_f32_16x16x32_bf16 v[156:159], v[52:55], v[44:47], v[156:159]
  s_waitcnt lgkmcnt(0)
  v_mfma_f32_16x16x32_bf16 v[156:159], v[84:87], v[76:79], v[156:159]
  s_barrier
  v_mfma_f32_16x16x32_bf16 v[128:131], v[112:115], v[96:99], v[128:131]
  ds_read_b64_tr_b16 v[48:49], v6 offset:0
  ds_read_b64_tr_b16 v[50:51], v6 offset:2048
  v_mfma_f32_16x16x32_bf16 v[128:131], v[208:211], v[192:195], v[128:131]
  ds_read_b128 v[32:35], v4 offset:0
  ds_read_b128 v[36:39], v4 offset:2048
  v_mfma_f32_16x16x32_bf16 v[136:139], v[112:115], v[100:103], v[136:139]
  ds_read_b128 v[40:43], v4 offset:4096
  ds_read_b128 v[44:47], v4 offset:6144
  v_mfma_f32_16x16x32_bf16 v[136:139], v[208:211], v[196:199], v[136:139]
  ds_read_b64_tr_b16 v[52:53], v7 offset:0
  ds_read_b64_tr_b16 v[54:55], v7 offset:2048
  v_mfma_f32_16x16x32_bf16 v[144:147], v[112:115], v[104:107], v[144:147]
  ds_read_b64_tr_b16 v[80:81], v6 offset:4096
  ds_read_b64_tr_b16 v[82:83], v6 offset:6144
  v_mfma_f32_16x16x32_bf16 v[144:147], v[208:211], v[200:203], v[144:147]
  ds_read_b128 v[64:67], v5 offset:0
  ds_read_b128 v[68:71], v5 offset:2048
  v_mfma_f32_16x16x32_bf16 v[152:155], v[112:115], v[108:111], v[152:155]
  ds_read_b128 v[72:75], v5 offset:4096
  ds_read_b128 v[76:79], v5 offset:6144
  v_mfma_f32_16x16x32_bf16 v[152:155], v[208:211], v[204:207], v[152:155]
  ds_read_b64_tr_b16 v[84:85], v7 offset:4096
  ds_read_b64_tr_b16 v[86:87], v7 offset:6144
  v_mfma_f32_16x16x32_bf16 v[132:135], v[116:119], v[96:99], v[132:135]
  s_nop 0
  s_add_u32 s16, s16, s17
  s_cmp_eq_u32 s16, 65536
  v_mfma_f32_16x16x32_bf16 v[132:135], v[212:215], v[192:195], v[132:135]
  s_cselect_b32 s23, s18, s17
  s_cselect_b32 s16, 0, s16
  v_mfma_f32_16x16x32_bf16 v[140:143], v[116:119], v[100:103], v[140:143]
  v_add_u32_e64 v4, s23, v4
  v_add_u32 v5, s23, v5
  v_mfma_f32_16x16x32_bf16 v[140:143], v[212:215], v[196:199], v[140:143]
  s_add_u32 s19, s19, s20
  s_cmp_eq_u32 s19, 81920
  v_mfma_f32_16x16x32_bf16 v[148:151], v[116:119], v[104:107], v[148:151]
  s_cselect_b32 s23, s21, s20
  s_cselect_b32 s19, 0, s19
  v_mfma_f32_16x16x32_bf16 v[148:151], v[212:215], v[200:203], v[148:151]
  v_add_u32_e64 v6, s23, v6
  v_add_u32 v7, s23, v7
  v_mfma_f32_16x16x32_bf16 v[156:159], v[116:119], v[108:111], v[156:159]
  s_waitcnt lgkmcnt(0)
  v_mfma_f32_16x16x32_bf16 v[156:159], v[212:215], v[204:207], v[156:159]
  s_waitcnt vmcnt(0)
  s_barrier
  v_mfma_f32_16x16x32_bf16 v[128:131], v[48:51], v[32:35], v[128:131]
  ds_read_b64_tr_b16 v[112:113], v6 offset:0
  ds_read_b64_tr_b16 v[114:115], v6 offset:2048
  v_mfma_f32_16x16x32_bf16 v[128:131], v[80:83], v[64:67], v[128:131]
  ds_read_b128 v[96:99], v4 offset:0
  ds_read_b128 v[100:103], v4 offset:2048
  v_mfma_f32_16x16x32_bf16 v[136:139], v[48:51], v[36:39], v[136:139]
  ds_read_b128 v[104:107], v4 offset:4096
  ds_read_b128 v[108:111], v4 offset:6144
  v_mfma_f32_16x16x32_bf16 v[136:139], v[80:83], v[68:71], v[136:139]
  ds_read_b64_tr_b16 v[116:117], v7 offset:0
  ds_read_b64_tr_b16 v[118:119], v7 offset:2048
  v_mfma_f32_16x16x32_bf16 v[144:147], v[48:51], v[40:43], v[144:147]
  ds_read_b64_tr_b16 v[208:209], v6 offset:4096
  ds_read_b64_tr_b16 v[210:211], v6 offset:6144
  v_mfma_f32_16x16x32_bf16 v[144:147], v[80:83], v[72:75], v[144:147]
  ds_read_b128 v[192:195], v5 offset:0
  ds_read_b128 v[196:199], v5 offset:2048
  v_mfma_f32_16x16x32_bf16 v[152:155], v[48:51], v[44:47], v[152:155]
  ds_read_b128 v[200:203], v5 offset:4096
  ds_read_b128 v[204:207], v5 offset:6144
  v_mfma_f32_16x16x32_bf16 v[152:155], v[80:83], v[76:79], v[152:155]
  ds_read_b64_tr_b16 v[212:213], v7 offset:4096
  ds_read_b64_tr_b16 v[214:215], v7 offset:6144
  v_mfma_f32_16x16x32_bf16 v[132:135], v[52:55], v[32:35], v[132:135]
  s_nop 0
  s_add_u32 s16, s16, s17
  s_cmp_eq_u32 s16, 65536
  v_mfma_f32_16x16x32_bf16 v[132:135], v[84:87], v[64:67], v[132:135]
  s_cselect_b32 s23, s18, s17
  s_cselect_b32 s16, 0, s16
  v_mfma_f32_16x16x32_bf16 v[140:143], v[52:55], v[36:39], v[140:143]
  v_add_u32_e64 v4, s23, v4
  v_add_u32 v5, s23, v5
  v_mfma_f32_16x16x32_bf16 v[140:143], v[84:87], v[68:71], v[140:143]
  s_add_u32 s19, s19, s20
  s_cmp_eq_u32 s19, 81920
  v_mfma_f32_16x16x32_bf16 v[148:151], v[52:55], v[40:43], v[148:151]
  s_cselect_b32 s23, s21, s20
  s_cselect_b32 s19, 0, s19
  v_mfma_f32_16x16x32_bf16 v[148:151], v[84:87], v[72:75], v[148:151]
  v_add_u32 v6, s23, v6
  v_add_u32 v7, s23, v7
  v_mfma_f32_16x16x32_bf16 v[156:159], v[52:55], v[44:47], v[156:159]
  s_waitcnt lgkmcnt(0)
  v_mfma_f32_16x16x32_bf16 v[156:159], v[84:87], v[76:79], v[156:159]
  s_barrier
  v_mfma_f32_16x16x32_bf16 v[128:131], v[112:115], v[96:99], v[128:131]
  ds_read_b64_tr_b16 v[48:49], v6 offset:0
  ds_read_b64_tr_b16 v[50:51], v6 offset:2048
  v_mfma_f32_16x16x32_bf16 v[128:131], v[208:211], v[192:195], v[128:131]
  ds_read_b128 v[32:35], v4 offset:0
  ds_read_b128 v[36:39], v4 offset:2048
  v_mfma_f32_16x16x32_bf16 v[136:139], v[112:115], v[100:103], v[136:139]
  ds_read_b128 v[40:43], v4 offset:4096
  ds_read_b128 v[44:47], v4 offset:6144
  v_mfma_f32_16x16x32_bf16 v[136:139], v[208:211], v[196:199], v[136:139]
  ds_read_b64_tr_b16 v[52:53], v7 offset:0
  ds_read_b64_tr_b16 v[54:55], v7 offset:2048
  v_mfma_f32_16x16x32_bf16 v[144:147], v[112:115], v[104:107], v[144:147]
  ds_read_b64_tr_b16 v[80:81], v6 offset:4096
  ds_read_b64_tr_b16 v[82:83], v6 offset:6144
  v_mfma_f32_16x16x32_bf16 v[144:147], v[208:211], v[200:203], v[144:147]
  ds_read_b128 v[64:67], v5 offset:0
  ds_read_b128 v[68:71], v5 offset:2048
  v_mfma_f32_16x16x32_bf16 v[152:155], v[112:115], v[108:111], v[152:155]
  ds_read_b128 v[72:75], v5 offset:4096
  ds_read_b128 v[76:79], v5 offset:6144
  v_mfma_f32_16x16x32_bf16 v[152:155], v[208:211], v[204:207], v[152:155]
  ds_read_b64_tr_b16 v[84:85], v7 offset:4096
  ds_read_b64_tr_b16 v[86:87], v7 offset:6144
  v_mfma_f32_16x16x32_bf16 v[132:135], v[116:119], v[96:99], v[132:135]
  s_nop 0
  s_add_u32 s16, s16, s17
  s_cmp_eq_u32 s16, 65536
  v_mfma_f32_16x16x32_bf16 v[132:135], v[212:215], v[192:195], v[132:135]
  s_cselect_b32 s23, s18, s17
  s_cselect_b32 s16, 0, s16
  v_mfma_f32_16x16x32_bf16 v[140:143], v[116:119], v[100:103], v[140:143]
  v_add_u32_e64 v4, s23, v4
  v_add_u32 v5, s23, v5
  v_mfma_f32_16x16x32_bf16 v[140:143], v[212:215], v[196:199], v[140:143]
  s_add_u32 s19, s19, s20
  s_cmp_eq_u32 s19, 81920
  v_mfma_f32_16x16x32_bf16 v[148:151], v[116:119], v[104:107], v[148:151]
  s_cselect_b32 s23, s21, s20
  s_cselect_b32 s19, 0, s19
  v_mfma_f32_16x16x32_bf16 v[148:151], v[212:215], v[200:203], v[148:151]
  v_add_u32 v6, s23, v6
  v_add_u32 v7, s23, v7
  v_mfma_f32_16x16x32_bf16 v[156:159], v[116:119], v[108:111], v[156:159]
  s_waitcnt lgkmcnt(0)
  v_mfma_f32_16x16x32_bf16 v[156:159], v[212:215], v[204:207], v[156:159]
  s_barrier
  v_mfma_f32_16x16x32_bf16 v[128:131], v[48:51], v[32:35], v[128:131]
  ds_read_b64_tr_b16 v[112:113], v6 offset:0
  ds_read_b64_tr_b16 v[114:115], v6 offset:2048
  v_mfma_f32_16x16x32_bf16 v[128:131], v[80:83], v[64:67], v[128:131]
  ds_read_b128 v[96:99], v4 offset:0
  ds_read_b128 v[100:103], v4 offset:2048
  v_mfma_f32_16x16x32_bf16 v[136:139], v[48:51], v[36:39], v[136:139]
  ds_read_b128 v[104:107], v4 offset:4096
  ds_read_b128 v[108:111], v4 offset:6144
  v_mfma_f32_16x16x32_bf16 v[136:139], v[80:83], v[68:71], v[136:139]
  ds_read_b64_tr_b16 v[116:117], v7 offset:0
  ds_read_b64_tr_b16 v[118:119], v7 offset:2048
  v_mfma_f32_16x16x32_bf16 v[144:147], v[48:51], v[40:43], v[144:147]
  ds_read_b64_tr_b16 v[208:209], v6 offset:4096
  ds_read_b64_tr_b16 v[210:211], v6 offset:6144
  v_mfma_f32_16x16x32_bf16 v[144:147], v[80:83], v[72:75], v[144:147]
  ds_read_b128 v[192:195], v5 offset:0
  ds_read_b128 v[196:199], v5 offset:2048
  v_mfma_f32_16x16x32_bf16 v[152:155], v[48:51], v[44:47], v[152:155]
  ds_read_b128 v[200:203], v5 offset:4096
  ds_read_b128 v[204:207], v5 offset:6144
  v_mfma_f32_16x16x32_bf16 v[152:155], v[80:83], v[76:79], v[152:155]
  ds_read_b64_tr_b16 v[212:213], v7 offset:4096
  ds_read_b64_tr_b16 v[214:215], v7 offset:6144
  v_mfma_f32_16x16x32_bf16 v[132:135], v[52:55], v[32:35], v[132:135]
  s_nop 0
  s_add_u32 s16, s16, s17
  s_cmp_eq_u32 s16, 65536
  v_mfma_f32_16x16x32_bf16 v[132:135], v[84:87], v[64:67], v[132:135]
  s_cselect_b32 s23, s18, s17
  s_cselect_b32 s16, 0, s16
  v_mfma_f32_16x16x32_bf16 v[140:143], v[52:55], v[36:39], v[140:143]
  v_add_u32_e64 v4, s23, v4
  v_add_u32 v5, s23, v5
  v_mfma_f32_16x16x32_bf16 v[140:143], v[84:87], v[68:71], v[140:143]
  s_add_u32 s19, s19, s20
  s_cmp_eq_u32 s19, 81920
  v_mfma_f32_16x16x32_bf16 v[148:151], v[52:55], v[40:43], v[148:151]
  s_cselect_b32 s23, s21, s20
  s_cselect_b32 s19, 0, s19
  v_mfma_f32_16x16x32_bf16 v[148:151], v[84:87], v[72:75], v[148:151]
  v_add_u32 v6, s23, v6
  v_add_u32 v7, s23, v7
  v_mfma_f32_16x16x32_bf16 v[156:159], v[52:55], v[44:47], v[156:159]
  s_waitcnt lgkmcnt(0)
  v_mfma_f32_16x16x32_bf16 v[156:159], v[84:87], v[76:79], v[156:159]
  s_barrier
  v_mfma_f32_16x16x32_bf16 v[128:131], v[112:115], v[96:99], v[128:131]
  ds_read_b64_tr_b16 v[48:49], v6 offset:0
  ds_read_b64_tr_b16 v[50:51], v6 offset:2048
  v_mfma_f32_16x16x32_bf16 v[128:131], v[208:211], v[192:195], v[128:131]
  ds_read_b128 v[32:35], v4 offset:0
  ds_read_b128 v[36:39], v4 offset:2048
  v_mfma_f32_16x16x32_bf16 v[136:139], v[112:115], v[100:103], v[136:139]
  ds_read_b128 v[40:43], v4 offset:4096
  ds_read_b128 v[44:47], v4 offset:6144
  v_mfma_f32_16x16x32_bf16 v[136:139], v[208:211], v[196:199], v[136:139]
  ds_read_b64_tr_b16 v[52:53], v7 offset:0
  ds_read_b64_tr_b16 v[54:55], v7 offset:2048
  v_mfma_f32_16x16x32_bf16 v[144:147], v[112:115], v[104:107], v[144:147]
  ds_read_b64_tr_b16 v[80:81], v6 offset:4096
  ds_read_b64_tr_b16 v[82:83], v6 offset:6144
  v_mfma_f32_16x16x32_bf16 v[144:147], v[208:211], v[200:203], v[144:147]
  ds_read_b128 v[64:67], v5 offset:0
  ds_read_b128 v[68:71], v5 offset:2048
  v_mfma_f32_16x16x32_bf16 v[152:155], v[112:115], v[108:111], v[152:155]
  ds_read_b128 v[72:75], v5 offset:4096
  ds_read_b128 v[76:79], v5 offset:6144
  v_mfma_f32_16x16x32_bf16 v[152:155], v[208:211], v[204:207], v[152:155]
  ds_read_b64_tr_b16 v[84:85], v7 offset:4096
  ds_read_b64_tr_b16 v[86:87], v7 offset:6144
  v_mfma_f32_16x16x32_bf16 v[132:135], v[116:119], v[96:99], v[132:135]
  s_nop 0
  s_add_u32 s16, s16, s17
  s_cmp_eq_u32 s16, 65536
  v_mfma_f32_16x16x32_bf16 v[132:135], v[212:215], v[192:195], v[132:135]
  s_cselect_b32 s23, s18, s17
  s_cselect_b32 s16, 0, s16
  v_mfma_f32_16x16x32_bf16 v[140:143], v[116:119], v[100:103], v[140:143]
  v_add_u32_e64 v4, s23, v4
  v_add_u32 v5, s23, v5
  v_mfma_f32_16x16x32_bf16 v[140:143], v[212:215], v[196:199], v[140:143]
  s_add_u32 s19, s19, s20
  s_cmp_eq_u32 s19, 81920
  v_mfma_f32_16x16x32_bf16 v[148:151], v[116:119], v[104:107], v[148:151]
  s_cselect_b32 s23, s21, s20
  s_cselect_b32 s19, 0, s19
  v_mfma_f32_16x16x32_bf16 v[148:151], v[212:215], v[200:203], v[148:151]
  v_add_u32 v6, s23, v6
  v_add_u32 v7, s23, v7
  v_mfma_f32_16x16x32_bf16 v[156:159], v[116:119], v[108:111], v[156:159]
  s_waitcnt lgkmcnt(0)
  v_mfma_f32_16x16x32_bf16 v[156:159], v[212:215], v[204:207], v[156:159]
  s_barrier
  v_mfma_f32_16x16x32_bf16 v[128:131], v[48:51], v[32:35], v[128:131]
  ds_read_b64_tr_b16 v[112:113], v6 offset:0
  ds_read_b64_tr_b16 v[114:115], v6 offset:2048
  v_mfma_f32_16x16x32_bf16 v[128:131], v[80:83], v[64:67], v[128:131]
  ds_read_b128 v[96:99], v4 offset:0
  ds_read_b128 v[100:103], v4 offset:2048
  v_mfma_f32_16x16x32_bf16 v[136:139], v[48:51], v[36:39], v[136:139]
  ds_read_b128 v[104:107], v4 offset:4096
  ds_read_b128 v[108:111], v4 offset:6144
  v_mfma_f32_16x16x32_bf16 v[136:139], v[80:83], v[68:71], v[136:139]
  ds_read_b64_tr_b16 v[116:117], v7 offset:0
  ds_read_b64_tr_b16 v[118:119], v7 offset:2048
  v_mfma_f32_16x16x32_bf16 v[144:147], v[48:51], v[40:43], v[144:147]
  ds_read_b64_tr_b16 v[208:209], v6 offset:4096
  ds_read_b64_tr_b16 v[210:211], v6 offset:6144
  v_mfma_f32_16x16x32_bf16 v[144:147], v[80:83], v[72:75], v[144:147]
  ds_read_b128 v[192:195], v5 offset:0
  ds_read_b128 v[196:199], v5 offset:2048
  v_mfma_f32_16x16x32_bf16 v[152:155], v[48:51], v[44:47], v[152:155]
  ds_read_b128 v[200:203], v5 offset:4096
  ds_read_b128 v[204:207], v5 offset:6144
  v_mfma_f32_16x16x32_bf16 v[152:155], v[80:83], v[76:79], v[152:155]
  ds_read_b64_tr_b16 v[212:213], v7 offset:4096
  ds_read_b64_tr_b16 v[214:215], v7 offset:6144
  v_mfma_f32_16x16x32_bf16 v[132:135], v[52:55], v[32:35], v[132:135]
  buffer_load_dwordx4 v[160:163], v11, s[40:43], s8 offen offset:0 sc0 sc1
  v_mfma_f32_16x16x32_bf16 v[132:135], v[84:87], v[64:67], v[132:135]
  buffer_load_dwordx4 v[164:167], v11, s[40:43], s8 offen offset:1024 sc0 sc1
  v_mfma_f32_16x16x32_bf16 v[140:143], v[52:55], v[36:39], v[140:143]
  buffer_load_dwordx4 v[168:171], v11, s[40:43], s8 offen offset:2048 sc0 sc1
  v_mfma_f32_16x16x32_bf16 v[140:143], v[84:87], v[68:71], v[140:143]
  buffer_load_dwordx4 v[172:175], v11, s[40:43], s8 offen offset:3072 sc0 sc1
  v_mfma_f32_16x16x32_bf16 v[148:151], v[52:55], v[40:43], v[148:151]
  v_mfma_f32_16x16x32_bf16 v[148:151], v[84:87], v[72:75], v[148:151]
  v_mfma_f32_16x16x32_bf16 v[156:159], v[52:55], v[44:47], v[156:159]
  s_waitcnt lgkmcnt(0)
  v_mfma_f32_16x16x32_bf16 v[156:159], v[84:87], v[76:79], v[156:159]
  s_barrier
  v_mfma_f32_16x16x32_bf16 v[128:131], v[112:115], v[96:99], v[128:131]
  v_mfma_f32_16x16x32_bf16 v[128:131], v[208:211], v[192:195], v[128:131]
  v_mfma_f32_16x16x32_bf16 v[136:139], v[112:115], v[100:103], v[136:139]
  v_mfma_f32_16x16x32_bf16 v[136:139], v[208:211], v[196:199], v[136:139]
  v_mfma_f32_16x16x32_bf16 v[144:147], v[112:115], v[104:107], v[144:147]
  v_mfma_f32_16x16x32_bf16 v[144:147], v[208:211], v[200:203], v[144:147]
  v_mfma_f32_16x16x32_bf16 v[152:155], v[112:115], v[108:111], v[152:155]
  v_mfma_f32_16x16x32_bf16 v[152:155], v[208:211], v[204:207], v[152:155]
  v_mfma_f32_16x16x32_bf16 v[132:135], v[116:119], v[96:99], v[132:135]
  v_mfma_f32_16x16x32_bf16 v[132:135], v[212:215], v[192:195], v[132:135]
  v_mfma_f32_16x16x32_bf16 v[140:143], v[116:119], v[100:103], v[140:143]
  v_mfma_f32_16x16x32_bf16 v[140:143], v[212:215], v[196:199], v[140:143]
  v_mfma_f32_16x16x32_bf16 v[148:151], v[116:119], v[104:107], v[148:151]
  v_mfma_f32_16x16x32_bf16 v[148:151], v[212:215], v[200:203], v[148:151]
  v_mfma_f32_16x16x32_bf16 v[156:159], v[116:119], v[108:111], v[156:159]
  s_nop 0
  s_waitcnt lgkmcnt(0)
  v_mfma_f32_16x16x32_bf16 v[156:159], v[212:215], v[204:207], v[156:159]
  s_mov_b32 s4, 0xffff0000
  s_waitcnt vmcnt(3)
  v_lshlrev_b32 v32, 16, v160
  v_and_b32 v33, s4, v160
  v_lshlrev_b32 v34, 16, v161
  v_and_b32 v35, s4, v161
  v_lshlrev_b32 v36, 16, v162
  v_and_b32 v37, s4, v162
  v_lshlrev_b32 v38, 16, v163
  v_and_b32_e64 v39, s4, v163
  v_pk_add_f32 v[128:129], v[128:129], v[32:33]
  v_pk_add_f32 v[130:131], v[130:131], v[34:35]
  v_pk_add_f32 v[132:133], v[132:133], v[36:37]
  v_pk_add_f32 v[134:135], v[134:135], v[38:39]
  s_waitcnt vmcnt(2)
  v_lshlrev_b32 v32, 16, v164
  v_and_b32 v33, s4, v164
  v_lshlrev_b32 v34, 16, v165
  v_and_b32 v35, s4, v165
  v_lshlrev_b32 v36, 16, v166
  v_and_b32 v37, s4, v166
  v_lshlrev_b32 v38, 16, v167
  v_and_b32_e64 v39, s4, v167
  v_pk_add_f32 v[136:137], v[136:137], v[32:33]
  v_pk_add_f32 v[138:139], v[138:139], v[34:35]
  v_pk_add_f32 v[140:141], v[140:141], v[36:37]
  v_pk_add_f32 v[142:143], v[142:143], v[38:39]
  s_waitcnt vmcnt(1)
  v_lshlrev_b32 v32, 16, v168
  v_and_b32 v33, s4, v168
  v_lshlrev_b32 v34, 16, v169
  v_and_b32 v35, s4, v169
  v_lshlrev_b32 v36, 16, v170
  v_and_b32 v37, s4, v170
  v_lshlrev_b32 v38, 16, v171
  v_and_b32_e64 v39, s4, v171
  v_pk_add_f32 v[144:145], v[144:145], v[32:33]
  v_pk_add_f32 v[146:147], v[146:147], v[34:35]
  v_pk_add_f32 v[148:149], v[148:149], v[36:37]
  v_pk_add_f32 v[150:151], v[150:151], v[38:39]
  s_waitcnt vmcnt(0)
  v_lshlrev_b32 v32, 16, v172
  v_and_b32 v33, s4, v172
  v_lshlrev_b32 v34, 16, v173
  v_and_b32 v35, s4, v173
  v_lshlrev_b32 v36, 16, v174
  v_and_b32 v37, s4, v174
  v_lshlrev_b32 v38, 16, v175
  v_and_b32_e64 v39, s4, v175
  v_pk_add_f32 v[152:153], v[152:153], v[32:33]
  v_pk_add_f32 v[154:155], v[154:155], v[34:35]
  v_pk_add_f32 v[156:157], v[156:157], v[36:37]
  v_pk_add_f32 v[158:159], v[158:159], v[38:39]
  v_cvt_pk_bf16_f32 v240, v128, v129
  v_cvt_pk_bf16_f32 v241, v130, v131
  v_cvt_pk_bf16_f32 v242, v132, v133
  v_cvt_pk_bf16_f32 v243, v134, v135
  v_cvt_pk_bf16_f32 v244, v136, v137
  v_cvt_pk_bf16_f32 v245, v138, v139
  v_cvt_pk_bf16_f32 v246, v140, v141
  v_cvt_pk_bf16_f32 v247, v142, v143
  v_cvt_pk_bf16_f32 v248, v144, v145
  v_cvt_pk_bf16_f32 v249, v146, v147
  v_cvt_pk_bf16_f32 v250, v148, v149
  v_cvt_pk_bf16_f32 v251, v150, v151
  v_cvt_pk_bf16_f32 v252, v152, v153
  v_cvt_pk_bf16_f32 v253, v154, v155
  v_cvt_pk_bf16_f32 v254, v156, v157
  v_cvt_pk_bf16_f32 v255, v158, v159
  s_cmp_lg_u32 s82, 0
  s_cbranch_scc1 L_cfinal
  s_lshl_b32 s4, s76, 4
  s_add_u32 s4, s4, s78
  s_lshl_b32 s6, s4, Lz1-Lz0+14
  s_add_u32 s6, s6, 35651584
  s_add_u32 s7, s6, 4096
  s_lshl_b32 s5, s78, Lz1-Lz0+1
  buffer_store_dwordx4 v[240:243], v0, s[40:43], s6 offen offset:0 sc0 sc1
  buffer_store_dwordx4 v[244:247], v0, s[40:43], s6 offen offset:2048 sc0 sc1
  buffer_store_dwordx4 v[248:251], v0, s[40:43], s7 offen offset:0 sc0 sc1
  buffer_store_dwordx4 v[252:255], v0, s[40:43], s7 offen offset:2048 sc0 sc1
  v_mov_b32 v40, 0x3f803f80
  v_dot2_f32_bf16 v32, v240, v40, 0
  v_dot2_f32_bf16 v36, v240, v240, 0
  v_dot2_f32_bf16 v33, v244, v40, 0
  v_dot2_f32_bf16 v37, v244, v244, 0
  v_dot2_f32_bf16 v34, v248, v40, 0
  v_dot2_f32_bf16 v38, v248, v248, 0
  v_dot2_f32_bf16 v35, v252, v40, 0
  v_dot2_f32_bf16 v39, v252, v252, 0
  v_dot2_f32_bf16 v32, v241, v40, v32
  v_dot2_f32_bf16 v36, v241, v241, v36
  v_dot2_f32_bf16 v33, v245, v40, v33
  v_dot2_f32_bf16 v37, v245, v245, v37
  v_dot2_f32_bf16 v34, v249, v40, v34
  v_dot2_f32_bf16 v38, v249, v249, v38
  v_dot2_f32_bf16 v35, v253, v40, v35
  v_dot2_f32_bf16 v39, v253, v253, v39
  v_dot2_f32_bf16 v32, v242, v40, v32
  v_dot2_f32_bf16 v36, v242, v242, v36
  v_dot2_f32_bf16 v33, v246, v40, v33
  v_dot2_f32_bf16 v37, v246, v246, v37
  v_dot2_f32_bf16 v34, v250, v40, v34
  v_dot2_f32_bf16 v38, v250, v250, v38
  v_dot2_f32_bf16 v35, v254, v40, v35
  v_dot2_f32_bf16 v39, v254, v254, v39
  v_dot2_f32_bf16 v32, v243, v40, v32
  v_dot2_f32_bf16 v36, v243, v243, v36
  v_dot2_f32_bf16 v33, v247, v40, v33
  v_dot2_f32_bf16 v37, v247, v247, v37
  v_dot2_f32_bf16 v34, v251, v40, v34
  v_dot2_f32_bf16 v38, v251, v251, v38
  v_dot2_f32_bf16 v35, v255, v40, v35
  v_dot2_f32_bf16 v39, v255, v255, v39
  s_lshl_b32 s6, s76, Lz1-Lz0+9
  s_lshl_b32 s7, s85, 8
  s_add_u32 s6, s6, s7
  s_add_u32 s6, s6, s5
  s_add_u32 s6, s6, s86
  s_lshl_b32 s6, s6, 6
  s_add_u32 s6, s6, s83
  s_add_u32 s6, s6, 36700160
  v_permlane32_swap_b32 v32, v34
  v_permlane32_swap_b32 v33, v35
  v_permlane32_swap_b32 v36, v38
  v_permlane32_swap_b32 v37, v39
  v_add_f32 v32, v32, v34
  v_add_f32 v33, v33, v35
  v_add_f32 v36, v36, v38
  v_add_f32 v37, v37, v39
  v_permlane16_swap_b32 v32, v33
  s_nop 0
  v_permlane16_swap_b32 v36, v37
  v_add_f32 v42, v32, v33
  v_add_f32_e64 v43, v36, v37
  buffer_store_dwordx2 v[42:43], v30, s[40:43], s6 offen sc0 sc1
  s_add_u32 s5, s87, 16
  s_sub_u32 s4, s78, s77
  s_lshl_b32 s4, s4, 7
  s_add_u32 s5, s5, s4
  s_waitcnt vmcnt(0)
  s_mov_b64 exec, 1
  ds_add_rtn_u32 v2, v28, v27 offset:0
  s_waitcnt lgkmcnt(0)
  v_readfirstlane_b32 s4, v2
  s_and_b32 s4, s4, Lz1-Lz0+3
  s_cmp_lg_u32 s4, 3
  s_cbranch_scc1 Ls_27
  s_mov_b32 exec_lo, 0xffff
  buffer_store_dword v27, v24, s[40:43], s5 offen sc0 sc1
Ls_27:
  s_nop 0
  s_mov_b64 exec, -1
  ds_write_b128 v0, v[240:243] offset:0
  ds_write_b128 v0, v[244:247] offset:2048
  ds_write_b128 v0, v[248:251] offset:4096
  ds_write_b128 v0, v[252:255] offset:6144
  s_mov_b32 s82, 1
  s_add_u32 s83, s83, 0
  s_add_u32 s87, s87, 32
  s_branch L_clayer
L_cfinal:
  s_nop 1
  v_permlane16_swap_b32 v240, v242
  v_permlane16_swap_b32 v241, v243
  v_permlane16_swap_b32 v244, v246
  v_permlane16_swap_b32 v245, v247
  v_permlane16_swap_b32 v248, v250
  v_permlane16_swap_b32 v249, v251
  v_permlane16_swap_b32 v252, v254
  v_permlane16_swap_b32 v253, v255
  v_and_b32 v2, 15, v1
  v_lshlrev_b32 v3, 12, v2
  v_and_b32 v2, 16, v1
  v_lshl_add_u32 v3, v2, 1, v3
  v_and_b32 v2, 32, v1
  v_lshrrev_b32 v2, 1, v2
  v_add_u32 v3, v2, v3
  s_lshl_b32 s5, s76, 18
  s_lshl_b32 s4, s85, 11
  s_add_u32 s5, s5, s4
  s_lshl_b32 s4, s78, 7
  s_add_u32 s5, s5, s4
  s_lshl_b32 s4, s86, 6
  s_add_u32 s5, s5, s4
  buffer_store_dwordx4 v[240:243], v3, s[64:67], s5 offen
  s_add_u32 s5, s5, 0x10000
  buffer_store_dwordx4 v[244:247], v3, s[64:67], s5 offen
  s_add_u32 s5, s5, 0x10000
  buffer_store_dwordx4 v[248:251], v3, s[64:67], s5 offen
  s_add_u32 s5, s5, 0x10000
  buffer_store_dwordx4 v[252:255], v3, s[64:67], s5 offen
  s_endpgm
Lo_6:
  s_mov_b64 vcc, 0
  s_waitcnt lgkmcnt(0)
  s_barrier
  ds_read_b128 v[64:67], v4 offset:0
  ds_read_b128 v[80:83], v5 offset:0
  ds_read_b128 v[68:71], v4 offset:2048
  ds_read_b128 v[84:87], v5 offset:2048
  ds_read_b128 v[72:75], v4 offset:4096
  ds_read_b128 v[88:91], v5 offset:4096
  ds_read_b64_tr_b16 v[96:97], v6 offset:0
  ds_read_b64_tr_b16 v[98:99], v6 offset:2048
  ds_read_b64_tr_b16 v[100:101], v6 offset:4096
  ds_read_b64_tr_b16 v[102:103], v6 offset:6144
  ds_read_b128 v[76:79], v4 offset:6144
  ds_read_b128 v[92:95], v5 offset:6144
  ds_read_b64_tr_b16 v[104:105], v7 offset:0
  s_nop 0
  s_waitcnt lgkmcnt(8)
  ds_read_b64_tr_b16 v[106:107], v7 offset:2048
  ds_read_b64_tr_b16 v[108:109], v7 offset:4096
  ds_read_b64_tr_b16 v[110:111], v7 offset:6144
  s_branch Lk_4
L_w1:
  s_and_b32 s80, s77, 7
  s_lshr_b32 s79, s77, 3
  s_lshl_b32 s78, s80, 1
  s_add_u32 s78, s78, s79
  s_lshl_b32 s5, s76, 4
  s_add_u32 s5, s5, s77
  s_lshl_b32 s84, s5, 11
  s_mov_b32 s83, 3145728
  s_mov_b32 s87, 1835016
  s_lshr_b32 s86, s81, 1
  s_mov_b32 s40, s38
  s_and_b32 s41, s39, 0xffff
  s_mov_b32 s42, 100663296
  s_mov_b32 s43, 0x00020000
  s_nop 0
  s_mov_b32 s52, s20
  s_and_b32 s53, s21, 0xffff
  s_mov_b32 s54, 2097152
  s_mov_b32 s55, 0x00020000
  s_nop 0
  s_mov_b32 s56, s24
  s_and_b32 s57, s25, 0xffff
  s_mov_b32 s58, 7340032
  s_mov_b32 s59, 0x00020000
  s_nop 0
  s_mov_b32 s60, s28
  s_and_b32 s61, s29, 0xffff
  s_mov_b32 s62, 7340032
  s_mov_b32 s63, 0x00020000
  v_lshrrev_b32 v2, 3, v1
  s_movk_i32 s4, 2048
  v_mad_u32_u24 v4, v2, s4, v10
  v_add_u32 v5, 15360, v4
  v_add_u32 v6, 30720, v4
  v_add_u32 v7, 46080, v4
  s_lshl_b32 s5, s78, 7
  s_mul_i32 s4, s85, 65536
  s_add_u32 s5, s5, s4
  s_mov_b32 s8, 131072
  s_mov_b32 s10, 2097152
  s_add_u32 s9, s5, s10
  s_mul_i32 s6, s76, s8
  s_add_u32 s7, s5, s6
  s_lshl_b32 s11, s85, 12
  s_add_u32 s11, s11, 65536
  s_add_u32 s15, s11, 81920
  s_add_u32 s11, s11, 32768
  s_mov_b32 s12, 0
  s_mov_b32 m0, s11
  s_waitcnt vmcnt(12)
  s_barrier
  s_branch Ll_41
Lt_47:
  s_cmp_lg_u32 s12, 2
  s_cbranch_scc1 Lt_45
  s_waitcnt vmcnt(8)
  s_barrier
  s_branch Ll_41
Lt_45:
  s_cmp_lg_u32 s12, 6
  s_cbranch_scc1 Ll_41
  s_barrier
Ll_41:
  buffer_load_dwordx4 v4, s[52:55], s7 offen offset:0 lds
  s_mov_b32 s5, s7
  buffer_load_dwordx4 v5, s[52:55], s5 offen offset:1024 lds
  s_add_u32 s7, s7, s8
  s_cmp_eq_u32 s7, s9
  s_cselect_b32 s4, s10, 0
  s_sub_u32 s7, s7, s4
  s_add_u32 s11, s11, 8192
  buffer_load_dwordx4 v6, s[52:55], s5 offen offset:2048 lds
  s_cmp_eq_u32 s11, s15
  s_cselect_b32 s4, 81920, 0
  s_sub_u32 s11, s11, s4
  s_add_u32 s12, s12, 1
  s_cmp_lg_u32 s12, 10
  buffer_load_dwordx4 v7, s[52:55], s5 offen offset:3072 lds
  s_mov_b32 m0, s11
  s_cbranch_scc1 Lt_47
Lt_48:
  v_mov_b32 v2, 156416
  v_mov_b32_e64 v3, 1
  s_waitcnt vmcnt(16)
  s_mov_b64 exec, 1
  ds_add_u32 v2, v3 offset:8
  s_mov_b64 exec, -1
  s_lshl_b32 s5, s82, 2
  s_add_u32 s5, s5, Lz1-Lz0+4
  s_mov_b32 s89, 1600000
Lw_49:
  ds_read_b32 v3, v2 offset:12
Lw_50:
  s_waitcnt lgkmcnt(0)
  v_readfirstlane_b32 s4, v3
  s_cmp_ge_u32 s4, s5
  s_cbranch_scc1 Lw_51
  s_sleep 1
  s_sub_u32 s89, s89, 1
  s_cbranch_scc0 Lw_49
Lw_51:
Ll_43:
  buffer_load_dwordx4 v4, s[52:55], s7 offen offset:0 lds
  s_mov_b32 s5, s7
  buffer_load_dwordx4 v5, s[52:55], s5 offen offset:1024 lds
  s_add_u32 s7, s7, s8
  s_cmp_eq_u32 s7, s9
  s_cselect_b32 s4, s10, 0
  s_sub_u32 s7, s7, s4
  s_add_u32 s11, s11, 8192
  buffer_load_dwordx4 v6, s[52:55], s5 offen offset:2048 lds
  s_cmp_eq_u32 s11, s15
  s_cselect_b32 s4, 81920, 0
  s_sub_u32 s11, s11, s4
  s_add_u32 s12, s12, 1
  s_cmp_lg_u32 s12, 16
  buffer_load_dwordx4 v7, s[52:55], s5 offen offset:3072 lds
  s_mov_b32 m0, s11
  s_cbranch_scc1 Ll_43
  s_waitcnt vmcnt(24)
  v_lshrrev_b32 v2, 3, v1
  s_mov_b32 s4, 7168
  v_mad_u32_u24 v4, v2, s4, v10
  v_add_u32 v5, 56320, v4
  v_add_u32 v6, 112640, v4
  v_add_u32 v7, 168960, v4
  v_lshrrev_b32 v2, 2, v1
  s_movk_i32 s4, 7168
  v_mul_u32_u24_e64 v2, s4, v2
  v_bfe_u32 v3, v10, 5, 1
  v_lshl_add_u32 v2, v3, 4, v2
  v_and_b32 v3, 1, v1
  v_lshlrev_b32 v3, 5, v3
  v_add_u32_e64 v8, v2, v3
  v_add_u32 v9, 113664, v8
  s_mul_i32 s5, s77, 448
  s_and_b32 s4, s77, Lz1-Lz0+1
  s_mul_i32 s94, s4, 448
  s_sub_u32 s94, 384, s94
  s_lshl_b32 s4, s4, 6
  s_add_u32 s5, s5, s4
  s_mul_i32 s4, s85, 229376
  s_add_u32 s5, s5, s4
  s_and_b32 s4, s76, 7
  s_add_u32 s6, s4, 1
  v_cmp_lt_u32 vcc, s6, v1
  v_add_u32 v12, s4, v1
  s_nop 0
  v_subbrev_co_u32 v12, vcc, 0, v12, vcc
  v_and_b32 v12, 7, v12
  v_subrev_u32 v2, 9, v1
  v_cmp_le_u32 vcc, s4, v2
  s_nop 1
  v_addc_co_u32 v2, vcc, 8, v2, vcc
  v_cmp_le_u32 vcc, 9, v1
  s_nop 1
  v_cndmask_b32 v12, v12, v2, vcc
  s_add_u32 s4, s4, 8
  s_mov_b32 m0, s6
  s_nop 0
  v_writelane_b32 v12, s4, m0
  s_and_b32 s4, s76, 8
  v_xor_b32 v12, s4, v12
  v_cmp_eq_u32 vcc, s78, v12
  s_nop 0
  v_mov_b32_dpp v2, v12 row_shr:1 row_mask:0xf bank_mask:0xf
  s_ff1_i32_b32 s4, vcc_lo
  v_cmp_ge_u32 vcc, s4, v1
  s_nop 1
  v_cndmask_b32 v12, v12, v2, vcc
  v_writelane_b32 v12, s78, 0
  s_mov_b32 s4, 458752
  v_mul_u32_u24 v12, s4, v12
  v_add_u32 v12, s5, v12
  s_nop 0
  v_readfirstlane_b32 s7, v12
  s_lshl_b32 s11, s85, Lz1-Lz0+12
  s_add_u32 s11, s11, 65536
  s_add_u32 s15, s11, 86016
  s_lshl_b32 s4, s85, Lz1-Lz0+11
  s_sub_u32 s13, 24576, s4
  s_mul_i32 s5, s85, 6144
  s_nop 0
  s_mov_b32 s68, s28
  s_and_b32 s69, s29, 0xffff
  s_mov_b32 s70, 7340032
  s_mov_b32 s71, 0x00020000
  s_lshl_b32 s4, s76, 4
  s_add_u32 s4, s4, s77
  s_mul_i32 s34, s4, 28672
  s_add_u32 s34, s34, s5
  v_lshlrev_b32 v15, 4, v1
  s_lshl_b32 s91, s85, Lz1-Lz0+13
  s_add_u32 s91, s91, 4096
  s_lshl_b32 s9, s76, 18
  s_add_u32 s9, s9, 3145728
  s_add_u32 s9, s9, s91
  s_add_u32 s10, s91, 65536
  s_add_u32 s91, s91, 49152
  s_add_u32 s8, s76, 3
  s_lshl_b32 s8, s8, 14
  s_mov_b32 s12, Lz1-Lz0+3
Lh_52:
  s_and_b32 s8, s8, 0x3ffff
  s_add_u32 s90, s8, s9
  s_mov_b32 m0, s91
  s_cmp_lt_u32 s12, 6
  s_cbranch_scc1 Lh_53
  s_waitcnt vmcnt(8)
Lh_53:
  s_barrier
Lh_54:
  buffer_load_dwordx4 v15, s[40:43], s90 offen offset:0 sc1 lds
  s_add_u32 s8, s8, 16384
  s_add_u32 s91, s91, 16384
  s_nop 0
  s_cmp_eq_u32 s91, s10
  buffer_load_dwordx4 v15, s[40:43], s90 offen offset:1024 sc1 lds
  s_cselect_b32 s4, 65536, 0
  s_sub_u32 s91, s91, s4
  s_add_u32 s12, s12, 1
  buffer_load_dwordx4 v15, s[40:43], s90 offen offset:2048 sc1 lds
  s_cmp_lg_u32 s12, Lz1-Lz0+16
  buffer_load_dwordx4 v15, s[40:43], s90 offen offset:3072 sc1 lds
  s_cbranch_scc1 Lh_52
  s_mov_b32 s12, 0
  s_mov_b32 m0, s11
  s_branch Ll_55
Lt_60:
  s_cmp_lg_u32 s12, 1
  s_cbranch_scc1 Ll_55
  s_waitcnt vmcnt(18)
  s_barrier
Ll_55:
  buffer_load_dwordx4 v4, s[56:59], s7 offen offset:0 lds
  buffer_load_dwordx4 v5, s[56:59], s7 offen offset:1024 lds
  buffer_load_dwordx4 v6, s[56:59], s7 offen offset:2048 lds
  buffer_load_dwordx4 v7, s[56:59], s7 offen offset:3072 lds
  s_add_u32 m0, s11, s13
  s_add_u32 s5, s7, s94
  buffer_load_dwordx4 v8, s[56:59], s5 offen offset:0 lds
  buffer_load_dwordx4 v9, s[56:59], s5 offen offset:1024 lds
  s_cmp_ge_u32 s12, Lz1-Lz0+2
  s_cbranch_scc1 Lm_61
  s_waitcnt vmcnt(20)
  s_cmp_lg_u32 s12, 0
  s_cbranch_scc1 Lm_62
  s_waitcnt vmcnt(14)
Lm_62:
  s_barrier
Lm_61:
  s_add_u32 m0, s11, 8192
  s_add_u32 s5, s7, 128
  buffer_load_dwordx4 v4, s[56:59], s5 offen offset:0 lds
  buffer_load_dwordx4 v5, s[56:59], s5 offen offset:1024 lds
  buffer_load_dwordx4 v6, s[56:59], s5 offen offset:2048 lds
  buffer_load_dwordx4 v7, s[56:59], s5 offen offset:3072 lds
  s_add_u32 m0, s11, 16384
  s_add_u32 s5, s7, 256
  buffer_load_dwordx4 v4, s[56:59], s5 offen offset:0 lds
  s_add_u32 s12, s12, Lz1-Lz0+1
  v_readlane_b32 s7, v12, s12
  s_add_u32 s11, s11, 28672
  buffer_load_dwordx4 v5, s[56:59], s5 offen offset:1024 lds
  s_cmp_eq_u32 s11, s15
  s_cselect_b32 s4, 86016, 0
  s_sub_u32 s11, s11, s4
  buffer_load_dwordx4 v6, s[56:59], s5 offen offset:2048 lds
  s_cmp_lg_u32 s12, 2
  buffer_load_dwordx4 v7, s[56:59], s5 offen offset:3072 lds
  s_mov_b32 m0, s11
  s_cbranch_scc1 Ll_56
  s_barrier
Lt_63:
  s_waitcnt vmcnt(0)
  s_barrier
Ll_56:
  s_cmp_lt_u32 s12, 3
  s_cbranch_scc1 Lt_60
  s_waitcnt vmcnt(14)
  s_barrier
  buffer_load_dwordx4 v4, s[56:59], s7 offen offset:0 lds
  buffer_load_dwordx4 v5, s[56:59], s7 offen offset:1024 lds
  buffer_load_dwordx4 v6, s[56:59], s7 offen offset:2048 lds
  buffer_load_dwordx4 v7, s[56:59], s7 offen offset:3072 lds
Ll_64:
  s_add_u32 m0, s11, s13
  s_add_u32 s5, s7, s94
  buffer_load_dwordx4 v8, s[56:59], s5 offen offset:0 lds
  buffer_load_dwordx4 v9, s[56:59], s5 offen offset:1024 lds
  s_add_u32 m0, s11, 8192
  s_add_u32 s5, s7, 128
  buffer_load_dwordx4 v4, s[56:59], s5 offen offset:0 lds
  buffer_load_dwordx4 v5, s[56:59], s5 offen offset:1024 lds
  buffer_load_dwordx4 v6, s[56:59], s5 offen offset:2048 lds
  buffer_load_dwordx4 v7, s[56:59], s5 offen offset:3072 lds
  s_add_u32 m0, s11, 16384
  s_add_u32 s5, s7, 256
  buffer_load_dwordx4 v4, s[56:59], s5 offen offset:0 lds
  s_add_u32 s12, s12, Lz1-Lz0+1
  v_readlane_b32 s7, v12, s12
  s_add_u32 s11, s11, 28672
  buffer_load_dwordx4 v5, s[56:59], s5 offen offset:1024 lds
  s_cmp_eq_u32 s11, s15
  s_cselect_b32 s4, 86016, 0
  s_sub_u32 s11, s11, s4
  buffer_load_dwordx4 v6, s[56:59], s5 offen offset:2048 lds
  s_cmp_eq_u32 s12, Lz1-Lz0+16
  buffer_load_dwordx4 v7, s[56:59], s5 offen offset:3072 lds
  s_mov_b32 m0, s11
  s_cbranch_scc1 Ll_65
  s_cmp_lg_u32 s82, 0
  s_cbranch_scc1 L_66
  s_buffer_load_dwordx2 s[98:99], s[68:71], s34 offset:60
  s_buffer_load_dwordx2 s[98:99], s[68:71], s34 offset:188
  s_buffer_load_dwordx2 s[98:99], s[68:71], s34 offset:316
  s_buffer_load_dwordx2 s[98:99], s[68:71], s34 offset:444
  s_add_u32 s34, s34, 512
L_66:
  s_waitcnt vmcnt(14)
  s_barrier
  buffer_load_dwordx4 v4, s[56:59], s7 offen offset:0 lds
  buffer_load_dwordx4 v5, s[56:59], s7 offen offset:1024 lds
  buffer_load_dwordx4 v6, s[56:59], s7 offen offset:2048 lds
  buffer_load_dwordx4 v7, s[56:59], s7 offen offset:3072 lds
  s_branch Ll_64
  s_nop 0
Ll_65:
  v_lshrrev_b32 v2, 3, v1
  s_movk_i32 s4, 2048
  v_mad_u32_u24 v4, v2, s4, v10
  v_add_u32 v5, 15360, v4
  v_add_u32 v6, 30720, v4
  v_add_u32 v7, 46080, v4
  s_lshl_b32 s5, s78, Lz1-Lz0+7
  s_mul_i32 s4, s79, 3670016
  s_add_u32 s5, s5, s4
  s_lshl_b32 s94, s79, 8
  s_sub_u32 s94, 128, s94
  v_subrev_u32 v2, 4, v1
  v_cmp_le_u32 vcc, 28, v1
  s_nop 1
  v_cndmask_b32 v13, v1, v2, vcc
  v_subrev_u32 v3, 3, v13
  v_mov_b32 v12, 4
  v_cmp_le_u32 vcc, 14, v13
  v_subrev_u32 v2, 14, v13
  s_nop 0
  v_cndmask_b32 v3, v3, v2, vcc
  v_cndmask_b32_e64 v12, v12, 12, vcc
  v_cmp_le_u32 vcc, 21, v13
  v_subrev_u32 v2, 21, v13
  s_nop 0
  v_cndmask_b32 v3, v3, v2, vcc
  v_cndmask_b32_e64 v12, v12, 20, vcc
  s_sub_u32 s4, s80, s76
  s_and_b32 s4, s4, 7
  v_cmp_le_u32 vcc, s4, v3
  v_mov_b32 v2, s76
  s_nop 0
  v_addc_co_u32 v3, vcc, v3, v2, vcc
  v_and_b32 v3, 7, v3
  v_add_u32 v12, v12, v3
  v_add_u32 v2, v2, v1
  v_and_b32 v2, 3, v2
  v_subrev_u32 v3, 10, v1
  v_cmp_gt_u32 vcc, 4, v3
  s_nop 1
  v_cndmask_b32 v12, v12, v2, vcc
  s_add_u32 s4, s80, Lz1-Lz0+4
  v_lshl_add_u32 v2, v1, 3, s4
  v_cmp_gt_u32 vcc, 3, v1
  s_nop 1
  v_cndmask_b32 v12, v12, v2, vcc
  v_subrev_u32 v2, 4, v12
  v_and_b32 v3, 7, v2
  v_lshrrev_b32 v2, 3, v2
  v_mad_u32_u24 v2, v3, 7, v2
  v_and_b32 v3, 1, v3
  v_add_u32 v2, v2, v3
  s_mul_i32 s4, s85, 3
  v_add_u32 v2, s4, v2
  s_add_u32 s4, s85, Lz1-Lz0+6
  v_mad_u32_u24 v3, v12, 14, s4
  v_cmp_gt_u32 vcc, 4, v12
  s_nop 1
  v_cndmask_b32_e64 v2, v2, v3, vcc
  v_lshl_add_u32 v12, v2, 16, s5
  s_mul_i32 s4, s79, 7340032
  s_sub_u32 s4, 3670016, s4
  v_add_u32 v2, s4, v12
  v_cmp_le_u32 vcc, 28, v1
  s_nop 1
  v_cndmask_b32 v12, v12, v2, vcc
  s_lshl_b32 s11, s85, Lz1-Lz0+12
  s_add_u32 s11, s11, 65536
  s_add_u32 s15, s11, 81920
  s_add_u32 s11, s11, 32768
  v_readfirstlane_b32 s7, v12
  s_mov_b32 s12, 0
  s_mov_b32 m0, s11
  s_waitcnt vmcnt(14)
  s_barrier
  s_branch Ll_67
Lt_73:
  s_cmp_lg_u32 s12, 1
  s_cbranch_scc1 Lt_71
  s_waitcnt vmcnt(8)
  s_barrier
  s_branch Ll_67
Lt_71:
  s_cmp_lg_u32 s12, 3
  s_cbranch_scc1 Ll_67
  s_barrier
Ll_67:
  buffer_load_dwordx4 v4, s[60:63], s7 offen offset:0 lds
  buffer_load_dwordx4 v5, s[60:63], s7 offen offset:1024 lds
  buffer_load_dwordx4 v6, s[60:63], s7 offen offset:2048 lds
  buffer_load_dwordx4 v7, s[60:63], s7 offen offset:3072 lds
  s_add_u32 m0, s11, 8192
  s_add_u32 s5, s7, s94
  buffer_load_dwordx4 v4, s[60:63], s5 offen offset:0 lds
  s_add_u32 s12, s12, 1
  v_readlane_b32 s7, v12, s12
  s_add_u32 s11, s11, 16384
  buffer_load_dwordx4 v5, s[60:63], s5 offen offset:1024 lds
  s_cmp_eq_u32 s11, s15
  s_cselect_b32 s4, 81920, 0
  s_sub_u32 s11, s11, s4
  buffer_load_dwordx4 v6, s[60:63], s5 offen offset:2048 lds
  s_cmp_lg_u32 s12, Lz1-Lz0+5
  buffer_load_dwordx4 v7, s[60:63], s5 offen offset:3072 lds
  s_mov_b32 m0, s11
  s_cbranch_scc1 Lt_73
Lt_74:
  s_waitcnt vmcnt(32)
  s_barrier
  s_waitcnt vmcnt(24)
  s_barrier
  buffer_load_dwordx4 v4, s[60:63], s7 offen offset:0 lds
  buffer_load_dwordx4 v5, s[60:63], s7 offen offset:1024 lds
  buffer_load_dwordx4 v6, s[60:63], s7 offen offset:2048 lds
  buffer_load_dwordx4 v7, s[60:63], s7 offen offset:3072 lds
Ll_75:
  s_add_u32 m0, s11, 8192
  s_add_u32 s5, s7, s94
  buffer_load_dwordx4 v4, s[60:63], s5 offen offset:0 lds
  s_add_u32 s12, s12, 1
  v_readlane_b32 s7, v12, s12
  s_add_u32 s11, s11, 16384
  buffer_load_dwordx4 v5, s[60:63], s5 offen offset:1024 lds
  s_cmp_eq_u32 s11, s15
  s_cselect_b32 s4, 81920, 0
  s_sub_u32 s11, s11, s4
  buffer_load_dwordx4 v6, s[60:63], s5 offen offset:2048 lds
  s_cmp_eq_u32 s12, Lz1-Lz0+24
  buffer_load_dwordx4 v7, s[60:63], s5 offen offset:3072 lds
  s_mov_b32 m0, s11
  s_cbranch_scc1 Ll_76
  s_waitcnt vmcnt(24)
  s_barrier
  buffer_load_dwordx4 v4, s[60:63], s7 offen offset:0 lds
  buffer_load_dwordx4 v5, s[60:63], s7 offen offset:1024 lds
  buffer_load_dwordx4 v6, s[60:63], s7 offen offset:2048 lds
  buffer_load_dwordx4 v7, s[60:63], s7 offen offset:3072 lds
  s_branch Ll_75
  s_nop 0
Ll_76:
  s_waitcnt vmcnt(24)
  s_barrier
  buffer_load_dwordx4 v4, s[60:63], s7 offen offset:0 lds
Ll_77:
  s_mov_b32 s5, s7
  buffer_load_dwordx4 v5, s[60:63], s5 offen offset:1024 lds
  s_add_u32 s12, s12, 1
  v_readlane_b32 s7, v12, s12
  s_add_u32 s11, s11, 16384
  s_nop 0
  s_cmp_eq_u32 s11, s15
  buffer_load_dwordx4 v6, s[60:63], s5 offen offset:2048 lds
  s_cselect_b32 s4, 81920, 0
  s_sub_u32 s11, s11, s4
  s_cmp_eq_u32 s12, 32
  buffer_load_dwordx4 v7, s[60:63], s5 offen offset:3072 lds
  s_mov_b32 m0, s11
  s_cbranch_scc1 Ll_78
  s_waitcnt vmcnt(12)
  s_barrier
  buffer_load_dwordx4 v4, s[60:63], s7 offen offset:0 lds
  s_branch Ll_77
  s_nop 0
Ll_78:
  v_lshrrev_b32 v2, 3, v1
  s_movk_i32 s4, 6144
  v_mad_u32_u24 v4, v2, s4, v10
  v_add_u32 v5, 48128, v4
  v_add_u32 v6, 96256, v4
  v_add_u32 v7, 144384, v4
  s_lshl_b32 s5, s77, Lz1-Lz0+7
  s_mul_i32 s4, s85, 196608
  s_add_u32 s5, s5, s4
  s_and_b32 s4, s76, 7
  s_add_u32 s6, s4, 1
  v_cmp_lt_u32 vcc, s6, v1
  v_add_u32 v12, s4, v1
  s_nop 0
  v_subbrev_co_u32 v12, vcc, 0, v12, vcc
  v_and_b32 v12, 7, v12
  v_subrev_u32 v2, 9, v1
  v_cmp_le_u32 vcc, s4, v2
  s_nop 1
  v_addc_co_u32 v2, vcc, 8, v2, vcc
  v_cmp_le_u32 vcc, 9, v1
  s_nop 1
  v_cndmask_b32 v12, v12, v2, vcc
  s_add_u32 s4, s4, 8
  s_mov_b32 m0, s6
  s_nop 0
  v_writelane_b32 v12, s4, m0
  s_and_b32 s4, s76, 8
  v_xor_b32 v12, s4, v12
  v_cmp_eq_u32 vcc, s78, v12
  s_nop 0
  v_mov_b32_dpp v2, v12 row_shr:1 row_mask:0xf bank_mask:0xf
  s_ff1_i32_b32 s4, vcc_lo
  v_cmp_ge_u32 vcc, s4, v1
  s_nop 1
  v_cndmask_b32 v12, v12, v2, vcc
  v_writelane_b32 v12, s78, 0
  s_mov_b32 s4, 393216
  v_mul_u32_u24 v12, s4, v12
  v_add_u32 v12, s5, v12
  s_nop 0
  v_readfirstlane_b32 s7, v12
  s_lshl_b32 s11, s85, Lz1-Lz0+12
  s_add_u32 s11, s11, 65536
  s_add_u32 s15, s11, 73728
  s_cmp_eq_u32 s82, 0
  s_mov_b32 s82, 1
  s_cbranch_scc1 L_wlayer
  s_waitcnt vmcnt(12)
  s_barrier
  s_waitcnt vmcnt(8)
  s_barrier
  s_waitcnt vmcnt(4)
  s_barrier
  s_waitcnt vmcnt(0)
  s_barrier
  s_barrier
  s_branch L_lend
L_x1:
  s_cmp_lg_u32 s82, 0
  s_cbranch_scc1 L_86
  s_and_b32 s80, s77, 7
  s_lshr_b32 s79, s77, 3
  s_lshl_b32 s78, s80, 1
  s_add_u32 s78, s78, s79
  s_lshl_b32 s5, s76, 4
  s_add_u32 s5, s5, s77
  s_lshl_b32 s84, s5, 11
  s_mov_b32 s83, 3145728
  s_mov_b32 s87, 1835016
  s_lshr_b32 s86, s81, 1
  v_lshlrev_b32 v4, 4, v1
  v_lshlrev_b32 v5, 4, v1
  v_lshlrev_b32 v6, 4, v1
  v_lshlrev_b32 v7, 4, v1
  s_movk_i32 s13, 4096
  s_movk_i32 s95, 8192
  v_and_b32 v2, 31, v1
  v_lshlrev_b32 v8, 7, v2
L_86:
  s_mov_b32 s40, s38
  s_and_b32 s41, s39, 0xffff
  s_mov_b32 s42, 100663296
  s_mov_b32 s43, 0x00020000
  s_mov_b32 s72, s40
  s_mov_b32 s73, s41
  s_mov_b32 s74, s42
  s_mov_b32 s11, 0
  s_mov_b32 s15, 65536
  s_mul_i32 s5, s76, 16
  s_lshl_b32 s5, s5, 14
  s_add_u32 s5, s5, 3145728
  s_mov_b32 s8, 16384
  s_mov_b32 s10, 262144
  s_add_u32 s9, s5, s10
  s_mul_i32 s6, s76, s8
  s_add_u32 s7, s5, s6
  s_lshr_b32 s6, s6, 14
  s_lshl_b32 s90, 0x7f, s6
  s_lshr_b32 s4, s90, 16
  s_or_b32 s90, s90, s4
  s_and_b32 s90, s90, 0xffff
  s_lshl_b32 s91, s84, 1
  s_add_u32 s91, s91, s87
  s_mov_b32 s89, 200000
  s_mov_b32 exec_lo, s90
  s_mov_b32 exec_hi, 0
  buffer_load_dword v12, v8, s[40:43], s91 offen sc0 sc1
Lp_87:
  s_waitcnt vmcnt(0)
  v_cmp_ne_u32 vcc, 0, v12
  s_andn2_b32 s3, exec_lo, vcc_lo
  s_cbranch_scc0 Lp_88
  s_mov_b32 exec_lo, s3
  s_sleep 1
  buffer_load_dword v12, v8, s[40:43], s91 offen sc0 sc1
  s_sub_u32 s89, s89, 1
  s_cbranch_scc0 Lp_87
Lp_88:
  s_mov_b64 exec, -1
  s_mov_b32 s12, 0
  s_mov_b32 m0, s11
Ll_89:
  s_nop 0
  buffer_load_dwordx4 v4, s[40:43], s7 offen offset:0 sc1 lds
  buffer_load_dwordx4 v5, s[40:43], s7 offen offset:1024 sc1 lds
  buffer_load_dwordx4 v6, s[40:43], s7 offen offset:2048 sc1 lds
  buffer_load_dwordx4 v7, s[40:43], s7 offen offset:3072 sc1 lds
  s_add_u32 m0, s11, 4096
  s_nop 0
  s_add_u32 s5, s7, s13
  buffer_load_dwordx4 v4, s[40:43], s5 offen offset:0 sc1 lds
  buffer_load_dwordx4 v5, s[40:43], s5 offen offset:1024 sc1 lds
  buffer_load_dwordx4 v6, s[40:43], s5 offen offset:2048 sc1 lds
  buffer_load_dwordx4 v7, s[40:43], s5 offen offset:3072 sc1 lds
  s_add_u32 m0, s11, 8192
  s_nop 0
  s_add_u32 s3, s7, s95
  buffer_load_dwordx4 v4, s[40:43], s3 offen offset:0 sc1 lds
  buffer_load_dwordx4 v5, s[40:43], s3 offen offset:1024 sc1 lds
  buffer_load_dwordx4 v6, s[40:43], s3 offen offset:2048 sc1 lds
  buffer_load_dwordx4 v7, s[40:43], s3 offen offset:3072 sc1 lds
  s_add_u32 m0, s11, 12288
  s_nop 0
  s_add_u32 s5, s3, s13
  buffer_load_dwordx4 v4, s[40:43], s5 offen offset:0 sc1 lds
  s_add_u32 s7, s7, s8
  s_cmp_eq_u32 s7, s9
  s_cselect_b32 s4, s10, 0
  s_sub_u32 s7, s7, s4
  buffer_load_dwordx4 v5, s[40:43], s5 offen offset:1024 sc1 lds
  s_add_u32 s11, s11, 16384
  s_cmp_eq_u32 s11, s15
  s_cselect_b32 s4, 65536, 0
  s_sub_u32 s11, s11, s4
  buffer_load_dwordx4 v6, s[40:43], s5 offen offset:2048 sc1 lds
  s_add_u32 s12, s12, 1
  s_cmp_lg_u32 s12, 3
  buffer_load_dwordx4 v7, s[40:43], s5 offen offset:3072 sc1 lds
  s_mov_b32 m0, s11
  s_cbranch_scc1 Ll_89
  s_waitcnt vmcnt(32)
  s_barrier
  buffer_load_dwordx4 v4, s[40:43], s7 offen offset:0 sc1 lds
  buffer_load_dwordx4 v5, s[40:43], s7 offen offset:1024 sc1 lds
  buffer_load_dwordx4 v6, s[40:43], s7 offen offset:2048 sc1 lds
  buffer_load_dwordx4 v7, s[40:43], s7 offen offset:3072 sc1 lds
  s_add_u32 m0, s11, 8192
  s_add_u32 s3, s7, s95
  buffer_load_dwordx4 v4, s[40:43], s3 offen offset:0 sc1 lds
  s_add_u32 s7, s7, s8
  s_cmp_eq_u32 s7, s9
  s_cselect_b32 s4, s10, 0
  buffer_load_dwordx4 v5, s[40:43], s3 offen offset:1024 sc1 lds
  s_sub_u32 s7, s7, s4
  s_add_u32 s11, s11, 16384
  s_cmp_eq_u32 s11, s15
  buffer_load_dwordx4 v6, s[40:43], s3 offen offset:2048 sc1 lds
  s_cselect_b32 s4, 65536, 0
  s_sub_u32 s11, s11, s4
  s_add_u32 s12, s12, 1
  buffer_load_dwordx4 v7, s[40:43], s3 offen offset:3072 sc1 lds
  s_mov_b32 m0, s11
  s_waitcnt vmcnt(24)
  s_nop 0
  s_barrier
  buffer_load_dwordx4 v4, s[40:43], s7 offen offset:0 sc1 lds
  buffer_load_dwordx4 v5, s[40:43], s7 offen offset:1024 sc1 lds
  buffer_load_dwordx4 v6, s[40:43], s7 offen offset:2048 sc1 lds
  buffer_load_dwordx4 v7, s[40:43], s7 offen offset:3072 sc1 lds
Ll_93:
  s_add_u32 m0, s11, 8192
  s_nop 0
  s_add_u32 s3, s7, s95
  buffer_load_dwordx4 v4, s[40:43], s3 offen offset:0 sc1 lds
  s_add_u32 s7, s7, s8
  s_cmp_eq_u32 s7, s9
  s_cselect_b32 s4, s10, 0
  s_sub_u32 s7, s7, s4
  buffer_load_dwordx4 v5, s[40:43], s3 offen offset:1024 sc1 lds
  s_add_u32 s11, s11, 16384
  s_cmp_eq_u32 s11, s15
  s_cselect_b32 s4, 65536, 0
  s_sub_u32 s11, s11, s4
  buffer_load_dwordx4 v6, s[40:43], s3 offen offset:2048 sc1 lds
  s_add_u32 s12, s12, 1
  s_cmp_eq_u32 s12, 16
  buffer_load_dwordx4 v7, s[40:43], s3 offen offset:3072 sc1 lds
  s_mov_b32 m0, s11
  s_cbranch_scc1 Ll_94
  s_waitcnt vmcnt(16)
  s_barrier
  buffer_load_dwordx4 v4, s[40:43], s7 offen offset:0 sc1 lds
  buffer_load_dwordx4 v5, s[40:43], s7 offen offset:1024 sc1 lds
  buffer_load_dwordx4 v6, s[40:43], s7 offen offset:2048 sc1 lds
  buffer_load_dwordx4 v7, s[40:43], s7 offen offset:3072 sc1 lds
  s_branch Ll_93
  s_nop 0
Ll_94:
  s_waitcnt vmcnt(16)
  s_barrier
  s_waitcnt vmcnt(8)
  s_barrier
  s_waitcnt vmcnt(0)
  s_barrier
  s_barrier
  s_mov_b32 s11, 0
  s_mov_b32 s15, 65536
  s_mul_i32 s5, s76, 16
  s_lshl_b32 s5, s5, 14
  s_add_u32 s5, s5, 7340032
  s_and_b32 s4, s76, 7
  s_add_u32 s6, s4, 1
  v_cmp_lt_u32 vcc, s6, v1
  v_add_u32 v9, s4, v1
  s_nop 0
  v_subbrev_co_u32 v9, vcc, 0, v9, vcc
  v_and_b32 v9, 7, v9
  v_subrev_u32 v2, 9, v1
  v_cmp_le_u32 vcc, s4, v2
  s_nop 1
  v_addc_co_u32 v2, vcc, 8, v2, vcc
  v_cmp_le_u32 vcc, 9, v1
  s_nop 1
  v_cndmask_b32 v9, v9, v2, vcc
  s_add_u32 s4, s4, Lz1-Lz0+8
  s_mov_b32 m0, s6
  s_nop 0
  v_writelane_b32 v9, s4, m0
  s_and_b32 s4, s76, 8
  v_xor_b32 v9, s4, v9
  v_cmp_eq_u32 vcc, s78, v9
  s_nop 0
  v_mov_b32_dpp v2, v9 row_shr:1 row_mask:0xf bank_mask:0xf
  s_ff1_i32_b32 s4, vcc_lo
  v_cmp_ge_u32 vcc, s4, v1
  s_nop 1
  v_cndmask_b32 v9, v9, v2, vcc
  v_writelane_b32 v9, s78, 0
  v_lshlrev_b32_e64 v11, 7, v9
  v_lshl_add_u32 v9, v9, 14, s5
  s_lshl_b32 s6, s76, Lz1-Lz0+14
  v_readlane_b32 s7, v9, 1
  s_mov_b32 s11, 16384
  s_mov_b32 s90, Lz1-Lz0+62
  s_add_u32 s91, s91, 4
  s_barrier
  s_mov_b32 s89, 200000
  s_mov_b32 exec_lo, s90
  s_mov_b32 exec_hi, 0
  buffer_load_dword v12, v11, s[40:43], s91 offen sc0 sc1
Lp_95:
  s_waitcnt vmcnt(0)
  v_cmp_ne_u32 vcc, 0, v12
  s_andn2_b32 s3, exec_lo, vcc_lo
  s_cbranch_scc0 Lp_96
  s_mov_b32 exec_lo, s3
  s_sleep 1
  buffer_load_dword v12, v11, s[40:43], s91 offen sc0 sc1
  s_sub_u32 s89, s89, 1
  s_cbranch_scc0 Lp_95
Lp_96:
  s_mov_b64 exec, -1
  s_mov_b32 s12, 1
  s_mov_b32 m0, s11
Ll_97:
  s_nop 0
  buffer_load_dwordx4 v4, s[72:75], s7 offen offset:0 sc1 lds
  buffer_load_dwordx4 v5, s[72:75], s7 offen offset:1024 sc1 lds
  buffer_load_dwordx4 v6, s[72:75], s7 offen offset:2048 sc1 lds
  buffer_load_dwordx4 v7, s[72:75], s7 offen offset:3072 sc1 lds
  s_add_u32 m0, s11, 4096
  s_nop 0
  s_add_u32 s5, s7, s13
  buffer_load_dwordx4 v4, s[72:75], s5 offen offset:0 sc1 lds
  buffer_load_dwordx4 v5, s[72:75], s5 offen offset:1024 sc1 lds
  buffer_load_dwordx4 v6, s[72:75], s5 offen offset:2048 sc1 lds
  buffer_load_dwordx4 v7, s[72:75], s5 offen offset:3072 sc1 lds
  s_add_u32 m0, s11, 8192
  s_nop 0
  s_add_u32 s3, s7, s95
  buffer_load_dwordx4 v4, s[72:75], s3 offen offset:0 sc1 lds
  buffer_load_dwordx4 v5, s[72:75], s3 offen offset:1024 sc1 lds
  buffer_load_dwordx4 v6, s[72:75], s3 offen offset:2048 sc1 lds
  buffer_load_dwordx4 v7, s[72:75], s3 offen offset:3072 sc1 lds
  s_add_u32 m0, s11, 12288
  s_add_u32 s5, s3, s13
  buffer_load_dwordx4 v4, s[72:75], s5 offen offset:0 sc1 lds
  s_add_u32 s12, s12, 1
  v_readlane_b32 s7, v9, s12
  s_add_u32 s11, s11, 16384
  buffer_load_dwordx4 v5, s[72:75], s5 offen offset:1024 sc1 lds
  s_cmp_eq_u32 s11, s15
  s_cselect_b32 s4, 65536, 0
  s_sub_u32 s11, s11, s4
  buffer_load_dwordx4 v6, s[72:75], s5 offen offset:2048 sc1 lds
  s_cmp_lg_u32 s12, Lz1-Lz0+4
  buffer_load_dwordx4 v7, s[72:75], s5 offen offset:3072 sc1 lds
  s_mov_b32 m0, s11
  s_cbranch_scc1 Ll_97
  s_waitcnt vmcnt(32)
  s_barrier
  buffer_load_dwordx4 v4, s[72:75], s7 offen offset:0 sc1 lds
  buffer_load_dwordx4 v5, s[72:75], s7 offen offset:1024 sc1 lds
  buffer_load_dwordx4 v6, s[72:75], s7 offen offset:2048 sc1 lds
  buffer_load_dwordx4 v7, s[72:75], s7 offen offset:3072 sc1 lds
Ll_101:
  s_add_u32 m0, s11, 4096
  s_nop 0
  s_add_u32 s5, s7, s13
  buffer_load_dwordx4 v4, s[72:75], s5 offen offset:0 sc1 lds
  buffer_load_dwordx4 v5, s[72:75], s5 offen offset:1024 sc1 lds
  buffer_load_dwordx4 v6, s[72:75], s5 offen offset:2048 sc1 lds
  buffer_load_dwordx4 v7, s[72:75], s5 offen offset:3072 sc1 lds
  s_add_u32 m0, s11, 8192
  s_nop 0
  s_add_u32 s3, s7, s95
  buffer_load_dwordx4 v4, s[72:75], s3 offen offset:0 sc1 lds
  buffer_load_dwordx4 v5, s[72:75], s3 offen offset:1024 sc1 lds
  buffer_load_dwordx4 v6, s[72:75], s3 offen offset:2048 sc1 lds
  buffer_load_dwordx4 v7, s[72:75], s3 offen offset:3072 sc1 lds
  s_add_u32 m0, s11, 12288
  s_add_u32 s5, s3, s13
  buffer_load_dwordx4 v4, s[72:75], s5 offen offset:0 sc1 lds
  s_add_u32 s12, s12, 1
  v_readlane_b32 s7, v9, s12
  s_add_u32 s11, s11, 16384
  buffer_load_dwordx4 v5, s[72:75], s5 offen offset:1024 sc1 lds
  s_cmp_eq_u32 s11, s15
  s_cselect_b32 s4, 65536, 0
  s_sub_u32 s11, s11, s4
  buffer_load_dwordx4 v6, s[72:75], s5 offen offset:2048 sc1 lds
  s_cmp_eq_u32 s12, Lz1-Lz0+16
  buffer_load_dwordx4 v7, s[72:75], s5 offen offset:3072 sc1 lds
  s_mov_b32 m0, s11
  s_cbranch_scc1 Ll_102
  s_waitcnt vmcnt(32)
  s_barrier
  buffer_load_dwordx4 v4, s[72:75], s7 offen offset:0 sc1 lds
  buffer_load_dwordx4 v5, s[72:75], s7 offen offset:1024 sc1 lds
  buffer_load_dwordx4 v6, s[72:75], s7 offen offset:2048 sc1 lds
  buffer_load_dwordx4 v7, s[72:75], s7 offen offset:3072 sc1 lds
  s_branch Ll_101
  s_nop 0
Ll_102:
  s_waitcnt vmcnt(32)
  s_barrier
  s_waitcnt vmcnt(16)
  s_barrier
  s_waitcnt vmcnt(0)
  s_barrier
  s_barrier
  s_mov_b32 s11, 0
  s_mov_b32 s15, 65536
  s_mul_i32 s5, s76, 56
  s_mul_i32 s4, s79, 28
  s_add_u32 s5, s5, s4
  s_lshl_b32 s5, s5, 14
  s_add_u32 s5, s5, 11534336
  v_subrev_u32 v2, 4, v1
  v_cmp_le_u32 vcc, 28, v1
  s_nop 1
  v_cndmask_b32 v10, v1, v2, vcc
  v_subrev_u32 v3, 3, v10
  v_mov_b32 v9, 4
  v_cmp_le_u32 vcc, 14, v10
  v_subrev_u32 v2, 14, v10
  s_nop 0
  v_cndmask_b32 v3, v3, v2, vcc
  v_cndmask_b32_e64 v9, v9, 12, vcc
  v_cmp_le_u32 vcc, 21, v10
  v_subrev_u32 v2, 21, v10
  s_nop 0
  v_cndmask_b32 v3, v3, v2, vcc
  v_cndmask_b32_e64 v9, v9, 20, vcc
  s_sub_u32 s4, s80, s76
  s_and_b32 s4, s4, 7
  v_cmp_le_u32 vcc, s4, v3
  v_mov_b32 v2, s76
  s_nop 0
  v_addc_co_u32 v3, vcc, v3, v2, vcc
  v_and_b32 v3, 7, v3
  v_add_u32 v9, v9, v3
  v_add_u32 v2, v2, v1
  v_and_b32 v2, 3, v2
  v_subrev_u32 v3, 10, v1
  v_cmp_gt_u32 vcc, 4, v3
  s_nop 1
  v_cndmask_b32 v9, v9, v2, vcc
  s_add_u32 s4, s80, Lz1-Lz0+4
  v_lshl_add_u32 v2, v1, 3, s4
  v_cmp_gt_u32 vcc, 3, v1
  s_nop 1
  v_cndmask_b32_e64 v9, v9, v2, vcc
  v_lshl_add_u32 v9, v9, 14, s5
  s_mul_i32 s4, s79, 917504
  s_sub_u32 s4, 458752, s4
  v_add_u32_e64 v2, s4, v9
  v_cmp_le_u32 vcc, 28, v1
  s_nop 1
  v_cndmask_b32 v9, v9, v2, vcc
  s_nop 0
  v_readlane_b32 s7, v9, 3
  s_mov_b32 s11, 49152
  s_add_u32 s91, s91, 4
  s_lshl_b32 s4, s79, 3
  s_lshl_b32 s90, 0xff, s4
  s_bitset0_b32 s90, s77
  s_mov_b32 s89, 200000
  s_mov_b32 exec_lo, s90
  s_mov_b32 exec_hi, Lz1-Lz0+0
  buffer_load_dword v12, v8, s[40:43], s91 offen sc0 sc1
Lp_103:
  s_waitcnt vmcnt(0)
  v_cmp_ne_u32 vcc, 0, v12
  s_andn2_b32 s3, exec_lo, vcc_lo
  s_cbranch_scc0 Lp_104
  s_mov_b32 exec_lo, s3
  s_sleep 1
  buffer_load_dword v12, v8, s[40:43], s91 offen sc0 sc1
  s_sub_u32 s89, s89, 1
  s_cbranch_scc0 Lp_103
Lp_104:
  s_mov_b64 exec, -1
  s_mov_b32 s12, 3
  s_mov_b32 m0, s11
Ll_105:
  s_nop 0
  buffer_load_dwordx4 v4, s[40:43], s7 offen offset:0 sc1 lds
  buffer_load_dwordx4 v5, s[40:43], s7 offen offset:1024 sc1 lds
  buffer_load_dwordx4 v6, s[40:43], s7 offen offset:2048 sc1 lds
  buffer_load_dwordx4 v7, s[40:43], s7 offen offset:3072 sc1 lds
  s_add_u32 m0, s11, 4096
  s_nop 0
  s_add_u32 s5, s7, s13
  buffer_load_dwordx4 v4, s[40:43], s5 offen offset:0 sc1 lds
  buffer_load_dwordx4 v5, s[40:43], s5 offen offset:1024 sc1 lds
  buffer_load_dwordx4 v6, s[40:43], s5 offen offset:2048 sc1 lds
  buffer_load_dwordx4 v7, s[40:43], s5 offen offset:3072 sc1 lds
  s_add_u32 m0, s11, 8192
  s_nop 0
  s_add_u32 s3, s7, s95
  buffer_load_dwordx4 v4, s[40:43], s3 offen offset:0 sc1 lds
  buffer_load_dwordx4 v5, s[40:43], s3 offen offset:1024 sc1 lds
  buffer_load_dwordx4 v6, s[40:43], s3 offen offset:2048 sc1 lds
  buffer_load_dwordx4 v7, s[40:43], s3 offen offset:3072 sc1 lds
  s_add_u32 m0, s11, 12288
  s_add_u32 s5, s3, s13
  buffer_load_dwordx4 v4, s[40:43], s5 offen offset:0 sc1 lds
  s_add_u32 s12, s12, 1
  v_readlane_b32 s7, v9, s12
  s_add_u32 s11, s11, 16384
  buffer_load_dwordx4 v5, s[40:43], s5 offen offset:1024 sc1 lds
  s_cmp_eq_u32 s11, s15
  s_cselect_b32 s4, 65536, 0
  s_sub_u32 s11, s11, s4
  buffer_load_dwordx4 v6, s[40:43], s5 offen offset:2048 sc1 lds
  s_cmp_lg_u32 s12, Lz1-Lz0+4
  buffer_load_dwordx4 v7, s[40:43], s5 offen offset:3072 sc1 lds
  s_mov_b32 m0, s11
  s_cbranch_scc1 Ll_105
  s_waitcnt vmcnt(48)
  s_barrier
  s_waitcnt vmcnt(32)
  s_barrier
  buffer_load_dwordx4 v4, s[40:43], s7 offen offset:0 sc1 lds
  buffer_load_dwordx4 v5, s[40:43], s7 offen offset:1024 sc1 lds
  buffer_load_dwordx4 v6, s[40:43], s7 offen offset:2048 sc1 lds
  buffer_load_dwordx4 v7, s[40:43], s7 offen offset:3072 sc1 lds
Ll_109:
  s_add_u32 m0, s11, 4096
  s_nop 0
  s_add_u32 s5, s7, s13
  buffer_load_dwordx4 v4, s[40:43], s5 offen offset:0 sc1 lds
  buffer_load_dwordx4 v5, s[40:43], s5 offen offset:1024 sc1 lds
  buffer_load_dwordx4 v6, s[40:43], s5 offen offset:2048 sc1 lds
  buffer_load_dwordx4 v7, s[40:43], s5 offen offset:3072 sc1 lds
  s_add_u32 m0, s11, 8192
  s_nop 0
  s_add_u32 s3, s7, s95
  buffer_load_dwordx4 v4, s[40:43], s3 offen offset:0 sc1 lds
  buffer_load_dwordx4 v5, s[40:43], s3 offen offset:1024 sc1 lds
  buffer_load_dwordx4 v6, s[40:43], s3 offen offset:2048 sc1 lds
  buffer_load_dwordx4 v7, s[40:43], s3 offen offset:3072 sc1 lds
  s_add_u32 m0, s11, 12288
  s_add_u32 s5, s3, s13
  buffer_load_dwordx4 v4, s[40:43], s5 offen offset:0 sc1 lds
  s_add_u32 s12, s12, 1
  v_readlane_b32 s7, v9, s12
  s_add_u32 s11, s11, 16384
  buffer_load_dwordx4 v5, s[40:43], s5 offen offset:1024 sc1 lds
  s_cmp_eq_u32 s11, s15
  s_cselect_b32 s4, 65536, 0
  s_sub_u32 s11, s11, s4
  buffer_load_dwordx4 v6, s[40:43], s5 offen offset:2048 sc1 lds
  s_cmp_eq_u32 s12, Lz1-Lz0+32
  buffer_load_dwordx4 v7, s[40:43], s5 offen offset:3072 sc1 lds
  s_mov_b32 m0, s11
  s_cbranch_scc1 Ll_110
  s_waitcnt vmcnt(32)
  s_barrier
  buffer_load_dwordx4 v4, s[40:43], s7 offen offset:0 sc1 lds
  buffer_load_dwordx4 v5, s[40:43], s7 offen offset:1024 sc1 lds
  buffer_load_dwordx4 v6, s[40:43], s7 offen offset:2048 sc1 lds
  buffer_load_dwordx4 v7, s[40:43], s7 offen offset:3072 sc1 lds
  s_branch Ll_109
  s_nop 0
Ll_110:
  s_waitcnt vmcnt(32)
  s_barrier
  s_waitcnt vmcnt(16)
  s_barrier
  s_waitcnt vmcnt(0)
  s_barrier
  s_barrier
  s_cmp_lg_u32 s82, 0
  s_cbranch_scc1 L_lend
  s_mov_b32 s11, 0
  s_mov_b32 s15, 65536
  s_mul_i32 s5, s76, 16
  s_lshl_b32 s5, s5, 14
  s_add_u32 s5, s5, 35651584
  s_and_b32 s4, s76, 7
  s_add_u32 s6, s4, 1
  v_cmp_lt_u32 vcc, s6, v1
  v_add_u32 v9, s4, v1
  s_nop 0
  v_subbrev_co_u32 v9, vcc, 0, v9, vcc
  v_and_b32 v9, 7, v9
  v_subrev_u32 v2, 9, v1
  v_cmp_le_u32 vcc, s4, v2
  s_nop 1
  v_addc_co_u32 v2, vcc, 8, v2, vcc
  v_cmp_le_u32 vcc, 9, v1
  s_nop 1
  v_cndmask_b32 v9, v9, v2, vcc
  s_add_u32 s4, s4, Lz1-Lz0+8
  s_mov_b32 m0, s6
  s_nop 0
  v_writelane_b32 v9, s4, m0
  s_and_b32 s4, s76, 8
  v_xor_b32 v9, s4, v9
  v_cmp_eq_u32 vcc, s78, v9
  s_nop 0
  v_mov_b32_dpp v2, v9 row_shr:1 row_mask:0xf bank_mask:0xf
  s_ff1_i32_b32 s4, vcc_lo
  v_cmp_ge_u32 vcc, s4, v1
  s_nop 1
  v_cndmask_b32 v9, v9, v2, vcc
  v_writelane_b32 v9, s78, 0
  v_lshlrev_b32_e64 v11, 7, v9
  v_lshl_add_u32 v9, v9, 14, s5
  s_lshl_b32 s6, s76, Lz1-Lz0+14
  v_readlane_b32 s7, v9, 1
  s_mov_b32 s11, 16384
  s_add_u32 s91, s91, 8
  s_mov_b32 s90, 0x3e
  s_barrier
  s_mov_b32 s82, 1
  s_add_u32 s83, s83, 0
  s_add_u32 s87, s87, 32
  s_mov_b32 s89, 200000
  s_mov_b32 exec_lo, s90
  s_mov_b32 exec_hi, 0
  buffer_load_dword v12, v11, s[40:43], s91 offen sc0 sc1
Lp_111:
  s_waitcnt vmcnt(0)
  v_cmp_ne_u32 vcc, 0, v12
  s_andn2_b32 s3, exec_lo, vcc_lo
  s_cbranch_scc0 Lp_112
  s_mov_b32 exec_lo, s3
  s_sleep 1
  buffer_load_dword v12, v11, s[40:43], s91 offen sc0 sc1
  s_sub_u32 s89, s89, 1
  s_cbranch_scc0 Lp_111
Lp_112:
  s_mov_b64 exec, -1
  s_branch L_xlayer
  s_nop 0
L_s1:
  v_mov_b32 v11, 1
  v_mov_b32 v2, 156416
  ds_write_b128 v2, v[24:27]
  v_and_b32 v2, 31, v1
  v_lshlrev_b32 v5, 7, v2
  v_lshlrev_b32 v10, 3, v2
  v_lshrrev_b32 v3, 5, v1
  v_mul_u32_u24 v3, 320, v3
  v_add_u32_e64 v10, v3, v10
  v_add_u32 v10, 151552, v10
  v_bfe_u32 v3, v1, 3, 1
  v_and_b32 v2, 7, v1
  v_lshlrev_b32 v12, 9, v3
  v_lshl_add_u32 v12, v2, 4, v12
  v_mul_u32_u24 v3, 320, v3
  v_lshl_add_u32 v13, v2, 3, v3
  v_add_u32 v13, 151808, v13
  v_and_b32 v2, 15, v1
  v_lshlrev_b32 v8, 4, v2
  v_lshlrev_b32 v15, 6, v2
  v_and_b32 v3, 48, v1
  v_add_u32 v15, v15, v3
  v_and_b32 v2, 14, v1
  v_lshlrev_b32 v6, 2, v2
  v_lshlrev_b32 v14, 16, v1
  s_lshl_b32 s4, s77, 12
  s_lshl_b32 s5, s76, 7
  s_add_u32 s4, s4, s5
  v_add_u32 v14, s4, v14
  v_lshrrev_b32 v2, 2, v1
  v_lshlrev_b32 v22, 7, v2
  v_lshlrev_b32 v96, 6, v2
  v_and_b32 v2, 3, v1
  v_lshl_add_u32 v22, v2, 3, v22
  v_lshl_add_u32 v96, v2, 3, v96
  v_add_u32 v22, 65536, v22
  v_add_u32 v96, 90112, v96
  v_bfe_u32 v3, v1, 3, 2
  v_xor_b32_e64 v2, 0, v3
  v_lshl_add_u32 v16, v2, 5, v22
  v_xor_b32_e64 v2, 1, v3
  v_lshl_add_u32 v17, v2, 5, v22
  v_xor_b32_e64 v2, 2, v3
  v_lshl_add_u32 v18, v2, 5, v22
  v_xor_b32_e64 v2, 3, v3
  v_lshl_add_u32 v19, v2, 5, v22
  v_bfe_u32 v3, v1, 4, 1
  v_xor_b32_e64 v2, 0, v3
  v_lshl_add_u32 v20, v2, 5, v96
  v_xor_b32_e64 v2, 1, v3
  v_lshl_add_u32 v21, v2, 5, v96
  v_mov_b32 v22, 0x3f803f80
  s_mul_i32 s4, s76, 11
  s_lshr_b32 s4, s4, 5
  s_mul_i32 s4, s4, 3
  s_and_b32 s14, s76, 1
  s_mov_b32 s15, 32768
  s_mul_i32 s4, s14, 24576
  v_add_u32 v16, s4, v16
  v_add_u32 v17, s4, v17
  v_add_u32 v18, s4, v18
  v_add_u32 v19, s4, v19
  s_mov_b32 s98, 0x00010001
  s_mov_b32 s99, 0x00010001
  v_cndmask_b32_e64 v200, 0, v22, s[98:99]
  v_cndmask_b32_e64 v201, 0, v22, s[98:99]
  v_cndmask_b32_e64 v202, 0, v22, s[98:99]
  v_cndmask_b32_e64 v203, 0, v22, s[98:99]
  s_nop 0
  s_lshl_b64 s[98:99], s[98:99], 1
  v_cndmask_b32_e64 v204, 0, v22, s[98:99]
  v_cndmask_b32_e64 v205, 0, v22, s[98:99]
  v_cndmask_b32_e64 v206, 0, v22, s[98:99]
  v_cndmask_b32_e64 v207, 0, v22, s[98:99]
  s_nop 0
  s_lshl_b64 s[98:99], s[98:99], 1
  v_cndmask_b32_e64 v208, 0, v22, s[98:99]
  v_cndmask_b32_e64 v209, 0, v22, s[98:99]
  v_cndmask_b32_e64 v210, 0, v22, s[98:99]
  v_cndmask_b32_e64 v211, 0, v22, s[98:99]
  s_nop 0
  s_lshl_b64 s[98:99], s[98:99], 1
  v_cndmask_b32_e64 v212, 0, v22, s[98:99]
  v_cndmask_b32_e64 v213, 0, v22, s[98:99]
  v_cndmask_b32_e64 v214, 0, v22, s[98:99]
  v_cndmask_b32_e64 v215, 0, v22, s[98:99]
  s_nop 0
  s_lshl_b64 s[98:99], s[98:99], 1
  v_cndmask_b32_e64 v216, 0, v22, s[98:99]
  v_cndmask_b32_e64 v217, 0, v22, s[98:99]
  v_cndmask_b32_e64 v218, 0, v22, s[98:99]
  v_cndmask_b32_e64 v219, 0, v22, s[98:99]
  s_nop 0
  s_lshl_b64 s[98:99], s[98:99], 1
  v_cndmask_b32_e64 v220, 0, v22, s[98:99]
  v_cndmask_b32_e64 v221, 0, v22, s[98:99]
  v_cndmask_b32_e64 v222, 0, v22, s[98:99]
  v_cndmask_b32_e64 v223, 0, v22, s[98:99]
  s_nop 0
  s_lshl_b64 s[98:99], s[98:99], 1
  v_cndmask_b32_e64 v224, 0, v22, s[98:99]
  v_cndmask_b32_e64 v225, 0, v22, s[98:99]
  v_cndmask_b32_e64 v226, 0, v22, s[98:99]
  v_cndmask_b32_e64 v227, 0, v22, s[98:99]
  s_nop 0
  s_lshl_b64 s[98:99], s[98:99], 1
  v_cndmask_b32_e64 v228, 0, v22, s[98:99]
  v_cndmask_b32_e64 v229, 0, v22, s[98:99]
  v_cndmask_b32_e64 v230, 0, v22, s[98:99]
  v_cndmask_b32_e64 v231, 0, v22, s[98:99]
  s_nop 0
  s_lshl_b64 s[98:99], s[98:99], 1
  v_cndmask_b32_e64 v232, 0, v22, s[98:99]
  v_cndmask_b32_e64 v233, 0, v22, s[98:99]
  v_cndmask_b32_e64 v234, 0, v22, s[98:99]
  v_cndmask_b32_e64 v235, 0, v22, s[98:99]
  s_nop 0
  s_lshl_b64 s[98:99], s[98:99], 1
  v_cndmask_b32_e64 v236, 0, v22, s[98:99]
  v_cndmask_b32_e64 v237, 0, v22, s[98:99]
  v_cndmask_b32_e64 v238, 0, v22, s[98:99]
  v_cndmask_b32_e64 v239, 0, v22, s[98:99]
  s_nop 0
  s_lshl_b64 s[98:99], s[98:99], 1
  v_cndmask_b32_e64 v240, 0, v22, s[98:99]
  v_cndmask_b32_e64 v241, 0, v22, s[98:99]
  v_cndmask_b32_e64 v242, 0, v22, s[98:99]
  v_cndmask_b32_e64 v243, 0, v22, s[98:99]
  s_nop 0
  s_lshl_b64 s[98:99], s[98:99], 1
  v_cndmask_b32_e64 v244, 0, v22, s[98:99]
  v_cndmask_b32_e64 v245, 0, v22, s[98:99]
  v_cndmask_b32_e64 v246, 0, v22, s[98:99]
  v_cndmask_b32_e64 v247, 0, v22, s[98:99]
  s_lshl_b64 s[98:99], s[98:99], 1
  s_mov_b32 s56, s24
  s_and_b32 s57, s25, 0xffff
  s_mov_b32 s58, 7340032
  s_mov_b32 s59, 0x00020000
  s_nop 0
  s_mov_b32 s60, s28
  s_and_b32 s61, s29, 0xffff
  s_mov_b32 s62, 7340032
  s_mov_b32 s63, 0x00020000
  s_mul_i32 s12, s84, Lz1-Lz0+14
  s_add_u32 s12, s12, 20480
  s_mov_b32 s13, s12
  v_lshlrev_b32 v110, 7, v1
  s_mov_b32 s8, 0x00500005
  s_mov_b32 s9, 0x50000500
L_slayer:
  s_barrier
  s_cmp_lg_u32 s82, Lz1-Lz0+0
  s_cbranch_scc1 L_113
  buffer_load_dwordx4 v[128:131], v108, s[44:47], s7 offen offset:0
  buffer_load_dwordx4 v[132:135], v108, s[44:47], s7 offen offset:128
  buffer_load_dwordx4 v[136:139], v108, s[44:47], s7 offen offset:256
  buffer_load_dwordx4 v[140:143], v108, s[44:47], s7 offen offset:384
  buffer_load_dwordx4 v[144:147], v108, s[44:47], s7 offen offset:512
  buffer_load_dwordx4 v[148:151], v108, s[44:47], s7 offen offset:640
  buffer_load_dwordx4 v[152:155], v108, s[44:47], s7 offen offset:768
  buffer_load_dwordx4 v[156:159], v108, s[44:47], s7 offen offset:896
  buffer_load_dwordx4 v[160:163], v108, s[44:47], s7 offen offset:1024
  buffer_load_dwordx4 v[164:167], v108, s[44:47], s7 offen offset:1152
  buffer_load_dwordx4 v[168:171], v108, s[44:47], s7 offen offset:1280
  buffer_load_dwordx4 v[172:175], v108, s[44:47], s7 offen offset:1408
  buffer_load_dwordx4 v[176:179], v108, s[44:47], s7 offen offset:1536
  buffer_load_dwordx4 v[180:183], v108, s[44:47], s7 offen offset:1664
  buffer_load_dwordx4 v[184:187], v108, s[44:47], s7 offen offset:1792
  buffer_load_dwordx4 v[188:191], v108, s[44:47], s7 offen offset:1920
  s_waitcnt vmcnt(16)
  s_lshl_b32 s4, s76, 4
  s_mov_b64 exec, 1
  buffer_atomic_add v11, v24, s[68:71], s4 offen sc1
  s_mov_b64 exec, -1
L_113:
  s_cmp_le_u32 s14, 0
  s_cbranch_scc1 L_115
  s_barrier
L_115:
  s_cmp_le_u32 s14, 1
  s_cbranch_scc1 L_116
  s_barrier
L_116:
  s_cmp_lg_u32 s82, 0
  s_cbranch_scc1 L_117
  ds_read_b64_tr_b16 v[32:33], v16 offset:0
  ds_read_b64_tr_b16 v[34:35], v16 offset:2048
  ds_read_b64_tr_b16 v[36:37], v17 offset:0
  ds_read_b64_tr_b16 v[38:39], v17 offset:2048
  ds_read_b64_tr_b16 v[40:41], v18 offset:0
  ds_read_b64_tr_b16 v[42:43], v18 offset:2048
  ds_read_b64_tr_b16 v[44:45], v19 offset:0
  ds_read_b64_tr_b16 v[46:47], v19 offset:2048
  ds_read_b64_tr_b16 v[48:49], v16 offset:4096
  ds_read_b64_tr_b16 v[50:51], v16 offset:6144
  ds_read_b64_tr_b16 v[52:53], v17 offset:4096
  ds_read_b64_tr_b16 v[54:55], v17 offset:6144
  s_nop 0
  s_waitcnt lgkmcnt(4)
  ds_read_b64_tr_b16 v[56:57], v18 offset:4096
  ds_read_b64_tr_b16 v[58:59], v18 offset:6144
  ds_read_b64_tr_b16 v[60:61], v19 offset:4096
  ds_read_b64_tr_b16 v[62:63], v19 offset:6144
  v_add_u32 v16, 8192, v16
  v_add_u32 v17, 8192, v17
  v_add_u32 v18, 8192, v18
  v_add_u32 v19, 8192, v19
  s_nop 0
  s_waitcnt lgkmcnt(2)
  ds_read_b64_tr_b16 v[64:65], v16 offset:0
  ds_read_b64_tr_b16 v[66:67], v16 offset:2048
  ds_read_b64_tr_b16 v[68:69], v17 offset:0
  ds_read_b64_tr_b16 v[70:71], v17 offset:2048
  ds_read_b64_tr_b16 v[72:73], v18 offset:0
  ds_read_b64_tr_b16 v[74:75], v18 offset:2048
  ds_read_b64_tr_b16 v[76:77], v19 offset:0
  ds_read_b64_tr_b16 v[78:79], v19 offset:2048
  ds_read_b64_tr_b16 v[80:81], v16 offset:4096
  ds_read_b64_tr_b16 v[82:83], v16 offset:6144
  ds_read_b64_tr_b16 v[84:85], v17 offset:4096
  ds_read_b64_tr_b16 v[86:87], v17 offset:6144
  s_nop 0
  s_waitcnt lgkmcnt(4)
  ds_read_b64_tr_b16 v[88:89], v18 offset:4096
  ds_read_b64_tr_b16 v[90:91], v18 offset:6144
  ds_read_b64_tr_b16 v[92:93], v19 offset:4096
  ds_read_b64_tr_b16 v[94:95], v19 offset:6144
  v_add_u32 v16, 8192, v16
  v_add_u32 v17, 8192, v17
  v_add_u32 v18, 8192, v18
  v_add_u32 v19, 8192, v19
  v_mfma_f32_16x16x32_bf16 v[28:31], v[32:35], v[200:203], 0
  v_mfma_f32_16x16x32_bf16 v[28:31], v[36:39], v[204:207], v[28:31]
  v_mfma_f32_16x16x32_bf16 v[28:31], v[40:43], v[208:211], v[28:31]
  v_mfma_f32_16x16x32_bf16 v[28:31], v[44:47], v[212:215], v[28:31]
  v_mfma_f32_16x16x32_bf16 v[28:31], v[48:51], v[200:203], v[28:31]
  v_mfma_f32_16x16x32_bf16 v[28:31], v[52:55], v[204:207], v[28:31]
  v_mfma_f32_16x16x32_bf16 v[28:31], v[56:59], v[208:211], v[28:31]
  v_mfma_f32_16x16x32_bf16 v[28:31], v[60:63], v[212:215], v[28:31]
  s_nop 0
  s_waitcnt lgkmcnt(2)
  ds_read_b64_tr_b16 v[32:33], v16 offset:0
  ds_read_b64_tr_b16 v[34:35], v16 offset:2048
  ds_read_b64_tr_b16 v[36:37], v17 offset:0
  ds_read_b64_tr_b16 v[38:39], v17 offset:2048
  ds_read_b64_tr_b16 v[40:41], v18 offset:0
  ds_read_b64_tr_b16 v[42:43], v18 offset:2048
  ds_read_b64_tr_b16 v[44:45], v19 offset:0
  ds_read_b64_tr_b16 v[46:47], v19 offset:2048
  ds_read_b64_tr_b16 v[48:49], v16 offset:4096
  ds_read_b64_tr_b16 v[50:51], v16 offset:6144
  ds_read_b64_tr_b16 v[52:53], v17 offset:4096
  ds_read_b64_tr_b16 v[54:55], v17 offset:6144
  s_nop 0
  s_waitcnt lgkmcnt(4)
  ds_read_b64_tr_b16 v[56:57], v18 offset:4096
  ds_read_b64_tr_b16 v[58:59], v18 offset:6144
  ds_read_b64_tr_b16 v[60:61], v19 offset:4096
  ds_read_b64_tr_b16 v[62:63], v19 offset:6144
  v_mfma_f32_16x16x32_bf16 v[28:31], v[64:67], v[216:219], v[28:31]
  v_mfma_f32_16x16x32_bf16 v[28:31], v[68:71], v[220:223], v[28:31]
  v_mfma_f32_16x16x32_bf16 v[28:31], v[72:75], v[224:227], v[28:31]
  v_mfma_f32_16x16x32_bf16 v[28:31], v[76:79], v[228:231], v[28:31]
  v_mfma_f32_16x16x32_bf16 v[28:31], v[80:83], v[216:219], v[28:31]
  v_mfma_f32_16x16x32_bf16 v[28:31], v[84:87], v[220:223], v[28:31]
  v_mfma_f32_16x16x32_bf16 v[28:31], v[88:91], v[224:227], v[28:31]
  v_mfma_f32_16x16x32_bf16 v[28:31], v[92:95], v[228:231], v[28:31]
  s_waitcnt lgkmcnt(0)
L_117:
  s_barrier
  s_cmp_lg_u32 s82, 0
  s_cbranch_scc1 L_119
  v_mfma_f32_16x16x32_bf16 v[28:31], v[32:35], v[232:235], v[28:31]
  v_mfma_f32_16x16x32_bf16 v[28:31], v[36:39], v[236:239], v[28:31]
  v_mfma_f32_16x16x32_bf16 v[28:31], v[40:43], v[240:243], v[28:31]
  v_mfma_f32_16x16x32_bf16 v[28:31], v[44:47], v[244:247], v[28:31]
  v_mfma_f32_16x16x32_bf16 v[28:31], v[48:51], v[232:235], v[28:31]
  v_mfma_f32_16x16x32_bf16 v[28:31], v[52:55], v[236:239], v[28:31]
  v_mfma_f32_16x16x32_bf16 v[28:31], v[56:59], v[240:243], v[28:31]
  v_mfma_f32_16x16x32_bf16 v[28:31], v[60:63], v[244:247], v[28:31]
  s_lshl_b32 s5, s77, 14
  s_lshl_b32 s4, s76, 10
  s_add_u32 s5, s5, s4
  s_add_u32 s5, s5, 1114112
  s_nop 3
  buffer_store_dwordx4 v[28:31], v15, s[40:43], s5 offen sc0 sc1
  s_branch L_120
L_119:
  s_lshl_b32 s91, s84, 1
  s_add_u32 s91, s91, s87
  s_sub_u32 s91, s91, 16
  s_mov_b32 s16, 0xffff
  s_mov_b32 exec_lo, s16
  s_mov_b32 exec_hi, 0
  buffer_load_dword v7, v5, s[40:43], s91 offen sc0 sc1
  s_mov_b64 exec, -1
L_120:
  s_barrier
  s_cmp_lg_u32 s82, 0
  s_cbranch_scc1 L_121
  s_branch L_122
L_121:
  s_waitcnt vmcnt(0)
  s_mov_b32 s89, 200000
  s_mov_b32 exec_lo, s16
  s_mov_b32 exec_hi, 0
  s_branch Lp_124
Lp_123:
  buffer_load_dword v7, v5, s[40:43], s91 offen sc0 sc1
  s_waitcnt vmcnt(0)
Lp_124:
  v_cmp_ne_u32 vcc, 0, v7
  s_andn2_b32 s3, s16, vcc_lo
  s_cbranch_scc0 Lp_125
  s_sleep 1
  s_sub_u32 s89, s89, 1
  s_cbranch_scc0 Lp_123
Lp_125:
  s_mov_b64 exec, -1
  s_add_u32 s5, s84, s92
  buffer_load_dwordx2 v[96:97], v6, s[40:43], s5 offen offset:0 sc1
  buffer_load_dwordx2 v[98:99], v6, s[40:43], s5 offen offset:512 sc1
  buffer_load_dwordx2 v[100:101], v6, s[40:43], s5 offen offset:1024 sc1
  buffer_load_dwordx2 v[102:103], v6, s[40:43], s5 offen offset:1536 sc1
L_122:
  s_barrier
  s_cmp_gt_u32 s14, 0
  s_cbranch_scc1 L_126
  s_barrier
L_126:
  s_cmp_gt_u32 s14, Lz1-Lz0+1
  s_cbranch_scc1 L_127
  s_barrier
L_127:
  s_cmp_lg_u32 s82, 0
  s_cbranch_scc1 L_128
  s_waitcnt vmcnt(2)
  buffer_load_dword v9, v8, s[68:71], 0 offen sc0 sc1
  s_mov_b32 s72, s26
  s_and_b32 s73, s27, 0xffff
  s_mov_b32 s74, 7168
  s_mov_b32 s75, 0x00020000
  s_mul_i32 s4, s77, 448
  s_and_b32 s5, s77, Lz1-Lz0+1
  s_lshl_b32 s6, s5, 6
  s_add_u32 s6, s6, s4
  s_mul_i32 s5, s5, 384
  s_sub_u32 s5, s4, s5
  v_lshlrev_b32 v2, 1, v1
  v_lshrrev_b32 v3, 1, v2
  v_xor_b32 v3, v3, v2
  v_and_b32 v3, 16, v3
  v_mul_u32_u24 v3, 3, v3
  v_xor_b32_e64 v3, v3, v2
  buffer_load_ushort v104, v2, s[72:75], s6 offen offset:0
  buffer_load_ushort v105, v2, s[72:75], s6 offen offset:128
  buffer_load_ushort v106, v2, s[72:75], s6 offen offset:256
  buffer_load_ushort v107, v3, s[72:75], s5 offen offset:384
  s_nop 0
  s_mov_b32 s64, s30
  s_and_b32 s65, s31, 0xffff
  s_mov_b32 s66, 2048
  s_mov_b32 s67, 0x00020000
  s_lshl_b32 s4, s78, Lz1-Lz0+7
  buffer_load_ushort v108, v2, s[64:67], s4 offen
  v_mov_b32 v32, v22
  v_mov_b32 v33, v22
  v_mov_b32_e64 v34, v22
  v_mov_b32 v35, v22
  s_nop 1
  v_mfma_f32_16x16x32_bf16 v[96:99], v[32:35], v[128:131], 0
  v_mfma_f32_16x16x32_bf16 v[100:103], v[128:131], v[128:131], 0
  v_mfma_f32_16x16x32_bf16 v[96:99], v[32:35], v[132:135], v[96:99]
  v_mfma_f32_16x16x32_bf16 v[100:103], v[132:135], v[132:135], v[100:103]
  v_mfma_f32_16x16x32_bf16 v[96:99], v[32:35], v[136:139], v[96:99]
  v_mfma_f32_16x16x32_bf16 v[100:103], v[136:139], v[136:139], v[100:103]
  v_mfma_f32_16x16x32_bf16 v[96:99], v[32:35], v[140:143], v[96:99]
  v_mfma_f32_16x16x32_bf16 v[100:103], v[140:143], v[140:143], v[100:103]
L_128:
  s_barrier
  s_cmp_lg_u32 s82, Lz1-Lz0+0
  s_cbranch_scc1 L_130
  v_mfma_f32_16x16x32_bf16 v[96:99], v[32:35], v[144:147], v[96:99]
  v_mfma_f32_16x16x32_bf16 v[100:103], v[144:147], v[144:147], v[100:103]
  v_mfma_f32_16x16x32_bf16 v[96:99], v[32:35], v[148:151], v[96:99]
  v_mfma_f32_16x16x32_bf16 v[100:103], v[148:151], v[148:151], v[100:103]
  v_mfma_f32_16x16x32_bf16 v[96:99], v[32:35], v[152:155], v[96:99]
  v_mfma_f32_16x16x32_bf16 v[100:103], v[152:155], v[152:155], v[100:103]
  v_mfma_f32_16x16x32_bf16 v[96:99], v[32:35], v[156:159], v[96:99]
  v_mfma_f32_16x16x32_bf16 v[100:103], v[156:159], v[156:159], v[100:103]
L_130:
  s_barrier
  s_cmp_lg_u32 s82, Lz1-Lz0+0
  s_cbranch_scc1 L_132
  v_mfma_f32_16x16x32_bf16 v[96:99], v[32:35], v[160:163], v[96:99]
  v_mfma_f32_16x16x32_bf16 v[100:103], v[160:163], v[160:163], v[100:103]
  v_mfma_f32_16x16x32_bf16 v[96:99], v[32:35], v[164:167], v[96:99]
  v_mfma_f32_16x16x32_bf16 v[100:103], v[164:167], v[164:167], v[100:103]
  v_mfma_f32_16x16x32_bf16 v[96:99], v[32:35], v[168:171], v[96:99]
  v_mfma_f32_16x16x32_bf16 v[100:103], v[168:171], v[168:171], v[100:103]
  v_mfma_f32_16x16x32_bf16 v[96:99], v[32:35], v[172:175], v[96:99]
  v_mfma_f32_16x16x32_bf16 v[100:103], v[172:175], v[172:175], v[100:103]
  s_waitcnt vmcnt(0)
  s_mov_b32 s89, 200000
  s_branch Lg_135
Lg_134:
  buffer_load_dword v9, v8, s[68:71], 0 offen sc0 sc1
  s_waitcnt vmcnt(0)
Lg_135:
  v_cmp_eq_u32 vcc, 16, v9
  s_andn2_b32 s3, 0xffff, vcc_lo
  s_cbranch_scc0 Lg_136
  s_sleep 2
  s_sub_u32 s89, s89, 1
  s_cbranch_scc0 Lg_134
Lg_136:
  s_mov_b32 s5, 1835008
  s_mov_b64 exec, 0xffff
  buffer_store_dword v11, v14, s[40:43], s5 offen sc0 sc1
  s_mov_b64 exec, -1
  s_getpc_b64 s[4:5]
L_pc0:
  s_sub_u32 s4, s4, L_pc0-mega_kernel
  s_nop 0
  s_subb_u32 s5, s5, 0
  s_bfe_u32 s6, s2, 0x20003
  s_mul_i32 s6, s6, 10240
  v_lshl_add_u32 v3, v1, 4, s6
  v_mov_b32_e64 v119, s5
  v_min_u32 v118, L_end-mega_kernel-16, v3
  v_add_co_u32_e64 v116, vcc, s4, v118
  v_add_u32 v3, 0x400, v3
  s_nop 0
  v_addc_co_u32 v117, vcc, 0, v119, vcc
  global_load_dwordx4 v[112:115], v[116:117], off
  v_min_u32 v118, L_end-mega_kernel-16, v3
  v_add_co_u32_e64 v116, vcc, s4, v118
  v_add_u32 v3, 0x400, v3
  s_nop 0
  v_addc_co_u32 v117, vcc, 0, v119, vcc
  global_load_dwordx4 v[112:115], v[116:117], off
  v_min_u32 v118, L_end-mega_kernel-16, v3
  v_add_co_u32_e64 v116, vcc, s4, v118
  v_add_u32 v3, 0x400, v3
  s_nop 0
  v_addc_co_u32 v117, vcc, 0, v119, vcc
  global_load_dwordx4 v[112:115], v[116:117], off
  v_min_u32 v118, L_end-mega_kernel-16, v3
  v_add_co_u32_e64 v116, vcc, s4, v118
  v_add_u32 v3, 0x400, v3
  s_nop 0
  v_addc_co_u32 v117, vcc, 0, v119, vcc
  global_load_dwordx4 v[112:115], v[116:117], off
  v_min_u32 v118, L_end-mega_kernel-16, v3
  v_add_co_u32 v116, vcc, s4, v118
  s_nop 1
  v_addc_co_u32 v117, vcc, 0, v119, vcc
  global_load_dwordx4 v[112:115], v[116:117], off
L_132:
  s_barrier
  s_cmp_lg_u32 s82, 0
  s_cbranch_scc1 L_137
  v_mfma_f32_16x16x32_bf16 v[96:99], v[32:35], v[176:179], v[96:99]
  v_mfma_f32_16x16x32_bf16 v[100:103], v[176:179], v[176:179], v[100:103]
  v_mfma_f32_16x16x32_bf16 v[96:99], v[32:35], v[180:183], v[96:99]
  v_mfma_f32_16x16x32_bf16 v[100:103], v[180:183], v[180:183], v[100:103]
  v_mfma_f32_16x16x32_bf16 v[96:99], v[32:35], v[184:187], v[96:99]
  v_mfma_f32_16x16x32_bf16 v[100:103], v[184:187], v[184:187], v[100:103]
  v_mfma_f32_16x16x32_bf16 v[96:99], v[32:35], v[188:191], v[96:99]
  v_mfma_f32_16x16x32_bf16 v[100:103], v[188:191], v[188:191], v[100:103]
  s_getpc_b64 s[4:5]
L_pc1:
  s_sub_u32 s4, s4, L_pc1-mega_kernel
  s_subb_u32 s5, s5, 0
  s_bfe_u32 s6, s2, 0x20003
  s_mul_i32 s6, s6, 10240
  s_add_u32 s6, s6, 5120
  v_lshl_add_u32 v3, v1, 4, s6
  v_mov_b32_e64 v119, s5
  v_min_u32 v118, L_end-mega_kernel-16, v3
  v_add_co_u32_e64 v116, vcc, s4, v118
  v_add_u32 v3, 0x400, v3
  s_nop 0
  v_addc_co_u32 v117, vcc, 0, v119, vcc
  global_load_dwordx4 v[112:115], v[116:117], off
  v_min_u32 v118, L_end-mega_kernel-16, v3
  v_add_co_u32_e64 v116, vcc, s4, v118
  v_add_u32 v3, 0x400, v3
  s_nop 0
  v_addc_co_u32 v117, vcc, 0, v119, vcc
  global_load_dwordx4 v[112:115], v[116:117], off
  v_min_u32 v118, L_end-mega_kernel-16, v3
  v_add_co_u32_e64 v116, vcc, s4, v118
  v_add_u32 v3, 0x400, v3
  s_nop 0
  v_addc_co_u32 v117, vcc, 0, v119, vcc
  global_load_dwordx4 v[112:115], v[116:117], off
  v_min_u32 v118, L_end-mega_kernel-16, v3
  v_add_co_u32_e64 v116, vcc, s4, v118
  v_add_u32 v3, 0x400, v3
  s_nop 0
  v_addc_co_u32 v117, vcc, 0, v119, vcc
  global_load_dwordx4 v[112:115], v[116:117], off
  v_min_u32 v118, L_end-mega_kernel-16, v3
  v_add_co_u32 v116, vcc, s4, v118
  s_nop 1
  v_addc_co_u32_e64 v117, vcc, 0, v119, vcc
  global_load_dwordx4 v[112:115], v[116:117], off
  s_mov_b32 s98, 0xaaaaaaaa
  s_mov_b32 s99, 0xaaaaaaaa
  v_cndmask_b32_e64 v100, v100, v101, s[98:99]
  v_cndmask_b32_e64 v102, v102, v103, s[98:99]
  s_mov_b32 s98, 0xcccccccc
  s_mov_b32 s99, 0xcccccccc
  v_cndmask_b32_e64 v97, v100, v102, s[98:99]
  v_add_f32_dpp v96, v96, v96 quad_perm:[1,0,3,2] row_mask:0xf bank_mask:0xf
  s_nop 0
  v_add_f32_dpp v97, v97, v97 quad_perm:[1,0,3,2] row_mask:0xf bank_mask:0xf
  s_branch L_138
L_137:
  s_waitcnt vmcnt(0)
  v_add_f32 v96, v96, v100
  v_add_f32 v97, v97, v101
  v_add_f32 v98, v98, v102
  v_add_f32 v99, v99, v103
  v_add_f32 v96, v96, v98
  v_add_f32 v97, v97, v99
  s_nop 0
  v_add_f32_dpp v96, v96, v96 row_ror:8 row_mask:0xf bank_mask:0xf
  v_add_f32_dpp v97, v97, v97 row_ror:8 row_mask:0xf bank_mask:0xf
  v_mov_b32 v98, v96
  v_mov_b32 v99, v97
  s_nop 0
  v_permlane16_swap_b32 v96, v98
  v_permlane16_swap_b32 v97, v99
  v_add_f32 v96, v96, v98
  v_add_f32 v97, v97, v99
  v_mov_b32 v98, v96
  v_mov_b32 v99, v97
  s_nop 0
  v_permlane32_swap_b32 v96, v98
  v_permlane32_swap_b32 v97, v99
  v_add_f32 v96, v96, v98
  v_add_f32 v97, v97, v99
L_138:
  v_mul_f32 v96, 0x3a800000, v96
  v_mul_f32 v97, 0x3a800000, v97
  v_fma_f32 v98, -v96, v96, v97
  v_max_f32_e64 v98, 0, v98
  v_add_f32 v98, 0x3727c5ac, v98
  v_rsq_f32 v98, v98
  s_nop 0
  v_mul_f32 v99, v96, v98
  s_mov_b64 exec, s[8:9]
  buffer_store_dwordx2 v[98:99], v6, s[40:43], s10 offen sc0 sc1
  s_mov_b64 exec, -1
  s_barrier
  s_cmp_lg_u32 s82, 0
  s_cbranch_scc1 L_139
  v_lshlrev_b32_e64 v6, 3, v1
  s_mov_b64 s[8:9], 0xff
  s_lshl_b32 s91, s84, Lz1-Lz0+1
  s_add_u32 s91, s91, 1835008
  s_mov_b32 exec_lo, 0xffff
  s_mov_b32 exec_hi, Lz1-Lz0+0
  buffer_load_dword v7, v5, s[40:43], s91 offen sc0 sc1
  s_mov_b64 exec, -1
L_139:
  s_barrier
  s_barrier
  s_waitcnt vmcnt(0)
  s_and_b32 s5, s10, 0xfffffc00
  buffer_load_dwordx4 v[120:123], v4, s[40:43], s5 offen sc1
  s_cmp_lg_u32 s82, 0
  s_cbranch_scc1 L_141
  s_mov_b32 s89, 200000
  s_mov_b32 exec_lo, 0xffff
  s_mov_b32 exec_hi, 0
  s_branch Lp_144
Lp_143:
  buffer_load_dword v7, v5, s[40:43], s91 offen sc0 sc1
  s_waitcnt vmcnt(0)
Lp_144:
  v_cmp_ne_u32 vcc, 0, v7
  s_andn2_b32 s3, 0xffff, vcc_lo
  s_cbranch_scc0 Lp_145
  s_sleep 1
  s_sub_u32 s89, s89, 1
  s_cbranch_scc0 Lp_143
Lp_145:
  s_mov_b64 exec, -1
  s_lshl_b32 s5, s77, 14
  s_add_u32 s5, s5, 1114112
  buffer_load_dwordx4 v[192:195], v4, s[40:43], s5 offen offset:0 sc1
  buffer_load_dwordx4 v[196:199], v4, s[40:43], s5 offen offset:1024 sc1
  buffer_load_dwordx4 v[200:203], v4, s[40:43], s5 offen offset:2048 sc1
  buffer_load_dwordx4 v[204:207], v4, s[40:43], s5 offen offset:3072 sc1
  s_add_u32 s5, s5, 4096
  buffer_load_dwordx4 v[208:211], v4, s[40:43], s5 offen offset:0 sc1
  buffer_load_dwordx4 v[212:215], v4, s[40:43], s5 offen offset:1024 sc1
  buffer_load_dwordx4 v[216:219], v4, s[40:43], s5 offen offset:2048 sc1
  buffer_load_dwordx4 v[220:223], v4, s[40:43], s5 offen offset:3072 sc1
L_141:
  s_barrier
  s_cmp_lg_u32 s82, 0
  s_cbranch_scc1 L_146
  s_lshl_b32 s5, s77, 14
  s_add_u32 s5, s5, 1122304
  buffer_load_dwordx4 v[224:227], v4, s[40:43], s5 offen offset:0 sc1
  buffer_load_dwordx4 v[228:231], v4, s[40:43], s5 offen offset:1024 sc1
  buffer_load_dwordx4 v[232:235], v4, s[40:43], s5 offen offset:2048 sc1
  buffer_load_dwordx4 v[236:239], v4, s[40:43], s5 offen offset:3072 sc1
  s_add_u32 s5, s5, 4096
  buffer_load_dwordx4 v[240:243], v4, s[40:43], s5 offen offset:0 sc1
  buffer_load_dwordx4 v[244:247], v4, s[40:43], s5 offen offset:1024 sc1
  buffer_load_dwordx4 v[248:251], v4, s[40:43], s5 offen offset:2048 sc1
  buffer_load_dwordx4 v[252:255], v4, s[40:43], s5 offen offset:3072 sc1
L_146:
  s_barrier
  s_cmp_lg_u32 s82, 0
  s_cbranch_scc1 L_148
  s_waitcnt vmcnt(16)
  s_branch L_149
L_148:
  s_waitcnt vmcnt(0)
L_149:
  s_mov_b32 s89, 200000
  s_branch Lp_151
  s_nop 0
Lp_150:
  s_and_b32 s5, s10, 0xfffffc00
  buffer_load_dwordx4 v[120:123], v4, s[40:43], s5 offen sc1
  s_waitcnt vmcnt(0)
Lp_151:
  v_min_u32 v2, v120, v122
  v_cmp_eq_u32 vcc, 0, v2
  s_cmp_eq_u64 vcc, 0
  s_cbranch_scc1 Lp_152
  s_sleep 1
  s_sub_u32 s89, s89, 1
  s_cbranch_scc0 Lp_150
Lp_152:
  s_and_b32 s5, s10, 0xfffffc00
  s_mov_b32 m0, 151552
  s_nop 0
  buffer_load_dword v6, s[40:43], s5 offen offset:0 sc1 lds
  s_mov_b32 m0, 152188
  s_nop 0
  buffer_load_dword v6, s[40:43], s5 offen offset:4 sc1 lds
  s_mov_b32 m0, 151360
  s_nop 0
  buffer_load_dword v6, s[40:43], s5 offen offset:512 sc1 lds
  s_mov_b32 m0, 151996
  s_nop 0
  buffer_load_dword v6, s[40:43], s5 offen offset:516 sc1 lds
  s_add_u32 s10, s10, 16384
  s_cmp_lg_u32 s82, 0
  s_cbranch_scc1 L_153
  buffer_load_dword v109, v110, s[56:59], s12 offen
  s_sub_u32 s12, s12, 8192
L_153:
  s_barrier
  s_cmp_lg_u32 s82, 0
  s_cbranch_scc1 L_155
  s_cmp_lg_u32 s82, 0
  s_cbranch_scc1 L_157
  s_waitcnt vmcnt(1)
  s_branch L_158
L_157:
  s_waitcnt vmcnt(0)
L_158:
  v_add_f32 v192, v192, v224
  v_add_f32 v193, v193, v225
  v_add_f32 v194, v194, v226
  v_add_f32 v195, v195, v227
  v_add_f32 v196, v196, v228
  v_add_f32 v197, v197, v229
  v_add_f32 v198, v198, v230
  v_add_f32 v199, v199, v231
  v_add_f32 v200, v200, v232
  v_add_f32 v201, v201, v233
  v_add_f32 v202, v202, v234
  v_add_f32 v203, v203, v235
  v_add_f32 v204, v204, v236
  v_add_f32 v205, v205, v237
  v_add_f32 v206, v206, v238
  v_add_f32 v207, v207, v239
  v_add_f32 v208, v208, v240
  v_add_f32 v209, v209, v241
  v_add_f32 v210, v210, v242
  v_add_f32 v211, v211, v243
  v_add_f32 v212, v212, v244
  v_add_f32 v213, v213, v245
  v_add_f32 v214, v214, v246
  v_add_f32 v215, v215, v247
  v_add_f32 v216, v216, v248
  v_add_f32 v217, v217, v249
  v_add_f32 v218, v218, v250
  v_add_f32 v219, v219, v251
  v_add_f32 v220, v220, v252
  v_add_f32 v221, v221, v253
  v_add_f32 v222, v222, v254
  v_add_f32 v223, v223, v255
  v_add_f32 v192, v192, v208
  v_add_f32 v193, v193, v209
  v_add_f32 v194, v194, v210
  v_add_f32 v195, v195, v211
  v_add_f32 v196, v196, v212
  v_add_f32 v197, v197, v213
  v_add_f32 v198, v198, v214
  v_add_f32 v199, v199, v215
  v_add_f32 v200, v200, v216
  v_add_f32 v201, v201, v217
  v_add_f32 v202, v202, v218
  v_add_f32 v203, v203, v219
  v_add_f32 v204, v204, v220
  v_add_f32 v205, v205, v221
  v_add_f32 v206, v206, v222
  v_add_f32 v207, v207, v223
  v_add_f32 v192, v192, v200
  v_add_f32 v193, v193, v201
  v_add_f32 v194, v194, v202
  v_add_f32 v195, v195, v203
  v_add_f32 v196, v196, v204
  v_add_f32 v197, v197, v205
  v_add_f32 v198, v198, v206
  v_add_f32 v199, v199, v207
  v_add_f32 v192, v192, v196
  v_add_f32 v193, v193, v197
  v_add_f32 v194, v194, v198
  v_add_f32 v195, v195, v199
  v_add_u32 v2, 153088, v4
  ds_write_b128 v2, v[192:195]
L_155:
  s_cmp_lg_u32 s82, 0
  s_cbranch_scc1 L_159
  buffer_load_dword v109, v110, s[56:59], s12 offen
  s_sub_u32 s12, s12, 8192
L_159:
  s_barrier
  s_cmp_lg_u32 s82, 0
  s_cbranch_scc1 L_161
  s_waitcnt vmcnt(2)
  s_branch L_162
  s_nop 0
L_161:
  s_waitcnt vmcnt(0)
L_162:
  s_waitcnt lgkmcnt(0)
  s_barrier
  s_cmp_lg_u32 s82, 0
  s_cbranch_scc1 L_163
  v_lshlrev_b32 v2, 2, v1
  v_add_u32 v2, 155136, v2
  v_lshlrev_b32_e64 v104, 16, v104
  v_mul_f32 v104, 0x3eeff558, v104
  ds_write_b32 v2, v104 offset:0
  v_lshlrev_b32_e64 v105, 16, v105
  v_mul_f32 v105, 0x3eeff558, v105
  ds_write_b32 v2, v105 offset:256
  v_lshlrev_b32_e64 v106, 16, v106
  v_mul_f32 v106, 0x3eeff558, v106
  ds_write_b32 v2, v106 offset:512
  v_lshlrev_b32_e64 v107, 16, v107
  v_mul_f32 v107, 0x3eeff558, v107
  ds_write_b32 v2, v107 offset:768
  v_lshlrev_b32_e64 v108, 16, v108
  ds_write_b32 v2, v108 offset:1024
  v_lshrrev_b32 v2, 2, v1
  v_lshlrev_b32 v22, 7, v2
  v_lshlrev_b32 v96, 6, v2
  v_and_b32 v2, 3, v1
  v_lshl_add_u32 v22, v2, 3, v22
  v_lshl_add_u32 v96, v2, 3, v96
  v_add_u32 v22, 65536, v22
  v_add_u32 v96, 90112, v96
  v_bfe_u32 v3, v1, 3, 2
  v_xor_b32_e64 v2, 0, v3
  v_lshl_add_u32 v16, v2, 5, v22
  v_xor_b32_e64 v2, 1, v3
  v_lshl_add_u32 v17, v2, 5, v22
  v_xor_b32_e64 v2, 2, v3
  v_lshl_add_u32 v18, v2, 5, v22
  v_xor_b32_e64 v2, 3, v3
  v_lshl_add_u32 v19, v2, 5, v22
  v_bfe_u32 v3, v1, 4, 1
  v_xor_b32_e64 v2, 0, v3
  v_lshl_add_u32 v20, v2, 5, v96
  v_xor_b32_e64 v2, 1, v3
  v_lshl_add_u32 v21, v2, 5, v96
  v_mov_b32 v22, 0x3f803f80
  s_mov_b32 s98, 0x00010001
  s_mov_b32 s99, 0x00010001
  v_cndmask_b32_e64 v200, 0, v22, s[98:99]
  v_cndmask_b32_e64 v201, 0, v22, s[98:99]
  v_cndmask_b32_e64 v202, 0, v22, s[98:99]
  v_cndmask_b32_e64 v203, 0, v22, s[98:99]
  s_nop 0
  s_lshl_b64 s[98:99], s[98:99], 1
  v_cndmask_b32_e64 v204, 0, v22, s[98:99]
  v_cndmask_b32_e64 v205, 0, v22, s[98:99]
  v_cndmask_b32_e64 v206, 0, v22, s[98:99]
  v_cndmask_b32_e64 v207, 0, v22, s[98:99]
  s_nop 0
  s_lshl_b64 s[98:99], s[98:99], 1
  v_cndmask_b32_e64 v208, 0, v22, s[98:99]
  v_cndmask_b32_e64 v209, 0, v22, s[98:99]
  v_cndmask_b32_e64 v210, 0, v22, s[98:99]
  v_cndmask_b32_e64 v211, 0, v22, s[98:99]
  s_nop 0
  s_lshl_b64 s[98:99], s[98:99], 1
  v_cndmask_b32_e64 v212, 0, v22, s[98:99]
  v_cndmask_b32_e64 v213, 0, v22, s[98:99]
  v_cndmask_b32_e64 v214, 0, v22, s[98:99]
  v_cndmask_b32_e64 v215, 0, v22, s[98:99]
  s_nop 0
  s_lshl_b64 s[98:99], s[98:99], 1
  v_cndmask_b32_e64 v216, 0, v22, s[98:99]
  v_cndmask_b32_e64 v217, 0, v22, s[98:99]
  v_cndmask_b32_e64 v218, 0, v22, s[98:99]
  v_cndmask_b32_e64 v219, 0, v22, s[98:99]
  s_nop 0
  s_lshl_b64 s[98:99], s[98:99], 1
  v_cndmask_b32_e64 v220, 0, v22, s[98:99]
  v_cndmask_b32_e64 v221, 0, v22, s[98:99]
  v_cndmask_b32_e64 v222, 0, v22, s[98:99]
  v_cndmask_b32_e64 v223, 0, v22, s[98:99]
  s_nop 0
  s_lshl_b64 s[98:99], s[98:99], 1
  v_cndmask_b32_e64 v224, 0, v22, s[98:99]
  v_cndmask_b32_e64 v225, 0, v22, s[98:99]
  v_cndmask_b32_e64 v226, 0, v22, s[98:99]
  v_cndmask_b32_e64 v227, 0, v22, s[98:99]
  s_nop 0
  s_lshl_b64 s[98:99], s[98:99], 1
  v_cndmask_b32_e64 v228, 0, v22, s[98:99]
  v_cndmask_b32_e64 v229, 0, v22, s[98:99]
  v_cndmask_b32_e64 v230, 0, v22, s[98:99]
  v_cndmask_b32_e64 v231, 0, v22, s[98:99]
  s_nop 0
  s_lshl_b64 s[98:99], s[98:99], 1
  v_cndmask_b32_e64 v232, 0, v22, s[98:99]
  v_cndmask_b32_e64 v233, 0, v22, s[98:99]
  v_cndmask_b32_e64 v234, 0, v22, s[98:99]
  v_cndmask_b32_e64 v235, 0, v22, s[98:99]
  s_nop 0
  s_lshl_b64 s[98:99], s[98:99], 1
  v_cndmask_b32_e64 v236, 0, v22, s[98:99]
  v_cndmask_b32_e64 v237, 0, v22, s[98:99]
  v_cndmask_b32_e64 v238, 0, v22, s[98:99]
  v_cndmask_b32_e64 v239, 0, v22, s[98:99]
  s_nop 0
  s_lshl_b64 s[98:99], s[98:99], 1
  v_cndmask_b32_e64 v240, 0, v22, s[98:99]
  v_cndmask_b32_e64 v241, 0, v22, s[98:99]
  v_cndmask_b32_e64 v242, 0, v22, s[98:99]
  v_cndmask_b32_e64 v243, 0, v22, s[98:99]
  s_nop 0
  s_lshl_b64 s[98:99], s[98:99], 1
  v_cndmask_b32_e64 v244, 0, v22, s[98:99]
  v_cndmask_b32_e64 v245, 0, v22, s[98:99]
  v_cndmask_b32_e64 v246, 0, v22, s[98:99]
  v_cndmask_b32_e64 v247, 0, v22, s[98:99]
  s_nop 0
  s_lshl_b64 s[98:99], s[98:99], 1
  v_cndmask_b32_e64 v248, 0, v22, s[98:99]
  v_cndmask_b32_e64 v249, 0, v22, s[98:99]
  v_cndmask_b32_e64 v250, 0, v22, s[98:99]
  v_cndmask_b32_e64 v251, 0, v22, s[98:99]
  s_nop 0
  s_lshl_b64 s[98:99], s[98:99], 1
  v_cndmask_b32_e64 v252, 0, v22, s[98:99]
  v_cndmask_b32_e64 v253, 0, v22, s[98:99]
  v_cndmask_b32_e64 v254, 0, v22, s[98:99]
  v_cndmask_b32_e64 v255, 0, v22, s[98:99]
  s_lshl_b64 s[98:99], s[98:99], 1
L_163:
  s_lshl_b32 s91, s84, 1
  s_add_u32 s91, s91, s87
  s_barrier
  s_mov_b32 exec_lo, 0xffff
  s_mov_b32 exec_hi, 0
  buffer_load_dword v7, v5, s[40:43], s91 offen sc0 sc1
  s_mov_b64 exec, -1
  s_barrier
  s_barrier
  s_barrier
  s_waitcnt vmcnt(0)
  s_mov_b32 s89, 200000
  s_mov_b32 exec_lo, 0xffff
  s_mov_b32 exec_hi, 0
  s_branch Lp_166
Lp_165:
  buffer_load_dword v7, v5, s[40:43], s91 offen sc0 sc1
  s_waitcnt vmcnt(0)
Lp_166:
  v_cmp_ne_u32 vcc, 0, v7
  s_andn2_b32 s3, 0xffff, vcc_lo
  s_cbranch_scc0 Lp_167
  s_sleep 1
  s_sub_u32 s89, s89, 1
  s_cbranch_scc0 Lp_165
Lp_167:
  s_mov_b64 exec, -1
  s_barrier
  s_barrier
  s_barrier
  s_barrier
  s_barrier
  s_barrier
  s_barrier
  s_barrier
  s_barrier
  s_barrier
  s_barrier
  s_barrier
  s_barrier
  s_add_u32 s92, s83, 31457280
  s_add_u32 s91, s91, 4
  s_sub_u32 s16, s78, s76
  s_add_u32 s16, s16, 1
  s_and_b32 s16, s16, 15
  s_barrier
  s_cmp_lg_u32 s82, 0
  s_cbranch_scc1 L_168
  s_cmp_eq_u32 s16, 1
  s_cselect_b32 s4, 0, 28672
  v_add_u32 v112, s4, v16
  v_add_u32 v113, s4, v17
  v_add_u32 v114, s4, v18
  v_add_u32 v115, s4, v19
  v_add_u32 v116, s4, v20
  v_add_u32 v117, s4, v21
  ds_read_b64_tr_b16 v[32:33], v112 offset:0
  ds_read_b64_tr_b16 v[34:35], v112 offset:2048
  ds_read_b64_tr_b16 v[36:37], v113 offset:0
  ds_read_b64_tr_b16 v[38:39], v113 offset:2048
  ds_read_b64_tr_b16 v[40:41], v114 offset:0
  ds_read_b64_tr_b16 v[42:43], v114 offset:2048
  ds_read_b64_tr_b16 v[44:45], v115 offset:0
  ds_read_b64_tr_b16 v[46:47], v115 offset:2048
  ds_read_b64_tr_b16 v[48:49], v112 offset:4096
  ds_read_b64_tr_b16 v[50:51], v112 offset:6144
  ds_read_b64_tr_b16 v[52:53], v113 offset:4096
  ds_read_b64_tr_b16 v[54:55], v113 offset:6144
  s_nop 0
  s_waitcnt lgkmcnt(6)
  ds_read_b64_tr_b16 v[56:57], v114 offset:4096
  ds_read_b64_tr_b16 v[58:59], v114 offset:6144
  ds_read_b64_tr_b16 v[60:61], v115 offset:4096
  ds_read_b64_tr_b16 v[62:63], v115 offset:6144
  s_nop 0
  s_waitcnt lgkmcnt(6)
  ds_read_b64_tr_b16 v[64:65], v112 offset:8192
  ds_read_b64_tr_b16 v[66:67], v112 offset:10240
  ds_read_b64_tr_b16 v[68:69], v113 offset:8192
  ds_read_b64_tr_b16 v[70:71], v113 offset:10240
  ds_read_b64_tr_b16 v[72:73], v114 offset:8192
  ds_read_b64_tr_b16 v[74:75], v114 offset:10240
  ds_read_b64_tr_b16 v[76:77], v115 offset:8192
  ds_read_b64_tr_b16 v[78:79], v115 offset:10240
  s_nop 0
  s_waitcnt lgkmcnt(8)
  v_mfma_f32_16x16x32_bf16 v[28:31], v[32:35], v[200:203], 0
  v_mfma_f32_16x16x32_bf16 v[28:31], v[36:39], v[204:207], v[28:31]
  v_mfma_f32_16x16x32_bf16 v[28:31], v[40:43], v[208:211], v[28:31]
  v_mfma_f32_16x16x32_bf16 v[28:31], v[44:47], v[212:215], v[28:31]
  v_mfma_f32_16x16x32_bf16 v[28:31], v[48:51], v[200:203], v[28:31]
  v_mfma_f32_16x16x32_bf16 v[28:31], v[52:55], v[204:207], v[28:31]
  v_mfma_f32_16x16x32_bf16 v[28:31], v[56:59], v[208:211], v[28:31]
  v_mfma_f32_16x16x32_bf16 v[28:31], v[60:63], v[212:215], v[28:31]
  s_nop 0
  s_waitcnt lgkmcnt(7)
  ds_read_b64_tr_b16 v[80:81], v112 offset:12288
  ds_read_b64_tr_b16 v[82:83], v112 offset:14336
  ds_read_b64_tr_b16 v[84:85], v113 offset:12288
  ds_read_b64_tr_b16 v[86:87], v113 offset:14336
  ds_read_b64_tr_b16 v[88:89], v114 offset:12288
  ds_read_b64_tr_b16 v[90:91], v114 offset:14336
  ds_read_b64_tr_b16 v[92:93], v115 offset:12288
  ds_read_b64_tr_b16 v[94:95], v115 offset:14336
  s_nop 0
  s_waitcnt lgkmcnt(6)
  ds_read_b64_tr_b16 v[128:129], v112 offset:16384
  ds_read_b64_tr_b16 v[130:131], v112 offset:18432
  ds_read_b64_tr_b16 v[132:133], v113 offset:16384
  ds_read_b64_tr_b16 v[134:135], v113 offset:18432
  ds_read_b64_tr_b16 v[136:137], v114 offset:16384
  ds_read_b64_tr_b16 v[138:139], v114 offset:18432
  ds_read_b64_tr_b16 v[140:141], v115 offset:16384
  ds_read_b64_tr_b16 v[142:143], v115 offset:18432
  s_nop 0
  s_waitcnt lgkmcnt(8)
  v_mfma_f32_16x16x32_bf16 v[28:31], v[64:67], v[216:219], v[28:31]
  v_mfma_f32_16x16x32_bf16 v[28:31], v[68:71], v[220:223], v[28:31]
  v_mfma_f32_16x16x32_bf16 v[28:31], v[72:75], v[224:227], v[28:31]
  v_mfma_f32_16x16x32_bf16 v[28:31], v[76:79], v[228:231], v[28:31]
  v_mfma_f32_16x16x32_bf16 v[28:31], v[80:83], v[216:219], v[28:31]
  v_mfma_f32_16x16x32_bf16 v[28:31], v[84:87], v[220:223], v[28:31]
  v_mfma_f32_16x16x32_bf16 v[28:31], v[88:91], v[224:227], v[28:31]
  v_mfma_f32_16x16x32_bf16 v[28:31], v[92:95], v[228:231], v[28:31]
  s_nop 0
  s_waitcnt lgkmcnt(7)
  ds_read_b64_tr_b16 v[144:145], v112 offset:20480
  ds_read_b64_tr_b16 v[146:147], v112 offset:22528
  ds_read_b64_tr_b16 v[148:149], v113 offset:20480
  ds_read_b64_tr_b16 v[150:151], v113 offset:22528
  ds_read_b64_tr_b16 v[152:153], v114 offset:20480
  ds_read_b64_tr_b16 v[154:155], v114 offset:22528
  ds_read_b64_tr_b16 v[156:157], v115 offset:20480
  ds_read_b64_tr_b16 v[158:159], v115 offset:22528
  s_nop 0
  s_waitcnt lgkmcnt(6)
  ds_read_b64_tr_b16 v[160:161], v116 offset:0
  ds_read_b64_tr_b16 v[162:163], v116 offset:1024
  ds_read_b64_tr_b16 v[164:165], v117 offset:0
  ds_read_b64_tr_b16 v[166:167], v117 offset:1024
  ds_read_b64_tr_b16 v[176:177], v116 offset:2048
  ds_read_b64_tr_b16 v[178:179], v116 offset:3072
  ds_read_b64_tr_b16 v[180:181], v117 offset:2048
  ds_read_b64_tr_b16 v[182:183], v117 offset:3072
  s_nop 0
  s_waitcnt lgkmcnt(8)
  v_mfma_f32_16x16x32_bf16 v[28:31], v[128:131], v[232:235], v[28:31]
  v_mfma_f32_16x16x32_bf16 v[28:31], v[132:135], v[236:239], v[28:31]
  v_mfma_f32_16x16x32_bf16 v[28:31], v[136:139], v[240:243], v[28:31]
  v_mfma_f32_16x16x32_bf16 v[28:31], v[140:143], v[244:247], v[28:31]
  v_mfma_f32_16x16x32_bf16 v[28:31], v[144:147], v[232:235], v[28:31]
  v_mfma_f32_16x16x32_bf16 v[28:31], v[148:151], v[236:239], v[28:31]
  v_mfma_f32_16x16x32_bf16 v[28:31], v[152:155], v[240:243], v[28:31]
  v_mfma_f32_16x16x32_bf16 v[28:31], v[156:159], v[244:247], v[28:31]
  s_waitcnt lgkmcnt(7)
  s_waitcnt lgkmcnt(0)
  v_mfma_f32_16x16x32_bf16 v[28:31], v[160:163], v[248:251], v[28:31]
  v_mfma_f32_16x16x32_bf16 v[28:31], v[164:167], v[252:255], v[28:31]
  v_mfma_f32_16x16x32_bf16 v[28:31], v[176:179], v[248:251], v[28:31]
  v_mfma_f32_16x16x32_bf16 v[28:31], v[180:183], v[252:255], v[28:31]
  s_lshl_b32 s5, s77, Lz1-Lz0+14
  s_lshl_b32 s4, s76, 10
  s_add_u32 s5, s5, s4
  s_add_u32 s5, s5, 1376256
  s_nop 3
  buffer_store_dwordx4 v[28:31], v15, s[40:43], s5 offen sc0 sc1
L_168:
  s_barrier
  s_mov_b32 exec_lo, 0xffff
  s_mov_b32 exec_hi, 0
  buffer_load_dword v7, v5, s[40:43], s91 offen sc0 sc1
  s_mov_b64 exec, -1
  s_barrier
  s_waitcnt vmcnt(0)
  s_mov_b32 s89, 200000
  s_mov_b32 exec_lo, 0xffff
  s_mov_b32 exec_hi, 0
  s_branch Lp_171
Lp_170:
  buffer_load_dword v7, v5, s[40:43], s91 offen sc0 sc1
  s_waitcnt vmcnt(0)
Lp_171:
  v_cmp_ne_u32 vcc, 0, v7
  s_andn2_b32 s3, 0xffff, vcc_lo
  s_cbranch_scc0 Lp_172
  s_sleep 1
  s_sub_u32 s89, s89, Lz1-Lz0+1
  s_cbranch_scc0 Lp_170
Lp_172:
  s_mov_b64 exec, -1
  s_cmp_lg_u32 s82, 0
  s_cbranch_scc1 L_173
  s_mov_b32 s5, 1835012
  s_mov_b64 exec, 0xffff
  buffer_store_dword v11, v14, s[40:43], s5 offen sc0 sc1
  s_mov_b64 exec, -1
L_173:
  s_add_u32 s5, s84, s92
  buffer_load_dwordx2 v[96:97], v6, s[40:43], s5 offen offset:0 sc1
  buffer_load_dwordx2 v[98:99], v6, s[40:43], s5 offen offset:512 sc1
  buffer_load_dwordx2 v[100:101], v6, s[40:43], s5 offen offset:1024 sc1
  buffer_load_dwordx2 v[102:103], v6, s[40:43], s5 offen offset:1536 sc1
  s_barrier
  s_barrier
  s_barrier
  s_waitcnt vmcnt(0)
  v_add_f32 v96, v96, v100
  v_add_f32 v97, v97, v101
  v_add_f32 v98, v98, v102
  v_add_f32 v99, v99, v103
  v_add_f32_e64 v96, v96, v98
  v_add_f32 v97, v97, v99
  s_nop 0
  v_add_f32_dpp v96, v96, v96 row_ror:8 row_mask:0xf bank_mask:0xf
  v_add_f32_dpp v97, v97, v97 row_ror:8 row_mask:0xf bank_mask:0xf
  v_mov_b32 v98, v96
  v_mov_b32 v99, v97
  s_nop 0
  v_permlane16_swap_b32 v96, v98
  v_permlane16_swap_b32 v97, v99
  v_add_f32 v96, v96, v98
  v_add_f32 v97, v97, v99
  v_mov_b32 v98, v96
  v_mov_b32 v99, v97
  s_nop 0
  v_permlane32_swap_b32 v96, v98
  v_permlane32_swap_b32 v97, v99
  v_add_f32 v96, v96, v98
  v_add_f32 v97, v97, v99
  v_mul_f32 v96, 0x3a800000, v96
  v_mul_f32 v97, 0x3a800000, v97
  v_fma_f32 v98, -v96, v96, v97
  v_max_f32_e64 v98, 0, v98
  v_add_f32 v98, 0x3727c5ac, v98
  v_rsq_f32 v98, v98
  s_nop 0
  v_mul_f32 v99, v96, v98
  s_mov_b64 exec, s[8:9]
  buffer_store_dwordx2 v[98:99], v6, s[40:43], s10 offen sc0 sc1
  s_mov_b64 exec, -1
  s_barrier
  s_barrier
  s_barrier
  s_barrier
  s_barrier
  s_cmp_lg_u32 s82, 0
  s_cbranch_scc1 L_175
  s_lshl_b32 s91, s84, Lz1-Lz0+1
  s_add_u32 s91, s91, 1835012
  s_mov_b32 exec_lo, 0xffff
  s_mov_b32 exec_hi, 0
  buffer_load_dword v7, v5, s[40:43], s91 offen sc0 sc1
  s_mov_b64 exec, -1
L_175:
  s_and_b32 s5, s10, 0xfffffc00
  buffer_load_dwordx4 v[120:123], v4, s[40:43], s5 offen sc1
  s_barrier
  s_barrier
  s_waitcnt vmcnt(0)
  s_mov_b32 s89, 200000
  s_branch Lp_178
Lp_177:
  s_and_b32 s5, s10, 0xfffffc00
  buffer_load_dwordx4 v[120:123], v4, s[40:43], s5 offen sc1
  s_waitcnt vmcnt(0)
Lp_178:
  v_min_u32 v2, v120, v122
  v_cmp_eq_u32 vcc, 0, v2
  s_cmp_eq_u64 vcc, 0
  s_cbranch_scc1 Lp_179
  s_sleep 1
  s_sub_u32 s89, s89, 1
  s_cbranch_scc0 Lp_177
Lp_179:
  s_and_b32 s5, s10, 0xfffffc00
  s_mov_b32 m0, 151552
  s_nop 0
  buffer_load_dword v6, s[40:43], s5 offen offset:0 sc1 lds
  s_mov_b32 m0, 152188
  s_nop 0
  buffer_load_dword v6, s[40:43], s5 offen offset:4 sc1 lds
  s_mov_b32 m0, 151360
  s_nop 0
  buffer_load_dword v6, s[40:43], s5 offen offset:512 sc1 lds
  s_mov_b32 m0, 151996
  s_nop 0
  buffer_load_dword v6, s[40:43], s5 offen offset:516 sc1 lds
  s_add_u32 s10, s10, 16384
  s_cmp_lg_u32 s82, 0
  s_cbranch_scc1 L_180
  s_mov_b32 s89, 200000
  s_mov_b32 exec_lo, 0xffff
  s_mov_b32 exec_hi, 0
  s_branch Lp_183
Lp_182:
  buffer_load_dword v7, v5, s[40:43], s91 offen sc0 sc1
  s_waitcnt vmcnt(0)
Lp_183:
  v_cmp_ne_u32 vcc, 0, v7
  s_andn2_b32 s3, 0xffff, vcc_lo
  s_cbranch_scc0 Lp_184
  s_sleep 1
  s_sub_u32 s89, s89, 1
  s_cbranch_scc0 Lp_182
Lp_184:
  s_mov_b64 exec, -1
  s_lshl_b32 s5, s77, 14
  s_add_u32 s5, s5, 1376256
  buffer_load_dwordx4 v[192:195], v4, s[40:43], s5 offen offset:0 sc1
  buffer_load_dwordx4 v[196:199], v4, s[40:43], s5 offen offset:1024 sc1
  buffer_load_dwordx4 v[200:203], v4, s[40:43], s5 offen offset:2048 sc1
  buffer_load_dwordx4 v[204:207], v4, s[40:43], s5 offen offset:3072 sc1
  s_add_u32 s5, s5, 4096
  buffer_load_dwordx4 v[208:211], v4, s[40:43], s5 offen offset:0 sc1
  buffer_load_dwordx4 v[212:215], v4, s[40:43], s5 offen offset:1024 sc1
  buffer_load_dwordx4 v[216:219], v4, s[40:43], s5 offen offset:2048 sc1
  buffer_load_dwordx4 v[220:223], v4, s[40:43], s5 offen offset:3072 sc1
L_180:
  s_barrier
  s_cmp_lg_u32 s82, 0
  s_cbranch_scc1 L_185
  s_lshl_b32 s5, s77, 14
  s_add_u32 s5, s5, 1384448
  buffer_load_dwordx4 v[224:227], v4, s[40:43], s5 offen offset:0 sc1
  buffer_load_dwordx4 v[228:231], v4, s[40:43], s5 offen offset:1024 sc1
  buffer_load_dwordx4 v[232:235], v4, s[40:43], s5 offen offset:2048 sc1
  buffer_load_dwordx4 v[236:239], v4, s[40:43], s5 offen offset:3072 sc1
  s_add_u32 s5, s5, 4096
  buffer_load_dwordx4 v[240:243], v4, s[40:43], s5 offen offset:0 sc1
  buffer_load_dwordx4 v[244:247], v4, s[40:43], s5 offen offset:1024 sc1
  buffer_load_dwordx4 v[248:251], v4, s[40:43], s5 offen offset:2048 sc1
  buffer_load_dwordx4 v[252:255], v4, s[40:43], s5 offen offset:3072 sc1
L_185:
  s_cmp_lg_u32 s82, 0
  s_cbranch_scc1 L_187
  buffer_load_dword v109, v110, s[60:63], s13 offen
  s_sub_u32 s13, s13, 8192
  buffer_load_dword v109, v110, s[60:63], s13 offen
  s_sub_u32 s13, s13, 8192
L_187:
  s_barrier
  s_barrier
  s_cmp_lg_u32 s82, 0
  s_cbranch_scc1 L_189
  s_cmp_lg_u32 s82, 0
  s_cbranch_scc1 L_191
  s_waitcnt vmcnt(2)
  s_branch L_192
  s_nop 0
L_191:
  s_waitcnt vmcnt(0)
L_192:
  v_add_f32 v192, v192, v224
  v_add_f32 v193, v193, v225
  v_add_f32 v194, v194, v226
  v_add_f32 v195, v195, v227
  v_add_f32 v196, v196, v228
  v_add_f32 v197, v197, v229
  v_add_f32 v198, v198, v230
  v_add_f32 v199, v199, v231
  v_add_f32 v200, v200, v232
  v_add_f32 v201, v201, v233
  v_add_f32 v202, v202, v234
  v_add_f32 v203, v203, v235
  v_add_f32 v204, v204, v236
  v_add_f32 v205, v205, v237
  v_add_f32 v206, v206, v238
  v_add_f32 v207, v207, v239
  v_add_f32 v208, v208, v240
  v_add_f32 v209, v209, v241
  v_add_f32 v210, v210, v242
  v_add_f32 v211, v211, v243
  v_add_f32 v212, v212, v244
  v_add_f32 v213, v213, v245
  v_add_f32 v214, v214, v246
  v_add_f32 v215, v215, v247
  v_add_f32 v216, v216, v248
  v_add_f32 v217, v217, v249
  v_add_f32 v218, v218, v250
  v_add_f32 v219, v219, v251
  v_add_f32 v220, v220, v252
  v_add_f32 v221, v221, v253
  v_add_f32 v222, v222, v254
  v_add_f32 v223, v223, v255
  v_add_f32 v192, v192, v208
  v_add_f32 v193, v193, v209
  v_add_f32 v194, v194, v210
  v_add_f32 v195, v195, v211
  v_add_f32 v196, v196, v212
  v_add_f32 v197, v197, v213
  v_add_f32 v198, v198, v214
  v_add_f32 v199, v199, v215
  v_add_f32 v200, v200, v216
  v_add_f32 v201, v201, v217
  v_add_f32 v202, v202, v218
  v_add_f32 v203, v203, v219
  v_add_f32 v204, v204, v220
  v_add_f32 v205, v205, v221
  v_add_f32 v206, v206, v222
  v_add_f32 v207, v207, v223
  v_add_f32 v192, v192, v200
  v_add_f32 v193, v193, v201
  v_add_f32 v194, v194, v202
  v_add_f32 v195, v195, v203
  v_add_f32 v196, v196, v204
  v_add_f32 v197, v197, v205
  v_add_f32 v198, v198, v206
  v_add_f32 v199, v199, v207
  v_add_f32 v192, v192, v196
  v_add_f32 v193, v193, v197
  v_add_f32 v194, v194, v198
  v_add_f32 v195, v195, v199
  v_add_u32 v2, 154112, v4
  ds_write_b128 v2, v[192:195]
  s_branch L_190
  s_nop 0
L_189:
  s_waitcnt vmcnt(0)
L_190:
  s_waitcnt lgkmcnt(0)
  s_barrier
  v_lshlrev_b32 v2, 12, v1
  s_lshl_b32 s4, s76, 16
  s_lshl_b32 s5, s77, 7
  s_add_u32 s4, s4, s5
  s_add_u32 s4, s4, s87
  s_add_u32 s5, s4, 24
  s_lshl_b32 s4, s79, 3
  s_lshl_b32 s90, 0xff, s4
  s_lshl_b32 s91, s84, 1
  s_add_u32 s91, s91, s87
  s_add_u32 s91, s91, 24
  s_barrier
  s_barrier
  s_barrier
  s_mov_b32 exec_lo, 0xffff
  s_mov_b32 exec_hi, Lz1-Lz0+0
  buffer_store_dword v11, v2, s[40:43], s5 offen sc0 sc1
  s_mov_b64 exec, -1
  s_barrier
  s_barrier
  s_barrier
  s_mov_b32 exec_lo, s90
  s_mov_b32 exec_hi, 0
  buffer_load_dword v7, v5, s[40:43], s91 offen sc0 sc1
  s_mov_b64 exec, -1
  s_barrier
  s_waitcnt vmcnt(0)
  s_mov_b32 s89, 200000
  s_mov_b32 exec_lo, s90
  s_mov_b32 exec_hi, 0
  s_branch Lp_194
Lp_193:
  buffer_load_dword v7, v5, s[40:43], s91 offen sc0 sc1
  s_waitcnt vmcnt(0)
Lp_194:
  v_cmp_ne_u32 vcc, 0, v7
  s_andn2_b32 s3, s90, vcc_lo
  s_cbranch_scc0 Lp_195
  s_sleep 1
  s_sub_u32 s89, s89, 1
  s_cbranch_scc0 Lp_193
Lp_195:
  s_mov_b64 exec, -1
  s_xor_b32 s90, s90, 0xffff
  s_barrier
  s_barrier
  s_barrier
  s_barrier
  s_barrier
  s_barrier
  s_barrier
  s_barrier
  s_barrier
  s_barrier
  s_mov_b32 exec_lo, s90
  s_mov_b32 exec_hi, 0
  buffer_load_dword v7, v5, s[40:43], s91 offen sc0 sc1
  s_mov_b64 exec, -1
  s_barrier
  s_barrier
  s_barrier
  s_waitcnt vmcnt(0)
  s_mov_b32 s89, 200000
  s_mov_b32 exec_lo, s90
  s_mov_b32 exec_hi, 0
  s_branch Lp_197
Lp_196:
  buffer_load_dword v7, v5, s[40:43], s91 offen sc0 sc1
  s_waitcnt vmcnt(0)
Lp_197:
  v_cmp_ne_u32 vcc, 0, v7
  s_andn2_b32 s3, s90, vcc_lo
  s_cbranch_scc0 Lp_198
  s_sleep 1
  s_sub_u32 s89, s89, 1
  s_cbranch_scc0 Lp_196
Lp_198:
  s_mov_b64 exec, -1
  s_sub_u32 s91, s91, Lz1-Lz0+12
  s_xor_b32 s5, s84, 16384
  s_lshl_b32 s5, s5, 1
  s_add_u32 s5, s5, s87
  s_add_u32 s5, s5, 12
  s_barrier
  s_barrier
  s_barrier
  s_barrier
  s_barrier
  s_barrier
  s_barrier
  s_barrier
  s_mov_b64 exec, 1
  buffer_store_dword v11, v5, s[40:43], s5 offen sc0 sc1
  s_mov_b64 exec, -1
  s_barrier
  s_barrier
  s_mov_b32 exec_lo, 1
  s_mov_b32 exec_hi, 0
  buffer_load_dword v7, v5, s[40:43], s91 offen sc0 sc1
  s_mov_b64 exec, -1
  s_barrier
  s_waitcnt vmcnt(0)
  s_mov_b32 s89, 200000
  s_mov_b32 exec_lo, 1
  s_mov_b32 exec_hi, 0
  s_branch Lp_200
  s_nop 0
Lp_199:
  buffer_load_dword v7, v5, s[40:43], s91 offen sc0 sc1
  s_waitcnt vmcnt(0)
Lp_200:
  v_cmp_ne_u32 vcc, 0, v7
  s_andn2_b32 s3, 1, vcc_lo
  s_cbranch_scc0 Lp_201
  s_sleep 1
  s_sub_u32 s89, s89, 1
  s_cbranch_scc0 Lp_199
Lp_201:
  s_mov_b64 exec, -1
  s_barrier
  s_barrier
  s_cmp_lg_u32 s82, 0
  s_cbranch_scc1 L_lend
  s_add_u32 s92, s83, 36700160
  s_mov_b32 s82, 1
  s_mov_b32 s14, 0
  s_add_u32 s83, s83, 0
  s_add_u32 s87, s87, 32
  s_branch L_slayer
L_lend:
Lz0:
Lz1:
L_end:
  s_endpgm
.section .rodata,"a"
.p2align 6
.amdhsa_kernel mega_kernel
  .amdhsa_next_free_vgpr 256
  .amdhsa_next_free_sgpr 102
  .amdhsa_accum_offset 256
  .amdhsa_group_segment_fixed_size 0
  .amdhsa_kernarg_size 88
  .amdhsa_user_sgpr_count 2
  .amdhsa_user_sgpr_kernarg_segment_ptr 1
  .amdhsa_system_sgpr_workgroup_id_x 1
  .amdhsa_float_denorm_mode_32 3
  .amdhsa_float_denorm_mode_16_64 3
.end_amdhsa_kernel
.text
```

```asm
; @launch kernel=mega_kernel grid=(256,1,1) block=(512,1,1) lds=156672
.amdgcn_target "amdgcn-amd-amdhsa--gfx950"
.text
.globl mega_kernel
.p2align 8
.type mega_kernel,@function
mega_kernel:
  s_cmp_ge_u32 s2, 256
  s_nop 0
  s_cbranch_scc1 L_end
  s_load_dwordx16 s[16:31], s[0:1], 0
  s_load_dwordx2 s[32:33], s[0:1], 64
  s_load_dwordx4 s[36:39], s[0:1], 72
  v_lshrrev_b32 v2, 6, v0
  v_and_b32 v1, 63, v0
  v_readfirstlane_b32 s81, v2
  s_and_b32 s3, s2, 7
  s_lshr_b32 s4, s2, 3
  s_and_b32 s5, s3, 1
  s_lshl_b32 s5, s5, 3
  s_and_b32 s6, s4, 7
  s_add_u32 s76, s5, s6
  s_lshr_b32 s5, s3, 1
  s_lshl_b32 s5, s5, 2
  s_lshr_b32 s6, s4, 3
  s_add_u32 s77, s5, s6
  s_mov_b32 s82, 0
  s_mov_b32 s88, 0
  s_and_b32 s85, s81, 1
  s_cmp_lt_u32 s81, 4
  s_cbranch_scc1 L_comp
  s_cmp_eq_u32 s81, Lz1-Lz0+5
  s_cbranch_scc1 L_serv
  s_setprio 0
  s_cmp_eq_u32 s81, 4
  s_cbranch_scc1 L_xload
  v_bfe_u32 v2, v1, 1, 2
  v_bfe_u32 v3, v1, 4, 2
  v_xor_b32 v2, v2, v3
  v_lshlrev_b32 v10, 5, v2
  v_and_b32_e64 v2, 1, v1
  v_lshl_add_u32 v10, v2, 4, v10
  v_lshrrev_b32_e64 v2, 5, v1
  v_bfe_u32 v3, v1, 3, 2
  v_lshl_add_u32 v2, v2, 3, v3
  s_mov_b32 s4, 6144
  v_mad_u32_u24 v16, v2, s4, v10
  v_add_u32 v17, 97280, v16
  v_add_u32 v18, 22528, v16
  v_add_u32 v19, 119808, v16
  s_lshl_b32 s5, s77, Lz1-Lz0+7
  s_mul_i32 s4, s85, 196608
  s_add_u32 s5, s5, s4
  s_and_b32 s6, s76, 6
  s_lshr_b32 s4, s76, 3
  s_add_u32 s6, s6, s4
  s_lshl_b32 s6, s6, 1
  v_add_u32 v20, s6, v1
  v_and_b32_e64 v20, 15, v20
  s_mov_b32 s4, 393216
  v_mul_u32_u24 v20, s4, v20
  v_add_u32 v20, s5, v20
  s_nop 0
  v_readfirstlane_b32 s7, v20
  s_lshl_b32 s11, s85, Lz1-Lz0+12
  s_add_u32 s11, s11, 65536
  s_add_u32 s15, s11, 73728
  s_waitcnt lgkmcnt(0)
  s_mov_b32 s48, s18
  s_and_b32 s49, s19, 0xffff
  s_mov_b32 s50, 6291456
  s_mov_b32 s51, 0x00020000
L_wlayer:
  s_mov_b32 s12, 0
  s_mov_b32 m0, s11
  s_cmp_eq_u32 s82, 0
  s_cbranch_scc1 Ll_31
  s_waitcnt vmcnt(12)
  s_barrier
  s_waitcnt vmcnt(8)
  s_barrier
  s_waitcnt vmcnt(4)
  s_barrier
  s_waitcnt vmcnt(0)
  s_barrier
  s_branch Ll_31
Lt_36:
  s_cmp_lg_u32 s12, 1
  s_cbranch_scc1 Ll_31
  s_cmp_eq_u32 s82, 0
  s_cbranch_scc1 Ll_31
  s_barrier
  v_mov_b32 v2, 156416
  s_lshl_b32 s5, s82, Lz1-Lz0+4
  s_mov_b32 s89, 1600000
Lw_37:
  ds_read_b32 v3, v2 offset:0
Lw_38:
  s_waitcnt lgkmcnt(0)
  v_readfirstlane_b32 s4, v3
  s_cmp_ge_u32 s4, s5
  s_cbranch_scc1 Lw_39
  s_sleep 1
  s_sub_u32 s89, s89, Lz1-Lz0+1
  s_cbranch_scc0 Lw_37
Lw_39:
Ll_31:
  buffer_load_dwordx4 v16, s[48:51], s7 offen offset:0 lds
  buffer_load_dwordx4 v17, s[48:51], s7 offen offset:1024 lds
  buffer_load_dwordx4 v18, s[48:51], s7 offen offset:2048 lds
  buffer_load_dwordx4 v19, s[48:51], s7 offen offset:3072 lds
  s_add_u32 m0, s11, 8192
  s_add_u32 s5, s7, 2048
  buffer_load_dwordx4 v16, s[48:51], s5 offen offset:0 lds
  buffer_load_dwordx4 v17, s[48:51], s5 offen offset:1024 lds
  buffer_load_dwordx4 v18, s[48:51], s5 offen offset:2048 lds
  buffer_load_dwordx4 v19, s[48:51], s5 offen offset:3072 lds
  s_add_u32 m0, s11, 16384
  s_add_u32 s5, s7, 4096
  buffer_load_dwordx4 v16, s[48:51], s5 offen offset:0 lds
  s_add_u32 s12, s12, Lz1-Lz0+1
  v_readlane_b32 s7, v20, s12
  s_add_u32 s11, s11, 24576
  buffer_load_dwordx4 v17, s[48:51], s5 offen offset:1024 lds
  s_cmp_eq_u32 s11, s15
  s_cselect_b32 s4, 73728, 0
  s_sub_u32 s11, s11, s4
  buffer_load_dwordx4 v18, s[48:51], s5 offen offset:2048 lds
  s_cmp_lg_u32 s12, Lz1-Lz0+3
  buffer_load_dwordx4 v19, s[48:51], s5 offen offset:3072 lds
  s_mov_b32 m0, s11
  s_cbranch_scc1 Lt_36
Lt_40:
  s_waitcnt vmcnt(24)
  s_barrier
  s_mul_i32 s5, s85, 6144
  s_nop 0
  s_mov_b32 s68, s24
  s_and_b32 s69, s25, 0xffff
  s_mov_b32 s70, 7340032
  s_mov_b32 s71, 0x00020000
  s_lshl_b32 s4, s76, Lz1-Lz0+4
  s_add_u32 s4, s4, s77
  s_mul_i32 s34, s4, 28672
  s_add_u32 s34, s34, s5
  s_waitcnt vmcnt(12)
  s_barrier
  buffer_load_dwordx4 v16, s[48:51], s7 offen offset:0 lds
  buffer_load_dwordx4 v17, s[48:51], s7 offen offset:1024 lds
  buffer_load_dwordx4 v18, s[48:51], s7 offen offset:2048 lds
  buffer_load_dwordx4 v19, s[48:51], s7 offen offset:3072 lds
Ll_41:
  s_add_u32 m0, s11, 8192
  s_add_u32 s5, s7, 2048
  buffer_load_dwordx4 v16, s[48:51], s5 offen offset:0 lds
  buffer_load_dwordx4 v17, s[48:51], s5 offen offset:1024 lds
  buffer_load_dwordx4 v18, s[48:51], s5 offen offset:2048 lds
  buffer_load_dwordx4 v19, s[48:51], s5 offen offset:3072 lds
  s_add_u32 m0, s11, 16384
  s_add_u32 s5, s7, 4096
  buffer_load_dwordx4 v16, s[48:51], s5 offen offset:0 lds
  s_add_u32 s12, s12, Lz1-Lz0+1
  v_readlane_b32 s7, v20, s12
  s_add_u32 s11, s11, 24576
  buffer_load_dwordx4 v17, s[48:51], s5 offen offset:1024 lds
  s_cmp_eq_u32 s11, s15
  s_cselect_b32 s4, 73728, 0
  s_sub_u32 s11, s11, s4
  buffer_load_dwordx4 v18, s[48:51], s5 offen offset:2048 lds
  s_cmp_eq_u32 s12, Lz1-Lz0+16
  buffer_load_dwordx4 v19, s[48:51], s5 offen offset:3072 lds
  s_mov_b32 m0, s11
  s_cbranch_scc1 Ll_42
  s_cmp_lg_u32 s82, 0
  s_cbranch_scc1 L_43
  s_buffer_load_dwordx2 s[98:99], s[68:71], s34 offset:60
  s_buffer_load_dwordx2 s[98:99], s[68:71], s34 offset:188
  s_buffer_load_dwordx2 s[98:99], s[68:71], s34 offset:316
  s_buffer_load_dwordx2 s[98:99], s[68:71], s34 offset:444
  s_add_u32 s34, s34, 512
L_43:
  s_waitcnt vmcnt(12)
  s_barrier
  buffer_load_dwordx4 v16, s[48:51], s7 offen offset:0 lds
  buffer_load_dwordx4 v17, s[48:51], s7 offen offset:1024 lds
  buffer_load_dwordx4 v18, s[48:51], s7 offen offset:2048 lds
  buffer_load_dwordx4 v19, s[48:51], s7 offen offset:3072 lds
  s_branch Ll_41
Ll_42:
  s_branch L_w1
L_xload:
  s_setprio 0
  v_lshrrev_b32 v2, 4, v1
  v_and_b32 v3, 7, v1
  v_xor_b32 v2, v2, v3
  v_lshrrev_b32 v3, 3, v1
  v_lshlrev_b32 v3, 12, v3
  v_lshl_add_u32 v4, v2, 4, v3
  v_xor_b32_e64 v5, 64, v4
  v_add_u32 v5, 31744, v5
  v_add_u32 v6, 63488, v4
  v_add_u32 v7, 63488, v5
  s_mov_b32 s13, 0x20000
  s_movk_i32 s95, 2048
  s_lshl_b32 s5, s76, 18
  s_and_b32 s6, s76, 6
  s_lshr_b32 s4, s76, 3
  s_add_u32 s6, s6, s4
  s_lshl_b32 s6, s6, 1
  v_add_u32 v9, s6, v1
  v_and_b32 v9, 15, v9
  v_lshl_add_u32 v9, v9, 7, s5
  s_nop 0
  v_readfirstlane_b32 s7, v9
  s_waitcnt lgkmcnt(0)
  s_mov_b32 s72, s16
  s_and_b32 s73, s17, 0xffff
  s_mov_b32 s74, 4194304
  s_mov_b32 s75, 0x00020000
  s_mov_b32 s11, 0
  s_mov_b32 s15, 65536
L_xlayer:
  s_mov_b32 s12, s82
  s_mov_b32 m0, s11
Ll_81:
  s_nop 0
  buffer_load_dwordx4 v4, s[72:75], s7 offen offset:0 sc1 lds
  buffer_load_dwordx4 v5, s[72:75], s7 offen offset:1024 sc1 lds
  buffer_load_dwordx4 v6, s[72:75], s7 offen offset:2048 sc1 lds
  buffer_load_dwordx4 v7, s[72:75], s7 offen offset:3072 sc1 lds
  s_add_u32 m0, s11, 4096
  s_nop 0
  s_add_u32 s5, s7, s13
  buffer_load_dwordx4 v4, s[72:75], s5 offen offset:0 sc1 lds
  buffer_load_dwordx4 v5, s[72:75], s5 offen offset:1024 sc1 lds
  buffer_load_dwordx4 v6, s[72:75], s5 offen offset:2048 sc1 lds
  buffer_load_dwordx4 v7, s[72:75], s5 offen offset:3072 sc1 lds
  s_add_u32 m0, s11, 8192
  s_nop 0
  s_add_u32 s3, s7, s95
  buffer_load_dwordx4 v4, s[72:75], s3 offen offset:0 sc1 lds
  buffer_load_dwordx4 v5, s[72:75], s3 offen offset:1024 sc1 lds
  buffer_load_dwordx4 v6, s[72:75], s3 offen offset:2048 sc1 lds
  buffer_load_dwordx4 v7, s[72:75], s3 offen offset:3072 sc1 lds
  s_add_u32 m0, s11, 12288
  s_add_u32 s5, s3, s13
  buffer_load_dwordx4 v4, s[72:75], s5 offen offset:0 sc1 lds
  s_add_u32 s12, s12, 1
  v_readlane_b32 s7, v9, s12
  s_add_u32 s11, s11, 16384
  buffer_load_dwordx4 v5, s[72:75], s5 offen offset:1024 sc1 lds
  s_cmp_eq_u32 s11, s15
  s_cselect_b32 s4, 65536, 0
  s_sub_u32 s11, s11, s4
  buffer_load_dwordx4 v6, s[72:75], s5 offen offset:2048 sc1 lds
  s_cmp_lg_u32 s12, Lz1-Lz0+3
  buffer_load_dwordx4 v7, s[72:75], s5 offen offset:3072 sc1 lds
  s_mov_b32 m0, s11
  s_cbranch_scc1 Ll_82
  s_cmp_lg_u32 s82, 0
  s_cbranch_scc1 Ll_82
  s_waitcnt vmcnt(32)
  s_barrier
Ll_82:
  s_cmp_lt_u32 s12, Lz1-Lz0+4
  s_cbranch_scc1 Ll_81
  s_mov_b32 s68, s20
  s_and_b32 s69, s21, 0xffff
  s_mov_b32 s70, 2097152
  s_mov_b32 s71, 0x00020000
  s_lshl_b32 s4, s76, 4
  s_add_u32 s4, s4, s77
  s_mul_i32 s34, s4, 8192
  s_waitcnt vmcnt(32)
  s_barrier
  buffer_load_dwordx4 v4, s[72:75], s7 offen offset:0 sc1 lds
  buffer_load_dwordx4 v5, s[72:75], s7 offen offset:1024 sc1 lds
  buffer_load_dwordx4 v6, s[72:75], s7 offen offset:2048 sc1 lds
  buffer_load_dwordx4 v7, s[72:75], s7 offen offset:3072 sc1 lds
Ll_85:
  s_add_u32 m0, s11, 4096
  s_nop 0
  s_add_u32 s5, s7, s13
  buffer_load_dwordx4 v4, s[72:75], s5 offen offset:0 sc1 lds
  buffer_load_dwordx4 v5, s[72:75], s5 offen offset:1024 sc1 lds
  buffer_load_dwordx4 v6, s[72:75], s5 offen offset:2048 sc1 lds
  buffer_load_dwordx4 v7, s[72:75], s5 offen offset:3072 sc1 lds
  s_add_u32 m0, s11, 8192
  s_nop 0
  s_add_u32 s3, s7, s95
  buffer_load_dwordx4 v4, s[72:75], s3 offen offset:0 sc1 lds
  buffer_load_dwordx4 v5, s[72:75], s3 offen offset:1024 sc1 lds
  buffer_load_dwordx4 v6, s[72:75], s3 offen offset:2048 sc1 lds
  buffer_load_dwordx4 v7, s[72:75], s3 offen offset:3072 sc1 lds
  s_add_u32 m0, s11, 12288
  s_add_u32 s5, s3, s13
  buffer_load_dwordx4 v4, s[72:75], s5 offen offset:0 sc1 lds
  s_add_u32 s12, s12, 1
  v_readlane_b32 s7, v9, s12
  s_add_u32 s11, s11, 16384
  buffer_load_dwordx4 v5, s[72:75], s5 offen offset:1024 sc1 lds
  s_cmp_eq_u32 s11, s15
  s_cselect_b32 s4, 65536, 0
  s_sub_u32 s11, s11, s4
  buffer_load_dwordx4 v6, s[72:75], s5 offen offset:2048 sc1 lds
  s_cmp_eq_u32 s12, Lz1-Lz0+16
  buffer_load_dwordx4 v7, s[72:75], s5 offen offset:3072 sc1 lds
  s_mov_b32 m0, s11
  s_cbranch_scc1 Ll_86
  s_cmp_lg_u32 s82, 0
  s_cbranch_scc1 L_87
  s_buffer_load_dwordx2 s[98:99], s[68:71], s34 offset:60
  s_buffer_load_dwordx2 s[98:99], s[68:71], s34 offset:188
  s_buffer_load_dwordx2 s[98:99], s[68:71], s34 offset:316
  s_buffer_load_dwordx2 s[98:99], s[68:71], s34 offset:444
  s_buffer_load_dwordx2 s[98:99], s[68:71], s34 offset:572
  s_add_u32 s34, s34, 640
L_87:
  s_waitcnt vmcnt(32)
  s_barrier
  buffer_load_dwordx4 v4, s[72:75], s7 offen offset:0 sc1 lds
  buffer_load_dwordx4 v5, s[72:75], s7 offen offset:1024 sc1 lds
  buffer_load_dwordx4 v6, s[72:75], s7 offen offset:2048 sc1 lds
  buffer_load_dwordx4 v7, s[72:75], s7 offen offset:3072 sc1 lds
  s_branch Ll_85
  s_nop 0
Ll_86:
  s_waitcnt vmcnt(32)
  s_barrier
  s_waitcnt vmcnt(16)
  s_barrier
  s_waitcnt vmcnt(0)
  s_barrier
  s_barrier
  s_branch L_x1
L_serv:
  s_setprio 3
  s_and_b32 s80, s77, 7
  s_lshr_b32 s79, s77, 3
  s_lshl_b32 s78, s80, 1
  s_add_u32 s78, s78, s79
  s_lshl_b32 s5, s76, 4
  s_add_u32 s5, s5, s77
  s_lshl_b32 s84, s5, 11
  s_mov_b32 s83, 3145728
  s_mov_b32 s87, 1835016
  s_lshr_b32 s86, s81, 1
  v_lshlrev_b32 v4, 4, v1
  v_mov_b32 v24, 0
  v_mov_b32 v25, 0
  v_mov_b32 v26, 0
  v_mov_b32 v27, 0
  v_and_b32 v2, 14, v1
  v_lshlrev_b32 v3, 11, v2
  v_and_b32_e64 v2, 1, v1
  v_lshl_add_u32 v3, v2, 4, v3
  v_and_b32_e64 v2, 48, v1
  v_lshl_add_u32 v3, v2, 1, v3
  v_bfe_u32 v2, v1, 3, 2
  v_and_b32 v22, 7, v1
  v_lshlrev_b32 v2, 14, v2
  v_lshl_add_u32 v2, v22, 3, v2
  s_lshl_b32 s5, s76, 7
  s_lshl_b32 s4, s80, 4
  s_add_u32 s6, s5, s4
  s_add_u32 s6, s6, s79
  s_lshl_b32 s6, s6, 11
  s_lshr_b32 s10, s84, 5
  s_add_u32 s10, s10, 1638400
  s_waitcnt lgkmcnt(0)
  s_mov_b32 s48, s18
  s_and_b32 s49, s19, 0xffff
  s_mov_b32 s50, 6291456
  s_mov_b32 s51, 0x00020000
  s_sub_u32 s4, 384, s48
  s_and_b32 s4, s4, 1023
  s_mul_i32 s5, s84, 12
  s_add_u32 s4, s4, s5
  v_lshlrev_b32_e64 v109, 10, v1
  s_mov_b64 exec, 0xffffff
  buffer_load_dword v109, v109, s[48:51], s4 offen
  s_mov_b64 exec, -1
  s_mov_b32 s40, s38
  s_and_b32 s41, s39, 0xffff
  s_mov_b32 s42, 100663296
  s_mov_b32 s43, 0x00020000
  s_nop 0
  s_mov_b32 s44, s16
  s_and_b32 s45, s17, 0xffff
  s_mov_b32 s46, 4194304
  s_mov_b32 s47, 0x00020000
  s_nop 0
  s_mov_b32 s68, s36
  s_and_b32 s69, s37, 0xffff
  s_mov_b32 s70, 256
  s_mov_b32 s71, 0x00020000
  s_lshl_b32 s4, s84, Lz1-Lz0+1
  s_add_u32 s4, s4, 1835008
  buffer_store_dwordx4 v[24:27], v4, s[40:43], s4 offen offset:0 sc0 sc1
  buffer_store_dwordx4 v[24:27], v4, s[40:43], s4 offen offset:1024 sc0 sc1
  s_mov_b64 exec, 0xffff
  buffer_store_dwordx4 v[24:27], v4, s[40:43], s4 offen offset:2048 sc0 sc1
  s_mov_b64 exec, -1
  v_mov_b32 v28, -1
  v_mov_b32 v29, -1
  v_mov_b32 v30, -1
  v_mov_b32 v31, -1
  s_lshl_b32 s4, s84, 1
  s_add_u32 s4, s4, Lz1-Lz0+0
  buffer_store_dwordx4 v[28:31], v4, s[40:43], s4 offen offset:0 sc0 sc1
  buffer_store_dwordx4 v[28:31], v4, s[40:43], s4 offen offset:1024 sc0 sc1
  buffer_store_dwordx4 v[28:31], v4, s[40:43], s4 offen offset:2048 sc0 sc1
  buffer_store_dwordx4 v[28:31], v4, s[40:43], s4 offen offset:3072 sc0 sc1
  buffer_store_dwordx2 v[24:25], v2, s[40:43], s10 offen sc0 sc1
  v_mov_b32 v108, v3
  s_mov_b32 s7, s6
  s_branch L_s1
L_comp:
  s_and_b32 s80, s77, 7
  s_lshr_b32 s79, s77, 3
  s_lshl_b32 s78, s80, 1
  s_add_u32 s78, s78, s79
  s_lshl_b32 s5, s76, 4
  s_add_u32 s5, s5, s77
  s_lshl_b32 s84, s5, 11
  s_mov_b32 s83, 3145728
  s_mov_b32 s87, 1835016
  s_lshr_b32 s86, s81, Lz1-Lz0+1
  s_waitcnt lgkmcnt(0)
  s_mov_b32 s40, s38
  s_and_b32 s41, s39, 0xffff
  s_mov_b32 s42, 100663296
  s_mov_b32 s43, 0x00020000
  s_nop 0
  s_mov_b32 s44, s16
  s_and_b32 s45, s17, 0xffff
  s_mov_b32 s46, 4194304
  s_mov_b32 s47, 0x00020000
  s_nop 0
  s_mov_b32 s64, s32
  s_and_b32 s65, s33, 0xffff
  s_mov_b32 s66, 4194304
  s_mov_b32 s67, 0x00020000
  s_setprio 1
  v_lshlrev_b32 v11, 4, v1
  v_lshrrev_b32 v2, 3, v1
  v_and_b32 v3, 7, v1
  v_lshlrev_b32_e64 v3, 3, v3
  v_lshl_add_u32 v30, v2, 11, v3
  s_lshl_b32 s4, s85, 13
  s_lshl_b32 s5, s86, 10
  s_add_u32 s4, s4, s5
  v_add_u32 v0, s4, v11
  v_mov_b32_e64 v27, 1
  v_mov_b32 v28, 156416
  v_and_b32 v29, 48, v1
  s_lshl_b32 s4, s76, 16
  s_lshl_b32 s5, s77, 7
  s_add_u32 s4, s4, s5
  v_lshlrev_b32 v24, 12, v1
  v_and_b32 v2, 16, v1
  v_lshl_add_u32 v24, v2, 7, v24
  v_add_u32 v24, s4, v24
  v_lshrrev_b32 v2, 2, v1
  v_lshlrev_b32 v25, 7, v2
  v_and_b32 v2, 3, v1
  v_lshl_add_u32 v25, v2, 3, v25
  v_add_u32 v25, 65536, v25
  v_bfe_u32 v26, v1, 3, 2
  v_and_b32 v2, 15, v1
  v_lshrrev_b32 v3, 2, v29
  v_sub_u32_e64 v2, v2, v3
  s_mov_b32 s4, 0xf149f2ca
  v_mov_b32 v32, s4
  v_subrev_u32 v3, 0, v2
  v_cmp_gt_u32 vcc, 8, v3
  s_nop 1
  v_cndmask_b32_e64 v12, v32, 0, vcc
  v_cmp_ge_i32 vcc, -9, v3
  s_nop 1
  v_cndmask_b32_e64 v16, v32, 0, vcc
  v_mov_b32 v20, v16
  v_subrev_u32 v3, 1, v2
  v_cmp_gt_u32 vcc, 8, v3
  s_nop 1
  v_cndmask_b32_e64 v13, v32, 0, vcc
  v_cmp_ge_i32 vcc, -9, v3
  s_nop 1
  v_cndmask_b32_e64 v17, v32, 0, vcc
  v_mov_b32 v21, v17
  v_subrev_u32 v3, 2, v2
  v_cmp_gt_u32 vcc, 8, v3
  s_nop 1
  v_cndmask_b32_e64 v14, v32, 0, vcc
  v_cmp_ge_i32 vcc, -9, v3
  s_nop 1
  v_cndmask_b32_e64 v18, v32, 0, vcc
  v_mov_b32 v22, v18
  v_subrev_u32 v3, 3, v2
  v_cmp_gt_u32 vcc, 8, v3
  s_nop 1
  v_cndmask_b32_e64 v15, v32, 0, vcc
  v_cmp_ge_i32 vcc, -9, v3
  s_nop 1
  v_cndmask_b32_e64 v19, v32, 0, vcc
  v_mov_b32 v23, v19
  s_cmp_lg_u32 s76, 0
  s_cbranch_scc1 L_1
  v_mov_b32 v20, v32
  v_mov_b32 v21, v32
  v_mov_b32 v22, v32
  v_mov_b32 v23, v32
L_1:
  s_lshl_b32 s11, s84, 1
  s_lshl_b32 s4, s81, 10
  s_add_u32 s11, s11, s4
L_clayer:
  s_mov_b32 s16, Lz1-Lz0+0
  s_mov_b32 s17, 16384
  s_mov_b32 s18, 0xffff4000
  s_mov_b32 s19, Lz1-Lz0+0
  s_mov_b32 s20, 24576
  s_mov_b32 s21, 0xffff4000
  s_mul_i32 s4, s85, 8192
  v_add_u32_e64 v4, s4, v11
  v_add_u32 v5, 1024, v4
  s_cmp_lg_u32 s82, 0
  s_cbranch_scc1 L_2
  v_and_b32 v2, 15, v1
  v_lshrrev_b32 v3, 1, v2
  v_lshrrev_b32 v32, 4, v1
  v_xor_b32 v3, v3, v32
  v_lshlrev_b32_e64 v3, 4, v3
  v_lshl_add_u32 v3, v2, 7, v3
  v_add_u32 v4, s4, v3
  v_xor_b32 v3, 64, v3
  v_add_u32 v5, s4, v3
L_2:
  s_lshl_b32 s4, s86, 1
  v_xor_b32_e64 v2, s4, v26
  v_lshl_add_u32 v6, v2, 5, v25
  s_add_u32 s4, s4, 1
  v_xor_b32 v2, s4, v26
  v_lshl_add_u32 v7, v2, 5, v25
  v_mov_b64 v[128:129], 0
  v_mov_b64 v[130:131], 0
  v_mov_b64 v[132:133], 0
  v_mov_b64 v[134:135], 0
  v_mov_b64 v[136:137], 0
  v_mov_b64 v[138:139], 0
  v_mov_b64 v[140:141], 0
  v_mov_b64 v[142:143], 0
  v_mov_b64 v[144:145], 0
  v_mov_b64 v[146:147], 0
  v_mov_b64 v[148:149], 0
  v_mov_b64 v[150:151], 0
  v_mov_b64 v[152:153], 0
  v_mov_b64 v[154:155], 0
  v_mov_b64 v[156:157], 0
  v_mov_b64 v[158:159], 0
  v_mov_b64 v[160:161], 0
  v_mov_b64 v[162:163], 0
  v_mov_b64 v[164:165], 0
  v_mov_b64 v[166:167], 0
  v_mov_b64 v[168:169], 0
  v_mov_b64 v[170:171], 0
  v_mov_b64 v[172:173], 0
  v_mov_b64 v[174:175], 0
  v_mov_b64 v[176:177], 0
  v_mov_b64 v[178:179], 0
  v_mov_b64 v[180:181], 0
  v_mov_b64 v[182:183], 0
  v_mov_b64 v[184:185], 0
  v_mov_b64 v[186:187], 0
  v_mov_b64 v[188:189], 0
  v_mov_b64 v[190:191], 0
  v_mov_b64 v[192:193], 0
  v_mov_b64 v[194:195], 0
  v_mov_b64 v[196:197], 0
  v_mov_b64 v[198:199], 0
  v_mov_b64 v[200:201], 0
  v_mov_b64 v[202:203], 0
  v_mov_b64 v[204:205], 0
  v_mov_b64 v[206:207], 0
  v_mov_b64 v[208:209], 0
  v_mov_b64 v[210:211], 0
  v_mov_b64 v[212:213], 0
  v_mov_b64 v[214:215], 0
  v_mov_b64 v[216:217], 0
  v_mov_b64 v[218:219], 0
  v_mov_b64 v[220:221], 0
  v_mov_b64 v[222:223], 0
  s_mov_b32 s22, Lz1-Lz0+8
  s_cmp_lg_u32 s82, 0
  s_cselect_b64 vcc, -1, 0
  s_waitcnt lgkmcnt(0)
  s_barrier
Lo_5:
  ds_read_b128 v[32:35], v4 offset:0
  ds_read_b128 v[48:51], v5 offset:0
  ds_read_b128 v[36:39], v4 offset:2048
  ds_read_b128 v[52:55], v5 offset:2048
  ds_read_b128 v[40:43], v4 offset:4096
  ds_read_b128 v[56:59], v5 offset:4096
  ds_read_b64_tr_b16 v[96:97], v6 offset:0
  ds_read_b64_tr_b16 v[98:99], v6 offset:2048
  ds_read_b64_tr_b16 v[100:101], v6 offset:4096
  ds_read_b64_tr_b16 v[102:103], v6 offset:6144
  ds_read_b128 v[44:47], v4 offset:6144
  ds_read_b128 v[60:63], v5 offset:6144
  ds_read_b64_tr_b16 v[104:105], v7 offset:0
  s_nop 0
  s_waitcnt lgkmcnt(8)
  ds_read_b64_tr_b16 v[106:107], v7 offset:2048
  ds_read_b64_tr_b16 v[108:109], v7 offset:4096
  ds_read_b64_tr_b16 v[110:111], v7 offset:6144
  s_nop 0
  s_waitcnt lgkmcnt(6)
  .p2align 6
Lk_3:
  v_mfma_f32_16x16x32_bf16 v[128:131], v[96:99], v[32:35], v[128:131]
  ds_read_b64_tr_b16 v[112:113], v6 offset:8192
  v_mfma_f32_16x16x32_bf16 v[128:131], v[100:103], v[48:51], v[128:131]
  ds_read_b64_tr_b16 v[114:115], v6 offset:10240
  v_mfma_f32_16x16x32_bf16 v[136:139], v[100:103], v[52:55], v[136:139]
  ds_read_b64_tr_b16 v[116:117], v6 offset:12288
  v_mfma_f32_16x16x32_bf16 v[136:139], v[96:99], v[36:39], v[136:139]
  ds_read_b64_tr_b16 v[118:119], v6 offset:14336
  v_mfma_f32_16x16x32_bf16 v[144:147], v[96:99], v[40:43], v[144:147]
  s_add_u32 s16, s16, s17
  s_cmp_eq_u32 s16, 65536
  s_cselect_b32 s23, s18, s17
  s_cselect_b32 s16, Lz1-Lz0+0, s16
  v_mfma_f32_16x16x32_bf16 v[144:147], v[100:103], v[56:59], v[144:147]
  v_add_u32_e64 v4, s23, v4
  v_add_u32 v5, s23, v5
  s_add_u32 s19, s19, s20
  s_cmp_eq_u32 s19, 73728
  s_waitcnt lgkmcnt(8)
  v_mfma_f32_16x16x32_bf16 v[152:155], v[100:103], v[60:63], v[152:155]
  s_cselect_b32 s23, s21, s20
  s_cselect_b32 s19, 0, s19
  v_mfma_f32_16x16x32_bf16 v[152:155], v[96:99], v[44:47], v[152:155]
  s_waitcnt lgkmcnt(4)
  v_mfma_f32_16x16x32_bf16 v[156:159], v[104:107], v[44:47], v[156:159]
  ds_read_b64_tr_b16 v[120:121], v7 offset:8192
  v_mfma_f32_16x16x32_bf16 v[156:159], v[108:111], v[60:63], v[156:159]
  ds_read_b64_tr_b16 v[122:123], v7 offset:10240
  v_mfma_f32_16x16x32_bf16 v[148:151], v[108:111], v[56:59], v[148:151]
  ds_read_b64_tr_b16 v[124:125], v7 offset:12288
  v_mfma_f32_16x16x32_bf16 v[148:151], v[104:107], v[40:43], v[148:151]
  ds_read_b64_tr_b16 v[126:127], v7 offset:14336
  v_mfma_f32_16x16x32_bf16 v[140:143], v[104:107], v[36:39], v[140:143]
  ds_read_b64_tr_b16 v[224:225], v6 offset:16384
  v_mfma_f32_16x16x32_bf16 v[140:143], v[108:111], v[52:55], v[140:143]
  ds_read_b64_tr_b16 v[226:227], v6 offset:18432
  v_mfma_f32_16x16x32_bf16 v[132:135], v[108:111], v[48:51], v[132:135]
  ds_read_b64_tr_b16 v[228:229], v6 offset:20480
  v_mfma_f32_16x16x32_bf16 v[132:135], v[104:107], v[32:35], v[132:135]
  ds_read_b64_tr_b16 v[230:231], v6 offset:22528
  s_nop 0
  s_waitcnt lgkmcnt(8)
  v_mfma_f32_16x16x32_bf16 v[160:163], v[112:115], v[32:35], v[160:163]
  ds_read_b64_tr_b16 v[232:233], v7 offset:16384
  v_mfma_f32_16x16x32_bf16 v[160:163], v[116:119], v[48:51], v[160:163]
  ds_read_b64_tr_b16 v[234:235], v7 offset:18432
  v_mfma_f32_16x16x32_bf16 v[168:171], v[116:119], v[52:55], v[168:171]
  ds_read_b64_tr_b16 v[236:237], v7 offset:20480
  v_mfma_f32_16x16x32_bf16 v[168:171], v[112:115], v[36:39], v[168:171]
  ds_read_b64_tr_b16 v[238:239], v7 offset:22528
  v_mfma_f32_16x16x32_bf16 v[176:179], v[112:115], v[40:43], v[176:179]
  v_add_u32_e64 v6, s23, v6
  v_mfma_f32_16x16x32_bf16 v[176:179], v[116:119], v[56:59], v[176:179]
  v_add_u32_e64 v7, s23, v7
  v_mfma_f32_16x16x32_bf16 v[184:187], v[116:119], v[60:63], v[184:187]
  v_mfma_f32_16x16x32_bf16 v[184:187], v[112:115], v[44:47], v[184:187]
  s_waitcnt lgkmcnt(0)
  s_cbranch_vccnz Lo_7
  s_nop 0
  s_barrier
Lo_7:
  v_mfma_f32_16x16x32_bf16 v[188:191], v[120:123], v[44:47], v[188:191]
  ds_read_b128 v[64:67], v4 offset:0
  v_mfma_f32_16x16x32_bf16 v[188:191], v[124:127], v[60:63], v[188:191]
  ds_read_b128 v[80:83], v5 offset:0
  v_mfma_f32_16x16x32_bf16 v[180:183], v[124:127], v[56:59], v[180:183]
  v_mfma_f32_16x16x32_bf16 v[180:183], v[120:123], v[40:43], v[180:183]
  ds_read_b128 v[68:71], v4 offset:2048
  v_mfma_f32_16x16x32_bf16 v[172:175], v[120:123], v[36:39], v[172:175]
  ds_read_b128 v[84:87], v5 offset:2048
  v_mfma_f32_16x16x32_bf16 v[172:175], v[124:127], v[52:55], v[172:175]
  v_mfma_f32_16x16x32_bf16 v[164:167], v[124:127], v[48:51], v[164:167]
  ds_read_b128 v[72:75], v4 offset:4096
  v_mfma_f32_16x16x32_bf16 v[164:167], v[120:123], v[32:35], v[164:167]
  ds_read_b128 v[88:91], v5 offset:4096
  v_mfma_f32_16x16x32_bf16 v[192:195], v[32:35], v[224:227], v[192:195]
  ds_read_b64_tr_b16 v[96:97], v6 offset:0
  v_mfma_f32_16x16x32_bf16 v[192:195], v[48:51], v[228:231], v[192:195]
  ds_read_b64_tr_b16 v[98:99], v6 offset:2048
  v_mfma_f32_16x16x32_bf16 v[200:203], v[52:55], v[228:231], v[200:203]
  ds_read_b64_tr_b16 v[100:101], v6 offset:4096
  v_mfma_f32_16x16x32_bf16 v[200:203], v[36:39], v[224:227], v[200:203]
  ds_read_b64_tr_b16 v[102:103], v6 offset:6144
  v_mfma_f32_16x16x32_bf16 v[208:211], v[40:43], v[224:227], v[208:211]
  ds_read_b128 v[76:79], v4 offset:6144
  v_mfma_f32_16x16x32_bf16 v[208:211], v[56:59], v[228:231], v[208:211]
  v_mfma_f32_16x16x32_bf16 v[216:219], v[60:63], v[228:231], v[216:219]
  ds_read_b128 v[92:95], v5 offset:6144
  v_mfma_f32_16x16x32_bf16 v[216:219], v[44:47], v[224:227], v[216:219]
  v_mfma_f32_16x16x32_bf16 v[220:223], v[44:47], v[232:235], v[220:223]
  ds_read_b64_tr_b16 v[104:105], v7 offset:0
  v_mfma_f32_16x16x32_bf16 v[220:223], v[60:63], v[236:239], v[220:223]
  v_mfma_f32_16x16x32_bf16 v[212:215], v[56:59], v[236:239], v[212:215]
  ds_read_b64_tr_b16 v[106:107], v7 offset:2048
  v_mfma_f32_16x16x32_bf16 v[212:215], v[40:43], v[232:235], v[212:215]
  v_mfma_f32_16x16x32_bf16 v[204:207], v[36:39], v[232:235], v[204:207]
  ds_read_b64_tr_b16 v[108:109], v7 offset:4096
  v_mfma_f32_16x16x32_bf16 v[204:207], v[52:55], v[236:239], v[204:207]
  v_mfma_f32_16x16x32_bf16 v[196:199], v[48:51], v[236:239], v[196:199]
  ds_read_b64_tr_b16 v[110:111], v7 offset:6144
  s_waitcnt lgkmcnt(6)
  v_mfma_f32_16x16x32_bf16 v[196:199], v[32:35], v[232:235], v[196:199]
  s_cbranch_vccnz Lo_6
Lk_4:
  v_mfma_f32_16x16x32_bf16 v[128:131], v[96:99], v[64:67], v[128:131]
  ds_read_b64_tr_b16 v[112:113], v6 offset:8192
  v_mfma_f32_16x16x32_bf16 v[128:131], v[100:103], v[80:83], v[128:131]
  ds_read_b64_tr_b16 v[114:115], v6 offset:10240
  v_mfma_f32_16x16x32_bf16 v[136:139], v[100:103], v[84:87], v[136:139]
  ds_read_b64_tr_b16 v[116:117], v6 offset:12288
  v_mfma_f32_16x16x32_bf16 v[136:139], v[96:99], v[68:71], v[136:139]
  ds_read_b64_tr_b16 v[118:119], v6 offset:14336
  v_mfma_f32_16x16x32_bf16 v[144:147], v[96:99], v[72:75], v[144:147]
  s_add_u32 s16, s16, s17
  s_cmp_eq_u32 s16, 65536
  s_cselect_b32 s23, s18, s17
  s_cselect_b32 s16, Lz1-Lz0+0, s16
  v_mfma_f32_16x16x32_bf16 v[144:147], v[100:103], v[88:91], v[144:147]
  v_add_u32_e64 v4, s23, v4
  v_add_u32 v5, s23, v5
  s_add_u32 s19, s19, s20
  s_cmp_eq_u32 s19, 73728
  s_waitcnt lgkmcnt(8)
  v_mfma_f32_16x16x32_bf16 v[152:155], v[100:103], v[92:95], v[152:155]
  s_cselect_b32 s23, s21, s20
  s_cselect_b32 s19, 0, s19
  v_mfma_f32_16x16x32_bf16 v[152:155], v[96:99], v[76:79], v[152:155]
  s_waitcnt lgkmcnt(4)
  v_mfma_f32_16x16x32_bf16 v[156:159], v[104:107], v[76:79], v[156:159]
  ds_read_b64_tr_b16 v[120:121], v7 offset:8192
  v_mfma_f32_16x16x32_bf16 v[156:159], v[108:111], v[92:95], v[156:159]
  ds_read_b64_tr_b16 v[122:123], v7 offset:10240
  v_mfma_f32_16x16x32_bf16 v[148:151], v[108:111], v[88:91], v[148:151]
  ds_read_b64_tr_b16 v[124:125], v7 offset:12288
  v_mfma_f32_16x16x32_bf16 v[148:151], v[104:107], v[72:75], v[148:151]
  ds_read_b64_tr_b16 v[126:127], v7 offset:14336
  v_mfma_f32_16x16x32_bf16 v[140:143], v[104:107], v[68:71], v[140:143]
  ds_read_b64_tr_b16 v[224:225], v6 offset:16384
  v_mfma_f32_16x16x32_bf16 v[140:143], v[108:111], v[84:87], v[140:143]
  ds_read_b64_tr_b16 v[226:227], v6 offset:18432
  v_mfma_f32_16x16x32_bf16 v[132:135], v[108:111], v[80:83], v[132:135]
  ds_read_b64_tr_b16 v[228:229], v6 offset:20480
  v_mfma_f32_16x16x32_bf16 v[132:135], v[104:107], v[64:67], v[132:135]
  ds_read_b64_tr_b16 v[230:231], v6 offset:22528
  s_nop 0
  s_waitcnt lgkmcnt(8)
  v_mfma_f32_16x16x32_bf16 v[160:163], v[112:115], v[64:67], v[160:163]
  ds_read_b64_tr_b16 v[232:233], v7 offset:16384
  v_mfma_f32_16x16x32_bf16 v[160:163], v[116:119], v[80:83], v[160:163]
  ds_read_b64_tr_b16 v[234:235], v7 offset:18432
  v_mfma_f32_16x16x32_bf16 v[168:171], v[116:119], v[84:87], v[168:171]
  ds_read_b64_tr_b16 v[236:237], v7 offset:20480
  v_mfma_f32_16x16x32_bf16 v[168:171], v[112:115], v[68:71], v[168:171]
  ds_read_b64_tr_b16 v[238:239], v7 offset:22528
  v_mfma_f32_16x16x32_bf16 v[176:179], v[112:115], v[72:75], v[176:179]
  v_add_u32_e64 v6, s23, v6
  v_mfma_f32_16x16x32_bf16 v[176:179], v[116:119], v[88:91], v[176:179]
  v_add_u32_e64 v7, s23, v7
  v_mfma_f32_16x16x32_bf16 v[184:187], v[116:119], v[92:95], v[184:187]
  v_mfma_f32_16x16x32_bf16 v[184:187], v[112:115], v[76:79], v[184:187]
  s_waitcnt lgkmcnt(0)
  s_barrier
  v_mfma_f32_16x16x32_bf16 v[188:191], v[120:123], v[76:79], v[188:191]
  ds_read_b128 v[32:35], v4 offset:0
  v_mfma_f32_16x16x32_bf16 v[188:191], v[124:127], v[92:95], v[188:191]
  ds_read_b128 v[48:51], v5 offset:0
  v_mfma_f32_16x16x32_bf16 v[180:183], v[124:127], v[88:91], v[180:183]
  v_mfma_f32_16x16x32_bf16 v[180:183], v[120:123], v[72:75], v[180:183]
  ds_read_b128 v[36:39], v4 offset:2048
  v_mfma_f32_16x16x32_bf16 v[172:175], v[120:123], v[68:71], v[172:175]
  ds_read_b128 v[52:55], v5 offset:2048
  v_mfma_f32_16x16x32_bf16 v[172:175], v[124:127], v[84:87], v[172:175]
  v_mfma_f32_16x16x32_bf16 v[164:167], v[124:127], v[80:83], v[164:167]
  ds_read_b128 v[40:43], v4 offset:4096
  v_mfma_f32_16x16x32_bf16 v[164:167], v[120:123], v[64:67], v[164:167]
  ds_read_b128 v[56:59], v5 offset:4096
  v_mfma_f32_16x16x32_bf16 v[192:195], v[64:67], v[224:227], v[192:195]
  ds_read_b64_tr_b16 v[96:97], v6 offset:0
  v_mfma_f32_16x16x32_bf16 v[192:195], v[80:83], v[228:231], v[192:195]
  ds_read_b64_tr_b16 v[98:99], v6 offset:2048
  v_mfma_f32_16x16x32_bf16 v[200:203], v[84:87], v[228:231], v[200:203]
  ds_read_b64_tr_b16 v[100:101], v6 offset:4096
  v_mfma_f32_16x16x32_bf16 v[200:203], v[68:71], v[224:227], v[200:203]
  ds_read_b64_tr_b16 v[102:103], v6 offset:6144
  v_mfma_f32_16x16x32_bf16 v[208:211], v[72:75], v[224:227], v[208:211]
  ds_read_b128 v[44:47], v4 offset:6144
  v_mfma_f32_16x16x32_bf16 v[208:211], v[88:91], v[228:231], v[208:211]
  v_mfma_f32_16x16x32_bf16 v[216:219], v[92:95], v[228:231], v[216:219]
  ds_read_b128 v[60:63], v5 offset:6144
  v_mfma_f32_16x16x32_bf16 v[216:219], v[76:79], v[224:227], v[216:219]
  v_mfma_f32_16x16x32_bf16 v[220:223], v[76:79], v[232:235], v[220:223]
  ds_read_b64_tr_b16 v[104:105], v7 offset:0
  v_mfma_f32_16x16x32_bf16 v[220:223], v[92:95], v[236:239], v[220:223]
  v_mfma_f32_16x16x32_bf16 v[212:215], v[88:91], v[236:239], v[212:215]
  ds_read_b64_tr_b16 v[106:107], v7 offset:2048
  v_mfma_f32_16x16x32_bf16 v[212:215], v[72:75], v[232:235], v[212:215]
  v_mfma_f32_16x16x32_bf16 v[204:207], v[68:71], v[232:235], v[204:207]
  ds_read_b64_tr_b16 v[108:109], v7 offset:4096
  v_mfma_f32_16x16x32_bf16 v[204:207], v[84:87], v[236:239], v[204:207]
  s_sub_u32 s22, s22, 1
  s_cmp_lg_u32 s22, 0
  v_mfma_f32_16x16x32_bf16 v[196:199], v[80:83], v[236:239], v[196:199]
  ds_read_b64_tr_b16 v[110:111], v7 offset:6144
  s_waitcnt lgkmcnt(6)
  v_mfma_f32_16x16x32_bf16 v[196:199], v[64:67], v[232:235], v[196:199]
  s_cbranch_scc1 Lk_3
  s_cmp_lg_u32 s82, 0
  s_cbranch_scc1 L_8
  v_and_b32 v2, 15, v1
  v_lshlrev_b32 v3, 12, v2
  v_and_b32_e64 v2, 16, v1
  v_lshl_add_u32 v3, v2, 1, v3
  v_and_b32 v2, 32, v1
  v_lshrrev_b32 v2, 1, v2
  v_add_u32 v3, v2, v3
  s_lshl_b32 s5, s76, 18
  s_lshl_b32 s4, s85, 11
  s_add_u32 s5, s5, s4
  s_lshl_b32 s4, s78, 7
  s_add_u32 s5, s5, s4
  s_lshl_b32 s4, s86, 6
  s_add_u32 s5, s5, s4
  buffer_load_dwordx4 v[240:243], v3, s[44:47], s5 offen
  s_add_u32 s5, s5, 0x10000
  buffer_load_dwordx4 v[244:247], v3, s[44:47], s5 offen
  s_add_u32 s5, s5, 0x10000
  buffer_load_dwordx4 v[248:251], v3, s[44:47], s5 offen
  s_add_u32 s5, s5, 0x10000
  buffer_load_dwordx4 v[252:255], v3, s[44:47], s5 offen
L_8:
  s_nop 0
  s_waitcnt lgkmcnt(0)
  s_mul_i32 s4, s85, 320
  s_add_u32 s4, s4, 151552
  v_and_b32_e64 v2, 15, v1
  v_lshl_add_u32 v3, v2, 2, s4
  v_add_u32 v124, s4, v29
  s_lshl_b32 s5, s86, 7
  s_add_u32 s5, s5, 153088
  v_add_u32_e64 v125, s5, v29
  v_lshl_add_u32 v2, v2, 2, s5
  s_mov_b32 s10, 0x7f
  s_mov_b32 s12, 0xff00ff00
  ds_read2_b32 v[94:95], v3 offset0:48 offset1:208
  ds_read_b128 v[106:109], v125 offset:256
  ds_read_b128 v[110:113], v125 offset:320
  ds_read_b128 v[224:227], v124 offset:192
  ds_read_b128 v[228:231], v124 offset:832
  ds_read2_b32 v[114:115], v2 offset0:128 offset1:144
  ds_read2_b32 v[88:89], v3 offset0:0 offset1:160
  ds_read2_b32 v[90:91], v3 offset0:16 offset1:176
  ds_read2_b32 v[92:93], v3 offset0:32 offset1:192
  ds_read_b128 v[98:101], v125 offset:0
  ds_read_b128 v[102:105], v125 offset:64
  s_add_u32 s9, s11, 65536
  v_lshrrev_b32_e64 v126, 1, v11
  v_bfi_b32 v126, s10, v11, v126
  v_mov_b64 v[64:65], 0
  v_mov_b64 v[66:67], 0
  v_mov_b64 v[232:233], 0
  v_mov_b64 v[234:235], 0
  v_mov_b32 v120, 0x3f803f80
  v_mov_b32 v121, 0x3f803f80
  v_mov_b32 v122, 0x3f803f80
  v_mov_b32 v123, 0x3f803f80
  s_nop 0
  s_waitcnt lgkmcnt(8)
  v_pk_mul_f32 v[116:117], v[106:107], v[94:95] op_sel:[0,1] op_sel_hi:[1,1]
  v_pk_mul_f32 v[118:119], v[108:109], v[94:95] op_sel:[0,1] op_sel_hi:[1,1]
  v_pk_fma_f32 v[184:185], v[184:185], v[94:95], v[116:117] op_sel:[0,0,0] op_sel_hi:[1,0,1] neg_lo:[0,0,1] neg_hi:[0,0,1]
  v_pk_fma_f32 v[186:187], v[186:187], v[94:95], v[118:119] op_sel:[0,0,0] op_sel_hi:[1,0,1] neg_lo:[0,0,1] neg_hi:[0,0,1]
  v_cvt_pk_bf16_f32 v60, v184, v185
  v_cvt_pk_bf16_f32 v61, v186, v187
  v_pk_mul_f32 v[116:117], v[110:111], v[94:95] op_sel:[0,1] op_sel_hi:[1,1]
  v_pk_mul_f32 v[118:119], v[112:113], v[94:95] op_sel:[0,1] op_sel_hi:[1,1]
  v_pk_fma_f32 v[188:189], v[188:189], v[94:95], v[116:117] op_sel:[0,0,0] op_sel_hi:[1,0,1] neg_lo:[0,0,1] neg_hi:[0,0,1]
  v_pk_fma_f32 v[190:191], v[190:191], v[94:95], v[118:119] op_sel:[0,0,0] op_sel_hi:[1,0,1] neg_lo:[0,0,1] neg_hi:[0,0,1]
  v_cvt_pk_bf16_f32 v62, v188, v189
  v_cvt_pk_bf16_f32 v63, v190, v191
  s_mov_b32 exec_lo, s12
  s_mov_b32 exec_hi, s12
  buffer_store_dwordx4 v[60:63], v126, s[40:43], s9 offen sc0 sc1
  s_mov_b64 exec, -1
  s_waitcnt lgkmcnt(5)
  v_pk_mul_f32 v[116:117], v[228:229], v[114:115] op_sel:[0,0] op_sel_hi:[1,0]
  v_pk_mul_f32 v[118:119], v[230:231], v[114:115] op_sel:[0,0] op_sel_hi:[1,0]
  v_pk_fma_f32 v[216:217], v[216:217], v[224:225], v[116:117] neg_lo:[0,0,1] neg_hi:[0,0,1]
  v_pk_fma_f32 v[218:219], v[218:219], v[226:227], v[118:119] neg_lo:[0,0,1] neg_hi:[0,0,1]
  v_cvt_pk_bf16_f32 v76, v216, v217
  v_cvt_pk_bf16_f32 v77, v218, v219
  v_pk_mul_f32 v[116:117], v[228:229], v[114:115] op_sel:[0,1] op_sel_hi:[1,1]
  v_pk_mul_f32 v[118:119], v[230:231], v[114:115] op_sel:[0,1] op_sel_hi:[1,1]
  v_pk_fma_f32 v[220:221], v[220:221], v[224:225], v[116:117] neg_lo:[0,0,1] neg_hi:[0,0,1]
  v_pk_fma_f32 v[222:223], v[222:223], v[226:227], v[118:119] neg_lo:[0,0,1] neg_hi:[0,0,1]
  v_cvt_pk_bf16_f32 v86, v220, v221
  v_cvt_pk_bf16_f32 v87, v222, v223
  v_mov_b64 v[78:79], v[86:87]
  s_mov_b32 exec_lo, 0
  s_mov_b32 exec_hi, Lz1-Lz0-1
  buffer_store_dwordx4 v[76:79], v11, s[40:43], s9 offen sc0 sc1
  s_mov_b64 exec, -1
  s_waitcnt lgkmcnt(0)
  v_pk_mul_f32 v[116:117], v[98:99], v[88:89] op_sel:[0,1] op_sel_hi:[1,1]
  v_pk_mul_f32 v[118:119], v[100:101], v[88:89] op_sel:[0,1] op_sel_hi:[1,1]
  v_pk_fma_f32 v[128:129], v[128:129], v[88:89], v[116:117] op_sel:[0,0,0] op_sel_hi:[1,0,1] neg_lo:[0,0,1] neg_hi:[0,0,1]
  v_pk_fma_f32 v[130:131], v[130:131], v[88:89], v[118:119] op_sel:[0,0,0] op_sel_hi:[1,0,1] neg_lo:[0,0,1] neg_hi:[0,0,1]
  v_cvt_pk_bf16_f32 v32, v128, v129
  v_cvt_pk_bf16_f32 v33, v130, v131
  v_pk_mul_f32 v[116:117], v[102:103], v[88:89] op_sel:[0,1] op_sel_hi:[1,1]
  v_pk_mul_f32 v[118:119], v[104:105], v[88:89] op_sel:[0,1] op_sel_hi:[1,1]
  v_pk_fma_f32 v[132:133], v[132:133], v[88:89], v[116:117] op_sel:[0,0,0] op_sel_hi:[1,0,1] neg_lo:[0,0,1] neg_hi:[0,0,1]
  v_pk_fma_f32 v[134:135], v[134:135], v[88:89], v[118:119] op_sel:[0,0,0] op_sel_hi:[1,0,1] neg_lo:[0,0,1] neg_hi:[0,0,1]
  v_cvt_pk_bf16_f32 v34, v132, v133
  v_cvt_pk_bf16_f32 v35, v134, v135
  v_pk_mul_f32 v[116:117], v[98:99], v[90:91] op_sel:[0,1] op_sel_hi:[1,1]
  v_pk_mul_f32 v[118:119], v[100:101], v[90:91] op_sel:[0,1] op_sel_hi:[1,1]
  v_pk_fma_f32 v[136:137], v[136:137], v[90:91], v[116:117] op_sel:[0,0,0] op_sel_hi:[1,0,1] neg_lo:[0,0,1] neg_hi:[0,0,1]
  v_pk_fma_f32 v[138:139], v[138:139], v[90:91], v[118:119] op_sel:[0,0,0] op_sel_hi:[1,0,1] neg_lo:[0,0,1] neg_hi:[0,0,1]
  v_cvt_pk_bf16_f32 v36, v136, v137
  v_cvt_pk_bf16_f32 v37, v138, v139
  v_pk_mul_f32 v[116:117], v[102:103], v[90:91] op_sel:[0,1] op_sel_hi:[1,1]
  v_pk_mul_f32 v[118:119], v[104:105], v[90:91] op_sel:[0,1] op_sel_hi:[1,1]
  v_pk_fma_f32 v[140:141], v[140:141], v[90:91], v[116:117] op_sel:[0,0,0] op_sel_hi:[1,0,1] neg_lo:[0,0,1] neg_hi:[0,0,1]
  v_pk_fma_f32 v[142:143], v[142:143], v[90:91], v[118:119] op_sel:[0,0,0] op_sel_hi:[1,0,1] neg_lo:[0,0,1] neg_hi:[0,0,1]
  v_cvt_pk_bf16_f32 v38, v140, v141
  v_cvt_pk_bf16_f32 v39, v142, v143
  v_pk_mul_f32 v[116:117], v[98:99], v[92:93] op_sel:[0,1] op_sel_hi:[1,1]
  v_pk_mul_f32 v[118:119], v[100:101], v[92:93] op_sel:[0,1] op_sel_hi:[1,1]
  v_pk_fma_f32 v[144:145], v[144:145], v[92:93], v[116:117] op_sel:[0,0,0] op_sel_hi:[1,0,1] neg_lo:[0,0,1] neg_hi:[0,0,1]
  v_pk_fma_f32 v[146:147], v[146:147], v[92:93], v[118:119] op_sel:[0,0,0] op_sel_hi:[1,0,1] neg_lo:[0,0,1] neg_hi:[0,0,1]
  v_cvt_pk_bf16_f32 v40, v144, v145
  v_cvt_pk_bf16_f32 v41, v146, v147
  v_pk_mul_f32 v[116:117], v[102:103], v[92:93] op_sel:[0,1] op_sel_hi:[1,1]
  v_pk_mul_f32 v[118:119], v[104:105], v[92:93] op_sel:[0,1] op_sel_hi:[1,1]
  v_pk_fma_f32 v[148:149], v[148:149], v[92:93], v[116:117] op_sel:[0,0,0] op_sel_hi:[1,0,1] neg_lo:[0,0,1] neg_hi:[0,0,1]
  v_pk_fma_f32 v[150:151], v[150:151], v[92:93], v[118:119] op_sel:[0,0,0] op_sel_hi:[1,0,1] neg_lo:[0,0,1] neg_hi:[0,0,1]
  v_cvt_pk_bf16_f32 v42, v148, v149
  v_cvt_pk_bf16_f32 v43, v150, v151
  v_pk_mul_f32 v[116:117], v[98:99], v[94:95] op_sel:[0,1] op_sel_hi:[1,1]
  v_pk_mul_f32 v[118:119], v[100:101], v[94:95] op_sel:[0,1] op_sel_hi:[1,1]
  v_pk_fma_f32 v[152:153], v[152:153], v[94:95], v[116:117] op_sel:[0,0,0] op_sel_hi:[1,0,1] neg_lo:[0,0,1] neg_hi:[0,0,1]
  v_pk_fma_f32 v[154:155], v[154:155], v[94:95], v[118:119] op_sel:[0,0,0] op_sel_hi:[1,0,1] neg_lo:[0,0,1] neg_hi:[0,0,1]
  v_cvt_pk_bf16_f32 v44, v152, v153
  v_cvt_pk_bf16_f32 v45, v154, v155
  v_pk_mul_f32 v[116:117], v[102:103], v[94:95] op_sel:[0,1] op_sel_hi:[1,1]
  v_pk_mul_f32 v[118:119], v[104:105], v[94:95] op_sel:[0,1] op_sel_hi:[1,1]
  v_pk_fma_f32 v[156:157], v[156:157], v[94:95], v[116:117] op_sel:[0,0,0] op_sel_hi:[1,0,1] neg_lo:[0,0,1] neg_hi:[0,0,1]
  v_pk_fma_f32 v[158:159], v[158:159], v[94:95], v[118:119] op_sel:[0,0,0] op_sel_hi:[1,0,1] neg_lo:[0,0,1] neg_hi:[0,0,1]
  v_cvt_pk_bf16_f32 v46, v156, v157
  v_cvt_pk_bf16_f32 v47, v158, v159
  ds_read_b128 v[128:131], v124 offset:0
  ds_read_b128 v[132:135], v124 offset:640
  ds_read_b128 v[136:139], v124 offset:64
  ds_read_b128 v[140:143], v124 offset:704
  ds_read_b128 v[144:147], v124 offset:128
  ds_read_b128 v[148:151], v124 offset:768
  v_pk_mul_f32 v[116:117], v[106:107], v[88:89] op_sel:[0,1] op_sel_hi:[1,1]
  v_pk_mul_f32 v[118:119], v[108:109], v[88:89] op_sel:[0,1] op_sel_hi:[1,1]
  v_pk_fma_f32 v[160:161], v[160:161], v[88:89], v[116:117] op_sel:[0,0,0] op_sel_hi:[1,0,1] neg_lo:[0,0,1] neg_hi:[0,0,1]
  v_pk_fma_f32 v[162:163], v[162:163], v[88:89], v[118:119] op_sel:[0,0,0] op_sel_hi:[1,0,1] neg_lo:[0,0,1] neg_hi:[0,0,1]
  v_cvt_pk_bf16_f32 v48, v160, v161
  v_cvt_pk_bf16_f32 v49, v162, v163
  v_pk_mul_f32 v[116:117], v[110:111], v[88:89] op_sel:[0,1] op_sel_hi:[1,1]
  v_pk_mul_f32 v[118:119], v[112:113], v[88:89] op_sel:[0,1] op_sel_hi:[1,1]
  v_pk_fma_f32 v[164:165], v[164:165], v[88:89], v[116:117] op_sel:[0,0,0] op_sel_hi:[1,0,1] neg_lo:[0,0,1] neg_hi:[0,0,1]
  v_pk_fma_f32 v[166:167], v[166:167], v[88:89], v[118:119] op_sel:[0,0,0] op_sel_hi:[1,0,1] neg_lo:[0,0,1] neg_hi:[0,0,1]
  v_cvt_pk_bf16_f32 v50, v164, v165
  v_cvt_pk_bf16_f32 v51, v166, v167
  v_pk_mul_f32 v[116:117], v[106:107], v[90:91] op_sel:[0,1] op_sel_hi:[1,1]
  v_pk_mul_f32 v[118:119], v[108:109], v[90:91] op_sel:[0,1] op_sel_hi:[1,1]
  v_pk_fma_f32 v[168:169], v[168:169], v[90:91], v[116:117] op_sel:[0,0,0] op_sel_hi:[1,0,1] neg_lo:[0,0,1] neg_hi:[0,0,1]
  v_pk_fma_f32 v[170:171], v[170:171], v[90:91], v[118:119] op_sel:[0,0,0] op_sel_hi:[1,0,1] neg_lo:[0,0,1] neg_hi:[0,0,1]
  v_cvt_pk_bf16_f32 v52, v168, v169
  v_cvt_pk_bf16_f32 v53, v170, v171
  v_pk_mul_f32 v[116:117], v[110:111], v[90:91] op_sel:[0,1] op_sel_hi:[1,1]
  v_pk_mul_f32 v[118:119], v[112:113], v[90:91] op_sel:[0,1] op_sel_hi:[1,1]
  v_pk_fma_f32 v[172:173], v[172:173], v[90:91], v[116:117] op_sel:[0,0,0] op_sel_hi:[1,0,1] neg_lo:[0,0,1] neg_hi:[0,0,1]
  v_pk_fma_f32 v[174:175], v[174:175], v[90:91], v[118:119] op_sel:[0,0,0] op_sel_hi:[1,0,1] neg_lo:[0,0,1] neg_hi:[0,0,1]
  v_cvt_pk_bf16_f32 v54, v172, v173
  v_cvt_pk_bf16_f32 v55, v174, v175
  v_pk_mul_f32 v[116:117], v[106:107], v[92:93] op_sel:[0,1] op_sel_hi:[1,1]
  v_pk_mul_f32 v[118:119], v[108:109], v[92:93] op_sel:[0,1] op_sel_hi:[1,1]
  v_pk_fma_f32 v[176:177], v[176:177], v[92:93], v[116:117] op_sel:[0,0,0] op_sel_hi:[1,0,1] neg_lo:[0,0,1] neg_hi:[0,0,1]
  v_pk_fma_f32 v[178:179], v[178:179], v[92:93], v[118:119] op_sel:[0,0,0] op_sel_hi:[1,0,1] neg_lo:[0,0,1] neg_hi:[0,0,1]
  v_cvt_pk_bf16_f32 v56, v176, v177
  v_cvt_pk_bf16_f32 v57, v178, v179
  v_pk_mul_f32 v[116:117], v[110:111], v[92:93] op_sel:[0,1] op_sel_hi:[1,1]
  v_pk_mul_f32 v[118:119], v[112:113], v[92:93] op_sel:[0,1] op_sel_hi:[1,1]
  v_pk_fma_f32 v[180:181], v[180:181], v[92:93], v[116:117] op_sel:[0,0,0] op_sel_hi:[1,0,1] neg_lo:[0,0,1] neg_hi:[0,0,1]
  v_pk_fma_f32 v[182:183], v[182:183], v[92:93], v[118:119] op_sel:[0,0,0] op_sel_hi:[1,0,1] neg_lo:[0,0,1] neg_hi:[0,0,1]
  v_cvt_pk_bf16_f32 v58, v180, v181
  v_cvt_pk_bf16_f32 v59, v182, v183
  v_mfma_f32_16x16x32_bf16 v[164:167], v[48:51], v[32:35], v[12:15]
  v_mfma_f32_16x16x32_bf16 v[168:171], v[48:51], v[36:39], v[16:19]
  v_mfma_f32_16x16x32_bf16 v[172:175], v[52:55], v[36:39], v[12:15]
  v_mfma_f32_16x16x32_bf16 v[176:179], v[52:55], v[40:43], v[16:19]
  v_mfma_f32_16x16x32_bf16 v[180:183], v[56:59], v[40:43], v[12:15]
  v_mfma_f32_16x16x32_bf16 v[184:187], v[56:59], v[44:47], v[16:19]
  v_mfma_f32_16x16x32_bf16 v[188:191], v[60:63], v[44:47], v[12:15]
  s_nop 0
  s_waitcnt lgkmcnt(0)
  v_pk_mul_f32 v[116:117], v[132:133], v[114:115] op_sel:[0,0] op_sel_hi:[1,0]
  v_pk_mul_f32 v[118:119], v[134:135], v[114:115] op_sel:[0,0] op_sel_hi:[1,0]
  v_pk_fma_f32 v[192:193], v[192:193], v[128:129], v[116:117] neg_lo:[0,0,1] neg_hi:[0,0,1]
  v_pk_fma_f32 v[194:195], v[194:195], v[130:131], v[118:119] neg_lo:[0,0,1] neg_hi:[0,0,1]
  v_cvt_pk_bf16_f32 v70, v192, v193
  v_cvt_pk_bf16_f32 v71, v194, v195
  v_pk_mul_f32 v[116:117], v[132:133], v[114:115] op_sel:[0,1] op_sel_hi:[1,1]
  v_pk_mul_f32 v[118:119], v[134:135], v[114:115] op_sel:[0,1] op_sel_hi:[1,1]
  v_pk_fma_f32 v[196:197], v[196:197], v[128:129], v[116:117] neg_lo:[0,0,1] neg_hi:[0,0,1]
  v_pk_fma_f32 v[198:199], v[198:199], v[130:131], v[118:119] neg_lo:[0,0,1] neg_hi:[0,0,1]
  v_cvt_pk_bf16_f32 v80, v196, v197
  v_cvt_pk_bf16_f32 v81, v198, v199
  v_pk_mul_f32 v[116:117], v[140:141], v[114:115] op_sel:[0,0] op_sel_hi:[1,0]
  v_pk_mul_f32 v[118:119], v[142:143], v[114:115] op_sel:[0,0] op_sel_hi:[1,0]
  v_pk_fma_f32 v[200:201], v[200:201], v[136:137], v[116:117] neg_lo:[0,0,1] neg_hi:[0,0,1]
  v_pk_fma_f32 v[202:203], v[202:203], v[138:139], v[118:119] neg_lo:[0,0,1] neg_hi:[0,0,1]
  v_cvt_pk_bf16_f32 v72, v200, v201
  v_cvt_pk_bf16_f32 v73, v202, v203
  v_pk_mul_f32 v[116:117], v[140:141], v[114:115] op_sel:[0,1] op_sel_hi:[1,1]
  v_pk_mul_f32 v[118:119], v[142:143], v[114:115] op_sel:[0,1] op_sel_hi:[1,1]
  v_pk_fma_f32 v[204:205], v[204:205], v[136:137], v[116:117] neg_lo:[0,0,1] neg_hi:[0,0,1]
  v_pk_fma_f32 v[206:207], v[206:207], v[138:139], v[118:119] neg_lo:[0,0,1] neg_hi:[0,0,1]
  v_cvt_pk_bf16_f32 v82, v204, v205
  v_cvt_pk_bf16_f32 v83, v206, v207
  v_pk_mul_f32 v[116:117], v[148:149], v[114:115] op_sel:[0,0] op_sel_hi:[1,0]
  v_pk_mul_f32 v[118:119], v[150:151], v[114:115] op_sel:[0,0] op_sel_hi:[1,0]
  v_pk_fma_f32 v[208:209], v[208:209], v[144:145], v[116:117] neg_lo:[0,0,1] neg_hi:[0,0,1]
  v_pk_fma_f32 v[210:211], v[210:211], v[146:147], v[118:119] neg_lo:[0,0,1] neg_hi:[0,0,1]
  v_cvt_pk_bf16_f32 v74, v208, v209
  v_cvt_pk_bf16_f32 v75, v210, v211
  v_pk_mul_f32 v[116:117], v[148:149], v[114:115] op_sel:[0,1] op_sel_hi:[1,1]
  v_pk_mul_f32 v[118:119], v[150:151], v[114:115] op_sel:[0,1] op_sel_hi:[1,1]
  v_pk_fma_f32 v[212:213], v[212:213], v[144:145], v[116:117] neg_lo:[0,0,1] neg_hi:[0,0,1]
  v_pk_fma_f32 v[214:215], v[214:215], v[146:147], v[118:119] neg_lo:[0,0,1] neg_hi:[0,0,1]
  v_cvt_pk_bf16_f32 v84, v212, v213
  v_cvt_pk_bf16_f32 v85, v214, v215
  v_max3_f32 v90, v172, v173, v174
  v_max3_f32 v99, v175, v168, v169
  v_max3_f32 v92, v180, v181, v182
  v_max3_f32 v100, v183, v176, v177
  v_max3_f32 v94, v188, v189, v190
  v_max3_f32 v101, v191, v184, v185
  v_max3_f32 v90, v90, v170, v171
  v_max3_f32 v92, v92, v178, v179
  v_max3_f32 v94, v94, v186, v187
  v_max_f32 v90, v90, v99
  v_max_f32 v92, v92, v100
  v_max_f32 v94, v94, v101
  v_mov_b32 v99, v90
  v_mov_b32 v100, v92
  v_mov_b32 v101, v94
  v_permlane32_swap_b32 v90, v99
  v_permlane32_swap_b32 v92, v100
  v_permlane32_swap_b32 v94, v101
  v_max_f32 v90, v90, v99
  v_max_f32 v92, v92, v100
  v_max_f32 v94, v94, v101
  v_mov_b32 v99, v90
  v_mov_b32 v100, v92
  v_mov_b32 v101, v94
  v_permlane16_swap_b32 v90, v99
  v_permlane16_swap_b32 v92, v100
  v_permlane16_swap_b32 v94, v101
  v_max_f32 v90, v90, v99
  v_max_f32 v92, v92, v100
  v_max_f32_e64 v94, v94, v101
  s_mov_b32 s4, 0x3e8293ee
  v_mul_f32 v90, s4, v90
  v_mov_b32 v91, s4
  v_mul_f32 v92, s4, v92
  v_mov_b32 v93, s4
  v_mul_f32 v94, s4, v94
  v_mov_b32 v95, s4
  v_pk_fma_f32 v[168:169], v[168:169], v[90:91], v[90:91] op_sel:[0,1,0] op_sel_hi:[1,1,0] neg_lo:[0,0,1] neg_hi:[0,0,1]
  v_pk_fma_f32 v[170:171], v[170:171], v[90:91], v[90:91] op_sel:[0,1,0] op_sel_hi:[1,1,0] neg_lo:[0,0,1] neg_hi:[0,0,1]
  v_pk_fma_f32 v[172:173], v[172:173], v[90:91], v[90:91] op_sel:[0,1,0] op_sel_hi:[1,1,0] neg_lo:[0,0,1] neg_hi:[0,0,1]
  v_pk_fma_f32 v[174:175], v[174:175], v[90:91], v[90:91] op_sel:[0,1,0] op_sel_hi:[1,1,0] neg_lo:[0,0,1] neg_hi:[0,0,1]
  v_pk_fma_f32 v[176:177], v[176:177], v[92:93], v[92:93] op_sel:[0,1,0] op_sel_hi:[1,1,0] neg_lo:[0,0,1] neg_hi:[0,0,1]
  v_pk_fma_f32 v[178:179], v[178:179], v[92:93], v[92:93] op_sel:[0,1,0] op_sel_hi:[1,1,0] neg_lo:[0,0,1] neg_hi:[0,0,1]
  v_pk_fma_f32 v[180:181], v[180:181], v[92:93], v[92:93] op_sel:[0,1,0] op_sel_hi:[1,1,0] neg_lo:[0,0,1] neg_hi:[0,0,1]
  v_pk_fma_f32 v[182:183], v[182:183], v[92:93], v[92:93] op_sel:[0,1,0] op_sel_hi:[1,1,0] neg_lo:[0,0,1] neg_hi:[0,0,1]
  v_pk_fma_f32 v[184:185], v[184:185], v[94:95], v[94:95] op_sel:[0,1,0] op_sel_hi:[1,1,0] neg_lo:[0,0,1] neg_hi:[0,0,1]
  v_pk_fma_f32 v[186:187], v[186:187], v[94:95], v[94:95] op_sel:[0,1,0] op_sel_hi:[1,1,0] neg_lo:[0,0,1] neg_hi:[0,0,1]
  v_pk_fma_f32 v[188:189], v[188:189], v[94:95], v[94:95] op_sel:[0,1,0] op_sel_hi:[1,1,0] neg_lo:[0,0,1] neg_hi:[0,0,1]
  v_pk_fma_f32 v[190:191], v[190:191], v[94:95], v[94:95] op_sel:[0,1,0] op_sel_hi:[1,1,0] neg_lo:[0,0,1] neg_hi:[0,0,1]
  s_lshl_b32 s6, s84, Lz1-Lz0+3
  s_add_u32 s6, s6, 3145728
  s_add_u32 s7, s6, 4096
  s_mov_b32 exec_lo, s12
  s_mov_b32 exec_hi, s12
  buffer_load_dwordx4 v[64:67], v126, s[40:43], s11 offen sc0 sc1
  s_mov_b32 exec_lo, 0
  s_mov_b32 exec_hi, -1
  buffer_load_dwordx4 v[232:235], v11, s[40:43], s11 offen sc0 sc1
  s_mov_b64 exec, -1
  v_exp_f32 v168, v168
  v_exp_f32 v169, v169
  v_exp_f32 v170, v170
  v_exp_f32 v171, v171
  v_exp_f32 v172, v172
  v_exp_f32 v173, v173
  v_exp_f32 v174, v174
  v_exp_f32_e64 v175, v175
  v_cvt_pk_bf16_f32 v36, v168, v169
  v_cvt_pk_bf16_f32 v37, v170, v171
  v_cvt_pk_bf16_f32 v38, v172, v173
  v_cvt_pk_bf16_f32 v39, v174, v175
  v_exp_f32 v176, v176
  v_exp_f32 v177, v177
  v_exp_f32 v178, v178
  v_exp_f32 v179, v179
  v_exp_f32 v180, v180
  v_exp_f32 v181, v181
  v_exp_f32 v182, v182
  v_exp_f32 v183, v183
  v_cvt_pk_bf16_f32 v40, v176, v177
  v_cvt_pk_bf16_f32 v41, v178, v179
  v_cvt_pk_bf16_f32 v42, v180, v181
  v_cvt_pk_bf16_f32 v43, v182, v183
  v_mfma_f32_16x16x32_bf16 v[132:135], v[120:123], v[36:39], 0
  v_mfma_f32_16x16x32_bf16 v[200:203], v[70:73], v[36:39], 0
  v_mfma_f32_16x16x32_bf16 v[204:207], v[80:83], v[36:39], 0
  v_exp_f32 v184, v184
  v_exp_f32 v185, v185
  v_exp_f32 v186, v186
  v_exp_f32 v187, v187
  v_exp_f32 v188, v188
  v_exp_f32 v189, v189
  v_exp_f32 v190, v190
  v_exp_f32 v191, v191
  v_cvt_pk_bf16_f32 v44, v184, v185
  v_cvt_pk_bf16_f32 v45, v186, v187
  v_cvt_pk_bf16_f32 v46, v188, v189
  v_cvt_pk_bf16_f32 v47, v190, v191
  v_mfma_f32_16x16x32_bf16 v[136:139], v[120:123], v[40:43], 0
  v_mfma_f32_16x16x32_bf16 v[208:211], v[72:75], v[40:43], 0
  v_mfma_f32_16x16x32_bf16 v[212:215], v[82:85], v[40:43], 0
  v_mfma_f32_16x16x32_bf16 v[140:143], v[120:123], v[44:47], 0
  v_mfma_f32_16x16x32_bf16 v[216:219], v[74:77], v[44:47], 0
  v_mfma_f32_16x16x32_bf16 v[220:223], v[84:87], v[44:47], 0
  v_rcp_f32 v132, v132
  s_nop 0
  v_pk_mul_f32 v[200:201], v[200:201], v[132:133] op_sel_hi:[1,0]
  v_pk_mul_f32 v[202:203], v[202:203], v[132:133] op_sel_hi:[1,0]
  v_pk_mul_f32 v[204:205], v[204:205], v[132:133] op_sel_hi:[1,0]
  v_pk_mul_f32 v[206:207], v[206:207], v[132:133] op_sel_hi:[1,0]
  v_cvt_pk_bf16_f32 v52, v200, v201
  v_cvt_pk_bf16_f32 v53, v202, v203
  v_cvt_pk_bf16_f32 v54, v204, v205
  v_cvt_pk_bf16_f32 v55, v206, v207
  buffer_store_dwordx4 v[52:55], v0, s[40:43], s6 offen offset:2048 sc0 sc1
  v_rcp_f32 v136, v136
  s_nop 0
  v_pk_mul_f32 v[208:209], v[208:209], v[136:137] op_sel_hi:[1,0]
  v_pk_mul_f32 v[210:211], v[210:211], v[136:137] op_sel_hi:[1,0]
  v_pk_mul_f32 v[212:213], v[212:213], v[136:137] op_sel_hi:[1,0]
  v_pk_mul_f32 v[214:215], v[214:215], v[136:137] op_sel_hi:[1,0]
  v_cvt_pk_bf16_f32 v56, v208, v209
  v_cvt_pk_bf16_f32 v57, v210, v211
  v_cvt_pk_bf16_f32 v58, v212, v213
  v_cvt_pk_bf16_f32 v59, v214, v215
  buffer_store_dwordx4 v[56:59], v0, s[40:43], s7 offen offset:0 sc0 sc1
  v_rcp_f32 v140, v140
  s_nop 0
  v_pk_mul_f32 v[216:217], v[216:217], v[140:141] op_sel_hi:[1,0]
  v_pk_mul_f32 v[218:219], v[218:219], v[140:141] op_sel_hi:[1,0]
  v_pk_mul_f32 v[220:221], v[220:221], v[140:141] op_sel_hi:[1,0]
  v_pk_mul_f32 v[222:223], v[222:223], v[140:141] op_sel_hi:[1,0]
  v_cvt_pk_bf16_f32 v60, v216, v217
  v_cvt_pk_bf16_f32 v61, v218, v219
  v_cvt_pk_bf16_f32 v62, v220, v221
  v_cvt_pk_bf16_f32 v63, v222, v223
  buffer_store_dwordx4 v[60:63], v0, s[40:43], s7 offen offset:2048 sc0 sc1
  s_cmp_eq_u32 s76, Lz1-Lz0+0
  s_mov_b32 s89, 200000
  s_waitcnt vmcnt(3)
  s_cbranch_scc0 Lh_10
  v_mov_b64 v[64:65], 0
  v_mov_b64 v[66:67], 0
  v_mov_b64 v[232:233], 0
  v_mov_b64 v[234:235], 0
  s_branch Lh_11
  s_nop 0
Lh_9:
  s_mov_b32 exec_lo, s12
  s_mov_b32 exec_hi, s12
  buffer_load_dwordx4 v[64:67], v126, s[40:43], s11 offen sc0 sc1
  s_mov_b32 exec_lo, 0
  s_mov_b32 exec_hi, -1
  buffer_load_dwordx4 v[232:235], v11, s[40:43], s11 offen sc0 sc1
  s_mov_b64 exec, -1
  s_waitcnt vmcnt(0)
Lh_10:
  v_max3_u32 v2, v64, v65, v66
  v_max3_u32 v3, v232, v233, v234
  v_max3_u32 v2, v2, v67, v235
  v_max_u32_e64 v2, v2, v3
  v_cmp_eq_u32 vcc, -1, v2
  s_cbranch_vccz Lh_11
  s_sub_u32 s89, s89, 1
  s_cbranch_scc0 Lh_9
Lh_11:
  v_mfma_f32_16x16x32_bf16 v[160:163], v[64:67], v[32:35], v[20:23]
  v_mov_b64 v[68:69], v[232:233]
  v_mov_b64 v[78:79], v[234:235]
  v_mov_b64 v[236:237], -1
  v_mov_b64 v[238:239], -1
  buffer_store_dwordx4 v[236:239], v11, s[40:43], s11 offen sc0 sc1
  v_max3_f32 v88, v164, v165, v166
  s_nop 0
  s_nop 1
  v_max3_f32 v98, v167, v160, v161
  v_max3_f32 v88, v88, v162, v163
  v_max_f32 v88, v88, v98
  v_mov_b32 v98, v88
  s_nop 1
  v_permlane32_swap_b32 v88, v98
  v_max_f32 v88, v88, v98
  v_mov_b32 v98, v88
  s_nop 1
  v_permlane16_swap_b32 v88, v98
  v_max_f32_e64 v88, v88, v98
  s_mov_b32 s4, 0x3e8293ee
  v_mul_f32 v88, s4, v88
  v_mov_b32 v89, s4
  v_pk_fma_f32 v[160:161], v[160:161], v[88:89], v[88:89] op_sel:[0,1,0] op_sel_hi:[1,1,0] neg_lo:[0,0,1] neg_hi:[0,0,1]
  v_pk_fma_f32 v[162:163], v[162:163], v[88:89], v[88:89] op_sel:[0,1,0] op_sel_hi:[1,1,0] neg_lo:[0,0,1] neg_hi:[0,0,1]
  v_pk_fma_f32 v[164:165], v[164:165], v[88:89], v[88:89] op_sel:[0,1,0] op_sel_hi:[1,1,0] neg_lo:[0,0,1] neg_hi:[0,0,1]
  v_pk_fma_f32 v[166:167], v[166:167], v[88:89], v[88:89] op_sel:[0,1,0] op_sel_hi:[1,1,0] neg_lo:[0,0,1] neg_hi:[0,0,1]
  v_exp_f32 v160, v160
  v_exp_f32 v161, v161
  v_exp_f32 v162, v162
  v_exp_f32 v163, v163
  v_exp_f32 v164, v164
  v_exp_f32 v165, v165
  v_exp_f32 v166, v166
  v_exp_f32 v167, v167
  v_cvt_pk_bf16_f32 v32, v160, v161
  v_cvt_pk_bf16_f32 v33, v162, v163
  v_cvt_pk_bf16_f32 v34, v164, v165
  v_cvt_pk_bf16_f32 v35, v166, v167
  s_nop 0
  s_nop 1
  v_mfma_f32_16x16x32_bf16 v[128:131], v[120:123], v[32:35], 0
  v_mfma_f32_16x16x32_bf16 v[192:195], v[68:71], v[32:35], 0
  v_mfma_f32_16x16x32_bf16 v[196:199], v[78:81], v[32:35], 0
  s_nop 5
  v_rcp_f32_e64 v128, v128
  s_nop 0
  v_pk_mul_f32 v[192:193], v[192:193], v[128:129] op_sel_hi:[1,0]
  v_pk_mul_f32 v[194:195], v[194:195], v[128:129] op_sel_hi:[1,0]
  v_pk_mul_f32 v[196:197], v[196:197], v[128:129] op_sel_hi:[1,0]
  v_pk_mul_f32 v[198:199], v[198:199], v[128:129] op_sel_hi:[1,0]
  v_cvt_pk_bf16_f32 v48, v192, v193
  v_cvt_pk_bf16_f32 v49, v194, v195
  v_cvt_pk_bf16_f32 v50, v196, v197
  v_cvt_pk_bf16_f32 v51, v198, v199
  buffer_store_dwordx4 v[48:51], v0, s[40:43], s6 offen offset:0 sc0 sc1
  ds_read_b32 v3, v28 offset:8
  s_cmp_lg_u32 s82, 0
  s_cbranch_scc1 L_13
  v_permlane16_swap_b32 v240, v242
  v_permlane16_swap_b32 v241, v243
  v_permlane16_swap_b32 v244, v246
  v_permlane16_swap_b32 v245, v247
  v_permlane16_swap_b32 v248, v250
  v_permlane16_swap_b32 v249, v251
  v_permlane16_swap_b32 v252, v254
  v_permlane16_swap_b32 v253, v255
L_13:
  s_mov_b32 s16, Lz1-Lz0+0
  s_mov_b32 s17, 16384
  s_mov_b32 s18, 0xffff4000
  s_mov_b32 s19, 32768
  s_mov_b32 s20, 8192
  s_mov_b32 s21, 0xfffee000
  s_mul_i32 s4, s85, 8192
  v_add_u32_e64 v4, s4, v11
  v_add_u32 v5, 1024, v4
  s_add_u32 s5, s19, 0
  s_lshl_b32 s4, s86, 1
  v_xor_b32_e64 v2, s4, v26
  v_lshl_add_u32 v6, v2, 5, v25
  v_add_u32 v6, s5, v6
  s_add_u32 s4, s4, 1
  v_xor_b32_e64 v2, s4, v26
  v_lshl_add_u32 v7, v2, 5, v25
  v_add_u32 v7, s5, v7
  s_lshl_b32 s5, s82, 1
  s_add_u32 s5, s5, Lz1-Lz0+2
  s_mov_b32 s89, 1600000
  s_branch Lw_15
Lw_14:
  ds_read_b32 v3, v28 offset:8
Lw_15:
  s_waitcnt lgkmcnt(0)
  v_readfirstlane_b32 s4, v3
  s_cmp_ge_u32 s4, s5
  s_cbranch_scc1 Lw_16
  s_sleep 1
  s_sub_u32 s89, s89, 1
  s_cbranch_scc0 Lw_14
Lw_16:
  ds_read_b64_tr_b16 v[48:49], v6 offset:0
  ds_read_b64_tr_b16 v[50:51], v6 offset:2048
  ds_read_b64_tr_b16 v[52:53], v7 offset:0
  ds_read_b64_tr_b16 v[54:55], v7 offset:2048
  ds_read_b64_tr_b16 v[80:81], v6 offset:4096
  ds_read_b64_tr_b16 v[82:83], v6 offset:6144
  ds_read_b64_tr_b16 v[84:85], v7 offset:4096
  ds_read_b64_tr_b16 v[86:87], v7 offset:6144
  ds_read_b64_tr_b16 v[112:113], v6 offset:8192
  ds_read_b64_tr_b16 v[114:115], v6 offset:10240
  ds_read_b64_tr_b16 v[116:117], v7 offset:8192
  ds_read_b64_tr_b16 v[118:119], v7 offset:10240
  s_nop 0
  s_waitcnt lgkmcnt(8)
  ds_read_b64_tr_b16 v[208:209], v6 offset:12288
  ds_read_b64_tr_b16 v[210:211], v6 offset:14336
  ds_read_b64_tr_b16 v[212:213], v7 offset:12288
  ds_read_b64_tr_b16 v[214:215], v7 offset:14336
  s_nop 0
  s_waitcnt lgkmcnt(8)
  ds_read_b64_tr_b16 v[160:161], v6 offset:16384
  ds_read_b64_tr_b16 v[162:163], v6 offset:18432
  ds_read_b64_tr_b16 v[164:165], v7 offset:16384
  ds_read_b64_tr_b16 v[166:167], v7 offset:18432
  s_nop 0
  s_waitcnt lgkmcnt(8)
  ds_read_b64_tr_b16 v[168:169], v6 offset:20480
  ds_read_b64_tr_b16 v[170:171], v6 offset:22528
  ds_read_b64_tr_b16 v[172:173], v7 offset:20480
  ds_read_b64_tr_b16 v[174:175], v7 offset:22528
  s_nop 0
  s_waitcnt lgkmcnt(8)
  ds_read_b64_tr_b16 v[176:177], v6 offset:24576
  ds_read_b64_tr_b16 v[178:179], v6 offset:26624
  ds_read_b64_tr_b16 v[180:181], v7 offset:24576
  ds_read_b64_tr_b16 v[182:183], v7 offset:26624
  s_nop 0
  s_waitcnt lgkmcnt(8)
  ds_read_b64_tr_b16 v[184:185], v6 offset:28672
  ds_read_b64_tr_b16 v[186:187], v6 offset:30720
  ds_read_b64_tr_b16 v[188:189], v7 offset:28672
  ds_read_b64_tr_b16 v[190:191], v7 offset:30720
  s_nop 0
  s_waitcnt lgkmcnt(8)
  ds_read_b64_tr_b16 v[224:225], v6 offset:32768
  ds_read_b64_tr_b16 v[226:227], v6 offset:34816
  ds_read_b64_tr_b16 v[228:229], v7 offset:32768
  ds_read_b64_tr_b16 v[230:231], v7 offset:34816
  s_nop 0
  s_waitcnt lgkmcnt(8)
  ds_read_b64_tr_b16 v[232:233], v6 offset:36864
  ds_read_b64_tr_b16 v[234:235], v6 offset:38912
  ds_read_b64_tr_b16 v[236:237], v7 offset:36864
  ds_read_b64_tr_b16 v[238:239], v7 offset:38912
  s_nop 0
  s_waitcnt lgkmcnt(8)
  ds_read_b64_tr_b16 v[56:57], v6 offset:40960
  ds_read_b64_tr_b16 v[58:59], v6 offset:43008
  ds_read_b64_tr_b16 v[60:61], v7 offset:40960
  ds_read_b64_tr_b16 v[62:63], v7 offset:43008
  s_nop 0
  s_waitcnt lgkmcnt(8)
  ds_read_b64_tr_b16 v[88:89], v6 offset:45056
  ds_read_b64_tr_b16 v[90:91], v6 offset:47104
  ds_read_b64_tr_b16 v[92:93], v7 offset:45056
  ds_read_b64_tr_b16 v[94:95], v7 offset:47104
  s_waitcnt lgkmcnt(8)
  s_mov_b32 s19, 0
  v_add_u32 v6, 0xffff8000, v6
  v_add_u32 v7, 0xffff8000, v7
  s_waitcnt lgkmcnt(0)
  s_mov_b64 exec, 1
  ds_add_u32 v28, v27 offset:12
  s_mov_b64 exec, -1
  s_add_u32 s5, s87, 0
  s_waitcnt vmcnt(0)
  s_mov_b64 exec, 1
  ds_add_rtn_u32 v2, v28, v27 offset:0
  s_waitcnt lgkmcnt(0)
  v_readfirstlane_b32 s4, v2
  s_and_b32 s4, s4, Lz1-Lz0+3
  s_cmp_lg_u32 s4, 3
  s_cbranch_scc1 Ls_17
  s_mov_b32 exec_lo, 0xffff
  buffer_store_dword v27, v24, s[40:43], s5 offen sc0 sc1
Ls_17:
  s_mov_b64 exec, -1
  s_mov_b32 s4, 0xffff0000
  v_lshlrev_b32 v128, 16, v240
  v_and_b32 v129, s4, v240
  v_lshlrev_b32 v130, 16, v241
  v_and_b32 v131, s4, v241
  v_lshlrev_b32 v132, 16, v242
  v_and_b32 v133, s4, v242
  v_lshlrev_b32 v134, 16, v243
  v_and_b32 v135, s4, v243
  v_lshlrev_b32 v136, 16, v244
  v_and_b32 v137, s4, v244
  v_lshlrev_b32 v138, 16, v245
  v_and_b32 v139, s4, v245
  v_lshlrev_b32 v140, 16, v246
  v_and_b32 v141, s4, v246
  v_lshlrev_b32 v142, 16, v247
  v_and_b32 v143, s4, v247
  v_lshlrev_b32 v144, 16, v248
  v_and_b32 v145, s4, v248
  v_lshlrev_b32 v146, 16, v249
  v_and_b32 v147, s4, v249
  v_lshlrev_b32 v148, 16, v250
  v_and_b32 v149, s4, v250
  v_lshlrev_b32 v150, 16, v251
  v_and_b32 v151, s4, v251
  v_lshlrev_b32 v152, 16, v252
  v_and_b32 v153, s4, v252
  v_lshlrev_b32 v154, 16, v253
  v_and_b32 v155, s4, v253
  v_lshlrev_b32 v156, 16, v254
  v_and_b32 v157, s4, v254
  v_lshlrev_b32 v158, 16, v255
  v_and_b32_e64 v159, s4, v255
  s_mov_b32 s22, 5
  s_barrier
  ds_read_b128 v[32:35], v4 offset:0
  ds_read_b128 v[36:39], v4 offset:2048
  ds_read_b128 v[40:43], v4 offset:4096
  ds_read_b128 v[44:47], v4 offset:6144
  ds_read_b128 v[64:67], v5 offset:0
  ds_read_b128 v[68:71], v5 offset:2048
  ds_read_b128 v[72:75], v5 offset:4096
  ds_read_b128 v[76:79], v5 offset:6144
  s_add_u32 s16, s16, s17
  s_cmp_eq_u32 s16, 65536
  s_cselect_b32 s23, s18, s17
  s_cselect_b32 s16, 0, s16
  v_add_u32 v4, s23, v4
  v_add_u32_e64 v5, s23, v5
  s_waitcnt lgkmcnt(0)
  s_barrier
  v_mfma_f32_16x16x32_bf16 v[128:131], v[48:51], v[32:35], v[128:131]
  ds_read_b128 v[96:99], v4 offset:0
  ds_read_b128 v[100:103], v4 offset:2048
  v_mfma_f32_16x16x32_bf16 v[128:131], v[80:83], v[64:67], v[128:131]
  ds_read_b128 v[104:107], v4 offset:4096
  ds_read_b128 v[108:111], v4 offset:6144
  v_mfma_f32_16x16x32_bf16 v[136:139], v[80:83], v[68:71], v[136:139]
  ds_read_b128 v[192:195], v5 offset:0
  ds_read_b128 v[196:199], v5 offset:2048
  v_mfma_f32_16x16x32_bf16 v[136:139], v[48:51], v[36:39], v[136:139]
  ds_read_b128 v[200:203], v5 offset:4096
  ds_read_b128 v[204:207], v5 offset:6144
  v_mfma_f32_16x16x32_bf16 v[144:147], v[48:51], v[40:43], v[144:147]
  s_add_u32 s16, s16, s17
  s_cmp_eq_u32 s16, 65536
  s_cselect_b32 s23, s18, s17
  v_mfma_f32_16x16x32_bf16 v[144:147], v[80:83], v[72:75], v[144:147]
  s_cselect_b32 s16, 0, s16
  v_add_u32 v4, s23, v4
  v_add_u32_e64 v5, s23, v5
  v_mfma_f32_16x16x32_bf16 v[152:155], v[80:83], v[76:79], v[152:155]
  v_mfma_f32_16x16x32_bf16 v[152:155], v[48:51], v[44:47], v[152:155]
  v_mfma_f32_16x16x32_bf16 v[156:159], v[52:55], v[44:47], v[156:159]
  v_mfma_f32_16x16x32_bf16 v[156:159], v[84:87], v[76:79], v[156:159]
  v_mfma_f32_16x16x32_bf16 v[148:151], v[84:87], v[72:75], v[148:151]
  v_mfma_f32_16x16x32_bf16 v[148:151], v[52:55], v[40:43], v[148:151]
  v_mfma_f32_16x16x32_bf16 v[140:143], v[52:55], v[36:39], v[140:143]
  v_mfma_f32_16x16x32_bf16 v[140:143], v[84:87], v[68:71], v[140:143]
  v_mfma_f32_16x16x32_bf16 v[132:135], v[84:87], v[64:67], v[132:135]
  s_waitcnt lgkmcnt(0)
  v_mfma_f32_16x16x32_bf16 v[132:135], v[52:55], v[32:35], v[132:135]
  s_barrier
  v_mfma_f32_16x16x32_bf16 v[128:131], v[112:115], v[96:99], v[128:131]
  ds_read_b128 v[32:35], v4 offset:0
  ds_read_b128 v[36:39], v4 offset:2048
  v_mfma_f32_16x16x32_bf16 v[128:131], v[208:211], v[192:195], v[128:131]
  ds_read_b128 v[40:43], v4 offset:4096
  ds_read_b128 v[44:47], v4 offset:6144
  v_mfma_f32_16x16x32_bf16 v[136:139], v[208:211], v[196:199], v[136:139]
  ds_read_b128 v[64:67], v5 offset:0
  ds_read_b128 v[68:71], v5 offset:2048
  v_mfma_f32_16x16x32_bf16 v[136:139], v[112:115], v[100:103], v[136:139]
  ds_read_b128 v[72:75], v5 offset:4096
  ds_read_b128 v[76:79], v5 offset:6144
  v_mfma_f32_16x16x32_bf16 v[144:147], v[112:115], v[104:107], v[144:147]
  s_add_u32 s16, s16, s17
  s_cmp_eq_u32 s16, 65536
  s_cselect_b32 s23, s18, s17
  v_mfma_f32_16x16x32_bf16 v[144:147], v[208:211], v[200:203], v[144:147]
  s_cselect_b32 s16, 0, s16
  v_add_u32 v4, s23, v4
  v_add_u32_e64 v5, s23, v5
  v_mfma_f32_16x16x32_bf16 v[152:155], v[208:211], v[204:207], v[152:155]
  v_mfma_f32_16x16x32_bf16 v[152:155], v[112:115], v[108:111], v[152:155]
  v_mfma_f32_16x16x32_bf16 v[156:159], v[116:119], v[108:111], v[156:159]
  v_mfma_f32_16x16x32_bf16 v[156:159], v[212:215], v[204:207], v[156:159]
  v_mfma_f32_16x16x32_bf16 v[148:151], v[212:215], v[200:203], v[148:151]
  v_mfma_f32_16x16x32_bf16 v[148:151], v[116:119], v[104:107], v[148:151]
  v_mfma_f32_16x16x32_bf16 v[140:143], v[116:119], v[100:103], v[140:143]
  v_mfma_f32_16x16x32_bf16 v[140:143], v[212:215], v[196:199], v[140:143]
  v_mfma_f32_16x16x32_bf16 v[132:135], v[212:215], v[192:195], v[132:135]
  s_waitcnt lgkmcnt(0)
  v_mfma_f32_16x16x32_bf16 v[132:135], v[116:119], v[96:99], v[132:135]
  s_barrier
  v_mfma_f32_16x16x32_bf16 v[128:131], v[160:163], v[32:35], v[128:131]
  ds_read_b128 v[96:99], v4 offset:0
  ds_read_b128 v[100:103], v4 offset:2048
  v_mfma_f32_16x16x32_bf16 v[128:131], v[168:171], v[64:67], v[128:131]
  ds_read_b128 v[104:107], v4 offset:4096
  ds_read_b128 v[108:111], v4 offset:6144
  v_mfma_f32_16x16x32_bf16 v[136:139], v[168:171], v[68:71], v[136:139]
  ds_read_b128 v[192:195], v5 offset:0
  ds_read_b128 v[196:199], v5 offset:2048
  v_mfma_f32_16x16x32_bf16 v[136:139], v[160:163], v[36:39], v[136:139]
  ds_read_b128 v[200:203], v5 offset:4096
  ds_read_b128 v[204:207], v5 offset:6144
  v_mfma_f32_16x16x32_bf16 v[144:147], v[160:163], v[40:43], v[144:147]
  s_add_u32 s16, s16, s17
  s_cmp_eq_u32 s16, 65536
  s_cselect_b32 s23, s18, s17
  v_mfma_f32_16x16x32_bf16 v[144:147], v[168:171], v[72:75], v[144:147]
  s_cselect_b32 s16, 0, s16
  v_add_u32 v4, s23, v4
  v_add_u32_e64 v5, s23, v5
  v_mfma_f32_16x16x32_bf16 v[152:155], v[168:171], v[76:79], v[152:155]
  v_mfma_f32_16x16x32_bf16 v[152:155], v[160:163], v[44:47], v[152:155]
  v_mfma_f32_16x16x32_bf16 v[156:159], v[164:167], v[44:47], v[156:159]
  v_mfma_f32_16x16x32_bf16 v[156:159], v[172:175], v[76:79], v[156:159]
  v_mfma_f32_16x16x32_bf16 v[148:151], v[172:175], v[72:75], v[148:151]
  v_mfma_f32_16x16x32_bf16 v[148:151], v[164:167], v[40:43], v[148:151]
  v_mfma_f32_16x16x32_bf16 v[140:143], v[164:167], v[36:39], v[140:143]
  v_mfma_f32_16x16x32_bf16 v[140:143], v[172:175], v[68:71], v[140:143]
  v_mfma_f32_16x16x32_bf16 v[132:135], v[172:175], v[64:67], v[132:135]
  s_waitcnt lgkmcnt(0)
  v_mfma_f32_16x16x32_bf16 v[132:135], v[164:167], v[32:35], v[132:135]
  s_barrier
  v_mfma_f32_16x16x32_bf16 v[128:131], v[176:179], v[96:99], v[128:131]
  ds_read_b128 v[32:35], v4 offset:0
  ds_read_b128 v[36:39], v4 offset:2048
  v_mfma_f32_16x16x32_bf16 v[128:131], v[184:187], v[192:195], v[128:131]
  ds_read_b128 v[40:43], v4 offset:4096
  ds_read_b128 v[44:47], v4 offset:6144
  v_mfma_f32_16x16x32_bf16 v[136:139], v[184:187], v[196:199], v[136:139]
  ds_read_b128 v[64:67], v5 offset:0
  ds_read_b128 v[68:71], v5 offset:2048
  v_mfma_f32_16x16x32_bf16 v[136:139], v[176:179], v[100:103], v[136:139]
  ds_read_b128 v[72:75], v5 offset:4096
  ds_read_b128 v[76:79], v5 offset:6144
  v_mfma_f32_16x16x32_bf16 v[144:147], v[176:179], v[104:107], v[144:147]
  s_add_u32 s16, s16, s17
  s_cmp_eq_u32 s16, 65536
  s_cselect_b32 s23, s18, s17
  v_mfma_f32_16x16x32_bf16 v[144:147], v[184:187], v[200:203], v[144:147]
  s_cselect_b32 s16, 0, s16
  v_add_u32 v4, s23, v4
  v_add_u32_e64 v5, s23, v5
  v_mfma_f32_16x16x32_bf16 v[152:155], v[184:187], v[204:207], v[152:155]
  v_mfma_f32_16x16x32_bf16 v[152:155], v[176:179], v[108:111], v[152:155]
  v_mfma_f32_16x16x32_bf16 v[156:159], v[180:183], v[108:111], v[156:159]
  v_mfma_f32_16x16x32_bf16 v[156:159], v[188:191], v[204:207], v[156:159]
  v_mfma_f32_16x16x32_bf16 v[148:151], v[188:191], v[200:203], v[148:151]
  v_mfma_f32_16x16x32_bf16 v[148:151], v[180:183], v[104:107], v[148:151]
  v_mfma_f32_16x16x32_bf16 v[140:143], v[180:183], v[100:103], v[140:143]
  v_mfma_f32_16x16x32_bf16 v[140:143], v[188:191], v[196:199], v[140:143]
  v_mfma_f32_16x16x32_bf16 v[132:135], v[188:191], v[192:195], v[132:135]
  s_waitcnt lgkmcnt(0)
  v_mfma_f32_16x16x32_bf16 v[132:135], v[180:183], v[96:99], v[132:135]
  s_barrier
  v_mfma_f32_16x16x32_bf16 v[128:131], v[224:227], v[32:35], v[128:131]
  ds_read_b128 v[96:99], v4 offset:0
  ds_read_b128 v[100:103], v4 offset:2048
  v_mfma_f32_16x16x32_bf16 v[128:131], v[232:235], v[64:67], v[128:131]
  ds_read_b128 v[104:107], v4 offset:4096
  ds_read_b128 v[108:111], v4 offset:6144
  v_mfma_f32_16x16x32_bf16 v[136:139], v[232:235], v[68:71], v[136:139]
  ds_read_b128 v[192:195], v5 offset:0
  ds_read_b128 v[196:199], v5 offset:2048
  v_mfma_f32_16x16x32_bf16 v[136:139], v[224:227], v[36:39], v[136:139]
  ds_read_b128 v[200:203], v5 offset:4096
  ds_read_b128 v[204:207], v5 offset:6144
  v_mfma_f32_16x16x32_bf16 v[144:147], v[224:227], v[40:43], v[144:147]
  s_add_u32 s16, s16, s17
  s_cmp_eq_u32 s16, 65536
  s_cselect_b32 s23, s18, s17
  v_mfma_f32_16x16x32_bf16 v[144:147], v[232:235], v[72:75], v[144:147]
  s_cselect_b32 s16, 0, s16
  v_add_u32 v4, s23, v4
  v_add_u32_e64 v5, s23, v5
  v_mfma_f32_16x16x32_bf16 v[152:155], v[232:235], v[76:79], v[152:155]
  v_mfma_f32_16x16x32_bf16 v[152:155], v[224:227], v[44:47], v[152:155]
  v_mfma_f32_16x16x32_bf16 v[156:159], v[228:231], v[44:47], v[156:159]
  v_mfma_f32_16x16x32_bf16 v[156:159], v[236:239], v[76:79], v[156:159]
  v_mfma_f32_16x16x32_bf16 v[148:151], v[236:239], v[72:75], v[148:151]
  v_mfma_f32_16x16x32_bf16 v[148:151], v[228:231], v[40:43], v[148:151]
  v_mfma_f32_16x16x32_bf16 v[140:143], v[228:231], v[36:39], v[140:143]
  v_mfma_f32_16x16x32_bf16 v[140:143], v[236:239], v[68:71], v[140:143]
  v_mfma_f32_16x16x32_bf16 v[132:135], v[236:239], v[64:67], v[132:135]
  s_waitcnt lgkmcnt(0)
  v_mfma_f32_16x16x32_bf16 v[132:135], v[228:231], v[32:35], v[132:135]
  s_barrier
  v_mfma_f32_16x16x32_bf16 v[128:131], v[56:59], v[96:99], v[128:131]
  ds_read_b64_tr_b16 v[48:49], v6 offset:0
  ds_read_b64_tr_b16 v[50:51], v6 offset:2048
  v_mfma_f32_16x16x32_bf16 v[128:131], v[88:91], v[192:195], v[128:131]
  ds_read_b128 v[32:35], v4 offset:0
  ds_read_b128 v[36:39], v4 offset:2048
  v_mfma_f32_16x16x32_bf16 v[136:139], v[88:91], v[196:199], v[136:139]
  ds_read_b128 v[40:43], v4 offset:4096
  ds_read_b128 v[44:47], v4 offset:6144
  v_mfma_f32_16x16x32_bf16 v[136:139], v[56:59], v[100:103], v[136:139]
  ds_read_b64_tr_b16 v[52:53], v7 offset:0
  ds_read_b64_tr_b16 v[54:55], v7 offset:2048
  v_mfma_f32_16x16x32_bf16 v[144:147], v[56:59], v[104:107], v[144:147]
  ds_read_b64_tr_b16 v[80:81], v6 offset:4096
  ds_read_b64_tr_b16 v[82:83], v6 offset:6144
  v_mfma_f32_16x16x32_bf16 v[144:147], v[88:91], v[200:203], v[144:147]
  ds_read_b128 v[64:67], v5 offset:0
  ds_read_b128 v[68:71], v5 offset:2048
  v_mfma_f32_16x16x32_bf16 v[152:155], v[88:91], v[204:207], v[152:155]
  ds_read_b128 v[72:75], v5 offset:4096
  ds_read_b128 v[76:79], v5 offset:6144
  v_mfma_f32_16x16x32_bf16 v[152:155], v[56:59], v[108:111], v[152:155]
  ds_read_b64_tr_b16 v[84:85], v7 offset:4096
  ds_read_b64_tr_b16 v[86:87], v7 offset:6144
  v_mfma_f32_16x16x32_bf16 v[156:159], v[60:63], v[108:111], v[156:159]
  s_add_u32 s16, s16, s17
  s_cmp_eq_u32 s16, 65536
  s_cselect_b32 s23, s18, s17
  v_mfma_f32_16x16x32_bf16 v[156:159], v[92:95], v[204:207], v[156:159]
  s_cselect_b32 s16, 0, s16
  v_add_u32 v4, s23, v4
  v_add_u32_e64 v5, s23, v5
  v_mfma_f32_16x16x32_bf16 v[148:151], v[92:95], v[200:203], v[148:151]
  s_add_u32 s19, s19, s20
  s_cmp_eq_u32 s19, 81920
  s_cselect_b32 s23, s21, s20
  v_mfma_f32_16x16x32_bf16 v[148:151], v[60:63], v[104:107], v[148:151]
  s_cselect_b32 s19, 0, s19
  v_add_u32 v6, s23, v6
  v_add_u32_e64 v7, s23, v7
  v_mfma_f32_16x16x32_bf16 v[140:143], v[60:63], v[100:103], v[140:143]
  v_mfma_f32_16x16x32_bf16 v[140:143], v[92:95], v[196:199], v[140:143]
  v_mfma_f32_16x16x32_bf16 v[132:135], v[92:95], v[192:195], v[132:135]
  s_waitcnt lgkmcnt(0)
  v_mfma_f32_16x16x32_bf16 v[132:135], v[60:63], v[96:99], v[132:135]
Lk_18:
  s_barrier
  v_mfma_f32_16x16x32_bf16 v[128:131], v[48:51], v[32:35], v[128:131]
  ds_read_b64_tr_b16 v[112:113], v6 offset:0
  ds_read_b64_tr_b16 v[114:115], v6 offset:2048
  v_mfma_f32_16x16x32_bf16 v[128:131], v[80:83], v[64:67], v[128:131]
  ds_read_b128 v[96:99], v4 offset:0
  ds_read_b128 v[100:103], v4 offset:2048
  v_mfma_f32_16x16x32_bf16 v[136:139], v[80:83], v[68:71], v[136:139]
  ds_read_b128 v[104:107], v4 offset:4096
  ds_read_b128 v[108:111], v4 offset:6144
  v_mfma_f32_16x16x32_bf16 v[136:139], v[48:51], v[36:39], v[136:139]
  ds_read_b64_tr_b16 v[116:117], v7 offset:0
  ds_read_b64_tr_b16 v[118:119], v7 offset:2048
  v_mfma_f32_16x16x32_bf16 v[144:147], v[48:51], v[40:43], v[144:147]
  ds_read_b64_tr_b16 v[208:209], v6 offset:4096
  ds_read_b64_tr_b16 v[210:211], v6 offset:6144
  v_mfma_f32_16x16x32_bf16 v[144:147], v[80:83], v[72:75], v[144:147]
  ds_read_b128 v[192:195], v5 offset:0
  ds_read_b128 v[196:199], v5 offset:2048
  v_mfma_f32_16x16x32_bf16 v[152:155], v[80:83], v[76:79], v[152:155]
  ds_read_b128 v[200:203], v5 offset:4096
  ds_read_b128 v[204:207], v5 offset:6144
  v_mfma_f32_16x16x32_bf16 v[152:155], v[48:51], v[44:47], v[152:155]
  ds_read_b64_tr_b16 v[212:213], v7 offset:4096
  ds_read_b64_tr_b16 v[214:215], v7 offset:6144
  v_mfma_f32_16x16x32_bf16 v[156:159], v[52:55], v[44:47], v[156:159]
  s_add_u32 s16, s16, s17
  s_cmp_eq_u32 s16, 65536
  s_cselect_b32 s23, s18, s17
  v_mfma_f32_16x16x32_bf16 v[156:159], v[84:87], v[76:79], v[156:159]
  s_cselect_b32 s16, 0, s16
  v_add_u32 v4, s23, v4
  v_add_u32_e64 v5, s23, v5
  v_mfma_f32_16x16x32_bf16 v[148:151], v[84:87], v[72:75], v[148:151]
  s_add_u32 s19, s19, s20
  s_cmp_eq_u32 s19, 81920
  s_cselect_b32 s23, s21, s20
  v_mfma_f32_16x16x32_bf16 v[148:151], v[52:55], v[40:43], v[148:151]
  s_cselect_b32 s19, 0, s19
  v_add_u32 v6, s23, v6
  v_add_u32_e64 v7, s23, v7
  v_mfma_f32_16x16x32_bf16 v[140:143], v[52:55], v[36:39], v[140:143]
  v_mfma_f32_16x16x32_bf16 v[140:143], v[84:87], v[68:71], v[140:143]
  v_mfma_f32_16x16x32_bf16 v[132:135], v[84:87], v[64:67], v[132:135]
  s_waitcnt lgkmcnt(0)
  v_mfma_f32_16x16x32_bf16 v[132:135], v[52:55], v[32:35], v[132:135]
  s_barrier
  v_mfma_f32_16x16x32_bf16 v[128:131], v[112:115], v[96:99], v[128:131]
  ds_read_b64_tr_b16 v[48:49], v6 offset:0
  ds_read_b64_tr_b16 v[50:51], v6 offset:2048
  v_mfma_f32_16x16x32_bf16 v[128:131], v[208:211], v[192:195], v[128:131]
  ds_read_b128 v[32:35], v4 offset:0
  ds_read_b128 v[36:39], v4 offset:2048
  v_mfma_f32_16x16x32_bf16 v[136:139], v[208:211], v[196:199], v[136:139]
  ds_read_b128 v[40:43], v4 offset:4096
  ds_read_b128 v[44:47], v4 offset:6144
  v_mfma_f32_16x16x32_bf16 v[136:139], v[112:115], v[100:103], v[136:139]
  ds_read_b64_tr_b16 v[52:53], v7 offset:0
  ds_read_b64_tr_b16 v[54:55], v7 offset:2048
  v_mfma_f32_16x16x32_bf16 v[144:147], v[112:115], v[104:107], v[144:147]
  ds_read_b64_tr_b16 v[80:81], v6 offset:4096
  ds_read_b64_tr_b16 v[82:83], v6 offset:6144
  v_mfma_f32_16x16x32_bf16 v[144:147], v[208:211], v[200:203], v[144:147]
  ds_read_b128 v[64:67], v5 offset:0
  ds_read_b128 v[68:71], v5 offset:2048
  v_mfma_f32_16x16x32_bf16 v[152:155], v[208:211], v[204:207], v[152:155]
  ds_read_b128 v[72:75], v5 offset:4096
  ds_read_b128 v[76:79], v5 offset:6144
  v_mfma_f32_16x16x32_bf16 v[152:155], v[112:115], v[108:111], v[152:155]
  ds_read_b64_tr_b16 v[84:85], v7 offset:4096
  ds_read_b64_tr_b16 v[86:87], v7 offset:6144
  v_mfma_f32_16x16x32_bf16 v[156:159], v[116:119], v[108:111], v[156:159]
  s_add_u32 s16, s16, s17
  s_cmp_eq_u32 s16, 65536
  s_cselect_b32 s23, s18, s17
  v_mfma_f32_16x16x32_bf16 v[156:159], v[212:215], v[204:207], v[156:159]
  s_cselect_b32 s16, 0, s16
  v_add_u32 v4, s23, v4
  v_add_u32_e64 v5, s23, v5
  v_mfma_f32_16x16x32_bf16 v[148:151], v[212:215], v[200:203], v[148:151]
  s_add_u32 s19, s19, s20
  s_cmp_eq_u32 s19, 81920
  s_cselect_b32 s23, s21, s20
  v_mfma_f32_16x16x32_bf16 v[148:151], v[116:119], v[104:107], v[148:151]
  s_cselect_b32 s19, 0, s19
  v_add_u32 v6, s23, v6
  v_add_u32_e64 v7, s23, v7
  v_mfma_f32_16x16x32_bf16 v[140:143], v[116:119], v[100:103], v[140:143]
  s_sub_u32 s22, s22, 1
  s_cmp_lg_u32 s22, 0
  v_mfma_f32_16x16x32_bf16 v[140:143], v[212:215], v[196:199], v[140:143]
  v_mfma_f32_16x16x32_bf16 v[132:135], v[212:215], v[192:195], v[132:135]
  s_nop 0
  s_waitcnt lgkmcnt(0)
  v_mfma_f32_16x16x32_bf16 v[132:135], v[116:119], v[96:99], v[132:135]
  s_cbranch_scc1 Lk_18
  s_waitcnt lgkmcnt(0)
  v_cvt_pk_bf16_f32 v240, v128, v129
  v_cvt_pk_bf16_f32 v241, v130, v131
  s_nop 0
  s_nop 3
  v_cvt_pk_bf16_f32 v242, v132, v133
  v_cvt_pk_bf16_f32 v243, v134, v135
  v_cvt_pk_bf16_f32 v244, v136, v137
  v_cvt_pk_bf16_f32 v245, v138, v139
  v_cvt_pk_bf16_f32 v246, v140, v141
  v_cvt_pk_bf16_f32 v247, v142, v143
  v_cvt_pk_bf16_f32 v248, v144, v145
  v_cvt_pk_bf16_f32 v249, v146, v147
  v_cvt_pk_bf16_f32 v250, v148, v149
  v_cvt_pk_bf16_f32 v251, v150, v151
  v_cvt_pk_bf16_f32 v252, v152, v153
  v_cvt_pk_bf16_f32 v253, v154, v155
  v_cvt_pk_bf16_f32 v254, v156, v157
  v_cvt_pk_bf16_f32 v255, v158, v159
  s_lshl_b32 s4, s76, 4
  s_add_u32 s4, s4, s78
  s_lshl_b32 s6, s4, Lz1-Lz0+14
  s_add_u32 s6, s6, 7340032
  s_add_u32 s7, s6, 4096
  s_lshl_b32 s5, s78, Lz1-Lz0+1
  buffer_store_dwordx4 v[240:243], v0, s[40:43], s6 offen offset:0 sc0 sc1
  buffer_store_dwordx4 v[244:247], v0, s[40:43], s6 offen offset:2048 sc0 sc1
  buffer_store_dwordx4 v[248:251], v0, s[40:43], s7 offen offset:0 sc0 sc1
  buffer_store_dwordx4 v[252:255], v0, s[40:43], s7 offen offset:2048 sc0 sc1
  v_mov_b32 v40, 0x3f803f80
  v_dot2_f32_bf16 v32, v240, v40, 0
  v_dot2_f32_bf16 v36, v240, v240, 0
  v_dot2_f32_bf16 v33, v244, v40, 0
  v_dot2_f32_bf16 v37, v244, v244, 0
  v_dot2_f32_bf16 v34, v248, v40, 0
  v_dot2_f32_bf16 v38, v248, v248, 0
  v_dot2_f32_bf16 v35, v252, v40, 0
  v_dot2_f32_bf16 v39, v252, v252, 0
  v_dot2_f32_bf16 v32, v241, v40, v32
  v_dot2_f32_bf16 v36, v241, v241, v36
  v_dot2_f32_bf16 v33, v245, v40, v33
  v_dot2_f32_bf16 v37, v245, v245, v37
  v_dot2_f32_bf16 v34, v249, v40, v34
  v_dot2_f32_bf16 v38, v249, v249, v38
  v_dot2_f32_bf16 v35, v253, v40, v35
  v_dot2_f32_bf16 v39, v253, v253, v39
  v_dot2_f32_bf16 v32, v242, v40, v32
  v_dot2_f32_bf16 v36, v242, v242, v36
  v_dot2_f32_bf16 v33, v246, v40, v33
  v_dot2_f32_bf16 v37, v246, v246, v37
  v_dot2_f32_bf16 v34, v250, v40, v34
  v_dot2_f32_bf16 v38, v250, v250, v38
  v_dot2_f32_bf16 v35, v254, v40, v35
  v_dot2_f32_bf16 v39, v254, v254, v39
  v_dot2_f32_bf16 v32, v243, v40, v32
  v_dot2_f32_bf16 v36, v243, v243, v36
  v_dot2_f32_bf16 v33, v247, v40, v33
  v_dot2_f32_bf16 v37, v247, v247, v37
  v_dot2_f32_bf16 v34, v251, v40, v34
  v_dot2_f32_bf16 v38, v251, v251, v38
  v_dot2_f32_bf16 v35, v255, v40, v35
  v_dot2_f32_bf16 v39, v255, v255, v39
  s_lshl_b32 s6, s76, Lz1-Lz0+9
  s_lshl_b32 s7, s85, 8
  s_add_u32 s6, s6, s7
  s_add_u32 s6, s6, s5
  s_add_u32 s6, s6, s86
  s_lshl_b32 s6, s6, 6
  s_add_u32 s6, s6, s83
  s_add_u32 s6, s6, 31457280
  v_permlane32_swap_b32 v32, v34
  v_permlane32_swap_b32 v33, v35
  v_permlane32_swap_b32 v36, v38
  v_permlane32_swap_b32 v37, v39
  v_add_f32 v32, v32, v34
  v_add_f32 v33, v33, v35
  v_add_f32 v36, v36, v38
  v_add_f32 v37, v37, v39
  v_permlane16_swap_b32 v32, v33
  s_nop 0
  v_permlane16_swap_b32 v36, v37
  v_add_f32 v42, v32, v33
  v_add_f32_e64 v43, v36, v37
  buffer_store_dwordx2 v[42:43], v30, s[40:43], s6 offen sc0 sc1
  ds_write_b128 v0, v[240:243] offset:0
  ds_write_b128 v0, v[244:247] offset:2048
  ds_write_b128 v0, v[248:251] offset:4096
  ds_write_b128 v0, v[252:255] offset:6144
  s_add_u32 s5, s87, 4
  s_sub_u32 s4, s78, s77
  s_lshl_b32 s4, s4, 7
  s_add_u32 s5, s5, s4
  s_waitcnt vmcnt(0)
  s_mov_b64 exec, 1
  ds_add_rtn_u32 v2, v28, v27 offset:0
  s_waitcnt lgkmcnt(0)
  v_readfirstlane_b32 s4, v2
  s_and_b32 s4, s4, Lz1-Lz0+3
  s_cmp_lg_u32 s4, 3
  s_cbranch_scc1 Ls_19
  s_mov_b32 exec_lo, 0xffff
  buffer_store_dword v27, v24, s[40:43], s5 offen sc0 sc1
Ls_19:
  s_mov_b64 exec, -1
  s_mov_b32 s16, 0
  s_mov_b32 s17, 16384
  s_mov_b32 s18, 0xffff4000
  s_mov_b32 s19, Lz1-Lz0+0
  s_mov_b32 s20, 28672
  s_mov_b32 s21, 0xffff2000
  s_mul_i32 s4, s85, 8192
  v_add_u32_e64 v4, s4, v11
  v_add_u32 v5, 1024, v4
  s_mul_i32 s4, s86, 6
  s_add_u32 s4, s4, 0
  s_lshr_b32 s5, s4, 2
  s_lshl_b32 s5, s5, 13
  s_and_b32 s4, s4, 3
  v_xor_b32 v2, s4, v26
  v_lshl_add_u32 v6, v2, 5, v25
  v_add_u32 v6, s5, v6
  s_mul_i32 s4, s86, 6
  s_add_u32 s4, s4, 1
  s_lshr_b32 s5, s4, 2
  s_lshl_b32 s5, s5, 13
  s_and_b32 s4, s4, 3
  v_xor_b32_e64 v2, s4, v26
  v_lshl_add_u32 v7, v2, 5, v25
  v_add_u32 v7, s5, v7
  s_mul_i32 s4, s86, 6
  s_add_u32 s4, s4, 2
  s_lshr_b32 s5, s4, 2
  s_lshl_b32 s5, s5, 13
  s_and_b32 s4, s4, 3
  v_xor_b32_e64 v2, s4, v26
  v_lshl_add_u32 v8, v2, 5, v25
  v_add_u32 v8, s5, v8
  s_mul_i32 s4, s86, 6
  s_add_u32 s4, s4, 3
  s_lshr_b32 s5, s4, 2
  s_lshl_b32 s5, s5, 13
  s_and_b32 s4, s4, 3
  v_xor_b32_e64 v2, s4, v26
  v_lshl_add_u32 v9, v2, 5, v25
  v_add_u32 v9, s5, v9
  v_lshrrev_b32 v2, 2, v1
  v_lshlrev_b32 v3, 6, v2
  v_and_b32 v2, 3, v1
  v_lshl_add_u32 v3, v2, 3, v3
  v_bfe_u32 v2, v1, 4, 1
  v_xor_b32_e64 v2, s86, v2
  v_lshl_add_u32 v3, v2, 5, v3
  v_add_u32 v10, 90112, v3
  v_mov_b64 v[128:129], 0
  v_mov_b64 v[130:131], 0
  v_mov_b64 v[132:133], 0
  v_mov_b64 v[134:135], 0
  v_mov_b64 v[136:137], 0
  v_mov_b64 v[138:139], 0
  v_mov_b64 v[140:141], 0
  v_mov_b64 v[142:143], 0
  v_mov_b64 v[144:145], 0
  v_mov_b64 v[146:147], 0
  v_mov_b64 v[148:149], 0
  v_mov_b64 v[150:151], 0
  v_mov_b64 v[152:153], 0
  v_mov_b64 v[154:155], 0
  v_mov_b64 v[156:157], 0
  v_mov_b64 v[158:159], 0
  v_mov_b64 v[160:161], 0
  v_mov_b64 v[162:163], 0
  v_mov_b64 v[164:165], 0
  v_mov_b64 v[166:167], 0
  v_mov_b64 v[168:169], 0
  v_mov_b64 v[170:171], 0
  v_mov_b64 v[172:173], 0
  v_mov_b64 v[174:175], 0
  v_mov_b64 v[176:177], 0
  v_mov_b64 v[178:179], 0
  v_mov_b64 v[180:181], 0
  v_mov_b64 v[182:183], 0
  v_mov_b64 v[184:185], 0
  v_mov_b64 v[186:187], 0
  v_mov_b64 v[188:189], 0
  v_mov_b64 v[190:191], 0
  v_mov_b64 v[192:193], 0
  v_mov_b64 v[194:195], 0
  v_mov_b64 v[196:197], 0
  v_mov_b64 v[198:199], 0
  v_mov_b64 v[200:201], 0
  v_mov_b64 v[202:203], 0
  v_mov_b64 v[204:205], 0
  v_mov_b64 v[206:207], 0
  v_mov_b64 v[208:209], 0
  v_mov_b64 v[210:211], 0
  v_mov_b64 v[212:213], 0
  v_mov_b64 v[214:215], 0
  v_mov_b64 v[216:217], 0
  v_mov_b64 v[218:219], 0
  v_mov_b64 v[220:221], 0
  v_mov_b64 v[222:223], 0
  v_mov_b64 v[224:225], 0
  v_mov_b64 v[226:227], 0
  v_mov_b64 v[228:229], 0
  v_mov_b64 v[230:231], 0
  v_mov_b64 v[232:233], 0
  v_mov_b64 v[234:235], 0
  v_mov_b64 v[236:237], 0
  v_mov_b64 v[238:239], 0
  s_mov_b32 s22, 8
  s_mov_b64 vcc, -1
  s_waitcnt lgkmcnt(0)
  s_barrier
  s_branch Lo_22
Lo_23:
  s_mov_b64 vcc, 0
  s_waitcnt lgkmcnt(0)
  s_barrier
  ds_read_b128 v[64:67], v4 offset:0
  ds_read_b128 v[80:83], v5 offset:0
  ds_read_b128 v[68:71], v4 offset:2048
  ds_read_b128 v[84:87], v5 offset:2048
  ds_read_b128 v[72:75], v4 offset:4096
  ds_read_b128 v[88:91], v5 offset:4096
  ds_read_b64_tr_b16 v[96:97], v6 offset:0
  ds_read_b64_tr_b16 v[98:99], v6 offset:2048
  ds_read_b64_tr_b16 v[100:101], v6 offset:4096
  ds_read_b64_tr_b16 v[102:103], v6 offset:6144
  ds_read_b128 v[76:79], v4 offset:6144
  ds_read_b128 v[92:95], v5 offset:6144
  ds_read_b64_tr_b16 v[104:105], v7 offset:0
  s_nop 0
  s_waitcnt lgkmcnt(8)
  ds_read_b64_tr_b16 v[106:107], v7 offset:2048
  ds_read_b64_tr_b16 v[108:109], v7 offset:4096
  ds_read_b64_tr_b16 v[110:111], v7 offset:6144
  s_waitcnt lgkmcnt(6)
  s_branch Lk_21
Lo_22:
  ds_read_b128 v[32:35], v4 offset:0
  ds_read_b128 v[48:51], v5 offset:0
  ds_read_b128 v[36:39], v4 offset:2048
  ds_read_b128 v[52:55], v5 offset:2048
  ds_read_b128 v[40:43], v4 offset:4096
  ds_read_b128 v[56:59], v5 offset:4096
  ds_read_b64_tr_b16 v[96:97], v6 offset:0
  ds_read_b64_tr_b16 v[98:99], v6 offset:2048
  ds_read_b64_tr_b16 v[100:101], v6 offset:4096
  ds_read_b64_tr_b16 v[102:103], v6 offset:6144
  ds_read_b128 v[44:47], v4 offset:6144
  ds_read_b128 v[60:63], v5 offset:6144
  ds_read_b64_tr_b16 v[104:105], v7 offset:0
  s_nop 0
  s_waitcnt lgkmcnt(8)
  ds_read_b64_tr_b16 v[106:107], v7 offset:2048
  ds_read_b64_tr_b16 v[108:109], v7 offset:4096
  ds_read_b64_tr_b16 v[110:111], v7 offset:6144
  s_nop 0
  s_waitcnt lgkmcnt(6)
  .p2align 6
Lk_20:
  v_mfma_f32_16x16x32_bf16 v[128:131], v[96:99], v[32:35], v[128:131]
  ds_read_b64_tr_b16 v[112:113], v8 offset:0
  v_mfma_f32_16x16x32_bf16 v[128:131], v[100:103], v[48:51], v[128:131]
  ds_read_b64_tr_b16 v[114:115], v8 offset:2048
  v_mfma_f32_16x16x32_bf16 v[132:135], v[100:103], v[52:55], v[132:135]
  ds_read_b64_tr_b16 v[116:117], v8 offset:4096
  v_mfma_f32_16x16x32_bf16 v[132:135], v[96:99], v[36:39], v[132:135]
  ds_read_b64_tr_b16 v[118:119], v8 offset:6144
  v_mfma_f32_16x16x32_bf16 v[136:139], v[96:99], v[40:43], v[136:139]
  s_add_u32 s16, s16, s17
  s_cmp_eq_u32 s16, 65536
  s_cselect_b32 s23, s18, s17
  s_cselect_b32 s16, Lz1-Lz0+0, s16
  v_mfma_f32_16x16x32_bf16 v[136:139], v[100:103], v[56:59], v[136:139]
  v_add_u32_e64 v4, s23, v4
  v_add_u32 v5, s23, v5
  s_add_u32 s19, s19, s20
  s_cmp_eq_u32 s19, 86016
  s_waitcnt lgkmcnt(8)
  v_mfma_f32_16x16x32_bf16 v[140:143], v[100:103], v[60:63], v[140:143]
  s_cselect_b32 s23, s21, s20
  s_cselect_b32 s19, 0, s19
  v_mfma_f32_16x16x32_bf16 v[140:143], v[96:99], v[44:47], v[140:143]
  s_waitcnt lgkmcnt(4)
  v_mfma_f32_16x16x32_bf16 v[156:159], v[104:107], v[44:47], v[156:159]
  ds_read_b64_tr_b16 v[120:121], v9 offset:0
  v_mfma_f32_16x16x32_bf16 v[156:159], v[108:111], v[60:63], v[156:159]
  ds_read_b64_tr_b16 v[122:123], v9 offset:2048
  v_mfma_f32_16x16x32_bf16 v[152:155], v[108:111], v[56:59], v[152:155]
  ds_read_b64_tr_b16 v[124:125], v9 offset:4096
  v_mfma_f32_16x16x32_bf16 v[152:155], v[104:107], v[40:43], v[152:155]
  ds_read_b64_tr_b16 v[126:127], v9 offset:6144
  v_mfma_f32_16x16x32_bf16 v[148:151], v[104:107], v[36:39], v[148:151]
  v_mfma_f32_16x16x32_bf16 v[148:151], v[108:111], v[52:55], v[148:151]
  v_mfma_f32_16x16x32_bf16 v[144:147], v[108:111], v[48:51], v[144:147]
  ds_read_b64_tr_b16 v[96:97], v6 offset:8192
  v_mfma_f32_16x16x32_bf16 v[144:147], v[104:107], v[32:35], v[144:147]
  ds_read_b64_tr_b16 v[98:99], v6 offset:10240
  s_nop 0
  s_waitcnt lgkmcnt(6)
  v_mfma_f32_16x16x32_bf16 v[160:163], v[112:115], v[32:35], v[160:163]
  ds_read_b64_tr_b16 v[100:101], v6 offset:12288
  v_mfma_f32_16x16x32_bf16 v[160:163], v[116:119], v[48:51], v[160:163]
  ds_read_b64_tr_b16 v[102:103], v6 offset:14336
  v_mfma_f32_16x16x32_bf16 v[164:167], v[116:119], v[52:55], v[164:167]
  v_mfma_f32_16x16x32_bf16 v[164:167], v[112:115], v[36:39], v[164:167]
  v_mfma_f32_16x16x32_bf16 v[168:171], v[112:115], v[40:43], v[168:171]
  ds_read_b64_tr_b16 v[104:105], v7 offset:8192
  v_mfma_f32_16x16x32_bf16 v[168:171], v[116:119], v[56:59], v[168:171]
  ds_read_b64_tr_b16 v[106:107], v7 offset:10240
  v_mfma_f32_16x16x32_bf16 v[172:175], v[116:119], v[60:63], v[172:175]
  ds_read_b64_tr_b16 v[108:109], v7 offset:12288
  v_mfma_f32_16x16x32_bf16 v[172:175], v[112:115], v[44:47], v[172:175]
  ds_read_b64_tr_b16 v[110:111], v7 offset:14336
  s_waitcnt lgkmcnt(8)
  v_mfma_f32_16x16x32_bf16 v[188:191], v[120:123], v[44:47], v[188:191]
  v_add_u32 v6, s23, v6
  v_add_u32_e64 v7, s23, v7
  v_mfma_f32_16x16x32_bf16 v[188:191], v[124:127], v[60:63], v[188:191]
  ds_read_b64_tr_b16 v[112:113], v10 offset:0
  v_mfma_f32_16x16x32_bf16 v[184:187], v[124:127], v[56:59], v[184:187]
  ds_read_b64_tr_b16 v[114:115], v10 offset:1024
  v_mfma_f32_16x16x32_bf16 v[184:187], v[120:123], v[40:43], v[184:187]
  ds_read_b64_tr_b16 v[116:117], v10 offset:2048
  v_mfma_f32_16x16x32_bf16 v[180:183], v[120:123], v[36:39], v[180:183]
  ds_read_b64_tr_b16 v[118:119], v10 offset:3072
  v_mfma_f32_16x16x32_bf16 v[180:183], v[124:127], v[52:55], v[180:183]
  v_add_u32 v8, s23, v8
  v_add_u32 v9, s23, v9
  v_mfma_f32_16x16x32_bf16 v[176:179], v[124:127], v[48:51], v[176:179]
  v_add_u32 v10, s23, v10
  v_mfma_f32_16x16x32_bf16 v[176:179], v[120:123], v[32:35], v[176:179]
  s_waitcnt lgkmcnt(0)
  s_cbranch_vccnz Lo_24
  s_barrier
Lo_24:
  v_mfma_f32_16x16x32_bf16 v[192:195], v[96:99], v[32:35], v[192:195]
  ds_read_b128 v[64:67], v4 offset:0
  v_mfma_f32_16x16x32_bf16 v[192:195], v[100:103], v[48:51], v[192:195]
  ds_read_b128 v[80:83], v5 offset:0
  v_mfma_f32_16x16x32_bf16 v[196:199], v[100:103], v[52:55], v[196:199]
  v_mfma_f32_16x16x32_bf16 v[196:199], v[96:99], v[36:39], v[196:199]
  ds_read_b128 v[68:71], v4 offset:2048
  v_mfma_f32_16x16x32_bf16 v[200:203], v[96:99], v[40:43], v[200:203]
  ds_read_b128 v[84:87], v5 offset:2048
  v_mfma_f32_16x16x32_bf16 v[200:203], v[100:103], v[56:59], v[200:203]
  v_mfma_f32_16x16x32_bf16 v[204:207], v[100:103], v[60:63], v[204:207]
  ds_read_b128 v[72:75], v4 offset:4096
  v_mfma_f32_16x16x32_bf16 v[204:207], v[96:99], v[44:47], v[204:207]
  ds_read_b128 v[88:91], v5 offset:4096
  v_mfma_f32_16x16x32_bf16 v[220:223], v[104:107], v[44:47], v[220:223]
  ds_read_b64_tr_b16 v[96:97], v6 offset:0
  v_mfma_f32_16x16x32_bf16 v[220:223], v[108:111], v[60:63], v[220:223]
  ds_read_b64_tr_b16 v[98:99], v6 offset:2048
  v_mfma_f32_16x16x32_bf16 v[216:219], v[108:111], v[56:59], v[216:219]
  ds_read_b64_tr_b16 v[100:101], v6 offset:4096
  v_mfma_f32_16x16x32_bf16 v[216:219], v[104:107], v[40:43], v[216:219]
  ds_read_b64_tr_b16 v[102:103], v6 offset:6144
  v_mfma_f32_16x16x32_bf16 v[212:215], v[104:107], v[36:39], v[212:215]
  ds_read_b128 v[76:79], v4 offset:6144
  v_mfma_f32_16x16x32_bf16 v[212:215], v[108:111], v[52:55], v[212:215]
  v_mfma_f32_16x16x32_bf16 v[208:211], v[108:111], v[48:51], v[208:211]
  ds_read_b128 v[92:95], v5 offset:6144
  v_mfma_f32_16x16x32_bf16 v[208:211], v[104:107], v[32:35], v[208:211]
  v_mfma_f32_16x16x32_bf16 v[224:227], v[112:115], v[32:35], v[224:227]
  ds_read_b64_tr_b16 v[104:105], v7 offset:0
  v_mfma_f32_16x16x32_bf16 v[224:227], v[116:119], v[48:51], v[224:227]
  v_mfma_f32_16x16x32_bf16 v[228:231], v[116:119], v[52:55], v[228:231]
  ds_read_b64_tr_b16 v[106:107], v7 offset:2048
  v_mfma_f32_16x16x32_bf16 v[228:231], v[112:115], v[36:39], v[228:231]
  v_mfma_f32_16x16x32_bf16 v[232:235], v[112:115], v[40:43], v[232:235]
  ds_read_b64_tr_b16 v[108:109], v7 offset:4096
  v_mfma_f32_16x16x32_bf16 v[232:235], v[116:119], v[56:59], v[232:235]
  v_mfma_f32_16x16x32_bf16 v[236:239], v[116:119], v[60:63], v[236:239]
  ds_read_b64_tr_b16 v[110:111], v7 offset:6144
  s_waitcnt lgkmcnt(6)
  v_mfma_f32_16x16x32_bf16 v[236:239], v[112:115], v[44:47], v[236:239]
  s_cbranch_vccnz Lo_23
Lk_21:
  v_mfma_f32_16x16x32_bf16 v[128:131], v[96:99], v[64:67], v[128:131]
  ds_read_b64_tr_b16 v[112:113], v8 offset:0
  v_mfma_f32_16x16x32_bf16 v[128:131], v[100:103], v[80:83], v[128:131]
  ds_read_b64_tr_b16 v[114:115], v8 offset:2048
  v_mfma_f32_16x16x32_bf16 v[132:135], v[100:103], v[84:87], v[132:135]
  ds_read_b64_tr_b16 v[116:117], v8 offset:4096
  v_mfma_f32_16x16x32_bf16 v[132:135], v[96:99], v[68:71], v[132:135]
  ds_read_b64_tr_b16 v[118:119], v8 offset:6144
  v_mfma_f32_16x16x32_bf16 v[136:139], v[96:99], v[72:75], v[136:139]
  s_add_u32 s16, s16, s17
  s_cmp_eq_u32 s16, 65536
  s_cselect_b32 s23, s18, s17
  s_cselect_b32 s16, Lz1-Lz0+0, s16
  v_mfma_f32_16x16x32_bf16 v[136:139], v[100:103], v[88:91], v[136:139]
  v_add_u32_e64 v4, s23, v4
  v_add_u32 v5, s23, v5
  s_add_u32 s19, s19, s20
  s_cmp_eq_u32 s19, 86016
  s_waitcnt lgkmcnt(8)
  v_mfma_f32_16x16x32_bf16 v[140:143], v[100:103], v[92:95], v[140:143]
  s_cselect_b32 s23, s21, s20
  s_cselect_b32 s19, 0, s19
  v_mfma_f32_16x16x32_bf16 v[140:143], v[96:99], v[76:79], v[140:143]
  s_waitcnt lgkmcnt(4)
  v_mfma_f32_16x16x32_bf16 v[156:159], v[104:107], v[76:79], v[156:159]
  ds_read_b64_tr_b16 v[120:121], v9 offset:0
  v_mfma_f32_16x16x32_bf16 v[156:159], v[108:111], v[92:95], v[156:159]
  ds_read_b64_tr_b16 v[122:123], v9 offset:2048
  v_mfma_f32_16x16x32_bf16 v[152:155], v[108:111], v[88:91], v[152:155]
  ds_read_b64_tr_b16 v[124:125], v9 offset:4096
  v_mfma_f32_16x16x32_bf16 v[152:155], v[104:107], v[72:75], v[152:155]
  ds_read_b64_tr_b16 v[126:127], v9 offset:6144
  v_mfma_f32_16x16x32_bf16 v[148:151], v[104:107], v[68:71], v[148:151]
  v_mfma_f32_16x16x32_bf16 v[148:151], v[108:111], v[84:87], v[148:151]
  v_mfma_f32_16x16x32_bf16 v[144:147], v[108:111], v[80:83], v[144:147]
  ds_read_b64_tr_b16 v[96:97], v6 offset:8192
  v_mfma_f32_16x16x32_bf16 v[144:147], v[104:107], v[64:67], v[144:147]
  ds_read_b64_tr_b16 v[98:99], v6 offset:10240
  s_nop 0
  s_waitcnt lgkmcnt(6)
  v_mfma_f32_16x16x32_bf16 v[160:163], v[112:115], v[64:67], v[160:163]
  ds_read_b64_tr_b16 v[100:101], v6 offset:12288
  v_mfma_f32_16x16x32_bf16 v[160:163], v[116:119], v[80:83], v[160:163]
  ds_read_b64_tr_b16 v[102:103], v6 offset:14336
  v_mfma_f32_16x16x32_bf16 v[164:167], v[116:119], v[84:87], v[164:167]
  v_mfma_f32_16x16x32_bf16 v[164:167], v[112:115], v[68:71], v[164:167]
  v_mfma_f32_16x16x32_bf16 v[168:171], v[112:115], v[72:75], v[168:171]
  ds_read_b64_tr_b16 v[104:105], v7 offset:8192
  v_mfma_f32_16x16x32_bf16 v[168:171], v[116:119], v[88:91], v[168:171]
  ds_read_b64_tr_b16 v[106:107], v7 offset:10240
  v_mfma_f32_16x16x32_bf16 v[172:175], v[116:119], v[92:95], v[172:175]
  ds_read_b64_tr_b16 v[108:109], v7 offset:12288
  v_mfma_f32_16x16x32_bf16 v[172:175], v[112:115], v[76:79], v[172:175]
  ds_read_b64_tr_b16 v[110:111], v7 offset:14336
  s_waitcnt lgkmcnt(8)
  v_mfma_f32_16x16x32_bf16 v[188:191], v[120:123], v[76:79], v[188:191]
  v_add_u32 v6, s23, v6
  v_add_u32_e64 v7, s23, v7
  v_mfma_f32_16x16x32_bf16 v[188:191], v[124:127], v[92:95], v[188:191]
  ds_read_b64_tr_b16 v[112:113], v10 offset:0
  v_mfma_f32_16x16x32_bf16 v[184:187], v[124:127], v[88:91], v[184:187]
  ds_read_b64_tr_b16 v[114:115], v10 offset:1024
  v_mfma_f32_16x16x32_bf16 v[184:187], v[120:123], v[72:75], v[184:187]
  ds_read_b64_tr_b16 v[116:117], v10 offset:2048
  v_mfma_f32_16x16x32_bf16 v[180:183], v[120:123], v[68:71], v[180:183]
  ds_read_b64_tr_b16 v[118:119], v10 offset:3072
  v_mfma_f32_16x16x32_bf16 v[180:183], v[124:127], v[84:87], v[180:183]
  v_add_u32 v8, s23, v8
  v_add_u32 v9, s23, v9
  v_mfma_f32_16x16x32_bf16 v[176:179], v[124:127], v[80:83], v[176:179]
  v_add_u32_e64 v10, s23, v10
  v_mfma_f32_16x16x32_bf16 v[176:179], v[120:123], v[64:67], v[176:179]
  s_waitcnt lgkmcnt(0)
  s_barrier
  v_mfma_f32_16x16x32_bf16 v[192:195], v[96:99], v[64:67], v[192:195]
  ds_read_b128 v[32:35], v4 offset:0
  v_mfma_f32_16x16x32_bf16 v[192:195], v[100:103], v[80:83], v[192:195]
  ds_read_b128 v[48:51], v5 offset:0
  v_mfma_f32_16x16x32_bf16 v[196:199], v[100:103], v[84:87], v[196:199]
  v_mfma_f32_16x16x32_bf16 v[196:199], v[96:99], v[68:71], v[196:199]
  ds_read_b128 v[36:39], v4 offset:2048
  v_mfma_f32_16x16x32_bf16 v[200:203], v[96:99], v[72:75], v[200:203]
  ds_read_b128 v[52:55], v5 offset:2048
  v_mfma_f32_16x16x32_bf16 v[200:203], v[100:103], v[88:91], v[200:203]
  v_mfma_f32_16x16x32_bf16 v[204:207], v[100:103], v[92:95], v[204:207]
  ds_read_b128 v[40:43], v4 offset:4096
  v_mfma_f32_16x16x32_bf16 v[204:207], v[96:99], v[76:79], v[204:207]
  ds_read_b128 v[56:59], v5 offset:4096
  v_mfma_f32_16x16x32_bf16 v[220:223], v[104:107], v[76:79], v[220:223]
  ds_read_b64_tr_b16 v[96:97], v6 offset:0
  v_mfma_f32_16x16x32_bf16 v[220:223], v[108:111], v[92:95], v[220:223]
  ds_read_b64_tr_b16 v[98:99], v6 offset:2048
  v_mfma_f32_16x16x32_bf16 v[216:219], v[108:111], v[88:91], v[216:219]
  ds_read_b64_tr_b16 v[100:101], v6 offset:4096
  v_mfma_f32_16x16x32_bf16 v[216:219], v[104:107], v[72:75], v[216:219]
  ds_read_b64_tr_b16 v[102:103], v6 offset:6144
  v_mfma_f32_16x16x32_bf16 v[212:215], v[104:107], v[68:71], v[212:215]
  ds_read_b128 v[44:47], v4 offset:6144
  v_mfma_f32_16x16x32_bf16 v[212:215], v[108:111], v[84:87], v[212:215]
  v_mfma_f32_16x16x32_bf16 v[208:211], v[108:111], v[80:83], v[208:211]
  ds_read_b128 v[60:63], v5 offset:6144
  v_mfma_f32_16x16x32_bf16 v[208:211], v[104:107], v[64:67], v[208:211]
  v_mfma_f32_16x16x32_bf16 v[224:227], v[112:115], v[64:67], v[224:227]
  ds_read_b64_tr_b16 v[104:105], v7 offset:0
  v_mfma_f32_16x16x32_bf16 v[224:227], v[116:119], v[80:83], v[224:227]
  v_mfma_f32_16x16x32_bf16 v[228:231], v[116:119], v[84:87], v[228:231]
  ds_read_b64_tr_b16 v[106:107], v7 offset:2048
  v_mfma_f32_16x16x32_bf16 v[228:231], v[112:115], v[68:71], v[228:231]
  v_mfma_f32_16x16x32_bf16 v[232:235], v[112:115], v[72:75], v[232:235]
  ds_read_b64_tr_b16 v[108:109], v7 offset:4096
  v_mfma_f32_16x16x32_bf16 v[232:235], v[116:119], v[88:91], v[232:235]
  s_sub_u32 s22, s22, 1
  s_cmp_lg_u32 s22, 0
  v_mfma_f32_16x16x32_bf16 v[236:239], v[116:119], v[92:95], v[236:239]
  ds_read_b64_tr_b16 v[110:111], v7 offset:6144
  s_nop 0
  s_waitcnt lgkmcnt(6)
  v_mfma_f32_16x16x32_bf16 v[236:239], v[112:115], v[76:79], v[236:239]
  s_cbranch_scc1 Lk_20
  s_waitcnt lgkmcnt(0)
  s_mul_i32 s4, s85, 320
  s_add_u32 s4, s4, 151552
  v_and_b32_e64 v2, 15, v1
  v_lshl_add_u32 v3, v2, 2, s4
  ds_read2_b32 v[88:89], v3 offset0:0 offset1:160
  ds_read2_b32 v[90:91], v3 offset0:16 offset1:176
  ds_read2_b32 v[92:93], v3 offset0:32 offset1:192
  ds_read2_b32 v[94:95], v3 offset0:48 offset1:208
  s_mul_i32 s5, s86, 384
  s_add_u32 s5, s5, 154112
  v_add_u32 v3, s5, v29
  s_lshl_b32 s5, s86, 6
  s_add_u32 s5, s5, 154880
  v_add_u32_e64 v2, s5, v29
  ds_read_b128 v[32:35], v3 offset:0
  ds_read_b128 v[36:39], v3 offset:1024
  ds_read_b128 v[40:43], v3 offset:64
  ds_read_b128 v[44:47], v3 offset:1088
  ds_read_b128 v[80:83], v2 offset:0
  ds_read_b128 v[84:87], v2 offset:1024
  ds_read_b128 v[48:51], v3 offset:128
  ds_read_b128 v[52:55], v3 offset:1152
  ds_read_b128 v[56:59], v3 offset:192
  ds_read_b128 v[60:63], v3 offset:1216
  v_mov_b32 v96, 0x409d30fc
  v_mov_b32 v97, 0x3eeff558
  v_and_b32_e64 v2, 32, v1
  v_mad_u32_u24 v98, v2, 48, v11
  s_mul_i32 s4, s76, 56
  s_mul_i32 s5, s79, 28
  s_add_u32 s4, s4, s5
  s_add_u32 s6, s4, s80
  s_lshl_b32 s6, s6, Lz1-Lz0+14
  s_add_u32 s6, s6, 11599872
  s_add_u32 s7, s6, 4096
  s_lshr_b32 s5, s80, 1
  s_add_u32 s4, s4, s5
  s_lshl_b32 s4, s4, 1
  s_add_u32 s4, s4, s85
  s_lshl_b32 s4, s4, Lz1-Lz0+3
  s_and_b32 s5, s80, 1
  s_add_u32 s4, s4, s5
  s_lshl_b32 s4, s4, 1
  s_add_u32 s4, s4, s86
  s_lshl_b32 s8, s4, 9
  s_add_u32 s8, s8, 11534336
  s_waitcnt lgkmcnt(6)
  ds_read_b128 v[64:67], v3 offset:256
  ds_read_b128 v[68:71], v3 offset:1280
  ds_read_b128 v[72:75], v3 offset:320
  ds_read_b128 v[76:79], v3 offset:1344
  v_pk_mul_f32 v[88:89], v[88:89], v[96:97] op_sel:[0,1] op_sel_hi:[1,1]
  v_pk_mul_f32 v[90:91], v[90:91], v[96:97] op_sel:[0,1] op_sel_hi:[1,1]
  v_pk_mul_f32 v[92:93], v[92:93], v[96:97] op_sel:[0,1] op_sel_hi:[1,1]
  v_pk_mul_f32 v[94:95], v[94:95], v[96:97] op_sel:[0,1] op_sel_hi:[1,1]
  s_lshl_b32 s4, s79, Lz1-Lz0+3
  s_lshl_b32 s10, 0xff, s4
  v_pk_fma_f32 v[100:101], v[32:33], v[88:89], v[36:37] op_sel:[0,1,0] op_sel_hi:[1,1,1] neg_lo:[0,1,0] neg_hi:[0,1,0]
  v_pk_fma_f32 v[102:103], v[34:35], v[88:89], v[38:39] op_sel:[0,1,0] op_sel_hi:[1,1,1] neg_lo:[0,1,0] neg_hi:[0,1,0]
  v_pk_fma_f32 v[104:105], v[40:41], v[88:89], v[44:45] op_sel:[0,1,0] op_sel_hi:[1,1,1] neg_lo:[0,1,0] neg_hi:[0,1,0]
  v_pk_fma_f32 v[106:107], v[42:43], v[88:89], v[46:47] op_sel:[0,1,0] op_sel_hi:[1,1,1] neg_lo:[0,1,0] neg_hi:[0,1,0]
  v_pk_fma_f32 v[128:129], v[128:129], v[88:89], v[100:101] op_sel:[0,0,0] op_sel_hi:[1,0,1]
  v_pk_fma_f32 v[130:131], v[130:131], v[88:89], v[102:103] op_sel:[0,0,0] op_sel_hi:[1,0,1]
  v_pk_fma_f32 v[144:145], v[144:145], v[88:89], v[104:105] op_sel:[0,0,0] op_sel_hi:[1,0,1]
  v_pk_fma_f32 v[146:147], v[146:147], v[88:89], v[106:107] op_sel:[0,0,0] op_sel_hi:[1,0,1]
  v_pk_fma_f32 v[100:101], v[128:129], v[128:129], v[96:97] op_sel_hi:[1,1,0]
  v_pk_fma_f32 v[102:103], v[130:131], v[130:131], v[96:97] op_sel_hi:[1,1,0]
  v_pk_fma_f32 v[104:105], v[144:145], v[144:145], v[96:97] op_sel_hi:[1,1,0]
  v_pk_fma_f32 v[106:107], v[146:147], v[146:147], v[96:97] op_sel_hi:[1,1,0]
  v_pk_mul_f32 v[100:101], v[100:101], v[128:129] neg_lo:[0,1] neg_hi:[0,1]
  v_pk_mul_f32 v[102:103], v[102:103], v[130:131] neg_lo:[0,1] neg_hi:[0,1]
  v_pk_mul_f32 v[104:105], v[104:105], v[144:145] neg_lo:[0,1] neg_hi:[0,1]
  v_pk_mul_f32 v[106:107], v[106:107], v[146:147] neg_lo:[0,1] neg_hi:[0,1]
  v_exp_f32 v100, v100
  v_exp_f32 v101, v101
  v_exp_f32 v102, v102
  v_exp_f32 v103, v103
  v_exp_f32 v104, v104
  v_exp_f32 v105, v105
  v_exp_f32 v106, v106
  v_exp_f32 v107, v107
  v_pk_fma_f32 v[100:101], v[100:101], v[96:97], v[96:97] op_sel:[0,1,1] op_sel_hi:[1,1,1]
  v_pk_fma_f32 v[102:103], v[102:103], v[96:97], v[96:97] op_sel:[0,1,1] op_sel_hi:[1,1,1]
  v_pk_fma_f32 v[104:105], v[104:105], v[96:97], v[96:97] op_sel:[0,1,1] op_sel_hi:[1,1,1]
  v_pk_fma_f32 v[106:107], v[106:107], v[96:97], v[96:97] op_sel:[0,1,1] op_sel_hi:[1,1,1]
  v_rcp_f32 v100, v100
  v_rcp_f32 v101, v101
  v_rcp_f32 v102, v102
  v_rcp_f32 v103, v103
  v_rcp_f32 v104, v104
  v_rcp_f32 v105, v105
  v_rcp_f32 v106, v106
  v_rcp_f32 v107, v107
  v_pk_mul_f32 v[128:129], v[128:129], v[100:101]
  v_pk_mul_f32 v[130:131], v[130:131], v[102:103]
  v_pk_mul_f32 v[144:145], v[144:145], v[104:105]
  v_pk_mul_f32 v[146:147], v[146:147], v[106:107]
  v_cvt_pk_bf16_f32 v116, v128, v129
  v_cvt_pk_bf16_f32 v117, v130, v131
  v_cvt_pk_bf16_f32 v118, v144, v145
  v_cvt_pk_bf16_f32 v119, v146, v147
  buffer_store_dwordx4 v[116:119], v0, s[40:43], s6 offen offset:0 sc0 sc1
  ds_write_b128 v0, v[116:119] offset:0
  v_pk_fma_f32 v[100:101], v[32:33], v[90:91], v[36:37] op_sel:[0,1,0] op_sel_hi:[1,1,1] neg_lo:[0,1,0] neg_hi:[0,1,0]
  v_pk_fma_f32 v[102:103], v[34:35], v[90:91], v[38:39] op_sel:[0,1,0] op_sel_hi:[1,1,1] neg_lo:[0,1,0] neg_hi:[0,1,0]
  v_pk_fma_f32 v[104:105], v[40:41], v[90:91], v[44:45] op_sel:[0,1,0] op_sel_hi:[1,1,1] neg_lo:[0,1,0] neg_hi:[0,1,0]
  v_pk_fma_f32 v[106:107], v[42:43], v[90:91], v[46:47] op_sel:[0,1,0] op_sel_hi:[1,1,1] neg_lo:[0,1,0] neg_hi:[0,1,0]
  v_pk_fma_f32 v[132:133], v[132:133], v[90:91], v[100:101] op_sel:[0,0,0] op_sel_hi:[1,0,1]
  v_pk_fma_f32 v[134:135], v[134:135], v[90:91], v[102:103] op_sel:[0,0,0] op_sel_hi:[1,0,1]
  v_pk_fma_f32 v[148:149], v[148:149], v[90:91], v[104:105] op_sel:[0,0,0] op_sel_hi:[1,0,1]
  v_pk_fma_f32 v[150:151], v[150:151], v[90:91], v[106:107] op_sel:[0,0,0] op_sel_hi:[1,0,1]
  v_pk_fma_f32 v[100:101], v[132:133], v[132:133], v[96:97] op_sel_hi:[1,1,0]
  v_pk_fma_f32 v[102:103], v[134:135], v[134:135], v[96:97] op_sel_hi:[1,1,0]
  v_pk_fma_f32 v[104:105], v[148:149], v[148:149], v[96:97] op_sel_hi:[1,1,0]
  v_pk_fma_f32 v[106:107], v[150:151], v[150:151], v[96:97] op_sel_hi:[1,1,0]
  v_pk_mul_f32 v[100:101], v[100:101], v[132:133] neg_lo:[0,1] neg_hi:[0,1]
  v_pk_mul_f32 v[102:103], v[102:103], v[134:135] neg_lo:[0,1] neg_hi:[0,1]
  v_pk_mul_f32 v[104:105], v[104:105], v[148:149] neg_lo:[0,1] neg_hi:[0,1]
  v_pk_mul_f32 v[106:107], v[106:107], v[150:151] neg_lo:[0,1] neg_hi:[0,1]
  v_exp_f32 v100, v100
  v_exp_f32 v101, v101
  v_exp_f32 v102, v102
  v_exp_f32 v103, v103
  v_exp_f32 v104, v104
  v_exp_f32 v105, v105
  v_exp_f32 v106, v106
  v_exp_f32 v107, v107
  v_pk_fma_f32 v[100:101], v[100:101], v[96:97], v[96:97] op_sel:[0,1,1] op_sel_hi:[1,1,1]
  v_pk_fma_f32 v[102:103], v[102:103], v[96:97], v[96:97] op_sel:[0,1,1] op_sel_hi:[1,1,1]
  v_pk_fma_f32 v[104:105], v[104:105], v[96:97], v[96:97] op_sel:[0,1,1] op_sel_hi:[1,1,1]
  v_pk_fma_f32 v[106:107], v[106:107], v[96:97], v[96:97] op_sel:[0,1,1] op_sel_hi:[1,1,1]
  v_rcp_f32 v100, v100
  v_rcp_f32 v101, v101
  v_rcp_f32 v102, v102
  v_rcp_f32 v103, v103
  v_rcp_f32 v104, v104
  v_rcp_f32 v105, v105
  v_rcp_f32 v106, v106
  v_rcp_f32 v107, v107
  v_pk_mul_f32 v[132:133], v[132:133], v[100:101]
  v_pk_mul_f32 v[134:135], v[134:135], v[102:103]
  v_pk_mul_f32 v[148:149], v[148:149], v[104:105]
  v_pk_mul_f32 v[150:151], v[150:151], v[106:107]
  v_cvt_pk_bf16_f32 v120, v132, v133
  v_cvt_pk_bf16_f32 v121, v134, v135
  v_cvt_pk_bf16_f32 v122, v148, v149
  v_cvt_pk_bf16_f32 v123, v150, v151
  buffer_store_dwordx4 v[120:123], v0, s[40:43], s6 offen offset:2048 sc0 sc1
  ds_write_b128 v0, v[120:123] offset:2048
  s_add_u32 s6, s6, 0x20000
  v_pk_fma_f32 v[100:101], v[32:33], v[92:93], v[36:37] op_sel:[0,1,0] op_sel_hi:[1,1,1] neg_lo:[0,1,0] neg_hi:[0,1,0]
  v_pk_fma_f32 v[102:103], v[34:35], v[92:93], v[38:39] op_sel:[0,1,0] op_sel_hi:[1,1,1] neg_lo:[0,1,0] neg_hi:[0,1,0]
  v_pk_fma_f32 v[104:105], v[40:41], v[92:93], v[44:45] op_sel:[0,1,0] op_sel_hi:[1,1,1] neg_lo:[0,1,0] neg_hi:[0,1,0]
  v_pk_fma_f32 v[106:107], v[42:43], v[92:93], v[46:47] op_sel:[0,1,0] op_sel_hi:[1,1,1] neg_lo:[0,1,0] neg_hi:[0,1,0]
  v_pk_fma_f32 v[136:137], v[136:137], v[92:93], v[100:101] op_sel:[0,0,0] op_sel_hi:[1,0,1]
  v_pk_fma_f32 v[138:139], v[138:139], v[92:93], v[102:103] op_sel:[0,0,0] op_sel_hi:[1,0,1]
  v_pk_fma_f32 v[152:153], v[152:153], v[92:93], v[104:105] op_sel:[0,0,0] op_sel_hi:[1,0,1]
  v_pk_fma_f32 v[154:155], v[154:155], v[92:93], v[106:107] op_sel:[0,0,0] op_sel_hi:[1,0,1]
  v_pk_fma_f32 v[100:101], v[136:137], v[136:137], v[96:97] op_sel_hi:[1,1,0]
  v_pk_fma_f32 v[102:103], v[138:139], v[138:139], v[96:97] op_sel_hi:[1,1,0]
  v_pk_fma_f32 v[104:105], v[152:153], v[152:153], v[96:97] op_sel_hi:[1,1,0]
  v_pk_fma_f32 v[106:107], v[154:155], v[154:155], v[96:97] op_sel_hi:[1,1,0]
  v_pk_mul_f32 v[100:101], v[100:101], v[136:137] neg_lo:[0,1] neg_hi:[0,1]
  v_pk_mul_f32 v[102:103], v[102:103], v[138:139] neg_lo:[0,1] neg_hi:[0,1]
  v_pk_mul_f32 v[104:105], v[104:105], v[152:153] neg_lo:[0,1] neg_hi:[0,1]
  v_pk_mul_f32 v[106:107], v[106:107], v[154:155] neg_lo:[0,1] neg_hi:[0,1]
  v_exp_f32 v100, v100
  v_exp_f32 v101, v101
  v_exp_f32 v102, v102
  v_exp_f32 v103, v103
  v_exp_f32 v104, v104
  v_exp_f32 v105, v105
  v_exp_f32 v106, v106
  v_exp_f32 v107, v107
  v_pk_fma_f32 v[100:101], v[100:101], v[96:97], v[96:97] op_sel:[0,1,1] op_sel_hi:[1,1,1]
  v_pk_fma_f32 v[102:103], v[102:103], v[96:97], v[96:97] op_sel:[0,1,1] op_sel_hi:[1,1,1]
  v_pk_fma_f32 v[104:105], v[104:105], v[96:97], v[96:97] op_sel:[0,1,1] op_sel_hi:[1,1,1]
  v_pk_fma_f32 v[106:107], v[106:107], v[96:97], v[96:97] op_sel:[0,1,1] op_sel_hi:[1,1,1]
  v_rcp_f32 v100, v100
  v_rcp_f32 v101, v101
  v_rcp_f32 v102, v102
  v_rcp_f32 v103, v103
  v_rcp_f32 v104, v104
  v_rcp_f32 v105, v105
  v_rcp_f32 v106, v106
  v_rcp_f32 v107, v107
  v_pk_mul_f32 v[136:137], v[136:137], v[100:101]
  v_pk_mul_f32 v[138:139], v[138:139], v[102:103]
  v_pk_mul_f32 v[152:153], v[152:153], v[104:105]
  v_pk_mul_f32 v[154:155], v[154:155], v[106:107]
  v_cvt_pk_bf16_f32 v116, v136, v137
  v_cvt_pk_bf16_f32 v117, v138, v139
  v_cvt_pk_bf16_f32 v118, v152, v153
  v_cvt_pk_bf16_f32 v119, v154, v155
  buffer_store_dwordx4 v[116:119], v0, s[40:43], s7 offen offset:0 sc0 sc1
  ds_write_b128 v0, v[116:119] offset:4096
  v_pk_fma_f32 v[100:101], v[32:33], v[94:95], v[36:37] op_sel:[0,1,0] op_sel_hi:[1,1,1] neg_lo:[0,1,0] neg_hi:[0,1,0]
  v_pk_fma_f32 v[102:103], v[34:35], v[94:95], v[38:39] op_sel:[0,1,0] op_sel_hi:[1,1,1] neg_lo:[0,1,0] neg_hi:[0,1,0]
  v_pk_fma_f32 v[104:105], v[40:41], v[94:95], v[44:45] op_sel:[0,1,0] op_sel_hi:[1,1,1] neg_lo:[0,1,0] neg_hi:[0,1,0]
  v_pk_fma_f32 v[106:107], v[42:43], v[94:95], v[46:47] op_sel:[0,1,0] op_sel_hi:[1,1,1] neg_lo:[0,1,0] neg_hi:[0,1,0]
  v_pk_fma_f32 v[140:141], v[140:141], v[94:95], v[100:101] op_sel:[0,0,0] op_sel_hi:[1,0,1]
  v_pk_fma_f32 v[142:143], v[142:143], v[94:95], v[102:103] op_sel:[0,0,0] op_sel_hi:[1,0,1]
  v_pk_fma_f32 v[156:157], v[156:157], v[94:95], v[104:105] op_sel:[0,0,0] op_sel_hi:[1,0,1]
  v_pk_fma_f32 v[158:159], v[158:159], v[94:95], v[106:107] op_sel:[0,0,0] op_sel_hi:[1,0,1]
  v_pk_fma_f32 v[100:101], v[140:141], v[140:141], v[96:97] op_sel_hi:[1,1,0]
  v_pk_fma_f32 v[102:103], v[142:143], v[142:143], v[96:97] op_sel_hi:[1,1,0]
  v_pk_fma_f32 v[104:105], v[156:157], v[156:157], v[96:97] op_sel_hi:[1,1,0]
  v_pk_fma_f32 v[106:107], v[158:159], v[158:159], v[96:97] op_sel_hi:[1,1,0]
  v_pk_mul_f32 v[100:101], v[100:101], v[140:141] neg_lo:[0,1] neg_hi:[0,1]
  v_pk_mul_f32 v[102:103], v[102:103], v[142:143] neg_lo:[0,1] neg_hi:[0,1]
  v_pk_mul_f32 v[104:105], v[104:105], v[156:157] neg_lo:[0,1] neg_hi:[0,1]
  v_pk_mul_f32 v[106:107], v[106:107], v[158:159] neg_lo:[0,1] neg_hi:[0,1]
  v_exp_f32 v100, v100
  v_exp_f32 v101, v101
  v_exp_f32 v102, v102
  v_exp_f32 v103, v103
  v_exp_f32 v104, v104
  v_exp_f32 v105, v105
  v_exp_f32 v106, v106
  v_exp_f32 v107, v107
  v_pk_fma_f32 v[100:101], v[100:101], v[96:97], v[96:97] op_sel:[0,1,1] op_sel_hi:[1,1,1]
  v_pk_fma_f32 v[102:103], v[102:103], v[96:97], v[96:97] op_sel:[0,1,1] op_sel_hi:[1,1,1]
  v_pk_fma_f32 v[104:105], v[104:105], v[96:97], v[96:97] op_sel:[0,1,1] op_sel_hi:[1,1,1]
  v_pk_fma_f32 v[106:107], v[106:107], v[96:97], v[96:97] op_sel:[0,1,1] op_sel_hi:[1,1,1]
  v_rcp_f32 v100, v100
  v_rcp_f32 v101, v101
  v_rcp_f32 v102, v102
  v_rcp_f32 v103, v103
  v_rcp_f32 v104, v104
  v_rcp_f32 v105, v105
  v_rcp_f32 v106, v106
  v_rcp_f32 v107, v107
  v_pk_mul_f32 v[140:141], v[140:141], v[100:101]
  v_pk_mul_f32 v[142:143], v[142:143], v[102:103]
  v_pk_mul_f32 v[156:157], v[156:157], v[104:105]
  v_pk_mul_f32 v[158:159], v[158:159], v[106:107]
  v_cvt_pk_bf16_f32 v120, v140, v141
  v_cvt_pk_bf16_f32 v121, v142, v143
  v_cvt_pk_bf16_f32 v122, v156, v157
  v_cvt_pk_bf16_f32 v123, v158, v159
  buffer_store_dwordx4 v[120:123], v0, s[40:43], s7 offen offset:2048 sc0 sc1
  ds_write_b128 v0, v[120:123] offset:6144
  s_add_u32 s7, s7, 0x20000
  s_nop 0
  s_waitcnt lgkmcnt(0)
  v_pk_fma_f32 v[100:101], v[80:81], v[88:89], v[84:85] op_sel:[0,1,0] op_sel_hi:[1,1,1] neg_lo:[0,1,0] neg_hi:[0,1,0]
  v_pk_fma_f32 v[102:103], v[82:83], v[88:89], v[86:87] op_sel:[0,1,0] op_sel_hi:[1,1,1] neg_lo:[0,1,0] neg_hi:[0,1,0]
  v_pk_fma_f32 v[104:105], v[80:81], v[90:91], v[84:85] op_sel:[0,1,0] op_sel_hi:[1,1,1] neg_lo:[0,1,0] neg_hi:[0,1,0]
  v_pk_fma_f32 v[106:107], v[82:83], v[90:91], v[86:87] op_sel:[0,1,0] op_sel_hi:[1,1,1] neg_lo:[0,1,0] neg_hi:[0,1,0]
  v_pk_fma_f32 v[224:225], v[224:225], v[88:89], v[100:101] op_sel:[0,0,0] op_sel_hi:[1,0,1]
  v_pk_fma_f32 v[226:227], v[226:227], v[88:89], v[102:103] op_sel:[0,0,0] op_sel_hi:[1,0,1]
  v_pk_fma_f32 v[228:229], v[228:229], v[90:91], v[104:105] op_sel:[0,0,0] op_sel_hi:[1,0,1]
  v_pk_fma_f32 v[230:231], v[230:231], v[90:91], v[106:107] op_sel:[0,0,0] op_sel_hi:[1,0,1]
  v_pk_fma_f32 v[100:101], v[224:225], v[224:225], v[96:97] op_sel_hi:[1,1,0]
  v_pk_fma_f32 v[102:103], v[226:227], v[226:227], v[96:97] op_sel_hi:[1,1,0]
  v_pk_fma_f32 v[104:105], v[228:229], v[228:229], v[96:97] op_sel_hi:[1,1,0]
  v_pk_fma_f32 v[106:107], v[230:231], v[230:231], v[96:97] op_sel_hi:[1,1,0]
  v_pk_mul_f32 v[100:101], v[100:101], v[224:225] neg_lo:[0,1] neg_hi:[0,1]
  v_pk_mul_f32 v[102:103], v[102:103], v[226:227] neg_lo:[0,1] neg_hi:[0,1]
  v_pk_mul_f32 v[104:105], v[104:105], v[228:229] neg_lo:[0,1] neg_hi:[0,1]
  v_pk_mul_f32 v[106:107], v[106:107], v[230:231] neg_lo:[0,1] neg_hi:[0,1]
  v_exp_f32 v100, v100
  v_exp_f32 v101, v101
  v_exp_f32 v102, v102
  v_exp_f32 v103, v103
  v_exp_f32 v104, v104
  v_exp_f32 v105, v105
  v_exp_f32 v106, v106
  v_exp_f32 v107, v107
  v_pk_fma_f32 v[100:101], v[100:101], v[96:97], v[96:97] op_sel:[0,1,1] op_sel_hi:[1,1,1]
  v_pk_fma_f32 v[102:103], v[102:103], v[96:97], v[96:97] op_sel:[0,1,1] op_sel_hi:[1,1,1]
  v_pk_fma_f32 v[104:105], v[104:105], v[96:97], v[96:97] op_sel:[0,1,1] op_sel_hi:[1,1,1]
  v_pk_fma_f32 v[106:107], v[106:107], v[96:97], v[96:97] op_sel:[0,1,1] op_sel_hi:[1,1,1]
  v_rcp_f32 v100, v100
  v_rcp_f32 v101, v101
  v_rcp_f32 v102, v102
  v_rcp_f32 v103, v103
  v_rcp_f32 v104, v104
  v_rcp_f32 v105, v105
  v_rcp_f32 v106, v106
  v_rcp_f32 v107, v107
  v_pk_mul_f32 v[224:225], v[224:225], v[100:101]
  v_pk_mul_f32 v[226:227], v[226:227], v[102:103]
  v_pk_mul_f32 v[228:229], v[228:229], v[104:105]
  v_pk_mul_f32 v[230:231], v[230:231], v[106:107]
  v_cvt_pk_bf16_f32 v116, v224, v225
  v_cvt_pk_bf16_f32 v117, v226, v227
  v_cvt_pk_bf16_f32 v118, v228, v229
  v_cvt_pk_bf16_f32 v119, v230, v231
  s_nop 0
  v_permlane32_swap_b32 v116, v118
  v_permlane32_swap_b32_e64 v117, v119
  buffer_store_dwordx4 v[116:119], v98, s[40:43], s8 offen sc0 sc1
  s_add_u32 s8, s8, 4096
  v_pk_fma_f32 v[100:101], v[80:81], v[92:93], v[84:85] op_sel:[0,1,0] op_sel_hi:[1,1,1] neg_lo:[0,1,0] neg_hi:[0,1,0]
  v_pk_fma_f32 v[102:103], v[82:83], v[92:93], v[86:87] op_sel:[0,1,0] op_sel_hi:[1,1,1] neg_lo:[0,1,0] neg_hi:[0,1,0]
  v_pk_fma_f32 v[104:105], v[80:81], v[94:95], v[84:85] op_sel:[0,1,0] op_sel_hi:[1,1,1] neg_lo:[0,1,0] neg_hi:[0,1,0]
  v_pk_fma_f32 v[106:107], v[82:83], v[94:95], v[86:87] op_sel:[0,1,0] op_sel_hi:[1,1,1] neg_lo:[0,1,0] neg_hi:[0,1,0]
  v_pk_fma_f32 v[232:233], v[232:233], v[92:93], v[100:101] op_sel:[0,0,0] op_sel_hi:[1,0,1]
  v_pk_fma_f32 v[234:235], v[234:235], v[92:93], v[102:103] op_sel:[0,0,0] op_sel_hi:[1,0,1]
  v_pk_fma_f32 v[236:237], v[236:237], v[94:95], v[104:105] op_sel:[0,0,0] op_sel_hi:[1,0,1]
  v_pk_fma_f32 v[238:239], v[238:239], v[94:95], v[106:107] op_sel:[0,0,0] op_sel_hi:[1,0,1]
  v_pk_fma_f32 v[100:101], v[232:233], v[232:233], v[96:97] op_sel_hi:[1,1,0]
  v_pk_fma_f32 v[102:103], v[234:235], v[234:235], v[96:97] op_sel_hi:[1,1,0]
  v_pk_fma_f32 v[104:105], v[236:237], v[236:237], v[96:97] op_sel_hi:[1,1,0]
  v_pk_fma_f32 v[106:107], v[238:239], v[238:239], v[96:97] op_sel_hi:[1,1,0]
  v_pk_mul_f32 v[100:101], v[100:101], v[232:233] neg_lo:[0,1] neg_hi:[0,1]
  v_pk_mul_f32 v[102:103], v[102:103], v[234:235] neg_lo:[0,1] neg_hi:[0,1]
  v_pk_mul_f32 v[104:105], v[104:105], v[236:237] neg_lo:[0,1] neg_hi:[0,1]
  v_pk_mul_f32 v[106:107], v[106:107], v[238:239] neg_lo:[0,1] neg_hi:[0,1]
  v_exp_f32 v100, v100
  v_exp_f32 v101, v101
  v_exp_f32 v102, v102
  v_exp_f32 v103, v103
  v_exp_f32 v104, v104
  v_exp_f32 v105, v105
  v_exp_f32 v106, v106
  v_exp_f32 v107, v107
  v_pk_fma_f32 v[100:101], v[100:101], v[96:97], v[96:97] op_sel:[0,1,1] op_sel_hi:[1,1,1]
  v_pk_fma_f32 v[102:103], v[102:103], v[96:97], v[96:97] op_sel:[0,1,1] op_sel_hi:[1,1,1]
  v_pk_fma_f32 v[104:105], v[104:105], v[96:97], v[96:97] op_sel:[0,1,1] op_sel_hi:[1,1,1]
  v_pk_fma_f32 v[106:107], v[106:107], v[96:97], v[96:97] op_sel:[0,1,1] op_sel_hi:[1,1,1]
  v_rcp_f32 v100, v100
  v_rcp_f32 v101, v101
  v_rcp_f32 v102, v102
  v_rcp_f32 v103, v103
  v_rcp_f32 v104, v104
  v_rcp_f32 v105, v105
  v_rcp_f32 v106, v106
  v_rcp_f32 v107, v107
  v_pk_mul_f32 v[232:233], v[232:233], v[100:101]
  v_pk_mul_f32 v[234:235], v[234:235], v[102:103]
  v_pk_mul_f32 v[236:237], v[236:237], v[104:105]
  v_pk_mul_f32 v[238:239], v[238:239], v[106:107]
  v_cvt_pk_bf16_f32 v120, v232, v233
  v_cvt_pk_bf16_f32 v121, v234, v235
  v_cvt_pk_bf16_f32 v122, v236, v237
  v_cvt_pk_bf16_f32 v123, v238, v239
  s_add_u32 s9, s87, Lz1-Lz0+8
  s_waitcnt vmcnt(1)
  s_mov_b64 exec, 1
  ds_add_rtn_u32 v124, v28, v27 offset:0
  s_mov_b64 exec, -1
  v_permlane32_swap_b32 v120, v122
  v_permlane32_swap_b32_e64 v121, v123
  buffer_store_dwordx4 v[120:123], v98, s[40:43], s8 offen sc0 sc1
  v_pk_fma_f32 v[100:101], v[48:49], v[88:89], v[52:53] op_sel:[0,1,0] op_sel_hi:[1,1,1] neg_lo:[0,1,0] neg_hi:[0,1,0]
  v_pk_fma_f32 v[102:103], v[50:51], v[88:89], v[54:55] op_sel:[0,1,0] op_sel_hi:[1,1,1] neg_lo:[0,1,0] neg_hi:[0,1,0]
  v_pk_fma_f32 v[104:105], v[56:57], v[88:89], v[60:61] op_sel:[0,1,0] op_sel_hi:[1,1,1] neg_lo:[0,1,0] neg_hi:[0,1,0]
  v_pk_fma_f32 v[106:107], v[58:59], v[88:89], v[62:63] op_sel:[0,1,0] op_sel_hi:[1,1,1] neg_lo:[0,1,0] neg_hi:[0,1,0]
  v_pk_fma_f32 v[160:161], v[160:161], v[88:89], v[100:101] op_sel:[0,0,0] op_sel_hi:[1,0,1]
  v_pk_fma_f32 v[162:163], v[162:163], v[88:89], v[102:103] op_sel:[0,0,0] op_sel_hi:[1,0,1]
  v_pk_fma_f32 v[176:177], v[176:177], v[88:89], v[104:105] op_sel:[0,0,0] op_sel_hi:[1,0,1]
  v_pk_fma_f32 v[178:179], v[178:179], v[88:89], v[106:107] op_sel:[0,0,0] op_sel_hi:[1,0,1]
  v_pk_fma_f32 v[100:101], v[160:161], v[160:161], v[96:97] op_sel_hi:[1,1,0]
  v_pk_fma_f32 v[102:103], v[162:163], v[162:163], v[96:97] op_sel_hi:[1,1,0]
  v_pk_fma_f32 v[104:105], v[176:177], v[176:177], v[96:97] op_sel_hi:[1,1,0]
  v_pk_fma_f32 v[106:107], v[178:179], v[178:179], v[96:97] op_sel_hi:[1,1,0]
  v_pk_mul_f32 v[100:101], v[100:101], v[160:161] neg_lo:[0,1] neg_hi:[0,1]
  v_pk_mul_f32 v[102:103], v[102:103], v[162:163] neg_lo:[0,1] neg_hi:[0,1]
  v_pk_mul_f32 v[104:105], v[104:105], v[176:177] neg_lo:[0,1] neg_hi:[0,1]
  v_pk_mul_f32 v[106:107], v[106:107], v[178:179] neg_lo:[0,1] neg_hi:[0,1]
  v_exp_f32 v100, v100
  v_exp_f32 v101, v101
  v_exp_f32 v102, v102
  v_exp_f32 v103, v103
  v_exp_f32 v104, v104
  v_exp_f32 v105, v105
  v_exp_f32 v106, v106
  v_exp_f32 v107, v107
  v_pk_fma_f32 v[100:101], v[100:101], v[96:97], v[96:97] op_sel:[0,1,1] op_sel_hi:[1,1,1]
  v_pk_fma_f32 v[102:103], v[102:103], v[96:97], v[96:97] op_sel:[0,1,1] op_sel_hi:[1,1,1]
  v_pk_fma_f32 v[104:105], v[104:105], v[96:97], v[96:97] op_sel:[0,1,1] op_sel_hi:[1,1,1]
  v_pk_fma_f32 v[106:107], v[106:107], v[96:97], v[96:97] op_sel:[0,1,1] op_sel_hi:[1,1,1]
  v_rcp_f32 v100, v100
  v_rcp_f32 v101, v101
  v_rcp_f32 v102, v102
  v_rcp_f32 v103, v103
  v_rcp_f32 v104, v104
  v_rcp_f32 v105, v105
  v_rcp_f32 v106, v106
  v_rcp_f32 v107, v107
  v_pk_mul_f32 v[160:161], v[160:161], v[100:101]
  v_pk_mul_f32 v[162:163], v[162:163], v[102:103]
  v_pk_mul_f32 v[176:177], v[176:177], v[104:105]
  v_pk_mul_f32 v[178:179], v[178:179], v[106:107]
  v_cvt_pk_bf16_f32 v116, v160, v161
  v_cvt_pk_bf16_f32 v117, v162, v163
  v_cvt_pk_bf16_f32 v118, v176, v177
  v_cvt_pk_bf16_f32 v119, v178, v179
  s_waitcnt lgkmcnt(0)
  v_readfirstlane_b32 s4, v124
  s_and_b32 s4, s4, 3
  s_cmp_lg_u32 s4, 3
  s_cbranch_scc1 Ls_25
  s_mov_b32 exec_lo, s10
  s_mov_b32 exec_hi, 0
  buffer_store_dword v27, v24, s[40:43], s9 offen sc0 sc1
Ls_25:
  s_mov_b64 exec, -1
  buffer_store_dwordx4 v[116:119], v0, s[40:43], s6 offen offset:0 sc0 sc1
  ds_write_b128 v0, v[116:119] offset:16384
  v_pk_fma_f32 v[100:101], v[48:49], v[90:91], v[52:53] op_sel:[0,1,0] op_sel_hi:[1,1,1] neg_lo:[0,1,0] neg_hi:[0,1,0]
  v_pk_fma_f32 v[102:103], v[50:51], v[90:91], v[54:55] op_sel:[0,1,0] op_sel_hi:[1,1,1] neg_lo:[0,1,0] neg_hi:[0,1,0]
  v_pk_fma_f32 v[104:105], v[56:57], v[90:91], v[60:61] op_sel:[0,1,0] op_sel_hi:[1,1,1] neg_lo:[0,1,0] neg_hi:[0,1,0]
  v_pk_fma_f32 v[106:107], v[58:59], v[90:91], v[62:63] op_sel:[0,1,0] op_sel_hi:[1,1,1] neg_lo:[0,1,0] neg_hi:[0,1,0]
  v_pk_fma_f32 v[164:165], v[164:165], v[90:91], v[100:101] op_sel:[0,0,0] op_sel_hi:[1,0,1]
  v_pk_fma_f32 v[166:167], v[166:167], v[90:91], v[102:103] op_sel:[0,0,0] op_sel_hi:[1,0,1]
  v_pk_fma_f32 v[180:181], v[180:181], v[90:91], v[104:105] op_sel:[0,0,0] op_sel_hi:[1,0,1]
  v_pk_fma_f32 v[182:183], v[182:183], v[90:91], v[106:107] op_sel:[0,0,0] op_sel_hi:[1,0,1]
  v_pk_fma_f32 v[100:101], v[164:165], v[164:165], v[96:97] op_sel_hi:[1,1,0]
  v_pk_fma_f32 v[102:103], v[166:167], v[166:167], v[96:97] op_sel_hi:[1,1,0]
  v_pk_fma_f32 v[104:105], v[180:181], v[180:181], v[96:97] op_sel_hi:[1,1,0]
  v_pk_fma_f32 v[106:107], v[182:183], v[182:183], v[96:97] op_sel_hi:[1,1,0]
  v_pk_mul_f32 v[100:101], v[100:101], v[164:165] neg_lo:[0,1] neg_hi:[0,1]
  v_pk_mul_f32 v[102:103], v[102:103], v[166:167] neg_lo:[0,1] neg_hi:[0,1]
  v_pk_mul_f32 v[104:105], v[104:105], v[180:181] neg_lo:[0,1] neg_hi:[0,1]
  v_pk_mul_f32 v[106:107], v[106:107], v[182:183] neg_lo:[0,1] neg_hi:[0,1]
  v_exp_f32 v100, v100
  v_exp_f32 v101, v101
  v_exp_f32 v102, v102
  v_exp_f32 v103, v103
  v_exp_f32 v104, v104
  v_exp_f32 v105, v105
  v_exp_f32 v106, v106
  v_exp_f32 v107, v107
  v_pk_fma_f32 v[100:101], v[100:101], v[96:97], v[96:97] op_sel:[0,1,1] op_sel_hi:[1,1,1]
  v_pk_fma_f32 v[102:103], v[102:103], v[96:97], v[96:97] op_sel:[0,1,1] op_sel_hi:[1,1,1]
  v_pk_fma_f32 v[104:105], v[104:105], v[96:97], v[96:97] op_sel:[0,1,1] op_sel_hi:[1,1,1]
  v_pk_fma_f32 v[106:107], v[106:107], v[96:97], v[96:97] op_sel:[0,1,1] op_sel_hi:[1,1,1]
  v_rcp_f32 v100, v100
  v_rcp_f32 v101, v101
  v_rcp_f32 v102, v102
  v_rcp_f32 v103, v103
  v_rcp_f32 v104, v104
  v_rcp_f32 v105, v105
  v_rcp_f32 v106, v106
  v_rcp_f32 v107, v107
  v_pk_mul_f32 v[164:165], v[164:165], v[100:101]
  v_pk_mul_f32 v[166:167], v[166:167], v[102:103]
  v_pk_mul_f32 v[180:181], v[180:181], v[104:105]
  v_pk_mul_f32 v[182:183], v[182:183], v[106:107]
  v_cvt_pk_bf16_f32 v120, v164, v165
  v_cvt_pk_bf16_f32 v121, v166, v167
  v_cvt_pk_bf16_f32 v122, v180, v181
  v_cvt_pk_bf16_f32 v123, v182, v183
  buffer_store_dwordx4 v[120:123], v0, s[40:43], s6 offen offset:2048 sc0 sc1
  ds_write_b128 v0, v[120:123] offset:18432
  s_add_u32 s6, s6, 0x20000
  v_pk_fma_f32 v[100:101], v[48:49], v[92:93], v[52:53] op_sel:[0,1,0] op_sel_hi:[1,1,1] neg_lo:[0,1,0] neg_hi:[0,1,0]
  v_pk_fma_f32 v[102:103], v[50:51], v[92:93], v[54:55] op_sel:[0,1,0] op_sel_hi:[1,1,1] neg_lo:[0,1,0] neg_hi:[0,1,0]
  v_pk_fma_f32 v[104:105], v[56:57], v[92:93], v[60:61] op_sel:[0,1,0] op_sel_hi:[1,1,1] neg_lo:[0,1,0] neg_hi:[0,1,0]
  v_pk_fma_f32 v[106:107], v[58:59], v[92:93], v[62:63] op_sel:[0,1,0] op_sel_hi:[1,1,1] neg_lo:[0,1,0] neg_hi:[0,1,0]
  v_pk_fma_f32 v[168:169], v[168:169], v[92:93], v[100:101] op_sel:[0,0,0] op_sel_hi:[1,0,1]
  v_pk_fma_f32 v[170:171], v[170:171], v[92:93], v[102:103] op_sel:[0,0,0] op_sel_hi:[1,0,1]
  v_pk_fma_f32 v[184:185], v[184:185], v[92:93], v[104:105] op_sel:[0,0,0] op_sel_hi:[1,0,1]
  v_pk_fma_f32 v[186:187], v[186:187], v[92:93], v[106:107] op_sel:[0,0,0] op_sel_hi:[1,0,1]
  v_pk_fma_f32 v[100:101], v[168:169], v[168:169], v[96:97] op_sel_hi:[1,1,0]
  v_pk_fma_f32 v[102:103], v[170:171], v[170:171], v[96:97] op_sel_hi:[1,1,0]
  v_pk_fma_f32 v[104:105], v[184:185], v[184:185], v[96:97] op_sel_hi:[1,1,0]
  v_pk_fma_f32 v[106:107], v[186:187], v[186:187], v[96:97] op_sel_hi:[1,1,0]
  v_pk_mul_f32 v[100:101], v[100:101], v[168:169] neg_lo:[0,1] neg_hi:[0,1]
  v_pk_mul_f32 v[102:103], v[102:103], v[170:171] neg_lo:[0,1] neg_hi:[0,1]
  v_pk_mul_f32 v[104:105], v[104:105], v[184:185] neg_lo:[0,1] neg_hi:[0,1]
  v_pk_mul_f32 v[106:107], v[106:107], v[186:187] neg_lo:[0,1] neg_hi:[0,1]
  v_exp_f32 v100, v100
  v_exp_f32 v101, v101
  v_exp_f32 v102, v102
  v_exp_f32 v103, v103
  v_exp_f32 v104, v104
  v_exp_f32 v105, v105
  v_exp_f32 v106, v106
  v_exp_f32 v107, v107
  v_pk_fma_f32 v[100:101], v[100:101], v[96:97], v[96:97] op_sel:[0,1,1] op_sel_hi:[1,1,1]
  v_pk_fma_f32 v[102:103], v[102:103], v[96:97], v[96:97] op_sel:[0,1,1] op_sel_hi:[1,1,1]
  v_pk_fma_f32 v[104:105], v[104:105], v[96:97], v[96:97] op_sel:[0,1,1] op_sel_hi:[1,1,1]
  v_pk_fma_f32 v[106:107], v[106:107], v[96:97], v[96:97] op_sel:[0,1,1] op_sel_hi:[1,1,1]
  v_rcp_f32 v100, v100
  v_rcp_f32 v101, v101
  v_rcp_f32 v102, v102
  v_rcp_f32 v103, v103
  v_rcp_f32 v104, v104
  v_rcp_f32 v105, v105
  v_rcp_f32 v106, v106
  v_rcp_f32 v107, v107
  v_pk_mul_f32 v[168:169], v[168:169], v[100:101]
  v_pk_mul_f32 v[170:171], v[170:171], v[102:103]
  v_pk_mul_f32 v[184:185], v[184:185], v[104:105]
  v_pk_mul_f32 v[186:187], v[186:187], v[106:107]
  v_cvt_pk_bf16_f32 v116, v168, v169
  v_cvt_pk_bf16_f32 v117, v170, v171
  v_cvt_pk_bf16_f32 v118, v184, v185
  v_cvt_pk_bf16_f32 v119, v186, v187
  buffer_store_dwordx4 v[116:119], v0, s[40:43], s7 offen offset:0 sc0 sc1
  ds_write_b128 v0, v[116:119] offset:20480
  v_pk_fma_f32 v[100:101], v[48:49], v[94:95], v[52:53] op_sel:[0,1,0] op_sel_hi:[1,1,1] neg_lo:[0,1,0] neg_hi:[0,1,0]
  v_pk_fma_f32 v[102:103], v[50:51], v[94:95], v[54:55] op_sel:[0,1,0] op_sel_hi:[1,1,1] neg_lo:[0,1,0] neg_hi:[0,1,0]
  v_pk_fma_f32 v[104:105], v[56:57], v[94:95], v[60:61] op_sel:[0,1,0] op_sel_hi:[1,1,1] neg_lo:[0,1,0] neg_hi:[0,1,0]
  v_pk_fma_f32 v[106:107], v[58:59], v[94:95], v[62:63] op_sel:[0,1,0] op_sel_hi:[1,1,1] neg_lo:[0,1,0] neg_hi:[0,1,0]
  v_pk_fma_f32 v[172:173], v[172:173], v[94:95], v[100:101] op_sel:[0,0,0] op_sel_hi:[1,0,1]
  v_pk_fma_f32 v[174:175], v[174:175], v[94:95], v[102:103] op_sel:[0,0,0] op_sel_hi:[1,0,1]
  v_pk_fma_f32 v[188:189], v[188:189], v[94:95], v[104:105] op_sel:[0,0,0] op_sel_hi:[1,0,1]
  v_pk_fma_f32 v[190:191], v[190:191], v[94:95], v[106:107] op_sel:[0,0,0] op_sel_hi:[1,0,1]
  v_pk_fma_f32 v[100:101], v[172:173], v[172:173], v[96:97] op_sel_hi:[1,1,0]
  v_pk_fma_f32 v[102:103], v[174:175], v[174:175], v[96:97] op_sel_hi:[1,1,0]
  v_pk_fma_f32 v[104:105], v[188:189], v[188:189], v[96:97] op_sel_hi:[1,1,0]
  v_pk_fma_f32 v[106:107], v[190:191], v[190:191], v[96:97] op_sel_hi:[1,1,0]
  v_pk_mul_f32 v[100:101], v[100:101], v[172:173] neg_lo:[0,1] neg_hi:[0,1]
  v_pk_mul_f32 v[102:103], v[102:103], v[174:175] neg_lo:[0,1] neg_hi:[0,1]
  v_pk_mul_f32 v[104:105], v[104:105], v[188:189] neg_lo:[0,1] neg_hi:[0,1]
  v_pk_mul_f32 v[106:107], v[106:107], v[190:191] neg_lo:[0,1] neg_hi:[0,1]
  v_exp_f32 v100, v100
  v_exp_f32 v101, v101
  v_exp_f32 v102, v102
  v_exp_f32 v103, v103
  v_exp_f32 v104, v104
  v_exp_f32 v105, v105
  v_exp_f32 v106, v106
  v_exp_f32 v107, v107
  v_pk_fma_f32 v[100:101], v[100:101], v[96:97], v[96:97] op_sel:[0,1,1] op_sel_hi:[1,1,1]
  v_pk_fma_f32 v[102:103], v[102:103], v[96:97], v[96:97] op_sel:[0,1,1] op_sel_hi:[1,1,1]
  v_pk_fma_f32 v[104:105], v[104:105], v[96:97], v[96:97] op_sel:[0,1,1] op_sel_hi:[1,1,1]
  v_pk_fma_f32 v[106:107], v[106:107], v[96:97], v[96:97] op_sel:[0,1,1] op_sel_hi:[1,1,1]
  v_rcp_f32 v100, v100
  v_rcp_f32 v101, v101
  v_rcp_f32 v102, v102
  v_rcp_f32 v103, v103
  v_rcp_f32 v104, v104
  v_rcp_f32 v105, v105
  v_rcp_f32 v106, v106
  v_rcp_f32 v107, v107
  v_pk_mul_f32 v[172:173], v[172:173], v[100:101]
  v_pk_mul_f32 v[174:175], v[174:175], v[102:103]
  v_pk_mul_f32 v[188:189], v[188:189], v[104:105]
  v_pk_mul_f32 v[190:191], v[190:191], v[106:107]
  v_cvt_pk_bf16_f32 v120, v172, v173
  v_cvt_pk_bf16_f32 v121, v174, v175
  v_cvt_pk_bf16_f32 v122, v188, v189
  v_cvt_pk_bf16_f32 v123, v190, v191
  buffer_store_dwordx4 v[120:123], v0, s[40:43], s7 offen offset:2048 sc0 sc1
  ds_write_b128 v0, v[120:123] offset:22528
  s_add_u32 s7, s7, 0x20000
  v_pk_fma_f32 v[100:101], v[64:65], v[88:89], v[68:69] op_sel:[0,1,0] op_sel_hi:[1,1,1] neg_lo:[0,1,0] neg_hi:[0,1,0]
  v_pk_fma_f32 v[102:103], v[66:67], v[88:89], v[70:71] op_sel:[0,1,0] op_sel_hi:[1,1,1] neg_lo:[0,1,0] neg_hi:[0,1,0]
  v_pk_fma_f32 v[104:105], v[72:73], v[88:89], v[76:77] op_sel:[0,1,0] op_sel_hi:[1,1,1] neg_lo:[0,1,0] neg_hi:[0,1,0]
  v_pk_fma_f32 v[106:107], v[74:75], v[88:89], v[78:79] op_sel:[0,1,0] op_sel_hi:[1,1,1] neg_lo:[0,1,0] neg_hi:[0,1,0]
  v_pk_fma_f32 v[192:193], v[192:193], v[88:89], v[100:101] op_sel:[0,0,0] op_sel_hi:[1,0,1]
  v_pk_fma_f32 v[194:195], v[194:195], v[88:89], v[102:103] op_sel:[0,0,0] op_sel_hi:[1,0,1]
  v_pk_fma_f32 v[208:209], v[208:209], v[88:89], v[104:105] op_sel:[0,0,0] op_sel_hi:[1,0,1]
  v_pk_fma_f32 v[210:211], v[210:211], v[88:89], v[106:107] op_sel:[0,0,0] op_sel_hi:[1,0,1]
  v_pk_fma_f32 v[100:101], v[192:193], v[192:193], v[96:97] op_sel_hi:[1,1,0]
  v_pk_fma_f32 v[102:103], v[194:195], v[194:195], v[96:97] op_sel_hi:[1,1,0]
  v_pk_fma_f32 v[104:105], v[208:209], v[208:209], v[96:97] op_sel_hi:[1,1,0]
  v_pk_fma_f32 v[106:107], v[210:211], v[210:211], v[96:97] op_sel_hi:[1,1,0]
  v_pk_mul_f32 v[100:101], v[100:101], v[192:193] neg_lo:[0,1] neg_hi:[0,1]
  v_pk_mul_f32 v[102:103], v[102:103], v[194:195] neg_lo:[0,1] neg_hi:[0,1]
  v_pk_mul_f32 v[104:105], v[104:105], v[208:209] neg_lo:[0,1] neg_hi:[0,1]
  v_pk_mul_f32 v[106:107], v[106:107], v[210:211] neg_lo:[0,1] neg_hi:[0,1]
  v_exp_f32 v100, v100
  v_exp_f32 v101, v101
  v_exp_f32 v102, v102
  v_exp_f32 v103, v103
  v_exp_f32 v104, v104
  v_exp_f32 v105, v105
  v_exp_f32 v106, v106
  v_exp_f32 v107, v107
  v_pk_fma_f32 v[100:101], v[100:101], v[96:97], v[96:97] op_sel:[0,1,1] op_sel_hi:[1,1,1]
  v_pk_fma_f32 v[102:103], v[102:103], v[96:97], v[96:97] op_sel:[0,1,1] op_sel_hi:[1,1,1]
  v_pk_fma_f32 v[104:105], v[104:105], v[96:97], v[96:97] op_sel:[0,1,1] op_sel_hi:[1,1,1]
  v_pk_fma_f32 v[106:107], v[106:107], v[96:97], v[96:97] op_sel:[0,1,1] op_sel_hi:[1,1,1]
  v_rcp_f32 v100, v100
  v_rcp_f32 v101, v101
  v_rcp_f32 v102, v102
  v_rcp_f32 v103, v103
  v_rcp_f32 v104, v104
  v_rcp_f32 v105, v105
  v_rcp_f32 v106, v106
  v_rcp_f32 v107, v107
  v_pk_mul_f32 v[192:193], v[192:193], v[100:101]
  v_pk_mul_f32 v[194:195], v[194:195], v[102:103]
  v_pk_mul_f32 v[208:209], v[208:209], v[104:105]
  v_pk_mul_f32 v[210:211], v[210:211], v[106:107]
  v_cvt_pk_bf16_f32 v116, v192, v193
  v_cvt_pk_bf16_f32 v117, v194, v195
  v_cvt_pk_bf16_f32 v118, v208, v209
  v_cvt_pk_bf16_f32 v119, v210, v211
  buffer_store_dwordx4 v[116:119], v0, s[40:43], s6 offen offset:0 sc0 sc1
  ds_write_b128 v0, v[116:119] offset:32768
  v_pk_fma_f32 v[100:101], v[64:65], v[90:91], v[68:69] op_sel:[0,1,0] op_sel_hi:[1,1,1] neg_lo:[0,1,0] neg_hi:[0,1,0]
  v_pk_fma_f32 v[102:103], v[66:67], v[90:91], v[70:71] op_sel:[0,1,0] op_sel_hi:[1,1,1] neg_lo:[0,1,0] neg_hi:[0,1,0]
  v_pk_fma_f32 v[104:105], v[72:73], v[90:91], v[76:77] op_sel:[0,1,0] op_sel_hi:[1,1,1] neg_lo:[0,1,0] neg_hi:[0,1,0]
  v_pk_fma_f32 v[106:107], v[74:75], v[90:91], v[78:79] op_sel:[0,1,0] op_sel_hi:[1,1,1] neg_lo:[0,1,0] neg_hi:[0,1,0]
  v_pk_fma_f32 v[196:197], v[196:197], v[90:91], v[100:101] op_sel:[0,0,0] op_sel_hi:[1,0,1]
  v_pk_fma_f32 v[198:199], v[198:199], v[90:91], v[102:103] op_sel:[0,0,0] op_sel_hi:[1,0,1]
  v_pk_fma_f32 v[212:213], v[212:213], v[90:91], v[104:105] op_sel:[0,0,0] op_sel_hi:[1,0,1]
  v_pk_fma_f32 v[214:215], v[214:215], v[90:91], v[106:107] op_sel:[0,0,0] op_sel_hi:[1,0,1]
  v_pk_fma_f32 v[100:101], v[196:197], v[196:197], v[96:97] op_sel_hi:[1,1,0]
  v_pk_fma_f32 v[102:103], v[198:199], v[198:199], v[96:97] op_sel_hi:[1,1,0]
  v_pk_fma_f32 v[104:105], v[212:213], v[212:213], v[96:97] op_sel_hi:[1,1,0]
  v_pk_fma_f32 v[106:107], v[214:215], v[214:215], v[96:97] op_sel_hi:[1,1,0]
  v_pk_mul_f32 v[100:101], v[100:101], v[196:197] neg_lo:[0,1] neg_hi:[0,1]
  v_pk_mul_f32 v[102:103], v[102:103], v[198:199] neg_lo:[0,1] neg_hi:[0,1]
  v_pk_mul_f32 v[104:105], v[104:105], v[212:213] neg_lo:[0,1] neg_hi:[0,1]
  v_pk_mul_f32 v[106:107], v[106:107], v[214:215] neg_lo:[0,1] neg_hi:[0,1]
  v_exp_f32 v100, v100
  v_exp_f32 v101, v101
  v_exp_f32 v102, v102
  v_exp_f32 v103, v103
  v_exp_f32 v104, v104
  v_exp_f32 v105, v105
  v_exp_f32 v106, v106
  v_exp_f32 v107, v107
  v_pk_fma_f32 v[100:101], v[100:101], v[96:97], v[96:97] op_sel:[0,1,1] op_sel_hi:[1,1,1]
  v_pk_fma_f32 v[102:103], v[102:103], v[96:97], v[96:97] op_sel:[0,1,1] op_sel_hi:[1,1,1]
  v_pk_fma_f32 v[104:105], v[104:105], v[96:97], v[96:97] op_sel:[0,1,1] op_sel_hi:[1,1,1]
  v_pk_fma_f32 v[106:107], v[106:107], v[96:97], v[96:97] op_sel:[0,1,1] op_sel_hi:[1,1,1]
  v_rcp_f32 v100, v100
  v_rcp_f32 v101, v101
  v_rcp_f32 v102, v102
  v_rcp_f32 v103, v103
  v_rcp_f32 v104, v104
  v_rcp_f32 v105, v105
  v_rcp_f32 v106, v106
  v_rcp_f32 v107, v107
  v_pk_mul_f32 v[196:197], v[196:197], v[100:101]
  v_pk_mul_f32 v[198:199], v[198:199], v[102:103]
  v_pk_mul_f32 v[212:213], v[212:213], v[104:105]
  v_pk_mul_f32 v[214:215], v[214:215], v[106:107]
  v_cvt_pk_bf16_f32 v120, v196, v197
  v_cvt_pk_bf16_f32 v121, v198, v199
  v_cvt_pk_bf16_f32 v122, v212, v213
  v_cvt_pk_bf16_f32 v123, v214, v215
  buffer_store_dwordx4 v[120:123], v0, s[40:43], s6 offen offset:2048 sc0 sc1
  ds_write_b128 v0, v[120:123] offset:34816
  v_pk_fma_f32 v[100:101], v[64:65], v[92:93], v[68:69] op_sel:[0,1,0] op_sel_hi:[1,1,1] neg_lo:[0,1,0] neg_hi:[0,1,0]
  v_pk_fma_f32 v[102:103], v[66:67], v[92:93], v[70:71] op_sel:[0,1,0] op_sel_hi:[1,1,1] neg_lo:[0,1,0] neg_hi:[0,1,0]
  v_pk_fma_f32 v[104:105], v[72:73], v[92:93], v[76:77] op_sel:[0,1,0] op_sel_hi:[1,1,1] neg_lo:[0,1,0] neg_hi:[0,1,0]
  v_pk_fma_f32 v[106:107], v[74:75], v[92:93], v[78:79] op_sel:[0,1,0] op_sel_hi:[1,1,1] neg_lo:[0,1,0] neg_hi:[0,1,0]
  v_pk_fma_f32 v[200:201], v[200:201], v[92:93], v[100:101] op_sel:[0,0,0] op_sel_hi:[1,0,1]
  v_pk_fma_f32 v[202:203], v[202:203], v[92:93], v[102:103] op_sel:[0,0,0] op_sel_hi:[1,0,1]
  v_pk_fma_f32 v[216:217], v[216:217], v[92:93], v[104:105] op_sel:[0,0,0] op_sel_hi:[1,0,1]
  v_pk_fma_f32 v[218:219], v[218:219], v[92:93], v[106:107] op_sel:[0,0,0] op_sel_hi:[1,0,1]
  v_pk_fma_f32 v[100:101], v[200:201], v[200:201], v[96:97] op_sel_hi:[1,1,0]
  v_pk_fma_f32 v[102:103], v[202:203], v[202:203], v[96:97] op_sel_hi:[1,1,0]
  v_pk_fma_f32 v[104:105], v[216:217], v[216:217], v[96:97] op_sel_hi:[1,1,0]
  v_pk_fma_f32 v[106:107], v[218:219], v[218:219], v[96:97] op_sel_hi:[1,1,0]
  v_pk_mul_f32 v[100:101], v[100:101], v[200:201] neg_lo:[0,1] neg_hi:[0,1]
  v_pk_mul_f32 v[102:103], v[102:103], v[202:203] neg_lo:[0,1] neg_hi:[0,1]
  v_pk_mul_f32 v[104:105], v[104:105], v[216:217] neg_lo:[0,1] neg_hi:[0,1]
  v_pk_mul_f32 v[106:107], v[106:107], v[218:219] neg_lo:[0,1] neg_hi:[0,1]
  v_exp_f32 v100, v100
  v_exp_f32 v101, v101
  v_exp_f32 v102, v102
  v_exp_f32 v103, v103
  v_exp_f32 v104, v104
  v_exp_f32 v105, v105
  v_exp_f32 v106, v106
  v_exp_f32 v107, v107
  v_pk_fma_f32 v[100:101], v[100:101], v[96:97], v[96:97] op_sel:[0,1,1] op_sel_hi:[1,1,1]
  v_pk_fma_f32 v[102:103], v[102:103], v[96:97], v[96:97] op_sel:[0,1,1] op_sel_hi:[1,1,1]
  v_pk_fma_f32 v[104:105], v[104:105], v[96:97], v[96:97] op_sel:[0,1,1] op_sel_hi:[1,1,1]
  v_pk_fma_f32 v[106:107], v[106:107], v[96:97], v[96:97] op_sel:[0,1,1] op_sel_hi:[1,1,1]
  v_rcp_f32 v100, v100
  v_rcp_f32 v101, v101
  v_rcp_f32 v102, v102
  v_rcp_f32 v103, v103
  v_rcp_f32 v104, v104
  v_rcp_f32 v105, v105
  v_rcp_f32 v106, v106
  v_rcp_f32 v107, v107
  v_pk_mul_f32 v[200:201], v[200:201], v[100:101]
  v_pk_mul_f32 v[202:203], v[202:203], v[102:103]
  v_pk_mul_f32 v[216:217], v[216:217], v[104:105]
  v_pk_mul_f32 v[218:219], v[218:219], v[106:107]
  v_cvt_pk_bf16_f32 v116, v200, v201
  v_cvt_pk_bf16_f32 v117, v202, v203
  v_cvt_pk_bf16_f32 v118, v216, v217
  v_cvt_pk_bf16_f32 v119, v218, v219
  buffer_store_dwordx4 v[116:119], v0, s[40:43], s7 offen offset:0 sc0 sc1
  ds_write_b128 v0, v[116:119] offset:36864
  v_pk_fma_f32 v[100:101], v[64:65], v[94:95], v[68:69] op_sel:[0,1,0] op_sel_hi:[1,1,1] neg_lo:[0,1,0] neg_hi:[0,1,0]
  v_pk_fma_f32 v[102:103], v[66:67], v[94:95], v[70:71] op_sel:[0,1,0] op_sel_hi:[1,1,1] neg_lo:[0,1,0] neg_hi:[0,1,0]
  v_pk_fma_f32 v[104:105], v[72:73], v[94:95], v[76:77] op_sel:[0,1,0] op_sel_hi:[1,1,1] neg_lo:[0,1,0] neg_hi:[0,1,0]
  v_pk_fma_f32 v[106:107], v[74:75], v[94:95], v[78:79] op_sel:[0,1,0] op_sel_hi:[1,1,1] neg_lo:[0,1,0] neg_hi:[0,1,0]
  v_pk_fma_f32 v[204:205], v[204:205], v[94:95], v[100:101] op_sel:[0,0,0] op_sel_hi:[1,0,1]
  v_pk_fma_f32 v[206:207], v[206:207], v[94:95], v[102:103] op_sel:[0,0,0] op_sel_hi:[1,0,1]
  v_pk_fma_f32 v[220:221], v[220:221], v[94:95], v[104:105] op_sel:[0,0,0] op_sel_hi:[1,0,1]
  v_pk_fma_f32 v[222:223], v[222:223], v[94:95], v[106:107] op_sel:[0,0,0] op_sel_hi:[1,0,1]
  v_pk_fma_f32 v[100:101], v[204:205], v[204:205], v[96:97] op_sel_hi:[1,1,0]
  v_pk_fma_f32 v[102:103], v[206:207], v[206:207], v[96:97] op_sel_hi:[1,1,0]
  v_pk_fma_f32 v[104:105], v[220:221], v[220:221], v[96:97] op_sel_hi:[1,1,0]
  v_pk_fma_f32 v[106:107], v[222:223], v[222:223], v[96:97] op_sel_hi:[1,1,0]
  v_pk_mul_f32 v[100:101], v[100:101], v[204:205] neg_lo:[0,1] neg_hi:[0,1]
  v_pk_mul_f32 v[102:103], v[102:103], v[206:207] neg_lo:[0,1] neg_hi:[0,1]
  v_pk_mul_f32 v[104:105], v[104:105], v[220:221] neg_lo:[0,1] neg_hi:[0,1]
  v_pk_mul_f32 v[106:107], v[106:107], v[222:223] neg_lo:[0,1] neg_hi:[0,1]
  v_exp_f32 v100, v100
  v_exp_f32 v101, v101
  v_exp_f32 v102, v102
  v_exp_f32 v103, v103
  v_exp_f32 v104, v104
  v_exp_f32 v105, v105
  v_exp_f32 v106, v106
  v_exp_f32 v107, v107
  v_pk_fma_f32 v[100:101], v[100:101], v[96:97], v[96:97] op_sel:[0,1,1] op_sel_hi:[1,1,1]
  v_pk_fma_f32 v[102:103], v[102:103], v[96:97], v[96:97] op_sel:[0,1,1] op_sel_hi:[1,1,1]
  v_pk_fma_f32 v[104:105], v[104:105], v[96:97], v[96:97] op_sel:[0,1,1] op_sel_hi:[1,1,1]
  v_pk_fma_f32 v[106:107], v[106:107], v[96:97], v[96:97] op_sel:[0,1,1] op_sel_hi:[1,1,1]
  v_rcp_f32 v100, v100
  v_rcp_f32 v101, v101
  v_rcp_f32 v102, v102
  v_rcp_f32 v103, v103
  v_rcp_f32 v104, v104
  v_rcp_f32 v105, v105
  v_rcp_f32 v106, v106
  v_rcp_f32 v107, v107
  v_pk_mul_f32 v[204:205], v[204:205], v[100:101]
  v_pk_mul_f32 v[206:207], v[206:207], v[102:103]
  v_pk_mul_f32 v[220:221], v[220:221], v[104:105]
  v_pk_mul_f32 v[222:223], v[222:223], v[106:107]
  v_cvt_pk_bf16_f32 v120, v204, v205
  v_cvt_pk_bf16_f32 v121, v206, v207
  v_cvt_pk_bf16_f32 v122, v220, v221
  v_cvt_pk_bf16_f32 v123, v222, v223
  buffer_store_dwordx4 v[120:123], v0, s[40:43], s7 offen offset:2048 sc0 sc1
  ds_write_b128 v0, v[120:123] offset:38912
  s_mov_b32 s16, Lz1-Lz0+0
  s_mov_b32 s17, 16384
  s_mov_b32 s18, 0xffff4000
  s_mov_b32 s19, 49152
  s_mov_b32 s20, 16384
  s_mov_b32 s21, 0xffff0000
  s_mul_i32 s4, s85, 8192
  v_add_u32_e64 v4, s4, v11
  v_add_u32 v5, 1024, v4
  s_lshl_b32 s4, s86, 1
  v_xor_b32 v2, s4, v26
  v_lshl_add_u32 v6, v2, 5, v25
  v_add_u32 v6, s19, v6
  s_add_u32 s4, s4, 1
  v_xor_b32_e64 v2, s4, v26
  v_lshl_add_u32 v7, v2, 5, v25
  v_add_u32_e64 v7, s19, v7
  s_mov_b32 s4, 0xffff0000
  v_lshlrev_b32 v128, 16, v240
  v_and_b32 v129, s4, v240
  v_lshlrev_b32 v130, 16, v241
  v_and_b32 v131, s4, v241
  v_lshlrev_b32 v132, 16, v242
  v_and_b32 v133, s4, v242
  v_lshlrev_b32 v134, 16, v243
  v_and_b32 v135, s4, v243
  v_lshlrev_b32 v136, 16, v244
  v_and_b32 v137, s4, v244
  v_lshlrev_b32 v138, 16, v245
  v_and_b32 v139, s4, v245
  v_lshlrev_b32 v140, 16, v246
  v_and_b32 v141, s4, v246
  v_lshlrev_b32 v142, 16, v247
  v_and_b32 v143, s4, v247
  v_lshlrev_b32 v144, 16, v248
  v_and_b32 v145, s4, v248
  v_lshlrev_b32 v146, 16, v249
  v_and_b32 v147, s4, v249
  v_lshlrev_b32 v148, 16, v250
  v_and_b32 v149, s4, v250
  v_lshlrev_b32 v150, 16, v251
  v_and_b32 v151, s4, v251
  v_lshlrev_b32 v152, 16, v252
  v_and_b32 v153, s4, v252
  v_lshlrev_b32 v154, 16, v253
  v_and_b32 v155, s4, v253
  v_lshlrev_b32 v156, 16, v254
  v_and_b32 v157, s4, v254
  v_lshlrev_b32 v158, 16, v255
  v_and_b32 v159, s4, v255
  s_lshl_b32 s5, s86, Lz1-Lz0+7
  s_add_u32 s5, s5, 156160
  v_add_u32_e64 v3, s5, v29
  ds_read_b128 v[32:35], v3
  ds_read_b128 v[36:39], v3 offset:64
  v_mov_b64 v[160:161], 0
  v_mov_b64 v[162:163], 0
  v_mov_b64 v[164:165], 0
  v_mov_b64 v[166:167], 0
  v_mov_b64 v[168:169], 0
  v_mov_b64 v[170:171], 0
  v_mov_b64 v[172:173], 0
  v_mov_b64 v[174:175], 0
  v_mov_b64 v[176:177], 0
  v_mov_b64 v[178:179], 0
  v_mov_b64 v[180:181], 0
  v_mov_b64 v[182:183], 0
  v_mov_b64 v[184:185], 0
  v_mov_b64 v[186:187], 0
  v_mov_b64_e64 v[188:189], 0
  v_mov_b64 v[190:191], 0
  s_waitcnt lgkmcnt(0)
  v_pk_add_f32 v[128:129], v[128:129], v[32:33]
  v_pk_add_f32 v[130:131], v[130:131], v[34:35]
  v_pk_add_f32 v[132:133], v[132:133], v[36:37]
  v_pk_add_f32 v[134:135], v[134:135], v[38:39]
  v_pk_add_f32 v[136:137], v[136:137], v[32:33]
  v_pk_add_f32 v[138:139], v[138:139], v[34:35]
  v_pk_add_f32 v[140:141], v[140:141], v[36:37]
  v_pk_add_f32 v[142:143], v[142:143], v[38:39]
  v_pk_add_f32 v[144:145], v[144:145], v[32:33]
  v_pk_add_f32 v[146:147], v[146:147], v[34:35]
  v_pk_add_f32 v[148:149], v[148:149], v[36:37]
  v_pk_add_f32 v[150:151], v[150:151], v[38:39]
  v_pk_add_f32 v[152:153], v[152:153], v[32:33]
  v_pk_add_f32 v[154:155], v[154:155], v[34:35]
  v_pk_add_f32 v[156:157], v[156:157], v[36:37]
  v_pk_add_f32 v[158:159], v[158:159], v[38:39]
  s_lshl_b32 s4, s76, 4
  s_add_u32 s4, s4, s78
  s_lshl_b32 s8, s4, Lz1-Lz0+14
  s_xor_b32 s6, s8, 16384
  s_add_u32 s8, s8, 7340032
  s_add_u32 s6, s6, 7340032
  s_add_u32 s7, s6, 4096
  s_add_u32 s9, s8, 4096
  s_lshl_b32 s4, s81, 7
  s_add_u32 s4, s4, s87
  s_add_u32 s4, s4, 12
  s_lshl_b32 s13, s84, 1
  s_xor_b32 s14, s13, 32768
  s_add_u32 s13, s13, s4
  s_add_u32 s14, s14, s4
  s_mov_b32 s22, 12
  s_barrier
  ds_read_b64_tr_b16 v[48:49], v6 offset:0
  ds_read_b64_tr_b16 v[50:51], v6 offset:2048
  ds_read_b128 v[32:35], v4 offset:0
  ds_read_b128 v[36:39], v4 offset:2048
  ds_read_b128 v[40:43], v4 offset:4096
  ds_read_b128 v[44:47], v4 offset:6144
  ds_read_b64_tr_b16 v[52:53], v7 offset:0
  ds_read_b64_tr_b16 v[54:55], v7 offset:2048
  ds_read_b64_tr_b16 v[56:57], v6 offset:8192
  ds_read_b64_tr_b16 v[58:59], v6 offset:10240
  ds_read_b64_tr_b16 v[60:61], v7 offset:8192
  ds_read_b64_tr_b16 v[62:63], v7 offset:10240
  ds_read_b64_tr_b16 v[80:81], v6 offset:4096
  s_nop 0
  s_waitcnt lgkmcnt(4)
  ds_read_b64_tr_b16 v[82:83], v6 offset:6144
  ds_read_b128 v[64:67], v5 offset:0
  ds_read_b128 v[68:71], v5 offset:2048
  ds_read_b128 v[72:75], v5 offset:4096
  ds_read_b128 v[76:79], v5 offset:6144
  ds_read_b64_tr_b16 v[84:85], v7 offset:4096
  ds_read_b64_tr_b16 v[86:87], v7 offset:6144
  ds_read_b64_tr_b16 v[88:89], v6 offset:12288
  ds_read_b64_tr_b16 v[90:91], v6 offset:14336
  ds_read_b64_tr_b16 v[92:93], v7 offset:12288
  ds_read_b64_tr_b16 v[94:95], v7 offset:14336
  s_add_u32 s16, s16, s17
  s_cmp_eq_u32 s16, 65536
  s_cselect_b32 s23, s18, s17
  s_cselect_b32 s16, 0, s16
  v_add_u32 v4, s23, v4
  v_add_u32 v5, s23, v5
  s_add_u32 s19, s19, s20
  s_cmp_eq_u32 s19, 81920
  s_cselect_b32 s23, s21, s20
  s_cselect_b32 s19, 0, s19
  v_add_u32 v6, s23, v6
  v_add_u32 v7, s23, v7
  s_waitcnt lgkmcnt(0)
Lk_26:
  s_barrier
  v_mfma_f32_16x16x32_bf16 v[128:131], v[48:51], v[32:35], v[128:131]
  ds_read_b64_tr_b16 v[112:113], v6 offset:0
  v_mfma_f32_16x16x32_bf16 v[128:131], v[80:83], v[64:67], v[128:131]
  ds_read_b64_tr_b16 v[114:115], v6 offset:2048
  v_mfma_f32_16x16x32_bf16 v[136:139], v[80:83], v[68:71], v[136:139]
  ds_read_b128 v[96:99], v4 offset:0
  v_mfma_f32_16x16x32_bf16 v[136:139], v[48:51], v[36:39], v[136:139]
  ds_read_b128 v[100:103], v4 offset:2048
  v_mfma_f32_16x16x32_bf16 v[144:147], v[48:51], v[40:43], v[144:147]
  ds_read_b128 v[104:107], v4 offset:4096
  v_mfma_f32_16x16x32_bf16 v[144:147], v[80:83], v[72:75], v[144:147]
  ds_read_b128 v[108:111], v4 offset:6144
  v_mfma_f32_16x16x32_bf16 v[152:155], v[80:83], v[76:79], v[152:155]
  ds_read_b64_tr_b16 v[116:117], v7 offset:0
  v_mfma_f32_16x16x32_bf16 v[152:155], v[48:51], v[44:47], v[152:155]
  ds_read_b64_tr_b16 v[118:119], v7 offset:2048
  v_mfma_f32_16x16x32_bf16 v[156:159], v[52:55], v[44:47], v[156:159]
  ds_read_b64_tr_b16 v[120:121], v6 offset:8192
  v_mfma_f32_16x16x32_bf16 v[156:159], v[84:87], v[76:79], v[156:159]
  ds_read_b64_tr_b16 v[122:123], v6 offset:10240
  v_mfma_f32_16x16x32_bf16 v[148:151], v[84:87], v[72:75], v[148:151]
  ds_read_b64_tr_b16 v[124:125], v7 offset:8192
  v_mfma_f32_16x16x32_bf16 v[148:151], v[52:55], v[40:43], v[148:151]
  ds_read_b64_tr_b16 v[126:127], v7 offset:10240
  v_mfma_f32_16x16x32_bf16 v[140:143], v[52:55], v[36:39], v[140:143]
  ds_read_b64_tr_b16 v[208:209], v6 offset:4096
  v_mfma_f32_16x16x32_bf16 v[140:143], v[84:87], v[68:71], v[140:143]
  ds_read_b64_tr_b16 v[210:211], v6 offset:6144
  v_mfma_f32_16x16x32_bf16 v[132:135], v[84:87], v[64:67], v[132:135]
  ds_read_b128 v[192:195], v5 offset:0
  v_mfma_f32_16x16x32_bf16 v[132:135], v[52:55], v[32:35], v[132:135]
  ds_read_b128 v[196:199], v5 offset:2048
  v_mfma_f32_16x16x32_bf16 v[160:163], v[56:59], v[32:35], v[160:163]
  ds_read_b128 v[200:203], v5 offset:4096
  v_mfma_f32_16x16x32_bf16 v[160:163], v[88:91], v[64:67], v[160:163]
  ds_read_b128 v[204:207], v5 offset:6144
  v_mfma_f32_16x16x32_bf16 v[168:171], v[88:91], v[68:71], v[168:171]
  ds_read_b64_tr_b16 v[212:213], v7 offset:4096
  v_mfma_f32_16x16x32_bf16 v[168:171], v[56:59], v[36:39], v[168:171]
  ds_read_b64_tr_b16 v[214:215], v7 offset:6144
  v_mfma_f32_16x16x32_bf16 v[176:179], v[56:59], v[40:43], v[176:179]
  ds_read_b64_tr_b16 v[216:217], v6 offset:12288
  v_mfma_f32_16x16x32_bf16 v[176:179], v[88:91], v[72:75], v[176:179]
  ds_read_b64_tr_b16 v[218:219], v6 offset:14336
  v_mfma_f32_16x16x32_bf16 v[184:187], v[88:91], v[76:79], v[184:187]
  ds_read_b64_tr_b16 v[220:221], v7 offset:12288
  v_mfma_f32_16x16x32_bf16 v[184:187], v[56:59], v[44:47], v[184:187]
  ds_read_b64_tr_b16 v[222:223], v7 offset:14336
  v_mfma_f32_16x16x32_bf16 v[188:191], v[60:63], v[44:47], v[188:191]
  s_add_u32 s16, s16, s17
  s_cmp_eq_u32 s16, 65536
  s_cselect_b32 s23, s18, s17
  v_mfma_f32_16x16x32_bf16 v[188:191], v[92:95], v[76:79], v[188:191]
  s_cselect_b32 s16, 0, s16
  v_add_u32 v4, s23, v4
  v_add_u32_e64 v5, s23, v5
  v_mfma_f32_16x16x32_bf16 v[180:183], v[92:95], v[72:75], v[180:183]
  s_add_u32 s19, s19, s20
  s_cmp_eq_u32 s19, 81920
  s_cselect_b32 s23, s21, s20
  v_mfma_f32_16x16x32_bf16 v[180:183], v[60:63], v[40:43], v[180:183]
  s_cselect_b32 s19, 0, s19
  v_add_u32 v6, s23, v6
  v_add_u32_e64 v7, s23, v7
  v_mfma_f32_16x16x32_bf16 v[172:175], v[60:63], v[36:39], v[172:175]
  v_mfma_f32_16x16x32_bf16 v[172:175], v[92:95], v[68:71], v[172:175]
  v_mfma_f32_16x16x32_bf16 v[164:167], v[92:95], v[64:67], v[164:167]
  s_nop 0
  s_waitcnt lgkmcnt(0)
  v_mfma_f32_16x16x32_bf16 v[164:167], v[60:63], v[32:35], v[164:167]
  s_waitcnt vmcnt(0)
  s_barrier
  v_mfma_f32_16x16x32_bf16 v[128:131], v[112:115], v[96:99], v[128:131]
  ds_read_b64_tr_b16 v[48:49], v6 offset:0
  v_mfma_f32_16x16x32_bf16 v[128:131], v[208:211], v[192:195], v[128:131]
  ds_read_b64_tr_b16 v[50:51], v6 offset:2048
  v_mfma_f32_16x16x32_bf16 v[136:139], v[208:211], v[196:199], v[136:139]
  ds_read_b128 v[32:35], v4 offset:0
  v_mfma_f32_16x16x32_bf16 v[136:139], v[112:115], v[100:103], v[136:139]
  ds_read_b128 v[36:39], v4 offset:2048
  v_mfma_f32_16x16x32_bf16 v[144:147], v[112:115], v[104:107], v[144:147]
  ds_read_b128 v[40:43], v4 offset:4096
  v_mfma_f32_16x16x32_bf16 v[144:147], v[208:211], v[200:203], v[144:147]
  ds_read_b128 v[44:47], v4 offset:6144
  v_mfma_f32_16x16x32_bf16 v[152:155], v[208:211], v[204:207], v[152:155]
  ds_read_b64_tr_b16 v[52:53], v7 offset:0
  v_mfma_f32_16x16x32_bf16 v[152:155], v[112:115], v[108:111], v[152:155]
  ds_read_b64_tr_b16 v[54:55], v7 offset:2048
  v_mfma_f32_16x16x32_bf16 v[156:159], v[116:119], v[108:111], v[156:159]
  ds_read_b64_tr_b16 v[56:57], v6 offset:8192
  v_mfma_f32_16x16x32_bf16 v[156:159], v[212:215], v[204:207], v[156:159]
  ds_read_b64_tr_b16 v[58:59], v6 offset:10240
  v_mfma_f32_16x16x32_bf16 v[148:151], v[212:215], v[200:203], v[148:151]
  ds_read_b64_tr_b16 v[60:61], v7 offset:8192
  v_mfma_f32_16x16x32_bf16 v[148:151], v[116:119], v[104:107], v[148:151]
  ds_read_b64_tr_b16 v[62:63], v7 offset:10240
  v_mfma_f32_16x16x32_bf16 v[140:143], v[116:119], v[100:103], v[140:143]
  ds_read_b64_tr_b16 v[80:81], v6 offset:4096
  v_mfma_f32_16x16x32_bf16 v[140:143], v[212:215], v[196:199], v[140:143]
  ds_read_b64_tr_b16 v[82:83], v6 offset:6144
  v_mfma_f32_16x16x32_bf16 v[132:135], v[212:215], v[192:195], v[132:135]
  ds_read_b128 v[64:67], v5 offset:0
  v_mfma_f32_16x16x32_bf16 v[132:135], v[116:119], v[96:99], v[132:135]
  ds_read_b128 v[68:71], v5 offset:2048
  v_mfma_f32_16x16x32_bf16 v[160:163], v[120:123], v[96:99], v[160:163]
  ds_read_b128 v[72:75], v5 offset:4096
  v_mfma_f32_16x16x32_bf16 v[160:163], v[216:219], v[192:195], v[160:163]
  ds_read_b128 v[76:79], v5 offset:6144
  v_mfma_f32_16x16x32_bf16 v[168:171], v[216:219], v[196:199], v[168:171]
  ds_read_b64_tr_b16 v[84:85], v7 offset:4096
  v_mfma_f32_16x16x32_bf16 v[168:171], v[120:123], v[100:103], v[168:171]
  ds_read_b64_tr_b16 v[86:87], v7 offset:6144
  v_mfma_f32_16x16x32_bf16 v[176:179], v[120:123], v[104:107], v[176:179]
  ds_read_b64_tr_b16 v[88:89], v6 offset:12288
  v_mfma_f32_16x16x32_bf16 v[176:179], v[216:219], v[200:203], v[176:179]
  ds_read_b64_tr_b16 v[90:91], v6 offset:14336
  v_mfma_f32_16x16x32_bf16 v[184:187], v[216:219], v[204:207], v[184:187]
  ds_read_b64_tr_b16 v[92:93], v7 offset:12288
  v_mfma_f32_16x16x32_bf16 v[184:187], v[120:123], v[108:111], v[184:187]
  ds_read_b64_tr_b16 v[94:95], v7 offset:14336
  v_mfma_f32_16x16x32_bf16 v[188:191], v[124:127], v[108:111], v[188:191]
  s_add_u32 s16, s16, s17
  s_cmp_eq_u32 s16, 65536
  s_cselect_b32 s23, s18, s17
  v_mfma_f32_16x16x32_bf16 v[188:191], v[220:223], v[204:207], v[188:191]
  s_cselect_b32 s16, 0, s16
  v_add_u32 v4, s23, v4
  v_add_u32_e64 v5, s23, v5
  v_mfma_f32_16x16x32_bf16 v[180:183], v[220:223], v[200:203], v[180:183]
  s_add_u32 s19, s19, s20
  s_cmp_eq_u32 s19, 81920
  s_cselect_b32 s23, s21, s20
  v_mfma_f32_16x16x32_bf16 v[180:183], v[124:127], v[104:107], v[180:183]
  s_cselect_b32 s19, 0, s19
  v_add_u32 v6, s23, v6
  v_add_u32_e64 v7, s23, v7
  v_mfma_f32_16x16x32_bf16 v[172:175], v[124:127], v[100:103], v[172:175]
  s_sub_u32 s22, s22, 1
  s_cmp_lg_u32 s22, 0
  v_mfma_f32_16x16x32_bf16 v[172:175], v[220:223], v[196:199], v[172:175]
  v_mfma_f32_16x16x32_bf16 v[164:167], v[220:223], v[192:195], v[164:167]
  s_nop 0
  s_waitcnt lgkmcnt(0)
  v_mfma_f32_16x16x32_bf16 v[164:167], v[124:127], v[96:99], v[164:167]
  s_cbranch_scc1 Lk_26
  s_barrier
  v_mfma_f32_16x16x32_bf16 v[128:131], v[48:51], v[32:35], v[128:131]
  ds_read_b64_tr_b16 v[112:113], v6 offset:0
  v_mfma_f32_16x16x32_bf16 v[128:131], v[80:83], v[64:67], v[128:131]
  ds_read_b64_tr_b16 v[114:115], v6 offset:2048
  v_mfma_f32_16x16x32_bf16 v[136:139], v[80:83], v[68:71], v[136:139]
  ds_read_b128 v[96:99], v4 offset:0
  v_mfma_f32_16x16x32_bf16 v[136:139], v[48:51], v[36:39], v[136:139]
  ds_read_b128 v[100:103], v4 offset:2048
  v_mfma_f32_16x16x32_bf16 v[144:147], v[48:51], v[40:43], v[144:147]
  ds_read_b128 v[104:107], v4 offset:4096
  v_mfma_f32_16x16x32_bf16 v[144:147], v[80:83], v[72:75], v[144:147]
  ds_read_b128 v[108:111], v4 offset:6144
  v_mfma_f32_16x16x32_bf16 v[152:155], v[80:83], v[76:79], v[152:155]
  ds_read_b64_tr_b16 v[116:117], v7 offset:0
  v_mfma_f32_16x16x32_bf16 v[152:155], v[48:51], v[44:47], v[152:155]
  ds_read_b64_tr_b16 v[118:119], v7 offset:2048
  v_mfma_f32_16x16x32_bf16 v[156:159], v[52:55], v[44:47], v[156:159]
  ds_read_b64_tr_b16 v[120:121], v6 offset:8192
  v_mfma_f32_16x16x32_bf16 v[156:159], v[84:87], v[76:79], v[156:159]
  ds_read_b64_tr_b16 v[122:123], v6 offset:10240
  v_mfma_f32_16x16x32_bf16 v[148:151], v[84:87], v[72:75], v[148:151]
  ds_read_b64_tr_b16 v[124:125], v7 offset:8192
  v_mfma_f32_16x16x32_bf16 v[148:151], v[52:55], v[40:43], v[148:151]
  ds_read_b64_tr_b16 v[126:127], v7 offset:10240
  v_mfma_f32_16x16x32_bf16 v[140:143], v[52:55], v[36:39], v[140:143]
  ds_read_b64_tr_b16 v[208:209], v6 offset:4096
  v_mfma_f32_16x16x32_bf16 v[140:143], v[84:87], v[68:71], v[140:143]
  ds_read_b64_tr_b16 v[210:211], v6 offset:6144
  v_mfma_f32_16x16x32_bf16 v[132:135], v[84:87], v[64:67], v[132:135]
  ds_read_b128 v[192:195], v5 offset:0
  v_mfma_f32_16x16x32_bf16 v[132:135], v[52:55], v[32:35], v[132:135]
  ds_read_b128 v[196:199], v5 offset:2048
  v_mfma_f32_16x16x32_bf16 v[160:163], v[56:59], v[32:35], v[160:163]
  ds_read_b128 v[200:203], v5 offset:4096
  v_mfma_f32_16x16x32_bf16 v[160:163], v[88:91], v[64:67], v[160:163]
  ds_read_b128 v[204:207], v5 offset:6144
  v_mfma_f32_16x16x32_bf16 v[168:171], v[88:91], v[68:71], v[168:171]
  ds_read_b64_tr_b16 v[212:213], v7 offset:4096
  v_mfma_f32_16x16x32_bf16 v[168:171], v[56:59], v[36:39], v[168:171]
  ds_read_b64_tr_b16 v[214:215], v7 offset:6144
  v_mfma_f32_16x16x32_bf16 v[176:179], v[56:59], v[40:43], v[176:179]
  ds_read_b64_tr_b16 v[216:217], v6 offset:12288
  v_mfma_f32_16x16x32_bf16 v[176:179], v[88:91], v[72:75], v[176:179]
  ds_read_b64_tr_b16 v[218:219], v6 offset:14336
  v_mfma_f32_16x16x32_bf16 v[184:187], v[88:91], v[76:79], v[184:187]
  ds_read_b64_tr_b16 v[220:221], v7 offset:12288
  v_mfma_f32_16x16x32_bf16 v[184:187], v[56:59], v[44:47], v[184:187]
  ds_read_b64_tr_b16 v[222:223], v7 offset:14336
  v_mfma_f32_16x16x32_bf16 v[188:191], v[60:63], v[44:47], v[188:191]
  s_add_u32 s16, s16, s17
  s_cmp_eq_u32 s16, 65536
  s_cselect_b32 s23, s18, s17
  v_mfma_f32_16x16x32_bf16 v[188:191], v[92:95], v[76:79], v[188:191]
  s_cselect_b32 s16, 0, s16
  v_add_u32 v4, s23, v4
  v_add_u32_e64 v5, s23, v5
  v_mfma_f32_16x16x32_bf16 v[180:183], v[92:95], v[72:75], v[180:183]
  s_add_u32 s19, s19, s20
  s_cmp_eq_u32 s19, 81920
  s_cselect_b32 s23, s21, s20
  v_mfma_f32_16x16x32_bf16 v[180:183], v[60:63], v[40:43], v[180:183]
  s_cselect_b32 s19, 0, s19
  v_add_u32 v6, s23, v6
  v_add_u32_e64 v7, s23, v7
  v_mfma_f32_16x16x32_bf16 v[172:175], v[60:63], v[36:39], v[172:175]
  v_mfma_f32_16x16x32_bf16 v[172:175], v[92:95], v[68:71], v[172:175]
  v_mfma_f32_16x16x32_bf16 v[164:167], v[92:95], v[64:67], v[164:167]
  s_waitcnt lgkmcnt(0)
  v_mfma_f32_16x16x32_bf16 v[164:167], v[60:63], v[32:35], v[164:167]
  s_barrier
  v_mfma_f32_16x16x32_bf16 v[160:163], v[120:123], v[96:99], v[160:163]
  ds_read_b64_tr_b16 v[48:49], v6 offset:0
  ds_read_b64_tr_b16 v[50:51], v6 offset:2048
  v_mfma_f32_16x16x32_bf16 v[160:163], v[216:219], v[192:195], v[160:163]
  ds_read_b128 v[32:35], v4 offset:0
  ds_read_b128 v[36:39], v4 offset:2048
  v_mfma_f32_16x16x32_bf16 v[164:167], v[220:223], v[192:195], v[164:167]
  ds_read_b128 v[40:43], v4 offset:4096
  ds_read_b128 v[44:47], v4 offset:6144
  v_mfma_f32_16x16x32_bf16 v[164:167], v[124:127], v[96:99], v[164:167]
  ds_read_b64_tr_b16 v[52:53], v7 offset:0
  ds_read_b64_tr_b16 v[54:55], v7 offset:2048
  v_mfma_f32_16x16x32_bf16 v[172:175], v[124:127], v[100:103], v[172:175]
  ds_read_b64_tr_b16 v[80:81], v6 offset:4096
  ds_read_b64_tr_b16 v[82:83], v6 offset:6144
  v_mfma_f32_16x16x32_bf16 v[172:175], v[220:223], v[196:199], v[172:175]
  v_cvt_pk_bf16_f32 v160, v160, v161
  v_cvt_pk_bf16_f32 v161, v162, v163
  v_mfma_f32_16x16x32_bf16 v[168:171], v[216:219], v[196:199], v[168:171]
  v_cvt_pk_bf16_f32 v162, v164, v165
  v_cvt_pk_bf16_f32 v163, v166, v167
  v_mfma_f32_16x16x32_bf16 v[168:171], v[120:123], v[100:103], v[168:171]
  buffer_store_dwordx4 v[160:163], v0, s[40:43], s6 offen offset:0 sc0 sc1
  v_mfma_f32_16x16x32_bf16 v[176:179], v[120:123], v[104:107], v[176:179]
  ds_read_b128 v[64:67], v5 offset:0
  v_mfma_f32_16x16x32_bf16 v[176:179], v[216:219], v[200:203], v[176:179]
  s_nop 0
  s_nop 3
  v_cvt_pk_bf16_f32 v164, v168, v169
  v_cvt_pk_bf16_f32 v165, v170, v171
  v_mfma_f32_16x16x32_bf16 v[180:183], v[220:223], v[200:203], v[180:183]
  v_cvt_pk_bf16_f32 v166, v172, v173
  v_cvt_pk_bf16_f32 v167, v174, v175
  v_mfma_f32_16x16x32_bf16 v[180:183], v[124:127], v[104:107], v[180:183]
  buffer_store_dwordx4 v[164:167], v0, s[40:43], s6 offen offset:2048 sc0 sc1
  ds_read_b128 v[68:71], v5 offset:2048
  v_mfma_f32_16x16x32_bf16 v[188:191], v[124:127], v[108:111], v[188:191]
  ds_read_b128 v[72:75], v5 offset:4096
  v_mfma_f32_16x16x32_bf16 v[188:191], v[220:223], v[204:207], v[188:191]
  v_cvt_pk_bf16_f32 v168, v176, v177
  v_cvt_pk_bf16_f32 v169, v178, v179
  v_mfma_f32_16x16x32_bf16 v[184:187], v[216:219], v[204:207], v[184:187]
  v_cvt_pk_bf16_f32 v170, v180, v181
  v_cvt_pk_bf16_f32 v171, v182, v183
  v_mfma_f32_16x16x32_bf16 v[184:187], v[120:123], v[108:111], v[184:187]
  buffer_store_dwordx4 v[168:171], v0, s[40:43], s7 offen offset:0 sc0 sc1
  ds_read_b128 v[76:79], v5 offset:6144
  v_mfma_f32_16x16x32_bf16 v[128:131], v[112:115], v[96:99], v[128:131]
  ds_read_b64_tr_b16 v[84:85], v7 offset:4096
  v_mfma_f32_16x16x32_bf16 v[128:131], v[208:211], v[192:195], v[128:131]
  s_nop 0
  s_nop 2
  v_cvt_pk_bf16_f32 v172, v184, v185
  v_cvt_pk_bf16_f32 v173, v186, v187
  v_mfma_f32_16x16x32_bf16 v[136:139], v[208:211], v[196:199], v[136:139]
  v_cvt_pk_bf16_f32 v174, v188, v189
  v_cvt_pk_bf16_f32 v175, v190, v191
  v_mfma_f32_16x16x32_bf16 v[136:139], v[112:115], v[100:103], v[136:139]
  buffer_store_dwordx4 v[172:175], v0, s[40:43], s7 offen offset:2048 sc0 sc1
  ds_read_b64_tr_b16 v[86:87], v7 offset:6144
  v_mfma_f32_16x16x32_bf16 v[144:147], v[112:115], v[104:107], v[144:147]
  s_add_u32 s16, s16, s17
  s_cmp_eq_u32 s16, 65536
  s_cselect_b32 s23, s18, s17
  v_mfma_f32_16x16x32_bf16 v[144:147], v[208:211], v[200:203], v[144:147]
  s_cselect_b32 s16, 0, s16
  v_add_u32 v4, s23, v4
  v_add_u32_e64 v5, s23, v5
  v_mfma_f32_16x16x32_bf16 v[152:155], v[208:211], v[204:207], v[152:155]
  s_add_u32 s19, s19, s20
  s_cmp_eq_u32 s19, 81920
  s_cselect_b32 s23, s21, s20
  v_mfma_f32_16x16x32_bf16 v[152:155], v[112:115], v[108:111], v[152:155]
  s_cselect_b32 s19, 0, s19
  v_add_u32 v6, s23, v6
  v_add_u32_e64 v7, s23, v7
  v_mfma_f32_16x16x32_bf16 v[156:159], v[116:119], v[108:111], v[156:159]
  v_mfma_f32_16x16x32_bf16 v[156:159], v[212:215], v[204:207], v[156:159]
  v_mfma_f32_16x16x32_bf16 v[148:151], v[212:215], v[200:203], v[148:151]
  v_mfma_f32_16x16x32_bf16 v[148:151], v[116:119], v[104:107], v[148:151]
  v_mfma_f32_16x16x32_bf16 v[140:143], v[116:119], v[100:103], v[140:143]
  v_mfma_f32_16x16x32_bf16 v[140:143], v[212:215], v[196:199], v[140:143]
  v_mfma_f32_16x16x32_bf16 v[132:135], v[212:215], v[192:195], v[132:135]
  s_waitcnt lgkmcnt(0)
  v_mfma_f32_16x16x32_bf16 v[132:135], v[116:119], v[96:99], v[132:135]
  s_barrier
  v_mfma_f32_16x16x32_bf16 v[128:131], v[48:51], v[32:35], v[128:131]
  ds_read_b64_tr_b16 v[112:113], v6 offset:0
  ds_read_b64_tr_b16 v[114:115], v6 offset:2048
  v_mfma_f32_16x16x32_bf16 v[128:131], v[80:83], v[64:67], v[128:131]
  ds_read_b128 v[96:99], v4 offset:0
  ds_read_b128 v[100:103], v4 offset:2048
  v_mfma_f32_16x16x32_bf16 v[136:139], v[80:83], v[68:71], v[136:139]
  ds_read_b128 v[104:107], v4 offset:4096
  ds_read_b128 v[108:111], v4 offset:6144
  v_mfma_f32_16x16x32_bf16 v[136:139], v[48:51], v[36:39], v[136:139]
  ds_read_b64_tr_b16 v[116:117], v7 offset:0
  ds_read_b64_tr_b16 v[118:119], v7 offset:2048
  v_mfma_f32_16x16x32_bf16 v[144:147], v[48:51], v[40:43], v[144:147]
  ds_read_b64_tr_b16 v[208:209], v6 offset:4096
  ds_read_b64_tr_b16 v[210:211], v6 offset:6144
  v_mfma_f32_16x16x32_bf16 v[144:147], v[80:83], v[72:75], v[144:147]
  ds_read_b128 v[192:195], v5 offset:0
  ds_read_b128 v[196:199], v5 offset:2048
  v_mfma_f32_16x16x32_bf16 v[152:155], v[80:83], v[76:79], v[152:155]
  ds_read_b128 v[200:203], v5 offset:4096
  ds_read_b128 v[204:207], v5 offset:6144
  v_mfma_f32_16x16x32_bf16 v[152:155], v[48:51], v[44:47], v[152:155]
  ds_read_b64_tr_b16 v[212:213], v7 offset:4096
  ds_read_b64_tr_b16 v[214:215], v7 offset:6144
  v_mfma_f32_16x16x32_bf16 v[156:159], v[52:55], v[44:47], v[156:159]
  s_add_u32 s16, s16, s17
  s_cmp_eq_u32 s16, 65536
  s_cselect_b32 s23, s18, s17
  v_mfma_f32_16x16x32_bf16 v[156:159], v[84:87], v[76:79], v[156:159]
  s_cselect_b32 s16, 0, s16
  v_add_u32 v4, s23, v4
  v_add_u32_e64 v5, s23, v5
  v_mfma_f32_16x16x32_bf16 v[148:151], v[84:87], v[72:75], v[148:151]
  s_add_u32 s19, s19, s20
  s_cmp_eq_u32 s19, 81920
  s_cselect_b32 s23, s21, s20
  v_mfma_f32_16x16x32_bf16 v[148:151], v[52:55], v[40:43], v[148:151]
  s_cselect_b32 s19, 0, s19
  v_add_u32 v6, s23, v6
  v_add_u32_e64 v7, s23, v7
  v_mfma_f32_16x16x32_bf16 v[140:143], v[52:55], v[36:39], v[140:143]
  buffer_load_dwordx4 v[176:179], v0, s[40:43], s8 offen offset:0 sc0 sc1
  buffer_load_dwordx4 v[180:183], v0, s[40:43], s8 offen offset:2048 sc0 sc1
  buffer_load_dwordx4 v[184:187], v0, s[40:43], s9 offen offset:0 sc0 sc1
  v_mfma_f32_16x16x32_bf16 v[140:143], v[84:87], v[68:71], v[140:143]
  buffer_load_dwordx4 v[188:191], v0, s[40:43], s9 offen offset:2048 sc0 sc1
  v_mfma_f32_16x16x32_bf16 v[132:135], v[84:87], v[64:67], v[132:135]
  s_waitcnt lgkmcnt(0)
  v_mfma_f32_16x16x32_bf16 v[132:135], v[52:55], v[32:35], v[132:135]
  s_barrier
  v_mfma_f32_16x16x32_bf16 v[128:131], v[112:115], v[96:99], v[128:131]
  ds_read_b64_tr_b16 v[48:49], v6 offset:0
  ds_read_b64_tr_b16 v[50:51], v6 offset:2048
  v_mfma_f32_16x16x32_bf16 v[128:131], v[208:211], v[192:195], v[128:131]
  ds_read_b128 v[32:35], v4 offset:0
  ds_read_b128 v[36:39], v4 offset:2048
  v_mfma_f32_16x16x32_bf16 v[136:139], v[208:211], v[196:199], v[136:139]
  ds_read_b128 v[40:43], v4 offset:4096
  ds_read_b128 v[44:47], v4 offset:6144
  v_mfma_f32_16x16x32_bf16 v[136:139], v[112:115], v[100:103], v[136:139]
  ds_read_b64_tr_b16 v[52:53], v7 offset:0
  ds_read_b64_tr_b16 v[54:55], v7 offset:2048
  v_mfma_f32_16x16x32_bf16 v[144:147], v[112:115], v[104:107], v[144:147]
  ds_read_b64_tr_b16 v[80:81], v6 offset:4096
  ds_read_b64_tr_b16 v[82:83], v6 offset:6144
  v_mfma_f32_16x16x32_bf16 v[144:147], v[208:211], v[200:203], v[144:147]
  ds_read_b128 v[64:67], v5 offset:0
  ds_read_b128 v[68:71], v5 offset:2048
  v_mfma_f32_16x16x32_bf16 v[152:155], v[208:211], v[204:207], v[152:155]
  ds_read_b128 v[72:75], v5 offset:4096
  ds_read_b128 v[76:79], v5 offset:6144
  v_mfma_f32_16x16x32_bf16 v[152:155], v[112:115], v[108:111], v[152:155]
  ds_read_b64_tr_b16 v[84:85], v7 offset:4096
  ds_read_b64_tr_b16 v[86:87], v7 offset:6144
  v_mfma_f32_16x16x32_bf16 v[156:159], v[116:119], v[108:111], v[156:159]
  s_nop 0
  s_add_u32 s16, s16, s17
  s_cmp_eq_u32 s16, 65536
  v_mfma_f32_16x16x32_bf16 v[156:159], v[212:215], v[204:207], v[156:159]
  s_cselect_b32 s23, s18, s17
  s_cselect_b32 s16, 0, s16
  v_mfma_f32_16x16x32_bf16 v[148:151], v[212:215], v[200:203], v[148:151]
  v_add_u32_e64 v4, s23, v4
  v_add_u32 v5, s23, v5
  v_mfma_f32_16x16x32_bf16 v[148:151], v[116:119], v[104:107], v[148:151]
  s_add_u32 s19, s19, s20
  s_cmp_eq_u32 s19, 81920
  v_mfma_f32_16x16x32_bf16 v[140:143], v[116:119], v[100:103], v[140:143]
  s_cselect_b32 s23, s21, s20
  s_cselect_b32 s19, 0, s19
  v_mfma_f32_16x16x32_bf16 v[140:143], v[212:215], v[196:199], v[140:143]
  v_add_u32 v6, s23, v6
  v_add_u32 v7, s23, v7
  v_mfma_f32_16x16x32_bf16 v[132:135], v[212:215], v[192:195], v[132:135]
  s_waitcnt lgkmcnt(0)
  v_mfma_f32_16x16x32_bf16 v[132:135], v[116:119], v[96:99], v[132:135]
  s_barrier
  v_mfma_f32_16x16x32_bf16 v[128:131], v[48:51], v[32:35], v[128:131]
  ds_read_b64_tr_b16 v[112:113], v6 offset:0
  ds_read_b64_tr_b16 v[114:115], v6 offset:2048
  v_mfma_f32_16x16x32_bf16 v[128:131], v[80:83], v[64:67], v[128:131]
  ds_read_b128 v[96:99], v4 offset:0
  ds_read_b128 v[100:103], v4 offset:2048
  v_mfma_f32_16x16x32_bf16 v[136:139], v[80:83], v[68:71], v[136:139]
  ds_read_b128 v[104:107], v4 offset:4096
  ds_read_b128 v[108:111], v4 offset:6144
  v_mfma_f32_16x16x32_bf16 v[136:139], v[48:51], v[36:39], v[136:139]
  ds_read_b64_tr_b16 v[116:117], v7 offset:0
  ds_read_b64_tr_b16 v[118:119], v7 offset:2048
  v_mfma_f32_16x16x32_bf16 v[144:147], v[48:51], v[40:43], v[144:147]
  ds_read_b64_tr_b16 v[208:209], v6 offset:4096
  ds_read_b64_tr_b16 v[210:211], v6 offset:6144
  v_mfma_f32_16x16x32_bf16 v[144:147], v[80:83], v[72:75], v[144:147]
  ds_read_b128 v[192:195], v5 offset:0
  ds_read_b128 v[196:199], v5 offset:2048
  v_mfma_f32_16x16x32_bf16 v[152:155], v[80:83], v[76:79], v[152:155]
  ds_read_b128 v[200:203], v5 offset:4096
  ds_read_b128 v[204:207], v5 offset:6144
  v_mfma_f32_16x16x32_bf16 v[152:155], v[48:51], v[44:47], v[152:155]
  ds_read_b64_tr_b16 v[212:213], v7 offset:4096
  ds_read_b64_tr_b16 v[214:215], v7 offset:6144
  v_mfma_f32_16x16x32_bf16 v[156:159], v[52:55], v[44:47], v[156:159]
  v_mfma_f32_16x16x32_bf16 v[156:159], v[84:87], v[76:79], v[156:159]
  v_mfma_f32_16x16x32_bf16 v[148:151], v[84:87], v[72:75], v[148:151]
  v_mfma_f32_16x16x32_bf16 v[148:151], v[52:55], v[40:43], v[148:151]
  v_mfma_f32_16x16x32_bf16 v[140:143], v[52:55], v[36:39], v[140:143]
  v_mfma_f32_16x16x32_bf16 v[140:143], v[84:87], v[68:71], v[140:143]
  v_mfma_f32_16x16x32_bf16 v[132:135], v[84:87], v[64:67], v[132:135]
  s_waitcnt lgkmcnt(0)
  v_mfma_f32_16x16x32_bf16 v[132:135], v[52:55], v[32:35], v[132:135]
  s_barrier
  v_mfma_f32_16x16x32_bf16 v[128:131], v[112:115], v[96:99], v[128:131]
  v_mfma_f32_16x16x32_bf16 v[128:131], v[208:211], v[192:195], v[128:131]
  v_mfma_f32_16x16x32_bf16 v[136:139], v[208:211], v[196:199], v[136:139]
  v_mfma_f32_16x16x32_bf16 v[136:139], v[112:115], v[100:103], v[136:139]
  v_mfma_f32_16x16x32_bf16 v[144:147], v[112:115], v[104:107], v[144:147]
  v_mfma_f32_16x16x32_bf16 v[144:147], v[208:211], v[200:203], v[144:147]
  v_mfma_f32_16x16x32_bf16 v[152:155], v[208:211], v[204:207], v[152:155]
  v_mfma_f32_16x16x32_bf16 v[152:155], v[112:115], v[108:111], v[152:155]
  v_mfma_f32_16x16x32_bf16 v[156:159], v[116:119], v[108:111], v[156:159]
  v_mfma_f32_16x16x32_bf16 v[156:159], v[212:215], v[204:207], v[156:159]
  v_mfma_f32_16x16x32_bf16 v[148:151], v[212:215], v[200:203], v[148:151]
  v_mfma_f32_16x16x32_bf16 v[148:151], v[116:119], v[104:107], v[148:151]
  v_mfma_f32_16x16x32_bf16 v[140:143], v[116:119], v[100:103], v[140:143]
  v_mfma_f32_16x16x32_bf16 v[140:143], v[212:215], v[196:199], v[140:143]
  v_mfma_f32_16x16x32_bf16 v[132:135], v[212:215], v[192:195], v[132:135]
  s_nop 0
  s_waitcnt lgkmcnt(0)
  v_mfma_f32_16x16x32_bf16 v[132:135], v[116:119], v[96:99], v[132:135]
  s_mov_b32 s89, 200000
  v_mov_b32_e64 v32, 0
  s_waitcnt vmcnt(0)
  s_mov_b64 exec, 1
  buffer_store_dword v27, off, s[40:43], s14 sc0 sc1
  s_mov_b64 exec, -1
Lx_28:
  v_cmpx_ne_u64 vcc, v[176:177], v[240:241]
  v_cmpx_ne_u64 vcc, v[178:179], v[242:243]
  v_cmpx_ne_u64 vcc, v[180:181], v[244:245]
  v_cmpx_ne_u64 vcc, v[182:183], v[246:247]
  v_cmpx_ne_u64 vcc, v[184:185], v[248:249]
  v_cmpx_ne_u64 vcc, v[186:187], v[250:251]
  v_cmpx_ne_u64 vcc, v[188:189], v[252:253]
  v_cmpx_ne_u64_e64 vcc, v[190:191], v[254:255]
  s_cmp_eq_u64 exec, -1
  s_cbranch_scc0 Lx_27
Lx_29:
  s_mov_b32 s4, 0xffff0000
  v_lshlrev_b32 v32, 16, v176
  v_and_b32 v33, s4, v176
  v_lshlrev_b32 v34, 16, v177
  v_and_b32 v35, s4, v177
  v_lshlrev_b32 v36, 16, v178
  v_and_b32 v37, s4, v178
  v_lshlrev_b32 v38, 16, v179
  v_and_b32 v39, s4, v179
  v_pk_add_f32 v[128:129], v[128:129], v[32:33]
  v_pk_add_f32 v[130:131], v[130:131], v[34:35]
  v_pk_add_f32 v[132:133], v[132:133], v[36:37]
  v_pk_add_f32 v[134:135], v[134:135], v[38:39]
  v_lshlrev_b32 v32, 16, v180
  v_and_b32 v33, s4, v180
  v_lshlrev_b32 v34, 16, v181
  v_and_b32 v35, s4, v181
  v_lshlrev_b32 v36, 16, v182
  v_and_b32 v37, s4, v182
  v_lshlrev_b32 v38, 16, v183
  v_and_b32 v39, s4, v183
  v_pk_add_f32 v[136:137], v[136:137], v[32:33]
  v_pk_add_f32 v[138:139], v[138:139], v[34:35]
  v_pk_add_f32 v[140:141], v[140:141], v[36:37]
  v_pk_add_f32 v[142:143], v[142:143], v[38:39]
  v_lshlrev_b32 v32, 16, v184
  v_and_b32 v33, s4, v184
  v_lshlrev_b32 v34, 16, v185
  v_and_b32 v35, s4, v185
  v_lshlrev_b32 v36, 16, v186
  v_and_b32 v37, s4, v186
  v_lshlrev_b32 v38, 16, v187
  v_and_b32 v39, s4, v187
  v_pk_add_f32 v[144:145], v[144:145], v[32:33]
  v_pk_add_f32 v[146:147], v[146:147], v[34:35]
  v_pk_add_f32 v[148:149], v[148:149], v[36:37]
  v_pk_add_f32 v[150:151], v[150:151], v[38:39]
  v_lshlrev_b32 v32, 16, v188
  v_and_b32 v33, s4, v188
  v_lshlrev_b32 v34, 16, v189
  v_and_b32 v35, s4, v189
  v_lshlrev_b32 v36, 16, v190
  v_and_b32 v37, s4, v190
  v_lshlrev_b32 v38, 16, v191
  v_and_b32 v39, s4, v191
  v_pk_add_f32 v[152:153], v[152:153], v[32:33]
  v_pk_add_f32 v[154:155], v[154:155], v[34:35]
  v_pk_add_f32 v[156:157], v[156:157], v[36:37]
  v_pk_add_f32 v[158:159], v[158:159], v[38:39]
  v_cvt_pk_bf16_f32 v240, v128, v129
  v_cvt_pk_bf16_f32 v241, v130, v131
  v_cvt_pk_bf16_f32 v242, v132, v133
  v_cvt_pk_bf16_f32 v243, v134, v135
  v_cvt_pk_bf16_f32 v244, v136, v137
  v_cvt_pk_bf16_f32 v245, v138, v139
  v_cvt_pk_bf16_f32 v246, v140, v141
  v_cvt_pk_bf16_f32 v247, v142, v143
  v_cvt_pk_bf16_f32 v248, v144, v145
  v_cvt_pk_bf16_f32 v249, v146, v147
  v_cvt_pk_bf16_f32 v250, v148, v149
  v_cvt_pk_bf16_f32 v251, v150, v151
  v_cvt_pk_bf16_f32 v252, v152, v153
  v_cvt_pk_bf16_f32 v253, v154, v155
  v_cvt_pk_bf16_f32 v254, v156, v157
  v_cvt_pk_bf16_f32 v255, v158, v159
  s_cmp_lg_u32 s82, 0
  s_cbranch_scc1 L_cfinal
  s_lshl_b32 s4, s76, 4
  s_add_u32 s4, s4, s78
  s_lshl_b32 s6, s4, Lz1-Lz0+14
  s_add_u32 s6, s6, 35651584
  s_add_u32 s7, s6, 4096
  s_lshl_b32 s5, s78, Lz1-Lz0+1
  buffer_store_dwordx4 v[240:243], v0, s[40:43], s6 offen offset:0 sc0 sc1
  buffer_store_dwordx4 v[244:247], v0, s[40:43], s6 offen offset:2048 sc0 sc1
  buffer_store_dwordx4 v[248:251], v0, s[40:43], s7 offen offset:0 sc0 sc1
  buffer_store_dwordx4 v[252:255], v0, s[40:43], s7 offen offset:2048 sc0 sc1
  v_mov_b32 v40, 0x3f803f80
  v_dot2_f32_bf16 v32, v240, v40, 0
  v_dot2_f32_bf16 v36, v240, v240, 0
  v_dot2_f32_bf16 v33, v244, v40, 0
  v_dot2_f32_bf16 v37, v244, v244, 0
  v_dot2_f32_bf16 v34, v248, v40, 0
  v_dot2_f32_bf16 v38, v248, v248, 0
  v_dot2_f32_bf16 v35, v252, v40, 0
  v_dot2_f32_bf16 v39, v252, v252, 0
  v_dot2_f32_bf16 v32, v241, v40, v32
  v_dot2_f32_bf16 v36, v241, v241, v36
  v_dot2_f32_bf16 v33, v245, v40, v33
  v_dot2_f32_bf16 v37, v245, v245, v37
  v_dot2_f32_bf16 v34, v249, v40, v34
  v_dot2_f32_bf16 v38, v249, v249, v38
  v_dot2_f32_bf16 v35, v253, v40, v35
  v_dot2_f32_bf16 v39, v253, v253, v39
  v_dot2_f32_bf16 v32, v242, v40, v32
  v_dot2_f32_bf16 v36, v242, v242, v36
  v_dot2_f32_bf16 v33, v246, v40, v33
  v_dot2_f32_bf16 v37, v246, v246, v37
  v_dot2_f32_bf16 v34, v250, v40, v34
  v_dot2_f32_bf16 v38, v250, v250, v38
  v_dot2_f32_bf16 v35, v254, v40, v35
  v_dot2_f32_bf16 v39, v254, v254, v39
  v_dot2_f32_bf16 v32, v243, v40, v32
  v_dot2_f32_bf16 v36, v243, v243, v36
  v_dot2_f32_bf16 v33, v247, v40, v33
  v_dot2_f32_bf16 v37, v247, v247, v37
  v_dot2_f32_bf16 v34, v251, v40, v34
  v_dot2_f32_bf16 v38, v251, v251, v38
  v_dot2_f32_bf16 v35, v255, v40, v35
  v_dot2_f32_bf16 v39, v255, v255, v39
  s_lshl_b32 s6, s76, Lz1-Lz0+9
  s_lshl_b32 s7, s85, 8
  s_add_u32 s6, s6, s7
  s_add_u32 s6, s6, s5
  s_add_u32 s6, s6, s86
  s_lshl_b32 s6, s6, 6
  s_add_u32 s6, s6, s83
  s_add_u32 s6, s6, 36700160
  v_permlane32_swap_b32 v32, v34
  v_permlane32_swap_b32 v33, v35
  v_permlane32_swap_b32 v36, v38
  v_permlane32_swap_b32 v37, v39
  v_add_f32 v32, v32, v34
  v_add_f32 v33, v33, v35
  v_add_f32 v36, v36, v38
  v_add_f32 v37, v37, v39
  v_permlane16_swap_b32 v32, v33
  s_nop 0
  v_permlane16_swap_b32 v36, v37
  v_add_f32 v42, v32, v33
  v_add_f32_e64 v43, v36, v37
  buffer_store_dwordx2 v[42:43], v30, s[40:43], s6 offen sc0 sc1
  s_add_u32 s5, s87, 16
  s_sub_u32 s4, s78, s77
  s_lshl_b32 s4, s4, 7
  s_add_u32 s5, s5, s4
  s_waitcnt vmcnt(0)
  s_mov_b64 exec, 1
  ds_add_rtn_u32 v2, v28, v27 offset:0
  s_waitcnt lgkmcnt(0)
  v_readfirstlane_b32 s4, v2
  s_and_b32 s4, s4, Lz1-Lz0+3
  s_cmp_lg_u32 s4, 3
  s_cbranch_scc1 Ls_30
  s_mov_b32 exec_lo, 0xffff
  buffer_store_dword v27, v24, s[40:43], s5 offen sc0 sc1
Ls_30:
  s_nop 0
  s_mov_b64 exec, -1
  ds_write_b128 v0, v[240:243] offset:0
  ds_write_b128 v0, v[244:247] offset:2048
  ds_write_b128 v0, v[248:251] offset:4096
  ds_write_b128 v0, v[252:255] offset:6144
  s_mov_b32 s82, 1
  s_add_u32 s83, s83, 0
  s_add_u32 s87, s87, 32
  s_branch L_clayer
L_cfinal:
  s_nop 1
  v_permlane16_swap_b32 v240, v242
  v_permlane16_swap_b32 v241, v243
  v_permlane16_swap_b32 v244, v246
  v_permlane16_swap_b32 v245, v247
  v_permlane16_swap_b32 v248, v250
  v_permlane16_swap_b32 v249, v251
  v_permlane16_swap_b32 v252, v254
  v_permlane16_swap_b32 v253, v255
  v_and_b32 v2, 15, v1
  v_lshlrev_b32 v3, 12, v2
  v_and_b32 v2, 16, v1
  v_lshl_add_u32 v3, v2, 1, v3
  v_and_b32 v2, 32, v1
  v_lshrrev_b32 v2, 1, v2
  v_add_u32 v3, v2, v3
  s_lshl_b32 s5, s76, 18
  s_lshl_b32 s4, s85, 11
  s_add_u32 s5, s5, s4
  s_lshl_b32 s4, s78, 7
  s_add_u32 s5, s5, s4
  s_lshl_b32 s4, s86, 6
  s_add_u32 s5, s5, s4
  buffer_store_dwordx4 v[240:243], v3, s[64:67], s5 offen
  s_add_u32 s5, s5, 0x10000
  buffer_store_dwordx4 v[244:247], v3, s[64:67], s5 offen
  s_add_u32 s5, s5, 0x10000
  buffer_store_dwordx4 v[248:251], v3, s[64:67], s5 offen
  s_add_u32 s5, s5, 0x10000
  buffer_store_dwordx4 v[252:255], v3, s[64:67], s5 offen
  s_endpgm
Lo_6:
  s_mov_b64 vcc, 0
  s_waitcnt lgkmcnt(0)
  s_barrier
  ds_read_b128 v[64:67], v4 offset:0
  ds_read_b128 v[80:83], v5 offset:0
  ds_read_b128 v[68:71], v4 offset:2048
  ds_read_b128 v[84:87], v5 offset:2048
  ds_read_b128 v[72:75], v4 offset:4096
  ds_read_b128 v[88:91], v5 offset:4096
  ds_read_b64_tr_b16 v[96:97], v6 offset:0
  ds_read_b64_tr_b16 v[98:99], v6 offset:2048
  ds_read_b64_tr_b16 v[100:101], v6 offset:4096
  ds_read_b64_tr_b16 v[102:103], v6 offset:6144
  ds_read_b128 v[76:79], v4 offset:6144
  ds_read_b128 v[92:95], v5 offset:6144
  ds_read_b64_tr_b16 v[104:105], v7 offset:0
  s_nop 0
  s_waitcnt lgkmcnt(8)
  ds_read_b64_tr_b16 v[106:107], v7 offset:2048
  ds_read_b64_tr_b16 v[108:109], v7 offset:4096
  ds_read_b64_tr_b16 v[110:111], v7 offset:6144
  s_waitcnt lgkmcnt(6)
  s_branch Lk_4
Lx_27:
  s_mov_b64 exec, -1
  v_readfirstlane_b32 s5, v32
  s_sub_u32 s89, s89, 1
  s_cbranch_scc1 Lx_29
  buffer_load_dword v32, off, s[40:43], s13 sc0 sc1
  buffer_load_dwordx4 v[176:179], v0, s[40:43], s8 offen offset:0 sc0 sc1
  buffer_load_dwordx4 v[180:183], v0, s[40:43], s8 offen offset:2048 sc0 sc1
  buffer_load_dwordx4 v[184:187], v0, s[40:43], s9 offen offset:0 sc0 sc1
  buffer_load_dwordx4 v[188:191], v0, s[40:43], s9 offen offset:2048 sc0 sc1
  s_waitcnt vmcnt(0)
  s_cmp_lg_u32 s5, 0
  s_cbranch_scc1 Lx_29
  s_branch Lx_28
  s_nop 0
L_w1:
  s_and_b32 s80, s77, 7
  s_lshr_b32 s79, s77, 3
  s_lshl_b32 s78, s80, 1
  s_add_u32 s78, s78, s79
  s_lshl_b32 s5, s76, 4
  s_add_u32 s5, s5, s77
  s_lshl_b32 s84, s5, 11
  s_mov_b32 s83, 3145728
  s_mov_b32 s87, 1835016
  s_lshr_b32 s86, s81, 1
  s_mov_b32 s40, s38
  s_and_b32 s41, s39, 0xffff
  s_mov_b32 s42, 100663296
  s_mov_b32 s43, 0x00020000
  s_nop 0
  s_mov_b32 s52, s20
  s_and_b32 s53, s21, 0xffff
  s_mov_b32 s54, 2097152
  s_mov_b32 s55, 0x00020000
  s_nop 0
  s_mov_b32 s56, s24
  s_and_b32 s57, s25, 0xffff
  s_mov_b32 s58, 7340032
  s_mov_b32 s59, 0x00020000
  s_nop 0
  s_mov_b32 s60, s28
  s_and_b32 s61, s29, 0xffff
  s_mov_b32 s62, 7340032
  s_mov_b32 s63, 0x00020000
  v_lshrrev_b32 v2, 3, v1
  s_movk_i32 s4, 2048
  v_mad_u32_u24 v4, v2, s4, v10
  v_add_u32 v5, 15360, v4
  v_add_u32 v6, 30720, v4
  v_add_u32 v7, 46080, v4
  s_lshl_b32 s5, s78, 7
  s_mul_i32 s4, s85, 65536
  s_add_u32 s5, s5, s4
  s_mov_b32 s8, 131072
  s_mov_b32 s10, 2097152
  s_add_u32 s9, s5, s10
  s_mul_i32 s6, s76, s8
  s_add_u32 s7, s5, s6
  s_lshl_b32 s11, s85, 12
  s_add_u32 s11, s11, 65536
  s_add_u32 s15, s11, 81920
  s_add_u32 s11, s11, 32768
  s_mov_b32 s12, 0
  s_mov_b32 m0, s11
  s_waitcnt vmcnt(12)
  s_barrier
  s_branch Ll_44
Lt_50:
  s_cmp_lg_u32 s12, 2
  s_cbranch_scc1 Lt_48
  s_waitcnt vmcnt(8)
  s_barrier
  s_branch Ll_44
Lt_48:
  s_cmp_lg_u32 s12, 6
  s_cbranch_scc1 Ll_44
  s_barrier
Ll_44:
  buffer_load_dwordx4 v4, s[52:55], s7 offen offset:0 lds
  s_mov_b32 s5, s7
  buffer_load_dwordx4 v5, s[52:55], s5 offen offset:1024 lds
  s_add_u32 s7, s7, s8
  s_cmp_eq_u32 s7, s9
  s_cselect_b32 s4, s10, 0
  s_sub_u32 s7, s7, s4
  s_add_u32 s11, s11, 8192
  buffer_load_dwordx4 v6, s[52:55], s5 offen offset:2048 lds
  s_cmp_eq_u32 s11, s15
  s_cselect_b32 s4, 81920, 0
  s_sub_u32 s11, s11, s4
  s_add_u32 s12, s12, 1
  s_cmp_lg_u32 s12, 10
  buffer_load_dwordx4 v7, s[52:55], s5 offen offset:3072 lds
  s_mov_b32 m0, s11
  s_cbranch_scc1 Lt_50
Lt_51:
  v_mov_b32 v2, 156416
  v_mov_b32_e64 v3, 1
  s_waitcnt vmcnt(16)
  s_mov_b64 exec, 1
  ds_add_u32 v2, v3 offset:8
  s_mov_b64 exec, -1
  s_lshl_b32 s5, s82, 2
  s_add_u32 s5, s5, Lz1-Lz0+4
  s_mov_b32 s89, 1600000
Lw_52:
  ds_read_b32 v3, v2 offset:12
Lw_53:
  s_waitcnt lgkmcnt(0)
  v_readfirstlane_b32 s4, v3
  s_cmp_ge_u32 s4, s5
  s_cbranch_scc1 Lw_54
  s_sleep 1
  s_sub_u32 s89, s89, 1
  s_cbranch_scc0 Lw_52
Lw_54:
Ll_46:
  buffer_load_dwordx4 v4, s[52:55], s7 offen offset:0 lds
  s_mov_b32 s5, s7
  buffer_load_dwordx4 v5, s[52:55], s5 offen offset:1024 lds
  s_add_u32 s7, s7, s8
  s_cmp_eq_u32 s7, s9
  s_cselect_b32 s4, s10, 0
  s_sub_u32 s7, s7, s4
  s_add_u32 s11, s11, 8192
  buffer_load_dwordx4 v6, s[52:55], s5 offen offset:2048 lds
  s_cmp_eq_u32 s11, s15
  s_cselect_b32 s4, 81920, 0
  s_sub_u32 s11, s11, s4
  s_add_u32 s12, s12, 1
  s_cmp_lg_u32 s12, 16
  buffer_load_dwordx4 v7, s[52:55], s5 offen offset:3072 lds
  s_mov_b32 m0, s11
  s_cbranch_scc1 Ll_46
  s_waitcnt vmcnt(24)
  v_lshrrev_b32 v2, 3, v1
  s_mov_b32 s4, 7168
  v_mad_u32_u24 v4, v2, s4, v10
  v_add_u32 v5, 56320, v4
  v_add_u32 v6, 112640, v4
  v_add_u32 v7, 168960, v4
  v_lshrrev_b32 v2, 2, v1
  s_movk_i32 s4, 7168
  v_mul_u32_u24_e64 v2, s4, v2
  v_bfe_u32 v3, v10, 5, 1
  v_lshl_add_u32 v2, v3, 4, v2
  v_and_b32 v3, 1, v1
  v_lshlrev_b32 v3, 5, v3
  v_add_u32_e64 v8, v2, v3
  v_add_u32 v9, 113664, v8
  s_mul_i32 s5, s77, 448
  s_and_b32 s4, s77, Lz1-Lz0+1
  s_mul_i32 s94, s4, 448
  s_sub_u32 s94, 384, s94
  s_lshl_b32 s4, s4, 6
  s_add_u32 s5, s5, s4
  s_mul_i32 s4, s85, 229376
  s_add_u32 s5, s5, s4
  s_and_b32 s4, s76, 7
  s_add_u32 s6, s4, 1
  v_cmp_lt_u32 vcc, s6, v1
  v_add_u32 v12, s4, v1
  s_nop 0
  v_subbrev_co_u32 v12, vcc, 0, v12, vcc
  v_and_b32 v12, 7, v12
  v_subrev_u32 v2, 9, v1
  v_cmp_le_u32 vcc, s4, v2
  s_nop 1
  v_addc_co_u32 v2, vcc, 8, v2, vcc
  v_cmp_le_u32 vcc, 9, v1
  s_nop 1
  v_cndmask_b32 v12, v12, v2, vcc
  s_add_u32 s4, s4, 8
  s_mov_b32 m0, s6
  s_nop 0
  v_writelane_b32 v12, s4, m0
  s_and_b32 s4, s76, 8
  v_xor_b32 v12, s4, v12
  v_cmp_eq_u32 vcc, s78, v12
  s_nop 0
  v_mov_b32_dpp v2, v12 row_shr:1 row_mask:0xf bank_mask:0xf
  s_ff1_i32_b32 s4, vcc_lo
  v_cmp_ge_u32 vcc, s4, v1
  s_nop 1
  v_cndmask_b32 v12, v12, v2, vcc
  v_writelane_b32 v12, s78, 0
  s_mov_b32 s4, 458752
  v_mul_u32_u24 v12, s4, v12
  v_add_u32 v12, s5, v12
  s_nop 0
  v_readfirstlane_b32 s7, v12
  s_lshl_b32 s11, s85, Lz1-Lz0+12
  s_add_u32 s11, s11, 65536
  s_add_u32 s15, s11, 86016
  s_lshl_b32 s4, s85, Lz1-Lz0+11
  s_sub_u32 s13, 24576, s4
  s_mul_i32 s5, s85, 6144
  s_nop 0
  s_mov_b32 s68, s28
  s_and_b32 s69, s29, 0xffff
  s_mov_b32 s70, 7340032
  s_mov_b32 s71, 0x00020000
  s_lshl_b32 s4, s76, 4
  s_add_u32 s4, s4, s77
  s_mul_i32 s34, s4, 28672
  s_add_u32 s34, s34, s5
  v_lshlrev_b32 v15, 4, v1
  s_lshl_b32 s91, s85, Lz1-Lz0+13
  s_add_u32 s91, s91, 4096
  s_mul_i32 s9, s76, 262144
  s_add_u32 s9, s9, 3145728
  s_nop 0
  s_add_u32 s9, s9, s91
  s_add_u32 s10, s91, 65536
  s_add_u32 s91, s91, 49152
  s_add_u32 s8, s76, 3
  s_lshl_b32 s8, s8, 14
  s_mov_b32 s12, Lz1-Lz0+3
Lh_55:
  s_and_b32 s8, s8, 0x3ffff
  s_add_u32 s90, s8, s9
  s_mov_b32 m0, s91
  s_cmp_lt_u32 s12, 6
  s_cbranch_scc1 Lh_56
  s_waitcnt vmcnt(8)
Lh_56:
  s_barrier
Lh_57:
  buffer_load_dwordx4 v15, s[40:43], s90 offen offset:0 sc1 lds
  s_add_u32 s8, s8, 16384
  s_add_u32 s91, s91, 16384
  s_nop 0
  s_cmp_eq_u32 s91, s10
  buffer_load_dwordx4 v15, s[40:43], s90 offen offset:1024 sc1 lds
  s_cselect_b32 s4, 65536, 0
  s_sub_u32 s91, s91, s4
  s_add_u32 s12, s12, 1
  buffer_load_dwordx4 v15, s[40:43], s90 offen offset:2048 sc1 lds
  s_cmp_lg_u32 s12, Lz1-Lz0+16
  buffer_load_dwordx4 v15, s[40:43], s90 offen offset:3072 sc1 lds
  s_cbranch_scc1 Lh_55
  s_mov_b32 s12, 0
  s_mov_b32 m0, s11
  s_branch Ll_58
Lt_63:
  s_cmp_lg_u32 s12, 1
  s_cbranch_scc1 Ll_58
  s_waitcnt vmcnt(18)
  s_barrier
Ll_58:
  buffer_load_dwordx4 v4, s[56:59], s7 offen offset:0 lds
  buffer_load_dwordx4 v5, s[56:59], s7 offen offset:1024 lds
  buffer_load_dwordx4 v6, s[56:59], s7 offen offset:2048 lds
  buffer_load_dwordx4 v7, s[56:59], s7 offen offset:3072 lds
  s_add_u32 m0, s11, s13
  s_add_u32 s5, s7, s94
  buffer_load_dwordx4 v8, s[56:59], s5 offen offset:0 lds
  buffer_load_dwordx4 v9, s[56:59], s5 offen offset:1024 lds
  s_cmp_ge_u32 s12, Lz1-Lz0+2
  s_cbranch_scc1 Lm_64
  s_waitcnt vmcnt(20)
  s_cmp_lg_u32 s12, 0
  s_cbranch_scc1 Lm_65
  s_waitcnt vmcnt(14)
Lm_65:
  s_barrier
Lm_64:
  s_add_u32 m0, s11, 8192
  s_add_u32 s5, s7, 128
  buffer_load_dwordx4 v4, s[56:59], s5 offen offset:0 lds
  buffer_load_dwordx4 v5, s[56:59], s5 offen offset:1024 lds
  buffer_load_dwordx4 v6, s[56:59], s5 offen offset:2048 lds
  buffer_load_dwordx4 v7, s[56:59], s5 offen offset:3072 lds
  s_add_u32 m0, s11, 16384
  s_add_u32 s5, s7, 256
  buffer_load_dwordx4 v4, s[56:59], s5 offen offset:0 lds
  s_add_u32 s12, s12, Lz1-Lz0+1
  v_readlane_b32 s7, v12, s12
  s_add_u32 s11, s11, 28672
  buffer_load_dwordx4 v5, s[56:59], s5 offen offset:1024 lds
  s_cmp_eq_u32 s11, s15
  s_cselect_b32 s4, 86016, 0
  s_sub_u32 s11, s11, s4
  buffer_load_dwordx4 v6, s[56:59], s5 offen offset:2048 lds
  s_cmp_lg_u32 s12, 2
  buffer_load_dwordx4 v7, s[56:59], s5 offen offset:3072 lds
  s_mov_b32 m0, s11
  s_cbranch_scc1 Ll_59
  s_barrier
Lt_66:
  s_waitcnt vmcnt(0)
  s_barrier
Ll_59:
  s_cmp_lt_u32 s12, 3
  s_cbranch_scc1 Lt_63
  s_waitcnt vmcnt(14)
  s_barrier
  buffer_load_dwordx4 v4, s[56:59], s7 offen offset:0 lds
  buffer_load_dwordx4 v5, s[56:59], s7 offen offset:1024 lds
  buffer_load_dwordx4 v6, s[56:59], s7 offen offset:2048 lds
  buffer_load_dwordx4 v7, s[56:59], s7 offen offset:3072 lds
Ll_67:
  s_add_u32 m0, s11, s13
  s_add_u32 s5, s7, s94
  buffer_load_dwordx4 v8, s[56:59], s5 offen offset:0 lds
  buffer_load_dwordx4 v9, s[56:59], s5 offen offset:1024 lds
  s_add_u32 m0, s11, 8192
  s_add_u32 s5, s7, 128
  buffer_load_dwordx4 v4, s[56:59], s5 offen offset:0 lds
  buffer_load_dwordx4 v5, s[56:59], s5 offen offset:1024 lds
  buffer_load_dwordx4 v6, s[56:59], s5 offen offset:2048 lds
  buffer_load_dwordx4 v7, s[56:59], s5 offen offset:3072 lds
  s_add_u32 m0, s11, 16384
  s_add_u32 s5, s7, 256
  buffer_load_dwordx4 v4, s[56:59], s5 offen offset:0 lds
  s_add_u32 s12, s12, Lz1-Lz0+1
  v_readlane_b32 s7, v12, s12
  s_add_u32 s11, s11, 28672
  buffer_load_dwordx4 v5, s[56:59], s5 offen offset:1024 lds
  s_cmp_eq_u32 s11, s15
  s_cselect_b32 s4, 86016, 0
  s_sub_u32 s11, s11, s4
  buffer_load_dwordx4 v6, s[56:59], s5 offen offset:2048 lds
  s_cmp_eq_u32 s12, Lz1-Lz0+16
  buffer_load_dwordx4 v7, s[56:59], s5 offen offset:3072 lds
  s_mov_b32 m0, s11
  s_cbranch_scc1 Ll_68
  s_cmp_lg_u32 s82, 0
  s_cbranch_scc1 L_69
  s_buffer_load_dwordx2 s[98:99], s[68:71], s34 offset:60
  s_buffer_load_dwordx2 s[98:99], s[68:71], s34 offset:188
  s_buffer_load_dwordx2 s[98:99], s[68:71], s34 offset:316
  s_buffer_load_dwordx2 s[98:99], s[68:71], s34 offset:444
  s_add_u32 s34, s34, 512
L_69:
  s_waitcnt vmcnt(14)
  s_barrier
  buffer_load_dwordx4 v4, s[56:59], s7 offen offset:0 lds
  buffer_load_dwordx4 v5, s[56:59], s7 offen offset:1024 lds
  buffer_load_dwordx4 v6, s[56:59], s7 offen offset:2048 lds
  buffer_load_dwordx4 v7, s[56:59], s7 offen offset:3072 lds
  s_branch Ll_67
  s_nop 0
Ll_68:
  v_lshrrev_b32 v2, 3, v1
  s_movk_i32 s4, 2048
  v_mad_u32_u24 v4, v2, s4, v10
  v_add_u32 v5, 15360, v4
  v_add_u32 v6, 30720, v4
  v_add_u32 v7, 46080, v4
  s_lshl_b32 s5, s78, Lz1-Lz0+7
  s_mul_i32 s4, s79, 3670016
  s_add_u32 s5, s5, s4
  s_lshl_b32 s94, s79, 8
  s_sub_u32 s94, 128, s94
  v_subrev_u32 v2, 2, v1
  v_cmp_le_u32 vcc, 28, v1
  s_nop 1
  v_cndmask_b32 v13, v1, v2, vcc
  v_subrev_u32 v3, 3, v13
  v_mov_b32 v12, 4
  v_cmp_le_u32 vcc, 14, v13
  v_subrev_u32 v2, 14, v13
  s_nop 0
  v_cndmask_b32 v3, v3, v2, vcc
  v_cndmask_b32_e64 v12, v12, 12, vcc
  v_cmp_le_u32 vcc, 21, v13
  v_subrev_u32 v2, 21, v13
  s_nop 0
  v_cndmask_b32 v3, v3, v2, vcc
  v_cndmask_b32_e64 v12, v12, 20, vcc
  s_sub_u32 s4, s80, s76
  s_and_b32 s4, s4, 7
  v_cmp_le_u32 vcc, s4, v3
  v_mov_b32 v2, s76
  s_nop 0
  v_addc_co_u32 v3, vcc, v3, v2, vcc
  v_and_b32 v3, 7, v3
  v_add_u32 v12, v12, v3
  v_add_u32 v2, v2, v1
  v_and_b32 v2, 3, v2
  v_subrev_u32 v3, 10, v1
  v_cmp_gt_u32 vcc, 4, v3
  s_nop 1
  v_cndmask_b32 v12, v12, v2, vcc
  s_add_u32 s4, s80, Lz1-Lz0+4
  v_lshl_add_u32 v2, v1, 3, s4
  v_cmp_gt_u32 vcc, 3, v1
  s_nop 1
  v_cndmask_b32 v12, v12, v2, vcc
  v_subrev_u32 v2, 4, v12
  v_and_b32 v3, 7, v2
  v_lshrrev_b32 v2, 3, v2
  v_mad_u32_u24 v2, v3, 7, v2
  v_and_b32 v3, 1, v3
  v_add_u32 v2, v2, v3
  s_mul_i32 s4, s85, 3
  v_add_u32 v2, s4, v2
  s_add_u32 s4, s85, Lz1-Lz0+6
  v_mad_u32_u24 v3, v12, 14, s4
  v_cmp_gt_u32 vcc, 4, v12
  s_nop 1
  v_cndmask_b32_e64 v2, v2, v3, vcc
  v_lshl_add_u32 v12, v2, 16, s5
  s_mul_i32 s4, s79, 7340032
  s_sub_u32 s4, 3670016, s4
  v_add_u32 v2, s4, v12
  v_cmp_le_u32 vcc, 28, v1
  s_nop 1
  v_cndmask_b32 v12, v12, v2, vcc
  s_lshl_b32 s11, s85, Lz1-Lz0+12
  s_add_u32 s11, s11, 65536
  s_add_u32 s15, s11, 81920
  s_add_u32 s11, s11, 49152
  v_readfirstlane_b32 s7, v12
  s_mov_b32 s12, 0
  s_mov_b32 m0, s11
  s_waitcnt vmcnt(14)
  s_barrier
  s_waitcnt vmcnt(0)
  s_barrier
  s_branch Ll_70
  s_nop 0
Lt_75:
  s_cmp_lg_u32 s12, 2
  s_cbranch_scc1 Ll_70
  s_barrier
Ll_70:
  buffer_load_dwordx4 v4, s[60:63], s7 offen offset:0 lds
  buffer_load_dwordx4 v5, s[60:63], s7 offen offset:1024 lds
  buffer_load_dwordx4 v6, s[60:63], s7 offen offset:2048 lds
  buffer_load_dwordx4 v7, s[60:63], s7 offen offset:3072 lds
  s_add_u32 m0, s11, 8192
  s_add_u32 s5, s7, s94
  buffer_load_dwordx4 v4, s[60:63], s5 offen offset:0 lds
  s_add_u32 s12, s12, 1
  v_readlane_b32 s7, v12, s12
  s_add_u32 s11, s11, 16384
  buffer_load_dwordx4 v5, s[60:63], s5 offen offset:1024 lds
  s_cmp_eq_u32 s11, s15
  s_cselect_b32 s4, 81920, 0
  s_sub_u32 s11, s11, s4
  buffer_load_dwordx4 v6, s[60:63], s5 offen offset:2048 lds
  s_cmp_lg_u32 s12, Lz1-Lz0+5
  buffer_load_dwordx4 v7, s[60:63], s5 offen offset:3072 lds
  s_mov_b32 m0, s11
  s_cbranch_scc1 Lt_75
Lt_76:
  v_lshrrev_b32 v2, 3, v1
  s_movk_i32 s4, 6144
  v_mad_u32_u24 v16, v2, s4, v10
  v_add_u32 v17, 48128, v16
  v_add_u32 v18, 96256, v16
  v_add_u32 v19, 144384, v16
  s_lshl_b32 s5, s77, Lz1-Lz0+7
  s_mul_i32 s4, s85, 196608
  s_add_u32 s5, s5, s4
  s_and_b32 s4, s76, 7
  s_add_u32 s6, s4, 1
  v_cmp_lt_u32 vcc, s6, v1
  v_add_u32 v20, s4, v1
  s_nop 0
  v_subbrev_co_u32 v20, vcc, 0, v20, vcc
  v_and_b32 v20, 7, v20
  v_subrev_u32 v2, 9, v1
  v_cmp_le_u32 vcc, s4, v2
  s_nop 1
  v_addc_co_u32 v2, vcc, 8, v2, vcc
  v_cmp_le_u32 vcc, 9, v1
  s_nop 1
  v_cndmask_b32 v20, v20, v2, vcc
  s_add_u32 s4, s4, 8
  s_mov_b32 m0, s6
  s_nop 0
  v_writelane_b32 v20, s4, m0
  s_and_b32 s4, s76, 8
  v_xor_b32 v20, s4, v20
  v_cmp_eq_u32 vcc, s78, v20
  s_nop 0
  v_mov_b32_dpp v2, v20 row_shr:1 row_mask:0xf bank_mask:0xf
  s_ff1_i32_b32 s4, vcc_lo
  v_cmp_ge_u32 vcc, s4, v1
  s_nop 1
  v_cndmask_b32 v20, v20, v2, vcc
  v_writelane_b32 v20, s78, 0
  s_mov_b32 s4, 393216
  v_mul_u32_u24_e64 v20, s4, v20
  v_add_u32 v20, s5, v20
  s_mov_b32 m0, s11
  s_waitcnt vmcnt(32)
  s_barrier
  s_waitcnt vmcnt(24)
  s_barrier
  buffer_load_dwordx4 v4, s[60:63], s7 offen offset:0 lds
  buffer_load_dwordx4 v5, s[60:63], s7 offen offset:1024 lds
  buffer_load_dwordx4 v6, s[60:63], s7 offen offset:2048 lds
  buffer_load_dwordx4 v7, s[60:63], s7 offen offset:3072 lds
Ll_77:
  s_add_u32 m0, s11, 8192
  s_add_u32 s5, s7, s94
  buffer_load_dwordx4 v4, s[60:63], s5 offen offset:0 lds
  s_add_u32 s12, s12, 1
  v_readlane_b32 s7, v12, s12
  s_add_u32 s11, s11, 16384
  buffer_load_dwordx4 v5, s[60:63], s5 offen offset:1024 lds
  s_cmp_eq_u32 s11, s15
  s_cselect_b32 s4, 81920, 0
  s_sub_u32 s11, s11, s4
  buffer_load_dwordx4 v6, s[60:63], s5 offen offset:2048 lds
  s_cmp_eq_u32 s12, Lz1-Lz0+26
  buffer_load_dwordx4 v7, s[60:63], s5 offen offset:3072 lds
  s_mov_b32 m0, s11
  s_cbranch_scc1 Ll_78
  s_waitcnt vmcnt(24)
  s_barrier
  buffer_load_dwordx4 v4, s[60:63], s7 offen offset:0 lds
  buffer_load_dwordx4 v5, s[60:63], s7 offen offset:1024 lds
  buffer_load_dwordx4 v6, s[60:63], s7 offen offset:2048 lds
  buffer_load_dwordx4 v7, s[60:63], s7 offen offset:3072 lds
  s_branch Ll_77
  s_nop 0
Ll_78:
  s_waitcnt vmcnt(24)
  s_barrier
  buffer_load_dwordx4 v4, s[60:63], s7 offen offset:0 lds
Ll_79:
  s_mov_b32 s5, s7
  buffer_load_dwordx4 v5, s[60:63], s5 offen offset:1024 lds
  s_add_u32 s12, s12, 1
  v_readlane_b32 s7, v12, s12
  s_add_u32 s11, s11, 16384
  s_nop 0
  s_cmp_eq_u32 s11, s15
  buffer_load_dwordx4 v6, s[60:63], s5 offen offset:2048 lds
  s_cselect_b32 s4, 81920, 0
  s_sub_u32 s11, s11, s4
  s_cmp_eq_u32 s12, 30
  buffer_load_dwordx4 v7, s[60:63], s5 offen offset:3072 lds
  s_mov_b32 m0, s11
  s_cbranch_scc1 Ll_80
  s_waitcnt vmcnt(12)
  s_barrier
  buffer_load_dwordx4 v4, s[60:63], s7 offen offset:0 lds
  s_branch Ll_79
  s_nop 0
Ll_80:
  v_readfirstlane_b32 s7, v20
  s_lshl_b32 s11, s85, 12
  s_add_u32 s11, s11, 65536
  s_add_u32 s15, s11, 73728
  s_cmp_eq_u32 s82, 0
  s_mov_b32 s82, 1
  s_cbranch_scc1 L_wlayer
  s_waitcnt vmcnt(12)
  s_barrier
  s_waitcnt vmcnt(8)
  s_barrier
  s_waitcnt vmcnt(4)
  s_barrier
  s_waitcnt vmcnt(0)
  s_barrier
  s_barrier
  s_branch L_lend
L_x1:
  s_cmp_lg_u32 s82, 0
  s_cbranch_scc1 L_88
  s_and_b32 s80, s77, 7
  s_lshr_b32 s79, s77, 3
  s_lshl_b32 s78, s80, 1
  s_add_u32 s78, s78, s79
  s_lshl_b32 s5, s76, 4
  s_add_u32 s5, s5, s77
  s_lshl_b32 s84, s5, 11
  s_mov_b32 s83, 3145728
  s_mov_b32 s87, 1835016
  s_lshr_b32 s86, s81, 1
  v_lshlrev_b32 v4, 4, v1
  v_lshlrev_b32 v5, 4, v1
  v_lshlrev_b32 v6, 4, v1
  v_lshlrev_b32 v7, 4, v1
  s_movk_i32 s13, 4096
  s_movk_i32 s95, 8192
  v_and_b32 v2, 31, v1
  v_lshlrev_b32 v8, 7, v2
L_88:
  s_mov_b32 s40, s38
  s_and_b32 s41, s39, 0xffff
  s_mov_b32 s42, 100663296
  s_mov_b32 s43, 0x00020000
  s_mov_b32 s72, s40
  s_mov_b32 s73, s41
  s_mov_b32 s74, s42
  s_mov_b32 s11, 0
  s_mov_b32 s15, 65536
  s_mul_i32 s5, s76, 16
  s_lshl_b32 s5, s5, 14
  s_add_u32 s5, s5, 3145728
  s_mov_b32 s8, 16384
  s_mov_b32 s10, 262144
  s_add_u32 s9, s5, s10
  s_mul_i32 s6, s76, s8
  s_add_u32 s7, s5, s6
  s_lshr_b32 s6, s6, 14
  s_lshl_b32 s90, 0x7f, s6
  s_lshr_b32 s4, s90, 16
  s_or_b32 s90, s90, s4
  s_and_b32 s90, s90, 0xffff
  s_lshl_b32 s91, s84, 1
  s_add_u32 s91, s91, s87
  s_mov_b32 s89, 200000
  s_mov_b32 exec_lo, s90
  s_mov_b32 exec_hi, 0
  buffer_load_dword v12, v8, s[40:43], s91 offen sc0 sc1
Lp_89:
  s_waitcnt vmcnt(0)
  v_cmp_ne_u32 vcc, 0, v12
  s_andn2_b32 s3, exec_lo, vcc_lo
  s_cbranch_scc0 Lp_90
  s_mov_b32 exec_lo, s3
  s_sleep 1
  buffer_load_dword v12, v8, s[40:43], s91 offen sc0 sc1
  s_sub_u32 s89, s89, 1
  s_cbranch_scc0 Lp_89
Lp_90:
  s_mov_b64 exec, -1
  s_mov_b32 s12, 0
  s_mov_b32 m0, s11
Ll_92:
  s_nop 0
  buffer_load_dwordx4 v4, s[40:43], s7 offen offset:0 sc1 lds
  buffer_load_dwordx4 v5, s[40:43], s7 offen offset:1024 sc1 lds
  buffer_load_dwordx4 v6, s[40:43], s7 offen offset:2048 sc1 lds
  buffer_load_dwordx4 v7, s[40:43], s7 offen offset:3072 sc1 lds
  s_add_u32 m0, s11, 4096
  s_nop 0
  s_add_u32 s5, s7, s13
  buffer_load_dwordx4 v4, s[40:43], s5 offen offset:0 sc1 lds
  buffer_load_dwordx4 v5, s[40:43], s5 offen offset:1024 sc1 lds
  buffer_load_dwordx4 v6, s[40:43], s5 offen offset:2048 sc1 lds
  buffer_load_dwordx4 v7, s[40:43], s5 offen offset:3072 sc1 lds
  s_add_u32 m0, s11, 8192
  s_nop 0
  s_add_u32 s3, s7, s95
  buffer_load_dwordx4 v4, s[40:43], s3 offen offset:0 sc1 lds
  buffer_load_dwordx4 v5, s[40:43], s3 offen offset:1024 sc1 lds
  buffer_load_dwordx4 v6, s[40:43], s3 offen offset:2048 sc1 lds
  buffer_load_dwordx4 v7, s[40:43], s3 offen offset:3072 sc1 lds
  s_add_u32 m0, s11, 12288
  s_nop 0
  s_add_u32 s5, s3, s13
  buffer_load_dwordx4 v4, s[40:43], s5 offen offset:0 sc1 lds
  s_add_u32 s7, s7, s8
  s_cmp_eq_u32 s7, s9
  s_cselect_b32 s4, s10, 0
  s_sub_u32 s7, s7, s4
  buffer_load_dwordx4 v5, s[40:43], s5 offen offset:1024 sc1 lds
  s_add_u32 s11, s11, 16384
  s_cmp_eq_u32 s11, s15
  s_cselect_b32 s4, 65536, 0
  s_sub_u32 s11, s11, s4
  buffer_load_dwordx4 v6, s[40:43], s5 offen offset:2048 sc1 lds
  s_add_u32 s12, s12, 1
  s_cmp_lg_u32 s12, 3
  buffer_load_dwordx4 v7, s[40:43], s5 offen offset:3072 sc1 lds
  s_mov_b32 m0, s11
  s_cbranch_scc1 Ll_92
  s_waitcnt vmcnt(32)
  s_barrier
  buffer_load_dwordx4 v4, s[40:43], s7 offen offset:0 sc1 lds
  buffer_load_dwordx4 v5, s[40:43], s7 offen offset:1024 sc1 lds
  buffer_load_dwordx4 v6, s[40:43], s7 offen offset:2048 sc1 lds
  buffer_load_dwordx4 v7, s[40:43], s7 offen offset:3072 sc1 lds
  s_add_u32 m0, s11, 8192
  s_add_u32 s3, s7, s95
  buffer_load_dwordx4 v4, s[40:43], s3 offen offset:0 sc1 lds
  s_add_u32 s7, s7, s8
  s_cmp_eq_u32 s7, s9
  s_cselect_b32 s4, s10, 0
  buffer_load_dwordx4 v5, s[40:43], s3 offen offset:1024 sc1 lds
  s_sub_u32 s7, s7, s4
  s_add_u32 s11, s11, 16384
  s_cmp_eq_u32 s11, s15
  buffer_load_dwordx4 v6, s[40:43], s3 offen offset:2048 sc1 lds
  s_cselect_b32 s4, 65536, 0
  s_sub_u32 s11, s11, s4
  s_add_u32 s12, s12, 1
  buffer_load_dwordx4 v7, s[40:43], s3 offen offset:3072 sc1 lds
  s_mov_b32 m0, s11
  s_waitcnt vmcnt(24)
  s_nop 0
  s_barrier
  buffer_load_dwordx4 v4, s[40:43], s7 offen offset:0 sc1 lds
  buffer_load_dwordx4 v5, s[40:43], s7 offen offset:1024 sc1 lds
  buffer_load_dwordx4 v6, s[40:43], s7 offen offset:2048 sc1 lds
  buffer_load_dwordx4 v7, s[40:43], s7 offen offset:3072 sc1 lds
Ll_96:
  s_add_u32 m0, s11, 8192
  s_nop 0
  s_add_u32 s3, s7, s95
  buffer_load_dwordx4 v4, s[40:43], s3 offen offset:0 sc1 lds
  s_add_u32 s7, s7, s8
  s_cmp_eq_u32 s7, s9
  s_cselect_b32 s4, s10, 0
  s_sub_u32 s7, s7, s4
  buffer_load_dwordx4 v5, s[40:43], s3 offen offset:1024 sc1 lds
  s_add_u32 s11, s11, 16384
  s_cmp_eq_u32 s11, s15
  s_cselect_b32 s4, 65536, 0
  s_sub_u32 s11, s11, s4
  buffer_load_dwordx4 v6, s[40:43], s3 offen offset:2048 sc1 lds
  s_add_u32 s12, s12, 1
  s_cmp_eq_u32 s12, 16
  buffer_load_dwordx4 v7, s[40:43], s3 offen offset:3072 sc1 lds
  s_mov_b32 m0, s11
  s_cbranch_scc1 Ll_97
  s_waitcnt vmcnt(16)
  s_barrier
  buffer_load_dwordx4 v4, s[40:43], s7 offen offset:0 sc1 lds
  buffer_load_dwordx4 v5, s[40:43], s7 offen offset:1024 sc1 lds
  buffer_load_dwordx4 v6, s[40:43], s7 offen offset:2048 sc1 lds
  buffer_load_dwordx4 v7, s[40:43], s7 offen offset:3072 sc1 lds
  s_branch Ll_96
  s_nop 0
Ll_97:
  s_waitcnt vmcnt(16)
  s_barrier
  s_waitcnt vmcnt(8)
  s_barrier
  s_waitcnt vmcnt(0)
  s_barrier
  s_barrier
  s_mov_b32 s11, 0
  s_mov_b32 s15, 65536
  s_mul_i32 s5, s76, 16
  s_lshl_b32 s5, s5, 14
  s_add_u32 s5, s5, 7340032
  s_and_b32 s4, s76, 7
  s_add_u32 s6, s4, 1
  v_cmp_lt_u32 vcc, s6, v1
  v_add_u32 v9, s4, v1
  s_nop 0
  v_subbrev_co_u32 v9, vcc, 0, v9, vcc
  v_and_b32 v9, 7, v9
  v_subrev_u32 v2, 9, v1
  v_cmp_le_u32 vcc, s4, v2
  s_nop 1
  v_addc_co_u32 v2, vcc, 8, v2, vcc
  v_cmp_le_u32 vcc, 9, v1
  s_nop 1
  v_cndmask_b32 v9, v9, v2, vcc
  s_add_u32 s4, s4, Lz1-Lz0+8
  s_mov_b32 m0, s6
  s_nop 0
  v_writelane_b32 v9, s4, m0
  s_and_b32 s4, s76, 8
  v_xor_b32 v9, s4, v9
  v_cmp_eq_u32 vcc, s78, v9
  s_nop 0
  v_mov_b32_dpp v2, v9 row_shr:1 row_mask:0xf bank_mask:0xf
  s_ff1_i32_b32 s4, vcc_lo
  v_cmp_ge_u32 vcc, s4, v1
  s_nop 1
  v_cndmask_b32 v9, v9, v2, vcc
  v_writelane_b32 v9, s78, 0
  v_lshlrev_b32_e64 v11, 7, v9
  v_lshl_add_u32 v9, v9, 14, s5
  s_lshl_b32 s6, s76, Lz1-Lz0+14
  v_readlane_b32 s7, v9, 1
  s_mov_b32 s11, 16384
  s_mov_b32 s90, Lz1-Lz0+62
  s_add_u32 s91, s91, 4
  s_barrier
  s_mov_b32 s89, 200000
  s_mov_b32 exec_lo, s90
  s_mov_b32 exec_hi, 0
  buffer_load_dword v12, v11, s[40:43], s91 offen sc0 sc1
Lp_98:
  s_waitcnt vmcnt(0)
  v_cmp_ne_u32 vcc, 0, v12
  s_andn2_b32 s3, exec_lo, vcc_lo
  s_cbranch_scc0 Lp_99
  s_mov_b32 exec_lo, s3
  s_sleep 1
  buffer_load_dword v12, v11, s[40:43], s91 offen sc0 sc1
  s_sub_u32 s89, s89, 1
  s_cbranch_scc0 Lp_98
Lp_99:
  s_mov_b64 exec, -1
  s_mov_b32 s12, 1
  s_mov_b32 m0, s11
Ll_101:
  s_nop 0
  buffer_load_dwordx4 v4, s[72:75], s7 offen offset:0 sc1 lds
  buffer_load_dwordx4 v5, s[72:75], s7 offen offset:1024 sc1 lds
  buffer_load_dwordx4 v6, s[72:75], s7 offen offset:2048 sc1 lds
  buffer_load_dwordx4 v7, s[72:75], s7 offen offset:3072 sc1 lds
  s_add_u32 m0, s11, 4096
  s_nop 0
  s_add_u32 s5, s7, s13
  buffer_load_dwordx4 v4, s[72:75], s5 offen offset:0 sc1 lds
  buffer_load_dwordx4 v5, s[72:75], s5 offen offset:1024 sc1 lds
  buffer_load_dwordx4 v6, s[72:75], s5 offen offset:2048 sc1 lds
  buffer_load_dwordx4 v7, s[72:75], s5 offen offset:3072 sc1 lds
  s_add_u32 m0, s11, 8192
  s_nop 0
  s_add_u32 s3, s7, s95
  buffer_load_dwordx4 v4, s[72:75], s3 offen offset:0 sc1 lds
  buffer_load_dwordx4 v5, s[72:75], s3 offen offset:1024 sc1 lds
  buffer_load_dwordx4 v6, s[72:75], s3 offen offset:2048 sc1 lds
  buffer_load_dwordx4 v7, s[72:75], s3 offen offset:3072 sc1 lds
  s_add_u32 m0, s11, 12288
  s_add_u32 s5, s3, s13
  buffer_load_dwordx4 v4, s[72:75], s5 offen offset:0 sc1 lds
  s_add_u32 s12, s12, 1
  v_readlane_b32 s7, v9, s12
  s_add_u32 s11, s11, 16384
  buffer_load_dwordx4 v5, s[72:75], s5 offen offset:1024 sc1 lds
  s_cmp_eq_u32 s11, s15
  s_cselect_b32 s4, 65536, 0
  s_sub_u32 s11, s11, s4
  buffer_load_dwordx4 v6, s[72:75], s5 offen offset:2048 sc1 lds
  s_cmp_lg_u32 s12, Lz1-Lz0+4
  buffer_load_dwordx4 v7, s[72:75], s5 offen offset:3072 sc1 lds
  s_mov_b32 m0, s11
  s_cbranch_scc1 Ll_101
  s_waitcnt vmcnt(32)
  s_barrier
  buffer_load_dwordx4 v4, s[72:75], s7 offen offset:0 sc1 lds
  buffer_load_dwordx4 v5, s[72:75], s7 offen offset:1024 sc1 lds
  buffer_load_dwordx4 v6, s[72:75], s7 offen offset:2048 sc1 lds
  buffer_load_dwordx4 v7, s[72:75], s7 offen offset:3072 sc1 lds
Ll_105:
  s_add_u32 m0, s11, 4096
  s_nop 0
  s_add_u32 s5, s7, s13
  buffer_load_dwordx4 v4, s[72:75], s5 offen offset:0 sc1 lds
  buffer_load_dwordx4 v5, s[72:75], s5 offen offset:1024 sc1 lds
  buffer_load_dwordx4 v6, s[72:75], s5 offen offset:2048 sc1 lds
  buffer_load_dwordx4 v7, s[72:75], s5 offen offset:3072 sc1 lds
  s_add_u32 m0, s11, 8192
  s_nop 0
  s_add_u32 s3, s7, s95
  buffer_load_dwordx4 v4, s[72:75], s3 offen offset:0 sc1 lds
  buffer_load_dwordx4 v5, s[72:75], s3 offen offset:1024 sc1 lds
  buffer_load_dwordx4 v6, s[72:75], s3 offen offset:2048 sc1 lds
  buffer_load_dwordx4 v7, s[72:75], s3 offen offset:3072 sc1 lds
  s_add_u32 m0, s11, 12288
  s_add_u32 s5, s3, s13
  buffer_load_dwordx4 v4, s[72:75], s5 offen offset:0 sc1 lds
  s_add_u32 s12, s12, 1
  v_readlane_b32 s7, v9, s12
  s_add_u32 s11, s11, 16384
  buffer_load_dwordx4 v5, s[72:75], s5 offen offset:1024 sc1 lds
  s_cmp_eq_u32 s11, s15
  s_cselect_b32 s4, 65536, 0
  s_sub_u32 s11, s11, s4
  buffer_load_dwordx4 v6, s[72:75], s5 offen offset:2048 sc1 lds
  s_cmp_eq_u32 s12, Lz1-Lz0+16
  buffer_load_dwordx4 v7, s[72:75], s5 offen offset:3072 sc1 lds
  s_mov_b32 m0, s11
  s_cbranch_scc1 Ll_106
  s_waitcnt vmcnt(32)
  s_barrier
  buffer_load_dwordx4 v4, s[72:75], s7 offen offset:0 sc1 lds
  buffer_load_dwordx4 v5, s[72:75], s7 offen offset:1024 sc1 lds
  buffer_load_dwordx4 v6, s[72:75], s7 offen offset:2048 sc1 lds
  buffer_load_dwordx4 v7, s[72:75], s7 offen offset:3072 sc1 lds
  s_branch Ll_105
  s_nop 0
Ll_106:
  s_waitcnt vmcnt(32)
  s_barrier
  s_waitcnt vmcnt(16)
  s_barrier
  s_waitcnt vmcnt(0)
  s_barrier
  s_barrier
  s_mov_b32 s11, 0
  s_mov_b32 s15, 65536
  s_mul_i32 s5, s76, 56
  s_mul_i32 s4, s79, 28
  s_add_u32 s5, s5, s4
  s_lshl_b32 s5, s5, 14
  s_add_u32 s5, s5, 11534336
  v_subrev_u32 v2, 2, v1
  v_cmp_le_u32 vcc, 28, v1
  s_nop 1
  v_cndmask_b32 v10, v1, v2, vcc
  v_subrev_u32 v3, 3, v10
  v_mov_b32 v9, 4
  v_cmp_le_u32 vcc, 14, v10
  v_subrev_u32 v2, 14, v10
  s_nop 0
  v_cndmask_b32 v3, v3, v2, vcc
  v_cndmask_b32_e64 v9, v9, 12, vcc
  v_cmp_le_u32 vcc, 21, v10
  v_subrev_u32 v2, 21, v10
  s_nop 0
  v_cndmask_b32 v3, v3, v2, vcc
  v_cndmask_b32_e64 v9, v9, 20, vcc
  s_sub_u32 s4, s80, s76
  s_and_b32 s4, s4, 7
  v_cmp_le_u32 vcc, s4, v3
  v_mov_b32 v2, s76
  s_nop 0
  v_addc_co_u32 v3, vcc, v3, v2, vcc
  v_and_b32 v3, 7, v3
  v_add_u32 v9, v9, v3
  v_add_u32 v2, v2, v1
  v_and_b32 v2, 3, v2
  v_subrev_u32 v3, 10, v1
  v_cmp_gt_u32 vcc, 4, v3
  s_nop 1
  v_cndmask_b32 v9, v9, v2, vcc
  s_add_u32 s4, s80, Lz1-Lz0+4
  v_lshl_add_u32 v2, v1, 3, s4
  v_cmp_gt_u32 vcc, 3, v1
  s_nop 1
  v_cndmask_b32_e64 v9, v9, v2, vcc
  v_lshl_add_u32 v9, v9, 14, s5
  s_mul_i32 s4, s79, 917504
  s_sub_u32 s4, 458752, s4
  v_add_u32_e64 v2, s4, v9
  v_cmp_le_u32 vcc, 28, v1
  s_nop 1
  v_cndmask_b32 v9, v9, v2, vcc
  s_nop 0
  v_readlane_b32 s7, v9, 3
  s_mov_b32 s11, 49152
  s_add_u32 s91, s91, 4
  s_lshl_b32 s4, s79, 3
  s_lshl_b32 s90, 0xff, s4
  s_bitset0_b32 s90, s77
  s_mov_b32 s89, 200000
  s_mov_b32 exec_lo, s90
  s_mov_b32 exec_hi, Lz1-Lz0+0
  buffer_load_dword v12, v8, s[40:43], s91 offen sc0 sc1
Lp_107:
  s_waitcnt vmcnt(0)
  v_cmp_ne_u32 vcc, 0, v12
  s_andn2_b32 s3, exec_lo, vcc_lo
  s_cbranch_scc0 Lp_108
  s_mov_b32 exec_lo, s3
  s_sleep 1
  buffer_load_dword v12, v8, s[40:43], s91 offen sc0 sc1
  s_sub_u32 s89, s89, 1
  s_cbranch_scc0 Lp_107
Lp_108:
  s_mov_b64 exec, -1
  s_mov_b32 s12, 3
  s_mov_b32 m0, s11
Ll_110:
  s_nop 0
  buffer_load_dwordx4 v4, s[40:43], s7 offen offset:0 sc1 lds
  buffer_load_dwordx4 v5, s[40:43], s7 offen offset:1024 sc1 lds
  buffer_load_dwordx4 v6, s[40:43], s7 offen offset:2048 sc1 lds
  buffer_load_dwordx4 v7, s[40:43], s7 offen offset:3072 sc1 lds
  s_add_u32 m0, s11, 4096
  s_nop 0
  s_add_u32 s5, s7, s13
  buffer_load_dwordx4 v4, s[40:43], s5 offen offset:0 sc1 lds
  buffer_load_dwordx4 v5, s[40:43], s5 offen offset:1024 sc1 lds
  buffer_load_dwordx4 v6, s[40:43], s5 offen offset:2048 sc1 lds
  buffer_load_dwordx4 v7, s[40:43], s5 offen offset:3072 sc1 lds
  s_add_u32 m0, s11, 8192
  s_nop 0
  s_add_u32 s3, s7, s95
  buffer_load_dwordx4 v4, s[40:43], s3 offen offset:0 sc1 lds
  buffer_load_dwordx4 v5, s[40:43], s3 offen offset:1024 sc1 lds
  buffer_load_dwordx4 v6, s[40:43], s3 offen offset:2048 sc1 lds
  buffer_load_dwordx4 v7, s[40:43], s3 offen offset:3072 sc1 lds
  s_add_u32 m0, s11, 12288
  s_add_u32 s5, s3, s13
  buffer_load_dwordx4 v4, s[40:43], s5 offen offset:0 sc1 lds
  s_add_u32 s12, s12, 1
  v_readlane_b32 s7, v9, s12
  s_add_u32 s11, s11, 16384
  buffer_load_dwordx4 v5, s[40:43], s5 offen offset:1024 sc1 lds
  s_cmp_eq_u32 s11, s15
  s_cselect_b32 s4, 65536, 0
  s_sub_u32 s11, s11, s4
  buffer_load_dwordx4 v6, s[40:43], s5 offen offset:2048 sc1 lds
  s_cmp_lg_u32 s12, Lz1-Lz0+4
  buffer_load_dwordx4 v7, s[40:43], s5 offen offset:3072 sc1 lds
  s_mov_b32 m0, s11
  s_cbranch_scc1 Ll_110
  s_waitcnt vmcnt(48)
  s_barrier
  s_waitcnt vmcnt(32)
  s_barrier
  buffer_load_dwordx4 v4, s[40:43], s7 offen offset:0 sc1 lds
  buffer_load_dwordx4 v5, s[40:43], s7 offen offset:1024 sc1 lds
  buffer_load_dwordx4 v6, s[40:43], s7 offen offset:2048 sc1 lds
  buffer_load_dwordx4 v7, s[40:43], s7 offen offset:3072 sc1 lds
Ll_114:
  s_add_u32 m0, s11, 4096
  s_nop 0
  s_add_u32 s5, s7, s13
  buffer_load_dwordx4 v4, s[40:43], s5 offen offset:0 sc1 lds
  buffer_load_dwordx4 v5, s[40:43], s5 offen offset:1024 sc1 lds
  buffer_load_dwordx4 v6, s[40:43], s5 offen offset:2048 sc1 lds
  buffer_load_dwordx4 v7, s[40:43], s5 offen offset:3072 sc1 lds
  s_add_u32 m0, s11, 8192
  s_nop 0
  s_add_u32 s3, s7, s95
  buffer_load_dwordx4 v4, s[40:43], s3 offen offset:0 sc1 lds
  buffer_load_dwordx4 v5, s[40:43], s3 offen offset:1024 sc1 lds
  buffer_load_dwordx4 v6, s[40:43], s3 offen offset:2048 sc1 lds
  buffer_load_dwordx4 v7, s[40:43], s3 offen offset:3072 sc1 lds
  s_add_u32 m0, s11, 12288
  s_add_u32 s5, s3, s13
  buffer_load_dwordx4 v4, s[40:43], s5 offen offset:0 sc1 lds
  s_add_u32 s12, s12, 1
  v_readlane_b32 s7, v9, s12
  s_add_u32 s11, s11, 16384
  buffer_load_dwordx4 v5, s[40:43], s5 offen offset:1024 sc1 lds
  s_cmp_eq_u32 s11, s15
  s_cselect_b32 s4, 65536, 0
  s_sub_u32 s11, s11, s4
  buffer_load_dwordx4 v6, s[40:43], s5 offen offset:2048 sc1 lds
  s_cmp_eq_u32 s12, Lz1-Lz0+30
  buffer_load_dwordx4 v7, s[40:43], s5 offen offset:3072 sc1 lds
  s_mov_b32 m0, s11
  s_cbranch_scc1 Ll_115
  s_waitcnt vmcnt(32)
  s_barrier
  buffer_load_dwordx4 v4, s[40:43], s7 offen offset:0 sc1 lds
  buffer_load_dwordx4 v5, s[40:43], s7 offen offset:1024 sc1 lds
  buffer_load_dwordx4 v6, s[40:43], s7 offen offset:2048 sc1 lds
  buffer_load_dwordx4 v7, s[40:43], s7 offen offset:3072 sc1 lds
  s_branch Ll_114
  s_nop 0
Ll_115:
  s_waitcnt vmcnt(32)
  s_barrier
  s_waitcnt vmcnt(16)
  s_barrier
  s_waitcnt vmcnt(0)
  s_barrier
  s_barrier
  s_cmp_lg_u32 s82, 0
  s_cbranch_scc1 L_lend
  s_mov_b32 s11, 0
  s_mov_b32 s15, 65536
  s_mul_i32 s5, s76, 16
  s_lshl_b32 s5, s5, 14
  s_add_u32 s5, s5, 35651584
  s_and_b32 s4, s76, 7
  s_add_u32 s6, s4, 1
  v_cmp_lt_u32 vcc, s6, v1
  v_add_u32 v9, s4, v1
  s_nop 0
  v_subbrev_co_u32 v9, vcc, 0, v9, vcc
  v_and_b32 v9, 7, v9
  v_subrev_u32 v2, 9, v1
  v_cmp_le_u32 vcc, s4, v2
  s_nop 1
  v_addc_co_u32 v2, vcc, 8, v2, vcc
  v_cmp_le_u32 vcc, 9, v1
  s_nop 1
  v_cndmask_b32 v9, v9, v2, vcc
  s_add_u32 s4, s4, Lz1-Lz0+8
  s_mov_b32 m0, s6
  s_nop 0
  v_writelane_b32 v9, s4, m0
  s_and_b32 s4, s76, 8
  v_xor_b32 v9, s4, v9
  v_cmp_eq_u32 vcc, s78, v9
  s_nop 0
  v_mov_b32_dpp v2, v9 row_shr:1 row_mask:0xf bank_mask:0xf
  s_ff1_i32_b32 s4, vcc_lo
  v_cmp_ge_u32 vcc, s4, v1
  s_nop 1
  v_cndmask_b32 v9, v9, v2, vcc
  v_writelane_b32 v9, s78, 0
  v_lshlrev_b32_e64 v11, 7, v9
  v_lshl_add_u32 v9, v9, 14, s5
  s_lshl_b32 s6, s76, Lz1-Lz0+14
  v_readlane_b32 s7, v9, 1
  s_mov_b32 s11, 16384
  s_add_u32 s91, s91, 8
  s_mov_b32 s90, 0x3e
  s_barrier
  s_mov_b32 s82, 1
  s_add_u32 s83, s83, 0
  s_add_u32 s87, s87, 32
  s_mov_b32 s89, 200000
  s_mov_b32 exec_lo, s90
  s_mov_b32 exec_hi, 0
  buffer_load_dword v12, v11, s[40:43], s91 offen sc0 sc1
Lp_116:
  s_waitcnt vmcnt(0)
  v_cmp_ne_u32 vcc, 0, v12
  s_andn2_b32 s3, exec_lo, vcc_lo
  s_cbranch_scc0 Lp_117
  s_mov_b32 exec_lo, s3
  s_sleep 1
  buffer_load_dword v12, v11, s[40:43], s91 offen sc0 sc1
  s_sub_u32 s89, s89, 1
  s_cbranch_scc0 Lp_116
Lp_117:
  s_mov_b64 exec, -1
  s_branch L_xlayer
  s_nop 0
L_s1:
  v_mov_b32 v11, 1
  v_mov_b32 v2, 156416
  ds_write_b128 v2, v[24:27]
  v_and_b32 v2, 31, v1
  v_lshlrev_b32 v5, 7, v2
  v_lshlrev_b32 v10, 3, v2
  v_lshrrev_b32 v3, 5, v1
  v_mul_u32_u24 v3, 320, v3
  v_add_u32_e64 v10, v3, v10
  v_add_u32 v10, 151552, v10
  v_bfe_u32 v3, v1, 3, 1
  v_and_b32 v2, 7, v1
  v_lshlrev_b32 v12, 9, v3
  v_lshl_add_u32 v12, v2, 4, v12
  v_mul_u32_u24 v3, 320, v3
  v_lshl_add_u32 v13, v2, 3, v3
  v_add_u32 v13, 151808, v13
  v_and_b32 v2, 15, v1
  v_lshlrev_b32 v8, 4, v2
  v_lshlrev_b32 v15, 6, v2
  v_and_b32 v3, 48, v1
  v_add_u32 v15, v15, v3
  v_and_b32 v2, 14, v1
  v_lshlrev_b32 v6, 2, v2
  v_lshlrev_b32 v14, 16, v1
  s_lshl_b32 s4, s77, 12
  s_lshl_b32 s5, s76, 7
  s_add_u32 s4, s4, s5
  v_add_u32 v14, s4, v14
  v_lshrrev_b32 v2, 2, v1
  v_lshlrev_b32 v22, 7, v2
  v_lshlrev_b32 v96, 6, v2
  v_and_b32 v2, 3, v1
  v_lshl_add_u32 v22, v2, 3, v22
  v_lshl_add_u32 v96, v2, 3, v96
  v_add_u32 v22, 65536, v22
  v_add_u32 v96, 90112, v96
  v_bfe_u32 v3, v1, 3, 2
  v_xor_b32_e64 v2, 0, v3
  v_lshl_add_u32 v16, v2, 5, v22
  v_xor_b32_e64 v2, 1, v3
  v_lshl_add_u32 v17, v2, 5, v22
  v_xor_b32_e64 v2, 2, v3
  v_lshl_add_u32 v18, v2, 5, v22
  v_xor_b32_e64 v2, 3, v3
  v_lshl_add_u32 v19, v2, 5, v22
  v_bfe_u32 v3, v1, 4, 1
  v_xor_b32_e64 v2, 0, v3
  v_lshl_add_u32 v20, v2, 5, v96
  v_xor_b32_e64 v2, 1, v3
  v_lshl_add_u32 v21, v2, 5, v96
  v_mov_b32 v22, 0x3f803f80
  s_mul_i32 s4, s76, 11
  s_lshr_b32 s4, s4, 5
  s_mul_i32 s4, s4, 3
  s_and_b32 s14, s76, 1
  s_mov_b32 s15, 32768
  s_mul_i32 s4, s14, 24576
  v_add_u32 v16, s4, v16
  v_add_u32 v17, s4, v17
  v_add_u32 v18, s4, v18
  v_add_u32 v19, s4, v19
  s_mov_b32 s98, 0x00010001
  s_mov_b32 s99, 0x00010001
  v_cndmask_b32_e64 v200, 0, v22, s[98:99]
  v_cndmask_b32_e64 v201, 0, v22, s[98:99]
  v_cndmask_b32_e64 v202, 0, v22, s[98:99]
  v_cndmask_b32_e64 v203, 0, v22, s[98:99]
  s_nop 0
  s_lshl_b64 s[98:99], s[98:99], 1
  v_cndmask_b32_e64 v204, 0, v22, s[98:99]
  v_cndmask_b32_e64 v205, 0, v22, s[98:99]
  v_cndmask_b32_e64 v206, 0, v22, s[98:99]
  v_cndmask_b32_e64 v207, 0, v22, s[98:99]
  s_nop 0
  s_lshl_b64 s[98:99], s[98:99], 1
  v_cndmask_b32_e64 v208, 0, v22, s[98:99]
  v_cndmask_b32_e64 v209, 0, v22, s[98:99]
  v_cndmask_b32_e64 v210, 0, v22, s[98:99]
  v_cndmask_b32_e64 v211, 0, v22, s[98:99]
  s_nop 0
  s_lshl_b64 s[98:99], s[98:99], 1
  v_cndmask_b32_e64 v212, 0, v22, s[98:99]
  v_cndmask_b32_e64 v213, 0, v22, s[98:99]
  v_cndmask_b32_e64 v214, 0, v22, s[98:99]
  v_cndmask_b32_e64 v215, 0, v22, s[98:99]
  s_nop 0
  s_lshl_b64 s[98:99], s[98:99], 1
  v_cndmask_b32_e64 v216, 0, v22, s[98:99]
  v_cndmask_b32_e64 v217, 0, v22, s[98:99]
  v_cndmask_b32_e64 v218, 0, v22, s[98:99]
  v_cndmask_b32_e64 v219, 0, v22, s[98:99]
  s_nop 0
  s_lshl_b64 s[98:99], s[98:99], 1
  v_cndmask_b32_e64 v220, 0, v22, s[98:99]
  v_cndmask_b32_e64 v221, 0, v22, s[98:99]
  v_cndmask_b32_e64 v222, 0, v22, s[98:99]
  v_cndmask_b32_e64 v223, 0, v22, s[98:99]
  s_nop 0
  s_lshl_b64 s[98:99], s[98:99], 1
  v_cndmask_b32_e64 v224, 0, v22, s[98:99]
  v_cndmask_b32_e64 v225, 0, v22, s[98:99]
  v_cndmask_b32_e64 v226, 0, v22, s[98:99]
  v_cndmask_b32_e64 v227, 0, v22, s[98:99]
  s_nop 0
  s_lshl_b64 s[98:99], s[98:99], 1
  v_cndmask_b32_e64 v228, 0, v22, s[98:99]
  v_cndmask_b32_e64 v229, 0, v22, s[98:99]
  v_cndmask_b32_e64 v230, 0, v22, s[98:99]
  v_cndmask_b32_e64 v231, 0, v22, s[98:99]
  s_nop 0
  s_lshl_b64 s[98:99], s[98:99], 1
  v_cndmask_b32_e64 v232, 0, v22, s[98:99]
  v_cndmask_b32_e64 v233, 0, v22, s[98:99]
  v_cndmask_b32_e64 v234, 0, v22, s[98:99]
  v_cndmask_b32_e64 v235, 0, v22, s[98:99]
  s_nop 0
  s_lshl_b64 s[98:99], s[98:99], 1
  v_cndmask_b32_e64 v236, 0, v22, s[98:99]
  v_cndmask_b32_e64 v237, 0, v22, s[98:99]
  v_cndmask_b32_e64 v238, 0, v22, s[98:99]
  v_cndmask_b32_e64 v239, 0, v22, s[98:99]
  s_nop 0
  s_lshl_b64 s[98:99], s[98:99], 1
  v_cndmask_b32_e64 v240, 0, v22, s[98:99]
  v_cndmask_b32_e64 v241, 0, v22, s[98:99]
  v_cndmask_b32_e64 v242, 0, v22, s[98:99]
  v_cndmask_b32_e64 v243, 0, v22, s[98:99]
  s_nop 0
  s_lshl_b64 s[98:99], s[98:99], 1
  v_cndmask_b32_e64 v244, 0, v22, s[98:99]
  v_cndmask_b32_e64 v245, 0, v22, s[98:99]
  v_cndmask_b32_e64 v246, 0, v22, s[98:99]
  v_cndmask_b32_e64 v247, 0, v22, s[98:99]
  s_lshl_b64 s[98:99], s[98:99], 1
  s_mov_b32 s56, s24
  s_and_b32 s57, s25, 0xffff
  s_mov_b32 s58, 7340032
  s_mov_b32 s59, 0x00020000
  s_nop 0
  s_mov_b32 s60, s28
  s_and_b32 s61, s29, 0xffff
  s_mov_b32 s62, 7340032
  s_mov_b32 s63, 0x00020000
  s_mul_i32 s12, s84, Lz1-Lz0+14
  s_add_u32 s12, s12, 20480
  s_mov_b32 s13, s12
  v_lshlrev_b32 v110, 7, v1
  s_mov_b32 s8, 0x00500005
  s_mov_b32 s9, 0x50000500
L_slayer:
  s_barrier
  s_cmp_lg_u32 s82, Lz1-Lz0+0
  s_cbranch_scc1 L_119
  buffer_load_dwordx4 v[128:131], v108, s[44:47], s7 offen offset:0
  buffer_load_dwordx4 v[132:135], v108, s[44:47], s7 offen offset:128
  buffer_load_dwordx4 v[136:139], v108, s[44:47], s7 offen offset:256
  buffer_load_dwordx4 v[140:143], v108, s[44:47], s7 offen offset:384
  buffer_load_dwordx4 v[144:147], v108, s[44:47], s7 offen offset:512
  buffer_load_dwordx4 v[148:151], v108, s[44:47], s7 offen offset:640
  buffer_load_dwordx4 v[152:155], v108, s[44:47], s7 offen offset:768
  buffer_load_dwordx4 v[156:159], v108, s[44:47], s7 offen offset:896
  buffer_load_dwordx4 v[160:163], v108, s[44:47], s7 offen offset:1024
  buffer_load_dwordx4 v[164:167], v108, s[44:47], s7 offen offset:1152
  buffer_load_dwordx4 v[168:171], v108, s[44:47], s7 offen offset:1280
  buffer_load_dwordx4 v[172:175], v108, s[44:47], s7 offen offset:1408
  buffer_load_dwordx4 v[176:179], v108, s[44:47], s7 offen offset:1536
  buffer_load_dwordx4 v[180:183], v108, s[44:47], s7 offen offset:1664
  buffer_load_dwordx4 v[184:187], v108, s[44:47], s7 offen offset:1792
  buffer_load_dwordx4 v[188:191], v108, s[44:47], s7 offen offset:1920
  s_waitcnt vmcnt(16)
  s_lshl_b32 s4, s76, 4
  s_mov_b64 exec, 1
  buffer_atomic_add v11, v24, s[68:71], s4 offen sc1
  s_mov_b64 exec, -1
L_119:
  s_cmp_le_u32 s14, 0
  s_cbranch_scc1 L_121
  s_barrier
L_121:
  s_cmp_le_u32 s14, 1
  s_cbranch_scc1 L_122
  s_barrier
L_122:
  s_cmp_lg_u32 s82, 0
  s_cbranch_scc1 L_123
  ds_read_b64_tr_b16 v[32:33], v16 offset:0
  ds_read_b64_tr_b16 v[34:35], v16 offset:2048
  ds_read_b64_tr_b16 v[36:37], v17 offset:0
  ds_read_b64_tr_b16 v[38:39], v17 offset:2048
  ds_read_b64_tr_b16 v[40:41], v18 offset:0
  ds_read_b64_tr_b16 v[42:43], v18 offset:2048
  ds_read_b64_tr_b16 v[44:45], v19 offset:0
  ds_read_b64_tr_b16 v[46:47], v19 offset:2048
  ds_read_b64_tr_b16 v[48:49], v16 offset:4096
  ds_read_b64_tr_b16 v[50:51], v16 offset:6144
  ds_read_b64_tr_b16 v[52:53], v17 offset:4096
  ds_read_b64_tr_b16 v[54:55], v17 offset:6144
  s_nop 0
  s_waitcnt lgkmcnt(4)
  ds_read_b64_tr_b16 v[56:57], v18 offset:4096
  ds_read_b64_tr_b16 v[58:59], v18 offset:6144
  ds_read_b64_tr_b16 v[60:61], v19 offset:4096
  ds_read_b64_tr_b16 v[62:63], v19 offset:6144
  v_add_u32 v16, 8192, v16
  v_add_u32 v17, 8192, v17
  v_add_u32 v18, 8192, v18
  v_add_u32 v19, 8192, v19
  s_nop 0
  s_waitcnt lgkmcnt(2)
  ds_read_b64_tr_b16 v[64:65], v16 offset:0
  ds_read_b64_tr_b16 v[66:67], v16 offset:2048
  ds_read_b64_tr_b16 v[68:69], v17 offset:0
  ds_read_b64_tr_b16 v[70:71], v17 offset:2048
  ds_read_b64_tr_b16 v[72:73], v18 offset:0
  ds_read_b64_tr_b16 v[74:75], v18 offset:2048
  ds_read_b64_tr_b16 v[76:77], v19 offset:0
  ds_read_b64_tr_b16 v[78:79], v19 offset:2048
  ds_read_b64_tr_b16 v[80:81], v16 offset:4096
  ds_read_b64_tr_b16 v[82:83], v16 offset:6144
  ds_read_b64_tr_b16 v[84:85], v17 offset:4096
  ds_read_b64_tr_b16 v[86:87], v17 offset:6144
  s_nop 0
  s_waitcnt lgkmcnt(4)
  ds_read_b64_tr_b16 v[88:89], v18 offset:4096
  ds_read_b64_tr_b16 v[90:91], v18 offset:6144
  ds_read_b64_tr_b16 v[92:93], v19 offset:4096
  ds_read_b64_tr_b16 v[94:95], v19 offset:6144
  v_add_u32 v16, 8192, v16
  v_add_u32 v17, 8192, v17
  v_add_u32 v18, 8192, v18
  v_add_u32 v19, 8192, v19
  v_mfma_f32_16x16x32_bf16 v[28:31], v[32:35], v[200:203], 0
  v_mfma_f32_16x16x32_bf16 v[28:31], v[36:39], v[204:207], v[28:31]
  v_mfma_f32_16x16x32_bf16 v[28:31], v[40:43], v[208:211], v[28:31]
  v_mfma_f32_16x16x32_bf16 v[28:31], v[44:47], v[212:215], v[28:31]
  v_mfma_f32_16x16x32_bf16 v[28:31], v[48:51], v[200:203], v[28:31]
  v_mfma_f32_16x16x32_bf16 v[28:31], v[52:55], v[204:207], v[28:31]
  v_mfma_f32_16x16x32_bf16 v[28:31], v[56:59], v[208:211], v[28:31]
  v_mfma_f32_16x16x32_bf16 v[28:31], v[60:63], v[212:215], v[28:31]
  s_nop 0
  s_waitcnt lgkmcnt(2)
  ds_read_b64_tr_b16 v[32:33], v16 offset:0
  ds_read_b64_tr_b16 v[34:35], v16 offset:2048
  ds_read_b64_tr_b16 v[36:37], v17 offset:0
  ds_read_b64_tr_b16 v[38:39], v17 offset:2048
  ds_read_b64_tr_b16 v[40:41], v18 offset:0
  ds_read_b64_tr_b16 v[42:43], v18 offset:2048
  ds_read_b64_tr_b16 v[44:45], v19 offset:0
  ds_read_b64_tr_b16 v[46:47], v19 offset:2048
  ds_read_b64_tr_b16 v[48:49], v16 offset:4096
  ds_read_b64_tr_b16 v[50:51], v16 offset:6144
  ds_read_b64_tr_b16 v[52:53], v17 offset:4096
  ds_read_b64_tr_b16 v[54:55], v17 offset:6144
  s_nop 0
  s_waitcnt lgkmcnt(4)
  ds_read_b64_tr_b16 v[56:57], v18 offset:4096
  ds_read_b64_tr_b16 v[58:59], v18 offset:6144
  ds_read_b64_tr_b16 v[60:61], v19 offset:4096
  ds_read_b64_tr_b16 v[62:63], v19 offset:6144
  v_mfma_f32_16x16x32_bf16 v[28:31], v[64:67], v[216:219], v[28:31]
  v_mfma_f32_16x16x32_bf16 v[28:31], v[68:71], v[220:223], v[28:31]
  v_mfma_f32_16x16x32_bf16 v[28:31], v[72:75], v[224:227], v[28:31]
  v_mfma_f32_16x16x32_bf16 v[28:31], v[76:79], v[228:231], v[28:31]
  v_mfma_f32_16x16x32_bf16 v[28:31], v[80:83], v[216:219], v[28:31]
  v_mfma_f32_16x16x32_bf16 v[28:31], v[84:87], v[220:223], v[28:31]
  v_mfma_f32_16x16x32_bf16 v[28:31], v[88:91], v[224:227], v[28:31]
  v_mfma_f32_16x16x32_bf16 v[28:31], v[92:95], v[228:231], v[28:31]
  s_waitcnt lgkmcnt(0)
L_123:
  s_barrier
  s_cmp_lg_u32 s82, 0
  s_cbranch_scc1 L_125
  v_mfma_f32_16x16x32_bf16 v[28:31], v[32:35], v[232:235], v[28:31]
  v_mfma_f32_16x16x32_bf16 v[28:31], v[36:39], v[236:239], v[28:31]
  v_mfma_f32_16x16x32_bf16 v[28:31], v[40:43], v[240:243], v[28:31]
  v_mfma_f32_16x16x32_bf16 v[28:31], v[44:47], v[244:247], v[28:31]
  v_mfma_f32_16x16x32_bf16 v[28:31], v[48:51], v[232:235], v[28:31]
  v_mfma_f32_16x16x32_bf16 v[28:31], v[52:55], v[236:239], v[28:31]
  v_mfma_f32_16x16x32_bf16 v[28:31], v[56:59], v[240:243], v[28:31]
  v_mfma_f32_16x16x32_bf16 v[28:31], v[60:63], v[244:247], v[28:31]
  s_lshl_b32 s5, s77, 14
  s_lshl_b32 s4, s76, 10
  s_add_u32 s5, s5, s4
  s_add_u32 s5, s5, 1114112
  s_nop 3
  buffer_store_dwordx4 v[28:31], v15, s[40:43], s5 offen sc0 sc1
  s_branch L_126
L_125:
  s_lshl_b32 s91, s84, 1
  s_add_u32 s91, s91, s87
  s_add_u32 s91, s91, 0xfffffff0
  s_mov_b32 s16, 0xffff
  s_mov_b32 exec_lo, s16
  s_mov_b32 exec_hi, 0
  buffer_load_dword v7, v5, s[40:43], s91 offen sc0 sc1
  s_mov_b64 exec, -1
L_126:
  s_barrier
  s_cmp_lg_u32 s82, 0
  s_cbranch_scc1 L_127
  s_branch L_128
L_127:
  s_waitcnt vmcnt(0)
  s_mov_b32 s89, 200000
  s_mov_b32 exec_lo, s16
  s_mov_b32 exec_hi, 0
  s_branch Lp_130
Lp_129:
  buffer_load_dword v7, v5, s[40:43], s91 offen sc0 sc1
  s_waitcnt vmcnt(0)
Lp_130:
  v_cmp_ne_u32 vcc, 0, v7
  s_andn2_b32 s3, s16, vcc_lo
  s_cbranch_scc0 Lp_131
  s_sleep 1
  s_sub_u32 s89, s89, 1
  s_cbranch_scc0 Lp_129
Lp_131:
  s_mov_b64 exec, -1
  s_add_u32 s5, s84, s92
  buffer_load_dwordx2 v[96:97], v6, s[40:43], s5 offen offset:0 sc1
  buffer_load_dwordx2 v[98:99], v6, s[40:43], s5 offen offset:512 sc1
  buffer_load_dwordx2 v[100:101], v6, s[40:43], s5 offen offset:1024 sc1
  buffer_load_dwordx2 v[102:103], v6, s[40:43], s5 offen offset:1536 sc1
L_128:
  s_barrier
  s_cmp_gt_u32 s14, 0
  s_cbranch_scc1 L_132
  s_barrier
L_132:
  s_cmp_gt_u32 s14, Lz1-Lz0+1
  s_cbranch_scc1 L_133
  s_barrier
L_133:
  s_cmp_lg_u32 s82, 0
  s_cbranch_scc1 L_134
  s_waitcnt vmcnt(2)
  buffer_load_dword v9, v8, s[68:71], 0 offen sc0 sc1
  s_mov_b32 s72, s26
  s_and_b32 s73, s27, 0xffff
  s_mov_b32 s74, 7168
  s_mov_b32 s75, 0x00020000
  s_mul_i32 s4, s77, 448
  s_and_b32 s5, s77, Lz1-Lz0+1
  s_lshl_b32 s6, s5, 6
  s_add_u32 s6, s6, s4
  s_mul_i32 s5, s5, 384
  s_sub_u32 s5, s4, s5
  v_lshlrev_b32 v2, 1, v1
  v_lshrrev_b32 v3, 1, v2
  v_xor_b32 v3, v3, v2
  v_and_b32 v3, 16, v3
  v_mul_u32_u24 v3, 3, v3
  v_xor_b32_e64 v3, v3, v2
  buffer_load_ushort v104, v2, s[72:75], s6 offen offset:0
  buffer_load_ushort v105, v2, s[72:75], s6 offen offset:128
  buffer_load_ushort v106, v2, s[72:75], s6 offen offset:256
  buffer_load_ushort v107, v3, s[72:75], s5 offen offset:384
  s_nop 0
  s_mov_b32 s64, s30
  s_and_b32 s65, s31, 0xffff
  s_mov_b32 s66, 2048
  s_mov_b32 s67, 0x00020000
  s_lshl_b32 s4, s78, Lz1-Lz0+7
  buffer_load_ushort v108, v2, s[64:67], s4 offen
  v_mov_b32 v32, v22
  v_mov_b32 v33, v22
  v_mov_b32_e64 v34, v22
  v_mov_b32 v35, v22
  s_nop 1
  v_mfma_f32_16x16x32_bf16 v[96:99], v[32:35], v[128:131], 0
  v_mfma_f32_16x16x32_bf16 v[100:103], v[128:131], v[128:131], 0
  v_mfma_f32_16x16x32_bf16 v[96:99], v[32:35], v[132:135], v[96:99]
  v_mfma_f32_16x16x32_bf16 v[100:103], v[132:135], v[132:135], v[100:103]
  v_mfma_f32_16x16x32_bf16 v[96:99], v[32:35], v[136:139], v[96:99]
  v_mfma_f32_16x16x32_bf16 v[100:103], v[136:139], v[136:139], v[100:103]
  v_mfma_f32_16x16x32_bf16 v[96:99], v[32:35], v[140:143], v[96:99]
  v_mfma_f32_16x16x32_bf16 v[100:103], v[140:143], v[140:143], v[100:103]
L_134:
  s_barrier
  s_cmp_lg_u32 s82, Lz1-Lz0+0
  s_cbranch_scc1 L_136
  v_mfma_f32_16x16x32_bf16 v[96:99], v[32:35], v[144:147], v[96:99]
  v_mfma_f32_16x16x32_bf16 v[100:103], v[144:147], v[144:147], v[100:103]
  v_mfma_f32_16x16x32_bf16 v[96:99], v[32:35], v[148:151], v[96:99]
  v_mfma_f32_16x16x32_bf16 v[100:103], v[148:151], v[148:151], v[100:103]
  v_mfma_f32_16x16x32_bf16 v[96:99], v[32:35], v[152:155], v[96:99]
  v_mfma_f32_16x16x32_bf16 v[100:103], v[152:155], v[152:155], v[100:103]
  v_mfma_f32_16x16x32_bf16 v[96:99], v[32:35], v[156:159], v[96:99]
  v_mfma_f32_16x16x32_bf16 v[100:103], v[156:159], v[156:159], v[100:103]
L_136:
  s_barrier
  s_cmp_lg_u32 s82, Lz1-Lz0+0
  s_cbranch_scc1 L_138
  v_mfma_f32_16x16x32_bf16 v[96:99], v[32:35], v[160:163], v[96:99]
  v_mfma_f32_16x16x32_bf16 v[100:103], v[160:163], v[160:163], v[100:103]
  v_mfma_f32_16x16x32_bf16 v[96:99], v[32:35], v[164:167], v[96:99]
  v_mfma_f32_16x16x32_bf16 v[100:103], v[164:167], v[164:167], v[100:103]
  v_mfma_f32_16x16x32_bf16 v[96:99], v[32:35], v[168:171], v[96:99]
  v_mfma_f32_16x16x32_bf16 v[100:103], v[168:171], v[168:171], v[100:103]
  v_mfma_f32_16x16x32_bf16 v[96:99], v[32:35], v[172:175], v[96:99]
  v_mfma_f32_16x16x32_bf16 v[100:103], v[172:175], v[172:175], v[100:103]
  s_waitcnt vmcnt(0)
  s_mov_b32 s89, 200000
  s_branch Lg_141
Lg_140:
  buffer_load_dword v9, v8, s[68:71], 0 offen sc0 sc1
  s_waitcnt vmcnt(0)
Lg_141:
  v_cmp_eq_u32 vcc, 16, v9
  s_andn2_b32 s3, 0xffff, vcc_lo
  s_cbranch_scc0 Lg_142
  s_sleep 2
  s_sub_u32 s89, s89, 1
  s_cbranch_scc0 Lg_140
Lg_142:
  s_mov_b32 s5, 1835008
  s_mov_b64 exec, 0x101
  buffer_store_dword v11, v14, s[40:43], s5 offen sc0 sc1
  s_mov_b64 exec, -1
  s_getpc_b64 s[4:5]
L_pc0:
  s_sub_u32 s4, s4, L_pc0-mega_kernel
  s_nop 0
  s_subb_u32 s5, s5, 0
  s_bfe_u32 s6, s2, 0x20003
  s_mul_i32 s6, s6, 10240
  v_lshl_add_u32 v3, v1, 4, s6
  v_mov_b32_e64 v119, s5
  v_min_u32 v118, L_end-mega_kernel-16, v3
  v_add_co_u32_e64 v116, vcc, s4, v118
  v_add_u32 v3, 0x400, v3
  s_nop 0
  v_addc_co_u32 v117, vcc, 0, v119, vcc
  global_load_dwordx4 v[112:115], v[116:117], off
  v_min_u32 v118, L_end-mega_kernel-16, v3
  v_add_co_u32_e64 v116, vcc, s4, v118
  v_add_u32 v3, 0x400, v3
  s_nop 0
  v_addc_co_u32 v117, vcc, 0, v119, vcc
  global_load_dwordx4 v[112:115], v[116:117], off
  v_min_u32 v118, L_end-mega_kernel-16, v3
  v_add_co_u32_e64 v116, vcc, s4, v118
  v_add_u32 v3, 0x400, v3
  s_nop 0
  v_addc_co_u32 v117, vcc, 0, v119, vcc
  global_load_dwordx4 v[112:115], v[116:117], off
  v_min_u32 v118, L_end-mega_kernel-16, v3
  v_add_co_u32_e64 v116, vcc, s4, v118
  v_add_u32 v3, 0x400, v3
  s_nop 0
  v_addc_co_u32 v117, vcc, 0, v119, vcc
  global_load_dwordx4 v[112:115], v[116:117], off
  v_min_u32 v118, L_end-mega_kernel-16, v3
  v_add_co_u32 v116, vcc, s4, v118
  s_nop 1
  v_addc_co_u32 v117, vcc, 0, v119, vcc
  global_load_dwordx4 v[112:115], v[116:117], off
L_138:
  s_barrier
  s_cmp_lg_u32 s82, 0
  s_cbranch_scc1 L_143
  v_mfma_f32_16x16x32_bf16 v[96:99], v[32:35], v[176:179], v[96:99]
  v_mfma_f32_16x16x32_bf16 v[100:103], v[176:179], v[176:179], v[100:103]
  v_mfma_f32_16x16x32_bf16 v[96:99], v[32:35], v[180:183], v[96:99]
  v_mfma_f32_16x16x32_bf16 v[100:103], v[180:183], v[180:183], v[100:103]
  v_mfma_f32_16x16x32_bf16 v[96:99], v[32:35], v[184:187], v[96:99]
  v_mfma_f32_16x16x32_bf16 v[100:103], v[184:187], v[184:187], v[100:103]
  v_mfma_f32_16x16x32_bf16 v[96:99], v[32:35], v[188:191], v[96:99]
  v_mfma_f32_16x16x32_bf16 v[100:103], v[188:191], v[188:191], v[100:103]
  s_getpc_b64 s[4:5]
L_pc1:
  s_sub_u32 s4, s4, L_pc1-mega_kernel
  s_subb_u32 s5, s5, 0
  s_bfe_u32 s6, s2, 0x20003
  s_mul_i32 s6, s6, 10240
  s_add_u32 s6, s6, 5120
  v_lshl_add_u32 v3, v1, 4, s6
  v_mov_b32_e64 v119, s5
  v_min_u32 v118, L_end-mega_kernel-16, v3
  v_add_co_u32_e64 v116, vcc, s4, v118
  v_add_u32 v3, 0x400, v3
  s_nop 0
  v_addc_co_u32 v117, vcc, 0, v119, vcc
  global_load_dwordx4 v[112:115], v[116:117], off
  v_min_u32 v118, L_end-mega_kernel-16, v3
  v_add_co_u32_e64 v116, vcc, s4, v118
  v_add_u32 v3, 0x400, v3
  s_nop 0
  v_addc_co_u32 v117, vcc, 0, v119, vcc
  global_load_dwordx4 v[112:115], v[116:117], off
  v_min_u32 v118, L_end-mega_kernel-16, v3
  v_add_co_u32_e64 v116, vcc, s4, v118
  v_add_u32 v3, 0x400, v3
  s_nop 0
  v_addc_co_u32 v117, vcc, 0, v119, vcc
  global_load_dwordx4 v[112:115], v[116:117], off
  v_min_u32 v118, L_end-mega_kernel-16, v3
  v_add_co_u32_e64 v116, vcc, s4, v118
  v_add_u32 v3, 0x400, v3
  s_nop 0
  v_addc_co_u32 v117, vcc, 0, v119, vcc
  global_load_dwordx4 v[112:115], v[116:117], off
  v_min_u32 v118, L_end-mega_kernel-16, v3
  v_add_co_u32 v116, vcc, s4, v118
  s_nop 1
  v_addc_co_u32_e64 v117, vcc, 0, v119, vcc
  global_load_dwordx4 v[112:115], v[116:117], off
  s_mov_b32 s98, 0xaaaaaaaa
  s_mov_b32 s99, 0xaaaaaaaa
  v_cndmask_b32_e64 v100, v100, v101, s[98:99]
  v_cndmask_b32_e64 v102, v102, v103, s[98:99]
  s_mov_b32 s98, 0xcccccccc
  s_mov_b32 s99, 0xcccccccc
  v_cndmask_b32_e64 v97, v100, v102, s[98:99]
  v_add_f32_dpp v96, v96, v96 quad_perm:[1,0,3,2] row_mask:0xf bank_mask:0xf
  s_nop 0
  v_add_f32_dpp v97, v97, v97 quad_perm:[1,0,3,2] row_mask:0xf bank_mask:0xf
  s_branch L_144
L_143:
  s_waitcnt vmcnt(0)
  v_add_f32 v96, v96, v100
  v_add_f32 v97, v97, v101
  v_add_f32 v98, v98, v102
  v_add_f32 v99, v99, v103
  v_add_f32 v96, v96, v98
  v_add_f32 v97, v97, v99
  s_nop 0
  v_add_f32_dpp v96, v96, v96 row_ror:8 row_mask:0xf bank_mask:0xf
  v_add_f32_dpp v97, v97, v97 row_ror:8 row_mask:0xf bank_mask:0xf
  v_mov_b32 v98, v96
  v_mov_b32 v99, v97
  s_nop 0
  v_permlane16_swap_b32 v96, v98
  v_permlane16_swap_b32 v97, v99
  v_add_f32 v96, v96, v98
  v_add_f32 v97, v97, v99
  v_mov_b32 v98, v96
  v_mov_b32 v99, v97
  s_nop 0
  v_permlane32_swap_b32 v96, v98
  v_permlane32_swap_b32 v97, v99
  v_add_f32 v96, v96, v98
  v_add_f32 v97, v97, v99
L_144:
  v_mul_f32 v96, 0x3a800000, v96
  v_mul_f32 v97, 0x3a800000, v97
  v_fma_f32 v98, -v96, v96, v97
  v_max_f32_e64 v98, 0, v98
  v_add_f32 v98, 0x3727c5ac, v98
  v_rsq_f32 v98, v98
  s_nop 0
  v_mul_f32 v99, v96, v98
  s_mov_b64 exec, s[8:9]
  buffer_store_dwordx2 v[98:99], v6, s[40:43], s10 offen sc0 sc1
  s_mov_b64 exec, -1
  s_barrier
  s_cmp_lg_u32 s82, 0
  s_cbranch_scc1 L_145
  v_lshlrev_b32_e64 v6, 3, v1
  s_mov_b64 s[8:9], 0xff
  s_lshl_b32 s91, s84, Lz1-Lz0+1
  s_and_b32 s91, s91, 0x8f000
  s_add_u32 s91, s91, 1835008
  s_mov_b32 exec_lo, 0xffff
  s_mov_b32 exec_hi, Lz1-Lz0+0
  buffer_load_dword v7, v5, s[40:43], s91 offen sc0 sc1
  s_mov_b64 exec, -1
L_145:
  s_barrier
  s_barrier
  s_waitcnt vmcnt(0)
  s_and_b32 s5, s10, 0xfffffc00
  buffer_load_dwordx4 v[120:123], v4, s[40:43], s5 offen sc1
  s_cmp_lg_u32 s82, 0
  s_cbranch_scc1 L_147
  s_mov_b32 s89, 200000
  s_mov_b32 exec_lo, 0xffff
  s_mov_b32 exec_hi, 0
  s_branch Lp_150
Lp_149:
  buffer_load_dword v7, v5, s[40:43], s91 offen sc0 sc1
  s_waitcnt vmcnt(0)
Lp_150:
  v_cmp_ne_u32 vcc, 0, v7
  s_andn2_b32 s3, 0xffff, vcc_lo
  s_cbranch_scc0 Lp_151
  s_sleep 1
  s_sub_u32 s89, s89, 1
  s_cbranch_scc0 Lp_149
Lp_151:
  s_mov_b64 exec, -1
  s_lshl_b32 s5, s77, 14
  s_add_u32 s5, s5, 1114112
  buffer_load_dwordx4 v[192:195], v4, s[40:43], s5 offen offset:0 sc1
  buffer_load_dwordx4 v[196:199], v4, s[40:43], s5 offen offset:1024 sc1
  buffer_load_dwordx4 v[200:203], v4, s[40:43], s5 offen offset:2048 sc1
  buffer_load_dwordx4 v[204:207], v4, s[40:43], s5 offen offset:3072 sc1
  s_add_u32 s5, s5, 4096
  buffer_load_dwordx4 v[208:211], v4, s[40:43], s5 offen offset:0 sc1
  buffer_load_dwordx4 v[212:215], v4, s[40:43], s5 offen offset:1024 sc1
  buffer_load_dwordx4 v[216:219], v4, s[40:43], s5 offen offset:2048 sc1
  buffer_load_dwordx4 v[220:223], v4, s[40:43], s5 offen offset:3072 sc1
L_147:
  s_barrier
  s_cmp_lg_u32 s82, 0
  s_cbranch_scc1 L_152
  s_lshl_b32 s5, s77, 14
  s_add_u32 s5, s5, 1122304
  buffer_load_dwordx4 v[224:227], v4, s[40:43], s5 offen offset:0 sc1
  buffer_load_dwordx4 v[228:231], v4, s[40:43], s5 offen offset:1024 sc1
  buffer_load_dwordx4 v[232:235], v4, s[40:43], s5 offen offset:2048 sc1
  buffer_load_dwordx4 v[236:239], v4, s[40:43], s5 offen offset:3072 sc1
  s_add_u32 s5, s5, 4096
  buffer_load_dwordx4 v[240:243], v4, s[40:43], s5 offen offset:0 sc1
  buffer_load_dwordx4 v[244:247], v4, s[40:43], s5 offen offset:1024 sc1
  buffer_load_dwordx4 v[248:251], v4, s[40:43], s5 offen offset:2048 sc1
  buffer_load_dwordx4 v[252:255], v4, s[40:43], s5 offen offset:3072 sc1
L_152:
  s_barrier
  s_cmp_lg_u32 s82, 0
  s_cbranch_scc1 L_154
  s_waitcnt vmcnt(16)
  s_branch L_155
L_154:
  s_waitcnt vmcnt(0)
L_155:
  s_mov_b32 s89, 200000
  s_branch Lp_157
  s_nop 0
Lp_156:
  s_and_b32 s5, s10, 0xfffffc00
  buffer_load_dwordx4 v[120:123], v4, s[40:43], s5 offen sc1
  s_waitcnt vmcnt(0)
Lp_157:
  v_min_u32 v2, v120, v122
  v_cmp_eq_u32 vcc, 0, v2
  s_cmp_eq_u64 vcc, 0
  s_cbranch_scc1 Lp_158
  s_sleep 1
  s_sub_u32 s89, s89, 1
  s_cbranch_scc0 Lp_156
Lp_158:
  s_and_b32 s5, s10, 0xfffffc00
  s_mov_b32 m0, 151552
  s_nop 0
  buffer_load_dword v6, s[40:43], s5 offen offset:0 sc1 lds
  s_mov_b32 m0, 152188
  s_nop 0
  buffer_load_dword v6, s[40:43], s5 offen offset:4 sc1 lds
  s_mov_b32 m0, 151360
  s_nop 0
  buffer_load_dword v6, s[40:43], s5 offen offset:512 sc1 lds
  s_mov_b32 m0, 151996
  s_nop 0
  buffer_load_dword v6, s[40:43], s5 offen offset:516 sc1 lds
  s_add_u32 s10, s10, 16384
  s_cmp_lg_u32 s82, 0
  s_cbranch_scc1 L_159
  buffer_load_dword v109, v110, s[56:59], s12 offen
  s_sub_u32 s12, s12, 8192
L_159:
  s_barrier
  s_cmp_lg_u32 s82, 0
  s_cbranch_scc1 L_161
  s_cmp_lg_u32 s82, 0
  s_cbranch_scc1 L_163
  s_waitcnt vmcnt(1)
  s_branch L_164
L_163:
  s_waitcnt vmcnt(0)
L_164:
  v_add_f32 v192, v192, v224
  v_add_f32 v193, v193, v225
  v_add_f32 v194, v194, v226
  v_add_f32 v195, v195, v227
  v_add_f32 v196, v196, v228
  v_add_f32 v197, v197, v229
  v_add_f32 v198, v198, v230
  v_add_f32 v199, v199, v231
  v_add_f32 v200, v200, v232
  v_add_f32 v201, v201, v233
  v_add_f32 v202, v202, v234
  v_add_f32 v203, v203, v235
  v_add_f32 v204, v204, v236
  v_add_f32 v205, v205, v237
  v_add_f32 v206, v206, v238
  v_add_f32 v207, v207, v239
  v_add_f32 v208, v208, v240
  v_add_f32 v209, v209, v241
  v_add_f32 v210, v210, v242
  v_add_f32 v211, v211, v243
  v_add_f32 v212, v212, v244
  v_add_f32 v213, v213, v245
  v_add_f32 v214, v214, v246
  v_add_f32 v215, v215, v247
  v_add_f32 v216, v216, v248
  v_add_f32 v217, v217, v249
  v_add_f32 v218, v218, v250
  v_add_f32 v219, v219, v251
  v_add_f32 v220, v220, v252
  v_add_f32 v221, v221, v253
  v_add_f32 v222, v222, v254
  v_add_f32 v223, v223, v255
  v_add_f32 v192, v192, v208
  v_add_f32 v193, v193, v209
  v_add_f32 v194, v194, v210
  v_add_f32 v195, v195, v211
  v_add_f32 v196, v196, v212
  v_add_f32 v197, v197, v213
  v_add_f32 v198, v198, v214
  v_add_f32 v199, v199, v215
  v_add_f32 v200, v200, v216
  v_add_f32 v201, v201, v217
  v_add_f32 v202, v202, v218
  v_add_f32 v203, v203, v219
  v_add_f32 v204, v204, v220
  v_add_f32 v205, v205, v221
  v_add_f32 v206, v206, v222
  v_add_f32 v207, v207, v223
  v_add_f32 v192, v192, v200
  v_add_f32 v193, v193, v201
  v_add_f32 v194, v194, v202
  v_add_f32 v195, v195, v203
  v_add_f32 v196, v196, v204
  v_add_f32 v197, v197, v205
  v_add_f32 v198, v198, v206
  v_add_f32 v199, v199, v207
  v_add_f32 v192, v192, v196
  v_add_f32 v193, v193, v197
  v_add_f32 v194, v194, v198
  v_add_f32 v195, v195, v199
  v_add_u32 v2, 153088, v4
  ds_write_b128 v2, v[192:195]
L_161:
  s_cmp_lg_u32 s82, 0
  s_cbranch_scc1 L_165
  buffer_load_dword v109, v110, s[56:59], s12 offen
  s_sub_u32 s12, s12, 8192
L_165:
  s_barrier
  s_cmp_lg_u32 s82, 0
  s_cbranch_scc1 L_167
  s_waitcnt vmcnt(2)
  s_branch L_168
  s_nop 0
L_167:
  s_waitcnt vmcnt(0)
L_168:
  s_waitcnt lgkmcnt(0)
  s_barrier
  s_cmp_lg_u32 s82, 0
  s_cbranch_scc1 L_169
  v_lshlrev_b32 v2, 2, v1
  v_add_u32 v2, 155136, v2
  v_lshlrev_b32_e64 v104, 16, v104
  v_mul_f32 v104, 0x3eeff558, v104
  ds_write_b32 v2, v104 offset:0
  v_lshlrev_b32_e64 v105, 16, v105
  v_mul_f32 v105, 0x3eeff558, v105
  ds_write_b32 v2, v105 offset:256
  v_lshlrev_b32_e64 v106, 16, v106
  v_mul_f32 v106, 0x3eeff558, v106
  ds_write_b32 v2, v106 offset:512
  v_lshlrev_b32_e64 v107, 16, v107
  v_mul_f32 v107, 0x3eeff558, v107
  ds_write_b32 v2, v107 offset:768
  v_lshlrev_b32_e64 v108, 16, v108
  ds_write_b32 v2, v108 offset:1024
  v_lshrrev_b32 v2, 2, v1
  v_lshlrev_b32 v22, 7, v2
  v_lshlrev_b32 v96, 6, v2
  v_and_b32 v2, 3, v1
  v_lshl_add_u32 v22, v2, 3, v22
  v_lshl_add_u32 v96, v2, 3, v96
  v_add_u32 v22, 65536, v22
  v_add_u32 v96, 90112, v96
  v_bfe_u32 v3, v1, 3, 2
  v_xor_b32_e64 v2, 0, v3
  v_lshl_add_u32 v16, v2, 5, v22
  v_xor_b32_e64 v2, 1, v3
  v_lshl_add_u32 v17, v2, 5, v22
  v_xor_b32_e64 v2, 2, v3
  v_lshl_add_u32 v18, v2, 5, v22
  v_xor_b32_e64 v2, 3, v3
  v_lshl_add_u32 v19, v2, 5, v22
  v_bfe_u32 v3, v1, 4, 1
  v_xor_b32_e64 v2, 0, v3
  v_lshl_add_u32 v20, v2, 5, v96
  v_xor_b32_e64 v2, 1, v3
  v_lshl_add_u32 v21, v2, 5, v96
  v_mov_b32 v22, 0x3f803f80
  s_mov_b32 s98, 0x00010001
  s_mov_b32 s99, 0x00010001
  v_cndmask_b32_e64 v200, 0, v22, s[98:99]
  v_cndmask_b32_e64 v201, 0, v22, s[98:99]
  v_cndmask_b32_e64 v202, 0, v22, s[98:99]
  v_cndmask_b32_e64 v203, 0, v22, s[98:99]
  s_nop 0
  s_lshl_b64 s[98:99], s[98:99], 1
  v_cndmask_b32_e64 v204, 0, v22, s[98:99]
  v_cndmask_b32_e64 v205, 0, v22, s[98:99]
  v_cndmask_b32_e64 v206, 0, v22, s[98:99]
  v_cndmask_b32_e64 v207, 0, v22, s[98:99]
  s_nop 0
  s_lshl_b64 s[98:99], s[98:99], 1
  v_cndmask_b32_e64 v208, 0, v22, s[98:99]
  v_cndmask_b32_e64 v209, 0, v22, s[98:99]
  v_cndmask_b32_e64 v210, 0, v22, s[98:99]
  v_cndmask_b32_e64 v211, 0, v22, s[98:99]
  s_nop 0
  s_lshl_b64 s[98:99], s[98:99], 1
  v_cndmask_b32_e64 v212, 0, v22, s[98:99]
  v_cndmask_b32_e64 v213, 0, v22, s[98:99]
  v_cndmask_b32_e64 v214, 0, v22, s[98:99]
  v_cndmask_b32_e64 v215, 0, v22, s[98:99]
  s_nop 0
  s_lshl_b64 s[98:99], s[98:99], 1
  v_cndmask_b32_e64 v216, 0, v22, s[98:99]
  v_cndmask_b32_e64 v217, 0, v22, s[98:99]
  v_cndmask_b32_e64 v218, 0, v22, s[98:99]
  v_cndmask_b32_e64 v219, 0, v22, s[98:99]
  s_nop 0
  s_lshl_b64 s[98:99], s[98:99], 1
  v_cndmask_b32_e64 v220, 0, v22, s[98:99]
  v_cndmask_b32_e64 v221, 0, v22, s[98:99]
  v_cndmask_b32_e64 v222, 0, v22, s[98:99]
  v_cndmask_b32_e64 v223, 0, v22, s[98:99]
  s_nop 0
  s_lshl_b64 s[98:99], s[98:99], 1
  v_cndmask_b32_e64 v224, 0, v22, s[98:99]
  v_cndmask_b32_e64 v225, 0, v22, s[98:99]
  v_cndmask_b32_e64 v226, 0, v22, s[98:99]
  v_cndmask_b32_e64 v227, 0, v22, s[98:99]
  s_nop 0
  s_lshl_b64 s[98:99], s[98:99], 1
  v_cndmask_b32_e64 v228, 0, v22, s[98:99]
  v_cndmask_b32_e64 v229, 0, v22, s[98:99]
  v_cndmask_b32_e64 v230, 0, v22, s[98:99]
  v_cndmask_b32_e64 v231, 0, v22, s[98:99]
  s_nop 0
  s_lshl_b64 s[98:99], s[98:99], 1
  v_cndmask_b32_e64 v232, 0, v22, s[98:99]
  v_cndmask_b32_e64 v233, 0, v22, s[98:99]
  v_cndmask_b32_e64 v234, 0, v22, s[98:99]
  v_cndmask_b32_e64 v235, 0, v22, s[98:99]
  s_nop 0
  s_lshl_b64 s[98:99], s[98:99], 1
  v_cndmask_b32_e64 v236, 0, v22, s[98:99]
  v_cndmask_b32_e64 v237, 0, v22, s[98:99]
  v_cndmask_b32_e64 v238, 0, v22, s[98:99]
  v_cndmask_b32_e64 v239, 0, v22, s[98:99]
  s_nop 0
  s_lshl_b64 s[98:99], s[98:99], 1
  v_cndmask_b32_e64 v240, 0, v22, s[98:99]
  v_cndmask_b32_e64 v241, 0, v22, s[98:99]
  v_cndmask_b32_e64 v242, 0, v22, s[98:99]
  v_cndmask_b32_e64 v243, 0, v22, s[98:99]
  s_nop 0
  s_lshl_b64 s[98:99], s[98:99], 1
  v_cndmask_b32_e64 v244, 0, v22, s[98:99]
  v_cndmask_b32_e64 v245, 0, v22, s[98:99]
  v_cndmask_b32_e64 v246, 0, v22, s[98:99]
  v_cndmask_b32_e64 v247, 0, v22, s[98:99]
  s_nop 0
  s_lshl_b64 s[98:99], s[98:99], 1
  v_cndmask_b32_e64 v248, 0, v22, s[98:99]
  v_cndmask_b32_e64 v249, 0, v22, s[98:99]
  v_cndmask_b32_e64 v250, 0, v22, s[98:99]
  v_cndmask_b32_e64 v251, 0, v22, s[98:99]
  s_nop 0
  s_lshl_b64 s[98:99], s[98:99], 1
  v_cndmask_b32_e64 v252, 0, v22, s[98:99]
  v_cndmask_b32_e64 v253, 0, v22, s[98:99]
  v_cndmask_b32_e64 v254, 0, v22, s[98:99]
  v_cndmask_b32_e64 v255, 0, v22, s[98:99]
  s_lshl_b64 s[98:99], s[98:99], 1
L_169:
  s_lshl_b32 s91, s84, 1
  s_add_u32 s91, s91, s87
  s_barrier
  s_mov_b32 exec_lo, 0xffff
  s_mov_b32 exec_hi, 0
  buffer_load_dword v7, v5, s[40:43], s91 offen sc0 sc1
  s_mov_b64 exec, -1
  s_barrier
  s_barrier
  s_barrier
  s_waitcnt vmcnt(0)
  s_mov_b32 s89, 200000
  s_mov_b32 exec_lo, 0xffff
  s_mov_b32 exec_hi, 0
  s_branch Lp_172
Lp_171:
  buffer_load_dword v7, v5, s[40:43], s91 offen sc0 sc1
  s_waitcnt vmcnt(0)
Lp_172:
  v_cmp_ne_u32 vcc, 0, v7
  s_andn2_b32 s3, 0xffff, vcc_lo
  s_cbranch_scc0 Lp_173
  s_sleep 1
  s_sub_u32 s89, s89, 1
  s_cbranch_scc0 Lp_171
Lp_173:
  s_mov_b64 exec, -1
  s_barrier
  s_barrier
  s_barrier
  s_barrier
  s_barrier
  s_barrier
  s_barrier
  s_barrier
  s_barrier
  s_barrier
  s_barrier
  s_barrier
  s_barrier
  s_add_u32 s92, s83, 31457280
  s_add_u32 s91, s91, 4
  s_sub_u32 s16, s78, s76
  s_add_u32 s16, s16, 1
  s_and_b32 s16, s16, 15
  s_barrier
  s_cmp_lg_u32 s82, 0
  s_cbranch_scc1 L_174
  s_cmp_eq_u32 s16, 1
  s_cselect_b32 s4, 0, 28672
  v_add_u32 v112, s4, v16
  v_add_u32 v113, s4, v17
  v_add_u32 v114, s4, v18
  v_add_u32 v115, s4, v19
  v_add_u32 v116, s4, v20
  v_add_u32 v117, s4, v21
  ds_read_b64_tr_b16 v[32:33], v112 offset:0
  ds_read_b64_tr_b16 v[34:35], v112 offset:2048
  ds_read_b64_tr_b16 v[36:37], v113 offset:0
  ds_read_b64_tr_b16 v[38:39], v113 offset:2048
  ds_read_b64_tr_b16 v[40:41], v114 offset:0
  ds_read_b64_tr_b16 v[42:43], v114 offset:2048
  ds_read_b64_tr_b16 v[44:45], v115 offset:0
  ds_read_b64_tr_b16 v[46:47], v115 offset:2048
  ds_read_b64_tr_b16 v[48:49], v112 offset:4096
  ds_read_b64_tr_b16 v[50:51], v112 offset:6144
  ds_read_b64_tr_b16 v[52:53], v113 offset:4096
  ds_read_b64_tr_b16 v[54:55], v113 offset:6144
  s_nop 0
  s_waitcnt lgkmcnt(6)
  ds_read_b64_tr_b16 v[56:57], v114 offset:4096
  ds_read_b64_tr_b16 v[58:59], v114 offset:6144
  ds_read_b64_tr_b16 v[60:61], v115 offset:4096
  ds_read_b64_tr_b16 v[62:63], v115 offset:6144
  s_nop 0
  s_waitcnt lgkmcnt(6)
  ds_read_b64_tr_b16 v[64:65], v112 offset:8192
  ds_read_b64_tr_b16 v[66:67], v112 offset:10240
  ds_read_b64_tr_b16 v[68:69], v113 offset:8192
  ds_read_b64_tr_b16 v[70:71], v113 offset:10240
  ds_read_b64_tr_b16 v[72:73], v114 offset:8192
  ds_read_b64_tr_b16 v[74:75], v114 offset:10240
  ds_read_b64_tr_b16 v[76:77], v115 offset:8192
  ds_read_b64_tr_b16 v[78:79], v115 offset:10240
  s_nop 0
  s_waitcnt lgkmcnt(8)
  v_mfma_f32_16x16x32_bf16 v[28:31], v[32:35], v[200:203], 0
  v_mfma_f32_16x16x32_bf16 v[28:31], v[36:39], v[204:207], v[28:31]
  v_mfma_f32_16x16x32_bf16 v[28:31], v[40:43], v[208:211], v[28:31]
  v_mfma_f32_16x16x32_bf16 v[28:31], v[44:47], v[212:215], v[28:31]
  v_mfma_f32_16x16x32_bf16 v[28:31], v[48:51], v[200:203], v[28:31]
  v_mfma_f32_16x16x32_bf16 v[28:31], v[52:55], v[204:207], v[28:31]
  v_mfma_f32_16x16x32_bf16 v[28:31], v[56:59], v[208:211], v[28:31]
  v_mfma_f32_16x16x32_bf16 v[28:31], v[60:63], v[212:215], v[28:31]
  s_nop 0
  s_waitcnt lgkmcnt(7)
  ds_read_b64_tr_b16 v[80:81], v112 offset:12288
  ds_read_b64_tr_b16 v[82:83], v112 offset:14336
  ds_read_b64_tr_b16 v[84:85], v113 offset:12288
  ds_read_b64_tr_b16 v[86:87], v113 offset:14336
  ds_read_b64_tr_b16 v[88:89], v114 offset:12288
  ds_read_b64_tr_b16 v[90:91], v114 offset:14336
  ds_read_b64_tr_b16 v[92:93], v115 offset:12288
  ds_read_b64_tr_b16 v[94:95], v115 offset:14336
  s_nop 0
  s_waitcnt lgkmcnt(6)
  ds_read_b64_tr_b16 v[128:129], v112 offset:16384
  ds_read_b64_tr_b16 v[130:131], v112 offset:18432
  ds_read_b64_tr_b16 v[132:133], v113 offset:16384
  ds_read_b64_tr_b16 v[134:135], v113 offset:18432
  ds_read_b64_tr_b16 v[136:137], v114 offset:16384
  ds_read_b64_tr_b16 v[138:139], v114 offset:18432
  ds_read_b64_tr_b16 v[140:141], v115 offset:16384
  ds_read_b64_tr_b16 v[142:143], v115 offset:18432
  s_nop 0
  s_waitcnt lgkmcnt(8)
  v_mfma_f32_16x16x32_bf16 v[28:31], v[64:67], v[216:219], v[28:31]
  v_mfma_f32_16x16x32_bf16 v[28:31], v[68:71], v[220:223], v[28:31]
  v_mfma_f32_16x16x32_bf16 v[28:31], v[72:75], v[224:227], v[28:31]
  v_mfma_f32_16x16x32_bf16 v[28:31], v[76:79], v[228:231], v[28:31]
  v_mfma_f32_16x16x32_bf16 v[28:31], v[80:83], v[216:219], v[28:31]
  v_mfma_f32_16x16x32_bf16 v[28:31], v[84:87], v[220:223], v[28:31]
  v_mfma_f32_16x16x32_bf16 v[28:31], v[88:91], v[224:227], v[28:31]
  v_mfma_f32_16x16x32_bf16 v[28:31], v[92:95], v[228:231], v[28:31]
  s_nop 0
  s_waitcnt lgkmcnt(7)
  ds_read_b64_tr_b16 v[144:145], v112 offset:20480
  ds_read_b64_tr_b16 v[146:147], v112 offset:22528
  ds_read_b64_tr_b16 v[148:149], v113 offset:20480
  ds_read_b64_tr_b16 v[150:151], v113 offset:22528
  ds_read_b64_tr_b16 v[152:153], v114 offset:20480
  ds_read_b64_tr_b16 v[154:155], v114 offset:22528
  ds_read_b64_tr_b16 v[156:157], v115 offset:20480
  ds_read_b64_tr_b16 v[158:159], v115 offset:22528
  s_nop 0
  s_waitcnt lgkmcnt(6)
  ds_read_b64_tr_b16 v[160:161], v116 offset:0
  ds_read_b64_tr_b16 v[162:163], v116 offset:1024
  ds_read_b64_tr_b16 v[164:165], v117 offset:0
  ds_read_b64_tr_b16 v[166:167], v117 offset:1024
  ds_read_b64_tr_b16 v[176:177], v116 offset:2048
  ds_read_b64_tr_b16 v[178:179], v116 offset:3072
  ds_read_b64_tr_b16 v[180:181], v117 offset:2048
  ds_read_b64_tr_b16 v[182:183], v117 offset:3072
  s_nop 0
  s_waitcnt lgkmcnt(8)
  v_mfma_f32_16x16x32_bf16 v[28:31], v[128:131], v[232:235], v[28:31]
  v_mfma_f32_16x16x32_bf16 v[28:31], v[132:135], v[236:239], v[28:31]
  v_mfma_f32_16x16x32_bf16 v[28:31], v[136:139], v[240:243], v[28:31]
  v_mfma_f32_16x16x32_bf16 v[28:31], v[140:143], v[244:247], v[28:31]
  v_mfma_f32_16x16x32_bf16 v[28:31], v[144:147], v[232:235], v[28:31]
  v_mfma_f32_16x16x32_bf16 v[28:31], v[148:151], v[236:239], v[28:31]
  v_mfma_f32_16x16x32_bf16 v[28:31], v[152:155], v[240:243], v[28:31]
  v_mfma_f32_16x16x32_bf16 v[28:31], v[156:159], v[244:247], v[28:31]
  s_waitcnt lgkmcnt(7)
  s_waitcnt lgkmcnt(0)
  v_mfma_f32_16x16x32_bf16 v[28:31], v[160:163], v[248:251], v[28:31]
  v_mfma_f32_16x16x32_bf16 v[28:31], v[164:167], v[252:255], v[28:31]
  v_mfma_f32_16x16x32_bf16 v[28:31], v[176:179], v[248:251], v[28:31]
  v_mfma_f32_16x16x32_bf16 v[28:31], v[180:183], v[252:255], v[28:31]
  s_lshl_b32 s5, s77, Lz1-Lz0+14
  s_lshl_b32 s4, s76, 10
  s_add_u32 s5, s5, s4
  s_add_u32 s5, s5, 1376256
  s_nop 3
  buffer_store_dwordx4 v[28:31], v15, s[40:43], s5 offen sc0 sc1
L_174:
  s_barrier
  s_mov_b32 exec_lo, 0xffff
  s_mov_b32 exec_hi, 0
  buffer_load_dword v7, v5, s[40:43], s91 offen sc0 sc1
  s_mov_b64 exec, -1
  s_barrier
  s_waitcnt vmcnt(0)
  s_mov_b32 s89, 200000
  s_mov_b32 exec_lo, 0xffff
  s_mov_b32 exec_hi, 0
  s_branch Lp_177
Lp_176:
  buffer_load_dword v7, v5, s[40:43], s91 offen sc0 sc1
  s_waitcnt vmcnt(0)
Lp_177:
  v_cmp_ne_u32 vcc, 0, v7
  s_andn2_b32 s3, 0xffff, vcc_lo
  s_cbranch_scc0 Lp_178
  s_sleep 1
  s_sub_u32 s89, s89, Lz1-Lz0+1
  s_cbranch_scc0 Lp_176
Lp_178:
  s_mov_b64 exec, -1
  s_cmp_lg_u32 s82, 0
  s_cbranch_scc1 L_179
  s_mov_b32 s5, 1835012
  s_mov_b64 exec, 0x101
  buffer_store_dword v11, v14, s[40:43], s5 offen sc0 sc1
  s_mov_b64 exec, -1
L_179:
  s_add_u32 s5, s84, s92
  buffer_load_dwordx2 v[96:97], v6, s[40:43], s5 offen offset:0 sc1
  buffer_load_dwordx2 v[98:99], v6, s[40:43], s5 offen offset:512 sc1
  buffer_load_dwordx2 v[100:101], v6, s[40:43], s5 offen offset:1024 sc1
  buffer_load_dwordx2 v[102:103], v6, s[40:43], s5 offen offset:1536 sc1
  s_barrier
  s_barrier
  s_barrier
  s_waitcnt vmcnt(0)
  v_add_f32 v96, v96, v100
  v_add_f32 v97, v97, v101
  v_add_f32 v98, v98, v102
  v_add_f32 v99, v99, v103
  v_add_f32_e64 v96, v96, v98
  v_add_f32 v97, v97, v99
  s_nop 0
  v_add_f32_dpp v96, v96, v96 row_ror:8 row_mask:0xf bank_mask:0xf
  v_add_f32_dpp v97, v97, v97 row_ror:8 row_mask:0xf bank_mask:0xf
  v_mov_b32 v98, v96
  v_mov_b32 v99, v97
  s_nop 0
  v_permlane16_swap_b32 v96, v98
  v_permlane16_swap_b32 v97, v99
  v_add_f32 v96, v96, v98
  v_add_f32 v97, v97, v99
  v_mov_b32 v98, v96
  v_mov_b32 v99, v97
  s_nop 0
  v_permlane32_swap_b32 v96, v98
  v_permlane32_swap_b32 v97, v99
  v_add_f32 v96, v96, v98
  v_add_f32 v97, v97, v99
  v_mul_f32 v96, 0x3a800000, v96
  v_mul_f32 v97, 0x3a800000, v97
  v_fma_f32 v98, -v96, v96, v97
  v_max_f32_e64 v98, 0, v98
  v_add_f32 v98, 0x3727c5ac, v98
  v_rsq_f32 v98, v98
  s_nop 0
  v_mul_f32 v99, v96, v98
  s_mov_b64 exec, s[8:9]
  buffer_store_dwordx2 v[98:99], v6, s[40:43], s10 offen sc0 sc1
  s_mov_b64 exec, -1
  s_barrier
  s_barrier
  s_barrier
  s_barrier
  s_barrier
  s_cmp_lg_u32 s82, 0
  s_cbranch_scc1 L_181
  s_lshl_b32 s91, s84, Lz1-Lz0+1
  s_and_b32 s91, s91, 0x8f000
  s_add_u32 s91, s91, 1835012
  s_mov_b32 exec_lo, 0xffff
  s_mov_b32 exec_hi, 0
  buffer_load_dword v7, v5, s[40:43], s91 offen sc0 sc1
  s_mov_b64 exec, -1
L_181:
  s_and_b32 s5, s10, 0xfffffc00
  buffer_load_dwordx4 v[120:123], v4, s[40:43], s5 offen sc1
  s_barrier
  s_barrier
  s_waitcnt vmcnt(0)
  s_mov_b32 s89, 200000
  s_branch Lp_184
Lp_183:
  s_and_b32 s5, s10, 0xfffffc00
  buffer_load_dwordx4 v[120:123], v4, s[40:43], s5 offen sc1
  s_waitcnt vmcnt(0)
Lp_184:
  v_min_u32 v2, v120, v122
  v_cmp_eq_u32 vcc, 0, v2
  s_cmp_eq_u64 vcc, 0
  s_cbranch_scc1 Lp_185
  s_sleep 1
  s_sub_u32 s89, s89, 1
  s_cbranch_scc0 Lp_183
Lp_185:
  s_and_b32 s5, s10, 0xfffffc00
  s_mov_b32 m0, 151552
  s_nop 0
  buffer_load_dword v6, s[40:43], s5 offen offset:0 sc1 lds
  s_mov_b32 m0, 152188
  s_nop 0
  buffer_load_dword v6, s[40:43], s5 offen offset:4 sc1 lds
  s_mov_b32 m0, 151360
  s_nop 0
  buffer_load_dword v6, s[40:43], s5 offen offset:512 sc1 lds
  s_mov_b32 m0, 151996
  s_nop 0
  buffer_load_dword v6, s[40:43], s5 offen offset:516 sc1 lds
  s_add_u32 s10, s10, 16384
  s_cmp_lg_u32 s82, 0
  s_cbranch_scc1 L_186
  s_mov_b32 s89, 200000
  s_mov_b32 exec_lo, 0xffff
  s_mov_b32 exec_hi, 0
  s_branch Lp_189
Lp_188:
  buffer_load_dword v7, v5, s[40:43], s91 offen sc0 sc1
  s_waitcnt vmcnt(0)
Lp_189:
  v_cmp_ne_u32 vcc, 0, v7
  s_andn2_b32 s3, 0xffff, vcc_lo
  s_cbranch_scc0 Lp_190
  s_sleep 1
  s_sub_u32 s89, s89, 1
  s_cbranch_scc0 Lp_188
Lp_190:
  s_mov_b64 exec, -1
  s_lshl_b32 s5, s77, 14
  s_add_u32 s5, s5, 1376256
  buffer_load_dwordx4 v[192:195], v4, s[40:43], s5 offen offset:0 sc1
  buffer_load_dwordx4 v[196:199], v4, s[40:43], s5 offen offset:1024 sc1
  buffer_load_dwordx4 v[200:203], v4, s[40:43], s5 offen offset:2048 sc1
  buffer_load_dwordx4 v[204:207], v4, s[40:43], s5 offen offset:3072 sc1
  s_add_u32 s5, s5, 4096
  buffer_load_dwordx4 v[208:211], v4, s[40:43], s5 offen offset:0 sc1
  buffer_load_dwordx4 v[212:215], v4, s[40:43], s5 offen offset:1024 sc1
  buffer_load_dwordx4 v[216:219], v4, s[40:43], s5 offen offset:2048 sc1
  buffer_load_dwordx4 v[220:223], v4, s[40:43], s5 offen offset:3072 sc1
L_186:
  s_barrier
  s_cmp_lg_u32 s82, 0
  s_cbranch_scc1 L_191
  s_lshl_b32 s5, s77, 14
  s_add_u32 s5, s5, 1384448
  buffer_load_dwordx4 v[224:227], v4, s[40:43], s5 offen offset:0 sc1
  buffer_load_dwordx4 v[228:231], v4, s[40:43], s5 offen offset:1024 sc1
  buffer_load_dwordx4 v[232:235], v4, s[40:43], s5 offen offset:2048 sc1
  buffer_load_dwordx4 v[236:239], v4, s[40:43], s5 offen offset:3072 sc1
  s_add_u32 s5, s5, 4096
  buffer_load_dwordx4 v[240:243], v4, s[40:43], s5 offen offset:0 sc1
  buffer_load_dwordx4 v[244:247], v4, s[40:43], s5 offen offset:1024 sc1
  buffer_load_dwordx4 v[248:251], v4, s[40:43], s5 offen offset:2048 sc1
  buffer_load_dwordx4 v[252:255], v4, s[40:43], s5 offen offset:3072 sc1
L_191:
  s_cmp_lg_u32 s82, 0
  s_cbranch_scc1 L_193
  buffer_load_dword v109, v110, s[60:63], s13 offen
  s_sub_u32 s13, s13, 8192
  buffer_load_dword v109, v110, s[60:63], s13 offen
  s_sub_u32 s13, s13, 8192
L_193:
  s_barrier
  s_barrier
  s_cmp_lg_u32 s82, 0
  s_cbranch_scc1 L_195
  s_cmp_lg_u32 s82, 0
  s_cbranch_scc1 L_197
  s_waitcnt vmcnt(2)
  s_branch L_198
  s_nop 0
L_197:
  s_waitcnt vmcnt(0)
L_198:
  v_add_f32 v192, v192, v224
  v_add_f32 v193, v193, v225
  v_add_f32 v194, v194, v226
  v_add_f32 v195, v195, v227
  v_add_f32 v196, v196, v228
  v_add_f32 v197, v197, v229
  v_add_f32 v198, v198, v230
  v_add_f32 v199, v199, v231
  v_add_f32 v200, v200, v232
  v_add_f32 v201, v201, v233
  v_add_f32 v202, v202, v234
  v_add_f32 v203, v203, v235
  v_add_f32 v204, v204, v236
  v_add_f32 v205, v205, v237
  v_add_f32 v206, v206, v238
  v_add_f32 v207, v207, v239
  v_add_f32 v208, v208, v240
  v_add_f32 v209, v209, v241
  v_add_f32 v210, v210, v242
  v_add_f32 v211, v211, v243
  v_add_f32 v212, v212, v244
  v_add_f32 v213, v213, v245
  v_add_f32 v214, v214, v246
  v_add_f32 v215, v215, v247
  v_add_f32 v216, v216, v248
  v_add_f32 v217, v217, v249
  v_add_f32 v218, v218, v250
  v_add_f32 v219, v219, v251
  v_add_f32 v220, v220, v252
  v_add_f32 v221, v221, v253
  v_add_f32 v222, v222, v254
  v_add_f32 v223, v223, v255
  v_add_f32 v192, v192, v208
  v_add_f32 v193, v193, v209
  v_add_f32 v194, v194, v210
  v_add_f32 v195, v195, v211
  v_add_f32 v196, v196, v212
  v_add_f32 v197, v197, v213
  v_add_f32 v198, v198, v214
  v_add_f32 v199, v199, v215
  v_add_f32 v200, v200, v216
  v_add_f32 v201, v201, v217
  v_add_f32 v202, v202, v218
  v_add_f32 v203, v203, v219
  v_add_f32 v204, v204, v220
  v_add_f32 v205, v205, v221
  v_add_f32 v206, v206, v222
  v_add_f32 v207, v207, v223
  v_add_f32 v192, v192, v200
  v_add_f32 v193, v193, v201
  v_add_f32 v194, v194, v202
  v_add_f32 v195, v195, v203
  v_add_f32 v196, v196, v204
  v_add_f32 v197, v197, v205
  v_add_f32 v198, v198, v206
  v_add_f32 v199, v199, v207
  v_add_f32 v192, v192, v196
  v_add_f32 v193, v193, v197
  v_add_f32 v194, v194, v198
  v_add_f32 v195, v195, v199
  v_add_u32 v2, 154112, v4
  ds_write_b128 v2, v[192:195]
  s_branch L_196
  s_nop 0
L_195:
  s_waitcnt vmcnt(0)
L_196:
  s_waitcnt lgkmcnt(0)
  s_barrier
  v_lshlrev_b32 v2, 12, v1
  s_lshl_b32 s4, s76, 16
  s_lshl_b32 s5, s77, 7
  s_add_u32 s4, s4, s5
  s_add_u32 s4, s4, s87
  s_add_u32 s5, s4, 24
  s_lshl_b32 s4, s79, 3
  s_lshl_b32 s90, 0xff, s4
  s_lshl_b32 s91, s84, 1
  s_add_u32 s91, s91, s87
  s_add_u32 s91, s91, 24
  s_lshl_b32 s4, s82, 7
  s_add_u32 s4, s4, 1837056
  s_lshl_b32 s5, s84, 1
  s_add_u32 s5, s5, s4
  s_and_b32 s91, s5, 0xffff0fff
  s_barrier
  s_barrier
  s_barrier
  s_mov_b32 exec_lo, 1
  s_mov_b32 exec_hi, Lz1-Lz0+0
  buffer_store_dword v11, v2, s[40:43], s5 offen sc0 sc1
  s_mov_b64 exec, -1
  s_barrier
  s_barrier
  s_barrier
  s_mov_b32 exec_lo, s90
  s_mov_b32 exec_hi, 0
  buffer_load_dword v7, v2, s[40:43], s91 offen sc0 sc1
  s_mov_b64 exec, -1
  s_barrier
  s_waitcnt vmcnt(0)
  s_mov_b32 s89, 200000
  s_mov_b32 exec_lo, s90
  s_mov_b32 exec_hi, 0
  s_branch Lp_200
Lp_199:
  buffer_load_dword v7, v2, s[40:43], s91 offen sc0 sc1
  s_waitcnt vmcnt(0)
Lp_200:
  v_cmp_ne_u32 vcc, 0, v7
  s_andn2_b32 s3, s90, vcc_lo
  s_cbranch_scc0 Lp_201
  s_sleep 1
  s_sub_u32 s89, s89, 1
  s_cbranch_scc0 Lp_199
Lp_201:
  s_mov_b64 exec, -1
  s_xor_b32 s90, s90, 0xffff
  s_barrier
  s_barrier
  s_barrier
  s_barrier
  s_barrier
  s_barrier
  s_barrier
  s_barrier
  s_barrier
  s_barrier
  s_mov_b32 exec_lo, s90
  s_mov_b32 exec_hi, 0
  buffer_load_dword v7, v2, s[40:43], s91 offen sc0 sc1
  s_mov_b64 exec, -1
  s_barrier
  s_barrier
  s_barrier
  s_waitcnt vmcnt(0)
  s_mov_b32 s89, 200000
  s_mov_b32 exec_lo, s90
  s_mov_b32 exec_hi, 0
  s_branch Lp_203
Lp_202:
  buffer_load_dword v7, v2, s[40:43], s91 offen sc0 sc1
  s_waitcnt vmcnt(0)
Lp_203:
  v_cmp_ne_u32 vcc, 0, v7
  s_andn2_b32 s3, s90, vcc_lo
  s_cbranch_scc0 Lp_204
  s_sleep 1
  s_sub_u32 s89, s89, 1
  s_cbranch_scc0 Lp_202
Lp_204:
  s_mov_b64 exec, -1
  s_barrier
  s_barrier
  s_barrier
  s_barrier
  s_barrier
  s_barrier
  s_barrier
  s_barrier
  s_barrier
  s_barrier
  s_barrier
  s_cmp_lg_u32 s82, 0
  s_cbranch_scc1 L_lend
  s_add_u32 s92, s83, 36700160
  s_mov_b32 s82, 1
  s_mov_b32 s14, 0
  s_add_u32 s83, s83, 0
  s_add_u32 s87, s87, 32
  s_branch L_slayer
L_lend:
Lz0:
Lz1:
L_end:
  s_endpgm
.section .rodata,"a"
.p2align 6
.amdhsa_kernel mega_kernel
  .amdhsa_next_free_vgpr 256
  .amdhsa_next_free_sgpr 102
  .amdhsa_accum_offset 256
  .amdhsa_group_segment_fixed_size 0
  .amdhsa_kernarg_size 88
  .amdhsa_user_sgpr_count 2
  .amdhsa_user_sgpr_kernarg_segment_ptr 1
  .amdhsa_system_sgpr_workgroup_id_x 1
  .amdhsa_float_denorm_mode_32 3
  .amdhsa_float_denorm_mode_16_64 3
.end_amdhsa_kernel
.text
```

```asm
; @launch kernel=mega_kernel grid=(256,1,1) block=(512,1,1) lds=156672
.amdgcn_target "amdgcn-amd-amdhsa--gfx950"
.text
.globl mega_kernel
.p2align 8
.type mega_kernel,@function
mega_kernel:
  s_cmp_ge_u32 s2, 256
  s_nop 0
  s_cbranch_scc1 L_end
  s_load_dwordx16 s[16:31], s[0:1], 0
  s_load_dwordx2 s[32:33], s[0:1], 64
  s_load_dwordx4 s[36:39], s[0:1], 72
  v_lshrrev_b32 v2, 6, v0
  v_and_b32 v1, 63, v0
  v_readfirstlane_b32 s81, v2
  s_and_b32 s3, s2, 7
  s_lshr_b32 s4, s2, 3
  s_and_b32 s5, s3, 1
  s_lshl_b32 s5, s5, 3
  s_and_b32 s6, s4, 7
  s_add_u32 s76, s5, s6
  s_lshr_b32 s5, s3, 1
  s_lshl_b32 s5, s5, 2
  s_lshr_b32 s6, s4, 3
  s_add_u32 s77, s5, s6
  s_mov_b32 s82, 0
  s_mov_b32 s88, 0
  s_and_b32 s85, s81, 1
  s_cmp_lt_u32 s81, 4
  s_cbranch_scc1 L_comp
  s_cmp_eq_u32 s81, Lz1-Lz0+5
  s_cbranch_scc1 L_serv
  s_setprio 0
  s_cmp_eq_u32 s81, 4
  s_cbranch_scc1 L_xload
  v_bfe_u32 v2, v1, 1, 2
  v_bfe_u32 v3, v1, 4, 2
  v_xor_b32 v2, v2, v3
  v_lshlrev_b32 v10, 5, v2
  v_and_b32_e64 v2, 1, v1
  v_lshl_add_u32 v10, v2, 4, v10
  v_lshrrev_b32_e64 v2, 5, v1
  v_bfe_u32 v3, v1, 3, 2
  v_lshl_add_u32 v2, v2, 3, v3
  s_mov_b32 s4, 6144
  v_mad_u32_u24 v16, v2, s4, v10
  v_add_u32 v17, 97280, v16
  v_add_u32 v18, 22528, v16
  v_add_u32 v19, 119808, v16
  s_lshl_b32 s5, s77, Lz1-Lz0+7
  s_mul_i32 s4, s85, 196608
  s_add_u32 s5, s5, s4
  s_and_b32 s6, s76, 6
  s_lshr_b32 s4, s76, 3
  s_add_u32 s6, s6, s4
  s_lshl_b32 s6, s6, 1
  v_add_u32 v20, s6, v1
  v_and_b32_e64 v20, 15, v20
  s_mov_b32 s4, 393216
  v_mul_u32_u24 v20, s4, v20
  v_add_u32 v20, s5, v20
  s_nop 0
  v_readfirstlane_b32 s7, v20
  s_lshl_b32 s11, s85, Lz1-Lz0+12
  s_add_u32 s11, s11, 65536
  s_add_u32 s15, s11, 73728
  s_waitcnt lgkmcnt(0)
  s_mov_b32 s48, s18
  s_and_b32 s49, s19, 0xffff
  s_mov_b32 s50, 6291456
  s_mov_b32 s51, 0x00020000
L_wlayer:
  s_mov_b32 s12, 0
  s_mov_b32 m0, s11
  s_cmp_eq_u32 s82, 0
  s_cbranch_scc1 Ll_33
  s_waitcnt vmcnt(12)
  s_barrier
  s_waitcnt vmcnt(8)
  s_barrier
  s_waitcnt vmcnt(4)
  s_barrier
  s_waitcnt vmcnt(0)
  s_barrier
  s_branch Ll_33
Lt_38:
  s_cmp_lg_u32 s12, 1
  s_cbranch_scc1 Ll_33
  s_cmp_eq_u32 s82, 0
  s_cbranch_scc1 Ll_33
  s_barrier
  v_mov_b32 v2, 156416
  s_lshl_b32 s5, s82, Lz1-Lz0+4
  s_mov_b32 s89, 1600000
Lw_39:
  ds_read_b32 v3, v2 offset:0
Lw_40:
  s_waitcnt lgkmcnt(0)
  v_readfirstlane_b32 s4, v3
  s_cmp_ge_u32 s4, s5
  s_cbranch_scc1 Lw_41
  s_sleep 1
  s_sub_u32 s89, s89, Lz1-Lz0+1
  s_cbranch_scc0 Lw_39
Lw_41:
Ll_33:
  buffer_load_dwordx4 v16, s[48:51], s7 offen offset:0  lds
  buffer_load_dwordx4 v17, s[48:51], s7 offen offset:1024  lds
  buffer_load_dwordx4 v18, s[48:51], s7 offen offset:2048  lds
  buffer_load_dwordx4 v19, s[48:51], s7 offen offset:3072  lds
  s_add_u32 m0, s11, 8192
  s_add_u32 s5, s7, 2048
  buffer_load_dwordx4 v16, s[48:51], s5 offen offset:0  lds
  buffer_load_dwordx4 v17, s[48:51], s5 offen offset:1024  lds
  buffer_load_dwordx4 v18, s[48:51], s5 offen offset:2048  lds
  buffer_load_dwordx4 v19, s[48:51], s5 offen offset:3072  lds
  s_add_u32 m0, s11, 16384
  s_add_u32 s5, s7, 4096
  buffer_load_dwordx4 v16, s[48:51], s5 offen offset:0  lds
  s_add_u32 s12, s12, Lz1-Lz0+1
  v_readlane_b32 s7, v20, s12
  s_add_u32 s11, s11, 24576
  buffer_load_dwordx4 v17, s[48:51], s5 offen offset:1024  lds
  s_cmp_eq_u32 s11, s15
  s_cselect_b32 s4, 73728, 0
  s_sub_u32 s11, s11, s4
  buffer_load_dwordx4 v18, s[48:51], s5 offen offset:2048  lds
  s_cmp_lg_u32 s12, Lz1-Lz0+3
  buffer_load_dwordx4 v19, s[48:51], s5 offen offset:3072  lds
  s_mov_b32 m0, s11
  s_cbranch_scc1 Lt_38
Lt_42:
  s_waitcnt vmcnt(24)
  s_barrier
  s_mul_i32 s5, s85, 6144
  s_nop 0
  s_mov_b32 s68, s24
  s_and_b32 s69, s25, 0xffff
  s_mov_b32 s70, 7340032
  s_mov_b32 s71, 0x00020000
  s_lshl_b32 s4, s76, Lz1-Lz0+4
  s_add_u32 s4, s4, s77
  s_mul_i32 s34, s4, 28672
  s_add_u32 s34, s34, s5
  s_waitcnt vmcnt(12)
  s_barrier
  buffer_load_dwordx4 v16, s[48:51], s7 offen offset:0  lds
  buffer_load_dwordx4 v17, s[48:51], s7 offen offset:1024  lds
  buffer_load_dwordx4 v18, s[48:51], s7 offen offset:2048  lds
  buffer_load_dwordx4 v19, s[48:51], s7 offen offset:3072  lds
Ll_43:
  s_add_u32 m0, s11, 8192
  s_add_u32 s5, s7, 2048
  buffer_load_dwordx4 v16, s[48:51], s5 offen offset:0  lds
  buffer_load_dwordx4 v17, s[48:51], s5 offen offset:1024  lds
  buffer_load_dwordx4 v18, s[48:51], s5 offen offset:2048  lds
  buffer_load_dwordx4 v19, s[48:51], s5 offen offset:3072  lds
  s_add_u32 m0, s11, 16384
  s_add_u32 s5, s7, 4096
  buffer_load_dwordx4 v16, s[48:51], s5 offen offset:0  lds
  s_add_u32 s12, s12, Lz1-Lz0+1
  v_readlane_b32 s7, v20, s12
  s_add_u32 s11, s11, 24576
  buffer_load_dwordx4 v17, s[48:51], s5 offen offset:1024  lds
  s_cmp_eq_u32 s11, s15
  s_cselect_b32 s4, 73728, 0
  s_sub_u32 s11, s11, s4
  buffer_load_dwordx4 v18, s[48:51], s5 offen offset:2048  lds
  s_cmp_eq_u32 s12, Lz1-Lz0+16
  buffer_load_dwordx4 v19, s[48:51], s5 offen offset:3072  lds
  s_mov_b32 m0, s11
  s_cbranch_scc1 Ll_44
  s_cmp_lg_u32 s82, 0
  s_cbranch_scc1 L_45
  s_buffer_load_dwordx2 s[98:99], s[68:71], s34 offset:60
  s_buffer_load_dwordx2 s[98:99], s[68:71], s34 offset:188
  s_buffer_load_dwordx2 s[98:99], s[68:71], s34 offset:316
  s_buffer_load_dwordx2 s[98:99], s[68:71], s34 offset:444
  s_add_u32 s34, s34, 512
L_45:
  s_waitcnt vmcnt(12)
  s_barrier
  buffer_load_dwordx4 v16, s[48:51], s7 offen offset:0  lds
  buffer_load_dwordx4 v17, s[48:51], s7 offen offset:1024  lds
  buffer_load_dwordx4 v18, s[48:51], s7 offen offset:2048  lds
  buffer_load_dwordx4 v19, s[48:51], s7 offen offset:3072  lds
  s_branch Ll_43
Ll_44:
  s_branch L_w1
L_xload:
  s_setprio 0
  v_lshrrev_b32 v2, 4, v1
  v_and_b32 v3, 7, v1
  v_xor_b32 v2, v2, v3
  v_lshrrev_b32 v3, 3, v1
  v_lshlrev_b32 v3, 12, v3
  v_lshl_add_u32 v4, v2, 4, v3
  v_xor_b32_e64 v5, 64, v4
  v_add_u32 v5, 31744, v5
  v_add_u32 v6, 63488, v4
  v_add_u32 v7, 63488, v5
  s_mov_b32 s13, 0x20000
  s_movk_i32 s95, 2048
  s_lshl_b32 s5, s76, 18
  s_and_b32 s6, s76, 6
  s_lshr_b32 s4, s76, 3
  s_add_u32 s6, s6, s4
  s_lshl_b32 s6, s6, 1
  v_add_u32 v9, s6, v1
  v_and_b32 v9, 15, v9
  v_lshl_add_u32 v9, v9, 7, s5
  s_nop 0
  v_readfirstlane_b32 s7, v9
  s_waitcnt lgkmcnt(0)
  s_mov_b32 s72, s16
  s_and_b32 s73, s17, 0xffff
  s_mov_b32 s74, 4194304
  s_mov_b32 s75, 0x00020000
  s_mov_b32 s11, 0
  s_mov_b32 s15, 65536
L_xlayer:
  s_mov_b32 s12, s82
  s_mov_b32 m0, s11
Ll_79:
  s_nop 0
  buffer_load_dwordx4 v4, s[72:75], s7 offen offset:0 sc1 lds
  buffer_load_dwordx4 v5, s[72:75], s7 offen offset:1024 sc1 lds
  buffer_load_dwordx4 v6, s[72:75], s7 offen offset:2048 sc1 lds
  buffer_load_dwordx4 v7, s[72:75], s7 offen offset:3072 sc1 lds
  s_add_u32 m0, s11, 4096
  s_nop 0
  s_add_u32 s5, s7, s13
  buffer_load_dwordx4 v4, s[72:75], s5 offen offset:0 sc1 lds
  buffer_load_dwordx4 v5, s[72:75], s5 offen offset:1024 sc1 lds
  buffer_load_dwordx4 v6, s[72:75], s5 offen offset:2048 sc1 lds
  buffer_load_dwordx4 v7, s[72:75], s5 offen offset:3072 sc1 lds
  s_add_u32 m0, s11, 8192
  s_nop 0
  s_add_u32 s3, s7, s95
  buffer_load_dwordx4 v4, s[72:75], s3 offen offset:0 sc1 lds
  buffer_load_dwordx4 v5, s[72:75], s3 offen offset:1024 sc1 lds
  buffer_load_dwordx4 v6, s[72:75], s3 offen offset:2048 sc1 lds
  buffer_load_dwordx4 v7, s[72:75], s3 offen offset:3072 sc1 lds
  s_add_u32 m0, s11, 12288
  s_add_u32 s5, s3, s13
  buffer_load_dwordx4 v4, s[72:75], s5 offen offset:0 sc1 lds
  s_add_u32 s12, s12, 1
  v_readlane_b32 s7, v9, s12
  s_add_u32 s11, s11, 16384
  buffer_load_dwordx4 v5, s[72:75], s5 offen offset:1024 sc1 lds
  s_cmp_eq_u32 s11, s15
  s_cselect_b32 s4, 65536, 0
  s_sub_u32 s11, s11, s4
  buffer_load_dwordx4 v6, s[72:75], s5 offen offset:2048 sc1 lds
  s_cmp_lg_u32 s12, Lz1-Lz0+3
  buffer_load_dwordx4 v7, s[72:75], s5 offen offset:3072 sc1 lds
  s_mov_b32 m0, s11
  s_cbranch_scc1 Ll_80
  s_cmp_lg_u32 s82, 0
  s_cbranch_scc1 Ll_80
  s_waitcnt vmcnt(32)
  s_barrier
Ll_80:
  s_cmp_lt_u32 s12, Lz1-Lz0+4
  s_cbranch_scc1 Ll_79
  s_mov_b32 s68, s20
  s_and_b32 s69, s21, 0xffff
  s_mov_b32 s70, 2097152
  s_mov_b32 s71, 0x00020000
  s_lshl_b32 s4, s76, 4
  s_add_u32 s4, s4, s77
  s_mul_i32 s34, s4, 8192
  s_waitcnt vmcnt(32)
  s_barrier
  buffer_load_dwordx4 v4, s[72:75], s7 offen offset:0 sc1 lds
  buffer_load_dwordx4 v5, s[72:75], s7 offen offset:1024 sc1 lds
  buffer_load_dwordx4 v6, s[72:75], s7 offen offset:2048 sc1 lds
  buffer_load_dwordx4 v7, s[72:75], s7 offen offset:3072 sc1 lds
Ll_83:
  s_add_u32 m0, s11, 4096
  s_nop 0
  s_add_u32 s5, s7, s13
  buffer_load_dwordx4 v4, s[72:75], s5 offen offset:0 sc1 lds
  buffer_load_dwordx4 v5, s[72:75], s5 offen offset:1024 sc1 lds
  buffer_load_dwordx4 v6, s[72:75], s5 offen offset:2048 sc1 lds
  buffer_load_dwordx4 v7, s[72:75], s5 offen offset:3072 sc1 lds
  s_add_u32 m0, s11, 8192
  s_nop 0
  s_add_u32 s3, s7, s95
  buffer_load_dwordx4 v4, s[72:75], s3 offen offset:0 sc1 lds
  buffer_load_dwordx4 v5, s[72:75], s3 offen offset:1024 sc1 lds
  buffer_load_dwordx4 v6, s[72:75], s3 offen offset:2048 sc1 lds
  buffer_load_dwordx4 v7, s[72:75], s3 offen offset:3072 sc1 lds
  s_add_u32 m0, s11, 12288
  s_add_u32 s5, s3, s13
  buffer_load_dwordx4 v4, s[72:75], s5 offen offset:0 sc1 lds
  s_add_u32 s12, s12, 1
  v_readlane_b32 s7, v9, s12
  s_add_u32 s11, s11, 16384
  buffer_load_dwordx4 v5, s[72:75], s5 offen offset:1024 sc1 lds
  s_cmp_eq_u32 s11, s15
  s_cselect_b32 s4, 65536, 0
  s_sub_u32 s11, s11, s4
  buffer_load_dwordx4 v6, s[72:75], s5 offen offset:2048 sc1 lds
  s_cmp_eq_u32 s12, Lz1-Lz0+16
  buffer_load_dwordx4 v7, s[72:75], s5 offen offset:3072 sc1 lds
  s_mov_b32 m0, s11
  s_cbranch_scc1 Ll_84
  s_cmp_lg_u32 s82, 0
  s_cbranch_scc1 L_85
  s_buffer_load_dwordx2 s[98:99], s[68:71], s34 offset:60
  s_buffer_load_dwordx2 s[98:99], s[68:71], s34 offset:188
  s_buffer_load_dwordx2 s[98:99], s[68:71], s34 offset:316
  s_buffer_load_dwordx2 s[98:99], s[68:71], s34 offset:444
  s_buffer_load_dwordx2 s[98:99], s[68:71], s34 offset:572
  s_add_u32 s34, s34, 640
L_85:
  s_waitcnt vmcnt(32)
  s_barrier
  buffer_load_dwordx4 v4, s[72:75], s7 offen offset:0 sc1 lds
  buffer_load_dwordx4 v5, s[72:75], s7 offen offset:1024 sc1 lds
  buffer_load_dwordx4 v6, s[72:75], s7 offen offset:2048 sc1 lds
  buffer_load_dwordx4 v7, s[72:75], s7 offen offset:3072 sc1 lds
  s_branch Ll_83
  s_nop 0
Ll_84:
  s_waitcnt vmcnt(32)
  s_barrier
  s_waitcnt vmcnt(16)
  s_barrier
  s_waitcnt vmcnt(0)
  s_barrier
  s_barrier
  s_branch L_x1
L_serv:
  s_setprio 3
  s_and_b32 s80, s77, 7
  s_lshr_b32 s79, s77, 3
  s_lshl_b32 s78, s80, 1
  s_add_u32 s78, s78, s79
  s_lshl_b32 s5, s76, 4
  s_add_u32 s5, s5, s77
  s_lshl_b32 s84, s5, 11
  s_mov_b32 s83, 3145728
  s_mov_b32 s87, 1835016
  s_lshr_b32 s86, s81, 1
  v_lshlrev_b32 v4, 4, v1
  v_mov_b32 v24, 0
  v_mov_b32 v25, 0
  v_mov_b32 v26, 0
  v_mov_b32 v27, 0
  v_and_b32 v2, 14, v1
  v_lshlrev_b32 v3, 11, v2
  v_and_b32_e64 v2, 1, v1
  v_lshl_add_u32 v3, v2, 4, v3
  v_and_b32_e64 v2, 48, v1
  v_lshl_add_u32 v3, v2, 1, v3
  v_bfe_u32 v2, v1, 3, 2
  v_and_b32 v22, 7, v1
  v_lshlrev_b32 v2, 14, v2
  v_lshl_add_u32 v2, v22, 3, v2
  s_lshl_b32 s5, s76, 7
  s_lshl_b32 s4, s80, 4
  s_add_u32 s6, s5, s4
  s_add_u32 s6, s6, s79
  s_lshl_b32 s6, s6, 11
  s_lshr_b32 s10, s84, 5
  s_add_u32 s10, s10, 1638400
  s_waitcnt lgkmcnt(0)
  s_mov_b32 s48, s18
  s_and_b32 s49, s19, 0xffff
  s_mov_b32 s50, 6291456
  s_mov_b32 s51, 0x00020000
  s_sub_u32 s4, 384, s48
  s_and_b32 s4, s4, 1023
  s_mul_i32 s5, s84, 12
  s_add_u32 s4, s4, s5
  v_lshlrev_b32_e64 v109, 10, v1
  s_mov_b64 exec, 0xffffff
  buffer_load_dword v109, v109, s[48:51], s4 offen
  s_mov_b64 exec, -1
  s_mov_b32 s40, s38
  s_and_b32 s41, s39, 0xffff
  s_mov_b32 s42, 100663296
  s_mov_b32 s43, 0x00020000
  s_nop 0
  s_mov_b32 s44, s16
  s_and_b32 s45, s17, 0xffff
  s_mov_b32 s46, 4194304
  s_mov_b32 s47, 0x00020000
  s_nop 0
  s_mov_b32 s68, s36
  s_and_b32 s69, s37, 0xffff
  s_mov_b32 s70, 256
  s_mov_b32 s71, 0x00020000
  s_lshl_b32 s4, s84, Lz1-Lz0+1
  s_add_u32 s4, s4, 1835008
  buffer_store_dwordx4 v[24:27], v4, s[40:43], s4 offen offset:0 sc0 sc1
  buffer_store_dwordx4 v[24:27], v4, s[40:43], s4 offen offset:1024 sc0 sc1
  s_mov_b64 exec, 0xffff
  buffer_store_dwordx4 v[24:27], v4, s[40:43], s4 offen offset:2048 sc0 sc1
  s_mov_b64 exec, -1
  v_mov_b32 v28, -1
  v_mov_b32 v29, -1
  v_mov_b32 v30, -1
  v_mov_b32 v31, -1
  s_lshl_b32 s4, s84, 1
  s_add_u32 s4, s4, Lz1-Lz0+0
  buffer_store_dwordx4 v[28:31], v4, s[40:43], s4 offen offset:0 sc0 sc1
  buffer_store_dwordx4 v[28:31], v4, s[40:43], s4 offen offset:1024 sc0 sc1
  buffer_store_dwordx4 v[28:31], v4, s[40:43], s4 offen offset:2048 sc0 sc1
  buffer_store_dwordx4 v[28:31], v4, s[40:43], s4 offen offset:3072 sc0 sc1
  buffer_store_dwordx2 v[24:25], v2, s[40:43], s10 offen sc0 sc1
  v_mov_b32 v108, v3
  s_mov_b32 s7, s6
  s_branch L_s1
L_comp:
  s_and_b32 s80, s77, 7
  s_lshr_b32 s79, s77, 3
  s_lshl_b32 s78, s80, 1
  s_add_u32 s78, s78, s79
  s_lshl_b32 s5, s76, 4
  s_add_u32 s5, s5, s77
  s_lshl_b32 s84, s5, 11
  s_mov_b32 s83, 3145728
  s_mov_b32 s87, 1835016
  s_lshr_b32 s86, s81, Lz1-Lz0+1
  s_waitcnt lgkmcnt(0)
  s_mov_b32 s40, s38
  s_and_b32 s41, s39, 0xffff
  s_mov_b32 s42, 100663296
  s_mov_b32 s43, 0x00020000
  s_nop 0
  s_mov_b32 s44, s16
  s_and_b32 s45, s17, 0xffff
  s_mov_b32 s46, 4194304
  s_mov_b32 s47, 0x00020000
  s_nop 0
  s_mov_b32 s64, s32
  s_and_b32 s65, s33, 0xffff
  s_mov_b32 s66, 4194304
  s_mov_b32 s67, 0x00020000
  s_setprio 1
  v_lshlrev_b32 v11, 4, v1
  v_lshrrev_b32 v2, 3, v1
  v_and_b32 v3, 7, v1
  v_lshlrev_b32_e64 v3, 3, v3
  v_lshl_add_u32 v30, v2, 11, v3
  s_lshl_b32 s4, s85, 13
  s_lshl_b32 s5, s86, 10
  s_add_u32 s4, s4, s5
  v_add_u32 v0, s4, v11
  v_mov_b32_e64 v27, 1
  v_mov_b32 v28, 156416
  v_and_b32 v29, 48, v1
  s_lshl_b32 s4, s76, 16
  s_lshl_b32 s5, s77, 7
  s_add_u32 s4, s4, s5
  v_lshlrev_b32 v24, 12, v1
  v_and_b32 v2, 16, v1
  v_lshl_add_u32 v24, v2, 7, v24
  v_add_u32 v24, s4, v24
  v_lshrrev_b32 v2, 2, v1
  v_lshlrev_b32 v25, 7, v2
  v_and_b32 v2, 3, v1
  v_lshl_add_u32 v25, v2, 3, v25
  v_add_u32 v25, 65536, v25
  v_bfe_u32 v26, v1, 3, 2
  v_and_b32 v2, 15, v1
  v_lshrrev_b32 v3, 2, v29
  v_sub_u32_e64 v2, v2, v3
  s_mov_b32 s4, 0xf149f2ca
  v_mov_b32 v32, s4
  v_subrev_u32 v3, 0, v2
  v_cmp_gt_u32 vcc, 8, v3
  s_nop 1
  v_cndmask_b32_e64 v12, v32, 0, vcc
  v_cmp_ge_i32 vcc, -9, v3
  s_nop 1
  v_cndmask_b32_e64 v16, v32, 0, vcc
  v_mov_b32 v20, v16
  v_subrev_u32 v3, 1, v2
  v_cmp_gt_u32 vcc, 8, v3
  s_nop 1
  v_cndmask_b32_e64 v13, v32, 0, vcc
  v_cmp_ge_i32 vcc, -9, v3
  s_nop 1
  v_cndmask_b32_e64 v17, v32, 0, vcc
  v_mov_b32 v21, v17
  v_subrev_u32 v3, 2, v2
  v_cmp_gt_u32 vcc, 8, v3
  s_nop 1
  v_cndmask_b32_e64 v14, v32, 0, vcc
  v_cmp_ge_i32 vcc, -9, v3
  s_nop 1
  v_cndmask_b32_e64 v18, v32, 0, vcc
  v_mov_b32 v22, v18
  v_subrev_u32 v3, 3, v2
  v_cmp_gt_u32 vcc, 8, v3
  s_nop 1
  v_cndmask_b32_e64 v15, v32, 0, vcc
  v_cmp_ge_i32 vcc, -9, v3
  s_nop 1
  v_cndmask_b32_e64 v19, v32, 0, vcc
  v_mov_b32 v23, v19
  s_cmp_lg_u32 s76, 0
  s_cbranch_scc1 L_1
  v_mov_b32 v20, v32
  v_mov_b32 v21, v32
  v_mov_b32 v22, v32
  v_mov_b32 v23, v32
L_1:
  s_lshl_b32 s11, s84, 1
  s_lshl_b32 s4, s81, 10
  s_add_u32 s11, s11, s4
  v_and_b32 v2, 15, v1
  v_lshlrev_b32 v255, 12, v2
  v_and_b32_e64 v2, 16, v1
  v_lshl_add_u32 v255, v2, 1, v255
  v_and_b32 v2, 32, v1
  v_lshrrev_b32 v2, 1, v2
  v_add_u32 v255, v2, v255
  s_lshl_b32 s25, s76, 18
  s_lshl_b32 s4, s85, 11
  s_add_u32 s25, s25, s4
  s_lshl_b32 s4, s78, 7
  s_add_u32 s25, s25, s4
  s_lshl_b32 s4, s86, 6
  s_add_u32 s25, s25, s4
L_clayer:
  s_mov_b32 s16, Lz1-Lz0+0
  s_mov_b32 s17, 16384
  s_mov_b32 s18, 0xffff4000
  s_mov_b32 s19, Lz1-Lz0+0
  s_mov_b32 s20, 24576
  s_mov_b32 s21, 0xffff4000
  s_mul_i32 s4, s85, 8192
  v_add_u32_e64 v4, s4, v11
  v_add_u32 v5, 1024, v4
  s_cmp_lg_u32 s82, 0
  s_cbranch_scc1 L_2
  v_and_b32 v2, 15, v1
  v_lshrrev_b32 v3, 1, v2
  v_lshrrev_b32 v32, 4, v1
  v_xor_b32 v3, v3, v32
  v_lshlrev_b32_e64 v3, 4, v3
  v_lshl_add_u32 v3, v2, 7, v3
  v_add_u32 v4, s4, v3
  v_xor_b32 v3, 64, v3
  v_add_u32 v5, s4, v3
L_2:
  s_lshl_b32 s4, s86, 1
  v_xor_b32_e64 v2, s4, v26
  v_lshl_add_u32 v6, v2, 5, v25
  s_add_u32 s4, s4, 1
  v_xor_b32 v2, s4, v26
  v_lshl_add_u32 v7, v2, 5, v25
  v_mov_b64 v[128:129], 0
  v_mov_b64 v[130:131], 0
  v_mov_b64 v[132:133], 0
  v_mov_b64 v[134:135], 0
  v_mov_b64 v[136:137], 0
  v_mov_b64 v[138:139], 0
  v_mov_b64 v[140:141], 0
  v_mov_b64 v[142:143], 0
  v_mov_b64 v[144:145], 0
  v_mov_b64 v[146:147], 0
  v_mov_b64 v[148:149], 0
  v_mov_b64 v[150:151], 0
  v_mov_b64 v[152:153], 0
  v_mov_b64 v[154:155], 0
  v_mov_b64 v[156:157], 0
  v_mov_b64 v[158:159], 0
  v_mov_b64 v[160:161], 0
  v_mov_b64 v[162:163], 0
  v_mov_b64 v[164:165], 0
  v_mov_b64 v[166:167], 0
  v_mov_b64 v[168:169], 0
  v_mov_b64 v[170:171], 0
  v_mov_b64 v[172:173], 0
  v_mov_b64 v[174:175], 0
  v_mov_b64 v[176:177], 0
  v_mov_b64 v[178:179], 0
  v_mov_b64 v[180:181], 0
  v_mov_b64 v[182:183], 0
  v_mov_b64 v[184:185], 0
  v_mov_b64 v[186:187], 0
  v_mov_b64 v[188:189], 0
  v_mov_b64 v[190:191], 0
  v_mov_b64 v[192:193], 0
  v_mov_b64 v[194:195], 0
  v_mov_b64 v[196:197], 0
  v_mov_b64 v[198:199], 0
  v_mov_b64 v[200:201], 0
  v_mov_b64 v[202:203], 0
  v_mov_b64 v[204:205], 0
  v_mov_b64 v[206:207], 0
  v_mov_b64 v[208:209], 0
  v_mov_b64 v[210:211], 0
  v_mov_b64 v[212:213], 0
  v_mov_b64 v[214:215], 0
  v_mov_b64 v[216:217], 0
  v_mov_b64 v[218:219], 0
  v_mov_b64 v[220:221], 0
  v_mov_b64 v[222:223], 0
  s_mul_i32 s4, s85, 320
  s_add_u32 s4, s4, 151552
  v_and_b32_e64 v2, 15, v1
  v_lshl_add_u32 v3, v2, 2, s4
  v_add_u32 v10, s4, v29
  s_lshl_b32 s5, s86, 7
  s_add_u32 s5, s5, 153088
  v_add_u32_e64 v8, s5, v29
  v_lshl_add_u32 v2, v2, 2, s5
  s_mov_b32 s10, 0x7f
  s_mov_b32 s12, 0xff00ff00
  s_add_u32 s9, s11, 65536
  v_lshrrev_b32_e64 v9, 1, v11
  v_bfi_b32 v9, s10, v11, v9
  s_mov_b32 s22, Lz1-Lz0+8
  s_cmp_lg_u32 s82, 0
  s_cselect_b64 vcc, -1, 0
  s_waitcnt lgkmcnt(0)
  s_barrier
Lo_6:
  ds_read_b128 v[32:35], v4 offset:0
  ds_read_b128 v[48:51], v5 offset:0
  ds_read_b128 v[36:39], v4 offset:2048
  ds_read_b128 v[52:55], v5 offset:2048
  ds_read_b128 v[40:43], v4 offset:4096
  ds_read_b128 v[56:59], v5 offset:4096
  ds_read_b64_tr_b16 v[96:97], v6 offset:0
  ds_read_b64_tr_b16 v[98:99], v6 offset:2048
  ds_read_b64_tr_b16 v[100:101], v6 offset:4096
  ds_read_b64_tr_b16 v[102:103], v6 offset:6144
  ds_read_b128 v[44:47], v4 offset:6144
  ds_read_b128 v[60:63], v5 offset:6144
  ds_read_b64_tr_b16 v[104:105], v7 offset:0
  s_nop 0
  s_waitcnt lgkmcnt(8)
  ds_read_b64_tr_b16 v[106:107], v7 offset:2048
  ds_read_b64_tr_b16 v[108:109], v7 offset:4096
  ds_read_b64_tr_b16 v[110:111], v7 offset:6144
  s_nop 0
  s_waitcnt lgkmcnt(6)
  .p2align 6
Lk_3:
  v_mfma_f32_16x16x32_bf16 v[128:131], v[96:99], v[32:35], v[128:131]
  ds_read_b64_tr_b16 v[112:113], v6 offset:8192
  v_mfma_f32_16x16x32_bf16 v[128:131], v[100:103], v[48:51], v[128:131]
  ds_read_b64_tr_b16 v[114:115], v6 offset:10240
  v_mfma_f32_16x16x32_bf16 v[136:139], v[100:103], v[52:55], v[136:139]
  ds_read_b64_tr_b16 v[116:117], v6 offset:12288
  v_mfma_f32_16x16x32_bf16 v[136:139], v[96:99], v[36:39], v[136:139]
  ds_read_b64_tr_b16 v[118:119], v6 offset:14336
  v_mfma_f32_16x16x32_bf16 v[144:147], v[96:99], v[40:43], v[144:147]
  s_add_u32 s16, s16, s17
  s_cmp_eq_u32 s16, 65536
  s_cselect_b32 s23, s18, s17
  s_cselect_b32 s16, Lz1-Lz0+0, s16
  v_mfma_f32_16x16x32_bf16 v[144:147], v[100:103], v[56:59], v[144:147]
  v_add_u32_e64 v4, s23, v4
  v_add_u32 v5, s23, v5
  s_add_u32 s19, s19, s20
  s_cmp_eq_u32 s19, 73728
  s_waitcnt lgkmcnt(8)
  v_mfma_f32_16x16x32_bf16 v[152:155], v[100:103], v[60:63], v[152:155]
  s_cselect_b32 s23, s21, s20
  s_cselect_b32 s19, 0, s19
  v_mfma_f32_16x16x32_bf16 v[152:155], v[96:99], v[44:47], v[152:155]
  s_waitcnt lgkmcnt(4)
  v_mfma_f32_16x16x32_bf16 v[156:159], v[104:107], v[44:47], v[156:159]
  ds_read_b64_tr_b16 v[120:121], v7 offset:8192
  v_mfma_f32_16x16x32_bf16 v[156:159], v[108:111], v[60:63], v[156:159]
  ds_read_b64_tr_b16 v[122:123], v7 offset:10240
  v_mfma_f32_16x16x32_bf16 v[148:151], v[108:111], v[56:59], v[148:151]
  ds_read_b64_tr_b16 v[124:125], v7 offset:12288
  v_mfma_f32_16x16x32_bf16 v[148:151], v[104:107], v[40:43], v[148:151]
  ds_read_b64_tr_b16 v[126:127], v7 offset:14336
  v_mfma_f32_16x16x32_bf16 v[140:143], v[104:107], v[36:39], v[140:143]
  ds_read_b64_tr_b16 v[224:225], v6 offset:16384
  v_mfma_f32_16x16x32_bf16 v[140:143], v[108:111], v[52:55], v[140:143]
  ds_read_b64_tr_b16 v[226:227], v6 offset:18432
  v_mfma_f32_16x16x32_bf16 v[132:135], v[108:111], v[48:51], v[132:135]
  ds_read_b64_tr_b16 v[228:229], v6 offset:20480
  v_mfma_f32_16x16x32_bf16 v[132:135], v[104:107], v[32:35], v[132:135]
  ds_read_b64_tr_b16 v[230:231], v6 offset:22528
  s_nop 0
  s_waitcnt lgkmcnt(8)
  v_mfma_f32_16x16x32_bf16 v[160:163], v[112:115], v[32:35], v[160:163]
  ds_read_b64_tr_b16 v[232:233], v7 offset:16384
  v_mfma_f32_16x16x32_bf16 v[160:163], v[116:119], v[48:51], v[160:163]
  ds_read_b64_tr_b16 v[234:235], v7 offset:18432
  v_mfma_f32_16x16x32_bf16 v[168:171], v[116:119], v[52:55], v[168:171]
  ds_read_b64_tr_b16 v[236:237], v7 offset:20480
  v_mfma_f32_16x16x32_bf16 v[168:171], v[112:115], v[36:39], v[168:171]
  ds_read_b64_tr_b16 v[238:239], v7 offset:22528
  v_mfma_f32_16x16x32_bf16 v[176:179], v[112:115], v[40:43], v[176:179]
  v_add_u32_e64 v6, s23, v6
  v_mfma_f32_16x16x32_bf16 v[176:179], v[116:119], v[56:59], v[176:179]
  v_add_u32_e64 v7, s23, v7
  v_mfma_f32_16x16x32_bf16 v[184:187], v[116:119], v[60:63], v[184:187]
  v_mfma_f32_16x16x32_bf16 v[184:187], v[112:115], v[44:47], v[184:187]
  s_waitcnt lgkmcnt(0)
  s_cbranch_vccnz Lo_8
  s_nop 0
  s_barrier
Lo_8:
  v_mfma_f32_16x16x32_bf16 v[188:191], v[120:123], v[44:47], v[188:191]
  ds_read_b128 v[64:67], v4 offset:0
  v_mfma_f32_16x16x32_bf16 v[188:191], v[124:127], v[60:63], v[188:191]
  ds_read_b128 v[80:83], v5 offset:0
  v_mfma_f32_16x16x32_bf16 v[180:183], v[124:127], v[56:59], v[180:183]
  v_mfma_f32_16x16x32_bf16 v[180:183], v[120:123], v[40:43], v[180:183]
  ds_read_b128 v[68:71], v4 offset:2048
  v_mfma_f32_16x16x32_bf16 v[172:175], v[120:123], v[36:39], v[172:175]
  ds_read_b128 v[84:87], v5 offset:2048
  v_mfma_f32_16x16x32_bf16 v[172:175], v[124:127], v[52:55], v[172:175]
  v_mfma_f32_16x16x32_bf16 v[164:167], v[124:127], v[48:51], v[164:167]
  ds_read_b128 v[72:75], v4 offset:4096
  v_mfma_f32_16x16x32_bf16 v[164:167], v[120:123], v[32:35], v[164:167]
  ds_read_b128 v[88:91], v5 offset:4096
  v_mfma_f32_16x16x32_bf16 v[192:195], v[32:35], v[224:227], v[192:195]
  ds_read_b64_tr_b16 v[96:97], v6 offset:0
  v_mfma_f32_16x16x32_bf16 v[192:195], v[48:51], v[228:231], v[192:195]
  ds_read_b64_tr_b16 v[98:99], v6 offset:2048
  v_mfma_f32_16x16x32_bf16 v[200:203], v[52:55], v[228:231], v[200:203]
  ds_read_b64_tr_b16 v[100:101], v6 offset:4096
  v_mfma_f32_16x16x32_bf16 v[200:203], v[36:39], v[224:227], v[200:203]
  ds_read_b64_tr_b16 v[102:103], v6 offset:6144
  v_mfma_f32_16x16x32_bf16 v[208:211], v[40:43], v[224:227], v[208:211]
  ds_read_b128 v[76:79], v4 offset:6144
  v_mfma_f32_16x16x32_bf16 v[208:211], v[56:59], v[228:231], v[208:211]
  v_mfma_f32_16x16x32_bf16 v[216:219], v[60:63], v[228:231], v[216:219]
  ds_read_b128 v[92:95], v5 offset:6144
  v_mfma_f32_16x16x32_bf16 v[216:219], v[44:47], v[224:227], v[216:219]
  v_mfma_f32_16x16x32_bf16 v[220:223], v[44:47], v[232:235], v[220:223]
  ds_read_b64_tr_b16 v[104:105], v7 offset:0
  v_mfma_f32_16x16x32_bf16 v[220:223], v[60:63], v[236:239], v[220:223]
  v_mfma_f32_16x16x32_bf16 v[212:215], v[56:59], v[236:239], v[212:215]
  ds_read_b64_tr_b16 v[106:107], v7 offset:2048
  v_mfma_f32_16x16x32_bf16 v[212:215], v[40:43], v[232:235], v[212:215]
  v_mfma_f32_16x16x32_bf16 v[204:207], v[36:39], v[232:235], v[204:207]
  ds_read_b64_tr_b16 v[108:109], v7 offset:4096
  v_mfma_f32_16x16x32_bf16 v[204:207], v[52:55], v[236:239], v[204:207]
  v_mfma_f32_16x16x32_bf16 v[196:199], v[48:51], v[236:239], v[196:199]
  ds_read_b64_tr_b16 v[110:111], v7 offset:6144
  s_waitcnt lgkmcnt(6)
  v_mfma_f32_16x16x32_bf16 v[196:199], v[32:35], v[232:235], v[196:199]
  s_cbranch_vccnz Lo_7
Lk_4:
  v_mfma_f32_16x16x32_bf16 v[128:131], v[96:99], v[64:67], v[128:131]
  ds_read_b64_tr_b16 v[112:113], v6 offset:8192
  v_mfma_f32_16x16x32_bf16 v[128:131], v[100:103], v[80:83], v[128:131]
  ds_read_b64_tr_b16 v[114:115], v6 offset:10240
  v_mfma_f32_16x16x32_bf16 v[136:139], v[100:103], v[84:87], v[136:139]
  ds_read_b64_tr_b16 v[116:117], v6 offset:12288
  v_mfma_f32_16x16x32_bf16 v[136:139], v[96:99], v[68:71], v[136:139]
  ds_read_b64_tr_b16 v[118:119], v6 offset:14336
  v_mfma_f32_16x16x32_bf16 v[144:147], v[96:99], v[72:75], v[144:147]
  s_add_u32 s16, s16, s17
  s_cmp_eq_u32 s16, 65536
  s_cselect_b32 s23, s18, s17
  s_cselect_b32 s16, Lz1-Lz0+0, s16
  v_mfma_f32_16x16x32_bf16 v[144:147], v[100:103], v[88:91], v[144:147]
  v_add_u32_e64 v4, s23, v4
  v_add_u32 v5, s23, v5
  s_add_u32 s19, s19, s20
  s_cmp_eq_u32 s19, 73728
  s_waitcnt lgkmcnt(8)
  v_mfma_f32_16x16x32_bf16 v[152:155], v[100:103], v[92:95], v[152:155]
  s_cselect_b32 s23, s21, s20
  s_cselect_b32 s19, 0, s19
  v_mfma_f32_16x16x32_bf16 v[152:155], v[96:99], v[76:79], v[152:155]
  s_waitcnt lgkmcnt(4)
  v_mfma_f32_16x16x32_bf16 v[156:159], v[104:107], v[76:79], v[156:159]
  ds_read_b64_tr_b16 v[120:121], v7 offset:8192
  v_mfma_f32_16x16x32_bf16 v[156:159], v[108:111], v[92:95], v[156:159]
  ds_read_b64_tr_b16 v[122:123], v7 offset:10240
  v_mfma_f32_16x16x32_bf16 v[148:151], v[108:111], v[88:91], v[148:151]
  ds_read_b64_tr_b16 v[124:125], v7 offset:12288
  v_mfma_f32_16x16x32_bf16 v[148:151], v[104:107], v[72:75], v[148:151]
  ds_read_b64_tr_b16 v[126:127], v7 offset:14336
  v_mfma_f32_16x16x32_bf16 v[140:143], v[104:107], v[68:71], v[140:143]
  ds_read_b64_tr_b16 v[224:225], v6 offset:16384
  v_mfma_f32_16x16x32_bf16 v[140:143], v[108:111], v[84:87], v[140:143]
  ds_read_b64_tr_b16 v[226:227], v6 offset:18432
  v_mfma_f32_16x16x32_bf16 v[132:135], v[108:111], v[80:83], v[132:135]
  ds_read_b64_tr_b16 v[228:229], v6 offset:20480
  v_mfma_f32_16x16x32_bf16 v[132:135], v[104:107], v[64:67], v[132:135]
  ds_read_b64_tr_b16 v[230:231], v6 offset:22528
  s_nop 0
  s_waitcnt lgkmcnt(8)
  v_mfma_f32_16x16x32_bf16 v[160:163], v[112:115], v[64:67], v[160:163]
  ds_read_b64_tr_b16 v[232:233], v7 offset:16384
  v_mfma_f32_16x16x32_bf16 v[160:163], v[116:119], v[80:83], v[160:163]
  ds_read_b64_tr_b16 v[234:235], v7 offset:18432
  v_mfma_f32_16x16x32_bf16 v[168:171], v[116:119], v[84:87], v[168:171]
  ds_read_b64_tr_b16 v[236:237], v7 offset:20480
  v_mfma_f32_16x16x32_bf16 v[168:171], v[112:115], v[68:71], v[168:171]
  ds_read_b64_tr_b16 v[238:239], v7 offset:22528
  v_mfma_f32_16x16x32_bf16 v[176:179], v[112:115], v[72:75], v[176:179]
  v_add_u32_e64 v6, s23, v6
  v_mfma_f32_16x16x32_bf16 v[176:179], v[116:119], v[88:91], v[176:179]
  v_add_u32_e64 v7, s23, v7
  v_mfma_f32_16x16x32_bf16 v[184:187], v[116:119], v[92:95], v[184:187]
  s_sub_u32 s22, s22, Lz1-Lz0+1
  s_cmp_lg_u32 s22, 0
  v_mfma_f32_16x16x32_bf16 v[184:187], v[112:115], v[76:79], v[184:187]
  s_waitcnt lgkmcnt(0)
  s_barrier
  s_cbranch_scc0 Lk_5
  v_mfma_f32_16x16x32_bf16 v[188:191], v[120:123], v[76:79], v[188:191]
  ds_read_b128 v[32:35], v4 offset:0
  v_mfma_f32_16x16x32_bf16 v[188:191], v[124:127], v[92:95], v[188:191]
  ds_read_b128 v[48:51], v5 offset:0
  v_mfma_f32_16x16x32_bf16 v[180:183], v[124:127], v[88:91], v[180:183]
  v_mfma_f32_16x16x32_bf16 v[180:183], v[120:123], v[72:75], v[180:183]
  ds_read_b128 v[36:39], v4 offset:2048
  v_mfma_f32_16x16x32_bf16 v[172:175], v[120:123], v[68:71], v[172:175]
  ds_read_b128 v[52:55], v5 offset:2048
  v_mfma_f32_16x16x32_bf16 v[172:175], v[124:127], v[84:87], v[172:175]
  v_mfma_f32_16x16x32_bf16 v[164:167], v[124:127], v[80:83], v[164:167]
  ds_read_b128 v[40:43], v4 offset:4096
  v_mfma_f32_16x16x32_bf16 v[164:167], v[120:123], v[64:67], v[164:167]
  ds_read_b128 v[56:59], v5 offset:4096
  v_mfma_f32_16x16x32_bf16 v[192:195], v[64:67], v[224:227], v[192:195]
  ds_read_b64_tr_b16 v[96:97], v6 offset:0
  v_mfma_f32_16x16x32_bf16 v[192:195], v[80:83], v[228:231], v[192:195]
  ds_read_b64_tr_b16 v[98:99], v6 offset:2048
  v_mfma_f32_16x16x32_bf16 v[200:203], v[84:87], v[228:231], v[200:203]
  ds_read_b64_tr_b16 v[100:101], v6 offset:4096
  v_mfma_f32_16x16x32_bf16 v[200:203], v[68:71], v[224:227], v[200:203]
  ds_read_b64_tr_b16 v[102:103], v6 offset:6144
  v_mfma_f32_16x16x32_bf16 v[208:211], v[72:75], v[224:227], v[208:211]
  ds_read_b128 v[44:47], v4 offset:6144
  v_mfma_f32_16x16x32_bf16 v[208:211], v[88:91], v[228:231], v[208:211]
  v_mfma_f32_16x16x32_bf16 v[216:219], v[92:95], v[228:231], v[216:219]
  ds_read_b128 v[60:63], v5 offset:6144
  v_mfma_f32_16x16x32_bf16 v[216:219], v[76:79], v[224:227], v[216:219]
  v_mfma_f32_16x16x32_bf16 v[220:223], v[76:79], v[232:235], v[220:223]
  ds_read_b64_tr_b16 v[104:105], v7 offset:0
  v_mfma_f32_16x16x32_bf16 v[220:223], v[92:95], v[236:239], v[220:223]
  v_mfma_f32_16x16x32_bf16 v[212:215], v[88:91], v[236:239], v[212:215]
  ds_read_b64_tr_b16 v[106:107], v7 offset:2048
  v_mfma_f32_16x16x32_bf16 v[212:215], v[72:75], v[232:235], v[212:215]
  v_mfma_f32_16x16x32_bf16 v[204:207], v[68:71], v[232:235], v[204:207]
  ds_read_b64_tr_b16 v[108:109], v7 offset:4096
  v_mfma_f32_16x16x32_bf16 v[204:207], v[84:87], v[236:239], v[204:207]
  v_mfma_f32_16x16x32_bf16 v[196:199], v[80:83], v[236:239], v[196:199]
  ds_read_b64_tr_b16 v[110:111], v7 offset:6144
  s_waitcnt lgkmcnt(6)
  v_mfma_f32_16x16x32_bf16 v[196:199], v[64:67], v[232:235], v[196:199]
  s_branch Lk_3
Lk_5:
  v_mfma_f32_16x16x32_bf16 v[188:191], v[120:123], v[76:79], v[188:191]
  ds_read2_b32 v[4:5], v3 offset0:48 offset1:208
  ds_read_b128 v[106:109], v8 offset:256
  v_mfma_f32_16x16x32_bf16 v[188:191], v[124:127], v[92:95], v[188:191]
  ds_read_b128 v[110:113], v8 offset:320
  ds_read_b128 v[32:35], v10 offset:192
  v_mfma_f32_16x16x32_bf16 v[216:219], v[92:95], v[228:231], v[216:219]
  ds_read_b128 v[36:39], v10 offset:832
  ds_read2_b32 v[114:115], v2 offset0:128 offset1:144
  v_mfma_f32_16x16x32_bf16 v[216:219], v[76:79], v[224:227], v[216:219]
  ds_read_b128 v[98:101], v8 offset:0
  ds_read_b128 v[102:105], v8 offset:64
  v_mfma_f32_16x16x32_bf16 v[220:223], v[76:79], v[232:235], v[220:223]
  ds_read2_b32 v[6:7], v3 offset0:32 offset1:192
  ds_read2_b32 v[96:97], v3 offset0:16 offset1:176
  v_mfma_f32_16x16x32_bf16 v[220:223], v[92:95], v[236:239], v[220:223]
  v_mfma_f32_16x16x32_bf16 v[180:183], v[124:127], v[88:91], v[180:183]
  v_mfma_f32_16x16x32_bf16 v[180:183], v[120:123], v[72:75], v[180:183]
  v_mfma_f32_16x16x32_bf16 v[172:175], v[120:123], v[68:71], v[172:175]
  s_waitcnt lgkmcnt(4)
  v_mul_f32 v116, v106, v5
  v_mul_f32 v117, v107, v5
  v_mul_f32 v118, v108, v5
  v_mfma_f32_16x16x32_bf16 v[172:175], v[124:127], v[84:87], v[172:175]
  v_mul_f32_e64 v119, v109, v5
  v_fma_f32 v184, v184, v4, -v116
  v_fma_f32 v185, v185, v4, -v117
  v_mfma_f32_16x16x32_bf16 v[164:167], v[124:127], v[80:83], v[164:167]
  v_fma_f32 v186, v186, v4, -v118
  v_fma_f32 v187, v187, v4, -v119
  v_cvt_pk_bf16_f32 v60, v184, v185
  v_mfma_f32_16x16x32_bf16 v[164:167], v[120:123], v[64:67], v[164:167]
  v_cvt_pk_bf16_f32 v61, v186, v187
  v_mul_f32 v116, v110, v5
  v_mul_f32 v117, v111, v5
  v_mfma_f32_16x16x32_bf16 v[192:195], v[64:67], v[224:227], v[192:195]
  ds_read2_b32 v[124:125], v3 offset0:0 offset1:160
  v_mul_f32 v118, v112, v5
  v_mul_f32 v119, v113, v5
  v_fma_f32 v188, v188, v4, -v116
  v_mfma_f32_16x16x32_bf16 v[192:195], v[80:83], v[228:231], v[192:195]
  v_mov_b32 v120, 0x3f803f80
  v_fma_f32 v189, v189, v4, -v117
  v_fma_f32 v190, v190, v4, -v118
  v_fma_f32 v191, v191, v4, -v119
  v_mfma_f32_16x16x32_bf16 v[196:199], v[80:83], v[236:239], v[196:199]
  v_mov_b32 v121, 0x3f803f80
  v_cvt_pk_bf16_f32 v62, v188, v189
  v_cvt_pk_bf16_f32 v63, v190, v191
  v_mfma_f32_16x16x32_bf16 v[196:199], v[64:67], v[232:235], v[196:199]
  v_mov_b32 v122, 0x3f803f80
  s_mov_b32 exec_lo, s12
  s_mov_b32 exec_hi, s12
  buffer_store_dwordx4 v[60:63], v9, s[40:43], s9 offen sc0 sc1
  s_mov_b64 exec, -1
  v_mul_f32 v116, v36, v114
  v_mul_f32 v117, v37, v114
  v_mul_f32 v118, v38, v114
  v_mfma_f32_16x16x32_bf16 v[204:207], v[68:71], v[232:235], v[204:207]
  v_mov_b32 v123, 0x3f803f80
  v_mul_f32_e64 v119, v39, v114
  v_fma_f32 v216, v216, v32, -v116
  v_fma_f32 v217, v217, v33, -v117
  v_mfma_f32_16x16x32_bf16 v[204:207], v[84:87], v[236:239], v[204:207]
  v_fma_f32 v218, v218, v34, -v118
  v_fma_f32 v219, v219, v35, -v119
  v_cvt_pk_bf16_f32 v76, v216, v217
  v_mfma_f32_16x16x32_bf16 v[200:203], v[84:87], v[228:231], v[200:203]
  v_cvt_pk_bf16_f32 v77, v218, v219
  v_mul_f32 v116, v36, v115
  v_mul_f32 v117, v37, v115
  v_mfma_f32_16x16x32_bf16 v[200:203], v[68:71], v[224:227], v[200:203]
  v_mul_f32 v118, v38, v115
  v_mul_f32 v119, v39, v115
  v_fma_f32 v220, v220, v32, -v116
  v_mfma_f32_16x16x32_bf16 v[208:211], v[72:75], v[224:227], v[208:211]
  v_fma_f32 v221, v221, v33, -v117
  v_fma_f32 v222, v222, v34, -v118
  v_fma_f32 v223, v223, v35, -v119
  v_mfma_f32_16x16x32_bf16 v[208:211], v[88:91], v[228:231], v[208:211]
  v_cvt_pk_bf16_f32 v78, v220, v221
  v_cvt_pk_bf16_f32 v79, v222, v223
  v_mfma_f32_16x16x32_bf16 v[212:215], v[88:91], v[236:239], v[212:215]
  s_mov_b32 exec_lo, 0
  buffer_store_dwordx4 v[76:79], v11, s[40:43], s9 offen sc0 sc1
  s_mov_b64 exec, -1
  v_mfma_f32_16x16x32_bf16 v[212:215], v[72:75], v[232:235], v[212:215]
  v_mov_b64_e64 v[86:87], v[78:79]
  s_cmp_lg_u32 s82, 0
  s_cbranch_scc1 L_9
  buffer_load_dwordx4 v[240:243], v255, s[44:47], s25 offen
  s_add_u32 s25, s25, 0x10000
  buffer_load_dwordx4 v[244:247], v255, s[44:47], s25 offen
  s_add_u32 s25, s25, 0x10000
  buffer_load_dwordx4 v[248:251], v255, s[44:47], s25 offen
  s_add_u32 s25, s25, 0x10000
  buffer_load_dwordx4 v[252:255], v255, s[44:47], s25 offen
L_9:
  v_mov_b64 v[64:65], 0
  v_mov_b64 v[66:67], 0
  v_mov_b64_e64 v[232:233], 0
  v_mov_b64 v[234:235], 0
  s_waitcnt lgkmcnt(0)
  v_pk_mul_f32 v[116:117], v[98:99], v[124:125] op_sel:[0,1] op_sel_hi:[1,1]
  v_pk_mul_f32 v[118:119], v[100:101], v[124:125] op_sel:[0,1] op_sel_hi:[1,1]
  v_pk_fma_f32 v[128:129], v[128:129], v[124:125], v[116:117] op_sel:[0,0,0] op_sel_hi:[1,0,1] neg_lo:[0,0,1] neg_hi:[0,0,1]
  v_pk_fma_f32 v[130:131], v[130:131], v[124:125], v[118:119] op_sel:[0,0,0] op_sel_hi:[1,0,1] neg_lo:[0,0,1] neg_hi:[0,0,1]
  v_cvt_pk_bf16_f32 v32, v128, v129
  v_cvt_pk_bf16_f32 v33, v130, v131
  v_pk_mul_f32 v[116:117], v[102:103], v[124:125] op_sel:[0,1] op_sel_hi:[1,1]
  v_pk_mul_f32 v[118:119], v[104:105], v[124:125] op_sel:[0,1] op_sel_hi:[1,1]
  v_pk_fma_f32 v[132:133], v[132:133], v[124:125], v[116:117] op_sel:[0,0,0] op_sel_hi:[1,0,1] neg_lo:[0,0,1] neg_hi:[0,0,1]
  v_pk_fma_f32 v[134:135], v[134:135], v[124:125], v[118:119] op_sel:[0,0,0] op_sel_hi:[1,0,1] neg_lo:[0,0,1] neg_hi:[0,0,1]
  v_cvt_pk_bf16_f32 v34, v132, v133
  v_cvt_pk_bf16_f32 v35, v134, v135
  v_pk_mul_f32 v[116:117], v[98:99], v[96:97] op_sel:[0,1] op_sel_hi:[1,1]
  v_pk_mul_f32 v[118:119], v[100:101], v[96:97] op_sel:[0,1] op_sel_hi:[1,1]
  v_pk_fma_f32 v[136:137], v[136:137], v[96:97], v[116:117] op_sel:[0,0,0] op_sel_hi:[1,0,1] neg_lo:[0,0,1] neg_hi:[0,0,1]
  v_pk_fma_f32 v[138:139], v[138:139], v[96:97], v[118:119] op_sel:[0,0,0] op_sel_hi:[1,0,1] neg_lo:[0,0,1] neg_hi:[0,0,1]
  v_cvt_pk_bf16_f32 v36, v136, v137
  v_cvt_pk_bf16_f32 v37, v138, v139
  v_pk_mul_f32 v[116:117], v[102:103], v[96:97] op_sel:[0,1] op_sel_hi:[1,1]
  v_pk_mul_f32 v[118:119], v[104:105], v[96:97] op_sel:[0,1] op_sel_hi:[1,1]
  v_pk_fma_f32 v[140:141], v[140:141], v[96:97], v[116:117] op_sel:[0,0,0] op_sel_hi:[1,0,1] neg_lo:[0,0,1] neg_hi:[0,0,1]
  v_pk_fma_f32 v[142:143], v[142:143], v[96:97], v[118:119] op_sel:[0,0,0] op_sel_hi:[1,0,1] neg_lo:[0,0,1] neg_hi:[0,0,1]
  v_cvt_pk_bf16_f32 v38, v140, v141
  v_cvt_pk_bf16_f32 v39, v142, v143
  v_pk_mul_f32 v[116:117], v[98:99], v[6:7] op_sel:[0,1] op_sel_hi:[1,1]
  v_pk_mul_f32 v[118:119], v[100:101], v[6:7] op_sel:[0,1] op_sel_hi:[1,1]
  v_pk_fma_f32 v[144:145], v[144:145], v[6:7], v[116:117] op_sel:[0,0,0] op_sel_hi:[1,0,1] neg_lo:[0,0,1] neg_hi:[0,0,1]
  v_pk_fma_f32 v[146:147], v[146:147], v[6:7], v[118:119] op_sel:[0,0,0] op_sel_hi:[1,0,1] neg_lo:[0,0,1] neg_hi:[0,0,1]
  v_cvt_pk_bf16_f32 v40, v144, v145
  v_cvt_pk_bf16_f32 v41, v146, v147
  v_pk_mul_f32 v[116:117], v[102:103], v[6:7] op_sel:[0,1] op_sel_hi:[1,1]
  v_pk_mul_f32 v[118:119], v[104:105], v[6:7] op_sel:[0,1] op_sel_hi:[1,1]
  v_pk_fma_f32 v[148:149], v[148:149], v[6:7], v[116:117] op_sel:[0,0,0] op_sel_hi:[1,0,1] neg_lo:[0,0,1] neg_hi:[0,0,1]
  v_pk_fma_f32 v[150:151], v[150:151], v[6:7], v[118:119] op_sel:[0,0,0] op_sel_hi:[1,0,1] neg_lo:[0,0,1] neg_hi:[0,0,1]
  v_cvt_pk_bf16_f32 v42, v148, v149
  v_cvt_pk_bf16_f32 v43, v150, v151
  v_pk_mul_f32 v[116:117], v[98:99], v[4:5] op_sel:[0,1] op_sel_hi:[1,1]
  v_pk_mul_f32 v[118:119], v[100:101], v[4:5] op_sel:[0,1] op_sel_hi:[1,1]
  v_pk_fma_f32 v[152:153], v[152:153], v[4:5], v[116:117] op_sel:[0,0,0] op_sel_hi:[1,0,1] neg_lo:[0,0,1] neg_hi:[0,0,1]
  v_pk_fma_f32 v[154:155], v[154:155], v[4:5], v[118:119] op_sel:[0,0,0] op_sel_hi:[1,0,1] neg_lo:[0,0,1] neg_hi:[0,0,1]
  v_cvt_pk_bf16_f32 v44, v152, v153
  v_cvt_pk_bf16_f32 v45, v154, v155
  v_pk_mul_f32 v[116:117], v[102:103], v[4:5] op_sel:[0,1] op_sel_hi:[1,1]
  v_pk_mul_f32 v[118:119], v[104:105], v[4:5] op_sel:[0,1] op_sel_hi:[1,1]
  v_pk_fma_f32 v[156:157], v[156:157], v[4:5], v[116:117] op_sel:[0,0,0] op_sel_hi:[1,0,1] neg_lo:[0,0,1] neg_hi:[0,0,1]
  v_pk_fma_f32 v[158:159], v[158:159], v[4:5], v[118:119] op_sel:[0,0,0] op_sel_hi:[1,0,1] neg_lo:[0,0,1] neg_hi:[0,0,1]
  v_cvt_pk_bf16_f32 v46, v156, v157
  v_cvt_pk_bf16_f32 v47, v158, v159
  ds_read_b128 v[128:131], v10 offset:0
  ds_read_b128 v[132:135], v10 offset:640
  ds_read_b128 v[136:139], v10 offset:64
  ds_read_b128 v[140:143], v10 offset:704
  ds_read_b128 v[144:147], v10 offset:128
  ds_read_b128 v[148:151], v10 offset:768
  v_pk_mul_f32 v[116:117], v[106:107], v[124:125] op_sel:[0,1] op_sel_hi:[1,1]
  v_pk_mul_f32 v[118:119], v[108:109], v[124:125] op_sel:[0,1] op_sel_hi:[1,1]
  v_pk_fma_f32 v[160:161], v[160:161], v[124:125], v[116:117] op_sel:[0,0,0] op_sel_hi:[1,0,1] neg_lo:[0,0,1] neg_hi:[0,0,1]
  v_pk_fma_f32 v[162:163], v[162:163], v[124:125], v[118:119] op_sel:[0,0,0] op_sel_hi:[1,0,1] neg_lo:[0,0,1] neg_hi:[0,0,1]
  v_cvt_pk_bf16_f32 v48, v160, v161
  v_cvt_pk_bf16_f32 v49, v162, v163
  v_pk_mul_f32 v[116:117], v[110:111], v[124:125] op_sel:[0,1] op_sel_hi:[1,1]
  v_pk_mul_f32 v[118:119], v[112:113], v[124:125] op_sel:[0,1] op_sel_hi:[1,1]
  v_pk_fma_f32 v[164:165], v[164:165], v[124:125], v[116:117] op_sel:[0,0,0] op_sel_hi:[1,0,1] neg_lo:[0,0,1] neg_hi:[0,0,1]
  v_pk_fma_f32 v[166:167], v[166:167], v[124:125], v[118:119] op_sel:[0,0,0] op_sel_hi:[1,0,1] neg_lo:[0,0,1] neg_hi:[0,0,1]
  v_cvt_pk_bf16_f32 v50, v164, v165
  v_cvt_pk_bf16_f32 v51, v166, v167
  v_pk_mul_f32 v[116:117], v[106:107], v[96:97] op_sel:[0,1] op_sel_hi:[1,1]
  v_pk_mul_f32 v[118:119], v[108:109], v[96:97] op_sel:[0,1] op_sel_hi:[1,1]
  v_pk_fma_f32 v[168:169], v[168:169], v[96:97], v[116:117] op_sel:[0,0,0] op_sel_hi:[1,0,1] neg_lo:[0,0,1] neg_hi:[0,0,1]
  v_pk_fma_f32 v[170:171], v[170:171], v[96:97], v[118:119] op_sel:[0,0,0] op_sel_hi:[1,0,1] neg_lo:[0,0,1] neg_hi:[0,0,1]
  v_cvt_pk_bf16_f32 v52, v168, v169
  v_cvt_pk_bf16_f32 v53, v170, v171
  v_pk_mul_f32 v[116:117], v[110:111], v[96:97] op_sel:[0,1] op_sel_hi:[1,1]
  v_pk_mul_f32 v[118:119], v[112:113], v[96:97] op_sel:[0,1] op_sel_hi:[1,1]
  v_pk_fma_f32 v[172:173], v[172:173], v[96:97], v[116:117] op_sel:[0,0,0] op_sel_hi:[1,0,1] neg_lo:[0,0,1] neg_hi:[0,0,1]
  v_pk_fma_f32 v[174:175], v[174:175], v[96:97], v[118:119] op_sel:[0,0,0] op_sel_hi:[1,0,1] neg_lo:[0,0,1] neg_hi:[0,0,1]
  v_cvt_pk_bf16_f32 v54, v172, v173
  v_cvt_pk_bf16_f32 v55, v174, v175
  v_pk_mul_f32 v[116:117], v[106:107], v[6:7] op_sel:[0,1] op_sel_hi:[1,1]
  v_pk_mul_f32 v[118:119], v[108:109], v[6:7] op_sel:[0,1] op_sel_hi:[1,1]
  v_pk_fma_f32 v[176:177], v[176:177], v[6:7], v[116:117] op_sel:[0,0,0] op_sel_hi:[1,0,1] neg_lo:[0,0,1] neg_hi:[0,0,1]
  v_pk_fma_f32 v[178:179], v[178:179], v[6:7], v[118:119] op_sel:[0,0,0] op_sel_hi:[1,0,1] neg_lo:[0,0,1] neg_hi:[0,0,1]
  v_cvt_pk_bf16_f32 v56, v176, v177
  v_cvt_pk_bf16_f32 v57, v178, v179
  v_pk_mul_f32 v[116:117], v[110:111], v[6:7] op_sel:[0,1] op_sel_hi:[1,1]
  v_pk_mul_f32 v[118:119], v[112:113], v[6:7] op_sel:[0,1] op_sel_hi:[1,1]
  v_pk_fma_f32 v[180:181], v[180:181], v[6:7], v[116:117] op_sel:[0,0,0] op_sel_hi:[1,0,1] neg_lo:[0,0,1] neg_hi:[0,0,1]
  v_pk_fma_f32 v[182:183], v[182:183], v[6:7], v[118:119] op_sel:[0,0,0] op_sel_hi:[1,0,1] neg_lo:[0,0,1] neg_hi:[0,0,1]
  v_cvt_pk_bf16_f32 v58, v180, v181
  v_cvt_pk_bf16_f32 v59, v182, v183
  v_mfma_f32_16x16x32_bf16 v[164:167], v[48:51], v[32:35], v[12:15]
  v_mfma_f32_16x16x32_bf16 v[168:171], v[48:51], v[36:39], v[16:19]
  v_mfma_f32_16x16x32_bf16 v[172:175], v[52:55], v[36:39], v[12:15]
  v_mfma_f32_16x16x32_bf16 v[176:179], v[52:55], v[40:43], v[16:19]
  v_mfma_f32_16x16x32_bf16 v[180:183], v[56:59], v[40:43], v[12:15]
  v_mfma_f32_16x16x32_bf16 v[184:187], v[56:59], v[44:47], v[16:19]
  v_mfma_f32_16x16x32_bf16 v[188:191], v[60:63], v[44:47], v[12:15]
  s_nop 0
  s_waitcnt lgkmcnt(0)
  v_pk_mul_f32 v[116:117], v[132:133], v[114:115] op_sel:[0,0] op_sel_hi:[1,0]
  v_pk_mul_f32 v[118:119], v[134:135], v[114:115] op_sel:[0,0] op_sel_hi:[1,0]
  v_pk_fma_f32 v[192:193], v[192:193], v[128:129], v[116:117] neg_lo:[0,0,1] neg_hi:[0,0,1]
  v_pk_fma_f32 v[194:195], v[194:195], v[130:131], v[118:119] neg_lo:[0,0,1] neg_hi:[0,0,1]
  v_cvt_pk_bf16_f32 v70, v192, v193
  v_cvt_pk_bf16_f32 v71, v194, v195
  v_pk_mul_f32 v[116:117], v[132:133], v[114:115] op_sel:[0,1] op_sel_hi:[1,1]
  v_pk_mul_f32 v[118:119], v[134:135], v[114:115] op_sel:[0,1] op_sel_hi:[1,1]
  v_pk_fma_f32 v[196:197], v[196:197], v[128:129], v[116:117] neg_lo:[0,0,1] neg_hi:[0,0,1]
  v_pk_fma_f32 v[198:199], v[198:199], v[130:131], v[118:119] neg_lo:[0,0,1] neg_hi:[0,0,1]
  v_cvt_pk_bf16_f32 v80, v196, v197
  v_cvt_pk_bf16_f32 v81, v198, v199
  v_pk_mul_f32 v[116:117], v[140:141], v[114:115] op_sel:[0,0] op_sel_hi:[1,0]
  v_pk_mul_f32 v[118:119], v[142:143], v[114:115] op_sel:[0,0] op_sel_hi:[1,0]
  v_pk_fma_f32 v[200:201], v[200:201], v[136:137], v[116:117] neg_lo:[0,0,1] neg_hi:[0,0,1]
  v_pk_fma_f32 v[202:203], v[202:203], v[138:139], v[118:119] neg_lo:[0,0,1] neg_hi:[0,0,1]
  v_cvt_pk_bf16_f32 v72, v200, v201
  v_cvt_pk_bf16_f32 v73, v202, v203
  v_pk_mul_f32 v[116:117], v[140:141], v[114:115] op_sel:[0,1] op_sel_hi:[1,1]
  v_pk_mul_f32 v[118:119], v[142:143], v[114:115] op_sel:[0,1] op_sel_hi:[1,1]
  v_pk_fma_f32 v[204:205], v[204:205], v[136:137], v[116:117] neg_lo:[0,0,1] neg_hi:[0,0,1]
  v_pk_fma_f32 v[206:207], v[206:207], v[138:139], v[118:119] neg_lo:[0,0,1] neg_hi:[0,0,1]
  v_cvt_pk_bf16_f32 v82, v204, v205
  v_cvt_pk_bf16_f32 v83, v206, v207
  v_pk_mul_f32 v[116:117], v[148:149], v[114:115] op_sel:[0,0] op_sel_hi:[1,0]
  v_pk_mul_f32 v[118:119], v[150:151], v[114:115] op_sel:[0,0] op_sel_hi:[1,0]
  v_pk_fma_f32 v[208:209], v[208:209], v[144:145], v[116:117] neg_lo:[0,0,1] neg_hi:[0,0,1]
  v_pk_fma_f32 v[210:211], v[210:211], v[146:147], v[118:119] neg_lo:[0,0,1] neg_hi:[0,0,1]
  v_cvt_pk_bf16_f32 v74, v208, v209
  v_cvt_pk_bf16_f32 v75, v210, v211
  v_pk_mul_f32 v[116:117], v[148:149], v[114:115] op_sel:[0,1] op_sel_hi:[1,1]
  v_pk_mul_f32 v[118:119], v[150:151], v[114:115] op_sel:[0,1] op_sel_hi:[1,1]
  v_pk_fma_f32 v[212:213], v[212:213], v[144:145], v[116:117] neg_lo:[0,0,1] neg_hi:[0,0,1]
  v_pk_fma_f32 v[214:215], v[214:215], v[146:147], v[118:119] neg_lo:[0,0,1] neg_hi:[0,0,1]
  v_cvt_pk_bf16_f32 v84, v212, v213
  v_cvt_pk_bf16_f32 v85, v214, v215
  v_max3_f32 v90, v172, v173, v174
  v_max3_f32 v99, v175, v168, v169
  v_max3_f32 v92, v180, v181, v182
  v_max3_f32 v100, v183, v176, v177
  v_max3_f32 v94, v188, v189, v190
  v_max3_f32 v101, v191, v184, v185
  v_max3_f32 v90, v90, v170, v171
  v_max3_f32 v92, v92, v178, v179
  v_max3_f32 v94, v94, v186, v187
  v_max_f32 v90, v90, v99
  v_max_f32 v92, v92, v100
  v_max_f32 v94, v94, v101
  v_mov_b32 v99, v90
  v_mov_b32 v100, v92
  v_mov_b32 v101, v94
  v_permlane32_swap_b32 v90, v99
  v_permlane32_swap_b32 v92, v100
  v_permlane32_swap_b32 v94, v101
  v_max_f32 v90, v90, v99
  v_max_f32 v92, v92, v100
  v_max_f32 v94, v94, v101
  v_mov_b32 v99, v90
  v_mov_b32 v100, v92
  v_mov_b32 v101, v94
  v_permlane16_swap_b32 v90, v99
  v_permlane16_swap_b32 v92, v100
  v_permlane16_swap_b32 v94, v101
  v_max_f32 v90, v90, v99
  v_max_f32 v92, v92, v100
  v_max_f32_e64 v94, v94, v101
  s_mov_b32 s4, 0x3e8293ee
  v_mul_f32 v90, s4, v90
  v_mov_b32 v91, s4
  v_mul_f32 v92, s4, v92
  v_mov_b32 v93, s4
  v_mul_f32 v94, s4, v94
  v_mov_b32 v95, s4
  v_pk_fma_f32 v[168:169], v[168:169], v[90:91], v[90:91] op_sel:[0,1,0] op_sel_hi:[1,1,0] neg_lo:[0,0,1] neg_hi:[0,0,1]
  v_pk_fma_f32 v[170:171], v[170:171], v[90:91], v[90:91] op_sel:[0,1,0] op_sel_hi:[1,1,0] neg_lo:[0,0,1] neg_hi:[0,0,1]
  v_pk_fma_f32 v[172:173], v[172:173], v[90:91], v[90:91] op_sel:[0,1,0] op_sel_hi:[1,1,0] neg_lo:[0,0,1] neg_hi:[0,0,1]
  v_pk_fma_f32 v[174:175], v[174:175], v[90:91], v[90:91] op_sel:[0,1,0] op_sel_hi:[1,1,0] neg_lo:[0,0,1] neg_hi:[0,0,1]
  v_pk_fma_f32 v[176:177], v[176:177], v[92:93], v[92:93] op_sel:[0,1,0] op_sel_hi:[1,1,0] neg_lo:[0,0,1] neg_hi:[0,0,1]
  v_pk_fma_f32 v[178:179], v[178:179], v[92:93], v[92:93] op_sel:[0,1,0] op_sel_hi:[1,1,0] neg_lo:[0,0,1] neg_hi:[0,0,1]
  v_pk_fma_f32 v[180:181], v[180:181], v[92:93], v[92:93] op_sel:[0,1,0] op_sel_hi:[1,1,0] neg_lo:[0,0,1] neg_hi:[0,0,1]
  v_pk_fma_f32 v[182:183], v[182:183], v[92:93], v[92:93] op_sel:[0,1,0] op_sel_hi:[1,1,0] neg_lo:[0,0,1] neg_hi:[0,0,1]
  v_pk_fma_f32 v[184:185], v[184:185], v[94:95], v[94:95] op_sel:[0,1,0] op_sel_hi:[1,1,0] neg_lo:[0,0,1] neg_hi:[0,0,1]
  v_pk_fma_f32 v[186:187], v[186:187], v[94:95], v[94:95] op_sel:[0,1,0] op_sel_hi:[1,1,0] neg_lo:[0,0,1] neg_hi:[0,0,1]
  v_pk_fma_f32 v[188:189], v[188:189], v[94:95], v[94:95] op_sel:[0,1,0] op_sel_hi:[1,1,0] neg_lo:[0,0,1] neg_hi:[0,0,1]
  v_pk_fma_f32 v[190:191], v[190:191], v[94:95], v[94:95] op_sel:[0,1,0] op_sel_hi:[1,1,0] neg_lo:[0,0,1] neg_hi:[0,0,1]
  s_lshl_b32 s6, s84, Lz1-Lz0+3
  s_add_u32 s6, s6, 3145728
  s_add_u32 s7, s6, 4096
  s_mov_b32 exec_lo, s12
  s_mov_b32 exec_hi, s12
  buffer_load_dwordx4 v[64:67], v9, s[40:43], s11 offen sc0 sc1
  s_mov_b32 exec_lo, 0
  s_mov_b32 exec_hi, -1
  buffer_load_dwordx4 v[232:235], v11, s[40:43], s11 offen sc0 sc1
  s_mov_b64 exec, -1
  v_exp_f32 v168, v168
  v_exp_f32 v169, v169
  v_exp_f32 v170, v170
  v_exp_f32 v171, v171
  v_exp_f32 v172, v172
  v_exp_f32 v173, v173
  v_exp_f32 v174, v174
  v_exp_f32_e64 v175, v175
  v_cvt_pk_bf16_f32 v36, v168, v169
  v_cvt_pk_bf16_f32 v37, v170, v171
  v_cvt_pk_bf16_f32 v38, v172, v173
  v_cvt_pk_bf16_f32 v39, v174, v175
  v_exp_f32 v176, v176
  v_exp_f32 v177, v177
  v_exp_f32 v178, v178
  v_exp_f32 v179, v179
  v_exp_f32 v180, v180
  v_exp_f32 v181, v181
  v_exp_f32 v182, v182
  v_exp_f32 v183, v183
  v_cvt_pk_bf16_f32 v40, v176, v177
  v_cvt_pk_bf16_f32 v41, v178, v179
  v_cvt_pk_bf16_f32 v42, v180, v181
  v_cvt_pk_bf16_f32 v43, v182, v183
  v_mfma_f32_16x16x32_bf16 v[132:135], v[120:123], v[36:39], 0
  v_mfma_f32_16x16x32_bf16 v[200:203], v[70:73], v[36:39], 0
  v_mfma_f32_16x16x32_bf16 v[204:207], v[80:83], v[36:39], 0
  v_exp_f32 v184, v184
  v_exp_f32 v185, v185
  v_exp_f32 v186, v186
  v_exp_f32 v187, v187
  v_exp_f32 v188, v188
  v_exp_f32 v189, v189
  v_exp_f32 v190, v190
  v_exp_f32 v191, v191
  v_cvt_pk_bf16_f32 v44, v184, v185
  v_cvt_pk_bf16_f32 v45, v186, v187
  v_cvt_pk_bf16_f32 v46, v188, v189
  v_cvt_pk_bf16_f32 v47, v190, v191
  v_mfma_f32_16x16x32_bf16 v[136:139], v[120:123], v[40:43], 0
  v_mfma_f32_16x16x32_bf16 v[208:211], v[72:75], v[40:43], 0
  v_mfma_f32_16x16x32_bf16 v[212:215], v[82:85], v[40:43], 0
  v_mfma_f32_16x16x32_bf16 v[140:143], v[120:123], v[44:47], 0
  v_mfma_f32_16x16x32_bf16 v[216:219], v[74:77], v[44:47], 0
  v_mfma_f32_16x16x32_bf16 v[220:223], v[84:87], v[44:47], 0
  v_rcp_f32 v132, v132
  s_nop 0
  v_pk_mul_f32 v[200:201], v[200:201], v[132:133] op_sel_hi:[1,0]
  v_pk_mul_f32 v[202:203], v[202:203], v[132:133] op_sel_hi:[1,0]
  v_pk_mul_f32 v[204:205], v[204:205], v[132:133] op_sel_hi:[1,0]
  v_pk_mul_f32 v[206:207], v[206:207], v[132:133] op_sel_hi:[1,0]
  v_cvt_pk_bf16_f32 v52, v200, v201
  v_cvt_pk_bf16_f32 v53, v202, v203
  v_cvt_pk_bf16_f32 v54, v204, v205
  v_cvt_pk_bf16_f32 v55, v206, v207
  buffer_store_dwordx4 v[52:55], v0, s[40:43], s6 offen offset:2048 sc0 sc1
  ds_write_b128 v0, v[52:55] offset:2048
  v_rcp_f32 v136, v136
  s_nop 0
  v_pk_mul_f32 v[208:209], v[208:209], v[136:137] op_sel_hi:[1,0]
  v_pk_mul_f32 v[210:211], v[210:211], v[136:137] op_sel_hi:[1,0]
  v_pk_mul_f32 v[212:213], v[212:213], v[136:137] op_sel_hi:[1,0]
  v_pk_mul_f32 v[214:215], v[214:215], v[136:137] op_sel_hi:[1,0]
  v_cvt_pk_bf16_f32 v56, v208, v209
  v_cvt_pk_bf16_f32 v57, v210, v211
  v_cvt_pk_bf16_f32 v58, v212, v213
  v_cvt_pk_bf16_f32 v59, v214, v215
  buffer_store_dwordx4 v[56:59], v0, s[40:43], s7 offen offset:0 sc0 sc1
  ds_write_b128 v0, v[56:59] offset:4096
  v_rcp_f32 v140, v140
  s_nop 0
  v_pk_mul_f32 v[216:217], v[216:217], v[140:141] op_sel_hi:[1,0]
  v_pk_mul_f32 v[218:219], v[218:219], v[140:141] op_sel_hi:[1,0]
  v_pk_mul_f32 v[220:221], v[220:221], v[140:141] op_sel_hi:[1,0]
  v_pk_mul_f32 v[222:223], v[222:223], v[140:141] op_sel_hi:[1,0]
  v_cvt_pk_bf16_f32 v60, v216, v217
  v_cvt_pk_bf16_f32 v61, v218, v219
  v_cvt_pk_bf16_f32 v62, v220, v221
  v_cvt_pk_bf16_f32 v63, v222, v223
  buffer_store_dwordx4 v[60:63], v0, s[40:43], s7 offen offset:2048 sc0 sc1
  ds_write_b128 v0, v[60:63] offset:6144
  s_cmp_eq_u32 s76, Lz1-Lz0+0
  s_mov_b32 s89, 200000
  s_waitcnt vmcnt(3)
  s_cbranch_scc0 Lh_11
  v_mov_b64 v[64:65], 0
  v_mov_b64 v[66:67], 0
  v_mov_b64 v[232:233], 0
  v_mov_b64 v[234:235], 0
  s_branch Lh_12
  s_nop 0
Lh_10:
  s_mov_b32 exec_lo, s12
  s_mov_b32 exec_hi, s12
  buffer_load_dwordx4 v[64:67], v9, s[40:43], s11 offen sc0 sc1
  s_mov_b32 exec_lo, 0
  s_mov_b32 exec_hi, -1
  buffer_load_dwordx4 v[232:235], v11, s[40:43], s11 offen sc0 sc1
  s_mov_b64 exec, -1
  s_waitcnt vmcnt(0)
Lh_11:
  v_max3_u32 v2, v64, v65, v66
  v_max3_u32 v3, v232, v233, v234
  v_max3_u32 v2, v2, v67, v235
  v_max_u32_e64 v2, v2, v3
  v_cmp_eq_u32 vcc, -1, v2
  s_cbranch_vccz Lh_12
  s_sub_u32 s89, s89, 1
  s_cbranch_scc0 Lh_10
Lh_12:
  v_mfma_f32_16x16x32_bf16 v[160:163], v[64:67], v[32:35], v[20:23]
  v_mov_b64 v[68:69], v[232:233]
  v_mov_b64 v[78:79], v[234:235]
  v_mov_b64 v[236:237], -1
  v_mov_b64 v[238:239], -1
  buffer_store_dwordx4 v[236:239], v11, s[40:43], s11 offen sc0 sc1
  v_max3_f32 v88, v164, v165, v166
  s_nop 0
  s_nop 1
  v_max3_f32 v98, v167, v160, v161
  v_max3_f32 v88, v88, v162, v163
  v_max_f32 v88, v88, v98
  v_mov_b32 v98, v88
  s_nop 1
  v_permlane32_swap_b32 v88, v98
  v_max_f32 v88, v88, v98
  v_mov_b32 v98, v88
  s_nop 1
  v_permlane16_swap_b32 v88, v98
  v_max_f32_e64 v88, v88, v98
  s_mov_b32 s4, 0x3e8293ee
  v_mul_f32 v88, s4, v88
  v_mov_b32 v89, s4
  v_pk_fma_f32 v[160:161], v[160:161], v[88:89], v[88:89] op_sel:[0,1,0] op_sel_hi:[1,1,0] neg_lo:[0,0,1] neg_hi:[0,0,1]
  v_pk_fma_f32 v[162:163], v[162:163], v[88:89], v[88:89] op_sel:[0,1,0] op_sel_hi:[1,1,0] neg_lo:[0,0,1] neg_hi:[0,0,1]
  v_pk_fma_f32 v[164:165], v[164:165], v[88:89], v[88:89] op_sel:[0,1,0] op_sel_hi:[1,1,0] neg_lo:[0,0,1] neg_hi:[0,0,1]
  v_pk_fma_f32 v[166:167], v[166:167], v[88:89], v[88:89] op_sel:[0,1,0] op_sel_hi:[1,1,0] neg_lo:[0,0,1] neg_hi:[0,0,1]
  v_exp_f32 v160, v160
  v_exp_f32 v161, v161
  v_exp_f32 v162, v162
  v_exp_f32 v163, v163
  v_exp_f32 v164, v164
  v_exp_f32 v165, v165
  v_exp_f32 v166, v166
  v_exp_f32 v167, v167
  v_cvt_pk_bf16_f32 v32, v160, v161
  v_cvt_pk_bf16_f32 v33, v162, v163
  v_cvt_pk_bf16_f32 v34, v164, v165
  v_cvt_pk_bf16_f32 v35, v166, v167
  s_nop 0
  s_nop 1
  v_mfma_f32_16x16x32_bf16 v[128:131], v[120:123], v[32:35], 0
  v_mfma_f32_16x16x32_bf16 v[192:195], v[68:71], v[32:35], 0
  v_mfma_f32_16x16x32_bf16 v[196:199], v[78:81], v[32:35], 0
  s_nop 5
  v_rcp_f32_e64 v128, v128
  s_nop 0
  v_pk_mul_f32 v[192:193], v[192:193], v[128:129] op_sel_hi:[1,0]
  v_pk_mul_f32 v[194:195], v[194:195], v[128:129] op_sel_hi:[1,0]
  v_pk_mul_f32 v[196:197], v[196:197], v[128:129] op_sel_hi:[1,0]
  v_pk_mul_f32 v[198:199], v[198:199], v[128:129] op_sel_hi:[1,0]
  v_cvt_pk_bf16_f32 v48, v192, v193
  v_cvt_pk_bf16_f32 v49, v194, v195
  v_cvt_pk_bf16_f32 v50, v196, v197
  v_cvt_pk_bf16_f32 v51, v198, v199
  buffer_store_dwordx4 v[48:51], v0, s[40:43], s6 offen offset:0 sc0 sc1
  ds_write_b128 v0, v[48:51] offset:0
  ds_read_b32 v3, v28 offset:8
  s_cmp_lg_u32 s82, 0
  s_cbranch_scc1 L_14
  v_permlane16_swap_b32 v240, v242
  v_permlane16_swap_b32 v241, v243
  v_permlane16_swap_b32 v244, v246
  v_permlane16_swap_b32 v245, v247
  v_permlane16_swap_b32 v248, v250
  v_permlane16_swap_b32 v249, v251
  v_permlane16_swap_b32 v252, v254
  v_permlane16_swap_b32 v253, v255
L_14:
  s_mov_b32 s16, Lz1-Lz0+0
  s_mov_b32 s17, 16384
  s_mov_b32 s18, 0xffff4000
  s_mov_b32 s19, 32768
  s_mov_b32 s20, 8192
  s_mov_b32 s21, 0xfffee000
  s_mul_i32 s4, s85, 8192
  v_add_u32_e64 v4, s4, v11
  v_add_u32 v5, 1024, v4
  s_add_u32 s5, s19, 0
  s_lshl_b32 s4, s86, 1
  v_xor_b32_e64 v2, s4, v26
  v_lshl_add_u32 v6, v2, 5, v25
  v_add_u32 v6, s5, v6
  s_add_u32 s4, s4, 1
  v_xor_b32_e64 v2, s4, v26
  v_lshl_add_u32 v7, v2, 5, v25
  v_add_u32 v7, s5, v7
  s_lshl_b32 s5, s82, 1
  s_add_u32 s5, s5, Lz1-Lz0+2
  s_mov_b32 s89, 1600000
  s_branch Lw_16
Lw_15:
  ds_read_b32 v3, v28 offset:8
Lw_16:
  s_waitcnt lgkmcnt(0)
  v_readfirstlane_b32 s4, v3
  s_cmp_ge_u32 s4, s5
  s_cbranch_scc1 Lw_17
  s_sleep 1
  s_sub_u32 s89, s89, 1
  s_cbranch_scc0 Lw_15
Lw_17:
  ds_read_b64_tr_b16 v[48:49], v6 offset:0
  ds_read_b64_tr_b16 v[50:51], v6 offset:2048
  ds_read_b64_tr_b16 v[52:53], v7 offset:0
  ds_read_b64_tr_b16 v[54:55], v7 offset:2048
  ds_read_b64_tr_b16 v[80:81], v6 offset:4096
  ds_read_b64_tr_b16 v[82:83], v6 offset:6144
  ds_read_b64_tr_b16 v[84:85], v7 offset:4096
  ds_read_b64_tr_b16 v[86:87], v7 offset:6144
  ds_read_b64_tr_b16 v[112:113], v6 offset:8192
  ds_read_b64_tr_b16 v[114:115], v6 offset:10240
  ds_read_b64_tr_b16 v[116:117], v7 offset:8192
  ds_read_b64_tr_b16 v[118:119], v7 offset:10240
  s_nop 0
  s_waitcnt lgkmcnt(8)
  ds_read_b64_tr_b16 v[208:209], v6 offset:12288
  ds_read_b64_tr_b16 v[210:211], v6 offset:14336
  ds_read_b64_tr_b16 v[212:213], v7 offset:12288
  ds_read_b64_tr_b16 v[214:215], v7 offset:14336
  s_nop 0
  s_waitcnt lgkmcnt(8)
  ds_read_b64_tr_b16 v[160:161], v6 offset:16384
  ds_read_b64_tr_b16 v[162:163], v6 offset:18432
  ds_read_b64_tr_b16 v[164:165], v7 offset:16384
  ds_read_b64_tr_b16 v[166:167], v7 offset:18432
  s_nop 0
  s_waitcnt lgkmcnt(8)
  ds_read_b64_tr_b16 v[168:169], v6 offset:20480
  ds_read_b64_tr_b16 v[170:171], v6 offset:22528
  ds_read_b64_tr_b16 v[172:173], v7 offset:20480
  ds_read_b64_tr_b16 v[174:175], v7 offset:22528
  s_nop 0
  s_waitcnt lgkmcnt(8)
  ds_read_b64_tr_b16 v[176:177], v6 offset:24576
  ds_read_b64_tr_b16 v[178:179], v6 offset:26624
  ds_read_b64_tr_b16 v[180:181], v7 offset:24576
  ds_read_b64_tr_b16 v[182:183], v7 offset:26624
  s_nop 0
  s_waitcnt lgkmcnt(8)
  ds_read_b64_tr_b16 v[184:185], v6 offset:28672
  ds_read_b64_tr_b16 v[186:187], v6 offset:30720
  ds_read_b64_tr_b16 v[188:189], v7 offset:28672
  ds_read_b64_tr_b16 v[190:191], v7 offset:30720
  s_nop 0
  s_waitcnt lgkmcnt(8)
  ds_read_b64_tr_b16 v[224:225], v6 offset:32768
  ds_read_b64_tr_b16 v[226:227], v6 offset:34816
  ds_read_b64_tr_b16 v[228:229], v7 offset:32768
  ds_read_b64_tr_b16 v[230:231], v7 offset:34816
  s_nop 0
  s_waitcnt lgkmcnt(8)
  ds_read_b64_tr_b16 v[232:233], v6 offset:36864
  ds_read_b64_tr_b16 v[234:235], v6 offset:38912
  ds_read_b64_tr_b16 v[236:237], v7 offset:36864
  ds_read_b64_tr_b16 v[238:239], v7 offset:38912
  s_nop 0
  s_waitcnt lgkmcnt(8)
  ds_read_b64_tr_b16 v[56:57], v6 offset:40960
  ds_read_b64_tr_b16 v[58:59], v6 offset:43008
  ds_read_b64_tr_b16 v[60:61], v7 offset:40960
  ds_read_b64_tr_b16 v[62:63], v7 offset:43008
  s_nop 0
  s_waitcnt lgkmcnt(8)
  ds_read_b64_tr_b16 v[88:89], v6 offset:45056
  ds_read_b64_tr_b16 v[90:91], v6 offset:47104
  ds_read_b64_tr_b16 v[92:93], v7 offset:45056
  ds_read_b64_tr_b16 v[94:95], v7 offset:47104
  s_waitcnt lgkmcnt(8)
  s_mov_b32 s19, 0
  v_add_u32 v6, 0xffff8000, v6
  v_add_u32 v7, 0xffff8000, v7
  s_waitcnt lgkmcnt(0)
  s_mov_b64 exec, 1
  ds_add_u32 v28, v27 offset:12
  s_mov_b64 exec, -1
  s_add_u32 s5, s87, 0
  s_waitcnt vmcnt(0)
  s_mov_b64 exec, 1
  ds_add_rtn_u32 v2, v28, v27 offset:0
  s_waitcnt lgkmcnt(0)
  v_readfirstlane_b32 s4, v2
  s_and_b32 s4, s4, Lz1-Lz0+3
  s_cmp_lg_u32 s4, 3
  s_cbranch_scc1 Ls_18
  s_mov_b32 exec_lo, 0xffff
  buffer_store_dword v27, v24, s[40:43], s5 offen sc0 sc1
Ls_18:
  s_mov_b64 exec, -1
  s_mov_b32 s4, 0xffff0000
  v_lshlrev_b32 v128, 16, v240
  v_and_b32 v129, s4, v240
  v_lshlrev_b32 v130, 16, v241
  v_and_b32 v131, s4, v241
  v_lshlrev_b32 v132, 16, v242
  v_and_b32 v133, s4, v242
  v_lshlrev_b32 v134, 16, v243
  v_and_b32 v135, s4, v243
  v_lshlrev_b32 v136, 16, v244
  v_and_b32 v137, s4, v244
  v_lshlrev_b32 v138, 16, v245
  v_and_b32 v139, s4, v245
  v_lshlrev_b32 v140, 16, v246
  v_and_b32 v141, s4, v246
  v_lshlrev_b32 v142, 16, v247
  v_and_b32 v143, s4, v247
  v_lshlrev_b32 v144, 16, v248
  v_and_b32 v145, s4, v248
  v_lshlrev_b32 v146, 16, v249
  v_and_b32 v147, s4, v249
  v_lshlrev_b32 v148, 16, v250
  v_and_b32 v149, s4, v250
  v_lshlrev_b32 v150, 16, v251
  v_and_b32 v151, s4, v251
  v_lshlrev_b32 v152, 16, v252
  v_and_b32 v153, s4, v252
  v_lshlrev_b32 v154, 16, v253
  v_and_b32 v155, s4, v253
  v_lshlrev_b32 v156, 16, v254
  v_and_b32 v157, s4, v254
  v_lshlrev_b32 v158, 16, v255
  v_and_b32_e64 v159, s4, v255
  s_mov_b32 s22, 5
  s_barrier
  ds_read_b128 v[32:35], v4 offset:0
  ds_read_b128 v[36:39], v4 offset:2048
  ds_read_b128 v[40:43], v4 offset:4096
  ds_read_b128 v[44:47], v4 offset:6144
  ds_read_b128 v[64:67], v5 offset:0
  ds_read_b128 v[68:71], v5 offset:2048
  ds_read_b128 v[72:75], v5 offset:4096
  ds_read_b128 v[76:79], v5 offset:6144
  s_add_u32 s16, s16, s17
  s_cmp_eq_u32 s16, 65536
  s_cselect_b32 s23, s18, s17
  s_cselect_b32 s16, 0, s16
  v_add_u32 v4, s23, v4
  v_add_u32 v5, s23, v5
  s_waitcnt lgkmcnt(0)
  v_mfma_f32_16x16x32_bf16 v[128:131], v[48:51], v[32:35], v[128:131]
  v_mfma_f32_16x16x32_bf16 v[128:131], v[80:83], v[64:67], v[128:131]
  v_mfma_f32_16x16x32_bf16 v[136:139], v[80:83], v[68:71], v[136:139]
  v_mfma_f32_16x16x32_bf16 v[136:139], v[48:51], v[36:39], v[136:139]
  v_mfma_f32_16x16x32_bf16 v[144:147], v[48:51], v[40:43], v[144:147]
  v_mfma_f32_16x16x32_bf16 v[144:147], v[80:83], v[72:75], v[144:147]
  v_mfma_f32_16x16x32_bf16 v[152:155], v[80:83], v[76:79], v[152:155]
  v_mfma_f32_16x16x32_bf16 v[152:155], v[48:51], v[44:47], v[152:155]
  v_mfma_f32_16x16x32_bf16 v[156:159], v[52:55], v[44:47], v[156:159]
  v_mfma_f32_16x16x32_bf16 v[156:159], v[84:87], v[76:79], v[156:159]
  v_mfma_f32_16x16x32_bf16 v[148:151], v[84:87], v[72:75], v[148:151]
  v_mfma_f32_16x16x32_bf16 v[148:151], v[52:55], v[40:43], v[148:151]
  v_mfma_f32_16x16x32_bf16 v[140:143], v[52:55], v[36:39], v[140:143]
  v_mfma_f32_16x16x32_bf16 v[140:143], v[84:87], v[68:71], v[140:143]
  v_mfma_f32_16x16x32_bf16 v[132:135], v[84:87], v[64:67], v[132:135]
  v_mfma_f32_16x16x32_bf16 v[132:135], v[52:55], v[32:35], v[132:135]
  s_nop 0
  s_barrier
  ds_read_b128 v[96:99], v4 offset:0
  ds_read_b128 v[192:195], v5 offset:0
  ds_read_b128 v[100:103], v4 offset:2048
  ds_read_b128 v[196:199], v5 offset:2048
  ds_read_b128 v[104:107], v4 offset:4096
  ds_read_b128 v[200:203], v5 offset:4096
  ds_read_b128 v[108:111], v4 offset:6144
  ds_read_b128 v[204:207], v5 offset:6144
  s_add_u32 s16, s16, s17
  s_cmp_eq_u32 s16, 65536
  s_cselect_b32 s23, s18, s17
  s_cselect_b32 s16, 0, s16
  v_add_u32 v4, s23, v4
  v_add_u32 v5, s23, v5
  s_waitcnt lgkmcnt(6)
  v_mfma_f32_16x16x32_bf16 v[128:131], v[112:115], v[96:99], v[128:131]
  v_mfma_f32_16x16x32_bf16 v[128:131], v[208:211], v[192:195], v[128:131]
  s_waitcnt lgkmcnt(4)
  v_mfma_f32_16x16x32_bf16 v[136:139], v[208:211], v[196:199], v[136:139]
  v_mfma_f32_16x16x32_bf16 v[136:139], v[112:115], v[100:103], v[136:139]
  s_waitcnt lgkmcnt(2)
  v_mfma_f32_16x16x32_bf16 v[144:147], v[112:115], v[104:107], v[144:147]
  v_mfma_f32_16x16x32_bf16 v[144:147], v[208:211], v[200:203], v[144:147]
  s_waitcnt lgkmcnt(0)
  v_mfma_f32_16x16x32_bf16 v[152:155], v[208:211], v[204:207], v[152:155]
  s_barrier
  v_mfma_f32_16x16x32_bf16 v[152:155], v[112:115], v[108:111], v[152:155]
  ds_read_b128 v[32:35], v4 offset:0
  ds_read_b128 v[36:39], v4 offset:2048
  v_mfma_f32_16x16x32_bf16 v[156:159], v[116:119], v[108:111], v[156:159]
  ds_read_b128 v[40:43], v4 offset:4096
  ds_read_b128 v[44:47], v4 offset:6144
  v_mfma_f32_16x16x32_bf16 v[156:159], v[212:215], v[204:207], v[156:159]
  ds_read_b128 v[64:67], v5 offset:0
  ds_read_b128 v[68:71], v5 offset:2048
  v_mfma_f32_16x16x32_bf16 v[148:151], v[212:215], v[200:203], v[148:151]
  ds_read_b128 v[72:75], v5 offset:4096
  ds_read_b128 v[76:79], v5 offset:6144
  v_mfma_f32_16x16x32_bf16 v[148:151], v[116:119], v[104:107], v[148:151]
  s_add_u32 s16, s16, s17
  s_cmp_eq_u32 s16, 65536
  s_cselect_b32 s23, s18, s17
  v_mfma_f32_16x16x32_bf16 v[140:143], v[116:119], v[100:103], v[140:143]
  s_cselect_b32 s16, 0, s16
  v_add_u32 v4, s23, v4
  v_add_u32_e64 v5, s23, v5
  v_mfma_f32_16x16x32_bf16 v[140:143], v[212:215], v[196:199], v[140:143]
  v_mfma_f32_16x16x32_bf16 v[132:135], v[212:215], v[192:195], v[132:135]
  s_waitcnt lgkmcnt(0)
  v_mfma_f32_16x16x32_bf16 v[132:135], v[116:119], v[96:99], v[132:135]
  s_barrier
  v_mfma_f32_16x16x32_bf16 v[128:131], v[160:163], v[32:35], v[128:131]
  ds_read_b128 v[96:99], v4 offset:0
  ds_read_b128 v[100:103], v4 offset:2048
  v_mfma_f32_16x16x32_bf16 v[128:131], v[168:171], v[64:67], v[128:131]
  ds_read_b128 v[104:107], v4 offset:4096
  ds_read_b128 v[108:111], v4 offset:6144
  v_mfma_f32_16x16x32_bf16 v[136:139], v[168:171], v[68:71], v[136:139]
  ds_read_b128 v[192:195], v5 offset:0
  ds_read_b128 v[196:199], v5 offset:2048
  v_mfma_f32_16x16x32_bf16 v[136:139], v[160:163], v[36:39], v[136:139]
  ds_read_b128 v[200:203], v5 offset:4096
  ds_read_b128 v[204:207], v5 offset:6144
  v_mfma_f32_16x16x32_bf16 v[144:147], v[160:163], v[40:43], v[144:147]
  s_add_u32 s16, s16, s17
  s_cmp_eq_u32 s16, 65536
  s_cselect_b32 s23, s18, s17
  v_mfma_f32_16x16x32_bf16 v[144:147], v[168:171], v[72:75], v[144:147]
  s_cselect_b32 s16, 0, s16
  v_add_u32 v4, s23, v4
  v_add_u32_e64 v5, s23, v5
  v_mfma_f32_16x16x32_bf16 v[152:155], v[168:171], v[76:79], v[152:155]
  v_mfma_f32_16x16x32_bf16 v[152:155], v[160:163], v[44:47], v[152:155]
  v_mfma_f32_16x16x32_bf16 v[156:159], v[164:167], v[44:47], v[156:159]
  v_mfma_f32_16x16x32_bf16 v[156:159], v[172:175], v[76:79], v[156:159]
  v_mfma_f32_16x16x32_bf16 v[148:151], v[172:175], v[72:75], v[148:151]
  v_mfma_f32_16x16x32_bf16 v[148:151], v[164:167], v[40:43], v[148:151]
  v_mfma_f32_16x16x32_bf16 v[140:143], v[164:167], v[36:39], v[140:143]
  v_mfma_f32_16x16x32_bf16 v[140:143], v[172:175], v[68:71], v[140:143]
  v_mfma_f32_16x16x32_bf16 v[132:135], v[172:175], v[64:67], v[132:135]
  s_waitcnt lgkmcnt(0)
  v_mfma_f32_16x16x32_bf16 v[132:135], v[164:167], v[32:35], v[132:135]
  s_barrier
  v_mfma_f32_16x16x32_bf16 v[128:131], v[176:179], v[96:99], v[128:131]
  ds_read_b128 v[32:35], v4 offset:0
  ds_read_b128 v[36:39], v4 offset:2048
  v_mfma_f32_16x16x32_bf16 v[128:131], v[184:187], v[192:195], v[128:131]
  ds_read_b128 v[40:43], v4 offset:4096
  ds_read_b128 v[44:47], v4 offset:6144
  v_mfma_f32_16x16x32_bf16 v[136:139], v[184:187], v[196:199], v[136:139]
  ds_read_b128 v[64:67], v5 offset:0
  ds_read_b128 v[68:71], v5 offset:2048
  v_mfma_f32_16x16x32_bf16 v[136:139], v[176:179], v[100:103], v[136:139]
  ds_read_b128 v[72:75], v5 offset:4096
  ds_read_b128 v[76:79], v5 offset:6144
  v_mfma_f32_16x16x32_bf16 v[144:147], v[176:179], v[104:107], v[144:147]
  s_add_u32 s16, s16, s17
  s_cmp_eq_u32 s16, 65536
  s_cselect_b32 s23, s18, s17
  v_mfma_f32_16x16x32_bf16 v[144:147], v[184:187], v[200:203], v[144:147]
  s_cselect_b32 s16, 0, s16
  v_add_u32 v4, s23, v4
  v_add_u32_e64 v5, s23, v5
  v_mfma_f32_16x16x32_bf16 v[152:155], v[184:187], v[204:207], v[152:155]
  v_mfma_f32_16x16x32_bf16 v[152:155], v[176:179], v[108:111], v[152:155]
  v_mfma_f32_16x16x32_bf16 v[156:159], v[180:183], v[108:111], v[156:159]
  v_mfma_f32_16x16x32_bf16 v[156:159], v[188:191], v[204:207], v[156:159]
  v_mfma_f32_16x16x32_bf16 v[148:151], v[188:191], v[200:203], v[148:151]
  v_mfma_f32_16x16x32_bf16 v[148:151], v[180:183], v[104:107], v[148:151]
  v_mfma_f32_16x16x32_bf16 v[140:143], v[180:183], v[100:103], v[140:143]
  v_mfma_f32_16x16x32_bf16 v[140:143], v[188:191], v[196:199], v[140:143]
  v_mfma_f32_16x16x32_bf16 v[132:135], v[188:191], v[192:195], v[132:135]
  s_waitcnt lgkmcnt(0)
  v_mfma_f32_16x16x32_bf16 v[132:135], v[180:183], v[96:99], v[132:135]
  s_barrier
  v_mfma_f32_16x16x32_bf16 v[128:131], v[224:227], v[32:35], v[128:131]
  ds_read_b128 v[96:99], v4 offset:0
  ds_read_b128 v[100:103], v4 offset:2048
  v_mfma_f32_16x16x32_bf16 v[128:131], v[232:235], v[64:67], v[128:131]
  ds_read_b128 v[104:107], v4 offset:4096
  ds_read_b128 v[108:111], v4 offset:6144
  v_mfma_f32_16x16x32_bf16 v[136:139], v[232:235], v[68:71], v[136:139]
  ds_read_b128 v[192:195], v5 offset:0
  ds_read_b128 v[196:199], v5 offset:2048
  v_mfma_f32_16x16x32_bf16 v[136:139], v[224:227], v[36:39], v[136:139]
  ds_read_b128 v[200:203], v5 offset:4096
  ds_read_b128 v[204:207], v5 offset:6144
  v_mfma_f32_16x16x32_bf16 v[144:147], v[224:227], v[40:43], v[144:147]
  s_add_u32 s16, s16, s17
  s_cmp_eq_u32 s16, 65536
  s_cselect_b32 s23, s18, s17
  v_mfma_f32_16x16x32_bf16 v[144:147], v[232:235], v[72:75], v[144:147]
  s_cselect_b32 s16, 0, s16
  v_add_u32 v4, s23, v4
  v_add_u32_e64 v5, s23, v5
  v_mfma_f32_16x16x32_bf16 v[152:155], v[232:235], v[76:79], v[152:155]
  v_mfma_f32_16x16x32_bf16 v[152:155], v[224:227], v[44:47], v[152:155]
  v_mfma_f32_16x16x32_bf16 v[156:159], v[228:231], v[44:47], v[156:159]
  v_mfma_f32_16x16x32_bf16 v[156:159], v[236:239], v[76:79], v[156:159]
  v_mfma_f32_16x16x32_bf16 v[148:151], v[236:239], v[72:75], v[148:151]
  v_mfma_f32_16x16x32_bf16 v[148:151], v[228:231], v[40:43], v[148:151]
  v_mfma_f32_16x16x32_bf16 v[140:143], v[228:231], v[36:39], v[140:143]
  v_mfma_f32_16x16x32_bf16 v[140:143], v[236:239], v[68:71], v[140:143]
  v_mfma_f32_16x16x32_bf16 v[132:135], v[236:239], v[64:67], v[132:135]
  s_waitcnt lgkmcnt(0)
  v_mfma_f32_16x16x32_bf16 v[132:135], v[228:231], v[32:35], v[132:135]
  s_barrier
  v_mfma_f32_16x16x32_bf16 v[128:131], v[56:59], v[96:99], v[128:131]
  ds_read_b64_tr_b16 v[48:49], v6 offset:0
  ds_read_b64_tr_b16 v[50:51], v6 offset:2048
  v_mfma_f32_16x16x32_bf16 v[128:131], v[88:91], v[192:195], v[128:131]
  ds_read_b128 v[32:35], v4 offset:0
  ds_read_b128 v[36:39], v4 offset:2048
  v_mfma_f32_16x16x32_bf16 v[136:139], v[88:91], v[196:199], v[136:139]
  ds_read_b128 v[40:43], v4 offset:4096
  ds_read_b128 v[44:47], v4 offset:6144
  v_mfma_f32_16x16x32_bf16 v[136:139], v[56:59], v[100:103], v[136:139]
  ds_read_b64_tr_b16 v[52:53], v7 offset:0
  ds_read_b64_tr_b16 v[54:55], v7 offset:2048
  v_mfma_f32_16x16x32_bf16 v[144:147], v[56:59], v[104:107], v[144:147]
  ds_read_b64_tr_b16 v[80:81], v6 offset:4096
  ds_read_b64_tr_b16 v[82:83], v6 offset:6144
  v_mfma_f32_16x16x32_bf16 v[144:147], v[88:91], v[200:203], v[144:147]
  ds_read_b128 v[64:67], v5 offset:0
  ds_read_b128 v[68:71], v5 offset:2048
  v_mfma_f32_16x16x32_bf16 v[152:155], v[88:91], v[204:207], v[152:155]
  ds_read_b128 v[72:75], v5 offset:4096
  ds_read_b128 v[76:79], v5 offset:6144
  v_mfma_f32_16x16x32_bf16 v[152:155], v[56:59], v[108:111], v[152:155]
  ds_read_b64_tr_b16 v[84:85], v7 offset:4096
  ds_read_b64_tr_b16 v[86:87], v7 offset:6144
  v_mfma_f32_16x16x32_bf16 v[156:159], v[60:63], v[108:111], v[156:159]
  s_add_u32 s16, s16, s17
  s_cmp_eq_u32 s16, 65536
  s_cselect_b32 s23, s18, s17
  v_mfma_f32_16x16x32_bf16 v[156:159], v[92:95], v[204:207], v[156:159]
  s_cselect_b32 s16, 0, s16
  v_add_u32 v4, s23, v4
  v_add_u32_e64 v5, s23, v5
  v_mfma_f32_16x16x32_bf16 v[148:151], v[92:95], v[200:203], v[148:151]
  s_add_u32 s19, s19, s20
  s_cmp_eq_u32 s19, 81920
  s_cselect_b32 s23, s21, s20
  v_mfma_f32_16x16x32_bf16 v[148:151], v[60:63], v[104:107], v[148:151]
  s_cselect_b32 s19, 0, s19
  v_add_u32 v6, s23, v6
  v_add_u32_e64 v7, s23, v7
  v_mfma_f32_16x16x32_bf16 v[140:143], v[60:63], v[100:103], v[140:143]
  v_mfma_f32_16x16x32_bf16 v[140:143], v[92:95], v[196:199], v[140:143]
  v_mfma_f32_16x16x32_bf16 v[132:135], v[92:95], v[192:195], v[132:135]
  s_waitcnt lgkmcnt(0)
  v_mfma_f32_16x16x32_bf16 v[132:135], v[60:63], v[96:99], v[132:135]
Lk_19:
  s_barrier
  v_mfma_f32_16x16x32_bf16 v[128:131], v[48:51], v[32:35], v[128:131]
  ds_read_b64_tr_b16 v[112:113], v6 offset:0
  ds_read_b64_tr_b16 v[114:115], v6 offset:2048
  v_mfma_f32_16x16x32_bf16 v[128:131], v[80:83], v[64:67], v[128:131]
  ds_read_b128 v[96:99], v4 offset:0
  ds_read_b128 v[100:103], v4 offset:2048
  v_mfma_f32_16x16x32_bf16 v[136:139], v[80:83], v[68:71], v[136:139]
  ds_read_b128 v[104:107], v4 offset:4096
  ds_read_b128 v[108:111], v4 offset:6144
  v_mfma_f32_16x16x32_bf16 v[136:139], v[48:51], v[36:39], v[136:139]
  ds_read_b64_tr_b16 v[116:117], v7 offset:0
  ds_read_b64_tr_b16 v[118:119], v7 offset:2048
  v_mfma_f32_16x16x32_bf16 v[144:147], v[48:51], v[40:43], v[144:147]
  ds_read_b64_tr_b16 v[208:209], v6 offset:4096
  ds_read_b64_tr_b16 v[210:211], v6 offset:6144
  v_mfma_f32_16x16x32_bf16 v[144:147], v[80:83], v[72:75], v[144:147]
  ds_read_b128 v[192:195], v5 offset:0
  ds_read_b128 v[196:199], v5 offset:2048
  v_mfma_f32_16x16x32_bf16 v[152:155], v[80:83], v[76:79], v[152:155]
  ds_read_b128 v[200:203], v5 offset:4096
  ds_read_b128 v[204:207], v5 offset:6144
  v_mfma_f32_16x16x32_bf16 v[152:155], v[48:51], v[44:47], v[152:155]
  ds_read_b64_tr_b16 v[212:213], v7 offset:4096
  ds_read_b64_tr_b16 v[214:215], v7 offset:6144
  v_mfma_f32_16x16x32_bf16 v[156:159], v[52:55], v[44:47], v[156:159]
  s_add_u32 s16, s16, s17
  s_cmp_eq_u32 s16, 65536
  s_cselect_b32 s23, s18, s17
  v_mfma_f32_16x16x32_bf16 v[156:159], v[84:87], v[76:79], v[156:159]
  s_cselect_b32 s16, 0, s16
  v_add_u32 v4, s23, v4
  v_add_u32_e64 v5, s23, v5
  v_mfma_f32_16x16x32_bf16 v[148:151], v[84:87], v[72:75], v[148:151]
  s_add_u32 s19, s19, s20
  s_cmp_eq_u32 s19, 81920
  s_cselect_b32 s23, s21, s20
  v_mfma_f32_16x16x32_bf16 v[148:151], v[52:55], v[40:43], v[148:151]
  s_cselect_b32 s19, 0, s19
  v_add_u32 v6, s23, v6
  v_add_u32_e64 v7, s23, v7
  v_mfma_f32_16x16x32_bf16 v[140:143], v[52:55], v[36:39], v[140:143]
  v_mfma_f32_16x16x32_bf16 v[140:143], v[84:87], v[68:71], v[140:143]
  v_mfma_f32_16x16x32_bf16 v[132:135], v[84:87], v[64:67], v[132:135]
  s_waitcnt lgkmcnt(0)
  v_mfma_f32_16x16x32_bf16 v[132:135], v[52:55], v[32:35], v[132:135]
  s_barrier
  v_mfma_f32_16x16x32_bf16 v[128:131], v[112:115], v[96:99], v[128:131]
  ds_read_b64_tr_b16 v[48:49], v6 offset:0
  ds_read_b64_tr_b16 v[50:51], v6 offset:2048
  v_mfma_f32_16x16x32_bf16 v[128:131], v[208:211], v[192:195], v[128:131]
  ds_read_b128 v[32:35], v4 offset:0
  ds_read_b128 v[36:39], v4 offset:2048
  v_mfma_f32_16x16x32_bf16 v[136:139], v[208:211], v[196:199], v[136:139]
  ds_read_b128 v[40:43], v4 offset:4096
  ds_read_b128 v[44:47], v4 offset:6144
  v_mfma_f32_16x16x32_bf16 v[136:139], v[112:115], v[100:103], v[136:139]
  ds_read_b64_tr_b16 v[52:53], v7 offset:0
  ds_read_b64_tr_b16 v[54:55], v7 offset:2048
  v_mfma_f32_16x16x32_bf16 v[144:147], v[112:115], v[104:107], v[144:147]
  ds_read_b64_tr_b16 v[80:81], v6 offset:4096
  ds_read_b64_tr_b16 v[82:83], v6 offset:6144
  v_mfma_f32_16x16x32_bf16 v[144:147], v[208:211], v[200:203], v[144:147]
  ds_read_b128 v[64:67], v5 offset:0
  ds_read_b128 v[68:71], v5 offset:2048
  v_mfma_f32_16x16x32_bf16 v[152:155], v[208:211], v[204:207], v[152:155]
  ds_read_b128 v[72:75], v5 offset:4096
  ds_read_b128 v[76:79], v5 offset:6144
  v_mfma_f32_16x16x32_bf16 v[152:155], v[112:115], v[108:111], v[152:155]
  ds_read_b64_tr_b16 v[84:85], v7 offset:4096
  ds_read_b64_tr_b16 v[86:87], v7 offset:6144
  v_mfma_f32_16x16x32_bf16 v[156:159], v[116:119], v[108:111], v[156:159]
  s_add_u32 s16, s16, s17
  s_cmp_eq_u32 s16, 65536
  s_cselect_b32 s23, s18, s17
  v_mfma_f32_16x16x32_bf16 v[156:159], v[212:215], v[204:207], v[156:159]
  s_cselect_b32 s16, 0, s16
  v_add_u32 v4, s23, v4
  v_add_u32_e64 v5, s23, v5
  v_mfma_f32_16x16x32_bf16 v[148:151], v[212:215], v[200:203], v[148:151]
  s_add_u32 s19, s19, s20
  s_cmp_eq_u32 s19, 81920
  s_cselect_b32 s23, s21, s20
  v_mfma_f32_16x16x32_bf16 v[148:151], v[116:119], v[104:107], v[148:151]
  s_cselect_b32 s19, 0, s19
  v_add_u32 v6, s23, v6
  v_add_u32_e64 v7, s23, v7
  v_mfma_f32_16x16x32_bf16 v[140:143], v[116:119], v[100:103], v[140:143]
  s_sub_u32 s22, s22, 1
  s_cmp_lg_u32 s22, 0
  v_mfma_f32_16x16x32_bf16 v[140:143], v[212:215], v[196:199], v[140:143]
  v_mfma_f32_16x16x32_bf16 v[132:135], v[212:215], v[192:195], v[132:135]
  s_nop 0
  s_waitcnt lgkmcnt(0)
  v_mfma_f32_16x16x32_bf16 v[132:135], v[116:119], v[96:99], v[132:135]
  s_cbranch_scc1 Lk_19
  s_waitcnt lgkmcnt(0)
  v_cvt_pk_bf16_f32 v240, v128, v129
  v_cvt_pk_bf16_f32 v241, v130, v131
  s_nop 0
  s_nop 3
  v_cvt_pk_bf16_f32 v242, v132, v133
  v_cvt_pk_bf16_f32 v243, v134, v135
  v_cvt_pk_bf16_f32 v244, v136, v137
  v_cvt_pk_bf16_f32 v245, v138, v139
  v_cvt_pk_bf16_f32 v246, v140, v141
  v_cvt_pk_bf16_f32 v247, v142, v143
  v_cvt_pk_bf16_f32 v248, v144, v145
  v_cvt_pk_bf16_f32 v249, v146, v147
  v_cvt_pk_bf16_f32 v250, v148, v149
  v_cvt_pk_bf16_f32 v251, v150, v151
  v_cvt_pk_bf16_f32 v252, v152, v153
  v_cvt_pk_bf16_f32 v253, v154, v155
  v_cvt_pk_bf16_f32 v254, v156, v157
  v_cvt_pk_bf16_f32 v255, v158, v159
  s_lshl_b32 s4, s76, 4
  s_add_u32 s4, s4, s78
  s_lshl_b32 s6, s4, Lz1-Lz0+14
  s_add_u32 s6, s6, 7340032
  s_add_u32 s7, s6, 4096
  s_lshl_b32 s5, s78, Lz1-Lz0+1
  buffer_store_dwordx4 v[240:243], v0, s[40:43], s6 offen offset:0 sc0 sc1
  buffer_store_dwordx4 v[244:247], v0, s[40:43], s6 offen offset:2048 sc0 sc1
  buffer_store_dwordx4 v[248:251], v0, s[40:43], s7 offen offset:0 sc0 sc1
  buffer_store_dwordx4 v[252:255], v0, s[40:43], s7 offen offset:2048 sc0 sc1
  v_mov_b32 v40, 0x3f803f80
  v_dot2_f32_bf16 v32, v240, v40, 0
  v_dot2_f32_bf16 v36, v240, v240, 0
  v_dot2_f32_bf16 v33, v244, v40, 0
  v_dot2_f32_bf16 v37, v244, v244, 0
  v_dot2_f32_bf16 v34, v248, v40, 0
  v_dot2_f32_bf16 v38, v248, v248, 0
  v_dot2_f32_bf16 v35, v252, v40, 0
  v_dot2_f32_bf16 v39, v252, v252, 0
  v_dot2_f32_bf16 v32, v241, v40, v32
  v_dot2_f32_bf16 v36, v241, v241, v36
  v_dot2_f32_bf16 v33, v245, v40, v33
  v_dot2_f32_bf16 v37, v245, v245, v37
  v_dot2_f32_bf16 v34, v249, v40, v34
  v_dot2_f32_bf16 v38, v249, v249, v38
  v_dot2_f32_bf16 v35, v253, v40, v35
  v_dot2_f32_bf16 v39, v253, v253, v39
  v_dot2_f32_bf16 v32, v242, v40, v32
  v_dot2_f32_bf16 v36, v242, v242, v36
  v_dot2_f32_bf16 v33, v246, v40, v33
  v_dot2_f32_bf16 v37, v246, v246, v37
  v_dot2_f32_bf16 v34, v250, v40, v34
  v_dot2_f32_bf16 v38, v250, v250, v38
  v_dot2_f32_bf16 v35, v254, v40, v35
  v_dot2_f32_bf16 v39, v254, v254, v39
  v_dot2_f32_bf16 v32, v243, v40, v32
  v_dot2_f32_bf16 v36, v243, v243, v36
  v_dot2_f32_bf16 v33, v247, v40, v33
  v_dot2_f32_bf16 v37, v247, v247, v37
  v_dot2_f32_bf16 v34, v251, v40, v34
  v_dot2_f32_bf16 v38, v251, v251, v38
  v_dot2_f32_bf16 v35, v255, v40, v35
  v_dot2_f32_bf16 v39, v255, v255, v39
  s_lshl_b32 s6, s76, Lz1-Lz0+9
  s_lshl_b32 s7, s85, 8
  s_add_u32 s6, s6, s7
  s_add_u32 s6, s6, s5
  s_add_u32 s6, s6, s86
  s_lshl_b32 s6, s6, 6
  s_add_u32 s6, s6, s83
  s_add_u32 s6, s6, 31457280
  v_permlane32_swap_b32 v32, v34
  v_permlane32_swap_b32 v33, v35
  v_permlane32_swap_b32 v36, v38
  v_permlane32_swap_b32 v37, v39
  v_add_f32 v32, v32, v34
  v_add_f32 v33, v33, v35
  v_add_f32 v36, v36, v38
  v_add_f32 v37, v37, v39
  v_permlane16_swap_b32 v32, v33
  s_nop 0
  v_permlane16_swap_b32 v36, v37
  v_add_f32 v42, v32, v33
  v_add_f32_e64 v43, v36, v37
  buffer_store_dwordx2 v[42:43], v30, s[40:43], s6 offen sc0 sc1
  ds_write_b128 v0, v[240:243] offset:0
  ds_write_b128 v0, v[244:247] offset:2048
  ds_write_b128 v0, v[248:251] offset:4096
  ds_write_b128 v0, v[252:255] offset:6144
  s_add_u32 s5, s87, 4
  s_sub_u32 s4, s78, s77
  s_lshl_b32 s4, s4, 7
  s_add_u32 s5, s5, s4
  s_waitcnt vmcnt(0)
  s_mov_b64 exec, 1
  ds_add_rtn_u32 v2, v28, v27 offset:0
  s_waitcnt lgkmcnt(0)
  v_readfirstlane_b32 s4, v2
  s_and_b32 s4, s4, Lz1-Lz0+3
  s_cmp_lg_u32 s4, 3
  s_cbranch_scc1 Ls_20
  s_mov_b32 exec_lo, 0xffff
  buffer_store_dword v27, v24, s[40:43], s5 offen sc0 sc1
Ls_20:
  s_mov_b64 exec, -1
  s_mov_b32 s16, 0
  s_mov_b32 s17, 16384
  s_mov_b32 s18, 0xffff4000
  s_mov_b32 s19, Lz1-Lz0+0
  s_mov_b32 s20, 28672
  s_mov_b32 s21, 0xffff2000
  s_mul_i32 s4, s85, 8192
  v_add_u32_e64 v4, s4, v11
  v_add_u32 v5, 1024, v4
  s_mul_i32 s4, s86, 6
  s_add_u32 s4, s4, 0
  s_lshr_b32 s5, s4, 2
  s_lshl_b32 s5, s5, 13
  s_and_b32 s4, s4, 3
  v_xor_b32 v2, s4, v26
  v_lshl_add_u32 v6, v2, 5, v25
  v_add_u32 v6, s5, v6
  s_mul_i32 s4, s86, 6
  s_add_u32 s4, s4, 1
  s_lshr_b32 s5, s4, 2
  s_lshl_b32 s5, s5, 13
  s_and_b32 s4, s4, 3
  v_xor_b32_e64 v2, s4, v26
  v_lshl_add_u32 v7, v2, 5, v25
  v_add_u32 v7, s5, v7
  s_mul_i32 s4, s86, 6
  s_add_u32 s4, s4, 2
  s_lshr_b32 s5, s4, 2
  s_lshl_b32 s5, s5, 13
  s_and_b32 s4, s4, 3
  v_xor_b32_e64 v2, s4, v26
  v_lshl_add_u32 v8, v2, 5, v25
  v_add_u32 v8, s5, v8
  s_mul_i32 s4, s86, 6
  s_add_u32 s4, s4, 3
  s_lshr_b32 s5, s4, 2
  s_lshl_b32 s5, s5, 13
  s_and_b32 s4, s4, 3
  v_xor_b32_e64 v2, s4, v26
  v_lshl_add_u32 v9, v2, 5, v25
  v_add_u32 v9, s5, v9
  v_lshrrev_b32 v2, 2, v1
  v_lshlrev_b32 v3, 6, v2
  v_and_b32 v2, 3, v1
  v_lshl_add_u32 v3, v2, 3, v3
  v_bfe_u32 v2, v1, 4, 1
  v_xor_b32_e64 v2, s86, v2
  v_lshl_add_u32 v3, v2, 5, v3
  v_add_u32 v10, 90112, v3
  v_mov_b64 v[128:129], 0
  v_mov_b64 v[130:131], 0
  v_mov_b64 v[132:133], 0
  v_mov_b64 v[134:135], 0
  v_mov_b64 v[136:137], 0
  v_mov_b64 v[138:139], 0
  v_mov_b64 v[140:141], 0
  v_mov_b64 v[142:143], 0
  v_mov_b64 v[144:145], 0
  v_mov_b64 v[146:147], 0
  v_mov_b64 v[148:149], 0
  v_mov_b64 v[150:151], 0
  v_mov_b64 v[152:153], 0
  v_mov_b64 v[154:155], 0
  v_mov_b64 v[156:157], 0
  v_mov_b64 v[158:159], 0
  v_mov_b64 v[160:161], 0
  v_mov_b64 v[162:163], 0
  v_mov_b64 v[164:165], 0
  v_mov_b64 v[166:167], 0
  v_mov_b64 v[168:169], 0
  v_mov_b64 v[170:171], 0
  v_mov_b64 v[172:173], 0
  v_mov_b64 v[174:175], 0
  v_mov_b64 v[176:177], 0
  v_mov_b64 v[178:179], 0
  v_mov_b64 v[180:181], 0
  v_mov_b64 v[182:183], 0
  v_mov_b64 v[184:185], 0
  v_mov_b64 v[186:187], 0
  v_mov_b64 v[188:189], 0
  v_mov_b64 v[190:191], 0
  v_mov_b64 v[192:193], 0
  v_mov_b64 v[194:195], 0
  v_mov_b64 v[196:197], 0
  v_mov_b64 v[198:199], 0
  v_mov_b64 v[200:201], 0
  v_mov_b64 v[202:203], 0
  v_mov_b64 v[204:205], 0
  v_mov_b64 v[206:207], 0
  v_mov_b64 v[208:209], 0
  v_mov_b64 v[210:211], 0
  v_mov_b64 v[212:213], 0
  v_mov_b64 v[214:215], 0
  v_mov_b64 v[216:217], 0
  v_mov_b64 v[218:219], 0
  v_mov_b64 v[220:221], 0
  v_mov_b64 v[222:223], 0
  v_mov_b64 v[224:225], 0
  v_mov_b64 v[226:227], 0
  v_mov_b64 v[228:229], 0
  v_mov_b64 v[230:231], 0
  v_mov_b64 v[232:233], 0
  v_mov_b64 v[234:235], 0
  v_mov_b64 v[236:237], 0
  v_mov_b64 v[238:239], 0
  s_mul_i32 s5, s86, 384
  s_add_u32 s5, s5, 154112
  v_add_u32 v3, s5, v29
  s_mul_i32 s4, s76, 56
  s_mul_i32 s5, s79, 28
  s_add_u32 s4, s4, s5
  s_add_u32 s6, s4, s80
  s_lshl_b32 s6, s6, 14
  s_add_u32 s6, s6, 11599872
  s_add_u32 s7, s6, 4096
  s_lshr_b32 s5, s80, 1
  s_add_u32 s4, s4, s5
  s_lshl_b32 s4, s4, 1
  s_add_u32 s4, s4, s85
  s_lshl_b32 s4, s4, 3
  s_and_b32 s5, s80, 1
  s_add_u32 s4, s4, s5
  s_lshl_b32 s4, s4, 1
  s_add_u32 s4, s4, s86
  s_lshl_b32 s8, s4, 9
  s_add_u32 s8, s8, 11534336
  s_lshl_b32 s4, s79, Lz1-Lz0+3
  s_lshl_b32 s10, 0xff, s4
  s_mov_b32 s22, 8
  s_mov_b64 vcc, -1
  s_waitcnt lgkmcnt(0)
  s_barrier
  s_branch Lo_24
Lo_25:
  s_mov_b64 vcc, 0
  s_waitcnt lgkmcnt(0)
  s_barrier
  ds_read_b128 v[64:67], v4 offset:0
  ds_read_b128 v[80:83], v5 offset:0
  ds_read_b128 v[68:71], v4 offset:2048
  ds_read_b128 v[84:87], v5 offset:2048
  ds_read_b128 v[72:75], v4 offset:4096
  ds_read_b128 v[88:91], v5 offset:4096
  ds_read_b64_tr_b16 v[96:97], v6 offset:0
  ds_read_b64_tr_b16 v[98:99], v6 offset:2048
  ds_read_b64_tr_b16 v[100:101], v6 offset:4096
  ds_read_b64_tr_b16 v[102:103], v6 offset:6144
  ds_read_b128 v[76:79], v4 offset:6144
  ds_read_b128 v[92:95], v5 offset:6144
  ds_read_b64_tr_b16 v[104:105], v7 offset:0
  s_nop 0
  s_waitcnt lgkmcnt(8)
  ds_read_b64_tr_b16 v[106:107], v7 offset:2048
  ds_read_b64_tr_b16 v[108:109], v7 offset:4096
  ds_read_b64_tr_b16 v[110:111], v7 offset:6144
  s_waitcnt lgkmcnt(6)
  s_branch Lk_22
Lo_24:
  ds_read_b128 v[32:35], v4 offset:0
  ds_read_b128 v[48:51], v5 offset:0
  ds_read_b128 v[36:39], v4 offset:2048
  ds_read_b128 v[52:55], v5 offset:2048
  ds_read_b128 v[40:43], v4 offset:4096
  ds_read_b128 v[56:59], v5 offset:4096
  ds_read_b64_tr_b16 v[96:97], v6 offset:0
  ds_read_b64_tr_b16 v[98:99], v6 offset:2048
  ds_read_b64_tr_b16 v[100:101], v6 offset:4096
  ds_read_b64_tr_b16 v[102:103], v6 offset:6144
  ds_read_b128 v[44:47], v4 offset:6144
  ds_read_b128 v[60:63], v5 offset:6144
  ds_read_b64_tr_b16 v[104:105], v7 offset:0
  s_nop 0
  s_waitcnt lgkmcnt(8)
  ds_read_b64_tr_b16 v[106:107], v7 offset:2048
  ds_read_b64_tr_b16 v[108:109], v7 offset:4096
  ds_read_b64_tr_b16 v[110:111], v7 offset:6144
  s_nop 0
  s_waitcnt lgkmcnt(6)
  .p2align 6
Lk_21:
  v_mfma_f32_16x16x32_bf16 v[128:131], v[96:99], v[32:35], v[128:131]
  ds_read_b64_tr_b16 v[112:113], v8 offset:0
  v_mfma_f32_16x16x32_bf16 v[128:131], v[100:103], v[48:51], v[128:131]
  ds_read_b64_tr_b16 v[114:115], v8 offset:2048
  v_mfma_f32_16x16x32_bf16 v[132:135], v[100:103], v[52:55], v[132:135]
  ds_read_b64_tr_b16 v[116:117], v8 offset:4096
  v_mfma_f32_16x16x32_bf16 v[132:135], v[96:99], v[36:39], v[132:135]
  ds_read_b64_tr_b16 v[118:119], v8 offset:6144
  v_mfma_f32_16x16x32_bf16 v[136:139], v[96:99], v[40:43], v[136:139]
  s_add_u32 s16, s16, s17
  s_cmp_eq_u32 s16, 65536
  s_cselect_b32 s23, s18, s17
  s_cselect_b32 s16, Lz1-Lz0+0, s16
  v_mfma_f32_16x16x32_bf16 v[136:139], v[100:103], v[56:59], v[136:139]
  v_add_u32_e64 v4, s23, v4
  v_add_u32 v5, s23, v5
  s_add_u32 s19, s19, s20
  s_cmp_eq_u32 s19, 86016
  s_waitcnt lgkmcnt(8)
  v_mfma_f32_16x16x32_bf16 v[140:143], v[100:103], v[60:63], v[140:143]
  s_cselect_b32 s23, s21, s20
  s_cselect_b32 s19, 0, s19
  v_mfma_f32_16x16x32_bf16 v[140:143], v[96:99], v[44:47], v[140:143]
  s_waitcnt lgkmcnt(4)
  v_mfma_f32_16x16x32_bf16 v[156:159], v[104:107], v[44:47], v[156:159]
  ds_read_b64_tr_b16 v[120:121], v9 offset:0
  v_mfma_f32_16x16x32_bf16 v[156:159], v[108:111], v[60:63], v[156:159]
  ds_read_b64_tr_b16 v[122:123], v9 offset:2048
  v_mfma_f32_16x16x32_bf16 v[152:155], v[108:111], v[56:59], v[152:155]
  ds_read_b64_tr_b16 v[124:125], v9 offset:4096
  v_mfma_f32_16x16x32_bf16 v[152:155], v[104:107], v[40:43], v[152:155]
  ds_read_b64_tr_b16 v[126:127], v9 offset:6144
  v_mfma_f32_16x16x32_bf16 v[148:151], v[104:107], v[36:39], v[148:151]
  v_mfma_f32_16x16x32_bf16 v[148:151], v[108:111], v[52:55], v[148:151]
  v_mfma_f32_16x16x32_bf16 v[144:147], v[108:111], v[48:51], v[144:147]
  ds_read_b64_tr_b16 v[96:97], v6 offset:8192
  v_mfma_f32_16x16x32_bf16 v[144:147], v[104:107], v[32:35], v[144:147]
  ds_read_b64_tr_b16 v[98:99], v6 offset:10240
  s_nop 0
  s_waitcnt lgkmcnt(6)
  v_mfma_f32_16x16x32_bf16 v[160:163], v[112:115], v[32:35], v[160:163]
  ds_read_b64_tr_b16 v[100:101], v6 offset:12288
  v_mfma_f32_16x16x32_bf16 v[160:163], v[116:119], v[48:51], v[160:163]
  ds_read_b64_tr_b16 v[102:103], v6 offset:14336
  v_mfma_f32_16x16x32_bf16 v[164:167], v[116:119], v[52:55], v[164:167]
  v_mfma_f32_16x16x32_bf16 v[164:167], v[112:115], v[36:39], v[164:167]
  v_mfma_f32_16x16x32_bf16 v[168:171], v[112:115], v[40:43], v[168:171]
  ds_read_b64_tr_b16 v[104:105], v7 offset:8192
  v_mfma_f32_16x16x32_bf16 v[168:171], v[116:119], v[56:59], v[168:171]
  ds_read_b64_tr_b16 v[106:107], v7 offset:10240
  v_mfma_f32_16x16x32_bf16 v[172:175], v[116:119], v[60:63], v[172:175]
  ds_read_b64_tr_b16 v[108:109], v7 offset:12288
  v_mfma_f32_16x16x32_bf16 v[172:175], v[112:115], v[44:47], v[172:175]
  ds_read_b64_tr_b16 v[110:111], v7 offset:14336
  s_waitcnt lgkmcnt(8)
  v_mfma_f32_16x16x32_bf16 v[188:191], v[120:123], v[44:47], v[188:191]
  v_add_u32 v6, s23, v6
  v_add_u32_e64 v7, s23, v7
  v_mfma_f32_16x16x32_bf16 v[188:191], v[124:127], v[60:63], v[188:191]
  ds_read_b64_tr_b16 v[112:113], v10 offset:0
  v_mfma_f32_16x16x32_bf16 v[184:187], v[124:127], v[56:59], v[184:187]
  ds_read_b64_tr_b16 v[114:115], v10 offset:1024
  v_mfma_f32_16x16x32_bf16 v[184:187], v[120:123], v[40:43], v[184:187]
  ds_read_b64_tr_b16 v[116:117], v10 offset:2048
  v_mfma_f32_16x16x32_bf16 v[180:183], v[120:123], v[36:39], v[180:183]
  ds_read_b64_tr_b16 v[118:119], v10 offset:3072
  v_mfma_f32_16x16x32_bf16 v[180:183], v[124:127], v[52:55], v[180:183]
  v_add_u32 v8, s23, v8
  v_add_u32 v9, s23, v9
  v_mfma_f32_16x16x32_bf16 v[176:179], v[124:127], v[48:51], v[176:179]
  v_add_u32 v10, s23, v10
  v_mfma_f32_16x16x32_bf16 v[176:179], v[120:123], v[32:35], v[176:179]
  s_waitcnt lgkmcnt(0)
  s_cbranch_vccnz Lo_26
  s_barrier
Lo_26:
  v_mfma_f32_16x16x32_bf16 v[192:195], v[96:99], v[32:35], v[192:195]
  ds_read_b128 v[64:67], v4 offset:0
  v_mfma_f32_16x16x32_bf16 v[192:195], v[100:103], v[48:51], v[192:195]
  ds_read_b128 v[80:83], v5 offset:0
  v_mfma_f32_16x16x32_bf16 v[196:199], v[100:103], v[52:55], v[196:199]
  v_mfma_f32_16x16x32_bf16 v[196:199], v[96:99], v[36:39], v[196:199]
  ds_read_b128 v[68:71], v4 offset:2048
  v_mfma_f32_16x16x32_bf16 v[200:203], v[96:99], v[40:43], v[200:203]
  ds_read_b128 v[84:87], v5 offset:2048
  v_mfma_f32_16x16x32_bf16 v[200:203], v[100:103], v[56:59], v[200:203]
  v_mfma_f32_16x16x32_bf16 v[204:207], v[100:103], v[60:63], v[204:207]
  ds_read_b128 v[72:75], v4 offset:4096
  v_mfma_f32_16x16x32_bf16 v[204:207], v[96:99], v[44:47], v[204:207]
  ds_read_b128 v[88:91], v5 offset:4096
  v_mfma_f32_16x16x32_bf16 v[220:223], v[104:107], v[44:47], v[220:223]
  ds_read_b64_tr_b16 v[96:97], v6 offset:0
  v_mfma_f32_16x16x32_bf16 v[220:223], v[108:111], v[60:63], v[220:223]
  ds_read_b64_tr_b16 v[98:99], v6 offset:2048
  v_mfma_f32_16x16x32_bf16 v[216:219], v[108:111], v[56:59], v[216:219]
  ds_read_b64_tr_b16 v[100:101], v6 offset:4096
  v_mfma_f32_16x16x32_bf16 v[216:219], v[104:107], v[40:43], v[216:219]
  ds_read_b64_tr_b16 v[102:103], v6 offset:6144
  v_mfma_f32_16x16x32_bf16 v[212:215], v[104:107], v[36:39], v[212:215]
  ds_read_b128 v[76:79], v4 offset:6144
  v_mfma_f32_16x16x32_bf16 v[212:215], v[108:111], v[52:55], v[212:215]
  v_mfma_f32_16x16x32_bf16 v[208:211], v[108:111], v[48:51], v[208:211]
  ds_read_b128 v[92:95], v5 offset:6144
  v_mfma_f32_16x16x32_bf16 v[208:211], v[104:107], v[32:35], v[208:211]
  v_mfma_f32_16x16x32_bf16 v[224:227], v[112:115], v[32:35], v[224:227]
  ds_read_b64_tr_b16 v[104:105], v7 offset:0
  v_mfma_f32_16x16x32_bf16 v[224:227], v[116:119], v[48:51], v[224:227]
  v_mfma_f32_16x16x32_bf16 v[228:231], v[116:119], v[52:55], v[228:231]
  ds_read_b64_tr_b16 v[106:107], v7 offset:2048
  v_mfma_f32_16x16x32_bf16 v[228:231], v[112:115], v[36:39], v[228:231]
  v_mfma_f32_16x16x32_bf16 v[232:235], v[112:115], v[40:43], v[232:235]
  ds_read_b64_tr_b16 v[108:109], v7 offset:4096
  v_mfma_f32_16x16x32_bf16 v[232:235], v[116:119], v[56:59], v[232:235]
  v_mfma_f32_16x16x32_bf16 v[236:239], v[116:119], v[60:63], v[236:239]
  ds_read_b64_tr_b16 v[110:111], v7 offset:6144
  s_waitcnt lgkmcnt(6)
  v_mfma_f32_16x16x32_bf16 v[236:239], v[112:115], v[44:47], v[236:239]
  s_cbranch_vccnz Lo_25
Lk_22:
  v_mfma_f32_16x16x32_bf16 v[128:131], v[96:99], v[64:67], v[128:131]
  ds_read_b64_tr_b16 v[112:113], v8 offset:0
  v_mfma_f32_16x16x32_bf16 v[128:131], v[100:103], v[80:83], v[128:131]
  ds_read_b64_tr_b16 v[114:115], v8 offset:2048
  v_mfma_f32_16x16x32_bf16 v[132:135], v[100:103], v[84:87], v[132:135]
  ds_read_b64_tr_b16 v[116:117], v8 offset:4096
  v_mfma_f32_16x16x32_bf16 v[132:135], v[96:99], v[68:71], v[132:135]
  ds_read_b64_tr_b16 v[118:119], v8 offset:6144
  v_mfma_f32_16x16x32_bf16 v[136:139], v[96:99], v[72:75], v[136:139]
  s_add_u32 s16, s16, s17
  s_cmp_eq_u32 s16, 65536
  s_cselect_b32 s23, s18, s17
  s_cselect_b32 s16, Lz1-Lz0+0, s16
  v_mfma_f32_16x16x32_bf16 v[136:139], v[100:103], v[88:91], v[136:139]
  v_add_u32_e64 v4, s23, v4
  v_add_u32 v5, s23, v5
  s_add_u32 s19, s19, s20
  s_cmp_eq_u32 s19, 86016
  s_waitcnt lgkmcnt(8)
  v_mfma_f32_16x16x32_bf16 v[140:143], v[100:103], v[92:95], v[140:143]
  s_cselect_b32 s23, s21, s20
  s_cselect_b32 s19, 0, s19
  v_mfma_f32_16x16x32_bf16 v[140:143], v[96:99], v[76:79], v[140:143]
  s_waitcnt lgkmcnt(4)
  v_mfma_f32_16x16x32_bf16 v[156:159], v[104:107], v[76:79], v[156:159]
  ds_read_b64_tr_b16 v[120:121], v9 offset:0
  v_mfma_f32_16x16x32_bf16 v[156:159], v[108:111], v[92:95], v[156:159]
  ds_read_b64_tr_b16 v[122:123], v9 offset:2048
  v_mfma_f32_16x16x32_bf16 v[152:155], v[108:111], v[88:91], v[152:155]
  ds_read_b64_tr_b16 v[124:125], v9 offset:4096
  v_mfma_f32_16x16x32_bf16 v[152:155], v[104:107], v[72:75], v[152:155]
  ds_read_b64_tr_b16 v[126:127], v9 offset:6144
  v_mfma_f32_16x16x32_bf16 v[148:151], v[104:107], v[68:71], v[148:151]
  s_sub_u32 s22, s22, 1
  s_cmp_lg_u32 s22, 0
  v_mfma_f32_16x16x32_bf16 v[148:151], v[108:111], v[84:87], v[148:151]
  v_mfma_f32_16x16x32_bf16 v[144:147], v[108:111], v[80:83], v[144:147]
  ds_read_b64_tr_b16 v[96:97], v6 offset:8192
  v_mfma_f32_16x16x32_bf16 v[144:147], v[104:107], v[64:67], v[144:147]
  ds_read_b64_tr_b16 v[98:99], v6 offset:10240
  s_nop 0
  s_waitcnt lgkmcnt(6)
  v_mfma_f32_16x16x32_bf16 v[160:163], v[112:115], v[64:67], v[160:163]
  ds_read_b64_tr_b16 v[100:101], v6 offset:12288
  v_mfma_f32_16x16x32_bf16 v[160:163], v[116:119], v[80:83], v[160:163]
  ds_read_b64_tr_b16 v[102:103], v6 offset:14336
  v_mfma_f32_16x16x32_bf16 v[164:167], v[116:119], v[84:87], v[164:167]
  v_mfma_f32_16x16x32_bf16 v[164:167], v[112:115], v[68:71], v[164:167]
  v_mfma_f32_16x16x32_bf16 v[168:171], v[112:115], v[72:75], v[168:171]
  ds_read_b64_tr_b16 v[104:105], v7 offset:8192
  v_mfma_f32_16x16x32_bf16 v[168:171], v[116:119], v[88:91], v[168:171]
  ds_read_b64_tr_b16 v[106:107], v7 offset:10240
  v_mfma_f32_16x16x32_bf16 v[172:175], v[116:119], v[92:95], v[172:175]
  ds_read_b64_tr_b16 v[108:109], v7 offset:12288
  v_mfma_f32_16x16x32_bf16 v[172:175], v[112:115], v[76:79], v[172:175]
  ds_read_b64_tr_b16 v[110:111], v7 offset:14336
  s_waitcnt lgkmcnt(8)
  v_mfma_f32_16x16x32_bf16 v[188:191], v[120:123], v[76:79], v[188:191]
  v_add_u32 v6, s23, v6
  v_add_u32_e64 v7, s23, v7
  v_mfma_f32_16x16x32_bf16 v[188:191], v[124:127], v[92:95], v[188:191]
  ds_read_b64_tr_b16 v[112:113], v10 offset:0
  v_mfma_f32_16x16x32_bf16 v[184:187], v[124:127], v[88:91], v[184:187]
  ds_read_b64_tr_b16 v[114:115], v10 offset:1024
  v_mfma_f32_16x16x32_bf16 v[184:187], v[120:123], v[72:75], v[184:187]
  ds_read_b64_tr_b16 v[116:117], v10 offset:2048
  v_mfma_f32_16x16x32_bf16 v[180:183], v[120:123], v[68:71], v[180:183]
  ds_read_b64_tr_b16 v[118:119], v10 offset:3072
  v_mfma_f32_16x16x32_bf16 v[180:183], v[124:127], v[84:87], v[180:183]
  v_add_u32 v8, s23, v8
  v_add_u32 v9, s23, v9
  v_mfma_f32_16x16x32_bf16 v[176:179], v[124:127], v[80:83], v[176:179]
  v_add_u32 v10, s23, v10
  v_mfma_f32_16x16x32_bf16 v[176:179], v[120:123], v[64:67], v[176:179]
  s_waitcnt lgkmcnt(0)
  s_barrier
  s_cbranch_scc0 Lk_23
  v_mfma_f32_16x16x32_bf16 v[192:195], v[96:99], v[64:67], v[192:195]
  ds_read_b128 v[32:35], v4 offset:0
  v_mfma_f32_16x16x32_bf16 v[192:195], v[100:103], v[80:83], v[192:195]
  ds_read_b128 v[48:51], v5 offset:0
  v_mfma_f32_16x16x32_bf16 v[196:199], v[100:103], v[84:87], v[196:199]
  v_mfma_f32_16x16x32_bf16 v[196:199], v[96:99], v[68:71], v[196:199]
  ds_read_b128 v[36:39], v4 offset:2048
  v_mfma_f32_16x16x32_bf16 v[200:203], v[96:99], v[72:75], v[200:203]
  ds_read_b128 v[52:55], v5 offset:2048
  v_mfma_f32_16x16x32_bf16 v[200:203], v[100:103], v[88:91], v[200:203]
  v_mfma_f32_16x16x32_bf16 v[204:207], v[100:103], v[92:95], v[204:207]
  ds_read_b128 v[40:43], v4 offset:4096
  v_mfma_f32_16x16x32_bf16 v[204:207], v[96:99], v[76:79], v[204:207]
  ds_read_b128 v[56:59], v5 offset:4096
  v_mfma_f32_16x16x32_bf16 v[220:223], v[104:107], v[76:79], v[220:223]
  ds_read_b64_tr_b16 v[96:97], v6 offset:0
  v_mfma_f32_16x16x32_bf16 v[220:223], v[108:111], v[92:95], v[220:223]
  ds_read_b64_tr_b16 v[98:99], v6 offset:2048
  v_mfma_f32_16x16x32_bf16 v[216:219], v[108:111], v[88:91], v[216:219]
  ds_read_b64_tr_b16 v[100:101], v6 offset:4096
  v_mfma_f32_16x16x32_bf16 v[216:219], v[104:107], v[72:75], v[216:219]
  ds_read_b64_tr_b16 v[102:103], v6 offset:6144
  v_mfma_f32_16x16x32_bf16 v[212:215], v[104:107], v[68:71], v[212:215]
  ds_read_b128 v[44:47], v4 offset:6144
  v_mfma_f32_16x16x32_bf16 v[212:215], v[108:111], v[84:87], v[212:215]
  v_mfma_f32_16x16x32_bf16 v[208:211], v[108:111], v[80:83], v[208:211]
  ds_read_b128 v[60:63], v5 offset:6144
  v_mfma_f32_16x16x32_bf16 v[208:211], v[104:107], v[64:67], v[208:211]
  v_mfma_f32_16x16x32_bf16 v[224:227], v[112:115], v[64:67], v[224:227]
  ds_read_b64_tr_b16 v[104:105], v7 offset:0
  v_mfma_f32_16x16x32_bf16 v[224:227], v[116:119], v[80:83], v[224:227]
  v_mfma_f32_16x16x32_bf16 v[228:231], v[116:119], v[84:87], v[228:231]
  ds_read_b64_tr_b16 v[106:107], v7 offset:2048
  v_mfma_f32_16x16x32_bf16 v[228:231], v[112:115], v[68:71], v[228:231]
  v_mfma_f32_16x16x32_bf16 v[232:235], v[112:115], v[72:75], v[232:235]
  ds_read_b64_tr_b16 v[108:109], v7 offset:4096
  v_mfma_f32_16x16x32_bf16 v[232:235], v[116:119], v[88:91], v[232:235]
  v_mfma_f32_16x16x32_bf16 v[236:239], v[116:119], v[92:95], v[236:239]
  ds_read_b64_tr_b16 v[110:111], v7 offset:6144
  s_waitcnt lgkmcnt(6)
  v_mfma_f32_16x16x32_bf16 v[236:239], v[112:115], v[76:79], v[236:239]
  s_branch Lk_21
Lk_23:
  v_mfma_f32_16x16x32_bf16 v[192:195], v[96:99], v[64:67], v[192:195]
  ds_read_b128 v[32:35], v3 offset:0
  s_mul_i32 s4, s85, 320
  v_mfma_f32_16x16x32_bf16 v[192:195], v[100:103], v[80:83], v[192:195]
  ds_read_b128 v[36:39], v3 offset:1024
  s_add_u32 s4, s4, 151552
  v_mfma_f32_16x16x32_bf16 v[196:199], v[100:103], v[84:87], v[196:199]
  ds_read_b128 v[40:43], v3 offset:64
  v_and_b32_e64 v2, 15, v1
  v_mfma_f32_16x16x32_bf16 v[196:199], v[96:99], v[68:71], v[196:199]
  ds_read_b128 v[44:47], v3 offset:1088
  v_lshl_add_u32 v7, v2, 2, s4
  v_mfma_f32_16x16x32_bf16 v[200:203], v[96:99], v[72:75], v[200:203]
  ds_read_b128 v[48:51], v3 offset:128
  v_mov_b32 v4, 0x409d30fc
  v_mfma_f32_16x16x32_bf16 v[200:203], v[100:103], v[88:91], v[200:203]
  ds_read_b128 v[52:55], v3 offset:1152
  v_mov_b32 v5, 0x3eeff558
  v_mfma_f32_16x16x32_bf16 v[204:207], v[100:103], v[92:95], v[204:207]
  ds_read_b128 v[56:59], v3 offset:192
  v_and_b32_e64 v2, 32, v1
  v_mfma_f32_16x16x32_bf16 v[204:207], v[96:99], v[76:79], v[204:207]
  ds_read_b128 v[60:63], v3 offset:1216
  v_mad_u32_u24 v6, v2, 48, v11
  v_mfma_f32_16x16x32_bf16 v[220:223], v[104:107], v[76:79], v[220:223]
  v_mfma_f32_16x16x32_bf16 v[220:223], v[108:111], v[92:95], v[220:223]
  ds_read2_b32 v[96:97], v7 offset0:0 offset1:160
  ds_read2_b32 v[98:99], v7 offset0:16 offset1:176
  v_mfma_f32_16x16x32_bf16 v[216:219], v[108:111], v[88:91], v[216:219]
  ds_read2_b32 v[100:101], v7 offset0:32 offset1:192
  ds_read2_b32 v[102:103], v7 offset0:48 offset1:208
  v_mfma_f32_16x16x32_bf16 v[216:219], v[104:107], v[72:75], v[216:219]
  s_lshl_b32 s5, s86, Lz1-Lz0+6
  s_add_u32 s5, s5, 154880
  v_mfma_f32_16x16x32_bf16 v[212:215], v[104:107], v[68:71], v[212:215]
  v_add_u32_e64 v2, s5, v29
  v_mfma_f32_16x16x32_bf16 v[212:215], v[108:111], v[84:87], v[212:215]
  v_mfma_f32_16x16x32_bf16 v[208:211], v[108:111], v[80:83], v[208:211]
  v_mfma_f32_16x16x32_bf16 v[208:211], v[104:107], v[64:67], v[208:211]
  v_mfma_f32_16x16x32_bf16 v[224:227], v[112:115], v[64:67], v[224:227]
  v_mfma_f32_16x16x32_bf16 v[224:227], v[116:119], v[80:83], v[224:227]
  v_mfma_f32_16x16x32_bf16 v[228:231], v[116:119], v[84:87], v[228:231]
  v_mfma_f32_16x16x32_bf16 v[228:231], v[112:115], v[68:71], v[228:231]
  s_waitcnt lgkmcnt(0)
  v_mul_f32 v96, v5, v96
  v_mul_f32_e64 v97, v5, v97
  v_mfma_f32_16x16x32_bf16 v[232:235], v[112:115], v[72:75], v[232:235]
  v_mul_f32 v98, v5, v98
  v_mul_f32 v99, v5, v99
  v_mfma_f32_16x16x32_bf16 v[232:235], v[116:119], v[88:91], v[232:235]
  v_mul_f32 v100, v5, v100
  v_mul_f32 v101, v5, v101
  v_mfma_f32_16x16x32_bf16 v[236:239], v[116:119], v[92:95], v[236:239]
  v_mul_f32 v102, v5, v102
  v_mul_f32 v103, v5, v103
  v_mfma_f32_16x16x32_bf16 v[236:239], v[112:115], v[76:79], v[236:239]
  ds_read_b128 v[80:83], v2 offset:0
  ds_read_b128 v[84:87], v2 offset:1024
  ds_read_b128 v[64:67], v3 offset:256
  ds_read_b128 v[68:71], v3 offset:1280
  ds_read_b128 v[72:75], v3 offset:320
  ds_read_b128 v[76:79], v3 offset:1344
  v_pk_fma_f32 v[104:105], v[32:33], v[96:97], v[36:37] op_sel:[0,1,0] op_sel_hi:[1,1,1] neg_lo:[0,1,0] neg_hi:[0,1,0]
  v_pk_fma_f32 v[106:107], v[34:35], v[96:97], v[38:39] op_sel:[0,1,0] op_sel_hi:[1,1,1] neg_lo:[0,1,0] neg_hi:[0,1,0]
  v_pk_fma_f32 v[108:109], v[40:41], v[96:97], v[44:45] op_sel:[0,1,0] op_sel_hi:[1,1,1] neg_lo:[0,1,0] neg_hi:[0,1,0]
  v_pk_fma_f32 v[110:111], v[42:43], v[96:97], v[46:47] op_sel:[0,1,0] op_sel_hi:[1,1,1] neg_lo:[0,1,0] neg_hi:[0,1,0]
  v_pk_fma_f32 v[128:129], v[128:129], v[96:97], v[104:105] op_sel:[0,0,0] op_sel_hi:[1,0,1]
  v_pk_fma_f32 v[130:131], v[130:131], v[96:97], v[106:107] op_sel:[0,0,0] op_sel_hi:[1,0,1]
  v_pk_fma_f32 v[144:145], v[144:145], v[96:97], v[108:109] op_sel:[0,0,0] op_sel_hi:[1,0,1]
  v_pk_fma_f32 v[146:147], v[146:147], v[96:97], v[110:111] op_sel:[0,0,0] op_sel_hi:[1,0,1]
  v_pk_fma_f32 v[104:105], v[128:129], v[128:129], v[4:5] op_sel_hi:[1,1,0]
  v_pk_fma_f32 v[106:107], v[130:131], v[130:131], v[4:5] op_sel_hi:[1,1,0]
  v_pk_fma_f32 v[108:109], v[144:145], v[144:145], v[4:5] op_sel_hi:[1,1,0]
  v_pk_fma_f32 v[110:111], v[146:147], v[146:147], v[4:5] op_sel_hi:[1,1,0]
  v_pk_mul_f32 v[104:105], v[104:105], v[128:129] neg_lo:[0,1] neg_hi:[0,1]
  v_pk_mul_f32 v[106:107], v[106:107], v[130:131] neg_lo:[0,1] neg_hi:[0,1]
  v_pk_mul_f32 v[108:109], v[108:109], v[144:145] neg_lo:[0,1] neg_hi:[0,1]
  v_pk_mul_f32 v[110:111], v[110:111], v[146:147] neg_lo:[0,1] neg_hi:[0,1]
  v_exp_f32 v104, v104
  v_exp_f32 v105, v105
  v_exp_f32 v106, v106
  v_exp_f32 v107, v107
  v_exp_f32 v108, v108
  v_exp_f32 v109, v109
  v_exp_f32 v110, v110
  v_exp_f32 v111, v111
  v_pk_fma_f32 v[104:105], v[104:105], v[4:5], v[4:5] op_sel:[0,1,1] op_sel_hi:[1,1,1]
  v_pk_fma_f32 v[106:107], v[106:107], v[4:5], v[4:5] op_sel:[0,1,1] op_sel_hi:[1,1,1]
  v_pk_fma_f32 v[108:109], v[108:109], v[4:5], v[4:5] op_sel:[0,1,1] op_sel_hi:[1,1,1]
  v_pk_fma_f32 v[110:111], v[110:111], v[4:5], v[4:5] op_sel:[0,1,1] op_sel_hi:[1,1,1]
  v_rcp_f32 v104, v104
  v_rcp_f32 v105, v105
  v_rcp_f32 v106, v106
  v_rcp_f32 v107, v107
  v_rcp_f32 v108, v108
  v_rcp_f32 v109, v109
  v_rcp_f32 v110, v110
  v_rcp_f32 v111, v111
  v_pk_mul_f32 v[128:129], v[128:129], v[104:105]
  v_pk_mul_f32 v[130:131], v[130:131], v[106:107]
  v_pk_mul_f32 v[144:145], v[144:145], v[108:109]
  v_pk_mul_f32 v[146:147], v[146:147], v[110:111]
  v_cvt_pk_bf16_f32 v116, v128, v129
  v_cvt_pk_bf16_f32 v117, v130, v131
  v_cvt_pk_bf16_f32 v118, v144, v145
  v_cvt_pk_bf16_f32 v119, v146, v147
  buffer_store_dwordx4 v[116:119], v0, s[40:43], s6 offen offset:0 sc0 sc1
  ds_write_b128 v0, v[116:119] offset:0
  v_pk_fma_f32 v[104:105], v[32:33], v[98:99], v[36:37] op_sel:[0,1,0] op_sel_hi:[1,1,1] neg_lo:[0,1,0] neg_hi:[0,1,0]
  v_pk_fma_f32 v[106:107], v[34:35], v[98:99], v[38:39] op_sel:[0,1,0] op_sel_hi:[1,1,1] neg_lo:[0,1,0] neg_hi:[0,1,0]
  v_pk_fma_f32 v[108:109], v[40:41], v[98:99], v[44:45] op_sel:[0,1,0] op_sel_hi:[1,1,1] neg_lo:[0,1,0] neg_hi:[0,1,0]
  v_pk_fma_f32 v[110:111], v[42:43], v[98:99], v[46:47] op_sel:[0,1,0] op_sel_hi:[1,1,1] neg_lo:[0,1,0] neg_hi:[0,1,0]
  v_pk_fma_f32 v[132:133], v[132:133], v[98:99], v[104:105] op_sel:[0,0,0] op_sel_hi:[1,0,1]
  v_pk_fma_f32 v[134:135], v[134:135], v[98:99], v[106:107] op_sel:[0,0,0] op_sel_hi:[1,0,1]
  v_pk_fma_f32 v[148:149], v[148:149], v[98:99], v[108:109] op_sel:[0,0,0] op_sel_hi:[1,0,1]
  v_pk_fma_f32 v[150:151], v[150:151], v[98:99], v[110:111] op_sel:[0,0,0] op_sel_hi:[1,0,1]
  v_pk_fma_f32 v[104:105], v[132:133], v[132:133], v[4:5] op_sel_hi:[1,1,0]
  v_pk_fma_f32 v[106:107], v[134:135], v[134:135], v[4:5] op_sel_hi:[1,1,0]
  v_pk_fma_f32 v[108:109], v[148:149], v[148:149], v[4:5] op_sel_hi:[1,1,0]
  v_pk_fma_f32 v[110:111], v[150:151], v[150:151], v[4:5] op_sel_hi:[1,1,0]
  v_pk_mul_f32 v[104:105], v[104:105], v[132:133] neg_lo:[0,1] neg_hi:[0,1]
  v_pk_mul_f32 v[106:107], v[106:107], v[134:135] neg_lo:[0,1] neg_hi:[0,1]
  v_pk_mul_f32 v[108:109], v[108:109], v[148:149] neg_lo:[0,1] neg_hi:[0,1]
  v_pk_mul_f32 v[110:111], v[110:111], v[150:151] neg_lo:[0,1] neg_hi:[0,1]
  v_exp_f32 v104, v104
  v_exp_f32 v105, v105
  v_exp_f32 v106, v106
  v_exp_f32 v107, v107
  v_exp_f32 v108, v108
  v_exp_f32 v109, v109
  v_exp_f32 v110, v110
  v_exp_f32 v111, v111
  v_pk_fma_f32 v[104:105], v[104:105], v[4:5], v[4:5] op_sel:[0,1,1] op_sel_hi:[1,1,1]
  v_pk_fma_f32 v[106:107], v[106:107], v[4:5], v[4:5] op_sel:[0,1,1] op_sel_hi:[1,1,1]
  v_pk_fma_f32 v[108:109], v[108:109], v[4:5], v[4:5] op_sel:[0,1,1] op_sel_hi:[1,1,1]
  v_pk_fma_f32 v[110:111], v[110:111], v[4:5], v[4:5] op_sel:[0,1,1] op_sel_hi:[1,1,1]
  v_rcp_f32 v104, v104
  v_rcp_f32 v105, v105
  v_rcp_f32 v106, v106
  v_rcp_f32 v107, v107
  v_rcp_f32 v108, v108
  v_rcp_f32 v109, v109
  v_rcp_f32 v110, v110
  v_rcp_f32 v111, v111
  v_pk_mul_f32 v[132:133], v[132:133], v[104:105]
  v_pk_mul_f32 v[134:135], v[134:135], v[106:107]
  v_pk_mul_f32 v[148:149], v[148:149], v[108:109]
  v_pk_mul_f32 v[150:151], v[150:151], v[110:111]
  v_cvt_pk_bf16_f32 v120, v132, v133
  v_cvt_pk_bf16_f32 v121, v134, v135
  v_cvt_pk_bf16_f32 v122, v148, v149
  v_cvt_pk_bf16_f32 v123, v150, v151
  buffer_store_dwordx4 v[120:123], v0, s[40:43], s6 offen offset:2048 sc0 sc1
  ds_write_b128 v0, v[120:123] offset:2048
  s_add_u32 s6, s6, 0x20000
  v_pk_fma_f32 v[104:105], v[32:33], v[100:101], v[36:37] op_sel:[0,1,0] op_sel_hi:[1,1,1] neg_lo:[0,1,0] neg_hi:[0,1,0]
  v_pk_fma_f32 v[106:107], v[34:35], v[100:101], v[38:39] op_sel:[0,1,0] op_sel_hi:[1,1,1] neg_lo:[0,1,0] neg_hi:[0,1,0]
  v_pk_fma_f32 v[108:109], v[40:41], v[100:101], v[44:45] op_sel:[0,1,0] op_sel_hi:[1,1,1] neg_lo:[0,1,0] neg_hi:[0,1,0]
  v_pk_fma_f32 v[110:111], v[42:43], v[100:101], v[46:47] op_sel:[0,1,0] op_sel_hi:[1,1,1] neg_lo:[0,1,0] neg_hi:[0,1,0]
  v_pk_fma_f32 v[136:137], v[136:137], v[100:101], v[104:105] op_sel:[0,0,0] op_sel_hi:[1,0,1]
  v_pk_fma_f32 v[138:139], v[138:139], v[100:101], v[106:107] op_sel:[0,0,0] op_sel_hi:[1,0,1]
  v_pk_fma_f32 v[152:153], v[152:153], v[100:101], v[108:109] op_sel:[0,0,0] op_sel_hi:[1,0,1]
  v_pk_fma_f32 v[154:155], v[154:155], v[100:101], v[110:111] op_sel:[0,0,0] op_sel_hi:[1,0,1]
  v_pk_fma_f32 v[104:105], v[136:137], v[136:137], v[4:5] op_sel_hi:[1,1,0]
  v_pk_fma_f32 v[106:107], v[138:139], v[138:139], v[4:5] op_sel_hi:[1,1,0]
  v_pk_fma_f32 v[108:109], v[152:153], v[152:153], v[4:5] op_sel_hi:[1,1,0]
  v_pk_fma_f32 v[110:111], v[154:155], v[154:155], v[4:5] op_sel_hi:[1,1,0]
  v_pk_mul_f32 v[104:105], v[104:105], v[136:137] neg_lo:[0,1] neg_hi:[0,1]
  v_pk_mul_f32 v[106:107], v[106:107], v[138:139] neg_lo:[0,1] neg_hi:[0,1]
  v_pk_mul_f32 v[108:109], v[108:109], v[152:153] neg_lo:[0,1] neg_hi:[0,1]
  v_pk_mul_f32 v[110:111], v[110:111], v[154:155] neg_lo:[0,1] neg_hi:[0,1]
  v_exp_f32 v104, v104
  v_exp_f32 v105, v105
  v_exp_f32 v106, v106
  v_exp_f32 v107, v107
  v_exp_f32 v108, v108
  v_exp_f32 v109, v109
  v_exp_f32 v110, v110
  v_exp_f32 v111, v111
  v_pk_fma_f32 v[104:105], v[104:105], v[4:5], v[4:5] op_sel:[0,1,1] op_sel_hi:[1,1,1]
  v_pk_fma_f32 v[106:107], v[106:107], v[4:5], v[4:5] op_sel:[0,1,1] op_sel_hi:[1,1,1]
  v_pk_fma_f32 v[108:109], v[108:109], v[4:5], v[4:5] op_sel:[0,1,1] op_sel_hi:[1,1,1]
  v_pk_fma_f32 v[110:111], v[110:111], v[4:5], v[4:5] op_sel:[0,1,1] op_sel_hi:[1,1,1]
  v_rcp_f32 v104, v104
  v_rcp_f32 v105, v105
  v_rcp_f32 v106, v106
  v_rcp_f32 v107, v107
  v_rcp_f32 v108, v108
  v_rcp_f32 v109, v109
  v_rcp_f32 v110, v110
  v_rcp_f32 v111, v111
  v_pk_mul_f32 v[136:137], v[136:137], v[104:105]
  v_pk_mul_f32 v[138:139], v[138:139], v[106:107]
  v_pk_mul_f32 v[152:153], v[152:153], v[108:109]
  v_pk_mul_f32 v[154:155], v[154:155], v[110:111]
  v_cvt_pk_bf16_f32 v116, v136, v137
  v_cvt_pk_bf16_f32 v117, v138, v139
  v_cvt_pk_bf16_f32 v118, v152, v153
  v_cvt_pk_bf16_f32 v119, v154, v155
  buffer_store_dwordx4 v[116:119], v0, s[40:43], s7 offen offset:0 sc0 sc1
  ds_write_b128 v0, v[116:119] offset:4096
  v_pk_fma_f32 v[104:105], v[32:33], v[102:103], v[36:37] op_sel:[0,1,0] op_sel_hi:[1,1,1] neg_lo:[0,1,0] neg_hi:[0,1,0]
  v_pk_fma_f32 v[106:107], v[34:35], v[102:103], v[38:39] op_sel:[0,1,0] op_sel_hi:[1,1,1] neg_lo:[0,1,0] neg_hi:[0,1,0]
  v_pk_fma_f32 v[108:109], v[40:41], v[102:103], v[44:45] op_sel:[0,1,0] op_sel_hi:[1,1,1] neg_lo:[0,1,0] neg_hi:[0,1,0]
  v_pk_fma_f32 v[110:111], v[42:43], v[102:103], v[46:47] op_sel:[0,1,0] op_sel_hi:[1,1,1] neg_lo:[0,1,0] neg_hi:[0,1,0]
  v_pk_fma_f32 v[140:141], v[140:141], v[102:103], v[104:105] op_sel:[0,0,0] op_sel_hi:[1,0,1]
  v_pk_fma_f32 v[142:143], v[142:143], v[102:103], v[106:107] op_sel:[0,0,0] op_sel_hi:[1,0,1]
  v_pk_fma_f32 v[156:157], v[156:157], v[102:103], v[108:109] op_sel:[0,0,0] op_sel_hi:[1,0,1]
  v_pk_fma_f32 v[158:159], v[158:159], v[102:103], v[110:111] op_sel:[0,0,0] op_sel_hi:[1,0,1]
  v_pk_fma_f32 v[104:105], v[140:141], v[140:141], v[4:5] op_sel_hi:[1,1,0]
  v_pk_fma_f32 v[106:107], v[142:143], v[142:143], v[4:5] op_sel_hi:[1,1,0]
  v_pk_fma_f32 v[108:109], v[156:157], v[156:157], v[4:5] op_sel_hi:[1,1,0]
  v_pk_fma_f32 v[110:111], v[158:159], v[158:159], v[4:5] op_sel_hi:[1,1,0]
  v_pk_mul_f32 v[104:105], v[104:105], v[140:141] neg_lo:[0,1] neg_hi:[0,1]
  v_pk_mul_f32 v[106:107], v[106:107], v[142:143] neg_lo:[0,1] neg_hi:[0,1]
  v_pk_mul_f32 v[108:109], v[108:109], v[156:157] neg_lo:[0,1] neg_hi:[0,1]
  v_pk_mul_f32 v[110:111], v[110:111], v[158:159] neg_lo:[0,1] neg_hi:[0,1]
  v_exp_f32 v104, v104
  v_exp_f32 v105, v105
  v_exp_f32 v106, v106
  v_exp_f32 v107, v107
  v_exp_f32 v108, v108
  v_exp_f32 v109, v109
  v_exp_f32 v110, v110
  v_exp_f32 v111, v111
  v_pk_fma_f32 v[104:105], v[104:105], v[4:5], v[4:5] op_sel:[0,1,1] op_sel_hi:[1,1,1]
  v_pk_fma_f32 v[106:107], v[106:107], v[4:5], v[4:5] op_sel:[0,1,1] op_sel_hi:[1,1,1]
  v_pk_fma_f32 v[108:109], v[108:109], v[4:5], v[4:5] op_sel:[0,1,1] op_sel_hi:[1,1,1]
  v_pk_fma_f32 v[110:111], v[110:111], v[4:5], v[4:5] op_sel:[0,1,1] op_sel_hi:[1,1,1]
  v_rcp_f32 v104, v104
  v_rcp_f32 v105, v105
  v_rcp_f32 v106, v106
  v_rcp_f32 v107, v107
  v_rcp_f32 v108, v108
  v_rcp_f32 v109, v109
  v_rcp_f32 v110, v110
  v_rcp_f32 v111, v111
  v_pk_mul_f32 v[140:141], v[140:141], v[104:105]
  v_pk_mul_f32 v[142:143], v[142:143], v[106:107]
  v_pk_mul_f32 v[156:157], v[156:157], v[108:109]
  v_pk_mul_f32 v[158:159], v[158:159], v[110:111]
  v_cvt_pk_bf16_f32 v120, v140, v141
  v_cvt_pk_bf16_f32 v121, v142, v143
  v_cvt_pk_bf16_f32 v122, v156, v157
  v_cvt_pk_bf16_f32 v123, v158, v159
  buffer_store_dwordx4 v[120:123], v0, s[40:43], s7 offen offset:2048 sc0 sc1
  ds_write_b128 v0, v[120:123] offset:6144
  s_add_u32 s7, s7, 0x20000
  s_nop 0
  s_waitcnt lgkmcnt(0)
  v_pk_fma_f32 v[104:105], v[80:81], v[96:97], v[84:85] op_sel:[0,1,0] op_sel_hi:[1,1,1] neg_lo:[0,1,0] neg_hi:[0,1,0]
  v_pk_fma_f32 v[106:107], v[82:83], v[96:97], v[86:87] op_sel:[0,1,0] op_sel_hi:[1,1,1] neg_lo:[0,1,0] neg_hi:[0,1,0]
  v_pk_fma_f32 v[108:109], v[80:81], v[98:99], v[84:85] op_sel:[0,1,0] op_sel_hi:[1,1,1] neg_lo:[0,1,0] neg_hi:[0,1,0]
  v_pk_fma_f32 v[110:111], v[82:83], v[98:99], v[86:87] op_sel:[0,1,0] op_sel_hi:[1,1,1] neg_lo:[0,1,0] neg_hi:[0,1,0]
  v_pk_fma_f32 v[224:225], v[224:225], v[96:97], v[104:105] op_sel:[0,0,0] op_sel_hi:[1,0,1]
  v_pk_fma_f32 v[226:227], v[226:227], v[96:97], v[106:107] op_sel:[0,0,0] op_sel_hi:[1,0,1]
  v_pk_fma_f32 v[228:229], v[228:229], v[98:99], v[108:109] op_sel:[0,0,0] op_sel_hi:[1,0,1]
  v_pk_fma_f32 v[230:231], v[230:231], v[98:99], v[110:111] op_sel:[0,0,0] op_sel_hi:[1,0,1]
  v_pk_fma_f32 v[104:105], v[224:225], v[224:225], v[4:5] op_sel_hi:[1,1,0]
  v_pk_fma_f32 v[106:107], v[226:227], v[226:227], v[4:5] op_sel_hi:[1,1,0]
  v_pk_fma_f32 v[108:109], v[228:229], v[228:229], v[4:5] op_sel_hi:[1,1,0]
  v_pk_fma_f32 v[110:111], v[230:231], v[230:231], v[4:5] op_sel_hi:[1,1,0]
  v_pk_mul_f32 v[104:105], v[104:105], v[224:225] neg_lo:[0,1] neg_hi:[0,1]
  v_pk_mul_f32 v[106:107], v[106:107], v[226:227] neg_lo:[0,1] neg_hi:[0,1]
  v_pk_mul_f32 v[108:109], v[108:109], v[228:229] neg_lo:[0,1] neg_hi:[0,1]
  v_pk_mul_f32 v[110:111], v[110:111], v[230:231] neg_lo:[0,1] neg_hi:[0,1]
  v_exp_f32 v104, v104
  v_exp_f32 v105, v105
  v_exp_f32 v106, v106
  v_exp_f32 v107, v107
  v_exp_f32 v108, v108
  v_exp_f32 v109, v109
  v_exp_f32 v110, v110
  v_exp_f32 v111, v111
  v_pk_fma_f32 v[104:105], v[104:105], v[4:5], v[4:5] op_sel:[0,1,1] op_sel_hi:[1,1,1]
  v_pk_fma_f32 v[106:107], v[106:107], v[4:5], v[4:5] op_sel:[0,1,1] op_sel_hi:[1,1,1]
  v_pk_fma_f32 v[108:109], v[108:109], v[4:5], v[4:5] op_sel:[0,1,1] op_sel_hi:[1,1,1]
  v_pk_fma_f32 v[110:111], v[110:111], v[4:5], v[4:5] op_sel:[0,1,1] op_sel_hi:[1,1,1]
  v_rcp_f32 v104, v104
  v_rcp_f32 v105, v105
  v_rcp_f32 v106, v106
  v_rcp_f32 v107, v107
  v_rcp_f32 v108, v108
  v_rcp_f32 v109, v109
  v_rcp_f32 v110, v110
  v_rcp_f32 v111, v111
  v_pk_mul_f32 v[224:225], v[224:225], v[104:105]
  v_pk_mul_f32 v[226:227], v[226:227], v[106:107]
  v_pk_mul_f32 v[228:229], v[228:229], v[108:109]
  v_pk_mul_f32 v[230:231], v[230:231], v[110:111]
  v_cvt_pk_bf16_f32 v116, v224, v225
  v_cvt_pk_bf16_f32 v117, v226, v227
  v_cvt_pk_bf16_f32 v118, v228, v229
  v_cvt_pk_bf16_f32 v119, v230, v231
  s_nop 0
  v_permlane32_swap_b32 v116, v118
  v_permlane32_swap_b32_e64 v117, v119
  buffer_store_dwordx4 v[116:119], v6, s[40:43], s8 offen sc0 sc1
  s_add_u32 s8, s8, 4096
  v_pk_fma_f32 v[104:105], v[80:81], v[100:101], v[84:85] op_sel:[0,1,0] op_sel_hi:[1,1,1] neg_lo:[0,1,0] neg_hi:[0,1,0]
  v_pk_fma_f32 v[106:107], v[82:83], v[100:101], v[86:87] op_sel:[0,1,0] op_sel_hi:[1,1,1] neg_lo:[0,1,0] neg_hi:[0,1,0]
  v_pk_fma_f32 v[108:109], v[80:81], v[102:103], v[84:85] op_sel:[0,1,0] op_sel_hi:[1,1,1] neg_lo:[0,1,0] neg_hi:[0,1,0]
  v_pk_fma_f32 v[110:111], v[82:83], v[102:103], v[86:87] op_sel:[0,1,0] op_sel_hi:[1,1,1] neg_lo:[0,1,0] neg_hi:[0,1,0]
  v_pk_fma_f32 v[232:233], v[232:233], v[100:101], v[104:105] op_sel:[0,0,0] op_sel_hi:[1,0,1]
  v_pk_fma_f32 v[234:235], v[234:235], v[100:101], v[106:107] op_sel:[0,0,0] op_sel_hi:[1,0,1]
  v_pk_fma_f32 v[236:237], v[236:237], v[102:103], v[108:109] op_sel:[0,0,0] op_sel_hi:[1,0,1]
  v_pk_fma_f32 v[238:239], v[238:239], v[102:103], v[110:111] op_sel:[0,0,0] op_sel_hi:[1,0,1]
  v_pk_fma_f32 v[104:105], v[232:233], v[232:233], v[4:5] op_sel_hi:[1,1,0]
  v_pk_fma_f32 v[106:107], v[234:235], v[234:235], v[4:5] op_sel_hi:[1,1,0]
  v_pk_fma_f32 v[108:109], v[236:237], v[236:237], v[4:5] op_sel_hi:[1,1,0]
  v_pk_fma_f32 v[110:111], v[238:239], v[238:239], v[4:5] op_sel_hi:[1,1,0]
  v_pk_mul_f32 v[104:105], v[104:105], v[232:233] neg_lo:[0,1] neg_hi:[0,1]
  v_pk_mul_f32 v[106:107], v[106:107], v[234:235] neg_lo:[0,1] neg_hi:[0,1]
  v_pk_mul_f32 v[108:109], v[108:109], v[236:237] neg_lo:[0,1] neg_hi:[0,1]
  v_pk_mul_f32 v[110:111], v[110:111], v[238:239] neg_lo:[0,1] neg_hi:[0,1]
  v_exp_f32 v104, v104
  v_exp_f32 v105, v105
  v_exp_f32 v106, v106
  v_exp_f32 v107, v107
  v_exp_f32 v108, v108
  v_exp_f32 v109, v109
  v_exp_f32 v110, v110
  v_exp_f32 v111, v111
  v_pk_fma_f32 v[104:105], v[104:105], v[4:5], v[4:5] op_sel:[0,1,1] op_sel_hi:[1,1,1]
  v_pk_fma_f32 v[106:107], v[106:107], v[4:5], v[4:5] op_sel:[0,1,1] op_sel_hi:[1,1,1]
  v_pk_fma_f32 v[108:109], v[108:109], v[4:5], v[4:5] op_sel:[0,1,1] op_sel_hi:[1,1,1]
  v_pk_fma_f32 v[110:111], v[110:111], v[4:5], v[4:5] op_sel:[0,1,1] op_sel_hi:[1,1,1]
  v_rcp_f32 v104, v104
  v_rcp_f32 v105, v105
  v_rcp_f32 v106, v106
  v_rcp_f32 v107, v107
  v_rcp_f32 v108, v108
  v_rcp_f32 v109, v109
  v_rcp_f32 v110, v110
  v_rcp_f32 v111, v111
  v_pk_mul_f32 v[232:233], v[232:233], v[104:105]
  v_pk_mul_f32 v[234:235], v[234:235], v[106:107]
  v_pk_mul_f32 v[236:237], v[236:237], v[108:109]
  v_pk_mul_f32 v[238:239], v[238:239], v[110:111]
  v_cvt_pk_bf16_f32 v120, v232, v233
  v_cvt_pk_bf16_f32 v121, v234, v235
  v_cvt_pk_bf16_f32 v122, v236, v237
  v_cvt_pk_bf16_f32 v123, v238, v239
  s_add_u32 s9, s87, Lz1-Lz0+8
  s_waitcnt vmcnt(1)
  s_mov_b64 exec, 1
  ds_add_rtn_u32 v124, v28, v27 offset:0
  s_mov_b64 exec, -1
  v_permlane32_swap_b32 v120, v122
  v_permlane32_swap_b32_e64 v121, v123
  buffer_store_dwordx4 v[120:123], v6, s[40:43], s8 offen sc0 sc1
  v_pk_fma_f32 v[104:105], v[48:49], v[96:97], v[52:53] op_sel:[0,1,0] op_sel_hi:[1,1,1] neg_lo:[0,1,0] neg_hi:[0,1,0]
  v_pk_fma_f32 v[106:107], v[50:51], v[96:97], v[54:55] op_sel:[0,1,0] op_sel_hi:[1,1,1] neg_lo:[0,1,0] neg_hi:[0,1,0]
  v_pk_fma_f32 v[108:109], v[56:57], v[96:97], v[60:61] op_sel:[0,1,0] op_sel_hi:[1,1,1] neg_lo:[0,1,0] neg_hi:[0,1,0]
  v_pk_fma_f32 v[110:111], v[58:59], v[96:97], v[62:63] op_sel:[0,1,0] op_sel_hi:[1,1,1] neg_lo:[0,1,0] neg_hi:[0,1,0]
  v_pk_fma_f32 v[160:161], v[160:161], v[96:97], v[104:105] op_sel:[0,0,0] op_sel_hi:[1,0,1]
  v_pk_fma_f32 v[162:163], v[162:163], v[96:97], v[106:107] op_sel:[0,0,0] op_sel_hi:[1,0,1]
  v_pk_fma_f32 v[176:177], v[176:177], v[96:97], v[108:109] op_sel:[0,0,0] op_sel_hi:[1,0,1]
  v_pk_fma_f32 v[178:179], v[178:179], v[96:97], v[110:111] op_sel:[0,0,0] op_sel_hi:[1,0,1]
  v_pk_fma_f32 v[104:105], v[160:161], v[160:161], v[4:5] op_sel_hi:[1,1,0]
  v_pk_fma_f32 v[106:107], v[162:163], v[162:163], v[4:5] op_sel_hi:[1,1,0]
  v_pk_fma_f32 v[108:109], v[176:177], v[176:177], v[4:5] op_sel_hi:[1,1,0]
  v_pk_fma_f32 v[110:111], v[178:179], v[178:179], v[4:5] op_sel_hi:[1,1,0]
  v_pk_mul_f32 v[104:105], v[104:105], v[160:161] neg_lo:[0,1] neg_hi:[0,1]
  v_pk_mul_f32 v[106:107], v[106:107], v[162:163] neg_lo:[0,1] neg_hi:[0,1]
  v_pk_mul_f32 v[108:109], v[108:109], v[176:177] neg_lo:[0,1] neg_hi:[0,1]
  v_pk_mul_f32 v[110:111], v[110:111], v[178:179] neg_lo:[0,1] neg_hi:[0,1]
  v_exp_f32 v104, v104
  v_exp_f32 v105, v105
  v_exp_f32 v106, v106
  v_exp_f32 v107, v107
  v_exp_f32 v108, v108
  v_exp_f32 v109, v109
  v_exp_f32 v110, v110
  v_exp_f32 v111, v111
  v_pk_fma_f32 v[104:105], v[104:105], v[4:5], v[4:5] op_sel:[0,1,1] op_sel_hi:[1,1,1]
  v_pk_fma_f32 v[106:107], v[106:107], v[4:5], v[4:5] op_sel:[0,1,1] op_sel_hi:[1,1,1]
  v_pk_fma_f32 v[108:109], v[108:109], v[4:5], v[4:5] op_sel:[0,1,1] op_sel_hi:[1,1,1]
  v_pk_fma_f32 v[110:111], v[110:111], v[4:5], v[4:5] op_sel:[0,1,1] op_sel_hi:[1,1,1]
  v_rcp_f32 v104, v104
  v_rcp_f32 v105, v105
  v_rcp_f32 v106, v106
  v_rcp_f32 v107, v107
  v_rcp_f32 v108, v108
  v_rcp_f32 v109, v109
  v_rcp_f32 v110, v110
  v_rcp_f32 v111, v111
  v_pk_mul_f32 v[160:161], v[160:161], v[104:105]
  v_pk_mul_f32 v[162:163], v[162:163], v[106:107]
  v_pk_mul_f32 v[176:177], v[176:177], v[108:109]
  v_pk_mul_f32 v[178:179], v[178:179], v[110:111]
  v_cvt_pk_bf16_f32 v116, v160, v161
  v_cvt_pk_bf16_f32 v117, v162, v163
  v_cvt_pk_bf16_f32 v118, v176, v177
  v_cvt_pk_bf16_f32 v119, v178, v179
  s_waitcnt lgkmcnt(0)
  v_readfirstlane_b32 s4, v124
  s_and_b32 s4, s4, 3
  s_cmp_lg_u32 s4, 3
  s_cbranch_scc1 Ls_27
  s_mov_b32 exec_lo, s10
  s_mov_b32 exec_hi, 0
  buffer_store_dword v27, v24, s[40:43], s9 offen sc0 sc1
Ls_27:
  s_mov_b64 exec, -1
  buffer_store_dwordx4 v[116:119], v0, s[40:43], s6 offen offset:0 sc0 sc1
  ds_write_b128 v0, v[116:119] offset:16384
  v_pk_fma_f32 v[104:105], v[48:49], v[98:99], v[52:53] op_sel:[0,1,0] op_sel_hi:[1,1,1] neg_lo:[0,1,0] neg_hi:[0,1,0]
  v_pk_fma_f32 v[106:107], v[50:51], v[98:99], v[54:55] op_sel:[0,1,0] op_sel_hi:[1,1,1] neg_lo:[0,1,0] neg_hi:[0,1,0]
  v_pk_fma_f32 v[108:109], v[56:57], v[98:99], v[60:61] op_sel:[0,1,0] op_sel_hi:[1,1,1] neg_lo:[0,1,0] neg_hi:[0,1,0]
  v_pk_fma_f32 v[110:111], v[58:59], v[98:99], v[62:63] op_sel:[0,1,0] op_sel_hi:[1,1,1] neg_lo:[0,1,0] neg_hi:[0,1,0]
  v_pk_fma_f32 v[164:165], v[164:165], v[98:99], v[104:105] op_sel:[0,0,0] op_sel_hi:[1,0,1]
  v_pk_fma_f32 v[166:167], v[166:167], v[98:99], v[106:107] op_sel:[0,0,0] op_sel_hi:[1,0,1]
  v_pk_fma_f32 v[180:181], v[180:181], v[98:99], v[108:109] op_sel:[0,0,0] op_sel_hi:[1,0,1]
  v_pk_fma_f32 v[182:183], v[182:183], v[98:99], v[110:111] op_sel:[0,0,0] op_sel_hi:[1,0,1]
  v_pk_fma_f32 v[104:105], v[164:165], v[164:165], v[4:5] op_sel_hi:[1,1,0]
  v_pk_fma_f32 v[106:107], v[166:167], v[166:167], v[4:5] op_sel_hi:[1,1,0]
  v_pk_fma_f32 v[108:109], v[180:181], v[180:181], v[4:5] op_sel_hi:[1,1,0]
  v_pk_fma_f32 v[110:111], v[182:183], v[182:183], v[4:5] op_sel_hi:[1,1,0]
  v_pk_mul_f32 v[104:105], v[104:105], v[164:165] neg_lo:[0,1] neg_hi:[0,1]
  v_pk_mul_f32 v[106:107], v[106:107], v[166:167] neg_lo:[0,1] neg_hi:[0,1]
  v_pk_mul_f32 v[108:109], v[108:109], v[180:181] neg_lo:[0,1] neg_hi:[0,1]
  v_pk_mul_f32 v[110:111], v[110:111], v[182:183] neg_lo:[0,1] neg_hi:[0,1]
  v_exp_f32 v104, v104
  v_exp_f32 v105, v105
  v_exp_f32 v106, v106
  v_exp_f32 v107, v107
  v_exp_f32 v108, v108
  v_exp_f32 v109, v109
  v_exp_f32 v110, v110
  v_exp_f32 v111, v111
  v_pk_fma_f32 v[104:105], v[104:105], v[4:5], v[4:5] op_sel:[0,1,1] op_sel_hi:[1,1,1]
  v_pk_fma_f32 v[106:107], v[106:107], v[4:5], v[4:5] op_sel:[0,1,1] op_sel_hi:[1,1,1]
  v_pk_fma_f32 v[108:109], v[108:109], v[4:5], v[4:5] op_sel:[0,1,1] op_sel_hi:[1,1,1]
  v_pk_fma_f32 v[110:111], v[110:111], v[4:5], v[4:5] op_sel:[0,1,1] op_sel_hi:[1,1,1]
  v_rcp_f32 v104, v104
  v_rcp_f32 v105, v105
  v_rcp_f32 v106, v106
  v_rcp_f32 v107, v107
  v_rcp_f32 v108, v108
  v_rcp_f32 v109, v109
  v_rcp_f32 v110, v110
  v_rcp_f32 v111, v111
  v_pk_mul_f32 v[164:165], v[164:165], v[104:105]
  v_pk_mul_f32 v[166:167], v[166:167], v[106:107]
  v_pk_mul_f32 v[180:181], v[180:181], v[108:109]
  v_pk_mul_f32 v[182:183], v[182:183], v[110:111]
  v_cvt_pk_bf16_f32 v120, v164, v165
  v_cvt_pk_bf16_f32 v121, v166, v167
  v_cvt_pk_bf16_f32 v122, v180, v181
  v_cvt_pk_bf16_f32 v123, v182, v183
  buffer_store_dwordx4 v[120:123], v0, s[40:43], s6 offen offset:2048 sc0 sc1
  ds_write_b128 v0, v[120:123] offset:18432
  s_add_u32 s6, s6, 0x20000
  v_pk_fma_f32 v[104:105], v[48:49], v[100:101], v[52:53] op_sel:[0,1,0] op_sel_hi:[1,1,1] neg_lo:[0,1,0] neg_hi:[0,1,0]
  v_pk_fma_f32 v[106:107], v[50:51], v[100:101], v[54:55] op_sel:[0,1,0] op_sel_hi:[1,1,1] neg_lo:[0,1,0] neg_hi:[0,1,0]
  v_pk_fma_f32 v[108:109], v[56:57], v[100:101], v[60:61] op_sel:[0,1,0] op_sel_hi:[1,1,1] neg_lo:[0,1,0] neg_hi:[0,1,0]
  v_pk_fma_f32 v[110:111], v[58:59], v[100:101], v[62:63] op_sel:[0,1,0] op_sel_hi:[1,1,1] neg_lo:[0,1,0] neg_hi:[0,1,0]
  v_pk_fma_f32 v[168:169], v[168:169], v[100:101], v[104:105] op_sel:[0,0,0] op_sel_hi:[1,0,1]
  v_pk_fma_f32 v[170:171], v[170:171], v[100:101], v[106:107] op_sel:[0,0,0] op_sel_hi:[1,0,1]
  v_pk_fma_f32 v[184:185], v[184:185], v[100:101], v[108:109] op_sel:[0,0,0] op_sel_hi:[1,0,1]
  v_pk_fma_f32 v[186:187], v[186:187], v[100:101], v[110:111] op_sel:[0,0,0] op_sel_hi:[1,0,1]
  v_pk_fma_f32 v[104:105], v[168:169], v[168:169], v[4:5] op_sel_hi:[1,1,0]
  v_pk_fma_f32 v[106:107], v[170:171], v[170:171], v[4:5] op_sel_hi:[1,1,0]
  v_pk_fma_f32 v[108:109], v[184:185], v[184:185], v[4:5] op_sel_hi:[1,1,0]
  v_pk_fma_f32 v[110:111], v[186:187], v[186:187], v[4:5] op_sel_hi:[1,1,0]
  v_pk_mul_f32 v[104:105], v[104:105], v[168:169] neg_lo:[0,1] neg_hi:[0,1]
  v_pk_mul_f32 v[106:107], v[106:107], v[170:171] neg_lo:[0,1] neg_hi:[0,1]
  v_pk_mul_f32 v[108:109], v[108:109], v[184:185] neg_lo:[0,1] neg_hi:[0,1]
  v_pk_mul_f32 v[110:111], v[110:111], v[186:187] neg_lo:[0,1] neg_hi:[0,1]
  v_exp_f32 v104, v104
  v_exp_f32 v105, v105
  v_exp_f32 v106, v106
  v_exp_f32 v107, v107
  v_exp_f32 v108, v108
  v_exp_f32 v109, v109
  v_exp_f32 v110, v110
  v_exp_f32 v111, v111
  v_pk_fma_f32 v[104:105], v[104:105], v[4:5], v[4:5] op_sel:[0,1,1] op_sel_hi:[1,1,1]
  v_pk_fma_f32 v[106:107], v[106:107], v[4:5], v[4:5] op_sel:[0,1,1] op_sel_hi:[1,1,1]
  v_pk_fma_f32 v[108:109], v[108:109], v[4:5], v[4:5] op_sel:[0,1,1] op_sel_hi:[1,1,1]
  v_pk_fma_f32 v[110:111], v[110:111], v[4:5], v[4:5] op_sel:[0,1,1] op_sel_hi:[1,1,1]
  v_rcp_f32 v104, v104
  v_rcp_f32 v105, v105
  v_rcp_f32 v106, v106
  v_rcp_f32 v107, v107
  v_rcp_f32 v108, v108
  v_rcp_f32 v109, v109
  v_rcp_f32 v110, v110
  v_rcp_f32 v111, v111
  v_pk_mul_f32 v[168:169], v[168:169], v[104:105]
  v_pk_mul_f32 v[170:171], v[170:171], v[106:107]
  v_pk_mul_f32 v[184:185], v[184:185], v[108:109]
  v_pk_mul_f32 v[186:187], v[186:187], v[110:111]
  v_cvt_pk_bf16_f32 v116, v168, v169
  v_cvt_pk_bf16_f32 v117, v170, v171
  v_cvt_pk_bf16_f32 v118, v184, v185
  v_cvt_pk_bf16_f32 v119, v186, v187
  buffer_store_dwordx4 v[116:119], v0, s[40:43], s7 offen offset:0 sc0 sc1
  ds_write_b128 v0, v[116:119] offset:20480
  v_pk_fma_f32 v[104:105], v[48:49], v[102:103], v[52:53] op_sel:[0,1,0] op_sel_hi:[1,1,1] neg_lo:[0,1,0] neg_hi:[0,1,0]
  v_pk_fma_f32 v[106:107], v[50:51], v[102:103], v[54:55] op_sel:[0,1,0] op_sel_hi:[1,1,1] neg_lo:[0,1,0] neg_hi:[0,1,0]
  v_pk_fma_f32 v[108:109], v[56:57], v[102:103], v[60:61] op_sel:[0,1,0] op_sel_hi:[1,1,1] neg_lo:[0,1,0] neg_hi:[0,1,0]
  v_pk_fma_f32 v[110:111], v[58:59], v[102:103], v[62:63] op_sel:[0,1,0] op_sel_hi:[1,1,1] neg_lo:[0,1,0] neg_hi:[0,1,0]
  v_pk_fma_f32 v[172:173], v[172:173], v[102:103], v[104:105] op_sel:[0,0,0] op_sel_hi:[1,0,1]
  v_pk_fma_f32 v[174:175], v[174:175], v[102:103], v[106:107] op_sel:[0,0,0] op_sel_hi:[1,0,1]
  v_pk_fma_f32 v[188:189], v[188:189], v[102:103], v[108:109] op_sel:[0,0,0] op_sel_hi:[1,0,1]
  v_pk_fma_f32 v[190:191], v[190:191], v[102:103], v[110:111] op_sel:[0,0,0] op_sel_hi:[1,0,1]
  v_pk_fma_f32 v[104:105], v[172:173], v[172:173], v[4:5] op_sel_hi:[1,1,0]
  v_pk_fma_f32 v[106:107], v[174:175], v[174:175], v[4:5] op_sel_hi:[1,1,0]
  v_pk_fma_f32 v[108:109], v[188:189], v[188:189], v[4:5] op_sel_hi:[1,1,0]
  v_pk_fma_f32 v[110:111], v[190:191], v[190:191], v[4:5] op_sel_hi:[1,1,0]
  v_pk_mul_f32 v[104:105], v[104:105], v[172:173] neg_lo:[0,1] neg_hi:[0,1]
  v_pk_mul_f32 v[106:107], v[106:107], v[174:175] neg_lo:[0,1] neg_hi:[0,1]
  v_pk_mul_f32 v[108:109], v[108:109], v[188:189] neg_lo:[0,1] neg_hi:[0,1]
  v_pk_mul_f32 v[110:111], v[110:111], v[190:191] neg_lo:[0,1] neg_hi:[0,1]
  v_exp_f32 v104, v104
  v_exp_f32 v105, v105
  v_exp_f32 v106, v106
  v_exp_f32 v107, v107
  v_exp_f32 v108, v108
  v_exp_f32 v109, v109
  v_exp_f32 v110, v110
  v_exp_f32 v111, v111
  v_pk_fma_f32 v[104:105], v[104:105], v[4:5], v[4:5] op_sel:[0,1,1] op_sel_hi:[1,1,1]
  v_pk_fma_f32 v[106:107], v[106:107], v[4:5], v[4:5] op_sel:[0,1,1] op_sel_hi:[1,1,1]
  v_pk_fma_f32 v[108:109], v[108:109], v[4:5], v[4:5] op_sel:[0,1,1] op_sel_hi:[1,1,1]
  v_pk_fma_f32 v[110:111], v[110:111], v[4:5], v[4:5] op_sel:[0,1,1] op_sel_hi:[1,1,1]
  v_rcp_f32 v104, v104
  v_rcp_f32 v105, v105
  v_rcp_f32 v106, v106
  v_rcp_f32 v107, v107
  v_rcp_f32 v108, v108
  v_rcp_f32 v109, v109
  v_rcp_f32 v110, v110
  v_rcp_f32 v111, v111
  v_pk_mul_f32 v[172:173], v[172:173], v[104:105]
  v_pk_mul_f32 v[174:175], v[174:175], v[106:107]
  v_pk_mul_f32 v[188:189], v[188:189], v[108:109]
  v_pk_mul_f32 v[190:191], v[190:191], v[110:111]
  v_cvt_pk_bf16_f32 v120, v172, v173
  v_cvt_pk_bf16_f32 v121, v174, v175
  v_cvt_pk_bf16_f32 v122, v188, v189
  v_cvt_pk_bf16_f32 v123, v190, v191
  buffer_store_dwordx4 v[120:123], v0, s[40:43], s7 offen offset:2048 sc0 sc1
  ds_write_b128 v0, v[120:123] offset:22528
  s_add_u32 s7, s7, 0x20000
  v_pk_fma_f32 v[104:105], v[64:65], v[96:97], v[68:69] op_sel:[0,1,0] op_sel_hi:[1,1,1] neg_lo:[0,1,0] neg_hi:[0,1,0]
  v_pk_fma_f32 v[106:107], v[66:67], v[96:97], v[70:71] op_sel:[0,1,0] op_sel_hi:[1,1,1] neg_lo:[0,1,0] neg_hi:[0,1,0]
  v_pk_fma_f32 v[108:109], v[72:73], v[96:97], v[76:77] op_sel:[0,1,0] op_sel_hi:[1,1,1] neg_lo:[0,1,0] neg_hi:[0,1,0]
  v_pk_fma_f32 v[110:111], v[74:75], v[96:97], v[78:79] op_sel:[0,1,0] op_sel_hi:[1,1,1] neg_lo:[0,1,0] neg_hi:[0,1,0]
  v_pk_fma_f32 v[192:193], v[192:193], v[96:97], v[104:105] op_sel:[0,0,0] op_sel_hi:[1,0,1]
  v_pk_fma_f32 v[194:195], v[194:195], v[96:97], v[106:107] op_sel:[0,0,0] op_sel_hi:[1,0,1]
  v_pk_fma_f32 v[208:209], v[208:209], v[96:97], v[108:109] op_sel:[0,0,0] op_sel_hi:[1,0,1]
  v_pk_fma_f32 v[210:211], v[210:211], v[96:97], v[110:111] op_sel:[0,0,0] op_sel_hi:[1,0,1]
  v_pk_fma_f32 v[104:105], v[192:193], v[192:193], v[4:5] op_sel_hi:[1,1,0]
  v_pk_fma_f32 v[106:107], v[194:195], v[194:195], v[4:5] op_sel_hi:[1,1,0]
  v_pk_fma_f32 v[108:109], v[208:209], v[208:209], v[4:5] op_sel_hi:[1,1,0]
  v_pk_fma_f32 v[110:111], v[210:211], v[210:211], v[4:5] op_sel_hi:[1,1,0]
  v_pk_mul_f32 v[104:105], v[104:105], v[192:193] neg_lo:[0,1] neg_hi:[0,1]
  v_pk_mul_f32 v[106:107], v[106:107], v[194:195] neg_lo:[0,1] neg_hi:[0,1]
  v_pk_mul_f32 v[108:109], v[108:109], v[208:209] neg_lo:[0,1] neg_hi:[0,1]
  v_pk_mul_f32 v[110:111], v[110:111], v[210:211] neg_lo:[0,1] neg_hi:[0,1]
  v_exp_f32 v104, v104
  v_exp_f32 v105, v105
  v_exp_f32 v106, v106
  v_exp_f32 v107, v107
  v_exp_f32 v108, v108
  v_exp_f32 v109, v109
  v_exp_f32 v110, v110
  v_exp_f32 v111, v111
  v_pk_fma_f32 v[104:105], v[104:105], v[4:5], v[4:5] op_sel:[0,1,1] op_sel_hi:[1,1,1]
  v_pk_fma_f32 v[106:107], v[106:107], v[4:5], v[4:5] op_sel:[0,1,1] op_sel_hi:[1,1,1]
  v_pk_fma_f32 v[108:109], v[108:109], v[4:5], v[4:5] op_sel:[0,1,1] op_sel_hi:[1,1,1]
  v_pk_fma_f32 v[110:111], v[110:111], v[4:5], v[4:5] op_sel:[0,1,1] op_sel_hi:[1,1,1]
  v_rcp_f32 v104, v104
  v_rcp_f32 v105, v105
  v_rcp_f32 v106, v106
  v_rcp_f32 v107, v107
  v_rcp_f32 v108, v108
  v_rcp_f32 v109, v109
  v_rcp_f32 v110, v110
  v_rcp_f32 v111, v111
  v_pk_mul_f32 v[192:193], v[192:193], v[104:105]
  v_pk_mul_f32 v[194:195], v[194:195], v[106:107]
  v_pk_mul_f32 v[208:209], v[208:209], v[108:109]
  v_pk_mul_f32 v[210:211], v[210:211], v[110:111]
  v_cvt_pk_bf16_f32 v116, v192, v193
  v_cvt_pk_bf16_f32 v117, v194, v195
  v_cvt_pk_bf16_f32 v118, v208, v209
  v_cvt_pk_bf16_f32 v119, v210, v211
  buffer_store_dwordx4 v[116:119], v0, s[40:43], s6 offen offset:0 sc0 sc1
  ds_write_b128 v0, v[116:119] offset:32768
  v_pk_fma_f32 v[104:105], v[64:65], v[98:99], v[68:69] op_sel:[0,1,0] op_sel_hi:[1,1,1] neg_lo:[0,1,0] neg_hi:[0,1,0]
  v_pk_fma_f32 v[106:107], v[66:67], v[98:99], v[70:71] op_sel:[0,1,0] op_sel_hi:[1,1,1] neg_lo:[0,1,0] neg_hi:[0,1,0]
  v_pk_fma_f32 v[108:109], v[72:73], v[98:99], v[76:77] op_sel:[0,1,0] op_sel_hi:[1,1,1] neg_lo:[0,1,0] neg_hi:[0,1,0]
  v_pk_fma_f32 v[110:111], v[74:75], v[98:99], v[78:79] op_sel:[0,1,0] op_sel_hi:[1,1,1] neg_lo:[0,1,0] neg_hi:[0,1,0]
  v_pk_fma_f32 v[196:197], v[196:197], v[98:99], v[104:105] op_sel:[0,0,0] op_sel_hi:[1,0,1]
  v_pk_fma_f32 v[198:199], v[198:199], v[98:99], v[106:107] op_sel:[0,0,0] op_sel_hi:[1,0,1]
  v_pk_fma_f32 v[212:213], v[212:213], v[98:99], v[108:109] op_sel:[0,0,0] op_sel_hi:[1,0,1]
  v_pk_fma_f32 v[214:215], v[214:215], v[98:99], v[110:111] op_sel:[0,0,0] op_sel_hi:[1,0,1]
  v_pk_fma_f32 v[104:105], v[196:197], v[196:197], v[4:5] op_sel_hi:[1,1,0]
  v_pk_fma_f32 v[106:107], v[198:199], v[198:199], v[4:5] op_sel_hi:[1,1,0]
  v_pk_fma_f32 v[108:109], v[212:213], v[212:213], v[4:5] op_sel_hi:[1,1,0]
  v_pk_fma_f32 v[110:111], v[214:215], v[214:215], v[4:5] op_sel_hi:[1,1,0]
  v_pk_mul_f32 v[104:105], v[104:105], v[196:197] neg_lo:[0,1] neg_hi:[0,1]
  v_pk_mul_f32 v[106:107], v[106:107], v[198:199] neg_lo:[0,1] neg_hi:[0,1]
  v_pk_mul_f32 v[108:109], v[108:109], v[212:213] neg_lo:[0,1] neg_hi:[0,1]
  v_pk_mul_f32 v[110:111], v[110:111], v[214:215] neg_lo:[0,1] neg_hi:[0,1]
  v_exp_f32 v104, v104
  v_exp_f32 v105, v105
  v_exp_f32 v106, v106
  v_exp_f32 v107, v107
  v_exp_f32 v108, v108
  v_exp_f32 v109, v109
  v_exp_f32 v110, v110
  v_exp_f32 v111, v111
  v_pk_fma_f32 v[104:105], v[104:105], v[4:5], v[4:5] op_sel:[0,1,1] op_sel_hi:[1,1,1]
  v_pk_fma_f32 v[106:107], v[106:107], v[4:5], v[4:5] op_sel:[0,1,1] op_sel_hi:[1,1,1]
  v_pk_fma_f32 v[108:109], v[108:109], v[4:5], v[4:5] op_sel:[0,1,1] op_sel_hi:[1,1,1]
  v_pk_fma_f32 v[110:111], v[110:111], v[4:5], v[4:5] op_sel:[0,1,1] op_sel_hi:[1,1,1]
  v_rcp_f32 v104, v104
  v_rcp_f32 v105, v105
  v_rcp_f32 v106, v106
  v_rcp_f32 v107, v107
  v_rcp_f32 v108, v108
  v_rcp_f32 v109, v109
  v_rcp_f32 v110, v110
  v_rcp_f32 v111, v111
  v_pk_mul_f32 v[196:197], v[196:197], v[104:105]
  v_pk_mul_f32 v[198:199], v[198:199], v[106:107]
  v_pk_mul_f32 v[212:213], v[212:213], v[108:109]
  v_pk_mul_f32 v[214:215], v[214:215], v[110:111]
  v_cvt_pk_bf16_f32 v120, v196, v197
  v_cvt_pk_bf16_f32 v121, v198, v199
  v_cvt_pk_bf16_f32 v122, v212, v213
  v_cvt_pk_bf16_f32 v123, v214, v215
  buffer_store_dwordx4 v[120:123], v0, s[40:43], s6 offen offset:2048 sc0 sc1
  ds_write_b128 v0, v[120:123] offset:34816
  v_pk_fma_f32 v[104:105], v[64:65], v[100:101], v[68:69] op_sel:[0,1,0] op_sel_hi:[1,1,1] neg_lo:[0,1,0] neg_hi:[0,1,0]
  v_pk_fma_f32 v[106:107], v[66:67], v[100:101], v[70:71] op_sel:[0,1,0] op_sel_hi:[1,1,1] neg_lo:[0,1,0] neg_hi:[0,1,0]
  v_pk_fma_f32 v[108:109], v[72:73], v[100:101], v[76:77] op_sel:[0,1,0] op_sel_hi:[1,1,1] neg_lo:[0,1,0] neg_hi:[0,1,0]
  v_pk_fma_f32 v[110:111], v[74:75], v[100:101], v[78:79] op_sel:[0,1,0] op_sel_hi:[1,1,1] neg_lo:[0,1,0] neg_hi:[0,1,0]
  v_pk_fma_f32 v[200:201], v[200:201], v[100:101], v[104:105] op_sel:[0,0,0] op_sel_hi:[1,0,1]
  v_pk_fma_f32 v[202:203], v[202:203], v[100:101], v[106:107] op_sel:[0,0,0] op_sel_hi:[1,0,1]
  v_pk_fma_f32 v[216:217], v[216:217], v[100:101], v[108:109] op_sel:[0,0,0] op_sel_hi:[1,0,1]
  v_pk_fma_f32 v[218:219], v[218:219], v[100:101], v[110:111] op_sel:[0,0,0] op_sel_hi:[1,0,1]
  v_pk_fma_f32 v[104:105], v[200:201], v[200:201], v[4:5] op_sel_hi:[1,1,0]
  v_pk_fma_f32 v[106:107], v[202:203], v[202:203], v[4:5] op_sel_hi:[1,1,0]
  v_pk_fma_f32 v[108:109], v[216:217], v[216:217], v[4:5] op_sel_hi:[1,1,0]
  v_pk_fma_f32 v[110:111], v[218:219], v[218:219], v[4:5] op_sel_hi:[1,1,0]
  v_pk_mul_f32 v[104:105], v[104:105], v[200:201] neg_lo:[0,1] neg_hi:[0,1]
  v_pk_mul_f32 v[106:107], v[106:107], v[202:203] neg_lo:[0,1] neg_hi:[0,1]
  v_pk_mul_f32 v[108:109], v[108:109], v[216:217] neg_lo:[0,1] neg_hi:[0,1]
  v_pk_mul_f32 v[110:111], v[110:111], v[218:219] neg_lo:[0,1] neg_hi:[0,1]
  v_exp_f32 v104, v104
  v_exp_f32 v105, v105
  v_exp_f32 v106, v106
  v_exp_f32 v107, v107
  v_exp_f32 v108, v108
  v_exp_f32 v109, v109
  v_exp_f32 v110, v110
  v_exp_f32 v111, v111
  v_pk_fma_f32 v[104:105], v[104:105], v[4:5], v[4:5] op_sel:[0,1,1] op_sel_hi:[1,1,1]
  v_pk_fma_f32 v[106:107], v[106:107], v[4:5], v[4:5] op_sel:[0,1,1] op_sel_hi:[1,1,1]
  v_pk_fma_f32 v[108:109], v[108:109], v[4:5], v[4:5] op_sel:[0,1,1] op_sel_hi:[1,1,1]
  v_pk_fma_f32 v[110:111], v[110:111], v[4:5], v[4:5] op_sel:[0,1,1] op_sel_hi:[1,1,1]
  v_rcp_f32 v104, v104
  v_rcp_f32 v105, v105
  v_rcp_f32 v106, v106
  v_rcp_f32 v107, v107
  v_rcp_f32 v108, v108
  v_rcp_f32 v109, v109
  v_rcp_f32 v110, v110
  v_rcp_f32 v111, v111
  v_pk_mul_f32 v[200:201], v[200:201], v[104:105]
  v_pk_mul_f32 v[202:203], v[202:203], v[106:107]
  v_pk_mul_f32 v[216:217], v[216:217], v[108:109]
  v_pk_mul_f32 v[218:219], v[218:219], v[110:111]
  v_cvt_pk_bf16_f32 v116, v200, v201
  v_cvt_pk_bf16_f32 v117, v202, v203
  v_cvt_pk_bf16_f32 v118, v216, v217
  v_cvt_pk_bf16_f32 v119, v218, v219
  buffer_store_dwordx4 v[116:119], v0, s[40:43], s7 offen offset:0 sc0 sc1
  ds_write_b128 v0, v[116:119] offset:36864
  v_pk_fma_f32 v[104:105], v[64:65], v[102:103], v[68:69] op_sel:[0,1,0] op_sel_hi:[1,1,1] neg_lo:[0,1,0] neg_hi:[0,1,0]
  v_pk_fma_f32 v[106:107], v[66:67], v[102:103], v[70:71] op_sel:[0,1,0] op_sel_hi:[1,1,1] neg_lo:[0,1,0] neg_hi:[0,1,0]
  v_pk_fma_f32 v[108:109], v[72:73], v[102:103], v[76:77] op_sel:[0,1,0] op_sel_hi:[1,1,1] neg_lo:[0,1,0] neg_hi:[0,1,0]
  v_pk_fma_f32 v[110:111], v[74:75], v[102:103], v[78:79] op_sel:[0,1,0] op_sel_hi:[1,1,1] neg_lo:[0,1,0] neg_hi:[0,1,0]
  v_pk_fma_f32 v[204:205], v[204:205], v[102:103], v[104:105] op_sel:[0,0,0] op_sel_hi:[1,0,1]
  v_pk_fma_f32 v[206:207], v[206:207], v[102:103], v[106:107] op_sel:[0,0,0] op_sel_hi:[1,0,1]
  v_pk_fma_f32 v[220:221], v[220:221], v[102:103], v[108:109] op_sel:[0,0,0] op_sel_hi:[1,0,1]
  v_pk_fma_f32 v[222:223], v[222:223], v[102:103], v[110:111] op_sel:[0,0,0] op_sel_hi:[1,0,1]
  v_pk_fma_f32 v[104:105], v[204:205], v[204:205], v[4:5] op_sel_hi:[1,1,0]
  v_pk_fma_f32 v[106:107], v[206:207], v[206:207], v[4:5] op_sel_hi:[1,1,0]
  v_pk_fma_f32 v[108:109], v[220:221], v[220:221], v[4:5] op_sel_hi:[1,1,0]
  v_pk_fma_f32 v[110:111], v[222:223], v[222:223], v[4:5] op_sel_hi:[1,1,0]
  v_pk_mul_f32 v[104:105], v[104:105], v[204:205] neg_lo:[0,1] neg_hi:[0,1]
  v_pk_mul_f32 v[106:107], v[106:107], v[206:207] neg_lo:[0,1] neg_hi:[0,1]
  v_pk_mul_f32 v[108:109], v[108:109], v[220:221] neg_lo:[0,1] neg_hi:[0,1]
  v_pk_mul_f32 v[110:111], v[110:111], v[222:223] neg_lo:[0,1] neg_hi:[0,1]
  v_exp_f32 v104, v104
  v_exp_f32 v105, v105
  v_exp_f32 v106, v106
  v_exp_f32 v107, v107
  v_exp_f32 v108, v108
  v_exp_f32 v109, v109
  v_exp_f32 v110, v110
  v_exp_f32 v111, v111
  v_pk_fma_f32 v[104:105], v[104:105], v[4:5], v[4:5] op_sel:[0,1,1] op_sel_hi:[1,1,1]
  v_pk_fma_f32 v[106:107], v[106:107], v[4:5], v[4:5] op_sel:[0,1,1] op_sel_hi:[1,1,1]
  v_pk_fma_f32 v[108:109], v[108:109], v[4:5], v[4:5] op_sel:[0,1,1] op_sel_hi:[1,1,1]
  v_pk_fma_f32 v[110:111], v[110:111], v[4:5], v[4:5] op_sel:[0,1,1] op_sel_hi:[1,1,1]
  v_rcp_f32 v104, v104
  v_rcp_f32 v105, v105
  v_rcp_f32 v106, v106
  v_rcp_f32 v107, v107
  v_rcp_f32 v108, v108
  v_rcp_f32 v109, v109
  v_rcp_f32 v110, v110
  v_rcp_f32 v111, v111
  v_pk_mul_f32 v[204:205], v[204:205], v[104:105]
  v_pk_mul_f32 v[206:207], v[206:207], v[106:107]
  v_pk_mul_f32 v[220:221], v[220:221], v[108:109]
  v_pk_mul_f32 v[222:223], v[222:223], v[110:111]
  v_cvt_pk_bf16_f32 v120, v204, v205
  v_cvt_pk_bf16_f32 v121, v206, v207
  v_cvt_pk_bf16_f32 v122, v220, v221
  v_cvt_pk_bf16_f32 v123, v222, v223
  buffer_store_dwordx4 v[120:123], v0, s[40:43], s7 offen offset:2048 sc0 sc1
  ds_write_b128 v0, v[120:123] offset:38912
  s_mov_b32 s16, Lz1-Lz0+0
  s_mov_b32 s17, 16384
  s_mov_b32 s18, 0xffff4000
  s_mov_b32 s19, 49152
  s_mov_b32 s20, 16384
  s_mov_b32 s21, 0xffff0000
  s_mul_i32 s4, s85, 8192
  v_add_u32_e64 v4, s4, v11
  v_add_u32 v5, 1024, v4
  s_lshl_b32 s4, s86, 1
  v_xor_b32 v2, s4, v26
  v_lshl_add_u32 v6, v2, 5, v25
  v_add_u32 v6, s19, v6
  s_add_u32 s4, s4, 1
  v_xor_b32_e64 v2, s4, v26
  v_lshl_add_u32 v7, v2, 5, v25
  v_add_u32_e64 v7, s19, v7
  s_mov_b32 s4, 0xffff0000
  v_lshlrev_b32 v128, 16, v240
  v_and_b32 v129, s4, v240
  v_lshlrev_b32 v130, 16, v241
  v_and_b32 v131, s4, v241
  v_lshlrev_b32 v132, 16, v242
  v_and_b32 v133, s4, v242
  v_lshlrev_b32 v134, 16, v243
  v_and_b32 v135, s4, v243
  v_lshlrev_b32 v136, 16, v244
  v_and_b32 v137, s4, v244
  v_lshlrev_b32 v138, 16, v245
  v_and_b32 v139, s4, v245
  v_lshlrev_b32 v140, 16, v246
  v_and_b32 v141, s4, v246
  v_lshlrev_b32 v142, 16, v247
  v_and_b32 v143, s4, v247
  v_lshlrev_b32 v144, 16, v248
  v_and_b32 v145, s4, v248
  v_lshlrev_b32 v146, 16, v249
  v_and_b32 v147, s4, v249
  v_lshlrev_b32 v148, 16, v250
  v_and_b32 v149, s4, v250
  v_lshlrev_b32 v150, 16, v251
  v_and_b32 v151, s4, v251
  v_lshlrev_b32 v152, 16, v252
  v_and_b32 v153, s4, v252
  v_lshlrev_b32 v154, 16, v253
  v_and_b32 v155, s4, v253
  v_lshlrev_b32 v156, 16, v254
  v_and_b32 v157, s4, v254
  v_lshlrev_b32 v158, 16, v255
  v_and_b32 v159, s4, v255
  s_lshl_b32 s5, s86, Lz1-Lz0+7
  s_add_u32 s5, s5, 156160
  v_add_u32_e64 v3, s5, v29
  ds_read_b128 v[32:35], v3
  ds_read_b128 v[36:39], v3 offset:64
  v_mov_b64 v[160:161], 0
  v_mov_b64 v[162:163], 0
  v_mov_b64 v[164:165], 0
  v_mov_b64 v[166:167], 0
  v_mov_b64 v[168:169], 0
  v_mov_b64 v[170:171], 0
  v_mov_b64 v[172:173], 0
  v_mov_b64 v[174:175], 0
  v_mov_b64 v[176:177], 0
  v_mov_b64 v[178:179], 0
  v_mov_b64 v[180:181], 0
  v_mov_b64 v[182:183], 0
  v_mov_b64 v[184:185], 0
  v_mov_b64 v[186:187], 0
  v_mov_b64_e64 v[188:189], 0
  v_mov_b64 v[190:191], 0
  s_waitcnt lgkmcnt(0)
  v_pk_add_f32 v[128:129], v[128:129], v[32:33]
  v_pk_add_f32 v[130:131], v[130:131], v[34:35]
  v_pk_add_f32 v[132:133], v[132:133], v[36:37]
  v_pk_add_f32 v[134:135], v[134:135], v[38:39]
  v_pk_add_f32 v[136:137], v[136:137], v[32:33]
  v_pk_add_f32 v[138:139], v[138:139], v[34:35]
  v_pk_add_f32 v[140:141], v[140:141], v[36:37]
  v_pk_add_f32 v[142:143], v[142:143], v[38:39]
  v_pk_add_f32 v[144:145], v[144:145], v[32:33]
  v_pk_add_f32 v[146:147], v[146:147], v[34:35]
  v_pk_add_f32 v[148:149], v[148:149], v[36:37]
  v_pk_add_f32 v[150:151], v[150:151], v[38:39]
  v_pk_add_f32 v[152:153], v[152:153], v[32:33]
  v_pk_add_f32 v[154:155], v[154:155], v[34:35]
  v_pk_add_f32 v[156:157], v[156:157], v[36:37]
  v_pk_add_f32 v[158:159], v[158:159], v[38:39]
  s_lshl_b32 s4, s76, 4
  s_add_u32 s4, s4, s78
  s_lshl_b32 s8, s4, Lz1-Lz0+14
  s_xor_b32 s6, s8, 16384
  s_add_u32 s8, s8, 7340032
  s_add_u32 s6, s6, 7340032
  s_add_u32 s7, s6, 4096
  s_add_u32 s9, s8, 4096
  s_lshl_b32 s4, s81, 7
  s_add_u32 s4, s4, s87
  s_add_u32 s4, s4, 12
  s_lshl_b32 s13, s84, 1
  s_xor_b32 s14, s13, 32768
  s_add_u32 s13, s13, s4
  s_add_u32 s14, s14, s4
  s_mov_b32 s22, 12
  s_barrier
  ds_read_b64_tr_b16 v[48:49], v6 offset:0
  ds_read_b64_tr_b16 v[50:51], v6 offset:2048
  ds_read_b128 v[32:35], v4 offset:0
  ds_read_b128 v[36:39], v4 offset:2048
  ds_read_b128 v[40:43], v4 offset:4096
  ds_read_b128 v[44:47], v4 offset:6144
  ds_read_b64_tr_b16 v[52:53], v7 offset:0
  ds_read_b64_tr_b16 v[54:55], v7 offset:2048
  ds_read_b64_tr_b16 v[56:57], v6 offset:8192
  ds_read_b64_tr_b16 v[58:59], v6 offset:10240
  ds_read_b64_tr_b16 v[60:61], v7 offset:8192
  ds_read_b64_tr_b16 v[62:63], v7 offset:10240
  ds_read_b64_tr_b16 v[80:81], v6 offset:4096
  s_nop 0
  s_waitcnt lgkmcnt(4)
  ds_read_b64_tr_b16 v[82:83], v6 offset:6144
  ds_read_b128 v[64:67], v5 offset:0
  ds_read_b128 v[68:71], v5 offset:2048
  ds_read_b128 v[72:75], v5 offset:4096
  ds_read_b128 v[76:79], v5 offset:6144
  ds_read_b64_tr_b16 v[84:85], v7 offset:4096
  ds_read_b64_tr_b16 v[86:87], v7 offset:6144
  ds_read_b64_tr_b16 v[88:89], v6 offset:12288
  ds_read_b64_tr_b16 v[90:91], v6 offset:14336
  ds_read_b64_tr_b16 v[92:93], v7 offset:12288
  ds_read_b64_tr_b16 v[94:95], v7 offset:14336
  s_add_u32 s16, s16, s17
  s_cmp_eq_u32 s16, 65536
  s_cselect_b32 s23, s18, s17
  s_cselect_b32 s16, 0, s16
  v_add_u32 v4, s23, v4
  v_add_u32 v5, s23, v5
  s_add_u32 s19, s19, s20
  s_cmp_eq_u32 s19, 81920
  s_cselect_b32 s23, s21, s20
  s_cselect_b32 s19, 0, s19
  v_add_u32 v6, s23, v6
  v_add_u32 v7, s23, v7
  s_waitcnt lgkmcnt(0)
Lk_28:
  s_barrier
  v_mfma_f32_16x16x32_bf16 v[128:131], v[48:51], v[32:35], v[128:131]
  ds_read_b64_tr_b16 v[112:113], v6 offset:0
  v_mfma_f32_16x16x32_bf16 v[128:131], v[80:83], v[64:67], v[128:131]
  ds_read_b64_tr_b16 v[114:115], v6 offset:2048
  v_mfma_f32_16x16x32_bf16 v[136:139], v[80:83], v[68:71], v[136:139]
  ds_read_b128 v[96:99], v4 offset:0
  v_mfma_f32_16x16x32_bf16 v[136:139], v[48:51], v[36:39], v[136:139]
  ds_read_b128 v[100:103], v4 offset:2048
  v_mfma_f32_16x16x32_bf16 v[144:147], v[48:51], v[40:43], v[144:147]
  ds_read_b128 v[104:107], v4 offset:4096
  v_mfma_f32_16x16x32_bf16 v[144:147], v[80:83], v[72:75], v[144:147]
  ds_read_b128 v[108:111], v4 offset:6144
  v_mfma_f32_16x16x32_bf16 v[152:155], v[80:83], v[76:79], v[152:155]
  ds_read_b64_tr_b16 v[116:117], v7 offset:0
  v_mfma_f32_16x16x32_bf16 v[152:155], v[48:51], v[44:47], v[152:155]
  ds_read_b64_tr_b16 v[118:119], v7 offset:2048
  v_mfma_f32_16x16x32_bf16 v[156:159], v[52:55], v[44:47], v[156:159]
  ds_read_b64_tr_b16 v[120:121], v6 offset:8192
  v_mfma_f32_16x16x32_bf16 v[156:159], v[84:87], v[76:79], v[156:159]
  ds_read_b64_tr_b16 v[122:123], v6 offset:10240
  v_mfma_f32_16x16x32_bf16 v[148:151], v[84:87], v[72:75], v[148:151]
  ds_read_b64_tr_b16 v[124:125], v7 offset:8192
  v_mfma_f32_16x16x32_bf16 v[148:151], v[52:55], v[40:43], v[148:151]
  ds_read_b64_tr_b16 v[126:127], v7 offset:10240
  v_mfma_f32_16x16x32_bf16 v[140:143], v[52:55], v[36:39], v[140:143]
  ds_read_b64_tr_b16 v[208:209], v6 offset:4096
  v_mfma_f32_16x16x32_bf16 v[140:143], v[84:87], v[68:71], v[140:143]
  ds_read_b64_tr_b16 v[210:211], v6 offset:6144
  v_mfma_f32_16x16x32_bf16 v[132:135], v[84:87], v[64:67], v[132:135]
  ds_read_b128 v[192:195], v5 offset:0
  v_mfma_f32_16x16x32_bf16 v[132:135], v[52:55], v[32:35], v[132:135]
  ds_read_b128 v[196:199], v5 offset:2048
  v_mfma_f32_16x16x32_bf16 v[160:163], v[56:59], v[32:35], v[160:163]
  ds_read_b128 v[200:203], v5 offset:4096
  v_mfma_f32_16x16x32_bf16 v[160:163], v[88:91], v[64:67], v[160:163]
  ds_read_b128 v[204:207], v5 offset:6144
  v_mfma_f32_16x16x32_bf16 v[168:171], v[88:91], v[68:71], v[168:171]
  ds_read_b64_tr_b16 v[212:213], v7 offset:4096
  v_mfma_f32_16x16x32_bf16 v[168:171], v[56:59], v[36:39], v[168:171]
  ds_read_b64_tr_b16 v[214:215], v7 offset:6144
  v_mfma_f32_16x16x32_bf16 v[176:179], v[56:59], v[40:43], v[176:179]
  ds_read_b64_tr_b16 v[216:217], v6 offset:12288
  v_mfma_f32_16x16x32_bf16 v[176:179], v[88:91], v[72:75], v[176:179]
  ds_read_b64_tr_b16 v[218:219], v6 offset:14336
  v_mfma_f32_16x16x32_bf16 v[184:187], v[88:91], v[76:79], v[184:187]
  ds_read_b64_tr_b16 v[220:221], v7 offset:12288
  v_mfma_f32_16x16x32_bf16 v[184:187], v[56:59], v[44:47], v[184:187]
  ds_read_b64_tr_b16 v[222:223], v7 offset:14336
  v_mfma_f32_16x16x32_bf16 v[188:191], v[60:63], v[44:47], v[188:191]
  s_add_u32 s16, s16, s17
  s_cmp_eq_u32 s16, 65536
  s_cselect_b32 s23, s18, s17
  v_mfma_f32_16x16x32_bf16 v[188:191], v[92:95], v[76:79], v[188:191]
  s_cselect_b32 s16, 0, s16
  v_add_u32 v4, s23, v4
  v_add_u32_e64 v5, s23, v5
  v_mfma_f32_16x16x32_bf16 v[180:183], v[92:95], v[72:75], v[180:183]
  s_add_u32 s19, s19, s20
  s_cmp_eq_u32 s19, 81920
  s_cselect_b32 s23, s21, s20
  v_mfma_f32_16x16x32_bf16 v[180:183], v[60:63], v[40:43], v[180:183]
  s_cselect_b32 s19, 0, s19
  v_add_u32 v6, s23, v6
  v_add_u32_e64 v7, s23, v7
  v_mfma_f32_16x16x32_bf16 v[172:175], v[60:63], v[36:39], v[172:175]
  v_mfma_f32_16x16x32_bf16 v[172:175], v[92:95], v[68:71], v[172:175]
  v_mfma_f32_16x16x32_bf16 v[164:167], v[92:95], v[64:67], v[164:167]
  s_nop 0
  s_waitcnt lgkmcnt(0)
  v_mfma_f32_16x16x32_bf16 v[164:167], v[60:63], v[32:35], v[164:167]
  s_waitcnt vmcnt(0)
  s_barrier
  v_mfma_f32_16x16x32_bf16 v[128:131], v[112:115], v[96:99], v[128:131]
  ds_read_b64_tr_b16 v[48:49], v6 offset:0
  v_mfma_f32_16x16x32_bf16 v[128:131], v[208:211], v[192:195], v[128:131]
  ds_read_b64_tr_b16 v[50:51], v6 offset:2048
  v_mfma_f32_16x16x32_bf16 v[136:139], v[208:211], v[196:199], v[136:139]
  ds_read_b128 v[32:35], v4 offset:0
  v_mfma_f32_16x16x32_bf16 v[136:139], v[112:115], v[100:103], v[136:139]
  ds_read_b128 v[36:39], v4 offset:2048
  v_mfma_f32_16x16x32_bf16 v[144:147], v[112:115], v[104:107], v[144:147]
  ds_read_b128 v[40:43], v4 offset:4096
  v_mfma_f32_16x16x32_bf16 v[144:147], v[208:211], v[200:203], v[144:147]
  ds_read_b128 v[44:47], v4 offset:6144
  v_mfma_f32_16x16x32_bf16 v[152:155], v[208:211], v[204:207], v[152:155]
  ds_read_b64_tr_b16 v[52:53], v7 offset:0
  v_mfma_f32_16x16x32_bf16 v[152:155], v[112:115], v[108:111], v[152:155]
  ds_read_b64_tr_b16 v[54:55], v7 offset:2048
  v_mfma_f32_16x16x32_bf16 v[156:159], v[116:119], v[108:111], v[156:159]
  ds_read_b64_tr_b16 v[56:57], v6 offset:8192
  v_mfma_f32_16x16x32_bf16 v[156:159], v[212:215], v[204:207], v[156:159]
  ds_read_b64_tr_b16 v[58:59], v6 offset:10240
  v_mfma_f32_16x16x32_bf16 v[148:151], v[212:215], v[200:203], v[148:151]
  ds_read_b64_tr_b16 v[60:61], v7 offset:8192
  v_mfma_f32_16x16x32_bf16 v[148:151], v[116:119], v[104:107], v[148:151]
  ds_read_b64_tr_b16 v[62:63], v7 offset:10240
  v_mfma_f32_16x16x32_bf16 v[140:143], v[116:119], v[100:103], v[140:143]
  ds_read_b64_tr_b16 v[80:81], v6 offset:4096
  v_mfma_f32_16x16x32_bf16 v[140:143], v[212:215], v[196:199], v[140:143]
  ds_read_b64_tr_b16 v[82:83], v6 offset:6144
  v_mfma_f32_16x16x32_bf16 v[132:135], v[212:215], v[192:195], v[132:135]
  ds_read_b128 v[64:67], v5 offset:0
  v_mfma_f32_16x16x32_bf16 v[132:135], v[116:119], v[96:99], v[132:135]
  ds_read_b128 v[68:71], v5 offset:2048
  v_mfma_f32_16x16x32_bf16 v[160:163], v[120:123], v[96:99], v[160:163]
  ds_read_b128 v[72:75], v5 offset:4096
  v_mfma_f32_16x16x32_bf16 v[160:163], v[216:219], v[192:195], v[160:163]
  ds_read_b128 v[76:79], v5 offset:6144
  v_mfma_f32_16x16x32_bf16 v[168:171], v[216:219], v[196:199], v[168:171]
  ds_read_b64_tr_b16 v[84:85], v7 offset:4096
  v_mfma_f32_16x16x32_bf16 v[168:171], v[120:123], v[100:103], v[168:171]
  ds_read_b64_tr_b16 v[86:87], v7 offset:6144
  v_mfma_f32_16x16x32_bf16 v[176:179], v[120:123], v[104:107], v[176:179]
  ds_read_b64_tr_b16 v[88:89], v6 offset:12288
  v_mfma_f32_16x16x32_bf16 v[176:179], v[216:219], v[200:203], v[176:179]
  ds_read_b64_tr_b16 v[90:91], v6 offset:14336
  v_mfma_f32_16x16x32_bf16 v[184:187], v[216:219], v[204:207], v[184:187]
  ds_read_b64_tr_b16 v[92:93], v7 offset:12288
  v_mfma_f32_16x16x32_bf16 v[184:187], v[120:123], v[108:111], v[184:187]
  ds_read_b64_tr_b16 v[94:95], v7 offset:14336
  v_mfma_f32_16x16x32_bf16 v[188:191], v[124:127], v[108:111], v[188:191]
  s_add_u32 s16, s16, s17
  s_cmp_eq_u32 s16, 65536
  s_cselect_b32 s23, s18, s17
  v_mfma_f32_16x16x32_bf16 v[188:191], v[220:223], v[204:207], v[188:191]
  s_cselect_b32 s16, 0, s16
  v_add_u32 v4, s23, v4
  v_add_u32_e64 v5, s23, v5
  v_mfma_f32_16x16x32_bf16 v[180:183], v[220:223], v[200:203], v[180:183]
  s_add_u32 s19, s19, s20
  s_cmp_eq_u32 s19, 81920
  s_cselect_b32 s23, s21, s20
  v_mfma_f32_16x16x32_bf16 v[180:183], v[124:127], v[104:107], v[180:183]
  s_cselect_b32 s19, 0, s19
  v_add_u32 v6, s23, v6
  v_add_u32_e64 v7, s23, v7
  v_mfma_f32_16x16x32_bf16 v[172:175], v[124:127], v[100:103], v[172:175]
  s_sub_u32 s22, s22, 1
  s_cmp_lg_u32 s22, 0
  v_mfma_f32_16x16x32_bf16 v[172:175], v[220:223], v[196:199], v[172:175]
  v_mfma_f32_16x16x32_bf16 v[164:167], v[220:223], v[192:195], v[164:167]
  s_nop 0
  s_waitcnt lgkmcnt(0)
  v_mfma_f32_16x16x32_bf16 v[164:167], v[124:127], v[96:99], v[164:167]
  s_cbranch_scc1 Lk_28
  s_barrier
  v_mfma_f32_16x16x32_bf16 v[128:131], v[48:51], v[32:35], v[128:131]
  ds_read_b64_tr_b16 v[112:113], v6 offset:0
  v_mfma_f32_16x16x32_bf16 v[128:131], v[80:83], v[64:67], v[128:131]
  ds_read_b64_tr_b16 v[114:115], v6 offset:2048
  v_mfma_f32_16x16x32_bf16 v[136:139], v[80:83], v[68:71], v[136:139]
  ds_read_b128 v[96:99], v4 offset:0
  v_mfma_f32_16x16x32_bf16 v[136:139], v[48:51], v[36:39], v[136:139]
  ds_read_b128 v[100:103], v4 offset:2048
  v_mfma_f32_16x16x32_bf16 v[144:147], v[48:51], v[40:43], v[144:147]
  ds_read_b128 v[104:107], v4 offset:4096
  v_mfma_f32_16x16x32_bf16 v[144:147], v[80:83], v[72:75], v[144:147]
  ds_read_b128 v[108:111], v4 offset:6144
  v_mfma_f32_16x16x32_bf16 v[152:155], v[80:83], v[76:79], v[152:155]
  ds_read_b64_tr_b16 v[116:117], v7 offset:0
  v_mfma_f32_16x16x32_bf16 v[152:155], v[48:51], v[44:47], v[152:155]
  ds_read_b64_tr_b16 v[118:119], v7 offset:2048
  v_mfma_f32_16x16x32_bf16 v[156:159], v[52:55], v[44:47], v[156:159]
  ds_read_b64_tr_b16 v[120:121], v6 offset:8192
  v_mfma_f32_16x16x32_bf16 v[156:159], v[84:87], v[76:79], v[156:159]
  ds_read_b64_tr_b16 v[122:123], v6 offset:10240
  v_mfma_f32_16x16x32_bf16 v[148:151], v[84:87], v[72:75], v[148:151]
  ds_read_b64_tr_b16 v[124:125], v7 offset:8192
  v_mfma_f32_16x16x32_bf16 v[148:151], v[52:55], v[40:43], v[148:151]
  ds_read_b64_tr_b16 v[126:127], v7 offset:10240
  v_mfma_f32_16x16x32_bf16 v[140:143], v[52:55], v[36:39], v[140:143]
  ds_read_b64_tr_b16 v[208:209], v6 offset:4096
  v_mfma_f32_16x16x32_bf16 v[140:143], v[84:87], v[68:71], v[140:143]
  ds_read_b64_tr_b16 v[210:211], v6 offset:6144
  v_mfma_f32_16x16x32_bf16 v[132:135], v[84:87], v[64:67], v[132:135]
  ds_read_b128 v[192:195], v5 offset:0
  v_mfma_f32_16x16x32_bf16 v[132:135], v[52:55], v[32:35], v[132:135]
  ds_read_b128 v[196:199], v5 offset:2048
  v_mfma_f32_16x16x32_bf16 v[160:163], v[56:59], v[32:35], v[160:163]
  ds_read_b128 v[200:203], v5 offset:4096
  v_mfma_f32_16x16x32_bf16 v[160:163], v[88:91], v[64:67], v[160:163]
  ds_read_b128 v[204:207], v5 offset:6144
  v_mfma_f32_16x16x32_bf16 v[168:171], v[88:91], v[68:71], v[168:171]
  ds_read_b64_tr_b16 v[212:213], v7 offset:4096
  v_mfma_f32_16x16x32_bf16 v[168:171], v[56:59], v[36:39], v[168:171]
  ds_read_b64_tr_b16 v[214:215], v7 offset:6144
  v_mfma_f32_16x16x32_bf16 v[176:179], v[56:59], v[40:43], v[176:179]
  ds_read_b64_tr_b16 v[216:217], v6 offset:12288
  v_mfma_f32_16x16x32_bf16 v[176:179], v[88:91], v[72:75], v[176:179]
  ds_read_b64_tr_b16 v[218:219], v6 offset:14336
  v_mfma_f32_16x16x32_bf16 v[184:187], v[88:91], v[76:79], v[184:187]
  ds_read_b64_tr_b16 v[220:221], v7 offset:12288
  v_mfma_f32_16x16x32_bf16 v[184:187], v[56:59], v[44:47], v[184:187]
  ds_read_b64_tr_b16 v[222:223], v7 offset:14336
  v_mfma_f32_16x16x32_bf16 v[188:191], v[60:63], v[44:47], v[188:191]
  s_add_u32 s16, s16, s17
  s_cmp_eq_u32 s16, 65536
  s_cselect_b32 s23, s18, s17
  v_mfma_f32_16x16x32_bf16 v[188:191], v[92:95], v[76:79], v[188:191]
  s_cselect_b32 s16, 0, s16
  v_add_u32 v4, s23, v4
  v_add_u32_e64 v5, s23, v5
  v_mfma_f32_16x16x32_bf16 v[180:183], v[92:95], v[72:75], v[180:183]
  s_add_u32 s19, s19, s20
  s_cmp_eq_u32 s19, 81920
  s_cselect_b32 s23, s21, s20
  v_mfma_f32_16x16x32_bf16 v[180:183], v[60:63], v[40:43], v[180:183]
  s_cselect_b32 s19, 0, s19
  v_add_u32 v6, s23, v6
  v_add_u32_e64 v7, s23, v7
  v_mfma_f32_16x16x32_bf16 v[172:175], v[60:63], v[36:39], v[172:175]
  v_mfma_f32_16x16x32_bf16 v[172:175], v[92:95], v[68:71], v[172:175]
  v_mfma_f32_16x16x32_bf16 v[164:167], v[92:95], v[64:67], v[164:167]
  s_waitcnt lgkmcnt(0)
  v_mfma_f32_16x16x32_bf16 v[164:167], v[60:63], v[32:35], v[164:167]
  s_barrier
  v_mfma_f32_16x16x32_bf16 v[160:163], v[120:123], v[96:99], v[160:163]
  ds_read_b64_tr_b16 v[48:49], v6 offset:0
  ds_read_b64_tr_b16 v[50:51], v6 offset:2048
  v_mfma_f32_16x16x32_bf16 v[160:163], v[216:219], v[192:195], v[160:163]
  ds_read_b128 v[32:35], v4 offset:0
  ds_read_b128 v[36:39], v4 offset:2048
  v_mfma_f32_16x16x32_bf16 v[164:167], v[220:223], v[192:195], v[164:167]
  ds_read_b128 v[40:43], v4 offset:4096
  ds_read_b128 v[44:47], v4 offset:6144
  v_mfma_f32_16x16x32_bf16 v[164:167], v[124:127], v[96:99], v[164:167]
  ds_read_b64_tr_b16 v[52:53], v7 offset:0
  ds_read_b64_tr_b16 v[54:55], v7 offset:2048
  v_mfma_f32_16x16x32_bf16 v[172:175], v[124:127], v[100:103], v[172:175]
  ds_read_b64_tr_b16 v[80:81], v6 offset:4096
  ds_read_b64_tr_b16 v[82:83], v6 offset:6144
  v_mfma_f32_16x16x32_bf16 v[172:175], v[220:223], v[196:199], v[172:175]
  v_cvt_pk_bf16_f32 v160, v160, v161
  v_cvt_pk_bf16_f32 v161, v162, v163
  v_mfma_f32_16x16x32_bf16 v[168:171], v[216:219], v[196:199], v[168:171]
  v_cvt_pk_bf16_f32 v162, v164, v165
  v_cvt_pk_bf16_f32 v163, v166, v167
  v_mfma_f32_16x16x32_bf16 v[168:171], v[120:123], v[100:103], v[168:171]
  buffer_store_dwordx4 v[160:163], v0, s[40:43], s6 offen offset:0 sc0 sc1
  v_mfma_f32_16x16x32_bf16 v[176:179], v[120:123], v[104:107], v[176:179]
  ds_read_b128 v[64:67], v5 offset:0
  v_mfma_f32_16x16x32_bf16 v[176:179], v[216:219], v[200:203], v[176:179]
  s_nop 0
  s_nop 3
  v_cvt_pk_bf16_f32 v164, v168, v169
  v_cvt_pk_bf16_f32 v165, v170, v171
  v_mfma_f32_16x16x32_bf16 v[180:183], v[220:223], v[200:203], v[180:183]
  v_cvt_pk_bf16_f32 v166, v172, v173
  v_cvt_pk_bf16_f32 v167, v174, v175
  v_mfma_f32_16x16x32_bf16 v[180:183], v[124:127], v[104:107], v[180:183]
  buffer_store_dwordx4 v[164:167], v0, s[40:43], s6 offen offset:2048 sc0 sc1
  ds_read_b128 v[68:71], v5 offset:2048
  v_mfma_f32_16x16x32_bf16 v[188:191], v[124:127], v[108:111], v[188:191]
  ds_read_b128 v[72:75], v5 offset:4096
  v_mfma_f32_16x16x32_bf16 v[188:191], v[220:223], v[204:207], v[188:191]
  v_cvt_pk_bf16_f32 v168, v176, v177
  v_cvt_pk_bf16_f32 v169, v178, v179
  v_mfma_f32_16x16x32_bf16 v[184:187], v[216:219], v[204:207], v[184:187]
  v_cvt_pk_bf16_f32 v170, v180, v181
  v_cvt_pk_bf16_f32 v171, v182, v183
  v_mfma_f32_16x16x32_bf16 v[184:187], v[120:123], v[108:111], v[184:187]
  buffer_store_dwordx4 v[168:171], v0, s[40:43], s7 offen offset:0 sc0 sc1
  ds_read_b128 v[76:79], v5 offset:6144
  v_mfma_f32_16x16x32_bf16 v[128:131], v[112:115], v[96:99], v[128:131]
  ds_read_b64_tr_b16 v[84:85], v7 offset:4096
  v_mfma_f32_16x16x32_bf16 v[128:131], v[208:211], v[192:195], v[128:131]
  s_nop 0
  s_nop 2
  v_cvt_pk_bf16_f32 v172, v184, v185
  v_cvt_pk_bf16_f32 v173, v186, v187
  v_mfma_f32_16x16x32_bf16 v[136:139], v[208:211], v[196:199], v[136:139]
  v_cvt_pk_bf16_f32 v174, v188, v189
  v_cvt_pk_bf16_f32 v175, v190, v191
  v_mfma_f32_16x16x32_bf16 v[136:139], v[112:115], v[100:103], v[136:139]
  buffer_store_dwordx4 v[172:175], v0, s[40:43], s7 offen offset:2048 sc0 sc1
  ds_read_b64_tr_b16 v[86:87], v7 offset:6144
  v_mfma_f32_16x16x32_bf16 v[144:147], v[112:115], v[104:107], v[144:147]
  s_add_u32 s16, s16, s17
  s_cmp_eq_u32 s16, 65536
  s_cselect_b32 s23, s18, s17
  v_mfma_f32_16x16x32_bf16 v[144:147], v[208:211], v[200:203], v[144:147]
  s_cselect_b32 s16, 0, s16
  v_add_u32 v4, s23, v4
  v_add_u32_e64 v5, s23, v5
  v_mfma_f32_16x16x32_bf16 v[152:155], v[208:211], v[204:207], v[152:155]
  s_add_u32 s19, s19, s20
  s_cmp_eq_u32 s19, 81920
  s_cselect_b32 s23, s21, s20
  v_mfma_f32_16x16x32_bf16 v[152:155], v[112:115], v[108:111], v[152:155]
  s_cselect_b32 s19, 0, s19
  v_add_u32 v6, s23, v6
  v_add_u32_e64 v7, s23, v7
  v_mfma_f32_16x16x32_bf16 v[156:159], v[116:119], v[108:111], v[156:159]
  v_mfma_f32_16x16x32_bf16 v[156:159], v[212:215], v[204:207], v[156:159]
  v_mfma_f32_16x16x32_bf16 v[148:151], v[212:215], v[200:203], v[148:151]
  v_mfma_f32_16x16x32_bf16 v[148:151], v[116:119], v[104:107], v[148:151]
  v_mfma_f32_16x16x32_bf16 v[140:143], v[116:119], v[100:103], v[140:143]
  v_mfma_f32_16x16x32_bf16 v[140:143], v[212:215], v[196:199], v[140:143]
  v_mfma_f32_16x16x32_bf16 v[132:135], v[212:215], v[192:195], v[132:135]
  s_waitcnt lgkmcnt(0)
  v_mfma_f32_16x16x32_bf16 v[132:135], v[116:119], v[96:99], v[132:135]
  s_barrier
  v_mfma_f32_16x16x32_bf16 v[128:131], v[48:51], v[32:35], v[128:131]
  ds_read_b64_tr_b16 v[112:113], v6 offset:0
  ds_read_b64_tr_b16 v[114:115], v6 offset:2048
  v_mfma_f32_16x16x32_bf16 v[128:131], v[80:83], v[64:67], v[128:131]
  ds_read_b128 v[96:99], v4 offset:0
  ds_read_b128 v[100:103], v4 offset:2048
  v_mfma_f32_16x16x32_bf16 v[136:139], v[80:83], v[68:71], v[136:139]
  ds_read_b128 v[104:107], v4 offset:4096
  ds_read_b128 v[108:111], v4 offset:6144
  v_mfma_f32_16x16x32_bf16 v[136:139], v[48:51], v[36:39], v[136:139]
  ds_read_b64_tr_b16 v[116:117], v7 offset:0
  ds_read_b64_tr_b16 v[118:119], v7 offset:2048
  v_mfma_f32_16x16x32_bf16 v[144:147], v[48:51], v[40:43], v[144:147]
  ds_read_b64_tr_b16 v[208:209], v6 offset:4096
  ds_read_b64_tr_b16 v[210:211], v6 offset:6144
  v_mfma_f32_16x16x32_bf16 v[144:147], v[80:83], v[72:75], v[144:147]
  ds_read_b128 v[192:195], v5 offset:0
  ds_read_b128 v[196:199], v5 offset:2048
  v_mfma_f32_16x16x32_bf16 v[152:155], v[80:83], v[76:79], v[152:155]
  ds_read_b128 v[200:203], v5 offset:4096
  ds_read_b128 v[204:207], v5 offset:6144
  v_mfma_f32_16x16x32_bf16 v[152:155], v[48:51], v[44:47], v[152:155]
  ds_read_b64_tr_b16 v[212:213], v7 offset:4096
  ds_read_b64_tr_b16 v[214:215], v7 offset:6144
  v_mfma_f32_16x16x32_bf16 v[156:159], v[52:55], v[44:47], v[156:159]
  s_add_u32 s16, s16, s17
  s_cmp_eq_u32 s16, 65536
  s_cselect_b32 s23, s18, s17
  v_mfma_f32_16x16x32_bf16 v[156:159], v[84:87], v[76:79], v[156:159]
  s_cselect_b32 s16, 0, s16
  v_add_u32 v4, s23, v4
  v_add_u32_e64 v5, s23, v5
  v_mfma_f32_16x16x32_bf16 v[148:151], v[84:87], v[72:75], v[148:151]
  s_add_u32 s19, s19, s20
  s_cmp_eq_u32 s19, 81920
  s_cselect_b32 s23, s21, s20
  v_mfma_f32_16x16x32_bf16 v[148:151], v[52:55], v[40:43], v[148:151]
  s_cselect_b32 s19, 0, s19
  v_add_u32 v6, s23, v6
  v_add_u32_e64 v7, s23, v7
  v_mfma_f32_16x16x32_bf16 v[140:143], v[52:55], v[36:39], v[140:143]
  buffer_load_dwordx4 v[176:179], v0, s[40:43], s8 offen offset:0 sc0 sc1
  buffer_load_dwordx4 v[180:183], v0, s[40:43], s8 offen offset:2048 sc0 sc1
  buffer_load_dwordx4 v[184:187], v0, s[40:43], s9 offen offset:0 sc0 sc1
  v_mfma_f32_16x16x32_bf16 v[140:143], v[84:87], v[68:71], v[140:143]
  buffer_load_dwordx4 v[188:191], v0, s[40:43], s9 offen offset:2048 sc0 sc1
  v_mfma_f32_16x16x32_bf16 v[132:135], v[84:87], v[64:67], v[132:135]
  s_waitcnt lgkmcnt(0)
  v_mfma_f32_16x16x32_bf16 v[132:135], v[52:55], v[32:35], v[132:135]
  s_barrier
  v_mfma_f32_16x16x32_bf16 v[128:131], v[112:115], v[96:99], v[128:131]
  ds_read_b64_tr_b16 v[48:49], v6 offset:0
  ds_read_b64_tr_b16 v[50:51], v6 offset:2048
  v_mfma_f32_16x16x32_bf16 v[128:131], v[208:211], v[192:195], v[128:131]
  ds_read_b128 v[32:35], v4 offset:0
  ds_read_b128 v[36:39], v4 offset:2048
  v_mfma_f32_16x16x32_bf16 v[136:139], v[208:211], v[196:199], v[136:139]
  ds_read_b128 v[40:43], v4 offset:4096
  ds_read_b128 v[44:47], v4 offset:6144
  v_mfma_f32_16x16x32_bf16 v[136:139], v[112:115], v[100:103], v[136:139]
  ds_read_b64_tr_b16 v[52:53], v7 offset:0
  ds_read_b64_tr_b16 v[54:55], v7 offset:2048
  v_mfma_f32_16x16x32_bf16 v[144:147], v[112:115], v[104:107], v[144:147]
  ds_read_b64_tr_b16 v[80:81], v6 offset:4096
  ds_read_b64_tr_b16 v[82:83], v6 offset:6144
  v_mfma_f32_16x16x32_bf16 v[144:147], v[208:211], v[200:203], v[144:147]
  ds_read_b128 v[64:67], v5 offset:0
  ds_read_b128 v[68:71], v5 offset:2048
  v_mfma_f32_16x16x32_bf16 v[152:155], v[208:211], v[204:207], v[152:155]
  ds_read_b128 v[72:75], v5 offset:4096
  ds_read_b128 v[76:79], v5 offset:6144
  v_mfma_f32_16x16x32_bf16 v[152:155], v[112:115], v[108:111], v[152:155]
  ds_read_b64_tr_b16 v[84:85], v7 offset:4096
  ds_read_b64_tr_b16 v[86:87], v7 offset:6144
  v_mfma_f32_16x16x32_bf16 v[156:159], v[116:119], v[108:111], v[156:159]
  s_nop 0
  s_add_u32 s16, s16, s17
  s_cmp_eq_u32 s16, 65536
  v_mfma_f32_16x16x32_bf16 v[156:159], v[212:215], v[204:207], v[156:159]
  s_cselect_b32 s23, s18, s17
  s_cselect_b32 s16, 0, s16
  v_mfma_f32_16x16x32_bf16 v[148:151], v[212:215], v[200:203], v[148:151]
  v_add_u32_e64 v4, s23, v4
  v_add_u32 v5, s23, v5
  v_mfma_f32_16x16x32_bf16 v[148:151], v[116:119], v[104:107], v[148:151]
  s_add_u32 s19, s19, s20
  s_cmp_eq_u32 s19, 81920
  v_mfma_f32_16x16x32_bf16 v[140:143], v[116:119], v[100:103], v[140:143]
  s_cselect_b32 s23, s21, s20
  s_cselect_b32 s19, 0, s19
  v_mfma_f32_16x16x32_bf16 v[140:143], v[212:215], v[196:199], v[140:143]
  v_add_u32 v6, s23, v6
  v_add_u32 v7, s23, v7
  v_mfma_f32_16x16x32_bf16 v[132:135], v[212:215], v[192:195], v[132:135]
  s_waitcnt lgkmcnt(0)
  v_mfma_f32_16x16x32_bf16 v[132:135], v[116:119], v[96:99], v[132:135]
  s_barrier
  v_mfma_f32_16x16x32_bf16 v[128:131], v[48:51], v[32:35], v[128:131]
  ds_read_b64_tr_b16 v[112:113], v6 offset:0
  ds_read_b64_tr_b16 v[114:115], v6 offset:2048
  v_mfma_f32_16x16x32_bf16 v[128:131], v[80:83], v[64:67], v[128:131]
  ds_read_b128 v[96:99], v4 offset:0
  ds_read_b128 v[100:103], v4 offset:2048
  v_mfma_f32_16x16x32_bf16 v[136:139], v[80:83], v[68:71], v[136:139]
  ds_read_b128 v[104:107], v4 offset:4096
  ds_read_b128 v[108:111], v4 offset:6144
  v_mfma_f32_16x16x32_bf16 v[136:139], v[48:51], v[36:39], v[136:139]
  ds_read_b64_tr_b16 v[116:117], v7 offset:0
  ds_read_b64_tr_b16 v[118:119], v7 offset:2048
  v_mfma_f32_16x16x32_bf16 v[144:147], v[48:51], v[40:43], v[144:147]
  ds_read_b64_tr_b16 v[208:209], v6 offset:4096
  ds_read_b64_tr_b16 v[210:211], v6 offset:6144
  v_mfma_f32_16x16x32_bf16 v[144:147], v[80:83], v[72:75], v[144:147]
  ds_read_b128 v[192:195], v5 offset:0
  ds_read_b128 v[196:199], v5 offset:2048
  v_mfma_f32_16x16x32_bf16 v[152:155], v[80:83], v[76:79], v[152:155]
  ds_read_b128 v[200:203], v5 offset:4096
  ds_read_b128 v[204:207], v5 offset:6144
  v_mfma_f32_16x16x32_bf16 v[152:155], v[48:51], v[44:47], v[152:155]
  ds_read_b64_tr_b16 v[212:213], v7 offset:4096
  ds_read_b64_tr_b16 v[214:215], v7 offset:6144
  v_mfma_f32_16x16x32_bf16 v[156:159], v[52:55], v[44:47], v[156:159]
  v_mfma_f32_16x16x32_bf16 v[156:159], v[84:87], v[76:79], v[156:159]
  v_mfma_f32_16x16x32_bf16 v[148:151], v[84:87], v[72:75], v[148:151]
  v_mfma_f32_16x16x32_bf16 v[148:151], v[52:55], v[40:43], v[148:151]
  v_mfma_f32_16x16x32_bf16 v[140:143], v[52:55], v[36:39], v[140:143]
  v_mfma_f32_16x16x32_bf16 v[140:143], v[84:87], v[68:71], v[140:143]
  v_mfma_f32_16x16x32_bf16 v[132:135], v[84:87], v[64:67], v[132:135]
  s_waitcnt lgkmcnt(0)
  v_mfma_f32_16x16x32_bf16 v[132:135], v[52:55], v[32:35], v[132:135]
  s_barrier
  v_mfma_f32_16x16x32_bf16 v[128:131], v[112:115], v[96:99], v[128:131]
  v_mfma_f32_16x16x32_bf16 v[128:131], v[208:211], v[192:195], v[128:131]
  v_mfma_f32_16x16x32_bf16 v[136:139], v[208:211], v[196:199], v[136:139]
  v_mfma_f32_16x16x32_bf16 v[136:139], v[112:115], v[100:103], v[136:139]
  v_mfma_f32_16x16x32_bf16 v[144:147], v[112:115], v[104:107], v[144:147]
  v_mfma_f32_16x16x32_bf16 v[144:147], v[208:211], v[200:203], v[144:147]
  v_mfma_f32_16x16x32_bf16 v[152:155], v[208:211], v[204:207], v[152:155]
  v_mfma_f32_16x16x32_bf16 v[152:155], v[112:115], v[108:111], v[152:155]
  v_mfma_f32_16x16x32_bf16 v[156:159], v[116:119], v[108:111], v[156:159]
  v_mfma_f32_16x16x32_bf16 v[156:159], v[212:215], v[204:207], v[156:159]
  v_mfma_f32_16x16x32_bf16 v[148:151], v[212:215], v[200:203], v[148:151]
  v_mfma_f32_16x16x32_bf16 v[148:151], v[116:119], v[104:107], v[148:151]
  v_mfma_f32_16x16x32_bf16 v[140:143], v[116:119], v[100:103], v[140:143]
  v_mfma_f32_16x16x32_bf16 v[140:143], v[212:215], v[196:199], v[140:143]
  v_mfma_f32_16x16x32_bf16 v[132:135], v[212:215], v[192:195], v[132:135]
  s_nop 0
  s_waitcnt lgkmcnt(0)
  v_mfma_f32_16x16x32_bf16 v[132:135], v[116:119], v[96:99], v[132:135]
  s_mov_b32 s89, 200000
  v_mov_b32_e64 v32, 0
  s_waitcnt vmcnt(0)
  s_mov_b64 exec, 1
  buffer_store_dword v27, off, s[40:43], s14 sc0 sc1
  s_mov_b64 exec, -1
Lx_30:
  v_cmpx_ne_u64 vcc, v[176:177], v[240:241]
  v_cmpx_ne_u64 vcc, v[178:179], v[242:243]
  v_cmpx_ne_u64 vcc, v[180:181], v[244:245]
  v_cmpx_ne_u64 vcc, v[182:183], v[246:247]
  v_cmpx_ne_u64 vcc, v[184:185], v[248:249]
  v_cmpx_ne_u64 vcc, v[186:187], v[250:251]
  v_cmpx_ne_u64 vcc, v[188:189], v[252:253]
  v_cmpx_ne_u64_e64 vcc, v[190:191], v[254:255]
  s_cmp_eq_u64 exec, -1
  s_cbranch_scc0 Lx_29
Lx_31:
  s_mov_b32 s4, 0xffff0000
  v_lshlrev_b32 v32, 16, v176
  v_and_b32 v33, s4, v176
  v_lshlrev_b32 v34, 16, v177
  v_and_b32 v35, s4, v177
  v_lshlrev_b32 v36, 16, v178
  v_and_b32 v37, s4, v178
  v_lshlrev_b32 v38, 16, v179
  v_and_b32 v39, s4, v179
  v_pk_add_f32 v[128:129], v[128:129], v[32:33]
  v_pk_add_f32 v[130:131], v[130:131], v[34:35]
  v_pk_add_f32 v[132:133], v[132:133], v[36:37]
  v_pk_add_f32 v[134:135], v[134:135], v[38:39]
  v_lshlrev_b32 v32, 16, v180
  v_and_b32 v33, s4, v180
  v_lshlrev_b32 v34, 16, v181
  v_and_b32 v35, s4, v181
  v_lshlrev_b32 v36, 16, v182
  v_and_b32 v37, s4, v182
  v_lshlrev_b32 v38, 16, v183
  v_and_b32 v39, s4, v183
  v_pk_add_f32 v[136:137], v[136:137], v[32:33]
  v_pk_add_f32 v[138:139], v[138:139], v[34:35]
  v_pk_add_f32 v[140:141], v[140:141], v[36:37]
  v_pk_add_f32 v[142:143], v[142:143], v[38:39]
  v_lshlrev_b32 v32, 16, v184
  v_and_b32 v33, s4, v184
  v_lshlrev_b32 v34, 16, v185
  v_and_b32 v35, s4, v185
  v_lshlrev_b32 v36, 16, v186
  v_and_b32 v37, s4, v186
  v_lshlrev_b32 v38, 16, v187
  v_and_b32 v39, s4, v187
  v_pk_add_f32 v[144:145], v[144:145], v[32:33]
  v_pk_add_f32 v[146:147], v[146:147], v[34:35]
  v_pk_add_f32 v[148:149], v[148:149], v[36:37]
  v_pk_add_f32 v[150:151], v[150:151], v[38:39]
  v_lshlrev_b32 v32, 16, v188
  v_and_b32 v33, s4, v188
  v_lshlrev_b32 v34, 16, v189
  v_and_b32 v35, s4, v189
  v_lshlrev_b32 v36, 16, v190
  v_and_b32 v37, s4, v190
  v_lshlrev_b32 v38, 16, v191
  v_and_b32 v39, s4, v191
  v_pk_add_f32 v[152:153], v[152:153], v[32:33]
  v_pk_add_f32 v[154:155], v[154:155], v[34:35]
  v_pk_add_f32 v[156:157], v[156:157], v[36:37]
  v_pk_add_f32 v[158:159], v[158:159], v[38:39]
  v_cvt_pk_bf16_f32 v240, v128, v129
  v_cvt_pk_bf16_f32 v241, v130, v131
  v_cvt_pk_bf16_f32 v242, v132, v133
  v_cvt_pk_bf16_f32 v243, v134, v135
  v_cvt_pk_bf16_f32 v244, v136, v137
  v_cvt_pk_bf16_f32 v245, v138, v139
  v_cvt_pk_bf16_f32 v246, v140, v141
  v_cvt_pk_bf16_f32 v247, v142, v143
  v_cvt_pk_bf16_f32 v248, v144, v145
  v_cvt_pk_bf16_f32 v249, v146, v147
  v_cvt_pk_bf16_f32 v250, v148, v149
  v_cvt_pk_bf16_f32 v251, v150, v151
  v_cvt_pk_bf16_f32 v252, v152, v153
  v_cvt_pk_bf16_f32 v253, v154, v155
  v_cvt_pk_bf16_f32 v254, v156, v157
  v_cvt_pk_bf16_f32 v255, v158, v159
  s_cmp_lg_u32 s82, 0
  s_cbranch_scc1 L_cfinal
  s_lshl_b32 s4, s76, 4
  s_add_u32 s4, s4, s78
  s_lshl_b32 s6, s4, Lz1-Lz0+14
  s_add_u32 s6, s6, 35651584
  s_add_u32 s7, s6, 4096
  s_lshl_b32 s5, s78, Lz1-Lz0+1
  buffer_store_dwordx4 v[240:243], v0, s[40:43], s6 offen offset:0 sc0 sc1
  buffer_store_dwordx4 v[244:247], v0, s[40:43], s6 offen offset:2048 sc0 sc1
  buffer_store_dwordx4 v[248:251], v0, s[40:43], s7 offen offset:0 sc0 sc1
  buffer_store_dwordx4 v[252:255], v0, s[40:43], s7 offen offset:2048 sc0 sc1
  v_mov_b32 v40, 0x3f803f80
  v_dot2_f32_bf16 v32, v240, v40, 0
  v_dot2_f32_bf16 v36, v240, v240, 0
  v_dot2_f32_bf16 v33, v244, v40, 0
  v_dot2_f32_bf16 v37, v244, v244, 0
  v_dot2_f32_bf16 v34, v248, v40, 0
  v_dot2_f32_bf16 v38, v248, v248, 0
  v_dot2_f32_bf16 v35, v252, v40, 0
  v_dot2_f32_bf16 v39, v252, v252, 0
  v_dot2_f32_bf16 v32, v241, v40, v32
  v_dot2_f32_bf16 v36, v241, v241, v36
  v_dot2_f32_bf16 v33, v245, v40, v33
  v_dot2_f32_bf16 v37, v245, v245, v37
  v_dot2_f32_bf16 v34, v249, v40, v34
  v_dot2_f32_bf16 v38, v249, v249, v38
  v_dot2_f32_bf16 v35, v253, v40, v35
  v_dot2_f32_bf16 v39, v253, v253, v39
  v_dot2_f32_bf16 v32, v242, v40, v32
  v_dot2_f32_bf16 v36, v242, v242, v36
  v_dot2_f32_bf16 v33, v246, v40, v33
  v_dot2_f32_bf16 v37, v246, v246, v37
  v_dot2_f32_bf16 v34, v250, v40, v34
  v_dot2_f32_bf16 v38, v250, v250, v38
  v_dot2_f32_bf16 v35, v254, v40, v35
  v_dot2_f32_bf16 v39, v254, v254, v39
  v_dot2_f32_bf16 v32, v243, v40, v32
  v_dot2_f32_bf16 v36, v243, v243, v36
  v_dot2_f32_bf16 v33, v247, v40, v33
  v_dot2_f32_bf16 v37, v247, v247, v37
  v_dot2_f32_bf16 v34, v251, v40, v34
  v_dot2_f32_bf16 v38, v251, v251, v38
  v_dot2_f32_bf16 v35, v255, v40, v35
  v_dot2_f32_bf16 v39, v255, v255, v39
  s_lshl_b32 s6, s76, Lz1-Lz0+9
  s_lshl_b32 s7, s85, 8
  s_add_u32 s6, s6, s7
  s_add_u32 s6, s6, s5
  s_add_u32 s6, s6, s86
  s_lshl_b32 s6, s6, 6
  s_add_u32 s6, s6, s83
  s_add_u32 s6, s6, 36700160
  v_permlane32_swap_b32 v32, v34
  v_permlane32_swap_b32 v33, v35
  v_permlane32_swap_b32 v36, v38
  v_permlane32_swap_b32 v37, v39
  v_add_f32 v32, v32, v34
  v_add_f32 v33, v33, v35
  v_add_f32 v36, v36, v38
  v_add_f32 v37, v37, v39
  v_permlane16_swap_b32 v32, v33
  s_nop 0
  v_permlane16_swap_b32 v36, v37
  v_add_f32 v42, v32, v33
  v_add_f32_e64 v43, v36, v37
  buffer_store_dwordx2 v[42:43], v30, s[40:43], s6 offen sc0 sc1
  s_add_u32 s5, s87, 16
  s_sub_u32 s4, s78, s77
  s_lshl_b32 s4, s4, 7
  s_add_u32 s5, s5, s4
  s_waitcnt vmcnt(0)
  s_mov_b64 exec, 1
  ds_add_rtn_u32 v2, v28, v27 offset:0
  s_waitcnt lgkmcnt(0)
  v_readfirstlane_b32 s4, v2
  s_and_b32 s4, s4, Lz1-Lz0+3
  s_cmp_lg_u32 s4, 3
  s_cbranch_scc1 Ls_32
  s_mov_b32 exec_lo, 0xffff
  buffer_store_dword v27, v24, s[40:43], s5 offen sc0 sc1
Ls_32:
  s_nop 0
  s_mov_b64 exec, -1
  ds_write_b128 v0, v[240:243] offset:0
  ds_write_b128 v0, v[244:247] offset:2048
  ds_write_b128 v0, v[248:251] offset:4096
  ds_write_b128 v0, v[252:255] offset:6144
  s_mov_b32 s82, 1
  s_add_u32 s83, s83, 0
  s_add_u32 s87, s87, 32
  s_branch L_clayer
L_cfinal:
  s_nop 1
  v_permlane16_swap_b32 v240, v242
  v_permlane16_swap_b32 v241, v243
  v_permlane16_swap_b32 v244, v246
  v_permlane16_swap_b32 v245, v247
  v_permlane16_swap_b32 v248, v250
  v_permlane16_swap_b32 v249, v251
  v_permlane16_swap_b32 v252, v254
  v_permlane16_swap_b32 v253, v255
  v_and_b32 v2, 15, v1
  v_lshlrev_b32 v3, 12, v2
  v_and_b32 v2, 16, v1
  v_lshl_add_u32 v3, v2, 1, v3
  v_and_b32 v2, 32, v1
  v_lshrrev_b32 v2, 1, v2
  v_add_u32 v3, v2, v3
  s_lshl_b32 s5, s76, 18
  s_lshl_b32 s4, s85, 11
  s_add_u32 s5, s5, s4
  s_lshl_b32 s4, s78, 7
  s_add_u32 s5, s5, s4
  s_lshl_b32 s4, s86, 6
  s_add_u32 s5, s5, s4
  buffer_store_dwordx4 v[240:243], v3, s[64:67], s5 offen
  s_add_u32 s5, s5, 0x10000
  buffer_store_dwordx4 v[244:247], v3, s[64:67], s5 offen
  s_add_u32 s5, s5, 0x10000
  buffer_store_dwordx4 v[248:251], v3, s[64:67], s5 offen
  s_add_u32 s5, s5, 0x10000
  buffer_store_dwordx4 v[252:255], v3, s[64:67], s5 offen
  s_endpgm
Lo_7:
  s_mov_b64 vcc, 0
  s_waitcnt lgkmcnt(0)
  s_barrier
  ds_read_b128 v[64:67], v4 offset:0
  ds_read_b128 v[80:83], v5 offset:0
  ds_read_b128 v[68:71], v4 offset:2048
  ds_read_b128 v[84:87], v5 offset:2048
  ds_read_b128 v[72:75], v4 offset:4096
  ds_read_b128 v[88:91], v5 offset:4096
  ds_read_b64_tr_b16 v[96:97], v6 offset:0
  ds_read_b64_tr_b16 v[98:99], v6 offset:2048
  ds_read_b64_tr_b16 v[100:101], v6 offset:4096
  ds_read_b64_tr_b16 v[102:103], v6 offset:6144
  ds_read_b128 v[76:79], v4 offset:6144
  ds_read_b128 v[92:95], v5 offset:6144
  ds_read_b64_tr_b16 v[104:105], v7 offset:0
  s_nop 0
  s_waitcnt lgkmcnt(8)
  ds_read_b64_tr_b16 v[106:107], v7 offset:2048
  ds_read_b64_tr_b16 v[108:109], v7 offset:4096
  ds_read_b64_tr_b16 v[110:111], v7 offset:6144
  s_waitcnt lgkmcnt(6)
  s_branch Lk_4
Lx_29:
  s_mov_b64 exec, -1
  v_readfirstlane_b32 s5, v32
  s_sub_u32 s89, s89, 1
  s_cbranch_scc1 Lx_31
  buffer_load_dword v32, off, s[40:43], s13 sc0 sc1
  buffer_load_dwordx4 v[176:179], v0, s[40:43], s8 offen offset:0 sc0 sc1
  buffer_load_dwordx4 v[180:183], v0, s[40:43], s8 offen offset:2048 sc0 sc1
  buffer_load_dwordx4 v[184:187], v0, s[40:43], s9 offen offset:0 sc0 sc1
  buffer_load_dwordx4 v[188:191], v0, s[40:43], s9 offen offset:2048 sc0 sc1
  s_waitcnt vmcnt(0)
  s_cmp_lg_u32 s5, 0
  s_cbranch_scc1 Lx_31
  s_branch Lx_30
  s_nop 0
L_w1:
  s_and_b32 s80, s77, 7
  s_lshr_b32 s79, s77, 3
  s_lshl_b32 s78, s80, 1
  s_add_u32 s78, s78, s79
  s_lshl_b32 s5, s76, 4
  s_add_u32 s5, s5, s77
  s_lshl_b32 s84, s5, 11
  s_mov_b32 s83, 3145728
  s_mov_b32 s87, 1835016
  s_lshr_b32 s86, s81, 1
  s_mov_b32 s40, s38
  s_and_b32 s41, s39, 0xffff
  s_mov_b32 s42, 100663296
  s_mov_b32 s43, 0x00020000
  s_nop 0
  s_mov_b32 s52, s20
  s_and_b32 s53, s21, 0xffff
  s_mov_b32 s54, 2097152
  s_mov_b32 s55, 0x00020000
  s_nop 0
  s_mov_b32 s56, s24
  s_and_b32 s57, s25, 0xffff
  s_mov_b32 s58, 7340032
  s_mov_b32 s59, 0x00020000
  s_nop 0
  s_mov_b32 s60, s28
  s_and_b32 s61, s29, 0xffff
  s_mov_b32 s62, 7340032
  s_mov_b32 s63, 0x00020000
  v_lshrrev_b32 v2, 3, v1
  s_movk_i32 s4, 2048
  v_mad_u32_u24 v4, v2, s4, v10
  v_add_u32 v5, 15360, v4
  v_add_u32 v6, 30720, v4
  v_add_u32 v7, 46080, v4
  s_lshl_b32 s5, s78, 7
  s_mul_i32 s4, s85, 65536
  s_add_u32 s5, s5, s4
  s_mov_b32 s8, 131072
  s_mov_b32 s10, 2097152
  s_add_u32 s9, s5, s10
  s_mul_i32 s6, s76, s8
  s_add_u32 s7, s5, s6
  s_lshl_b32 s11, s85, 12
  s_add_u32 s11, s11, 65536
  s_add_u32 s15, s11, 81920
  s_add_u32 s11, s11, 32768
  s_mul_i32 s4, s76, 14
  s_lshr_b32 s4, s4, 4
  v_add_u32 v14, s4, v1
  v_subrev_u32 v2, 14, v14
  v_min_u32 v14, v14, v2
  v_cmp_le_u32 vcc, 14, v1
  s_nop 1
  v_cndmask_b32 v14, v14, v1, vcc
  v_lshlrev_b32_e64 v14, 2, v14
  v_mov_b32 v2, 0x87654210
  v_mov_b32 v3, 0xb3fedca9
  v_lshrrev_b64 v[2:3], v14, v[2:3]
  v_and_b32_e64 v14, 15, v2
  v_cmp_eq_u32 vcc, s77, v14
  s_nop 0
  v_mov_b32_dpp v2, v14 row_shr:1 row_mask:0xf bank_mask:0xf
  s_ff1_i32_b32 s4, vcc_lo
  v_cmp_ge_u32 vcc, s4, v1
  s_nop 1
  v_cndmask_b32 v14, v14, v2, vcc
  v_writelane_b32 v14, s77, 0
  v_lshl_add_u32 v12, v14, 17, s5
  s_nop 0
  v_readfirstlane_b32 s7, v12
  s_mov_b32 s12, 0
  s_mov_b32 m0, s11
  s_waitcnt vmcnt(12)
  s_barrier
  s_branch Ll_46
Lt_52:
  s_cmp_lg_u32 s12, 2
  s_cbranch_scc1 Lt_50
  s_waitcnt vmcnt(8)
  s_barrier
  s_branch Ll_46
  s_nop 0
Lt_50:
  s_cmp_lg_u32 s12, 3
  s_cbranch_scc1 Ll_46
  s_barrier
Ll_46:
  buffer_load_dwordx4 v4, s[52:55], s7 offen offset:0  lds
  s_mov_b32 s5, s7
  buffer_load_dwordx4 v5, s[52:55], s5 offen offset:1024  lds
  s_add_u32 s12, s12, 1
  v_readlane_b32 s7, v12, s12
  s_add_u32 s11, s11, 8192
  s_nop 0
  s_cmp_eq_u32 s11, s15
  buffer_load_dwordx4 v6, s[52:55], s5 offen offset:2048  lds
  s_cselect_b32 s4, 81920, 0
  s_sub_u32 s11, s11, s4
  s_cmp_lg_u32 s12, 10
  buffer_load_dwordx4 v7, s[52:55], s5 offen offset:3072  lds
  s_mov_b32 m0, s11
  s_cbranch_scc1 Lt_52
Lt_53:
  v_mov_b32 v2, 156416
  v_mov_b32_e64 v3, 1
  s_waitcnt vmcnt(16)
  s_mov_b64 exec, 1
  ds_add_u32 v2, v3 offset:8
  s_mov_b64 exec, -1
  s_barrier
Ll_48:
  buffer_load_dwordx4 v4, s[52:55], s7 offen offset:0  lds
  s_mov_b32 s5, s7
  buffer_load_dwordx4 v5, s[52:55], s5 offen offset:1024  lds
  s_add_u32 s12, s12, 1
  v_readlane_b32 s7, v12, s12
  s_add_u32 s11, s11, 8192
  s_nop 0
  s_cmp_eq_u32 s11, s15
  buffer_load_dwordx4 v6, s[52:55], s5 offen offset:2048  lds
  s_cselect_b32 s4, 81920, 0
  s_sub_u32 s11, s11, s4
  s_cmp_lg_u32 s12, 16
  buffer_load_dwordx4 v7, s[52:55], s5 offen offset:3072  lds
  s_mov_b32 m0, s11
  s_cbranch_scc1 Ll_48
  v_lshrrev_b32 v2, 3, v1
  s_movk_i32 s4, 7168
  v_mad_u32_u24 v4, v2, s4, v10
  v_add_u32 v5, 56320, v4
  v_add_u32 v6, 112640, v4
  v_add_u32 v7, 168960, v4
  v_lshrrev_b32 v2, 2, v1
  s_movk_i32 s4, 7168
  v_mul_u32_u24_e64 v2, s4, v2
  v_bfe_u32 v3, v10, 5, 1
  v_lshl_add_u32 v2, v3, 4, v2
  v_and_b32 v3, 1, v1
  v_lshlrev_b32 v3, 5, v3
  v_add_u32_e64 v8, v2, v3
  v_add_u32 v9, 113664, v8
  s_mul_i32 s5, s77, 448
  s_and_b32 s4, s77, Lz1-Lz0+1
  s_mul_i32 s94, s4, 448
  s_sub_u32 s94, 384, s94
  s_lshl_b32 s4, s4, 6
  s_add_u32 s5, s5, s4
  s_mul_i32 s4, s85, 229376
  s_add_u32 s5, s5, s4
  s_and_b32 s4, s76, 7
  s_add_u32 s6, s4, 1
  v_cmp_lt_u32 vcc, s6, v1
  v_add_u32 v12, s4, v1
  s_nop 0
  v_subbrev_co_u32 v12, vcc, 0, v12, vcc
  v_and_b32 v12, 7, v12
  v_subrev_u32 v2, 9, v1
  v_cmp_le_u32 vcc, s4, v2
  s_nop 1
  v_addc_co_u32 v2, vcc, 8, v2, vcc
  v_cmp_le_u32 vcc, 9, v1
  s_nop 1
  v_cndmask_b32 v12, v12, v2, vcc
  s_add_u32 s4, s4, 8
  s_mov_b32 m0, s6
  s_nop 0
  v_writelane_b32 v12, s4, m0
  s_and_b32 s4, s76, 8
  v_xor_b32 v12, s4, v12
  v_cmp_eq_u32 vcc, s78, v12
  s_nop 0
  v_mov_b32_dpp v2, v12 row_shr:1 row_mask:0xf bank_mask:0xf
  s_ff1_i32_b32 s4, vcc_lo
  v_cmp_ge_u32 vcc, s4, v1
  s_nop 1
  v_cndmask_b32 v12, v12, v2, vcc
  v_writelane_b32 v12, s78, 0
  s_mov_b32 s4, 458752
  v_mul_u32_u24 v12, s4, v12
  v_add_u32 v12, s5, v12
  s_nop 0
  v_readfirstlane_b32 s7, v12
  s_lshl_b32 s11, s85, Lz1-Lz0+12
  s_add_u32 s11, s11, 65536
  s_add_u32 s15, s11, 86016
  s_lshl_b32 s4, s85, Lz1-Lz0+11
  s_sub_u32 s13, 24576, s4
  s_mul_i32 s5, s85, 6144
  s_nop 0
  s_mov_b32 s68, s28
  s_and_b32 s69, s29, 0xffff
  s_mov_b32 s70, 7340032
  s_mov_b32 s71, 0x00020000
  s_lshl_b32 s4, s76, 4
  s_add_u32 s4, s4, s77
  s_mul_i32 s34, s4, 28672
  s_add_u32 s34, s34, s5
  v_lshlrev_b32 v15, 4, v1
  s_lshl_b32 s91, s85, Lz1-Lz0+13
  s_add_u32 s91, s91, 4096
  s_mul_i32 s4, s76, 262144
  s_add_u32 s4, s4, 3145728
  s_add_u32 s4, s4, s91
  v_lshl_add_u32 v14, v14, 14, s4
  s_mov_b32 s12, 4
Lh_54:
  v_readlane_b32 s90, v14, s12
  s_mov_b32 m0, s91
  s_cmp_lt_u32 s12, Lz1-Lz0+7
  s_cbranch_scc1 Lh_55
  s_waitcnt vmcnt(8)
Lh_55:
  s_barrier
  buffer_load_dwordx4 v15, s[40:43], s90 offen offset:0 sc1 lds
  s_add_u32 s91, s91, 16384
  s_and_b32 s91, s91, 0xffff
  buffer_load_dwordx4 v15, s[40:43], s90 offen offset:1024 sc1 lds
  s_add_u32 s12, s12, 1
  s_cmp_lg_u32 s12, 16
  buffer_load_dwordx4 v15, s[40:43], s90 offen offset:2048 sc1 lds
  buffer_load_dwordx4 v15, s[40:43], s90 offen offset:3072 sc1 lds
  s_cbranch_scc1 Lh_54
  s_mov_b32 s12, 0
  s_mov_b32 m0, s11
  s_branch Ll_56
Lt_61:
  s_cmp_lg_u32 s12, 1
  s_cbranch_scc1 Ll_56
  s_waitcnt vmcnt(18)
  s_barrier
Ll_56:
  buffer_load_dwordx4 v4, s[56:59], s7 offen offset:0  lds
  buffer_load_dwordx4 v5, s[56:59], s7 offen offset:1024  lds
  buffer_load_dwordx4 v6, s[56:59], s7 offen offset:2048  lds
  buffer_load_dwordx4 v7, s[56:59], s7 offen offset:3072  lds
  s_add_u32 m0, s11, s13
  s_add_u32 s5, s7, s94
  buffer_load_dwordx4 v8, s[56:59], s5 offen offset:0  lds
  buffer_load_dwordx4 v9, s[56:59], s5 offen offset:1024  lds
  s_cmp_ge_u32 s12, Lz1-Lz0+2
  s_cbranch_scc1 Lm_62
  s_waitcnt vmcnt(20)
  s_cmp_lg_u32 s12, 0
  s_cbranch_scc1 Lm_63
  s_waitcnt vmcnt(14)
Lm_63:
  s_barrier
Lm_62:
  s_add_u32 m0, s11, 8192
  s_add_u32 s5, s7, 128
  buffer_load_dwordx4 v4, s[56:59], s5 offen offset:0  lds
  buffer_load_dwordx4 v5, s[56:59], s5 offen offset:1024  lds
  buffer_load_dwordx4 v6, s[56:59], s5 offen offset:2048  lds
  buffer_load_dwordx4 v7, s[56:59], s5 offen offset:3072  lds
  s_add_u32 m0, s11, 16384
  s_add_u32 s5, s7, 256
  buffer_load_dwordx4 v4, s[56:59], s5 offen offset:0  lds
  s_add_u32 s12, s12, Lz1-Lz0+1
  v_readlane_b32 s7, v12, s12
  s_add_u32 s11, s11, 28672
  buffer_load_dwordx4 v5, s[56:59], s5 offen offset:1024  lds
  s_cmp_eq_u32 s11, s15
  s_cselect_b32 s4, 86016, 0
  s_sub_u32 s11, s11, s4
  buffer_load_dwordx4 v6, s[56:59], s5 offen offset:2048  lds
  s_cmp_lg_u32 s12, 2
  buffer_load_dwordx4 v7, s[56:59], s5 offen offset:3072  lds
  s_mov_b32 m0, s11
  s_cbranch_scc1 Ll_57
  s_barrier
Lt_64:
  s_waitcnt vmcnt(0)
  s_barrier
Ll_57:
  s_cmp_lt_u32 s12, 3
  s_cbranch_scc1 Lt_61
  s_waitcnt vmcnt(14)
  s_barrier
  buffer_load_dwordx4 v4, s[56:59], s7 offen offset:0  lds
  buffer_load_dwordx4 v5, s[56:59], s7 offen offset:1024  lds
  buffer_load_dwordx4 v6, s[56:59], s7 offen offset:2048  lds
  buffer_load_dwordx4 v7, s[56:59], s7 offen offset:3072  lds
Ll_65:
  s_add_u32 m0, s11, s13
  s_add_u32 s5, s7, s94
  buffer_load_dwordx4 v8, s[56:59], s5 offen offset:0  lds
  buffer_load_dwordx4 v9, s[56:59], s5 offen offset:1024  lds
  s_add_u32 m0, s11, 8192
  s_add_u32 s5, s7, 128
  buffer_load_dwordx4 v4, s[56:59], s5 offen offset:0  lds
  buffer_load_dwordx4 v5, s[56:59], s5 offen offset:1024  lds
  buffer_load_dwordx4 v6, s[56:59], s5 offen offset:2048  lds
  buffer_load_dwordx4 v7, s[56:59], s5 offen offset:3072  lds
  s_add_u32 m0, s11, 16384
  s_add_u32 s5, s7, 256
  buffer_load_dwordx4 v4, s[56:59], s5 offen offset:0  lds
  s_add_u32 s12, s12, Lz1-Lz0+1
  v_readlane_b32 s7, v12, s12
  s_add_u32 s11, s11, 28672
  buffer_load_dwordx4 v5, s[56:59], s5 offen offset:1024  lds
  s_cmp_eq_u32 s11, s15
  s_cselect_b32 s4, 86016, 0
  s_sub_u32 s11, s11, s4
  buffer_load_dwordx4 v6, s[56:59], s5 offen offset:2048  lds
  s_cmp_eq_u32 s12, Lz1-Lz0+16
  buffer_load_dwordx4 v7, s[56:59], s5 offen offset:3072  lds
  s_mov_b32 m0, s11
  s_cbranch_scc1 Ll_66
  s_cmp_lg_u32 s82, 0
  s_cbranch_scc1 L_67
  s_buffer_load_dwordx2 s[98:99], s[68:71], s34 offset:60
  s_buffer_load_dwordx2 s[98:99], s[68:71], s34 offset:188
  s_buffer_load_dwordx2 s[98:99], s[68:71], s34 offset:316
  s_buffer_load_dwordx2 s[98:99], s[68:71], s34 offset:444
  s_add_u32 s34, s34, 512
L_67:
  s_waitcnt vmcnt(14)
  s_barrier
  buffer_load_dwordx4 v4, s[56:59], s7 offen offset:0  lds
  buffer_load_dwordx4 v5, s[56:59], s7 offen offset:1024  lds
  buffer_load_dwordx4 v6, s[56:59], s7 offen offset:2048  lds
  buffer_load_dwordx4 v7, s[56:59], s7 offen offset:3072  lds
  s_branch Ll_65
  s_nop 0
Ll_66:
  v_lshrrev_b32 v2, 3, v1
  s_movk_i32 s4, 2048
  v_mad_u32_u24 v4, v2, s4, v10
  v_add_u32 v5, 15360, v4
  v_add_u32 v6, 30720, v4
  v_add_u32 v7, 46080, v4
  s_lshl_b32 s5, s78, Lz1-Lz0+7
  s_mul_i32 s4, s79, 3670016
  s_add_u32 s5, s5, s4
  s_lshl_b32 s94, s79, 8
  s_sub_u32 s94, 128, s94
  v_subrev_u32 v2, 2, v1
  v_cmp_le_u32 vcc, 28, v1
  s_nop 1
  v_cndmask_b32 v13, v1, v2, vcc
  v_subrev_u32 v3, 3, v13
  v_mov_b32 v12, 4
  v_cmp_le_u32 vcc, 14, v13
  v_subrev_u32 v2, 14, v13
  s_nop 0
  v_cndmask_b32 v3, v3, v2, vcc
  v_cndmask_b32_e64 v12, v12, 12, vcc
  v_cmp_le_u32 vcc, 21, v13
  v_subrev_u32 v2, 21, v13
  s_nop 0
  v_cndmask_b32 v3, v3, v2, vcc
  v_cndmask_b32_e64 v12, v12, 20, vcc
  s_sub_u32 s4, s80, s76
  s_and_b32 s4, s4, 7
  v_cmp_le_u32 vcc, s4, v3
  v_mov_b32 v2, s76
  s_nop 0
  v_addc_co_u32 v3, vcc, v3, v2, vcc
  v_and_b32 v3, 7, v3
  v_add_u32 v12, v12, v3
  v_add_u32 v2, v2, v1
  v_and_b32 v2, 3, v2
  v_subrev_u32 v3, 10, v1
  v_cmp_gt_u32 vcc, 4, v3
  s_nop 1
  v_cndmask_b32 v12, v12, v2, vcc
  s_add_u32 s4, s80, Lz1-Lz0+4
  v_lshl_add_u32 v2, v1, 3, s4
  v_cmp_gt_u32 vcc, 3, v1
  s_nop 1
  v_cndmask_b32 v12, v12, v2, vcc
  v_subrev_u32 v2, 4, v12
  v_and_b32 v3, 7, v2
  v_lshrrev_b32 v2, 3, v2
  v_mad_u32_u24 v2, v3, 7, v2
  v_and_b32 v3, 1, v3
  v_add_u32 v2, v2, v3
  s_mul_i32 s4, s85, 3
  v_add_u32 v2, s4, v2
  s_add_u32 s4, s85, Lz1-Lz0+6
  v_mad_u32_u24 v3, v12, 14, s4
  v_cmp_gt_u32 vcc, 4, v12
  s_nop 1
  v_cndmask_b32_e64 v2, v2, v3, vcc
  v_lshl_add_u32 v12, v2, 16, s5
  s_mul_i32 s4, s79, 7340032
  s_sub_u32 s4, 3670016, s4
  v_add_u32 v2, s4, v12
  v_cmp_le_u32 vcc, 28, v1
  s_nop 1
  v_cndmask_b32 v12, v12, v2, vcc
  s_lshl_b32 s11, s85, Lz1-Lz0+12
  s_add_u32 s11, s11, 65536
  s_add_u32 s15, s11, 81920
  s_add_u32 s11, s11, 49152
  v_readfirstlane_b32 s7, v12
  s_mov_b32 s12, 0
  s_mov_b32 m0, s11
  s_waitcnt vmcnt(14)
  s_barrier
  s_waitcnt vmcnt(0)
  s_barrier
  s_branch Ll_68
  s_nop 0
Lt_73:
  s_cmp_lg_u32 s12, 2
  s_cbranch_scc1 Ll_68
  s_barrier
Ll_68:
  buffer_load_dwordx4 v4, s[60:63], s7 offen offset:0  lds
  buffer_load_dwordx4 v5, s[60:63], s7 offen offset:1024  lds
  buffer_load_dwordx4 v6, s[60:63], s7 offen offset:2048  lds
  buffer_load_dwordx4 v7, s[60:63], s7 offen offset:3072  lds
  s_add_u32 m0, s11, 8192
  s_add_u32 s5, s7, s94
  buffer_load_dwordx4 v4, s[60:63], s5 offen offset:0  lds
  s_add_u32 s12, s12, 1
  v_readlane_b32 s7, v12, s12
  s_add_u32 s11, s11, 16384
  buffer_load_dwordx4 v5, s[60:63], s5 offen offset:1024  lds
  s_cmp_eq_u32 s11, s15
  s_cselect_b32 s4, 81920, 0
  s_sub_u32 s11, s11, s4
  buffer_load_dwordx4 v6, s[60:63], s5 offen offset:2048  lds
  s_cmp_lg_u32 s12, Lz1-Lz0+5
  buffer_load_dwordx4 v7, s[60:63], s5 offen offset:3072  lds
  s_mov_b32 m0, s11
  s_cbranch_scc1 Lt_73
Lt_74:
  v_lshrrev_b32 v2, 3, v1
  s_movk_i32 s4, 6144
  v_mad_u32_u24 v16, v2, s4, v10
  v_add_u32 v17, 48128, v16
  v_add_u32 v18, 96256, v16
  v_add_u32 v19, 144384, v16
  s_lshl_b32 s5, s77, Lz1-Lz0+7
  s_mul_i32 s4, s85, 196608
  s_add_u32 s5, s5, s4
  s_and_b32 s4, s76, 7
  s_add_u32 s6, s4, 1
  v_cmp_lt_u32 vcc, s6, v1
  v_add_u32 v20, s4, v1
  s_nop 0
  v_subbrev_co_u32 v20, vcc, 0, v20, vcc
  v_and_b32 v20, 7, v20
  v_subrev_u32 v2, 9, v1
  v_cmp_le_u32 vcc, s4, v2
  s_nop 1
  v_addc_co_u32 v2, vcc, 8, v2, vcc
  v_cmp_le_u32 vcc, 9, v1
  s_nop 1
  v_cndmask_b32 v20, v20, v2, vcc
  s_add_u32 s4, s4, 8
  s_mov_b32 m0, s6
  s_nop 0
  v_writelane_b32 v20, s4, m0
  s_and_b32 s4, s76, 8
  v_xor_b32 v20, s4, v20
  v_cmp_eq_u32 vcc, s78, v20
  s_nop 0
  v_mov_b32_dpp v2, v20 row_shr:1 row_mask:0xf bank_mask:0xf
  s_ff1_i32_b32 s4, vcc_lo
  v_cmp_ge_u32 vcc, s4, v1
  s_nop 1
  v_cndmask_b32 v20, v20, v2, vcc
  v_writelane_b32 v20, s78, 0
  s_mov_b32 s4, 393216
  v_mul_u32_u24_e64 v20, s4, v20
  v_add_u32 v20, s5, v20
  s_mov_b32 m0, s11
  s_waitcnt vmcnt(32)
  s_barrier
  s_waitcnt vmcnt(24)
  s_barrier
  buffer_load_dwordx4 v4, s[60:63], s7 offen offset:0  lds
  buffer_load_dwordx4 v5, s[60:63], s7 offen offset:1024  lds
  buffer_load_dwordx4 v6, s[60:63], s7 offen offset:2048  lds
  buffer_load_dwordx4 v7, s[60:63], s7 offen offset:3072  lds
Ll_75:
  s_add_u32 m0, s11, 8192
  s_add_u32 s5, s7, s94
  buffer_load_dwordx4 v4, s[60:63], s5 offen offset:0  lds
  s_add_u32 s12, s12, 1
  v_readlane_b32 s7, v12, s12
  s_add_u32 s11, s11, 16384
  buffer_load_dwordx4 v5, s[60:63], s5 offen offset:1024  lds
  s_cmp_eq_u32 s11, s15
  s_cselect_b32 s4, 81920, 0
  s_sub_u32 s11, s11, s4
  buffer_load_dwordx4 v6, s[60:63], s5 offen offset:2048  lds
  s_cmp_eq_u32 s12, Lz1-Lz0+26
  buffer_load_dwordx4 v7, s[60:63], s5 offen offset:3072  lds
  s_mov_b32 m0, s11
  s_cbranch_scc1 Ll_76
  s_waitcnt vmcnt(24)
  s_barrier
  buffer_load_dwordx4 v4, s[60:63], s7 offen offset:0  lds
  buffer_load_dwordx4 v5, s[60:63], s7 offen offset:1024  lds
  buffer_load_dwordx4 v6, s[60:63], s7 offen offset:2048  lds
  buffer_load_dwordx4 v7, s[60:63], s7 offen offset:3072  lds
  s_branch Ll_75
  s_nop 0
Ll_76:
  s_waitcnt vmcnt(24)
  s_barrier
  buffer_load_dwordx4 v4, s[60:63], s7 offen offset:0  lds
Ll_77:
  s_mov_b32 s5, s7
  buffer_load_dwordx4 v5, s[60:63], s5 offen offset:1024  lds
  s_add_u32 s12, s12, 1
  v_readlane_b32 s7, v12, s12
  s_add_u32 s11, s11, 16384
  s_nop 0
  s_cmp_eq_u32 s11, s15
  buffer_load_dwordx4 v6, s[60:63], s5 offen offset:2048  lds
  s_cselect_b32 s4, 81920, 0
  s_sub_u32 s11, s11, s4
  s_cmp_eq_u32 s12, 30
  buffer_load_dwordx4 v7, s[60:63], s5 offen offset:3072  lds
  s_mov_b32 m0, s11
  s_cbranch_scc1 Ll_78
  s_waitcnt vmcnt(12)
  s_barrier
  buffer_load_dwordx4 v4, s[60:63], s7 offen offset:0  lds
  s_branch Ll_77
  s_nop 0
Ll_78:
  v_readfirstlane_b32 s7, v20
  s_lshl_b32 s11, s85, 12
  s_add_u32 s11, s11, 65536
  s_add_u32 s15, s11, 73728
  s_cmp_eq_u32 s82, 0
  s_mov_b32 s82, 1
  s_cbranch_scc1 L_wlayer
  s_waitcnt vmcnt(12)
  s_barrier
  s_waitcnt vmcnt(8)
  s_barrier
  s_waitcnt vmcnt(4)
  s_barrier
  s_waitcnt vmcnt(0)
  s_barrier
  s_barrier
  s_branch L_lend
L_x1:
  s_cmp_lg_u32 s82, 0
  s_cbranch_scc1 L_86
  s_and_b32 s80, s77, 7
  s_lshr_b32 s79, s77, 3
  s_lshl_b32 s78, s80, 1
  s_add_u32 s78, s78, s79
  s_lshl_b32 s5, s76, 4
  s_add_u32 s5, s5, s77
  s_lshl_b32 s84, s5, 11
  s_mov_b32 s83, 3145728
  s_mov_b32 s87, 1835016
  s_lshr_b32 s86, s81, 1
  v_lshlrev_b32 v4, 4, v1
  v_lshlrev_b32 v5, 4, v1
  v_lshlrev_b32 v6, 4, v1
  v_lshlrev_b32 v7, 4, v1
  s_movk_i32 s13, 4096
  s_movk_i32 s95, 8192
  v_and_b32 v2, 31, v1
  v_lshlrev_b32 v8, 7, v2
L_86:
  s_mov_b32 s40, s38
  s_and_b32 s41, s39, 0xffff
  s_mov_b32 s42, 100663296
  s_mov_b32 s43, 0x00020000
  s_mov_b32 s72, s40
  s_mov_b32 s73, s41
  s_mov_b32 s74, s42
  s_mov_b32 s11, 0
  s_mov_b32 s15, 65536
  s_mul_i32 s5, s76, 16
  s_lshl_b32 s5, s5, 14
  s_add_u32 s5, s5, 3145728
  s_mul_i32 s4, s76, 14
  s_lshr_b32 s4, s4, 4
  v_add_u32 v9, s4, v1
  v_subrev_u32 v2, 14, v9
  v_min_u32 v9, v9, v2
  v_cmp_le_u32 vcc, 14, v1
  s_nop 1
  v_cndmask_b32 v9, v9, v1, vcc
  v_lshlrev_b32_e64 v9, 2, v9
  v_mov_b32 v2, 0x87654210
  v_mov_b32 v3, 0xb3fedca9
  v_lshrrev_b64 v[2:3], v9, v[2:3]
  v_and_b32_e64 v9, 15, v2
  v_cmp_eq_u32 vcc, s77, v9
  s_nop 0
  v_mov_b32_dpp v2, v9 row_shr:1 row_mask:0xf bank_mask:0xf
  s_ff1_i32_b32 s4, vcc_lo
  v_cmp_ge_u32 vcc, s4, v1
  s_nop 1
  v_cndmask_b32 v9, v9, v2, vcc
  v_writelane_b32 v9, s77, 0
  v_lshlrev_b32 v11, 7, v9
  v_lshl_add_u32 v9, v9, 14, s5
  s_nop 0
  v_readlane_b32 s7, v9, 1
  s_mov_b32 s11, 16384
  s_mov_b32 s90, 0xfe
  s_lshl_b32 s91, s84, Lz1-Lz0+1
  s_add_u32 s91, s91, s87
  s_barrier
  s_mov_b32 s89, 200000
  s_mov_b32 exec_lo, s90
  s_mov_b32 exec_hi, 0
  buffer_load_dword v12, v11, s[40:43], s91 offen sc0 sc1
Lp_87:
  s_waitcnt vmcnt(0)
  v_cmp_ne_u32 vcc, 0, v12
  s_andn2_b32 s3, exec_lo, vcc_lo
  s_cbranch_scc0 Lp_88
  s_mov_b32 exec_lo, s3
  s_sleep 1
  buffer_load_dword v12, v11, s[40:43], s91 offen sc0 sc1
  s_sub_u32 s89, s89, 1
  s_cbranch_scc0 Lp_87
Lp_88:
  s_mov_b64 exec, -1
  s_mov_b32 s12, 1
  s_mov_b32 m0, s11
Ll_90:
  s_nop 0
  buffer_load_dwordx4 v4, s[40:43], s7 offen offset:0 sc1 lds
  buffer_load_dwordx4 v5, s[40:43], s7 offen offset:1024 sc1 lds
  buffer_load_dwordx4 v6, s[40:43], s7 offen offset:2048 sc1 lds
  buffer_load_dwordx4 v7, s[40:43], s7 offen offset:3072 sc1 lds
  s_add_u32 m0, s11, 4096
  s_nop 0
  s_add_u32 s5, s7, s13
  buffer_load_dwordx4 v4, s[40:43], s5 offen offset:0 sc1 lds
  buffer_load_dwordx4 v5, s[40:43], s5 offen offset:1024 sc1 lds
  buffer_load_dwordx4 v6, s[40:43], s5 offen offset:2048 sc1 lds
  buffer_load_dwordx4 v7, s[40:43], s5 offen offset:3072 sc1 lds
  s_add_u32 m0, s11, 8192
  s_nop 0
  s_add_u32 s3, s7, s95
  buffer_load_dwordx4 v4, s[40:43], s3 offen offset:0 sc1 lds
  buffer_load_dwordx4 v5, s[40:43], s3 offen offset:1024 sc1 lds
  buffer_load_dwordx4 v6, s[40:43], s3 offen offset:2048 sc1 lds
  buffer_load_dwordx4 v7, s[40:43], s3 offen offset:3072 sc1 lds
  s_add_u32 m0, s11, 12288
  s_add_u32 s5, s3, s13
  buffer_load_dwordx4 v4, s[40:43], s5 offen offset:0 sc1 lds
  s_add_u32 s12, s12, 1
  v_readlane_b32 s7, v9, s12
  s_add_u32 s11, s11, 16384
  buffer_load_dwordx4 v5, s[40:43], s5 offen offset:1024 sc1 lds
  s_cmp_eq_u32 s11, s15
  s_cselect_b32 s4, 65536, 0
  s_sub_u32 s11, s11, s4
  buffer_load_dwordx4 v6, s[40:43], s5 offen offset:2048 sc1 lds
  s_cmp_lg_u32 s12, Lz1-Lz0+4
  buffer_load_dwordx4 v7, s[40:43], s5 offen offset:3072 sc1 lds
  s_mov_b32 m0, s11
  s_cbranch_scc1 Ll_90
  s_waitcnt vmcnt(32)
  s_barrier
  buffer_load_dwordx4 v4, s[40:43], s7 offen offset:0 sc1 lds
  buffer_load_dwordx4 v5, s[40:43], s7 offen offset:1024 sc1 lds
  buffer_load_dwordx4 v6, s[40:43], s7 offen offset:2048 sc1 lds
  buffer_load_dwordx4 v7, s[40:43], s7 offen offset:3072 sc1 lds
  s_add_u32 m0, s11, 8192
  s_add_u32 s3, s7, s95
  buffer_load_dwordx4 v4, s[40:43], s3 offen offset:0 sc1 lds
  s_add_u32 s12, s12, 1
  v_readlane_b32 s7, v9, s12
  buffer_load_dwordx4 v5, s[40:43], s3 offen offset:1024 sc1 lds
  s_add_u32 s11, s11, 16384
  s_nop 0
  s_cmp_eq_u32 s11, s15
  buffer_load_dwordx4 v6, s[40:43], s3 offen offset:2048 sc1 lds
  s_cselect_b32 s4, 65536, 0
  s_sub_u32 s11, s11, s4
  buffer_load_dwordx4 v7, s[40:43], s3 offen offset:3072 sc1 lds
  s_mov_b32 m0, s11
  s_waitcnt vmcnt(24)
  s_barrier
  buffer_load_dwordx4 v4, s[40:43], s7 offen offset:0 sc1 lds
  buffer_load_dwordx4 v5, s[40:43], s7 offen offset:1024 sc1 lds
  buffer_load_dwordx4 v6, s[40:43], s7 offen offset:2048 sc1 lds
  buffer_load_dwordx4 v7, s[40:43], s7 offen offset:3072 sc1 lds
Ll_94:
  s_add_u32 m0, s11, 8192
  s_add_u32 s3, s7, s95
  buffer_load_dwordx4 v4, s[40:43], s3 offen offset:0 sc1 lds
  s_add_u32 s12, s12, 1
  v_readlane_b32 s7, v9, s12
  s_add_u32 s11, s11, 16384
  buffer_load_dwordx4 v5, s[40:43], s3 offen offset:1024 sc1 lds
  s_cmp_eq_u32 s11, s15
  s_cselect_b32 s4, 65536, 0
  s_sub_u32 s11, s11, s4
  buffer_load_dwordx4 v6, s[40:43], s3 offen offset:2048 sc1 lds
  s_cmp_eq_u32 s12, Lz1-Lz0+16
  buffer_load_dwordx4 v7, s[40:43], s3 offen offset:3072 sc1 lds
  s_mov_b32 m0, s11
  s_cbranch_scc1 Ll_95
  s_waitcnt vmcnt(16)
  s_barrier
  buffer_load_dwordx4 v4, s[40:43], s7 offen offset:0 sc1 lds
  buffer_load_dwordx4 v5, s[40:43], s7 offen offset:1024 sc1 lds
  buffer_load_dwordx4 v6, s[40:43], s7 offen offset:2048 sc1 lds
  buffer_load_dwordx4 v7, s[40:43], s7 offen offset:3072 sc1 lds
  s_branch Ll_94
  s_nop 0
Ll_95:
  s_waitcnt vmcnt(16)
  s_barrier
  s_waitcnt vmcnt(8)
  s_barrier
  s_waitcnt vmcnt(0)
  s_barrier
  s_barrier
  s_mov_b32 s11, 0
  s_mov_b32 s15, 65536
  s_mul_i32 s5, s76, 16
  s_lshl_b32 s5, s5, 14
  s_add_u32 s5, s5, 7340032
  s_and_b32 s4, s76, 7
  s_add_u32 s6, s4, 1
  v_cmp_lt_u32 vcc, s6, v1
  v_add_u32 v9, s4, v1
  s_nop 0
  v_subbrev_co_u32 v9, vcc, 0, v9, vcc
  v_and_b32 v9, 7, v9
  v_subrev_u32 v2, 9, v1
  v_cmp_le_u32 vcc, s4, v2
  s_nop 1
  v_addc_co_u32 v2, vcc, 8, v2, vcc
  v_cmp_le_u32 vcc, 9, v1
  s_nop 1
  v_cndmask_b32 v9, v9, v2, vcc
  s_add_u32 s4, s4, Lz1-Lz0+8
  s_mov_b32 m0, s6
  s_nop 0
  v_writelane_b32 v9, s4, m0
  s_and_b32 s4, s76, 8
  v_xor_b32 v9, s4, v9
  v_cmp_eq_u32 vcc, s78, v9
  s_nop 0
  v_mov_b32_dpp v2, v9 row_shr:1 row_mask:0xf bank_mask:0xf
  s_ff1_i32_b32 s4, vcc_lo
  v_cmp_ge_u32 vcc, s4, v1
  s_nop 1
  v_cndmask_b32 v9, v9, v2, vcc
  v_writelane_b32 v9, s78, 0
  v_lshlrev_b32_e64 v11, 7, v9
  v_lshl_add_u32 v9, v9, 14, s5
  s_lshl_b32 s6, s76, Lz1-Lz0+14
  v_readlane_b32 s7, v9, 1
  s_mov_b32 s11, 16384
  s_mov_b32 s90, Lz1-Lz0+62
  s_add_u32 s91, s91, 4
  s_barrier
  s_mov_b32 s89, 200000
  s_mov_b32 exec_lo, s90
  s_mov_b32 exec_hi, 0
  buffer_load_dword v12, v11, s[40:43], s91 offen sc0 sc1
Lp_96:
  s_waitcnt vmcnt(0)
  v_cmp_ne_u32 vcc, 0, v12
  s_andn2_b32 s3, exec_lo, vcc_lo
  s_cbranch_scc0 Lp_97
  s_mov_b32 exec_lo, s3
  s_sleep 1
  buffer_load_dword v12, v11, s[40:43], s91 offen sc0 sc1
  s_sub_u32 s89, s89, 1
  s_cbranch_scc0 Lp_96
Lp_97:
  s_mov_b64 exec, -1
  s_mov_b32 s12, 1
  s_mov_b32 m0, s11
Ll_99:
  s_nop 0
  buffer_load_dwordx4 v4, s[72:75], s7 offen offset:0 sc1 lds
  buffer_load_dwordx4 v5, s[72:75], s7 offen offset:1024 sc1 lds
  buffer_load_dwordx4 v6, s[72:75], s7 offen offset:2048 sc1 lds
  buffer_load_dwordx4 v7, s[72:75], s7 offen offset:3072 sc1 lds
  s_add_u32 m0, s11, 4096
  s_nop 0
  s_add_u32 s5, s7, s13
  buffer_load_dwordx4 v4, s[72:75], s5 offen offset:0 sc1 lds
  buffer_load_dwordx4 v5, s[72:75], s5 offen offset:1024 sc1 lds
  buffer_load_dwordx4 v6, s[72:75], s5 offen offset:2048 sc1 lds
  buffer_load_dwordx4 v7, s[72:75], s5 offen offset:3072 sc1 lds
  s_add_u32 m0, s11, 8192
  s_nop 0
  s_add_u32 s3, s7, s95
  buffer_load_dwordx4 v4, s[72:75], s3 offen offset:0 sc1 lds
  buffer_load_dwordx4 v5, s[72:75], s3 offen offset:1024 sc1 lds
  buffer_load_dwordx4 v6, s[72:75], s3 offen offset:2048 sc1 lds
  buffer_load_dwordx4 v7, s[72:75], s3 offen offset:3072 sc1 lds
  s_add_u32 m0, s11, 12288
  s_add_u32 s5, s3, s13
  buffer_load_dwordx4 v4, s[72:75], s5 offen offset:0 sc1 lds
  s_add_u32 s12, s12, 1
  v_readlane_b32 s7, v9, s12
  s_add_u32 s11, s11, 16384
  buffer_load_dwordx4 v5, s[72:75], s5 offen offset:1024 sc1 lds
  s_cmp_eq_u32 s11, s15
  s_cselect_b32 s4, 65536, 0
  s_sub_u32 s11, s11, s4
  buffer_load_dwordx4 v6, s[72:75], s5 offen offset:2048 sc1 lds
  s_cmp_lg_u32 s12, Lz1-Lz0+4
  buffer_load_dwordx4 v7, s[72:75], s5 offen offset:3072 sc1 lds
  s_mov_b32 m0, s11
  s_cbranch_scc1 Ll_99
  s_waitcnt vmcnt(32)
  s_barrier
  buffer_load_dwordx4 v4, s[72:75], s7 offen offset:0 sc1 lds
  buffer_load_dwordx4 v5, s[72:75], s7 offen offset:1024 sc1 lds
  buffer_load_dwordx4 v6, s[72:75], s7 offen offset:2048 sc1 lds
  buffer_load_dwordx4 v7, s[72:75], s7 offen offset:3072 sc1 lds
Ll_103:
  s_add_u32 m0, s11, 4096
  s_nop 0
  s_add_u32 s5, s7, s13
  buffer_load_dwordx4 v4, s[72:75], s5 offen offset:0 sc1 lds
  buffer_load_dwordx4 v5, s[72:75], s5 offen offset:1024 sc1 lds
  buffer_load_dwordx4 v6, s[72:75], s5 offen offset:2048 sc1 lds
  buffer_load_dwordx4 v7, s[72:75], s5 offen offset:3072 sc1 lds
  s_add_u32 m0, s11, 8192
  s_nop 0
  s_add_u32 s3, s7, s95
  buffer_load_dwordx4 v4, s[72:75], s3 offen offset:0 sc1 lds
  buffer_load_dwordx4 v5, s[72:75], s3 offen offset:1024 sc1 lds
  buffer_load_dwordx4 v6, s[72:75], s3 offen offset:2048 sc1 lds
  buffer_load_dwordx4 v7, s[72:75], s3 offen offset:3072 sc1 lds
  s_add_u32 m0, s11, 12288
  s_add_u32 s5, s3, s13
  buffer_load_dwordx4 v4, s[72:75], s5 offen offset:0 sc1 lds
  s_add_u32 s12, s12, 1
  v_readlane_b32 s7, v9, s12
  s_add_u32 s11, s11, 16384
  buffer_load_dwordx4 v5, s[72:75], s5 offen offset:1024 sc1 lds
  s_cmp_eq_u32 s11, s15
  s_cselect_b32 s4, 65536, 0
  s_sub_u32 s11, s11, s4
  buffer_load_dwordx4 v6, s[72:75], s5 offen offset:2048 sc1 lds
  s_cmp_eq_u32 s12, Lz1-Lz0+16
  buffer_load_dwordx4 v7, s[72:75], s5 offen offset:3072 sc1 lds
  s_mov_b32 m0, s11
  s_cbranch_scc1 Ll_104
  s_waitcnt vmcnt(32)
  s_barrier
  buffer_load_dwordx4 v4, s[72:75], s7 offen offset:0 sc1 lds
  buffer_load_dwordx4 v5, s[72:75], s7 offen offset:1024 sc1 lds
  buffer_load_dwordx4 v6, s[72:75], s7 offen offset:2048 sc1 lds
  buffer_load_dwordx4 v7, s[72:75], s7 offen offset:3072 sc1 lds
  s_branch Ll_103
  s_nop 0
Ll_104:
  s_waitcnt vmcnt(32)
  s_barrier
  s_waitcnt vmcnt(16)
  s_barrier
  s_waitcnt vmcnt(0)
  s_barrier
  s_barrier
  s_mov_b32 s11, 0
  s_mov_b32 s15, 65536
  s_mul_i32 s5, s76, 56
  s_mul_i32 s4, s79, 28
  s_add_u32 s5, s5, s4
  s_lshl_b32 s5, s5, 14
  s_add_u32 s5, s5, 11534336
  v_subrev_u32 v2, 2, v1
  v_cmp_le_u32 vcc, 28, v1
  s_nop 1
  v_cndmask_b32 v10, v1, v2, vcc
  v_subrev_u32 v3, 3, v10
  v_mov_b32 v9, 4
  v_cmp_le_u32 vcc, 14, v10
  v_subrev_u32 v2, 14, v10
  s_nop 0
  v_cndmask_b32 v3, v3, v2, vcc
  v_cndmask_b32_e64 v9, v9, 12, vcc
  v_cmp_le_u32 vcc, 21, v10
  v_subrev_u32 v2, 21, v10
  s_nop 0
  v_cndmask_b32 v3, v3, v2, vcc
  v_cndmask_b32_e64 v9, v9, 20, vcc
  s_sub_u32 s4, s80, s76
  s_and_b32 s4, s4, 7
  v_cmp_le_u32 vcc, s4, v3
  v_mov_b32 v2, s76
  s_nop 0
  v_addc_co_u32 v3, vcc, v3, v2, vcc
  v_and_b32 v3, 7, v3
  v_add_u32 v9, v9, v3
  v_add_u32 v2, v2, v1
  v_and_b32 v2, 3, v2
  v_subrev_u32 v3, 10, v1
  v_cmp_gt_u32 vcc, 4, v3
  s_nop 1
  v_cndmask_b32 v9, v9, v2, vcc
  s_add_u32 s4, s80, Lz1-Lz0+4
  v_lshl_add_u32 v2, v1, 3, s4
  v_cmp_gt_u32 vcc, 3, v1
  s_nop 1
  v_cndmask_b32_e64 v9, v9, v2, vcc
  v_lshl_add_u32 v9, v9, 14, s5
  s_mul_i32 s4, s79, 917504
  s_sub_u32 s4, 458752, s4
  v_add_u32_e64 v2, s4, v9
  v_cmp_le_u32 vcc, 28, v1
  s_nop 1
  v_cndmask_b32 v9, v9, v2, vcc
  s_nop 0
  v_readlane_b32 s7, v9, 3
  s_mov_b32 s11, 49152
  s_add_u32 s91, s91, 4
  s_lshl_b32 s4, s79, 3
  s_lshl_b32 s90, 0xff, s4
  s_bitset0_b32 s90, s77
  s_mov_b32 s89, 200000
  s_mov_b32 exec_lo, s90
  s_mov_b32 exec_hi, Lz1-Lz0+0
  buffer_load_dword v12, v8, s[40:43], s91 offen sc0 sc1
Lp_105:
  s_waitcnt vmcnt(0)
  v_cmp_ne_u32 vcc, 0, v12
  s_andn2_b32 s3, exec_lo, vcc_lo
  s_cbranch_scc0 Lp_106
  s_mov_b32 exec_lo, s3
  s_sleep 1
  buffer_load_dword v12, v8, s[40:43], s91 offen sc0 sc1
  s_sub_u32 s89, s89, 1
  s_cbranch_scc0 Lp_105
Lp_106:
  s_mov_b64 exec, -1
  s_mov_b32 s12, 3
  s_mov_b32 m0, s11
Ll_108:
  s_nop 0
  buffer_load_dwordx4 v4, s[40:43], s7 offen offset:0 sc1 lds
  buffer_load_dwordx4 v5, s[40:43], s7 offen offset:1024 sc1 lds
  buffer_load_dwordx4 v6, s[40:43], s7 offen offset:2048 sc1 lds
  buffer_load_dwordx4 v7, s[40:43], s7 offen offset:3072 sc1 lds
  s_add_u32 m0, s11, 4096
  s_nop 0
  s_add_u32 s5, s7, s13
  buffer_load_dwordx4 v4, s[40:43], s5 offen offset:0 sc1 lds
  buffer_load_dwordx4 v5, s[40:43], s5 offen offset:1024 sc1 lds
  buffer_load_dwordx4 v6, s[40:43], s5 offen offset:2048 sc1 lds
  buffer_load_dwordx4 v7, s[40:43], s5 offen offset:3072 sc1 lds
  s_add_u32 m0, s11, 8192
  s_nop 0
  s_add_u32 s3, s7, s95
  buffer_load_dwordx4 v4, s[40:43], s3 offen offset:0 sc1 lds
  buffer_load_dwordx4 v5, s[40:43], s3 offen offset:1024 sc1 lds
  buffer_load_dwordx4 v6, s[40:43], s3 offen offset:2048 sc1 lds
  buffer_load_dwordx4 v7, s[40:43], s3 offen offset:3072 sc1 lds
  s_add_u32 m0, s11, 12288
  s_add_u32 s5, s3, s13
  buffer_load_dwordx4 v4, s[40:43], s5 offen offset:0 sc1 lds
  s_add_u32 s12, s12, 1
  v_readlane_b32 s7, v9, s12
  s_add_u32 s11, s11, 16384
  buffer_load_dwordx4 v5, s[40:43], s5 offen offset:1024 sc1 lds
  s_cmp_eq_u32 s11, s15
  s_cselect_b32 s4, 65536, 0
  s_sub_u32 s11, s11, s4
  buffer_load_dwordx4 v6, s[40:43], s5 offen offset:2048 sc1 lds
  s_cmp_lg_u32 s12, Lz1-Lz0+4
  buffer_load_dwordx4 v7, s[40:43], s5 offen offset:3072 sc1 lds
  s_mov_b32 m0, s11
  s_cbranch_scc1 Ll_108
  s_waitcnt vmcnt(48)
  s_barrier
  s_waitcnt vmcnt(32)
  s_barrier
  buffer_load_dwordx4 v4, s[40:43], s7 offen offset:0 sc1 lds
  buffer_load_dwordx4 v5, s[40:43], s7 offen offset:1024 sc1 lds
  buffer_load_dwordx4 v6, s[40:43], s7 offen offset:2048 sc1 lds
  buffer_load_dwordx4 v7, s[40:43], s7 offen offset:3072 sc1 lds
Ll_112:
  s_add_u32 m0, s11, 4096
  s_nop 0
  s_add_u32 s5, s7, s13
  buffer_load_dwordx4 v4, s[40:43], s5 offen offset:0 sc1 lds
  buffer_load_dwordx4 v5, s[40:43], s5 offen offset:1024 sc1 lds
  buffer_load_dwordx4 v6, s[40:43], s5 offen offset:2048 sc1 lds
  buffer_load_dwordx4 v7, s[40:43], s5 offen offset:3072 sc1 lds
  s_add_u32 m0, s11, 8192
  s_nop 0
  s_add_u32 s3, s7, s95
  buffer_load_dwordx4 v4, s[40:43], s3 offen offset:0 sc1 lds
  buffer_load_dwordx4 v5, s[40:43], s3 offen offset:1024 sc1 lds
  buffer_load_dwordx4 v6, s[40:43], s3 offen offset:2048 sc1 lds
  buffer_load_dwordx4 v7, s[40:43], s3 offen offset:3072 sc1 lds
  s_add_u32 m0, s11, 12288
  s_add_u32 s5, s3, s13
  buffer_load_dwordx4 v4, s[40:43], s5 offen offset:0 sc1 lds
  s_add_u32 s12, s12, 1
  v_readlane_b32 s7, v9, s12
  s_add_u32 s11, s11, 16384
  buffer_load_dwordx4 v5, s[40:43], s5 offen offset:1024 sc1 lds
  s_cmp_eq_u32 s11, s15
  s_cselect_b32 s4, 65536, 0
  s_sub_u32 s11, s11, s4
  buffer_load_dwordx4 v6, s[40:43], s5 offen offset:2048 sc1 lds
  s_cmp_eq_u32 s12, Lz1-Lz0+30
  buffer_load_dwordx4 v7, s[40:43], s5 offen offset:3072 sc1 lds
  s_mov_b32 m0, s11
  s_cbranch_scc1 Ll_113
  s_waitcnt vmcnt(32)
  s_barrier
  buffer_load_dwordx4 v4, s[40:43], s7 offen offset:0 sc1 lds
  buffer_load_dwordx4 v5, s[40:43], s7 offen offset:1024 sc1 lds
  buffer_load_dwordx4 v6, s[40:43], s7 offen offset:2048 sc1 lds
  buffer_load_dwordx4 v7, s[40:43], s7 offen offset:3072 sc1 lds
  s_branch Ll_112
  s_nop 0
Ll_113:
  s_waitcnt vmcnt(32)
  s_barrier
  s_waitcnt vmcnt(16)
  s_barrier
  s_waitcnt vmcnt(0)
  s_barrier
  s_barrier
  s_cmp_lg_u32 s82, 0
  s_cbranch_scc1 L_lend
  s_mov_b32 s11, 0
  s_mov_b32 s15, 65536
  s_mul_i32 s5, s76, 16
  s_lshl_b32 s5, s5, 14
  s_add_u32 s5, s5, 35651584
  s_and_b32 s4, s76, 7
  s_add_u32 s6, s4, 1
  v_cmp_lt_u32 vcc, s6, v1
  v_add_u32 v9, s4, v1
  s_nop 0
  v_subbrev_co_u32 v9, vcc, 0, v9, vcc
  v_and_b32 v9, 7, v9
  v_subrev_u32 v2, 9, v1
  v_cmp_le_u32 vcc, s4, v2
  s_nop 1
  v_addc_co_u32 v2, vcc, 8, v2, vcc
  v_cmp_le_u32 vcc, 9, v1
  s_nop 1
  v_cndmask_b32 v9, v9, v2, vcc
  s_add_u32 s4, s4, Lz1-Lz0+8
  s_mov_b32 m0, s6
  s_nop 0
  v_writelane_b32 v9, s4, m0
  s_and_b32 s4, s76, 8
  v_xor_b32 v9, s4, v9
  v_cmp_eq_u32 vcc, s78, v9
  s_nop 0
  v_mov_b32_dpp v2, v9 row_shr:1 row_mask:0xf bank_mask:0xf
  s_ff1_i32_b32 s4, vcc_lo
  v_cmp_ge_u32 vcc, s4, v1
  s_nop 1
  v_cndmask_b32 v9, v9, v2, vcc
  v_writelane_b32 v9, s78, 0
  v_lshlrev_b32_e64 v11, 7, v9
  v_lshl_add_u32 v9, v9, 14, s5
  s_lshl_b32 s6, s76, Lz1-Lz0+14
  v_readlane_b32 s7, v9, 1
  s_mov_b32 s11, 16384
  s_add_u32 s91, s91, 8
  s_mov_b32 s90, 0x3e
  s_barrier
  s_mov_b32 s82, 1
  s_add_u32 s83, s83, 0
  s_add_u32 s87, s87, 32
  s_mov_b32 s89, 200000
  s_mov_b32 exec_lo, s90
  s_mov_b32 exec_hi, 0
  buffer_load_dword v12, v11, s[40:43], s91 offen sc0 sc1
Lp_114:
  s_waitcnt vmcnt(0)
  v_cmp_ne_u32 vcc, 0, v12
  s_andn2_b32 s3, exec_lo, vcc_lo
  s_cbranch_scc0 Lp_115
  s_mov_b32 exec_lo, s3
  s_sleep 1
  buffer_load_dword v12, v11, s[40:43], s91 offen sc0 sc1
  s_sub_u32 s89, s89, 1
  s_cbranch_scc0 Lp_114
Lp_115:
  s_mov_b64 exec, -1
  s_branch L_xlayer
  s_nop 0
L_s1:
  v_mov_b32 v11, 1
  v_mov_b32 v2, 156416
  ds_write_b128 v2, v[24:27]
  v_and_b32 v2, 31, v1
  v_lshlrev_b32 v5, 7, v2
  v_lshlrev_b32 v10, 3, v2
  v_lshrrev_b32 v3, 5, v1
  v_mul_u32_u24 v3, 320, v3
  v_add_u32_e64 v10, v3, v10
  v_add_u32 v10, 151552, v10
  v_bfe_u32 v3, v1, 3, 1
  v_and_b32 v2, 7, v1
  v_lshlrev_b32 v12, 9, v3
  v_lshl_add_u32 v12, v2, 4, v12
  v_mul_u32_u24 v3, 320, v3
  v_lshl_add_u32 v13, v2, 3, v3
  v_add_u32 v13, 151808, v13
  v_and_b32 v2, 15, v1
  v_lshlrev_b32 v8, 4, v2
  v_lshlrev_b32 v15, 6, v2
  v_and_b32 v3, 48, v1
  v_add_u32 v15, v15, v3
  v_and_b32 v2, 14, v1
  v_lshlrev_b32 v6, 2, v2
  v_lshlrev_b32 v14, 16, v1
  s_lshl_b32 s4, s77, 12
  s_lshl_b32 s5, s76, 7
  s_add_u32 s4, s4, s5
  v_add_u32 v14, s4, v14
  v_lshrrev_b32 v2, 2, v1
  v_lshlrev_b32 v22, 7, v2
  v_lshlrev_b32 v96, 6, v2
  v_and_b32 v2, 3, v1
  v_lshl_add_u32 v22, v2, 3, v22
  v_lshl_add_u32 v96, v2, 3, v96
  v_add_u32 v22, 65536, v22
  v_add_u32 v96, 90112, v96
  v_bfe_u32 v3, v1, 3, 2
  v_xor_b32_e64 v2, 0, v3
  v_lshl_add_u32 v16, v2, 5, v22
  v_xor_b32_e64 v2, 1, v3
  v_lshl_add_u32 v17, v2, 5, v22
  v_xor_b32_e64 v2, 2, v3
  v_lshl_add_u32 v18, v2, 5, v22
  v_xor_b32_e64 v2, 3, v3
  v_lshl_add_u32 v19, v2, 5, v22
  v_bfe_u32 v3, v1, 4, 1
  v_xor_b32_e64 v2, 0, v3
  v_lshl_add_u32 v20, v2, 5, v96
  v_xor_b32_e64 v2, 1, v3
  v_lshl_add_u32 v21, v2, 5, v96
  v_mov_b32 v22, 0x3f803f80
  s_mul_i32 s4, s76, 11
  s_lshr_b32 s4, s4, 5
  s_mul_i32 s4, s4, 3
  s_and_b32 s14, s76, 1
  s_mov_b32 s15, 32768
  s_mul_i32 s4, s14, 24576
  v_add_u32 v16, s4, v16
  v_add_u32 v17, s4, v17
  v_add_u32 v18, s4, v18
  v_add_u32 v19, s4, v19
  s_mov_b32 s98, 0x00010001
  s_mov_b32 s99, 0x00010001
  v_cndmask_b32_e64 v200, 0, v22, s[98:99]
  v_cndmask_b32_e64 v201, 0, v22, s[98:99]
  v_cndmask_b32_e64 v202, 0, v22, s[98:99]
  v_cndmask_b32_e64 v203, 0, v22, s[98:99]
  s_nop 0
  s_lshl_b64 s[98:99], s[98:99], 1
  v_cndmask_b32_e64 v204, 0, v22, s[98:99]
  v_cndmask_b32_e64 v205, 0, v22, s[98:99]
  v_cndmask_b32_e64 v206, 0, v22, s[98:99]
  v_cndmask_b32_e64 v207, 0, v22, s[98:99]
  s_nop 0
  s_lshl_b64 s[98:99], s[98:99], 1
  v_cndmask_b32_e64 v208, 0, v22, s[98:99]
  v_cndmask_b32_e64 v209, 0, v22, s[98:99]
  v_cndmask_b32_e64 v210, 0, v22, s[98:99]
  v_cndmask_b32_e64 v211, 0, v22, s[98:99]
  s_nop 0
  s_lshl_b64 s[98:99], s[98:99], 1
  v_cndmask_b32_e64 v212, 0, v22, s[98:99]
  v_cndmask_b32_e64 v213, 0, v22, s[98:99]
  v_cndmask_b32_e64 v214, 0, v22, s[98:99]
  v_cndmask_b32_e64 v215, 0, v22, s[98:99]
  s_nop 0
  s_lshl_b64 s[98:99], s[98:99], 1
  v_cndmask_b32_e64 v216, 0, v22, s[98:99]
  v_cndmask_b32_e64 v217, 0, v22, s[98:99]
  v_cndmask_b32_e64 v218, 0, v22, s[98:99]
  v_cndmask_b32_e64 v219, 0, v22, s[98:99]
  s_nop 0
  s_lshl_b64 s[98:99], s[98:99], 1
  v_cndmask_b32_e64 v220, 0, v22, s[98:99]
  v_cndmask_b32_e64 v221, 0, v22, s[98:99]
  v_cndmask_b32_e64 v222, 0, v22, s[98:99]
  v_cndmask_b32_e64 v223, 0, v22, s[98:99]
  s_nop 0
  s_lshl_b64 s[98:99], s[98:99], 1
  v_cndmask_b32_e64 v224, 0, v22, s[98:99]
  v_cndmask_b32_e64 v225, 0, v22, s[98:99]
  v_cndmask_b32_e64 v226, 0, v22, s[98:99]
  v_cndmask_b32_e64 v227, 0, v22, s[98:99]
  s_nop 0
  s_lshl_b64 s[98:99], s[98:99], 1
  v_cndmask_b32_e64 v228, 0, v22, s[98:99]
  v_cndmask_b32_e64 v229, 0, v22, s[98:99]
  v_cndmask_b32_e64 v230, 0, v22, s[98:99]
  v_cndmask_b32_e64 v231, 0, v22, s[98:99]
  s_nop 0
  s_lshl_b64 s[98:99], s[98:99], 1
  v_cndmask_b32_e64 v232, 0, v22, s[98:99]
  v_cndmask_b32_e64 v233, 0, v22, s[98:99]
  v_cndmask_b32_e64 v234, 0, v22, s[98:99]
  v_cndmask_b32_e64 v235, 0, v22, s[98:99]
  s_nop 0
  s_lshl_b64 s[98:99], s[98:99], 1
  v_cndmask_b32_e64 v236, 0, v22, s[98:99]
  v_cndmask_b32_e64 v237, 0, v22, s[98:99]
  v_cndmask_b32_e64 v238, 0, v22, s[98:99]
  v_cndmask_b32_e64 v239, 0, v22, s[98:99]
  s_nop 0
  s_lshl_b64 s[98:99], s[98:99], 1
  v_cndmask_b32_e64 v240, 0, v22, s[98:99]
  v_cndmask_b32_e64 v241, 0, v22, s[98:99]
  v_cndmask_b32_e64 v242, 0, v22, s[98:99]
  v_cndmask_b32_e64 v243, 0, v22, s[98:99]
  s_nop 0
  s_lshl_b64 s[98:99], s[98:99], 1
  v_cndmask_b32_e64 v244, 0, v22, s[98:99]
  v_cndmask_b32_e64 v245, 0, v22, s[98:99]
  v_cndmask_b32_e64 v246, 0, v22, s[98:99]
  v_cndmask_b32_e64 v247, 0, v22, s[98:99]
  s_lshl_b64 s[98:99], s[98:99], 1
  s_mov_b32 s56, s24
  s_and_b32 s57, s25, 0xffff
  s_mov_b32 s58, 7340032
  s_mov_b32 s59, 0x00020000
  s_nop 0
  s_mov_b32 s60, s28
  s_and_b32 s61, s29, 0xffff
  s_mov_b32 s62, 7340032
  s_mov_b32 s63, 0x00020000
  s_mul_i32 s12, s84, Lz1-Lz0+14
  s_add_u32 s12, s12, 20480
  s_mov_b32 s13, s12
  v_lshlrev_b32 v110, 7, v1
  s_mov_b32 s8, 0x00500005
  s_mov_b32 s9, 0x50000500
L_slayer:
  s_barrier
  s_cmp_lg_u32 s82, Lz1-Lz0+0
  s_cbranch_scc1 L_117
  buffer_load_dwordx4 v[128:131], v108, s[44:47], s7 offen offset:0
  buffer_load_dwordx4 v[132:135], v108, s[44:47], s7 offen offset:128
  buffer_load_dwordx4 v[136:139], v108, s[44:47], s7 offen offset:256
  buffer_load_dwordx4 v[140:143], v108, s[44:47], s7 offen offset:384
  buffer_load_dwordx4 v[144:147], v108, s[44:47], s7 offen offset:512
  buffer_load_dwordx4 v[148:151], v108, s[44:47], s7 offen offset:640
  buffer_load_dwordx4 v[152:155], v108, s[44:47], s7 offen offset:768
  buffer_load_dwordx4 v[156:159], v108, s[44:47], s7 offen offset:896
  buffer_load_dwordx4 v[160:163], v108, s[44:47], s7 offen offset:1024
  buffer_load_dwordx4 v[164:167], v108, s[44:47], s7 offen offset:1152
  buffer_load_dwordx4 v[168:171], v108, s[44:47], s7 offen offset:1280
  buffer_load_dwordx4 v[172:175], v108, s[44:47], s7 offen offset:1408
  buffer_load_dwordx4 v[176:179], v108, s[44:47], s7 offen offset:1536
  buffer_load_dwordx4 v[180:183], v108, s[44:47], s7 offen offset:1664
  buffer_load_dwordx4 v[184:187], v108, s[44:47], s7 offen offset:1792
  buffer_load_dwordx4 v[188:191], v108, s[44:47], s7 offen offset:1920
  s_waitcnt vmcnt(16)
  s_lshl_b32 s4, s76, 4
  s_mov_b64 exec, 1
  buffer_atomic_add v11, v24, s[68:71], s4 offen sc1
  s_mov_b64 exec, -1
L_117:
  s_cmp_le_u32 s14, 0
  s_cbranch_scc1 L_119
  s_barrier
L_119:
  s_cmp_le_u32 s14, 1
  s_cbranch_scc1 L_120
  s_barrier
L_120:
  s_cmp_lg_u32 s82, 0
  s_cbranch_scc1 L_121
  ds_read_b64_tr_b16 v[32:33], v16 offset:0
  ds_read_b64_tr_b16 v[34:35], v16 offset:2048
  ds_read_b64_tr_b16 v[36:37], v17 offset:0
  ds_read_b64_tr_b16 v[38:39], v17 offset:2048
  ds_read_b64_tr_b16 v[40:41], v18 offset:0
  ds_read_b64_tr_b16 v[42:43], v18 offset:2048
  ds_read_b64_tr_b16 v[44:45], v19 offset:0
  ds_read_b64_tr_b16 v[46:47], v19 offset:2048
  ds_read_b64_tr_b16 v[48:49], v16 offset:4096
  ds_read_b64_tr_b16 v[50:51], v16 offset:6144
  ds_read_b64_tr_b16 v[52:53], v17 offset:4096
  ds_read_b64_tr_b16 v[54:55], v17 offset:6144
  s_nop 0
  s_waitcnt lgkmcnt(4)
  ds_read_b64_tr_b16 v[56:57], v18 offset:4096
  ds_read_b64_tr_b16 v[58:59], v18 offset:6144
  ds_read_b64_tr_b16 v[60:61], v19 offset:4096
  ds_read_b64_tr_b16 v[62:63], v19 offset:6144
  v_add_u32 v16, 8192, v16
  v_add_u32 v17, 8192, v17
  v_add_u32 v18, 8192, v18
  v_add_u32 v19, 8192, v19
  s_nop 0
  s_waitcnt lgkmcnt(2)
  ds_read_b64_tr_b16 v[64:65], v16 offset:0
  ds_read_b64_tr_b16 v[66:67], v16 offset:2048
  ds_read_b64_tr_b16 v[68:69], v17 offset:0
  ds_read_b64_tr_b16 v[70:71], v17 offset:2048
  ds_read_b64_tr_b16 v[72:73], v18 offset:0
  ds_read_b64_tr_b16 v[74:75], v18 offset:2048
  ds_read_b64_tr_b16 v[76:77], v19 offset:0
  ds_read_b64_tr_b16 v[78:79], v19 offset:2048
  ds_read_b64_tr_b16 v[80:81], v16 offset:4096
  ds_read_b64_tr_b16 v[82:83], v16 offset:6144
  ds_read_b64_tr_b16 v[84:85], v17 offset:4096
  ds_read_b64_tr_b16 v[86:87], v17 offset:6144
  s_nop 0
  s_waitcnt lgkmcnt(4)
  ds_read_b64_tr_b16 v[88:89], v18 offset:4096
  ds_read_b64_tr_b16 v[90:91], v18 offset:6144
  ds_read_b64_tr_b16 v[92:93], v19 offset:4096
  ds_read_b64_tr_b16 v[94:95], v19 offset:6144
  v_add_u32 v16, 8192, v16
  v_add_u32 v17, 8192, v17
  v_add_u32 v18, 8192, v18
  v_add_u32 v19, 8192, v19
  v_mfma_f32_16x16x32_bf16 v[28:31], v[32:35], v[200:203], 0
  v_mfma_f32_16x16x32_bf16 v[28:31], v[36:39], v[204:207], v[28:31]
  v_mfma_f32_16x16x32_bf16 v[28:31], v[40:43], v[208:211], v[28:31]
  v_mfma_f32_16x16x32_bf16 v[28:31], v[44:47], v[212:215], v[28:31]
  v_mfma_f32_16x16x32_bf16 v[28:31], v[48:51], v[200:203], v[28:31]
  v_mfma_f32_16x16x32_bf16 v[28:31], v[52:55], v[204:207], v[28:31]
  v_mfma_f32_16x16x32_bf16 v[28:31], v[56:59], v[208:211], v[28:31]
  v_mfma_f32_16x16x32_bf16 v[28:31], v[60:63], v[212:215], v[28:31]
  s_nop 0
  s_waitcnt lgkmcnt(2)
  ds_read_b64_tr_b16 v[32:33], v16 offset:0
  ds_read_b64_tr_b16 v[34:35], v16 offset:2048
  ds_read_b64_tr_b16 v[36:37], v17 offset:0
  ds_read_b64_tr_b16 v[38:39], v17 offset:2048
  ds_read_b64_tr_b16 v[40:41], v18 offset:0
  ds_read_b64_tr_b16 v[42:43], v18 offset:2048
  ds_read_b64_tr_b16 v[44:45], v19 offset:0
  ds_read_b64_tr_b16 v[46:47], v19 offset:2048
  ds_read_b64_tr_b16 v[48:49], v16 offset:4096
  ds_read_b64_tr_b16 v[50:51], v16 offset:6144
  ds_read_b64_tr_b16 v[52:53], v17 offset:4096
  ds_read_b64_tr_b16 v[54:55], v17 offset:6144
  s_nop 0
  s_waitcnt lgkmcnt(4)
  ds_read_b64_tr_b16 v[56:57], v18 offset:4096
  ds_read_b64_tr_b16 v[58:59], v18 offset:6144
  ds_read_b64_tr_b16 v[60:61], v19 offset:4096
  ds_read_b64_tr_b16 v[62:63], v19 offset:6144
  v_mfma_f32_16x16x32_bf16 v[28:31], v[64:67], v[216:219], v[28:31]
  v_mfma_f32_16x16x32_bf16 v[28:31], v[68:71], v[220:223], v[28:31]
  v_mfma_f32_16x16x32_bf16 v[28:31], v[72:75], v[224:227], v[28:31]
  v_mfma_f32_16x16x32_bf16 v[28:31], v[76:79], v[228:231], v[28:31]
  v_mfma_f32_16x16x32_bf16 v[28:31], v[80:83], v[216:219], v[28:31]
  v_mfma_f32_16x16x32_bf16 v[28:31], v[84:87], v[220:223], v[28:31]
  v_mfma_f32_16x16x32_bf16 v[28:31], v[88:91], v[224:227], v[28:31]
  v_mfma_f32_16x16x32_bf16 v[28:31], v[92:95], v[228:231], v[28:31]
  s_waitcnt lgkmcnt(0)
L_121:
  s_barrier
  s_cmp_lg_u32 s82, 0
  s_cbranch_scc1 L_123
  v_mfma_f32_16x16x32_bf16 v[28:31], v[32:35], v[232:235], v[28:31]
  v_mfma_f32_16x16x32_bf16 v[28:31], v[36:39], v[236:239], v[28:31]
  v_mfma_f32_16x16x32_bf16 v[28:31], v[40:43], v[240:243], v[28:31]
  v_mfma_f32_16x16x32_bf16 v[28:31], v[44:47], v[244:247], v[28:31]
  v_mfma_f32_16x16x32_bf16 v[28:31], v[48:51], v[232:235], v[28:31]
  v_mfma_f32_16x16x32_bf16 v[28:31], v[52:55], v[236:239], v[28:31]
  v_mfma_f32_16x16x32_bf16 v[28:31], v[56:59], v[240:243], v[28:31]
  v_mfma_f32_16x16x32_bf16 v[28:31], v[60:63], v[244:247], v[28:31]
  s_lshl_b32 s5, s77, 14
  s_lshl_b32 s4, s76, 10
  s_add_u32 s5, s5, s4
  s_add_u32 s5, s5, 1114112
  s_nop 3
  buffer_store_dwordx4 v[28:31], v15, s[40:43], s5 offen sc0 sc1
  s_branch L_124
L_123:
  s_lshl_b32 s91, s84, 1
  s_add_u32 s91, s91, s87
  s_add_u32 s91, s91, 0xfffffff0
  s_mov_b32 s16, 0xffff
  s_mov_b32 exec_lo, s16
  s_mov_b32 exec_hi, 0
  buffer_load_dword v7, v5, s[40:43], s91 offen sc0 sc1
  s_mov_b64 exec, -1
L_124:
  s_barrier
  s_cmp_lg_u32 s82, 0
  s_cbranch_scc1 L_125
  s_branch L_126
L_125:
  s_waitcnt vmcnt(0)
  s_mov_b32 s89, 200000
  s_mov_b32 exec_lo, s16
  s_mov_b32 exec_hi, 0
  s_branch Lp_128
Lp_127:
  buffer_load_dword v7, v5, s[40:43], s91 offen sc0 sc1
  s_waitcnt vmcnt(0)
Lp_128:
  v_cmp_ne_u32 vcc, 0, v7
  s_andn2_b32 s3, s16, vcc_lo
  s_cbranch_scc0 Lp_129
  s_sleep 1
  s_sub_u32 s89, s89, 1
  s_cbranch_scc0 Lp_127
Lp_129:
  s_mov_b64 exec, -1
  s_add_u32 s5, s84, s92
  buffer_load_dwordx2 v[96:97], v6, s[40:43], s5 offen offset:0 sc1
  buffer_load_dwordx2 v[98:99], v6, s[40:43], s5 offen offset:512 sc1
  buffer_load_dwordx2 v[100:101], v6, s[40:43], s5 offen offset:1024 sc1
  buffer_load_dwordx2 v[102:103], v6, s[40:43], s5 offen offset:1536 sc1
L_126:
  s_barrier
  s_cmp_gt_u32 s14, 0
  s_cbranch_scc1 L_130
  s_barrier
L_130:
  s_cmp_gt_u32 s14, Lz1-Lz0+1
  s_cbranch_scc1 L_131
  s_barrier
L_131:
  s_cmp_lg_u32 s82, 0
  s_cbranch_scc1 L_132
  s_waitcnt vmcnt(2)
  buffer_load_dword v9, v8, s[68:71], 0 offen sc0 sc1
  s_mov_b32 s72, s26
  s_and_b32 s73, s27, 0xffff
  s_mov_b32 s74, 7168
  s_mov_b32 s75, 0x00020000
  s_mul_i32 s4, s77, 448
  s_and_b32 s5, s77, Lz1-Lz0+1
  s_lshl_b32 s6, s5, 6
  s_add_u32 s6, s6, s4
  s_mul_i32 s5, s5, 384
  s_sub_u32 s5, s4, s5
  v_lshlrev_b32 v2, 1, v1
  v_lshrrev_b32 v3, 1, v2
  v_xor_b32 v3, v3, v2
  v_and_b32 v3, 16, v3
  v_mul_u32_u24 v3, 3, v3
  v_xor_b32_e64 v3, v3, v2
  buffer_load_ushort v104, v2, s[72:75], s6 offen offset:0
  buffer_load_ushort v105, v2, s[72:75], s6 offen offset:128
  buffer_load_ushort v106, v2, s[72:75], s6 offen offset:256
  buffer_load_ushort v107, v3, s[72:75], s5 offen offset:384
  s_nop 0
  s_mov_b32 s64, s30
  s_and_b32 s65, s31, 0xffff
  s_mov_b32 s66, 2048
  s_mov_b32 s67, 0x00020000
  s_lshl_b32 s4, s78, Lz1-Lz0+7
  buffer_load_ushort v108, v2, s[64:67], s4 offen
  v_mov_b32 v32, v22
  v_mov_b32 v33, v22
  v_mov_b32_e64 v34, v22
  v_mov_b32 v35, v22
  s_nop 1
  v_mfma_f32_16x16x32_bf16 v[96:99], v[32:35], v[128:131], 0
  v_mfma_f32_16x16x32_bf16 v[100:103], v[128:131], v[128:131], 0
  v_mfma_f32_16x16x32_bf16 v[96:99], v[32:35], v[132:135], v[96:99]
  v_mfma_f32_16x16x32_bf16 v[100:103], v[132:135], v[132:135], v[100:103]
  v_mfma_f32_16x16x32_bf16 v[96:99], v[32:35], v[136:139], v[96:99]
  v_mfma_f32_16x16x32_bf16 v[100:103], v[136:139], v[136:139], v[100:103]
  v_mfma_f32_16x16x32_bf16 v[96:99], v[32:35], v[140:143], v[96:99]
  v_mfma_f32_16x16x32_bf16 v[100:103], v[140:143], v[140:143], v[100:103]
L_132:
  s_barrier
  s_cmp_lg_u32 s82, Lz1-Lz0+0
  s_cbranch_scc1 L_134
  v_mfma_f32_16x16x32_bf16 v[96:99], v[32:35], v[144:147], v[96:99]
  v_mfma_f32_16x16x32_bf16 v[100:103], v[144:147], v[144:147], v[100:103]
  v_mfma_f32_16x16x32_bf16 v[96:99], v[32:35], v[148:151], v[96:99]
  v_mfma_f32_16x16x32_bf16 v[100:103], v[148:151], v[148:151], v[100:103]
  v_mfma_f32_16x16x32_bf16 v[96:99], v[32:35], v[152:155], v[96:99]
  v_mfma_f32_16x16x32_bf16 v[100:103], v[152:155], v[152:155], v[100:103]
  v_mfma_f32_16x16x32_bf16 v[96:99], v[32:35], v[156:159], v[96:99]
  v_mfma_f32_16x16x32_bf16 v[100:103], v[156:159], v[156:159], v[100:103]
L_134:
  s_barrier
  s_cmp_lg_u32 s82, Lz1-Lz0+0
  s_cbranch_scc1 L_136
  v_mfma_f32_16x16x32_bf16 v[96:99], v[32:35], v[160:163], v[96:99]
  v_mfma_f32_16x16x32_bf16 v[100:103], v[160:163], v[160:163], v[100:103]
  v_mfma_f32_16x16x32_bf16 v[96:99], v[32:35], v[164:167], v[96:99]
  v_mfma_f32_16x16x32_bf16 v[100:103], v[164:167], v[164:167], v[100:103]
  v_mfma_f32_16x16x32_bf16 v[96:99], v[32:35], v[168:171], v[96:99]
  v_mfma_f32_16x16x32_bf16 v[100:103], v[168:171], v[168:171], v[100:103]
  v_mfma_f32_16x16x32_bf16 v[96:99], v[32:35], v[172:175], v[96:99]
  v_mfma_f32_16x16x32_bf16 v[100:103], v[172:175], v[172:175], v[100:103]
  s_waitcnt vmcnt(0)
  s_mov_b32 s89, 200000
  s_branch Lg_139
Lg_138:
  buffer_load_dword v9, v8, s[68:71], 0 offen sc0 sc1
  s_waitcnt vmcnt(0)
Lg_139:
  v_cmp_eq_u32 vcc, 16, v9
  s_andn2_b32 s3, 0xffff, vcc_lo
  s_cbranch_scc0 Lg_140
  s_sleep 2
  s_sub_u32 s89, s89, 1
  s_cbranch_scc0 Lg_138
Lg_140:
  s_mov_b32 s5, 1835008
  s_mov_b64 exec, 0x101
  buffer_store_dword v11, v14, s[40:43], s5 offen sc0 sc1
  s_mov_b64 exec, -1
  s_getpc_b64 s[4:5]
L_pc0:
  s_sub_u32 s4, s4, L_pc0-mega_kernel
  s_nop 0
  s_subb_u32 s5, s5, 0
  s_bfe_u32 s6, s2, 0x20003
  s_mul_i32 s6, s6, 10240
  v_lshl_add_u32 v3, v1, 4, s6
  v_mov_b32_e64 v119, s5
  v_min_u32 v118, L_end-mega_kernel-16, v3
  v_add_co_u32_e64 v116, vcc, s4, v118
  v_add_u32 v3, 0x400, v3
  s_nop 0
  v_addc_co_u32 v117, vcc, 0, v119, vcc
  global_load_dwordx4 v[112:115], v[116:117], off
  v_min_u32 v118, L_end-mega_kernel-16, v3
  v_add_co_u32_e64 v116, vcc, s4, v118
  v_add_u32 v3, 0x400, v3
  s_nop 0
  v_addc_co_u32 v117, vcc, 0, v119, vcc
  global_load_dwordx4 v[112:115], v[116:117], off
  v_min_u32 v118, L_end-mega_kernel-16, v3
  v_add_co_u32_e64 v116, vcc, s4, v118
  v_add_u32 v3, 0x400, v3
  s_nop 0
  v_addc_co_u32 v117, vcc, 0, v119, vcc
  global_load_dwordx4 v[112:115], v[116:117], off
  v_min_u32 v118, L_end-mega_kernel-16, v3
  v_add_co_u32_e64 v116, vcc, s4, v118
  v_add_u32 v3, 0x400, v3
  s_nop 0
  v_addc_co_u32 v117, vcc, 0, v119, vcc
  global_load_dwordx4 v[112:115], v[116:117], off
  v_min_u32 v118, L_end-mega_kernel-16, v3
  v_add_co_u32 v116, vcc, s4, v118
  s_nop 1
  v_addc_co_u32 v117, vcc, 0, v119, vcc
  global_load_dwordx4 v[112:115], v[116:117], off
L_136:
  s_barrier
  s_cmp_lg_u32 s82, 0
  s_cbranch_scc1 L_141
  v_mfma_f32_16x16x32_bf16 v[96:99], v[32:35], v[176:179], v[96:99]
  v_mfma_f32_16x16x32_bf16 v[100:103], v[176:179], v[176:179], v[100:103]
  v_mfma_f32_16x16x32_bf16 v[96:99], v[32:35], v[180:183], v[96:99]
  v_mfma_f32_16x16x32_bf16 v[100:103], v[180:183], v[180:183], v[100:103]
  v_mfma_f32_16x16x32_bf16 v[96:99], v[32:35], v[184:187], v[96:99]
  v_mfma_f32_16x16x32_bf16 v[100:103], v[184:187], v[184:187], v[100:103]
  v_mfma_f32_16x16x32_bf16 v[96:99], v[32:35], v[188:191], v[96:99]
  v_mfma_f32_16x16x32_bf16 v[100:103], v[188:191], v[188:191], v[100:103]
  s_getpc_b64 s[4:5]
L_pc1:
  s_sub_u32 s4, s4, L_pc1-mega_kernel
  s_subb_u32 s5, s5, 0
  s_bfe_u32 s6, s2, 0x20003
  s_mul_i32 s6, s6, 10240
  s_add_u32 s6, s6, 5120
  v_lshl_add_u32 v3, v1, 4, s6
  v_mov_b32_e64 v119, s5
  v_min_u32 v118, L_end-mega_kernel-16, v3
  v_add_co_u32_e64 v116, vcc, s4, v118
  v_add_u32 v3, 0x400, v3
  s_nop 0
  v_addc_co_u32 v117, vcc, 0, v119, vcc
  global_load_dwordx4 v[112:115], v[116:117], off
  v_min_u32 v118, L_end-mega_kernel-16, v3
  v_add_co_u32_e64 v116, vcc, s4, v118
  v_add_u32 v3, 0x400, v3
  s_nop 0
  v_addc_co_u32 v117, vcc, 0, v119, vcc
  global_load_dwordx4 v[112:115], v[116:117], off
  v_min_u32 v118, L_end-mega_kernel-16, v3
  v_add_co_u32_e64 v116, vcc, s4, v118
  v_add_u32 v3, 0x400, v3
  s_nop 0
  v_addc_co_u32 v117, vcc, 0, v119, vcc
  global_load_dwordx4 v[112:115], v[116:117], off
  v_min_u32 v118, L_end-mega_kernel-16, v3
  v_add_co_u32_e64 v116, vcc, s4, v118
  v_add_u32 v3, 0x400, v3
  s_nop 0
  v_addc_co_u32 v117, vcc, 0, v119, vcc
  global_load_dwordx4 v[112:115], v[116:117], off
  v_min_u32 v118, L_end-mega_kernel-16, v3
  v_add_co_u32 v116, vcc, s4, v118
  s_nop 1
  v_addc_co_u32_e64 v117, vcc, 0, v119, vcc
  global_load_dwordx4 v[112:115], v[116:117], off
  s_mov_b32 s98, 0xaaaaaaaa
  s_mov_b32 s99, 0xaaaaaaaa
  v_cndmask_b32_e64 v100, v100, v101, s[98:99]
  v_cndmask_b32_e64 v102, v102, v103, s[98:99]
  s_mov_b32 s98, 0xcccccccc
  s_mov_b32 s99, 0xcccccccc
  v_cndmask_b32_e64 v97, v100, v102, s[98:99]
  v_add_f32_dpp v96, v96, v96 quad_perm:[1,0,3,2] row_mask:0xf bank_mask:0xf
  s_nop 0
  v_add_f32_dpp v97, v97, v97 quad_perm:[1,0,3,2] row_mask:0xf bank_mask:0xf
  s_branch L_142
L_141:
  s_waitcnt vmcnt(0)
  v_add_f32 v96, v96, v100
  v_add_f32 v97, v97, v101
  v_add_f32 v98, v98, v102
  v_add_f32 v99, v99, v103
  v_add_f32 v96, v96, v98
  v_add_f32 v97, v97, v99
  s_nop 0
  v_add_f32_dpp v96, v96, v96 row_ror:8 row_mask:0xf bank_mask:0xf
  v_add_f32_dpp v97, v97, v97 row_ror:8 row_mask:0xf bank_mask:0xf
  v_mov_b32 v98, v96
  v_mov_b32 v99, v97
  s_nop 0
  v_permlane16_swap_b32 v96, v98
  v_permlane16_swap_b32 v97, v99
  v_add_f32 v96, v96, v98
  v_add_f32 v97, v97, v99
  v_mov_b32 v98, v96
  v_mov_b32 v99, v97
  s_nop 0
  v_permlane32_swap_b32 v96, v98
  v_permlane32_swap_b32 v97, v99
  v_add_f32 v96, v96, v98
  v_add_f32 v97, v97, v99
L_142:
  v_mul_f32 v96, 0x3a800000, v96
  v_mul_f32 v97, 0x3a800000, v97
  v_fma_f32 v98, -v96, v96, v97
  v_max_f32_e64 v98, 0, v98
  v_add_f32 v98, 0x3727c5ac, v98
  v_rsq_f32 v98, v98
  s_nop 0
  v_mul_f32 v99, v96, v98
  s_mov_b64 exec, s[8:9]
  buffer_store_dwordx2 v[98:99], v6, s[40:43], s10 offen sc0 sc1
  s_mov_b64 exec, -1
  s_barrier
  s_cmp_lg_u32 s82, 0
  s_cbranch_scc1 L_143
  v_lshlrev_b32_e64 v6, 3, v1
  s_mov_b64 s[8:9], 0xff
  s_lshl_b32 s91, s84, Lz1-Lz0+1
  s_and_b32 s91, s91, 0x8f000
  s_add_u32 s91, s91, 1835008
  s_mov_b32 exec_lo, 0xffff
  s_mov_b32 exec_hi, Lz1-Lz0+0
  buffer_load_dword v7, v5, s[40:43], s91 offen sc0 sc1
  s_mov_b64 exec, -1
L_143:
  s_barrier
  s_barrier
  s_waitcnt vmcnt(0)
  s_and_b32 s5, s10, 0xfffffc00
  buffer_load_dwordx4 v[120:123], v4, s[40:43], s5 offen sc1
  s_cmp_lg_u32 s82, 0
  s_cbranch_scc1 L_145
  s_mov_b32 s89, 200000
  s_mov_b32 exec_lo, 0xffff
  s_mov_b32 exec_hi, 0
  s_branch Lp_148
Lp_147:
  buffer_load_dword v7, v5, s[40:43], s91 offen sc0 sc1
  s_waitcnt vmcnt(0)
Lp_148:
  v_cmp_ne_u32 vcc, 0, v7
  s_andn2_b32 s3, 0xffff, vcc_lo
  s_cbranch_scc0 Lp_149
  s_sleep 1
  s_sub_u32 s89, s89, 1
  s_cbranch_scc0 Lp_147
Lp_149:
  s_mov_b64 exec, -1
  s_lshl_b32 s5, s77, 14
  s_add_u32 s5, s5, 1114112
  buffer_load_dwordx4 v[192:195], v4, s[40:43], s5 offen offset:0 sc1
  buffer_load_dwordx4 v[196:199], v4, s[40:43], s5 offen offset:1024 sc1
  buffer_load_dwordx4 v[200:203], v4, s[40:43], s5 offen offset:2048 sc1
  buffer_load_dwordx4 v[204:207], v4, s[40:43], s5 offen offset:3072 sc1
  s_add_u32 s5, s5, 4096
  buffer_load_dwordx4 v[208:211], v4, s[40:43], s5 offen offset:0 sc1
  buffer_load_dwordx4 v[212:215], v4, s[40:43], s5 offen offset:1024 sc1
  buffer_load_dwordx4 v[216:219], v4, s[40:43], s5 offen offset:2048 sc1
  buffer_load_dwordx4 v[220:223], v4, s[40:43], s5 offen offset:3072 sc1
L_145:
  s_barrier
  s_cmp_lg_u32 s82, 0
  s_cbranch_scc1 L_150
  s_lshl_b32 s5, s77, 14
  s_add_u32 s5, s5, 1122304
  buffer_load_dwordx4 v[224:227], v4, s[40:43], s5 offen offset:0 sc1
  buffer_load_dwordx4 v[228:231], v4, s[40:43], s5 offen offset:1024 sc1
  buffer_load_dwordx4 v[232:235], v4, s[40:43], s5 offen offset:2048 sc1
  buffer_load_dwordx4 v[236:239], v4, s[40:43], s5 offen offset:3072 sc1
  s_add_u32 s5, s5, 4096
  buffer_load_dwordx4 v[240:243], v4, s[40:43], s5 offen offset:0 sc1
  buffer_load_dwordx4 v[244:247], v4, s[40:43], s5 offen offset:1024 sc1
  buffer_load_dwordx4 v[248:251], v4, s[40:43], s5 offen offset:2048 sc1
  buffer_load_dwordx4 v[252:255], v4, s[40:43], s5 offen offset:3072 sc1
L_150:
  s_barrier
  s_cmp_lg_u32 s82, 0
  s_cbranch_scc1 L_152
  s_waitcnt vmcnt(16)
  s_branch L_153
L_152:
  s_waitcnt vmcnt(0)
L_153:
  s_mov_b32 s89, 200000
  s_branch Lp_155
  s_nop 0
Lp_154:
  s_and_b32 s5, s10, 0xfffffc00
  buffer_load_dwordx4 v[120:123], v4, s[40:43], s5 offen sc1
  s_waitcnt vmcnt(0)
Lp_155:
  v_min_u32 v2, v120, v122
  v_cmp_eq_u32 vcc, 0, v2
  s_cmp_eq_u64 vcc, 0
  s_cbranch_scc1 Lp_156
  s_sleep 1
  s_sub_u32 s89, s89, 1
  s_cbranch_scc0 Lp_154
Lp_156:
  s_and_b32 s5, s10, 0xfffffc00
  s_mov_b32 m0, 151552
  s_nop 0
  buffer_load_dword v6, s[40:43], s5 offen offset:0 sc1 lds
  s_mov_b32 m0, 152188
  s_nop 0
  buffer_load_dword v6, s[40:43], s5 offen offset:4 sc1 lds
  s_mov_b32 m0, 151360
  s_nop 0
  buffer_load_dword v6, s[40:43], s5 offen offset:512 sc1 lds
  s_mov_b32 m0, 151996
  s_nop 0
  buffer_load_dword v6, s[40:43], s5 offen offset:516 sc1 lds
  s_add_u32 s10, s10, 16384
  s_cmp_lg_u32 s82, 0
  s_cbranch_scc1 L_157
  buffer_load_dword v109, v110, s[56:59], s12 offen
  s_sub_u32 s12, s12, 8192
L_157:
  s_barrier
  s_cmp_lg_u32 s82, 0
  s_cbranch_scc1 L_159
  s_cmp_lg_u32 s82, 0
  s_cbranch_scc1 L_161
  s_waitcnt vmcnt(1)
  s_branch L_162
L_161:
  s_waitcnt vmcnt(0)
L_162:
  v_add_f32 v192, v192, v224
  v_add_f32 v193, v193, v225
  v_add_f32 v194, v194, v226
  v_add_f32 v195, v195, v227
  v_add_f32 v196, v196, v228
  v_add_f32 v197, v197, v229
  v_add_f32 v198, v198, v230
  v_add_f32 v199, v199, v231
  v_add_f32 v200, v200, v232
  v_add_f32 v201, v201, v233
  v_add_f32 v202, v202, v234
  v_add_f32 v203, v203, v235
  v_add_f32 v204, v204, v236
  v_add_f32 v205, v205, v237
  v_add_f32 v206, v206, v238
  v_add_f32 v207, v207, v239
  v_add_f32 v208, v208, v240
  v_add_f32 v209, v209, v241
  v_add_f32 v210, v210, v242
  v_add_f32 v211, v211, v243
  v_add_f32 v212, v212, v244
  v_add_f32 v213, v213, v245
  v_add_f32 v214, v214, v246
  v_add_f32 v215, v215, v247
  v_add_f32 v216, v216, v248
  v_add_f32 v217, v217, v249
  v_add_f32 v218, v218, v250
  v_add_f32 v219, v219, v251
  v_add_f32 v220, v220, v252
  v_add_f32 v221, v221, v253
  v_add_f32 v222, v222, v254
  v_add_f32 v223, v223, v255
  v_add_f32 v192, v192, v208
  v_add_f32 v193, v193, v209
  v_add_f32 v194, v194, v210
  v_add_f32 v195, v195, v211
  v_add_f32 v196, v196, v212
  v_add_f32 v197, v197, v213
  v_add_f32 v198, v198, v214
  v_add_f32 v199, v199, v215
  v_add_f32 v200, v200, v216
  v_add_f32 v201, v201, v217
  v_add_f32 v202, v202, v218
  v_add_f32 v203, v203, v219
  v_add_f32 v204, v204, v220
  v_add_f32 v205, v205, v221
  v_add_f32 v206, v206, v222
  v_add_f32 v207, v207, v223
  v_add_f32 v192, v192, v200
  v_add_f32 v193, v193, v201
  v_add_f32 v194, v194, v202
  v_add_f32 v195, v195, v203
  v_add_f32 v196, v196, v204
  v_add_f32 v197, v197, v205
  v_add_f32 v198, v198, v206
  v_add_f32 v199, v199, v207
  v_add_f32 v192, v192, v196
  v_add_f32 v193, v193, v197
  v_add_f32 v194, v194, v198
  v_add_f32 v195, v195, v199
  v_add_u32 v2, 153088, v4
  ds_write_b128 v2, v[192:195]
L_159:
  s_cmp_lg_u32 s82, 0
  s_cbranch_scc1 L_163
  buffer_load_dword v109, v110, s[56:59], s12 offen
  s_sub_u32 s12, s12, 8192
L_163:
  s_barrier
  s_cmp_lg_u32 s82, 0
  s_cbranch_scc1 L_165
  s_waitcnt vmcnt(2)
  s_branch L_166
  s_nop 0
L_165:
  s_waitcnt vmcnt(0)
L_166:
  s_waitcnt lgkmcnt(0)
  s_barrier
  s_cmp_lg_u32 s82, 0
  s_cbranch_scc1 L_167
  v_lshlrev_b32 v2, 2, v1
  v_add_u32 v2, 155136, v2
  v_lshlrev_b32_e64 v104, 16, v104
  v_mul_f32 v104, 0x3eeff558, v104
  ds_write_b32 v2, v104 offset:0
  v_lshlrev_b32_e64 v105, 16, v105
  v_mul_f32 v105, 0x3eeff558, v105
  ds_write_b32 v2, v105 offset:256
  v_lshlrev_b32_e64 v106, 16, v106
  v_mul_f32 v106, 0x3eeff558, v106
  ds_write_b32 v2, v106 offset:512
  v_lshlrev_b32_e64 v107, 16, v107
  v_mul_f32 v107, 0x3eeff558, v107
  ds_write_b32 v2, v107 offset:768
  v_lshlrev_b32_e64 v108, 16, v108
  ds_write_b32 v2, v108 offset:1024
  v_lshrrev_b32 v2, 2, v1
  v_lshlrev_b32 v22, 7, v2
  v_lshlrev_b32 v96, 6, v2
  v_and_b32 v2, 3, v1
  v_lshl_add_u32 v22, v2, 3, v22
  v_lshl_add_u32 v96, v2, 3, v96
  v_add_u32 v22, 65536, v22
  v_add_u32 v96, 90112, v96
  v_bfe_u32 v3, v1, 3, 2
  v_xor_b32_e64 v2, 0, v3
  v_lshl_add_u32 v16, v2, 5, v22
  v_xor_b32_e64 v2, 1, v3
  v_lshl_add_u32 v17, v2, 5, v22
  v_xor_b32_e64 v2, 2, v3
  v_lshl_add_u32 v18, v2, 5, v22
  v_xor_b32_e64 v2, 3, v3
  v_lshl_add_u32 v19, v2, 5, v22
  v_bfe_u32 v3, v1, 4, 1
  v_xor_b32_e64 v2, 0, v3
  v_lshl_add_u32 v20, v2, 5, v96
  v_xor_b32_e64 v2, 1, v3
  v_lshl_add_u32 v21, v2, 5, v96
  v_mov_b32 v22, 0x3f803f80
  s_mov_b32 s98, 0x00010001
  s_mov_b32 s99, 0x00010001
  v_cndmask_b32_e64 v200, 0, v22, s[98:99]
  v_cndmask_b32_e64 v201, 0, v22, s[98:99]
  v_cndmask_b32_e64 v202, 0, v22, s[98:99]
  v_cndmask_b32_e64 v203, 0, v22, s[98:99]
  s_nop 0
  s_lshl_b64 s[98:99], s[98:99], 1
  v_cndmask_b32_e64 v204, 0, v22, s[98:99]
  v_cndmask_b32_e64 v205, 0, v22, s[98:99]
  v_cndmask_b32_e64 v206, 0, v22, s[98:99]
  v_cndmask_b32_e64 v207, 0, v22, s[98:99]
  s_nop 0
  s_lshl_b64 s[98:99], s[98:99], 1
  v_cndmask_b32_e64 v208, 0, v22, s[98:99]
  v_cndmask_b32_e64 v209, 0, v22, s[98:99]
  v_cndmask_b32_e64 v210, 0, v22, s[98:99]
  v_cndmask_b32_e64 v211, 0, v22, s[98:99]
  s_nop 0
  s_lshl_b64 s[98:99], s[98:99], 1
  v_cndmask_b32_e64 v212, 0, v22, s[98:99]
  v_cndmask_b32_e64 v213, 0, v22, s[98:99]
  v_cndmask_b32_e64 v214, 0, v22, s[98:99]
  v_cndmask_b32_e64 v215, 0, v22, s[98:99]
  s_nop 0
  s_lshl_b64 s[98:99], s[98:99], 1
  v_cndmask_b32_e64 v216, 0, v22, s[98:99]
  v_cndmask_b32_e64 v217, 0, v22, s[98:99]
  v_cndmask_b32_e64 v218, 0, v22, s[98:99]
  v_cndmask_b32_e64 v219, 0, v22, s[98:99]
  s_nop 0
  s_lshl_b64 s[98:99], s[98:99], 1
  v_cndmask_b32_e64 v220, 0, v22, s[98:99]
  v_cndmask_b32_e64 v221, 0, v22, s[98:99]
  v_cndmask_b32_e64 v222, 0, v22, s[98:99]
  v_cndmask_b32_e64 v223, 0, v22, s[98:99]
  s_nop 0
  s_lshl_b64 s[98:99], s[98:99], 1
  v_cndmask_b32_e64 v224, 0, v22, s[98:99]
  v_cndmask_b32_e64 v225, 0, v22, s[98:99]
  v_cndmask_b32_e64 v226, 0, v22, s[98:99]
  v_cndmask_b32_e64 v227, 0, v22, s[98:99]
  s_nop 0
  s_lshl_b64 s[98:99], s[98:99], 1
  v_cndmask_b32_e64 v228, 0, v22, s[98:99]
  v_cndmask_b32_e64 v229, 0, v22, s[98:99]
  v_cndmask_b32_e64 v230, 0, v22, s[98:99]
  v_cndmask_b32_e64 v231, 0, v22, s[98:99]
  s_nop 0
  s_lshl_b64 s[98:99], s[98:99], 1
  v_cndmask_b32_e64 v232, 0, v22, s[98:99]
  v_cndmask_b32_e64 v233, 0, v22, s[98:99]
  v_cndmask_b32_e64 v234, 0, v22, s[98:99]
  v_cndmask_b32_e64 v235, 0, v22, s[98:99]
  s_nop 0
  s_lshl_b64 s[98:99], s[98:99], 1
  v_cndmask_b32_e64 v236, 0, v22, s[98:99]
  v_cndmask_b32_e64 v237, 0, v22, s[98:99]
  v_cndmask_b32_e64 v238, 0, v22, s[98:99]
  v_cndmask_b32_e64 v239, 0, v22, s[98:99]
  s_nop 0
  s_lshl_b64 s[98:99], s[98:99], 1
  v_cndmask_b32_e64 v240, 0, v22, s[98:99]
  v_cndmask_b32_e64 v241, 0, v22, s[98:99]
  v_cndmask_b32_e64 v242, 0, v22, s[98:99]
  v_cndmask_b32_e64 v243, 0, v22, s[98:99]
  s_nop 0
  s_lshl_b64 s[98:99], s[98:99], 1
  v_cndmask_b32_e64 v244, 0, v22, s[98:99]
  v_cndmask_b32_e64 v245, 0, v22, s[98:99]
  v_cndmask_b32_e64 v246, 0, v22, s[98:99]
  v_cndmask_b32_e64 v247, 0, v22, s[98:99]
  s_nop 0
  s_lshl_b64 s[98:99], s[98:99], 1
  v_cndmask_b32_e64 v248, 0, v22, s[98:99]
  v_cndmask_b32_e64 v249, 0, v22, s[98:99]
  v_cndmask_b32_e64 v250, 0, v22, s[98:99]
  v_cndmask_b32_e64 v251, 0, v22, s[98:99]
  s_nop 0
  s_lshl_b64 s[98:99], s[98:99], 1
  v_cndmask_b32_e64 v252, 0, v22, s[98:99]
  v_cndmask_b32_e64 v253, 0, v22, s[98:99]
  v_cndmask_b32_e64 v254, 0, v22, s[98:99]
  v_cndmask_b32_e64 v255, 0, v22, s[98:99]
  s_lshl_b64 s[98:99], s[98:99], 1
L_167:
  s_lshl_b32 s91, s84, Lz1-Lz0+1
  s_add_u32 s91, s91, s87
  s_barrier
  s_barrier
  s_mov_b32 exec_lo, 0xf7f7
  s_mov_b32 exec_hi, 0
  buffer_load_dword v7, v5, s[40:43], s91 offen sc0 sc1
  s_mov_b64 exec, -1
  s_barrier
  s_barrier
  s_barrier
  s_waitcnt vmcnt(0)
  s_mov_b32 s89, 200000
  s_mov_b32 exec_lo, 0xf7f7
  s_mov_b32 exec_hi, 0
  s_branch Lp_170
Lp_169:
  buffer_load_dword v7, v5, s[40:43], s91 offen sc0 sc1
  s_waitcnt vmcnt(0)
Lp_170:
  v_cmp_ne_u32 vcc, 0, v7
  s_andn2_b32 s3, 0xf7f7, vcc_lo
  s_cbranch_scc0 Lp_171
  s_sleep 1
  s_sub_u32 s89, s89, Lz1-Lz0+1
  s_cbranch_scc0 Lp_169
Lp_171:
  s_mov_b64 exec, -1
  s_barrier
  s_barrier
  s_mov_b32 exec_lo, 0x808
  s_mov_b32 exec_hi, Lz1-Lz0+0
  buffer_load_dword v7, v5, s[40:43], s91 offen sc0 sc1
  s_mov_b64 exec, -1
  s_barrier
  s_barrier
  s_barrier
  s_barrier
  s_waitcnt vmcnt(0)
  s_mov_b32 s89, 200000
  s_mov_b32 exec_lo, 0x808
  s_mov_b32 exec_hi, 0
  s_branch Lp_173
Lp_172:
  buffer_load_dword v7, v5, s[40:43], s91 offen sc0 sc1
  s_waitcnt vmcnt(0)
Lp_173:
  v_cmp_ne_u32 vcc, 0, v7
  s_andn2_b32 s3, 0x808, vcc_lo
  s_cbranch_scc0 Lp_174
  s_sleep 1
  s_sub_u32 s89, s89, Lz1-Lz0+1
  s_cbranch_scc0 Lp_172
Lp_174:
  s_mov_b64 exec, -1
  s_barrier
  s_barrier
  s_barrier
  s_barrier
  s_barrier
  s_barrier
  s_add_u32 s92, s83, 31457280
  s_add_u32 s91, s91, 4
  s_sub_u32 s16, s78, s76
  s_add_u32 s16, s16, 1
  s_and_b32 s16, s16, 15
  s_barrier
  s_cmp_lg_u32 s82, 0
  s_cbranch_scc1 L_175
  s_cmp_eq_u32 s16, 1
  s_cselect_b32 s4, 0, 28672
  v_add_u32 v112, s4, v16
  v_add_u32 v113, s4, v17
  v_add_u32 v114, s4, v18
  v_add_u32 v115, s4, v19
  v_add_u32 v116, s4, v20
  v_add_u32 v117, s4, v21
  ds_read_b64_tr_b16 v[32:33], v112 offset:0
  ds_read_b64_tr_b16 v[34:35], v112 offset:2048
  ds_read_b64_tr_b16 v[36:37], v113 offset:0
  ds_read_b64_tr_b16 v[38:39], v113 offset:2048
  ds_read_b64_tr_b16 v[40:41], v114 offset:0
  ds_read_b64_tr_b16 v[42:43], v114 offset:2048
  ds_read_b64_tr_b16 v[44:45], v115 offset:0
  ds_read_b64_tr_b16 v[46:47], v115 offset:2048
  ds_read_b64_tr_b16 v[48:49], v112 offset:4096
  ds_read_b64_tr_b16 v[50:51], v112 offset:6144
  ds_read_b64_tr_b16 v[52:53], v113 offset:4096
  ds_read_b64_tr_b16 v[54:55], v113 offset:6144
  s_nop 0
  s_waitcnt lgkmcnt(6)
  ds_read_b64_tr_b16 v[56:57], v114 offset:4096
  ds_read_b64_tr_b16 v[58:59], v114 offset:6144
  ds_read_b64_tr_b16 v[60:61], v115 offset:4096
  ds_read_b64_tr_b16 v[62:63], v115 offset:6144
  s_nop 0
  s_waitcnt lgkmcnt(6)
  ds_read_b64_tr_b16 v[64:65], v112 offset:8192
  ds_read_b64_tr_b16 v[66:67], v112 offset:10240
  ds_read_b64_tr_b16 v[68:69], v113 offset:8192
  ds_read_b64_tr_b16 v[70:71], v113 offset:10240
  ds_read_b64_tr_b16 v[72:73], v114 offset:8192
  ds_read_b64_tr_b16 v[74:75], v114 offset:10240
  ds_read_b64_tr_b16 v[76:77], v115 offset:8192
  ds_read_b64_tr_b16 v[78:79], v115 offset:10240
  s_nop 0
  s_waitcnt lgkmcnt(8)
  v_mfma_f32_16x16x32_bf16 v[28:31], v[32:35], v[200:203], 0
  v_mfma_f32_16x16x32_bf16 v[28:31], v[36:39], v[204:207], v[28:31]
  v_mfma_f32_16x16x32_bf16 v[28:31], v[40:43], v[208:211], v[28:31]
  v_mfma_f32_16x16x32_bf16 v[28:31], v[44:47], v[212:215], v[28:31]
  v_mfma_f32_16x16x32_bf16 v[28:31], v[48:51], v[200:203], v[28:31]
  v_mfma_f32_16x16x32_bf16 v[28:31], v[52:55], v[204:207], v[28:31]
  v_mfma_f32_16x16x32_bf16 v[28:31], v[56:59], v[208:211], v[28:31]
  v_mfma_f32_16x16x32_bf16 v[28:31], v[60:63], v[212:215], v[28:31]
  s_nop 0
  s_waitcnt lgkmcnt(7)
  ds_read_b64_tr_b16 v[80:81], v112 offset:12288
  ds_read_b64_tr_b16 v[82:83], v112 offset:14336
  ds_read_b64_tr_b16 v[84:85], v113 offset:12288
  ds_read_b64_tr_b16 v[86:87], v113 offset:14336
  ds_read_b64_tr_b16 v[88:89], v114 offset:12288
  ds_read_b64_tr_b16 v[90:91], v114 offset:14336
  ds_read_b64_tr_b16 v[92:93], v115 offset:12288
  ds_read_b64_tr_b16 v[94:95], v115 offset:14336
  s_nop 0
  s_waitcnt lgkmcnt(6)
  ds_read_b64_tr_b16 v[128:129], v112 offset:16384
  ds_read_b64_tr_b16 v[130:131], v112 offset:18432
  ds_read_b64_tr_b16 v[132:133], v113 offset:16384
  ds_read_b64_tr_b16 v[134:135], v113 offset:18432
  ds_read_b64_tr_b16 v[136:137], v114 offset:16384
  ds_read_b64_tr_b16 v[138:139], v114 offset:18432
  ds_read_b64_tr_b16 v[140:141], v115 offset:16384
  ds_read_b64_tr_b16 v[142:143], v115 offset:18432
  s_nop 0
  s_waitcnt lgkmcnt(8)
  v_mfma_f32_16x16x32_bf16 v[28:31], v[64:67], v[216:219], v[28:31]
  v_mfma_f32_16x16x32_bf16 v[28:31], v[68:71], v[220:223], v[28:31]
  v_mfma_f32_16x16x32_bf16 v[28:31], v[72:75], v[224:227], v[28:31]
  v_mfma_f32_16x16x32_bf16 v[28:31], v[76:79], v[228:231], v[28:31]
  v_mfma_f32_16x16x32_bf16 v[28:31], v[80:83], v[216:219], v[28:31]
  v_mfma_f32_16x16x32_bf16 v[28:31], v[84:87], v[220:223], v[28:31]
  v_mfma_f32_16x16x32_bf16 v[28:31], v[88:91], v[224:227], v[28:31]
  v_mfma_f32_16x16x32_bf16 v[28:31], v[92:95], v[228:231], v[28:31]
  s_nop 0
  s_waitcnt lgkmcnt(7)
  ds_read_b64_tr_b16 v[144:145], v112 offset:20480
  ds_read_b64_tr_b16 v[146:147], v112 offset:22528
  ds_read_b64_tr_b16 v[148:149], v113 offset:20480
  ds_read_b64_tr_b16 v[150:151], v113 offset:22528
  ds_read_b64_tr_b16 v[152:153], v114 offset:20480
  ds_read_b64_tr_b16 v[154:155], v114 offset:22528
  ds_read_b64_tr_b16 v[156:157], v115 offset:20480
  ds_read_b64_tr_b16 v[158:159], v115 offset:22528
  s_nop 0
  s_waitcnt lgkmcnt(6)
  ds_read_b64_tr_b16 v[160:161], v116 offset:0
  ds_read_b64_tr_b16 v[162:163], v116 offset:1024
  ds_read_b64_tr_b16 v[164:165], v117 offset:0
  ds_read_b64_tr_b16 v[166:167], v117 offset:1024
  ds_read_b64_tr_b16 v[176:177], v116 offset:2048
  ds_read_b64_tr_b16 v[178:179], v116 offset:3072
  ds_read_b64_tr_b16 v[180:181], v117 offset:2048
  ds_read_b64_tr_b16 v[182:183], v117 offset:3072
  s_nop 0
  s_waitcnt lgkmcnt(8)
  v_mfma_f32_16x16x32_bf16 v[28:31], v[128:131], v[232:235], v[28:31]
  v_mfma_f32_16x16x32_bf16 v[28:31], v[132:135], v[236:239], v[28:31]
  v_mfma_f32_16x16x32_bf16 v[28:31], v[136:139], v[240:243], v[28:31]
  v_mfma_f32_16x16x32_bf16 v[28:31], v[140:143], v[244:247], v[28:31]
  v_mfma_f32_16x16x32_bf16 v[28:31], v[144:147], v[232:235], v[28:31]
  v_mfma_f32_16x16x32_bf16 v[28:31], v[148:151], v[236:239], v[28:31]
  v_mfma_f32_16x16x32_bf16 v[28:31], v[152:155], v[240:243], v[28:31]
  v_mfma_f32_16x16x32_bf16 v[28:31], v[156:159], v[244:247], v[28:31]
  s_waitcnt lgkmcnt(7)
  s_waitcnt lgkmcnt(0)
  v_mfma_f32_16x16x32_bf16 v[28:31], v[160:163], v[248:251], v[28:31]
  v_mfma_f32_16x16x32_bf16 v[28:31], v[164:167], v[252:255], v[28:31]
  v_mfma_f32_16x16x32_bf16 v[28:31], v[176:179], v[248:251], v[28:31]
  v_mfma_f32_16x16x32_bf16 v[28:31], v[180:183], v[252:255], v[28:31]
  s_lshl_b32 s5, s77, Lz1-Lz0+14
  s_lshl_b32 s4, s76, 10
  s_add_u32 s5, s5, s4
  s_add_u32 s5, s5, 1376256
  s_nop 3
  buffer_store_dwordx4 v[28:31], v15, s[40:43], s5 offen sc0 sc1
L_175:
  s_barrier
  s_mov_b32 exec_lo, 0xffff
  s_mov_b32 exec_hi, 0
  buffer_load_dword v7, v5, s[40:43], s91 offen sc0 sc1
  s_mov_b64 exec, -1
  s_barrier
  s_waitcnt vmcnt(0)
  s_mov_b32 s89, 200000
  s_mov_b32 exec_lo, 0xffff
  s_mov_b32 exec_hi, 0
  s_branch Lp_178
Lp_177:
  buffer_load_dword v7, v5, s[40:43], s91 offen sc0 sc1
  s_waitcnt vmcnt(0)
Lp_178:
  v_cmp_ne_u32 vcc, 0, v7
  s_andn2_b32 s3, 0xffff, vcc_lo
  s_cbranch_scc0 Lp_179
  s_sleep 1
  s_sub_u32 s89, s89, Lz1-Lz0+1
  s_cbranch_scc0 Lp_177
Lp_179:
  s_mov_b64 exec, -1
  s_cmp_lg_u32 s82, 0
  s_cbranch_scc1 L_180
  s_mov_b32 s5, 1835012
  s_mov_b64 exec, 0x101
  buffer_store_dword v11, v14, s[40:43], s5 offen sc0 sc1
  s_mov_b64 exec, -1
L_180:
  s_add_u32 s5, s84, s92
  buffer_load_dwordx2 v[96:97], v6, s[40:43], s5 offen offset:0 sc1
  buffer_load_dwordx2 v[98:99], v6, s[40:43], s5 offen offset:512 sc1
  buffer_load_dwordx2 v[100:101], v6, s[40:43], s5 offen offset:1024 sc1
  buffer_load_dwordx2 v[102:103], v6, s[40:43], s5 offen offset:1536 sc1
  s_barrier
  s_barrier
  s_barrier
  s_waitcnt vmcnt(0)
  v_add_f32 v96, v96, v100
  v_add_f32 v97, v97, v101
  v_add_f32 v98, v98, v102
  v_add_f32 v99, v99, v103
  v_add_f32_e64 v96, v96, v98
  v_add_f32 v97, v97, v99
  s_nop 0
  v_add_f32_dpp v96, v96, v96 row_ror:8 row_mask:0xf bank_mask:0xf
  v_add_f32_dpp v97, v97, v97 row_ror:8 row_mask:0xf bank_mask:0xf
  v_mov_b32 v98, v96
  v_mov_b32 v99, v97
  s_nop 0
  v_permlane16_swap_b32 v96, v98
  v_permlane16_swap_b32 v97, v99
  v_add_f32 v96, v96, v98
  v_add_f32 v97, v97, v99
  v_mov_b32 v98, v96
  v_mov_b32 v99, v97
  s_nop 0
  v_permlane32_swap_b32 v96, v98
  v_permlane32_swap_b32 v97, v99
  v_add_f32 v96, v96, v98
  v_add_f32 v97, v97, v99
  v_mul_f32 v96, 0x3a800000, v96
  v_mul_f32 v97, 0x3a800000, v97
  v_fma_f32 v98, -v96, v96, v97
  v_max_f32_e64 v98, 0, v98
  v_add_f32 v98, 0x3727c5ac, v98
  v_rsq_f32 v98, v98
  s_nop 0
  v_mul_f32 v99, v96, v98
  s_mov_b64 exec, s[8:9]
  buffer_store_dwordx2 v[98:99], v6, s[40:43], s10 offen sc0 sc1
  s_mov_b64 exec, -1
  s_barrier
  s_barrier
  s_barrier
  s_barrier
  s_barrier
  s_cmp_lg_u32 s82, 0
  s_cbranch_scc1 L_182
  s_lshl_b32 s91, s84, Lz1-Lz0+1
  s_and_b32 s91, s91, 0x8f000
  s_add_u32 s91, s91, 1835012
  s_mov_b32 exec_lo, 0xffff
  s_mov_b32 exec_hi, 0
  buffer_load_dword v7, v5, s[40:43], s91 offen sc0 sc1
  s_mov_b64 exec, -1
L_182:
  s_and_b32 s5, s10, 0xfffffc00
  buffer_load_dwordx4 v[120:123], v4, s[40:43], s5 offen sc1
  s_barrier
  s_barrier
  s_waitcnt vmcnt(0)
  s_mov_b32 s89, 200000
  s_branch Lp_185
Lp_184:
  s_and_b32 s5, s10, 0xfffffc00
  buffer_load_dwordx4 v[120:123], v4, s[40:43], s5 offen sc1
  s_waitcnt vmcnt(0)
Lp_185:
  v_min_u32 v2, v120, v122
  v_cmp_eq_u32 vcc, 0, v2
  s_cmp_eq_u64 vcc, 0
  s_cbranch_scc1 Lp_186
  s_sleep 1
  s_sub_u32 s89, s89, 1
  s_cbranch_scc0 Lp_184
Lp_186:
  s_and_b32 s5, s10, 0xfffffc00
  s_mov_b32 m0, 151552
  s_nop 0
  buffer_load_dword v6, s[40:43], s5 offen offset:0 sc1 lds
  s_mov_b32 m0, 152188
  s_nop 0
  buffer_load_dword v6, s[40:43], s5 offen offset:4 sc1 lds
  s_mov_b32 m0, 151360
  s_nop 0
  buffer_load_dword v6, s[40:43], s5 offen offset:512 sc1 lds
  s_mov_b32 m0, 151996
  s_nop 0
  buffer_load_dword v6, s[40:43], s5 offen offset:516 sc1 lds
  s_add_u32 s10, s10, 16384
  s_cmp_lg_u32 s82, 0
  s_cbranch_scc1 L_187
  s_mov_b32 s89, 200000
  s_mov_b32 exec_lo, 0xffff
  s_mov_b32 exec_hi, 0
  s_branch Lp_190
Lp_189:
  buffer_load_dword v7, v5, s[40:43], s91 offen sc0 sc1
  s_waitcnt vmcnt(0)
Lp_190:
  v_cmp_ne_u32 vcc, 0, v7
  s_andn2_b32 s3, 0xffff, vcc_lo
  s_cbranch_scc0 Lp_191
  s_sleep 1
  s_sub_u32 s89, s89, 1
  s_cbranch_scc0 Lp_189
Lp_191:
  s_mov_b64 exec, -1
  s_lshl_b32 s5, s77, 14
  s_add_u32 s5, s5, 1376256
  buffer_load_dwordx4 v[192:195], v4, s[40:43], s5 offen offset:0 sc1
  buffer_load_dwordx4 v[196:199], v4, s[40:43], s5 offen offset:1024 sc1
  buffer_load_dwordx4 v[200:203], v4, s[40:43], s5 offen offset:2048 sc1
  buffer_load_dwordx4 v[204:207], v4, s[40:43], s5 offen offset:3072 sc1
  s_add_u32 s5, s5, 4096
  buffer_load_dwordx4 v[208:211], v4, s[40:43], s5 offen offset:0 sc1
  buffer_load_dwordx4 v[212:215], v4, s[40:43], s5 offen offset:1024 sc1
  buffer_load_dwordx4 v[216:219], v4, s[40:43], s5 offen offset:2048 sc1
  buffer_load_dwordx4 v[220:223], v4, s[40:43], s5 offen offset:3072 sc1
L_187:
  s_barrier
  s_cmp_lg_u32 s82, 0
  s_cbranch_scc1 L_192
  s_lshl_b32 s5, s77, 14
  s_add_u32 s5, s5, 1384448
  buffer_load_dwordx4 v[224:227], v4, s[40:43], s5 offen offset:0 sc1
  buffer_load_dwordx4 v[228:231], v4, s[40:43], s5 offen offset:1024 sc1
  buffer_load_dwordx4 v[232:235], v4, s[40:43], s5 offen offset:2048 sc1
  buffer_load_dwordx4 v[236:239], v4, s[40:43], s5 offen offset:3072 sc1
  s_add_u32 s5, s5, 4096
  buffer_load_dwordx4 v[240:243], v4, s[40:43], s5 offen offset:0 sc1
  buffer_load_dwordx4 v[244:247], v4, s[40:43], s5 offen offset:1024 sc1
  buffer_load_dwordx4 v[248:251], v4, s[40:43], s5 offen offset:2048 sc1
  buffer_load_dwordx4 v[252:255], v4, s[40:43], s5 offen offset:3072 sc1
L_192:
  s_cmp_lg_u32 s82, 0
  s_cbranch_scc1 L_194
  buffer_load_dword v109, v110, s[60:63], s13 offen
  s_sub_u32 s13, s13, 8192
  buffer_load_dword v109, v110, s[60:63], s13 offen
  s_sub_u32 s13, s13, 8192
L_194:
  s_barrier
  s_barrier
  s_cmp_lg_u32 s82, 0
  s_cbranch_scc1 L_196
  s_cmp_lg_u32 s82, 0
  s_cbranch_scc1 L_198
  s_waitcnt vmcnt(2)
  s_branch L_199
  s_nop 0
L_198:
  s_waitcnt vmcnt(0)
L_199:
  v_add_f32 v192, v192, v224
  v_add_f32 v193, v193, v225
  v_add_f32 v194, v194, v226
  v_add_f32 v195, v195, v227
  v_add_f32 v196, v196, v228
  v_add_f32 v197, v197, v229
  v_add_f32 v198, v198, v230
  v_add_f32 v199, v199, v231
  v_add_f32 v200, v200, v232
  v_add_f32 v201, v201, v233
  v_add_f32 v202, v202, v234
  v_add_f32 v203, v203, v235
  v_add_f32 v204, v204, v236
  v_add_f32 v205, v205, v237
  v_add_f32 v206, v206, v238
  v_add_f32 v207, v207, v239
  v_add_f32 v208, v208, v240
  v_add_f32 v209, v209, v241
  v_add_f32 v210, v210, v242
  v_add_f32 v211, v211, v243
  v_add_f32 v212, v212, v244
  v_add_f32 v213, v213, v245
  v_add_f32 v214, v214, v246
  v_add_f32 v215, v215, v247
  v_add_f32 v216, v216, v248
  v_add_f32 v217, v217, v249
  v_add_f32 v218, v218, v250
  v_add_f32 v219, v219, v251
  v_add_f32 v220, v220, v252
  v_add_f32 v221, v221, v253
  v_add_f32 v222, v222, v254
  v_add_f32 v223, v223, v255
  v_add_f32 v192, v192, v208
  v_add_f32 v193, v193, v209
  v_add_f32 v194, v194, v210
  v_add_f32 v195, v195, v211
  v_add_f32 v196, v196, v212
  v_add_f32 v197, v197, v213
  v_add_f32 v198, v198, v214
  v_add_f32 v199, v199, v215
  v_add_f32 v200, v200, v216
  v_add_f32 v201, v201, v217
  v_add_f32 v202, v202, v218
  v_add_f32 v203, v203, v219
  v_add_f32 v204, v204, v220
  v_add_f32 v205, v205, v221
  v_add_f32 v206, v206, v222
  v_add_f32 v207, v207, v223
  v_add_f32 v192, v192, v200
  v_add_f32 v193, v193, v201
  v_add_f32 v194, v194, v202
  v_add_f32 v195, v195, v203
  v_add_f32 v196, v196, v204
  v_add_f32 v197, v197, v205
  v_add_f32 v198, v198, v206
  v_add_f32 v199, v199, v207
  v_add_f32 v192, v192, v196
  v_add_f32 v193, v193, v197
  v_add_f32 v194, v194, v198
  v_add_f32 v195, v195, v199
  v_add_u32 v2, 154112, v4
  ds_write_b128 v2, v[192:195]
  s_branch L_197
  s_nop 0
L_196:
  s_waitcnt vmcnt(0)
L_197:
  s_waitcnt lgkmcnt(0)
  s_barrier
  v_lshlrev_b32 v2, 12, v1
  s_lshl_b32 s4, s76, 16
  s_lshl_b32 s5, s77, 7
  s_add_u32 s4, s4, s5
  s_add_u32 s4, s4, s87
  s_add_u32 s5, s4, 24
  s_lshl_b32 s4, s79, 3
  s_lshl_b32 s90, 0xff, s4
  s_lshl_b32 s91, s84, 1
  s_add_u32 s91, s91, s87
  s_add_u32 s91, s91, 24
  s_lshl_b32 s4, s82, 7
  s_add_u32 s4, s4, 1837056
  s_lshl_b32 s5, s84, 1
  s_add_u32 s5, s5, s4
  s_and_b32 s91, s5, 0xffff0fff
  s_barrier
  s_barrier
  s_barrier
  s_mov_b32 exec_lo, 1
  s_mov_b32 exec_hi, Lz1-Lz0+0
  buffer_store_dword v11, v2, s[40:43], s5 offen sc0 sc1
  s_mov_b64 exec, -1
  s_barrier
  s_barrier
  s_barrier
  s_mov_b32 exec_lo, s90
  s_mov_b32 exec_hi, 0
  buffer_load_dword v7, v2, s[40:43], s91 offen sc0 sc1
  s_mov_b64 exec, -1
  s_barrier
  s_waitcnt vmcnt(0)
  s_mov_b32 s89, 200000
  s_mov_b32 exec_lo, s90
  s_mov_b32 exec_hi, 0
  s_branch Lp_201
Lp_200:
  buffer_load_dword v7, v2, s[40:43], s91 offen sc0 sc1
  s_waitcnt vmcnt(0)
Lp_201:
  v_cmp_ne_u32 vcc, 0, v7
  s_andn2_b32 s3, s90, vcc_lo
  s_cbranch_scc0 Lp_202
  s_sleep 1
  s_sub_u32 s89, s89, 1
  s_cbranch_scc0 Lp_200
Lp_202:
  s_mov_b64 exec, -1
  s_xor_b32 s90, s90, 0xffff
  s_barrier
  s_barrier
  s_barrier
  s_barrier
  s_barrier
  s_barrier
  s_barrier
  s_barrier
  s_barrier
  s_barrier
  s_mov_b32 exec_lo, s90
  s_mov_b32 exec_hi, 0
  buffer_load_dword v7, v2, s[40:43], s91 offen sc0 sc1
  s_mov_b64 exec, -1
  s_barrier
  s_barrier
  s_barrier
  s_waitcnt vmcnt(0)
  s_mov_b32 s89, 200000
  s_mov_b32 exec_lo, s90
  s_mov_b32 exec_hi, 0
  s_branch Lp_204
Lp_203:
  buffer_load_dword v7, v2, s[40:43], s91 offen sc0 sc1
  s_waitcnt vmcnt(0)
Lp_204:
  v_cmp_ne_u32 vcc, 0, v7
  s_andn2_b32 s3, s90, vcc_lo
  s_cbranch_scc0 Lp_205
  s_sleep 1
  s_sub_u32 s89, s89, 1
  s_cbranch_scc0 Lp_203
Lp_205:
  s_mov_b64 exec, -1
  s_barrier
  s_barrier
  s_barrier
  s_barrier
  s_barrier
  s_barrier
  s_barrier
  s_barrier
  s_barrier
  s_barrier
  s_barrier
  s_cmp_lg_u32 s82, 0
  s_cbranch_scc1 L_lend
  s_add_u32 s92, s83, 36700160
  s_mov_b32 s82, 1
  s_mov_b32 s14, 0
  s_add_u32 s83, s83, 0
  s_add_u32 s87, s87, 32
  s_branch L_slayer
L_lend:
Lz0:
Lz1:
L_end:
  s_endpgm
.section .rodata,"a"
.p2align 6
.amdhsa_kernel mega_kernel
  .amdhsa_next_free_vgpr 256
  .amdhsa_next_free_sgpr 102
  .amdhsa_accum_offset 256
  .amdhsa_group_segment_fixed_size 0
  .amdhsa_kernarg_size 88
  .amdhsa_user_sgpr_count 2
  .amdhsa_user_sgpr_kernarg_segment_ptr 1
  .amdhsa_system_sgpr_workgroup_id_x 1
  .amdhsa_float_denorm_mode_32 3
  .amdhsa_float_denorm_mode_16_64 3
.end_amdhsa_kernel
.text
```

```asm
; @launch kernel=mega_kernel grid=(256,1,1) block=(512,1,1) lds=156672
.amdgcn_target "amdgcn-amd-amdhsa--gfx950"
.text
.globl mega_kernel
.p2align 8
.type mega_kernel,@function
mega_kernel:
  s_cmp_ge_u32 s2, 256
  s_nop 0
  s_cbranch_scc1 L_end
  s_load_dwordx16 s[16:31], s[0:1], 0
  s_load_dwordx2 s[32:33], s[0:1], 64
  s_load_dwordx4 s[36:39], s[0:1], 72
  v_lshrrev_b32 v2, 6, v0
  v_and_b32 v1, 63, v0
  v_readfirstlane_b32 s81, v2
  s_and_b32 s3, s2, 7
  s_lshr_b32 s4, s2, 3
  s_and_b32 s5, s3, 1
  s_lshl_b32 s5, s5, 3
  s_and_b32 s6, s4, 7
  s_add_u32 s76, s5, s6
  s_lshr_b32 s5, s3, 1
  s_lshl_b32 s5, s5, 2
  s_lshr_b32 s6, s4, 3
  s_add_u32 s77, s5, s6
  s_mov_b32 s82, 0
  s_mov_b32 s88, 0
  s_and_b32 s85, s81, 1
  s_cmp_lt_u32 s81, 4
  s_cbranch_scc1 L_comp
  s_cmp_eq_u32 s81, Lz1-Lz0+5
  s_cbranch_scc1 L_serv
  s_setprio 0
  s_cmp_eq_u32 s81, 4
  s_cbranch_scc1 L_xload
  v_bfe_u32 v2, v1, 1, 2
  v_bfe_u32 v3, v1, 4, 2
  v_xor_b32 v2, v2, v3
  v_lshlrev_b32 v10, 5, v2
  v_and_b32_e64 v2, 1, v1
  v_lshl_add_u32 v10, v2, 4, v10
  v_lshrrev_b32_e64 v2, 5, v1
  v_bfe_u32 v3, v1, 3, 2
  v_lshl_add_u32 v2, v2, 3, v3
  s_mov_b32 s4, 6144
  v_mad_u32_u24 v16, v2, s4, v10
  v_add_u32 v17, 97280, v16
  v_add_u32 v18, 22528, v16
  v_add_u32 v19, 119808, v16
  s_lshl_b32 s5, s77, Lz1-Lz0+7
  s_mul_i32 s4, s85, 196608
  s_add_u32 s5, s5, s4
  s_and_b32 s6, s76, 6
  s_lshr_b32 s4, s76, 3
  s_add_u32 s6, s6, s4
  s_lshl_b32 s6, s6, 1
  v_add_u32 v20, s6, v1
  v_and_b32_e64 v20, 15, v20
  s_mov_b32 s4, 393216
  v_mul_u32_u24 v20, s4, v20
  v_add_u32 v20, s5, v20
  s_nop 0
  v_readfirstlane_b32 s7, v20
  s_lshl_b32 s11, s85, Lz1-Lz0+12
  s_add_u32 s11, s11, 65536
  s_add_u32 s15, s11, 73728
  s_waitcnt lgkmcnt(0)
  s_mov_b32 s48, s18
  s_and_b32 s49, s19, 0xffff
  s_mov_b32 s50, 6291456
  s_mov_b32 s51, 0x00020000
L_wlayer:
  s_mov_b32 s12, 0
  s_mov_b32 m0, s11
  s_cmp_eq_u32 s82, 0
  s_cbranch_scc1 Ll_33
  s_waitcnt vmcnt(12)
  s_barrier
  s_waitcnt vmcnt(8)
  s_barrier
  s_waitcnt vmcnt(4)
  s_barrier
  s_waitcnt vmcnt(0)
  s_barrier
  s_barrier
  s_branch Ll_33
Lt_39:
  s_cmp_lg_u32 s12, 1
  s_cbranch_scc1 Ll_33
  s_cmp_eq_u32 s82, 0
  s_cbranch_scc1 Ll_33
  v_mov_b32 v2, 156416
  s_lshl_b32 s5, s82, Lz1-Lz0+4
  s_mov_b32 s89, 1600000
Lw_40:
  ds_read_b32 v3, v2 offset:0
Lw_41:
  s_waitcnt lgkmcnt(0)
  v_readfirstlane_b32 s4, v3
  s_cmp_ge_u32 s4, s5
  s_cbranch_scc1 Lw_42
  s_sleep 1
  s_sub_u32 s89, s89, Lz1-Lz0+1
  s_cbranch_scc0 Lw_40
Lw_42:
Ll_33:
  buffer_load_dwordx4 v16, s[48:51], s7 offen offset:0  lds
  buffer_load_dwordx4 v17, s[48:51], s7 offen offset:1024  lds
  buffer_load_dwordx4 v18, s[48:51], s7 offen offset:2048  lds
  buffer_load_dwordx4 v19, s[48:51], s7 offen offset:3072  lds
  s_add_u32 m0, s11, 8192
  s_add_u32 s5, s7, 2048
  buffer_load_dwordx4 v16, s[48:51], s5 offen offset:0  lds
  buffer_load_dwordx4 v17, s[48:51], s5 offen offset:1024  lds
  buffer_load_dwordx4 v18, s[48:51], s5 offen offset:2048  lds
  buffer_load_dwordx4 v19, s[48:51], s5 offen offset:3072  lds
  s_add_u32 m0, s11, 16384
  s_add_u32 s5, s7, 4096
  buffer_load_dwordx4 v16, s[48:51], s5 offen offset:0  lds
  s_add_u32 s12, s12, Lz1-Lz0+1
  v_readlane_b32 s7, v20, s12
  s_add_u32 s11, s11, 24576
  buffer_load_dwordx4 v17, s[48:51], s5 offen offset:1024  lds
  s_cmp_eq_u32 s11, s15
  s_cselect_b32 s4, 73728, 0
  s_sub_u32 s11, s11, s4
  buffer_load_dwordx4 v18, s[48:51], s5 offen offset:2048  lds
  s_cmp_lg_u32 s12, Lz1-Lz0+3
  buffer_load_dwordx4 v19, s[48:51], s5 offen offset:3072  lds
  s_mov_b32 m0, s11
  s_cbranch_scc1 Lt_39
Lt_43:
  s_waitcnt vmcnt(24)
  s_barrier
Ll_44:
  s_mul_i32 s5, s85, 6144
  s_nop 0
  s_mov_b32 s68, s24
  s_and_b32 s69, s25, 0xffff
  s_mov_b32 s70, 7340032
  s_mov_b32 s71, 0x00020000
  s_lshl_b32 s4, s76, Lz1-Lz0+4
  s_add_u32 s4, s4, s77
  s_mul_i32 s34, s4, 28672
  s_add_u32 s34, s34, s5
  s_waitcnt vmcnt(12)
  s_barrier
  buffer_load_dwordx4 v16, s[48:51], s7 offen offset:0  lds
  buffer_load_dwordx4 v17, s[48:51], s7 offen offset:1024  lds
  buffer_load_dwordx4 v18, s[48:51], s7 offen offset:2048  lds
  buffer_load_dwordx4 v19, s[48:51], s7 offen offset:3072  lds
Ll_45:
  s_add_u32 m0, s11, 8192
  s_add_u32 s5, s7, 2048
  buffer_load_dwordx4 v16, s[48:51], s5 offen offset:0  lds
  buffer_load_dwordx4 v17, s[48:51], s5 offen offset:1024  lds
  buffer_load_dwordx4 v18, s[48:51], s5 offen offset:2048  lds
  buffer_load_dwordx4 v19, s[48:51], s5 offen offset:3072  lds
  s_add_u32 m0, s11, 16384
  s_add_u32 s5, s7, 4096
  buffer_load_dwordx4 v16, s[48:51], s5 offen offset:0  lds
  s_add_u32 s12, s12, Lz1-Lz0+1
  v_readlane_b32 s7, v20, s12
  s_add_u32 s11, s11, 24576
  buffer_load_dwordx4 v17, s[48:51], s5 offen offset:1024  lds
  s_cmp_eq_u32 s11, s15
  s_cselect_b32 s4, 73728, 0
  s_sub_u32 s11, s11, s4
  buffer_load_dwordx4 v18, s[48:51], s5 offen offset:2048  lds
  s_cmp_eq_u32 s12, Lz1-Lz0+16
  buffer_load_dwordx4 v19, s[48:51], s5 offen offset:3072  lds
  s_mov_b32 m0, s11
  s_cbranch_scc1 Ll_46
  s_cmp_lg_u32 s82, 0
  s_cbranch_scc1 L_47
  s_buffer_load_dwordx2 s[98:99], s[68:71], s34 offset:60
  s_buffer_load_dwordx2 s[98:99], s[68:71], s34 offset:188
  s_buffer_load_dwordx2 s[98:99], s[68:71], s34 offset:316
  s_buffer_load_dwordx2 s[98:99], s[68:71], s34 offset:444
  s_add_u32 s34, s34, 512
L_47:
  s_waitcnt vmcnt(12)
  s_barrier
  buffer_load_dwordx4 v16, s[48:51], s7 offen offset:0  lds
  buffer_load_dwordx4 v17, s[48:51], s7 offen offset:1024  lds
  buffer_load_dwordx4 v18, s[48:51], s7 offen offset:2048  lds
  buffer_load_dwordx4 v19, s[48:51], s7 offen offset:3072  lds
  s_branch Ll_45
Ll_46:
  s_branch L_w1
L_xload:
  s_setprio 0
  v_lshrrev_b32 v2, 4, v1
  v_and_b32 v3, 7, v1
  v_xor_b32 v2, v2, v3
  v_lshrrev_b32 v3, 3, v1
  v_lshlrev_b32 v3, 12, v3
  v_lshl_add_u32 v4, v2, 4, v3
  v_xor_b32_e64 v5, 64, v4
  v_add_u32 v5, 31744, v5
  v_add_u32 v6, 63488, v4
  v_add_u32 v7, 63488, v5
  s_mov_b32 s13, 0x20000
  s_movk_i32 s95, 2048
  s_lshl_b32 s5, s76, 18
  s_and_b32 s6, s76, 6
  s_lshr_b32 s4, s76, 3
  s_add_u32 s6, s6, s4
  s_lshl_b32 s6, s6, 1
  v_add_u32 v9, s6, v1
  v_and_b32 v9, 15, v9
  v_lshl_add_u32 v9, v9, 7, s5
  s_nop 0
  v_readfirstlane_b32 s7, v9
  s_waitcnt lgkmcnt(0)
  s_mov_b32 s72, s16
  s_and_b32 s73, s17, 0xffff
  s_mov_b32 s74, 4194304
  s_mov_b32 s75, 0x00020000
  s_mov_b32 s11, 0
  s_mov_b32 s15, 65536
L_xlayer:
  s_mov_b32 s12, s82
  s_mov_b32 m0, s11
Ll_86:
  s_nop 0
  buffer_load_dwordx4 v4, s[72:75], s7 offen offset:0 sc1 lds
  buffer_load_dwordx4 v5, s[72:75], s7 offen offset:1024 sc1 lds
  buffer_load_dwordx4 v6, s[72:75], s7 offen offset:2048 sc1 lds
  buffer_load_dwordx4 v7, s[72:75], s7 offen offset:3072 sc1 lds
  s_add_u32 m0, s11, 4096
  s_nop 0
  s_add_u32 s5, s7, s13
  buffer_load_dwordx4 v4, s[72:75], s5 offen offset:0 sc1 lds
  buffer_load_dwordx4 v5, s[72:75], s5 offen offset:1024 sc1 lds
  buffer_load_dwordx4 v6, s[72:75], s5 offen offset:2048 sc1 lds
  buffer_load_dwordx4 v7, s[72:75], s5 offen offset:3072 sc1 lds
  s_add_u32 m0, s11, 8192
  s_nop 0
  s_add_u32 s3, s7, s95
  buffer_load_dwordx4 v4, s[72:75], s3 offen offset:0 sc1 lds
  buffer_load_dwordx4 v5, s[72:75], s3 offen offset:1024 sc1 lds
  buffer_load_dwordx4 v6, s[72:75], s3 offen offset:2048 sc1 lds
  buffer_load_dwordx4 v7, s[72:75], s3 offen offset:3072 sc1 lds
  s_add_u32 m0, s11, 12288
  s_add_u32 s5, s3, s13
  buffer_load_dwordx4 v4, s[72:75], s5 offen offset:0 sc1 lds
  s_add_u32 s12, s12, 1
  v_readlane_b32 s7, v9, s12
  s_add_u32 s11, s11, 16384
  buffer_load_dwordx4 v5, s[72:75], s5 offen offset:1024 sc1 lds
  s_cmp_eq_u32 s11, s15
  s_cselect_b32 s4, 65536, 0
  s_sub_u32 s11, s11, s4
  buffer_load_dwordx4 v6, s[72:75], s5 offen offset:2048 sc1 lds
  s_cmp_lg_u32 s12, Lz1-Lz0+3
  buffer_load_dwordx4 v7, s[72:75], s5 offen offset:3072 sc1 lds
  s_mov_b32 m0, s11
  s_cbranch_scc1 Ll_87
  s_cmp_lg_u32 s82, 0
  s_cbranch_scc1 Ll_87
  s_waitcnt vmcnt(32)
  s_barrier
Ll_91:
Ll_87:
  s_cmp_lt_u32 s12, Lz1-Lz0+4
  s_cbranch_scc1 Ll_86
  s_mov_b32 s68, s20
  s_and_b32 s69, s21, 0xffff
  s_mov_b32 s70, 2097152
  s_mov_b32 s71, 0x00020000
  s_lshl_b32 s4, s76, 4
  s_add_u32 s4, s4, s77
  s_mul_i32 s34, s4, 8192
  s_waitcnt vmcnt(32)
  s_barrier
  buffer_load_dwordx4 v4, s[72:75], s7 offen offset:0 sc1 lds
  buffer_load_dwordx4 v5, s[72:75], s7 offen offset:1024 sc1 lds
  buffer_load_dwordx4 v6, s[72:75], s7 offen offset:2048 sc1 lds
  buffer_load_dwordx4 v7, s[72:75], s7 offen offset:3072 sc1 lds
Ll_92:
  s_add_u32 m0, s11, 4096
  s_nop 0
  s_add_u32 s5, s7, s13
  buffer_load_dwordx4 v4, s[72:75], s5 offen offset:0 sc1 lds
  buffer_load_dwordx4 v5, s[72:75], s5 offen offset:1024 sc1 lds
  buffer_load_dwordx4 v6, s[72:75], s5 offen offset:2048 sc1 lds
  buffer_load_dwordx4 v7, s[72:75], s5 offen offset:3072 sc1 lds
  s_add_u32 m0, s11, 8192
  s_nop 0
  s_add_u32 s3, s7, s95
  buffer_load_dwordx4 v4, s[72:75], s3 offen offset:0 sc1 lds
  buffer_load_dwordx4 v5, s[72:75], s3 offen offset:1024 sc1 lds
  buffer_load_dwordx4 v6, s[72:75], s3 offen offset:2048 sc1 lds
  buffer_load_dwordx4 v7, s[72:75], s3 offen offset:3072 sc1 lds
  s_add_u32 m0, s11, 12288
  s_add_u32 s5, s3, s13
  buffer_load_dwordx4 v4, s[72:75], s5 offen offset:0 sc1 lds
  s_add_u32 s12, s12, 1
  v_readlane_b32 s7, v9, s12
  s_add_u32 s11, s11, 16384
  buffer_load_dwordx4 v5, s[72:75], s5 offen offset:1024 sc1 lds
  s_cmp_eq_u32 s11, s15
  s_cselect_b32 s4, 65536, 0
  s_sub_u32 s11, s11, s4
  buffer_load_dwordx4 v6, s[72:75], s5 offen offset:2048 sc1 lds
  s_cmp_eq_u32 s12, Lz1-Lz0+16
  buffer_load_dwordx4 v7, s[72:75], s5 offen offset:3072 sc1 lds
  s_mov_b32 m0, s11
  s_cbranch_scc1 Ll_93
  s_cmp_lg_u32 s82, 0
  s_cbranch_scc1 L_94
  s_buffer_load_dwordx2 s[98:99], s[68:71], s34 offset:60
  s_buffer_load_dwordx2 s[98:99], s[68:71], s34 offset:188
  s_buffer_load_dwordx2 s[98:99], s[68:71], s34 offset:316
  s_buffer_load_dwordx2 s[98:99], s[68:71], s34 offset:444
  s_buffer_load_dwordx2 s[98:99], s[68:71], s34 offset:572
  s_add_u32 s34, s34, 640
L_94:
  s_waitcnt vmcnt(32)
  s_barrier
  buffer_load_dwordx4 v4, s[72:75], s7 offen offset:0 sc1 lds
  buffer_load_dwordx4 v5, s[72:75], s7 offen offset:1024 sc1 lds
  buffer_load_dwordx4 v6, s[72:75], s7 offen offset:2048 sc1 lds
  buffer_load_dwordx4 v7, s[72:75], s7 offen offset:3072 sc1 lds
  s_branch Ll_92
  s_nop 0
Ll_93:
  s_waitcnt vmcnt(32)
  s_barrier
  s_waitcnt vmcnt(16)
  s_barrier
  s_waitcnt vmcnt(0)
  s_barrier
  s_barrier
  s_branch L_x1
L_serv:
  s_setprio 3
  s_and_b32 s80, s77, 7
  s_lshr_b32 s79, s77, 3
  s_lshl_b32 s78, s80, 1
  s_add_u32 s78, s78, s79
  s_lshl_b32 s5, s76, 4
  s_add_u32 s5, s5, s77
  s_lshl_b32 s84, s5, 11
  s_mov_b32 s83, 3145728
  s_mov_b32 s87, 1835016
  s_lshr_b32 s86, s81, 1
  v_lshlrev_b32 v4, 4, v1
  v_mov_b32 v24, 0
  v_mov_b32 v25, 0
  v_mov_b32 v26, 0
  v_mov_b32 v27, 0
  v_and_b32 v2, 14, v1
  v_lshlrev_b32 v3, 11, v2
  v_and_b32_e64 v2, 1, v1
  v_lshl_add_u32 v3, v2, 4, v3
  v_and_b32_e64 v2, 48, v1
  v_lshl_add_u32 v3, v2, 1, v3
  v_bfe_u32 v2, v1, 3, 2
  v_and_b32 v22, 7, v1
  v_lshlrev_b32 v2, 14, v2
  v_lshl_add_u32 v2, v22, 3, v2
  s_lshl_b32 s5, s76, 7
  s_lshl_b32 s4, s80, 4
  s_add_u32 s6, s5, s4
  s_add_u32 s6, s6, s79
  s_lshl_b32 s6, s6, 11
  s_lshr_b32 s10, s84, 5
  s_add_u32 s10, s10, 1638400
  s_waitcnt lgkmcnt(0)
  s_mov_b32 s48, s18
  s_and_b32 s49, s19, 0xffff
  s_mov_b32 s50, 6291456
  s_mov_b32 s51, 0x00020000
  s_sub_u32 s4, 384, s48
  s_and_b32 s4, s4, 1023
  s_mul_i32 s5, s84, 12
  s_add_u32 s4, s4, s5
  v_lshlrev_b32_e64 v109, 10, v1
  s_mov_b64 exec, 0xffffff
  buffer_load_dword v109, v109, s[48:51], s4 offen
  s_mov_b64 exec, -1
  s_mov_b32 s40, s38
  s_and_b32 s41, s39, 0xffff
  s_mov_b32 s42, 100663296
  s_mov_b32 s43, 0x00020000
  s_nop 0
  s_mov_b32 s44, s16
  s_and_b32 s45, s17, 0xffff
  s_mov_b32 s46, 4194304
  s_mov_b32 s47, 0x00020000
  s_nop 0
  s_mov_b32 s68, s36
  s_and_b32 s69, s37, 0xffff
  s_mov_b32 s70, 256
  s_mov_b32 s71, 0x00020000
  s_lshl_b32 s4, s84, Lz1-Lz0+1
  s_add_u32 s4, s4, 1835008
  buffer_store_dwordx4 v[24:27], v4, s[40:43], s4 offen offset:0 sc0 sc1
  buffer_store_dwordx4 v[24:27], v4, s[40:43], s4 offen offset:1024 sc0 sc1
  s_mov_b64 exec, 0xffff
  buffer_store_dwordx4 v[24:27], v4, s[40:43], s4 offen offset:2048 sc0 sc1
  s_mov_b64 exec, -1
  v_mov_b32 v28, -1
  v_mov_b32 v29, -1
  v_mov_b32 v30, -1
  v_mov_b32 v31, -1
  s_lshl_b32 s4, s84, 1
  s_add_u32 s4, s4, Lz1-Lz0+0
  buffer_store_dwordx4 v[28:31], v4, s[40:43], s4 offen offset:0 sc0 sc1
  buffer_store_dwordx4 v[28:31], v4, s[40:43], s4 offen offset:1024 sc0 sc1
  buffer_store_dwordx4 v[28:31], v4, s[40:43], s4 offen offset:2048 sc0 sc1
  buffer_store_dwordx4 v[28:31], v4, s[40:43], s4 offen offset:3072 sc0 sc1
  buffer_store_dwordx2 v[24:25], v2, s[40:43], s10 offen sc0 sc1
  v_mov_b32 v108, v3
  s_mov_b32 s7, s6
  s_branch L_s1
L_comp:
  s_and_b32 s80, s77, 7
  s_lshr_b32 s79, s77, 3
  s_lshl_b32 s78, s80, 1
  s_add_u32 s78, s78, s79
  s_lshl_b32 s5, s76, 4
  s_add_u32 s5, s5, s77
  s_lshl_b32 s84, s5, 11
  s_mov_b32 s83, 3145728
  s_mov_b32 s87, 1835016
  s_lshr_b32 s86, s81, Lz1-Lz0+1
  s_waitcnt lgkmcnt(0)
  s_mov_b32 s40, s38
  s_and_b32 s41, s39, 0xffff
  s_mov_b32 s42, 100663296
  s_mov_b32 s43, 0x00020000
  s_nop 0
  s_mov_b32 s44, s16
  s_and_b32 s45, s17, 0xffff
  s_mov_b32 s46, 4194304
  s_mov_b32 s47, 0x00020000
  s_nop 0
  s_mov_b32 s64, s32
  s_and_b32 s65, s33, 0xffff
  s_mov_b32 s66, 4194304
  s_mov_b32 s67, 0x00020000
  s_setprio 1
  v_lshlrev_b32 v11, 4, v1
  v_lshrrev_b32 v2, 3, v1
  v_and_b32 v3, 7, v1
  v_lshlrev_b32_e64 v3, 3, v3
  v_lshl_add_u32 v30, v2, 11, v3
  s_lshl_b32 s4, s85, 13
  s_lshl_b32 s5, s86, 10
  s_add_u32 s4, s4, s5
  v_add_u32 v0, s4, v11
  v_mov_b32_e64 v27, 1
  v_mov_b32 v28, 156416
  v_and_b32 v29, 48, v1
  s_lshl_b32 s4, s76, 16
  s_lshl_b32 s5, s77, 7
  s_add_u32 s4, s4, s5
  v_lshlrev_b32 v24, 12, v1
  v_and_b32 v2, 16, v1
  v_lshl_add_u32 v24, v2, 7, v24
  v_add_u32 v24, s4, v24
  v_lshrrev_b32 v2, 2, v1
  v_lshlrev_b32 v25, 7, v2
  v_and_b32 v2, 3, v1
  v_lshl_add_u32 v25, v2, 3, v25
  v_add_u32 v25, 65536, v25
  v_bfe_u32 v26, v1, 3, 2
  v_and_b32 v2, 15, v1
  v_lshrrev_b32 v3, 2, v29
  v_sub_u32_e64 v2, v2, v3
  s_mov_b32 s4, 0xf149f2ca
  v_mov_b32 v32, s4
  v_subrev_u32 v3, 0, v2
  v_cmp_gt_u32 vcc, 8, v3
  s_nop 1
  v_cndmask_b32_e64 v12, v32, 0, vcc
  v_cmp_ge_i32 vcc, -9, v3
  s_nop 1
  v_cndmask_b32_e64 v16, v32, 0, vcc
  v_mov_b32 v20, v16
  v_subrev_u32 v3, 1, v2
  v_cmp_gt_u32 vcc, 8, v3
  s_nop 1
  v_cndmask_b32_e64 v13, v32, 0, vcc
  v_cmp_ge_i32 vcc, -9, v3
  s_nop 1
  v_cndmask_b32_e64 v17, v32, 0, vcc
  v_mov_b32 v21, v17
  v_subrev_u32 v3, 2, v2
  v_cmp_gt_u32 vcc, 8, v3
  s_nop 1
  v_cndmask_b32_e64 v14, v32, 0, vcc
  v_cmp_ge_i32 vcc, -9, v3
  s_nop 1
  v_cndmask_b32_e64 v18, v32, 0, vcc
  v_mov_b32 v22, v18
  v_subrev_u32 v3, 3, v2
  v_cmp_gt_u32 vcc, 8, v3
  s_nop 1
  v_cndmask_b32_e64 v15, v32, 0, vcc
  v_cmp_ge_i32 vcc, -9, v3
  s_nop 1
  v_cndmask_b32_e64 v19, v32, 0, vcc
  v_mov_b32 v23, v19
  s_cmp_lg_u32 s76, 0
  s_cbranch_scc1 L_1
  v_mov_b32 v20, v32
  v_mov_b32 v21, v32
  v_mov_b32 v22, v32
  v_mov_b32 v23, v32
L_1:
  s_lshl_b32 s11, s84, 1
  s_lshl_b32 s4, s81, 10
  s_add_u32 s11, s11, s4
  v_and_b32 v2, 15, v1
  v_lshlrev_b32 v255, 12, v2
  v_and_b32_e64 v2, 16, v1
  v_lshl_add_u32 v255, v2, 1, v255
  v_and_b32 v2, 32, v1
  v_lshrrev_b32 v2, 1, v2
  v_add_u32 v255, v2, v255
  s_lshl_b32 s25, s76, 18
  s_lshl_b32 s4, s85, 11
  s_add_u32 s25, s25, s4
  s_lshl_b32 s4, s78, 7
  s_add_u32 s25, s25, s4
  s_lshl_b32 s4, s86, 6
  s_add_u32 s25, s25, s4
L_clayer:
  s_mov_b32 s16, Lz1-Lz0+0
  s_mov_b32 s17, 16384
  s_mov_b32 s18, 0xffff4000
  s_mov_b32 s19, Lz1-Lz0+0
  s_mov_b32 s20, 24576
  s_mov_b32 s21, 0xffff4000
  s_mul_i32 s4, s85, 8192
  v_add_u32_e64 v4, s4, v11
  v_add_u32 v5, 1024, v4
  s_cmp_lg_u32 s82, 0
  s_cbranch_scc1 L_2
  v_and_b32 v2, 15, v1
  v_lshrrev_b32 v3, 1, v2
  v_lshrrev_b32 v32, 4, v1
  v_xor_b32 v3, v3, v32
  v_lshlrev_b32_e64 v3, 4, v3
  v_lshl_add_u32 v3, v2, 7, v3
  v_add_u32 v4, s4, v3
  v_xor_b32 v3, 64, v3
  v_add_u32 v5, s4, v3
L_2:
  s_lshl_b32 s4, s86, 1
  v_xor_b32_e64 v2, s4, v26
  v_lshl_add_u32 v6, v2, 5, v25
  s_add_u32 s4, s4, 1
  v_xor_b32 v2, s4, v26
  v_lshl_add_u32 v7, v2, 5, v25
  v_mov_b64 v[128:129], 0
  v_mov_b64 v[130:131], 0
  v_mov_b64 v[132:133], 0
  v_mov_b64 v[134:135], 0
  v_mov_b64 v[136:137], 0
  v_mov_b64 v[138:139], 0
  v_mov_b64 v[140:141], 0
  v_mov_b64 v[142:143], 0
  v_mov_b64 v[144:145], 0
  v_mov_b64 v[146:147], 0
  v_mov_b64 v[148:149], 0
  v_mov_b64 v[150:151], 0
  v_mov_b64 v[152:153], 0
  v_mov_b64 v[154:155], 0
  v_mov_b64 v[156:157], 0
  v_mov_b64 v[158:159], 0
  v_mov_b64 v[160:161], 0
  v_mov_b64 v[162:163], 0
  v_mov_b64 v[164:165], 0
  v_mov_b64 v[166:167], 0
  v_mov_b64 v[168:169], 0
  v_mov_b64 v[170:171], 0
  v_mov_b64 v[172:173], 0
  v_mov_b64 v[174:175], 0
  v_mov_b64 v[176:177], 0
  v_mov_b64 v[178:179], 0
  v_mov_b64 v[180:181], 0
  v_mov_b64 v[182:183], 0
  v_mov_b64 v[184:185], 0
  v_mov_b64 v[186:187], 0
  v_mov_b64 v[188:189], 0
  v_mov_b64 v[190:191], 0
  v_mov_b64 v[192:193], 0
  v_mov_b64 v[194:195], 0
  v_mov_b64 v[196:197], 0
  v_mov_b64 v[198:199], 0
  v_mov_b64 v[200:201], 0
  v_mov_b64 v[202:203], 0
  v_mov_b64 v[204:205], 0
  v_mov_b64 v[206:207], 0
  v_mov_b64 v[208:209], 0
  v_mov_b64 v[210:211], 0
  v_mov_b64 v[212:213], 0
  v_mov_b64 v[214:215], 0
  v_mov_b64 v[216:217], 0
  v_mov_b64 v[218:219], 0
  v_mov_b64 v[220:221], 0
  v_mov_b64 v[222:223], 0
  s_mul_i32 s4, s85, 320
  s_add_u32 s4, s4, 151552
  v_and_b32_e64 v2, 15, v1
  v_lshl_add_u32 v3, v2, 2, s4
  v_add_u32 v10, s4, v29
  s_lshl_b32 s5, s86, 7
  s_add_u32 s5, s5, 153088
  v_add_u32_e64 v8, s5, v29
  v_lshl_add_u32 v2, v2, 2, s5
  s_mov_b32 s10, 0x7f
  s_mov_b32 s12, 0xff00ff00
  s_add_u32 s9, s11, 65536
  v_lshrrev_b32_e64 v9, 1, v11
  v_bfi_b32 v9, s10, v11, v9
  s_mov_b32 s22, Lz1-Lz0+8
  s_cmp_lg_u32 s82, 0
  s_cselect_b64 vcc, -1, 0
  s_waitcnt lgkmcnt(0)
  s_barrier
Lo_6:
  ds_read_b128 v[32:35], v4 offset:0
  ds_read_b128 v[48:51], v5 offset:0
  ds_read_b128 v[36:39], v4 offset:2048
  ds_read_b128 v[52:55], v5 offset:2048
  ds_read_b128 v[40:43], v4 offset:4096
  ds_read_b128 v[56:59], v5 offset:4096
  ds_read_b64_tr_b16 v[96:97], v6 offset:0
  ds_read_b64_tr_b16 v[98:99], v6 offset:2048
  ds_read_b64_tr_b16 v[100:101], v6 offset:4096
  ds_read_b64_tr_b16 v[102:103], v6 offset:6144
  ds_read_b128 v[44:47], v4 offset:6144
  ds_read_b128 v[60:63], v5 offset:6144
  ds_read_b64_tr_b16 v[104:105], v7 offset:0
  s_nop 0
  s_waitcnt lgkmcnt(8)
  ds_read_b64_tr_b16 v[106:107], v7 offset:2048
  ds_read_b64_tr_b16 v[108:109], v7 offset:4096
  ds_read_b64_tr_b16 v[110:111], v7 offset:6144
  s_nop 0
  s_waitcnt lgkmcnt(6)
  .p2align 6
Lk_3:
  v_mfma_f32_16x16x32_bf16 v[128:131], v[96:99], v[32:35], v[128:131]
  ds_read_b64_tr_b16 v[112:113], v6 offset:8192
  v_mfma_f32_16x16x32_bf16 v[128:131], v[100:103], v[48:51], v[128:131]
  ds_read_b64_tr_b16 v[114:115], v6 offset:10240
  v_mfma_f32_16x16x32_bf16 v[136:139], v[100:103], v[52:55], v[136:139]
  ds_read_b64_tr_b16 v[116:117], v6 offset:12288
  v_mfma_f32_16x16x32_bf16 v[136:139], v[96:99], v[36:39], v[136:139]
  ds_read_b64_tr_b16 v[118:119], v6 offset:14336
  v_mfma_f32_16x16x32_bf16 v[144:147], v[96:99], v[40:43], v[144:147]
  s_add_u32 s16, s16, s17
  s_cmp_eq_u32 s16, 65536
  s_cselect_b32 s23, s18, s17
  s_cselect_b32 s16, Lz1-Lz0+0, s16
  v_mfma_f32_16x16x32_bf16 v[144:147], v[100:103], v[56:59], v[144:147]
  v_add_u32_e64 v4, s23, v4
  v_add_u32 v5, s23, v5
  s_add_u32 s19, s19, s20
  s_cmp_eq_u32 s19, 73728
  s_waitcnt lgkmcnt(8)
  v_mfma_f32_16x16x32_bf16 v[152:155], v[100:103], v[60:63], v[152:155]
  s_cselect_b32 s23, s21, s20
  s_cselect_b32 s19, 0, s19
  v_mfma_f32_16x16x32_bf16 v[152:155], v[96:99], v[44:47], v[152:155]
  s_waitcnt lgkmcnt(4)
  v_mfma_f32_16x16x32_bf16 v[156:159], v[104:107], v[44:47], v[156:159]
  ds_read_b64_tr_b16 v[120:121], v7 offset:8192
  v_mfma_f32_16x16x32_bf16 v[156:159], v[108:111], v[60:63], v[156:159]
  ds_read_b64_tr_b16 v[122:123], v7 offset:10240
  v_mfma_f32_16x16x32_bf16 v[148:151], v[108:111], v[56:59], v[148:151]
  ds_read_b64_tr_b16 v[124:125], v7 offset:12288
  v_mfma_f32_16x16x32_bf16 v[148:151], v[104:107], v[40:43], v[148:151]
  ds_read_b64_tr_b16 v[126:127], v7 offset:14336
  v_mfma_f32_16x16x32_bf16 v[140:143], v[104:107], v[36:39], v[140:143]
  ds_read_b64_tr_b16 v[224:225], v6 offset:16384
  v_mfma_f32_16x16x32_bf16 v[140:143], v[108:111], v[52:55], v[140:143]
  ds_read_b64_tr_b16 v[226:227], v6 offset:18432
  v_mfma_f32_16x16x32_bf16 v[132:135], v[108:111], v[48:51], v[132:135]
  ds_read_b64_tr_b16 v[228:229], v6 offset:20480
  v_mfma_f32_16x16x32_bf16 v[132:135], v[104:107], v[32:35], v[132:135]
  ds_read_b64_tr_b16 v[230:231], v6 offset:22528
  s_nop 0
  s_waitcnt lgkmcnt(8)
  v_mfma_f32_16x16x32_bf16 v[160:163], v[112:115], v[32:35], v[160:163]
  ds_read_b64_tr_b16 v[232:233], v7 offset:16384
  v_mfma_f32_16x16x32_bf16 v[160:163], v[116:119], v[48:51], v[160:163]
  ds_read_b64_tr_b16 v[234:235], v7 offset:18432
  v_mfma_f32_16x16x32_bf16 v[168:171], v[116:119], v[52:55], v[168:171]
  ds_read_b64_tr_b16 v[236:237], v7 offset:20480
  v_mfma_f32_16x16x32_bf16 v[168:171], v[112:115], v[36:39], v[168:171]
  ds_read_b64_tr_b16 v[238:239], v7 offset:22528
  v_mfma_f32_16x16x32_bf16 v[176:179], v[112:115], v[40:43], v[176:179]
  v_add_u32_e64 v6, s23, v6
  v_mfma_f32_16x16x32_bf16 v[176:179], v[116:119], v[56:59], v[176:179]
  v_add_u32_e64 v7, s23, v7
  v_mfma_f32_16x16x32_bf16 v[184:187], v[116:119], v[60:63], v[184:187]
  v_mfma_f32_16x16x32_bf16 v[184:187], v[112:115], v[44:47], v[184:187]
  s_waitcnt lgkmcnt(0)
  s_cbranch_vccnz Lo_8
  s_nop 0
  s_barrier
Lo_8:
  v_mfma_f32_16x16x32_bf16 v[188:191], v[120:123], v[44:47], v[188:191]
  ds_read_b128 v[64:67], v4 offset:0
  v_mfma_f32_16x16x32_bf16 v[188:191], v[124:127], v[60:63], v[188:191]
  ds_read_b128 v[80:83], v5 offset:0
  v_mfma_f32_16x16x32_bf16 v[180:183], v[124:127], v[56:59], v[180:183]
  v_mfma_f32_16x16x32_bf16 v[180:183], v[120:123], v[40:43], v[180:183]
  ds_read_b128 v[68:71], v4 offset:2048
  v_mfma_f32_16x16x32_bf16 v[172:175], v[120:123], v[36:39], v[172:175]
  ds_read_b128 v[84:87], v5 offset:2048
  v_mfma_f32_16x16x32_bf16 v[172:175], v[124:127], v[52:55], v[172:175]
  v_mfma_f32_16x16x32_bf16 v[164:167], v[124:127], v[48:51], v[164:167]
  ds_read_b128 v[72:75], v4 offset:4096
  v_mfma_f32_16x16x32_bf16 v[164:167], v[120:123], v[32:35], v[164:167]
  ds_read_b128 v[88:91], v5 offset:4096
  v_mfma_f32_16x16x32_bf16 v[192:195], v[32:35], v[224:227], v[192:195]
  ds_read_b64_tr_b16 v[96:97], v6 offset:0
  v_mfma_f32_16x16x32_bf16 v[192:195], v[48:51], v[228:231], v[192:195]
  ds_read_b64_tr_b16 v[98:99], v6 offset:2048
  v_mfma_f32_16x16x32_bf16 v[200:203], v[52:55], v[228:231], v[200:203]
  ds_read_b64_tr_b16 v[100:101], v6 offset:4096
  v_mfma_f32_16x16x32_bf16 v[200:203], v[36:39], v[224:227], v[200:203]
  ds_read_b64_tr_b16 v[102:103], v6 offset:6144
  v_mfma_f32_16x16x32_bf16 v[208:211], v[40:43], v[224:227], v[208:211]
  ds_read_b128 v[76:79], v4 offset:6144
  v_mfma_f32_16x16x32_bf16 v[208:211], v[56:59], v[228:231], v[208:211]
  v_mfma_f32_16x16x32_bf16 v[216:219], v[60:63], v[228:231], v[216:219]
  ds_read_b128 v[92:95], v5 offset:6144
  v_mfma_f32_16x16x32_bf16 v[216:219], v[44:47], v[224:227], v[216:219]
  v_mfma_f32_16x16x32_bf16 v[220:223], v[44:47], v[232:235], v[220:223]
  ds_read_b64_tr_b16 v[104:105], v7 offset:0
  v_mfma_f32_16x16x32_bf16 v[220:223], v[60:63], v[236:239], v[220:223]
  v_mfma_f32_16x16x32_bf16 v[212:215], v[56:59], v[236:239], v[212:215]
  ds_read_b64_tr_b16 v[106:107], v7 offset:2048
  v_mfma_f32_16x16x32_bf16 v[212:215], v[40:43], v[232:235], v[212:215]
  v_mfma_f32_16x16x32_bf16 v[204:207], v[36:39], v[232:235], v[204:207]
  ds_read_b64_tr_b16 v[108:109], v7 offset:4096
  v_mfma_f32_16x16x32_bf16 v[204:207], v[52:55], v[236:239], v[204:207]
  v_mfma_f32_16x16x32_bf16 v[196:199], v[48:51], v[236:239], v[196:199]
  ds_read_b64_tr_b16 v[110:111], v7 offset:6144
  s_waitcnt lgkmcnt(6)
  v_mfma_f32_16x16x32_bf16 v[196:199], v[32:35], v[232:235], v[196:199]
  s_cbranch_vccnz Lo_7
Lk_4:
  v_mfma_f32_16x16x32_bf16 v[128:131], v[96:99], v[64:67], v[128:131]
  ds_read_b64_tr_b16 v[112:113], v6 offset:8192
  v_mfma_f32_16x16x32_bf16 v[128:131], v[100:103], v[80:83], v[128:131]
  ds_read_b64_tr_b16 v[114:115], v6 offset:10240
  v_mfma_f32_16x16x32_bf16 v[136:139], v[100:103], v[84:87], v[136:139]
  ds_read_b64_tr_b16 v[116:117], v6 offset:12288
  v_mfma_f32_16x16x32_bf16 v[136:139], v[96:99], v[68:71], v[136:139]
  ds_read_b64_tr_b16 v[118:119], v6 offset:14336
  v_mfma_f32_16x16x32_bf16 v[144:147], v[96:99], v[72:75], v[144:147]
  s_add_u32 s16, s16, s17
  s_cmp_eq_u32 s16, 65536
  s_cselect_b32 s23, s18, s17
  s_cselect_b32 s16, Lz1-Lz0+0, s16
  v_mfma_f32_16x16x32_bf16 v[144:147], v[100:103], v[88:91], v[144:147]
  v_add_u32_e64 v4, s23, v4
  v_add_u32 v5, s23, v5
  s_add_u32 s19, s19, s20
  s_cmp_eq_u32 s19, 73728
  s_waitcnt lgkmcnt(8)
  v_mfma_f32_16x16x32_bf16 v[152:155], v[100:103], v[92:95], v[152:155]
  s_cselect_b32 s23, s21, s20
  s_cselect_b32 s19, 0, s19
  v_mfma_f32_16x16x32_bf16 v[152:155], v[96:99], v[76:79], v[152:155]
  s_waitcnt lgkmcnt(4)
  v_mfma_f32_16x16x32_bf16 v[156:159], v[104:107], v[76:79], v[156:159]
  ds_read_b64_tr_b16 v[120:121], v7 offset:8192
  v_mfma_f32_16x16x32_bf16 v[156:159], v[108:111], v[92:95], v[156:159]
  ds_read_b64_tr_b16 v[122:123], v7 offset:10240
  v_mfma_f32_16x16x32_bf16 v[148:151], v[108:111], v[88:91], v[148:151]
  ds_read_b64_tr_b16 v[124:125], v7 offset:12288
  v_mfma_f32_16x16x32_bf16 v[148:151], v[104:107], v[72:75], v[148:151]
  ds_read_b64_tr_b16 v[126:127], v7 offset:14336
  v_mfma_f32_16x16x32_bf16 v[140:143], v[104:107], v[68:71], v[140:143]
  ds_read_b64_tr_b16 v[224:225], v6 offset:16384
  v_mfma_f32_16x16x32_bf16 v[140:143], v[108:111], v[84:87], v[140:143]
  ds_read_b64_tr_b16 v[226:227], v6 offset:18432
  v_mfma_f32_16x16x32_bf16 v[132:135], v[108:111], v[80:83], v[132:135]
  ds_read_b64_tr_b16 v[228:229], v6 offset:20480
  v_mfma_f32_16x16x32_bf16 v[132:135], v[104:107], v[64:67], v[132:135]
  ds_read_b64_tr_b16 v[230:231], v6 offset:22528
  s_nop 0
  s_waitcnt lgkmcnt(8)
  v_mfma_f32_16x16x32_bf16 v[160:163], v[112:115], v[64:67], v[160:163]
  ds_read_b64_tr_b16 v[232:233], v7 offset:16384
  v_mfma_f32_16x16x32_bf16 v[160:163], v[116:119], v[80:83], v[160:163]
  ds_read_b64_tr_b16 v[234:235], v7 offset:18432
  v_mfma_f32_16x16x32_bf16 v[168:171], v[116:119], v[84:87], v[168:171]
  ds_read_b64_tr_b16 v[236:237], v7 offset:20480
  v_mfma_f32_16x16x32_bf16 v[168:171], v[112:115], v[68:71], v[168:171]
  ds_read_b64_tr_b16 v[238:239], v7 offset:22528
  v_mfma_f32_16x16x32_bf16 v[176:179], v[112:115], v[72:75], v[176:179]
  v_add_u32_e64 v6, s23, v6
  v_mfma_f32_16x16x32_bf16 v[176:179], v[116:119], v[88:91], v[176:179]
  v_add_u32_e64 v7, s23, v7
  v_mfma_f32_16x16x32_bf16 v[184:187], v[116:119], v[92:95], v[184:187]
  s_sub_u32 s22, s22, Lz1-Lz0+1
  s_cmp_lg_u32 s22, 0
  v_mfma_f32_16x16x32_bf16 v[184:187], v[112:115], v[76:79], v[184:187]
  s_waitcnt lgkmcnt(0)
  s_barrier
  s_cbranch_scc0 Lk_5
  v_mfma_f32_16x16x32_bf16 v[188:191], v[120:123], v[76:79], v[188:191]
  ds_read_b128 v[32:35], v4 offset:0
  v_mfma_f32_16x16x32_bf16 v[188:191], v[124:127], v[92:95], v[188:191]
  ds_read_b128 v[48:51], v5 offset:0
  v_mfma_f32_16x16x32_bf16 v[180:183], v[124:127], v[88:91], v[180:183]
  v_mfma_f32_16x16x32_bf16 v[180:183], v[120:123], v[72:75], v[180:183]
  ds_read_b128 v[36:39], v4 offset:2048
  v_mfma_f32_16x16x32_bf16 v[172:175], v[120:123], v[68:71], v[172:175]
  ds_read_b128 v[52:55], v5 offset:2048
  v_mfma_f32_16x16x32_bf16 v[172:175], v[124:127], v[84:87], v[172:175]
  v_mfma_f32_16x16x32_bf16 v[164:167], v[124:127], v[80:83], v[164:167]
  ds_read_b128 v[40:43], v4 offset:4096
  v_mfma_f32_16x16x32_bf16 v[164:167], v[120:123], v[64:67], v[164:167]
  ds_read_b128 v[56:59], v5 offset:4096
  v_mfma_f32_16x16x32_bf16 v[192:195], v[64:67], v[224:227], v[192:195]
  ds_read_b64_tr_b16 v[96:97], v6 offset:0
  v_mfma_f32_16x16x32_bf16 v[192:195], v[80:83], v[228:231], v[192:195]
  ds_read_b64_tr_b16 v[98:99], v6 offset:2048
  v_mfma_f32_16x16x32_bf16 v[200:203], v[84:87], v[228:231], v[200:203]
  ds_read_b64_tr_b16 v[100:101], v6 offset:4096
  v_mfma_f32_16x16x32_bf16 v[200:203], v[68:71], v[224:227], v[200:203]
  ds_read_b64_tr_b16 v[102:103], v6 offset:6144
  v_mfma_f32_16x16x32_bf16 v[208:211], v[72:75], v[224:227], v[208:211]
  ds_read_b128 v[44:47], v4 offset:6144
  v_mfma_f32_16x16x32_bf16 v[208:211], v[88:91], v[228:231], v[208:211]
  v_mfma_f32_16x16x32_bf16 v[216:219], v[92:95], v[228:231], v[216:219]
  ds_read_b128 v[60:63], v5 offset:6144
  v_mfma_f32_16x16x32_bf16 v[216:219], v[76:79], v[224:227], v[216:219]
  v_mfma_f32_16x16x32_bf16 v[220:223], v[76:79], v[232:235], v[220:223]
  ds_read_b64_tr_b16 v[104:105], v7 offset:0
  v_mfma_f32_16x16x32_bf16 v[220:223], v[92:95], v[236:239], v[220:223]
  v_mfma_f32_16x16x32_bf16 v[212:215], v[88:91], v[236:239], v[212:215]
  ds_read_b64_tr_b16 v[106:107], v7 offset:2048
  v_mfma_f32_16x16x32_bf16 v[212:215], v[72:75], v[232:235], v[212:215]
  v_mfma_f32_16x16x32_bf16 v[204:207], v[68:71], v[232:235], v[204:207]
  ds_read_b64_tr_b16 v[108:109], v7 offset:4096
  v_mfma_f32_16x16x32_bf16 v[204:207], v[84:87], v[236:239], v[204:207]
  v_mfma_f32_16x16x32_bf16 v[196:199], v[80:83], v[236:239], v[196:199]
  ds_read_b64_tr_b16 v[110:111], v7 offset:6144
  s_waitcnt lgkmcnt(6)
  v_mfma_f32_16x16x32_bf16 v[196:199], v[64:67], v[232:235], v[196:199]
  s_branch Lk_3
Lk_5:
  v_mfma_f32_16x16x32_bf16 v[188:191], v[120:123], v[76:79], v[188:191]
  ds_read2_b32 v[4:5], v3 offset0:48 offset1:208
  ds_read_b128 v[106:109], v8 offset:256
  v_mfma_f32_16x16x32_bf16 v[188:191], v[124:127], v[92:95], v[188:191]
  ds_read_b128 v[110:113], v8 offset:320
  ds_read_b128 v[32:35], v10 offset:192
  v_mfma_f32_16x16x32_bf16 v[216:219], v[92:95], v[228:231], v[216:219]
  ds_read_b128 v[36:39], v10 offset:832
  ds_read2_b32 v[114:115], v2 offset0:128 offset1:144
  v_mfma_f32_16x16x32_bf16 v[216:219], v[76:79], v[224:227], v[216:219]
  ds_read_b128 v[98:101], v8 offset:0
  ds_read_b128 v[102:105], v8 offset:64
  v_mfma_f32_16x16x32_bf16 v[220:223], v[76:79], v[232:235], v[220:223]
  ds_read2_b32 v[6:7], v3 offset0:32 offset1:192
  ds_read2_b32 v[96:97], v3 offset0:16 offset1:176
  v_mfma_f32_16x16x32_bf16 v[220:223], v[92:95], v[236:239], v[220:223]
  v_mfma_f32_16x16x32_bf16 v[180:183], v[124:127], v[88:91], v[180:183]
  v_mfma_f32_16x16x32_bf16 v[180:183], v[120:123], v[72:75], v[180:183]
  v_mfma_f32_16x16x32_bf16 v[172:175], v[120:123], v[68:71], v[172:175]
  s_waitcnt lgkmcnt(4)
  v_mul_f32 v116, v106, v5
  v_mul_f32 v117, v107, v5
  v_mul_f32 v118, v108, v5
  v_mfma_f32_16x16x32_bf16 v[172:175], v[124:127], v[84:87], v[172:175]
  v_mul_f32_e64 v119, v109, v5
  v_fma_f32 v184, v184, v4, -v116
  v_fma_f32 v185, v185, v4, -v117
  v_mfma_f32_16x16x32_bf16 v[164:167], v[124:127], v[80:83], v[164:167]
  v_fma_f32 v186, v186, v4, -v118
  v_fma_f32 v187, v187, v4, -v119
  v_cvt_pk_bf16_f32 v60, v184, v185
  v_mfma_f32_16x16x32_bf16 v[164:167], v[120:123], v[64:67], v[164:167]
  v_cvt_pk_bf16_f32 v61, v186, v187
  v_mul_f32 v116, v110, v5
  v_mul_f32 v117, v111, v5
  v_mfma_f32_16x16x32_bf16 v[192:195], v[64:67], v[224:227], v[192:195]
  ds_read2_b32 v[124:125], v3 offset0:0 offset1:160
  v_mul_f32 v118, v112, v5
  v_mul_f32 v119, v113, v5
  v_fma_f32 v188, v188, v4, -v116
  v_mfma_f32_16x16x32_bf16 v[192:195], v[80:83], v[228:231], v[192:195]
  v_mov_b32 v120, 0x3f803f80
  v_fma_f32 v189, v189, v4, -v117
  v_fma_f32 v190, v190, v4, -v118
  v_fma_f32 v191, v191, v4, -v119
  v_mfma_f32_16x16x32_bf16 v[196:199], v[80:83], v[236:239], v[196:199]
  v_mov_b32 v121, 0x3f803f80
  v_cvt_pk_bf16_f32 v62, v188, v189
  v_cvt_pk_bf16_f32 v63, v190, v191
  v_mfma_f32_16x16x32_bf16 v[196:199], v[64:67], v[232:235], v[196:199]
  v_mov_b32 v122, 0x3f803f80
  s_mov_b32 exec_lo, s12
  s_mov_b32 exec_hi, s12
  buffer_store_dwordx4 v[60:63], v9, s[40:43], s9 offen sc0 sc1
  s_mov_b64 exec, -1
  v_mul_f32 v116, v36, v114
  v_mul_f32 v117, v37, v114
  v_mul_f32 v118, v38, v114
  v_mfma_f32_16x16x32_bf16 v[204:207], v[68:71], v[232:235], v[204:207]
  v_mov_b32 v123, 0x3f803f80
  v_mul_f32_e64 v119, v39, v114
  v_fma_f32 v216, v216, v32, -v116
  v_fma_f32 v217, v217, v33, -v117
  v_mfma_f32_16x16x32_bf16 v[204:207], v[84:87], v[236:239], v[204:207]
  v_fma_f32 v218, v218, v34, -v118
  v_fma_f32 v219, v219, v35, -v119
  v_cvt_pk_bf16_f32 v76, v216, v217
  v_mfma_f32_16x16x32_bf16 v[200:203], v[84:87], v[228:231], v[200:203]
  v_cvt_pk_bf16_f32 v77, v218, v219
  v_mul_f32 v116, v36, v115
  v_mul_f32 v117, v37, v115
  v_mfma_f32_16x16x32_bf16 v[200:203], v[68:71], v[224:227], v[200:203]
  v_mul_f32 v118, v38, v115
  v_mul_f32 v119, v39, v115
  v_fma_f32 v220, v220, v32, -v116
  v_mfma_f32_16x16x32_bf16 v[208:211], v[72:75], v[224:227], v[208:211]
  v_fma_f32 v221, v221, v33, -v117
  v_fma_f32 v222, v222, v34, -v118
  v_fma_f32 v223, v223, v35, -v119
  v_mfma_f32_16x16x32_bf16 v[208:211], v[88:91], v[228:231], v[208:211]
  v_cvt_pk_bf16_f32 v78, v220, v221
  v_cvt_pk_bf16_f32 v79, v222, v223
  v_mfma_f32_16x16x32_bf16 v[212:215], v[88:91], v[236:239], v[212:215]
  s_mov_b32 exec_lo, 0
  buffer_store_dwordx4 v[76:79], v11, s[40:43], s9 offen sc0 sc1
  s_mov_b64 exec, -1
  v_mfma_f32_16x16x32_bf16 v[212:215], v[72:75], v[232:235], v[212:215]
  v_mov_b64_e64 v[86:87], v[78:79]
  s_cmp_lg_u32 s82, 0
  s_cbranch_scc1 L_9
  buffer_load_dwordx4 v[240:243], v255, s[44:47], s25 offen
  s_add_u32 s25, s25, 0x10000
  buffer_load_dwordx4 v[244:247], v255, s[44:47], s25 offen
  s_add_u32 s25, s25, 0x10000
  buffer_load_dwordx4 v[248:251], v255, s[44:47], s25 offen
  s_add_u32 s25, s25, 0x10000
  buffer_load_dwordx4 v[252:255], v255, s[44:47], s25 offen
L_9:
  v_mov_b64 v[64:65], 0
  v_mov_b64 v[66:67], 0
  v_mov_b64_e64 v[232:233], 0
  v_mov_b64 v[234:235], 0
  s_waitcnt lgkmcnt(0)
  v_pk_mul_f32 v[116:117], v[98:99], v[124:125] op_sel:[0,1] op_sel_hi:[1,1]
  v_pk_mul_f32 v[118:119], v[100:101], v[124:125] op_sel:[0,1] op_sel_hi:[1,1]
  v_pk_fma_f32 v[128:129], v[128:129], v[124:125], v[116:117] op_sel:[0,0,0] op_sel_hi:[1,0,1] neg_lo:[0,0,1] neg_hi:[0,0,1]
  v_pk_fma_f32 v[130:131], v[130:131], v[124:125], v[118:119] op_sel:[0,0,0] op_sel_hi:[1,0,1] neg_lo:[0,0,1] neg_hi:[0,0,1]
  v_cvt_pk_bf16_f32 v32, v128, v129
  v_cvt_pk_bf16_f32 v33, v130, v131
  v_pk_mul_f32 v[116:117], v[102:103], v[124:125] op_sel:[0,1] op_sel_hi:[1,1]
  v_pk_mul_f32 v[118:119], v[104:105], v[124:125] op_sel:[0,1] op_sel_hi:[1,1]
  v_pk_fma_f32 v[132:133], v[132:133], v[124:125], v[116:117] op_sel:[0,0,0] op_sel_hi:[1,0,1] neg_lo:[0,0,1] neg_hi:[0,0,1]
  v_pk_fma_f32 v[134:135], v[134:135], v[124:125], v[118:119] op_sel:[0,0,0] op_sel_hi:[1,0,1] neg_lo:[0,0,1] neg_hi:[0,0,1]
  v_cvt_pk_bf16_f32 v34, v132, v133
  v_cvt_pk_bf16_f32 v35, v134, v135
  v_pk_mul_f32 v[116:117], v[98:99], v[96:97] op_sel:[0,1] op_sel_hi:[1,1]
  v_pk_mul_f32 v[118:119], v[100:101], v[96:97] op_sel:[0,1] op_sel_hi:[1,1]
  v_pk_fma_f32 v[136:137], v[136:137], v[96:97], v[116:117] op_sel:[0,0,0] op_sel_hi:[1,0,1] neg_lo:[0,0,1] neg_hi:[0,0,1]
  v_pk_fma_f32 v[138:139], v[138:139], v[96:97], v[118:119] op_sel:[0,0,0] op_sel_hi:[1,0,1] neg_lo:[0,0,1] neg_hi:[0,0,1]
  v_cvt_pk_bf16_f32 v36, v136, v137
  v_cvt_pk_bf16_f32 v37, v138, v139
  v_pk_mul_f32 v[116:117], v[102:103], v[96:97] op_sel:[0,1] op_sel_hi:[1,1]
  v_pk_mul_f32 v[118:119], v[104:105], v[96:97] op_sel:[0,1] op_sel_hi:[1,1]
  v_pk_fma_f32 v[140:141], v[140:141], v[96:97], v[116:117] op_sel:[0,0,0] op_sel_hi:[1,0,1] neg_lo:[0,0,1] neg_hi:[0,0,1]
  v_pk_fma_f32 v[142:143], v[142:143], v[96:97], v[118:119] op_sel:[0,0,0] op_sel_hi:[1,0,1] neg_lo:[0,0,1] neg_hi:[0,0,1]
  v_cvt_pk_bf16_f32 v38, v140, v141
  v_cvt_pk_bf16_f32 v39, v142, v143
  v_pk_mul_f32 v[116:117], v[98:99], v[6:7] op_sel:[0,1] op_sel_hi:[1,1]
  v_pk_mul_f32 v[118:119], v[100:101], v[6:7] op_sel:[0,1] op_sel_hi:[1,1]
  v_pk_fma_f32 v[144:145], v[144:145], v[6:7], v[116:117] op_sel:[0,0,0] op_sel_hi:[1,0,1] neg_lo:[0,0,1] neg_hi:[0,0,1]
  v_pk_fma_f32 v[146:147], v[146:147], v[6:7], v[118:119] op_sel:[0,0,0] op_sel_hi:[1,0,1] neg_lo:[0,0,1] neg_hi:[0,0,1]
  v_cvt_pk_bf16_f32 v40, v144, v145
  v_cvt_pk_bf16_f32 v41, v146, v147
  v_pk_mul_f32 v[116:117], v[102:103], v[6:7] op_sel:[0,1] op_sel_hi:[1,1]
  v_pk_mul_f32 v[118:119], v[104:105], v[6:7] op_sel:[0,1] op_sel_hi:[1,1]
  v_pk_fma_f32 v[148:149], v[148:149], v[6:7], v[116:117] op_sel:[0,0,0] op_sel_hi:[1,0,1] neg_lo:[0,0,1] neg_hi:[0,0,1]
  v_pk_fma_f32 v[150:151], v[150:151], v[6:7], v[118:119] op_sel:[0,0,0] op_sel_hi:[1,0,1] neg_lo:[0,0,1] neg_hi:[0,0,1]
  v_cvt_pk_bf16_f32 v42, v148, v149
  v_cvt_pk_bf16_f32 v43, v150, v151
  v_pk_mul_f32 v[116:117], v[98:99], v[4:5] op_sel:[0,1] op_sel_hi:[1,1]
  v_pk_mul_f32 v[118:119], v[100:101], v[4:5] op_sel:[0,1] op_sel_hi:[1,1]
  v_pk_fma_f32 v[152:153], v[152:153], v[4:5], v[116:117] op_sel:[0,0,0] op_sel_hi:[1,0,1] neg_lo:[0,0,1] neg_hi:[0,0,1]
  v_pk_fma_f32 v[154:155], v[154:155], v[4:5], v[118:119] op_sel:[0,0,0] op_sel_hi:[1,0,1] neg_lo:[0,0,1] neg_hi:[0,0,1]
  v_cvt_pk_bf16_f32 v44, v152, v153
  v_cvt_pk_bf16_f32 v45, v154, v155
  v_pk_mul_f32 v[116:117], v[102:103], v[4:5] op_sel:[0,1] op_sel_hi:[1,1]
  v_pk_mul_f32 v[118:119], v[104:105], v[4:5] op_sel:[0,1] op_sel_hi:[1,1]
  v_pk_fma_f32 v[156:157], v[156:157], v[4:5], v[116:117] op_sel:[0,0,0] op_sel_hi:[1,0,1] neg_lo:[0,0,1] neg_hi:[0,0,1]
  v_pk_fma_f32 v[158:159], v[158:159], v[4:5], v[118:119] op_sel:[0,0,0] op_sel_hi:[1,0,1] neg_lo:[0,0,1] neg_hi:[0,0,1]
  v_cvt_pk_bf16_f32 v46, v156, v157
  v_cvt_pk_bf16_f32 v47, v158, v159
  ds_read_b128 v[128:131], v10 offset:0
  ds_read_b128 v[132:135], v10 offset:640
  ds_read_b128 v[136:139], v10 offset:64
  ds_read_b128 v[140:143], v10 offset:704
  ds_read_b128 v[144:147], v10 offset:128
  ds_read_b128 v[148:151], v10 offset:768
  v_pk_mul_f32 v[116:117], v[106:107], v[124:125] op_sel:[0,1] op_sel_hi:[1,1]
  v_pk_mul_f32 v[118:119], v[108:109], v[124:125] op_sel:[0,1] op_sel_hi:[1,1]
  v_pk_fma_f32 v[160:161], v[160:161], v[124:125], v[116:117] op_sel:[0,0,0] op_sel_hi:[1,0,1] neg_lo:[0,0,1] neg_hi:[0,0,1]
  v_pk_fma_f32 v[162:163], v[162:163], v[124:125], v[118:119] op_sel:[0,0,0] op_sel_hi:[1,0,1] neg_lo:[0,0,1] neg_hi:[0,0,1]
  v_cvt_pk_bf16_f32 v48, v160, v161
  v_cvt_pk_bf16_f32 v49, v162, v163
  v_pk_mul_f32 v[116:117], v[110:111], v[124:125] op_sel:[0,1] op_sel_hi:[1,1]
  v_pk_mul_f32 v[118:119], v[112:113], v[124:125] op_sel:[0,1] op_sel_hi:[1,1]
  v_pk_fma_f32 v[164:165], v[164:165], v[124:125], v[116:117] op_sel:[0,0,0] op_sel_hi:[1,0,1] neg_lo:[0,0,1] neg_hi:[0,0,1]
  v_pk_fma_f32 v[166:167], v[166:167], v[124:125], v[118:119] op_sel:[0,0,0] op_sel_hi:[1,0,1] neg_lo:[0,0,1] neg_hi:[0,0,1]
  v_cvt_pk_bf16_f32 v50, v164, v165
  v_cvt_pk_bf16_f32 v51, v166, v167
  v_pk_mul_f32 v[116:117], v[106:107], v[96:97] op_sel:[0,1] op_sel_hi:[1,1]
  v_pk_mul_f32 v[118:119], v[108:109], v[96:97] op_sel:[0,1] op_sel_hi:[1,1]
  v_pk_fma_f32 v[168:169], v[168:169], v[96:97], v[116:117] op_sel:[0,0,0] op_sel_hi:[1,0,1] neg_lo:[0,0,1] neg_hi:[0,0,1]
  v_pk_fma_f32 v[170:171], v[170:171], v[96:97], v[118:119] op_sel:[0,0,0] op_sel_hi:[1,0,1] neg_lo:[0,0,1] neg_hi:[0,0,1]
  v_cvt_pk_bf16_f32 v52, v168, v169
  v_cvt_pk_bf16_f32 v53, v170, v171
  v_pk_mul_f32 v[116:117], v[110:111], v[96:97] op_sel:[0,1] op_sel_hi:[1,1]
  v_pk_mul_f32 v[118:119], v[112:113], v[96:97] op_sel:[0,1] op_sel_hi:[1,1]
  v_pk_fma_f32 v[172:173], v[172:173], v[96:97], v[116:117] op_sel:[0,0,0] op_sel_hi:[1,0,1] neg_lo:[0,0,1] neg_hi:[0,0,1]
  v_pk_fma_f32 v[174:175], v[174:175], v[96:97], v[118:119] op_sel:[0,0,0] op_sel_hi:[1,0,1] neg_lo:[0,0,1] neg_hi:[0,0,1]
  v_cvt_pk_bf16_f32 v54, v172, v173
  v_cvt_pk_bf16_f32 v55, v174, v175
  v_pk_mul_f32 v[116:117], v[106:107], v[6:7] op_sel:[0,1] op_sel_hi:[1,1]
  v_pk_mul_f32 v[118:119], v[108:109], v[6:7] op_sel:[0,1] op_sel_hi:[1,1]
  v_pk_fma_f32 v[176:177], v[176:177], v[6:7], v[116:117] op_sel:[0,0,0] op_sel_hi:[1,0,1] neg_lo:[0,0,1] neg_hi:[0,0,1]
  v_pk_fma_f32 v[178:179], v[178:179], v[6:7], v[118:119] op_sel:[0,0,0] op_sel_hi:[1,0,1] neg_lo:[0,0,1] neg_hi:[0,0,1]
  v_cvt_pk_bf16_f32 v56, v176, v177
  v_cvt_pk_bf16_f32 v57, v178, v179
  v_pk_mul_f32 v[116:117], v[110:111], v[6:7] op_sel:[0,1] op_sel_hi:[1,1]
  v_pk_mul_f32 v[118:119], v[112:113], v[6:7] op_sel:[0,1] op_sel_hi:[1,1]
  v_pk_fma_f32 v[180:181], v[180:181], v[6:7], v[116:117] op_sel:[0,0,0] op_sel_hi:[1,0,1] neg_lo:[0,0,1] neg_hi:[0,0,1]
  v_pk_fma_f32 v[182:183], v[182:183], v[6:7], v[118:119] op_sel:[0,0,0] op_sel_hi:[1,0,1] neg_lo:[0,0,1] neg_hi:[0,0,1]
  v_cvt_pk_bf16_f32 v58, v180, v181
  v_cvt_pk_bf16_f32 v59, v182, v183
  v_mfma_f32_16x16x32_bf16 v[164:167], v[48:51], v[32:35], v[12:15]
  v_mfma_f32_16x16x32_bf16 v[168:171], v[48:51], v[36:39], v[16:19]
  v_mfma_f32_16x16x32_bf16 v[172:175], v[52:55], v[36:39], v[12:15]
  v_mfma_f32_16x16x32_bf16 v[176:179], v[52:55], v[40:43], v[16:19]
  v_mfma_f32_16x16x32_bf16 v[180:183], v[56:59], v[40:43], v[12:15]
  v_mfma_f32_16x16x32_bf16 v[184:187], v[56:59], v[44:47], v[16:19]
  v_mfma_f32_16x16x32_bf16 v[188:191], v[60:63], v[44:47], v[12:15]
  s_nop 0
  s_waitcnt lgkmcnt(0)
  v_pk_mul_f32 v[116:117], v[132:133], v[114:115] op_sel:[0,0] op_sel_hi:[1,0]
  v_pk_mul_f32 v[118:119], v[134:135], v[114:115] op_sel:[0,0] op_sel_hi:[1,0]
  v_pk_fma_f32 v[192:193], v[192:193], v[128:129], v[116:117] neg_lo:[0,0,1] neg_hi:[0,0,1]
  v_pk_fma_f32 v[194:195], v[194:195], v[130:131], v[118:119] neg_lo:[0,0,1] neg_hi:[0,0,1]
  v_cvt_pk_bf16_f32 v70, v192, v193
  v_cvt_pk_bf16_f32 v71, v194, v195
  v_pk_mul_f32 v[116:117], v[132:133], v[114:115] op_sel:[0,1] op_sel_hi:[1,1]
  v_pk_mul_f32 v[118:119], v[134:135], v[114:115] op_sel:[0,1] op_sel_hi:[1,1]
  v_pk_fma_f32 v[196:197], v[196:197], v[128:129], v[116:117] neg_lo:[0,0,1] neg_hi:[0,0,1]
  v_pk_fma_f32 v[198:199], v[198:199], v[130:131], v[118:119] neg_lo:[0,0,1] neg_hi:[0,0,1]
  v_cvt_pk_bf16_f32 v80, v196, v197
  v_cvt_pk_bf16_f32 v81, v198, v199
  v_pk_mul_f32 v[116:117], v[140:141], v[114:115] op_sel:[0,0] op_sel_hi:[1,0]
  v_pk_mul_f32 v[118:119], v[142:143], v[114:115] op_sel:[0,0] op_sel_hi:[1,0]
  v_pk_fma_f32 v[200:201], v[200:201], v[136:137], v[116:117] neg_lo:[0,0,1] neg_hi:[0,0,1]
  v_pk_fma_f32 v[202:203], v[202:203], v[138:139], v[118:119] neg_lo:[0,0,1] neg_hi:[0,0,1]
  v_cvt_pk_bf16_f32 v72, v200, v201
  v_cvt_pk_bf16_f32 v73, v202, v203
  v_pk_mul_f32 v[116:117], v[140:141], v[114:115] op_sel:[0,1] op_sel_hi:[1,1]
  v_pk_mul_f32 v[118:119], v[142:143], v[114:115] op_sel:[0,1] op_sel_hi:[1,1]
  v_pk_fma_f32 v[204:205], v[204:205], v[136:137], v[116:117] neg_lo:[0,0,1] neg_hi:[0,0,1]
  v_pk_fma_f32 v[206:207], v[206:207], v[138:139], v[118:119] neg_lo:[0,0,1] neg_hi:[0,0,1]
  v_cvt_pk_bf16_f32 v82, v204, v205
  v_cvt_pk_bf16_f32 v83, v206, v207
  v_pk_mul_f32 v[116:117], v[148:149], v[114:115] op_sel:[0,0] op_sel_hi:[1,0]
  v_pk_mul_f32 v[118:119], v[150:151], v[114:115] op_sel:[0,0] op_sel_hi:[1,0]
  v_pk_fma_f32 v[208:209], v[208:209], v[144:145], v[116:117] neg_lo:[0,0,1] neg_hi:[0,0,1]
  v_pk_fma_f32 v[210:211], v[210:211], v[146:147], v[118:119] neg_lo:[0,0,1] neg_hi:[0,0,1]
  v_cvt_pk_bf16_f32 v74, v208, v209
  v_cvt_pk_bf16_f32 v75, v210, v211
  v_pk_mul_f32 v[116:117], v[148:149], v[114:115] op_sel:[0,1] op_sel_hi:[1,1]
  v_pk_mul_f32 v[118:119], v[150:151], v[114:115] op_sel:[0,1] op_sel_hi:[1,1]
  v_pk_fma_f32 v[212:213], v[212:213], v[144:145], v[116:117] neg_lo:[0,0,1] neg_hi:[0,0,1]
  v_pk_fma_f32 v[214:215], v[214:215], v[146:147], v[118:119] neg_lo:[0,0,1] neg_hi:[0,0,1]
  v_cvt_pk_bf16_f32 v84, v212, v213
  v_cvt_pk_bf16_f32 v85, v214, v215
  v_max3_f32 v90, v172, v173, v174
  v_max3_f32 v99, v175, v168, v169
  v_max3_f32 v92, v180, v181, v182
  v_max3_f32 v100, v183, v176, v177
  v_max3_f32 v94, v188, v189, v190
  v_max3_f32 v101, v191, v184, v185
  v_max3_f32 v90, v90, v170, v171
  v_max3_f32 v92, v92, v178, v179
  v_max3_f32 v94, v94, v186, v187
  v_max_f32 v90, v90, v99
  v_max_f32 v92, v92, v100
  v_max_f32 v94, v94, v101
  v_mov_b32 v99, v90
  v_mov_b32 v100, v92
  v_mov_b32 v101, v94
  v_permlane32_swap_b32 v90, v99
  v_permlane32_swap_b32 v92, v100
  v_permlane32_swap_b32 v94, v101
  v_max_f32 v90, v90, v99
  v_max_f32 v92, v92, v100
  v_max_f32 v94, v94, v101
  v_mov_b32 v99, v90
  v_mov_b32 v100, v92
  v_mov_b32 v101, v94
  v_permlane16_swap_b32 v90, v99
  v_permlane16_swap_b32 v92, v100
  v_permlane16_swap_b32 v94, v101
  v_max_f32 v90, v90, v99
  v_max_f32 v92, v92, v100
  v_max_f32_e64 v94, v94, v101
  s_mov_b32 s4, 0x3e8293ee
  v_mul_f32 v90, s4, v90
  v_mov_b32 v91, s4
  v_mul_f32 v92, s4, v92
  v_mov_b32 v93, s4
  v_mul_f32 v94, s4, v94
  v_mov_b32 v95, s4
  v_pk_fma_f32 v[168:169], v[168:169], v[90:91], v[90:91] op_sel:[0,1,0] op_sel_hi:[1,1,0] neg_lo:[0,0,1] neg_hi:[0,0,1]
  v_pk_fma_f32 v[170:171], v[170:171], v[90:91], v[90:91] op_sel:[0,1,0] op_sel_hi:[1,1,0] neg_lo:[0,0,1] neg_hi:[0,0,1]
  v_pk_fma_f32 v[172:173], v[172:173], v[90:91], v[90:91] op_sel:[0,1,0] op_sel_hi:[1,1,0] neg_lo:[0,0,1] neg_hi:[0,0,1]
  v_pk_fma_f32 v[174:175], v[174:175], v[90:91], v[90:91] op_sel:[0,1,0] op_sel_hi:[1,1,0] neg_lo:[0,0,1] neg_hi:[0,0,1]
  v_pk_fma_f32 v[176:177], v[176:177], v[92:93], v[92:93] op_sel:[0,1,0] op_sel_hi:[1,1,0] neg_lo:[0,0,1] neg_hi:[0,0,1]
  v_pk_fma_f32 v[178:179], v[178:179], v[92:93], v[92:93] op_sel:[0,1,0] op_sel_hi:[1,1,0] neg_lo:[0,0,1] neg_hi:[0,0,1]
  v_pk_fma_f32 v[180:181], v[180:181], v[92:93], v[92:93] op_sel:[0,1,0] op_sel_hi:[1,1,0] neg_lo:[0,0,1] neg_hi:[0,0,1]
  v_pk_fma_f32 v[182:183], v[182:183], v[92:93], v[92:93] op_sel:[0,1,0] op_sel_hi:[1,1,0] neg_lo:[0,0,1] neg_hi:[0,0,1]
  v_pk_fma_f32 v[184:185], v[184:185], v[94:95], v[94:95] op_sel:[0,1,0] op_sel_hi:[1,1,0] neg_lo:[0,0,1] neg_hi:[0,0,1]
  v_pk_fma_f32 v[186:187], v[186:187], v[94:95], v[94:95] op_sel:[0,1,0] op_sel_hi:[1,1,0] neg_lo:[0,0,1] neg_hi:[0,0,1]
  v_pk_fma_f32 v[188:189], v[188:189], v[94:95], v[94:95] op_sel:[0,1,0] op_sel_hi:[1,1,0] neg_lo:[0,0,1] neg_hi:[0,0,1]
  v_pk_fma_f32 v[190:191], v[190:191], v[94:95], v[94:95] op_sel:[0,1,0] op_sel_hi:[1,1,0] neg_lo:[0,0,1] neg_hi:[0,0,1]
  s_lshl_b32 s6, s84, Lz1-Lz0+3
  s_add_u32 s6, s6, 3145728
  s_add_u32 s7, s6, 4096
  s_mov_b32 exec_lo, s12
  s_mov_b32 exec_hi, s12
  buffer_load_dwordx4 v[64:67], v9, s[40:43], s11 offen sc0 sc1
  s_mov_b32 exec_lo, 0
  s_mov_b32 exec_hi, -1
  buffer_load_dwordx4 v[232:235], v11, s[40:43], s11 offen sc0 sc1
  s_mov_b64 exec, -1
  v_exp_f32 v168, v168
  v_exp_f32 v169, v169
  v_exp_f32 v170, v170
  v_exp_f32 v171, v171
  v_exp_f32 v172, v172
  v_exp_f32 v173, v173
  v_exp_f32 v174, v174
  v_exp_f32_e64 v175, v175
  v_cvt_pk_bf16_f32 v36, v168, v169
  v_cvt_pk_bf16_f32 v37, v170, v171
  v_cvt_pk_bf16_f32 v38, v172, v173
  v_cvt_pk_bf16_f32 v39, v174, v175
  v_exp_f32 v176, v176
  v_exp_f32 v177, v177
  v_exp_f32 v178, v178
  v_exp_f32 v179, v179
  v_exp_f32 v180, v180
  v_exp_f32 v181, v181
  v_exp_f32 v182, v182
  v_exp_f32 v183, v183
  v_cvt_pk_bf16_f32 v40, v176, v177
  v_cvt_pk_bf16_f32 v41, v178, v179
  v_cvt_pk_bf16_f32 v42, v180, v181
  v_cvt_pk_bf16_f32 v43, v182, v183
  v_mfma_f32_16x16x32_bf16 v[132:135], v[120:123], v[36:39], 0
  v_mfma_f32_16x16x32_bf16 v[200:203], v[70:73], v[36:39], 0
  v_mfma_f32_16x16x32_bf16 v[204:207], v[80:83], v[36:39], 0
  v_exp_f32 v184, v184
  v_exp_f32 v185, v185
  v_exp_f32 v186, v186
  v_exp_f32 v187, v187
  v_exp_f32 v188, v188
  v_exp_f32 v189, v189
  v_exp_f32 v190, v190
  v_exp_f32 v191, v191
  v_cvt_pk_bf16_f32 v44, v184, v185
  v_cvt_pk_bf16_f32 v45, v186, v187
  v_cvt_pk_bf16_f32 v46, v188, v189
  v_cvt_pk_bf16_f32 v47, v190, v191
  v_mfma_f32_16x16x32_bf16 v[136:139], v[120:123], v[40:43], 0
  v_mfma_f32_16x16x32_bf16 v[208:211], v[72:75], v[40:43], 0
  v_mfma_f32_16x16x32_bf16 v[212:215], v[82:85], v[40:43], 0
  v_mfma_f32_16x16x32_bf16 v[140:143], v[120:123], v[44:47], 0
  v_mfma_f32_16x16x32_bf16 v[216:219], v[74:77], v[44:47], 0
  v_mfma_f32_16x16x32_bf16 v[220:223], v[84:87], v[44:47], 0
  v_rcp_f32 v132, v132
  s_nop 0
  v_pk_mul_f32 v[200:201], v[200:201], v[132:133] op_sel_hi:[1,0]
  v_pk_mul_f32 v[202:203], v[202:203], v[132:133] op_sel_hi:[1,0]
  v_pk_mul_f32 v[204:205], v[204:205], v[132:133] op_sel_hi:[1,0]
  v_pk_mul_f32 v[206:207], v[206:207], v[132:133] op_sel_hi:[1,0]
  v_cvt_pk_bf16_f32 v52, v200, v201
  v_cvt_pk_bf16_f32 v53, v202, v203
  v_cvt_pk_bf16_f32 v54, v204, v205
  v_cvt_pk_bf16_f32 v55, v206, v207
  buffer_store_dwordx4 v[52:55], v0, s[40:43], s6 offen offset:2048 sc0 sc1
  ds_write_b128 v0, v[52:55] offset:2048
  v_rcp_f32 v136, v136
  s_nop 0
  v_pk_mul_f32 v[208:209], v[208:209], v[136:137] op_sel_hi:[1,0]
  v_pk_mul_f32 v[210:211], v[210:211], v[136:137] op_sel_hi:[1,0]
  v_pk_mul_f32 v[212:213], v[212:213], v[136:137] op_sel_hi:[1,0]
  v_pk_mul_f32 v[214:215], v[214:215], v[136:137] op_sel_hi:[1,0]
  v_cvt_pk_bf16_f32 v56, v208, v209
  v_cvt_pk_bf16_f32 v57, v210, v211
  v_cvt_pk_bf16_f32 v58, v212, v213
  v_cvt_pk_bf16_f32 v59, v214, v215
  buffer_store_dwordx4 v[56:59], v0, s[40:43], s7 offen offset:0 sc0 sc1
  ds_write_b128 v0, v[56:59] offset:4096
  v_rcp_f32 v140, v140
  s_nop 0
  v_pk_mul_f32 v[216:217], v[216:217], v[140:141] op_sel_hi:[1,0]
  v_pk_mul_f32 v[218:219], v[218:219], v[140:141] op_sel_hi:[1,0]
  v_pk_mul_f32 v[220:221], v[220:221], v[140:141] op_sel_hi:[1,0]
  v_pk_mul_f32 v[222:223], v[222:223], v[140:141] op_sel_hi:[1,0]
  v_cvt_pk_bf16_f32 v60, v216, v217
  v_cvt_pk_bf16_f32 v61, v218, v219
  v_cvt_pk_bf16_f32 v62, v220, v221
  v_cvt_pk_bf16_f32 v63, v222, v223
  buffer_store_dwordx4 v[60:63], v0, s[40:43], s7 offen offset:2048 sc0 sc1
  ds_write_b128 v0, v[60:63] offset:6144
  s_cmp_eq_u32 s76, Lz1-Lz0+0
  s_mov_b32 s89, 200000
  s_waitcnt vmcnt(3)
  s_cbranch_scc0 Lh_11
  v_mov_b64 v[64:65], 0
  v_mov_b64 v[66:67], 0
  v_mov_b64 v[232:233], 0
  v_mov_b64 v[234:235], 0
  s_branch Lh_12
  s_nop 0
Lh_10:
  s_mov_b32 exec_lo, s12
  s_mov_b32 exec_hi, s12
  buffer_load_dwordx4 v[64:67], v9, s[40:43], s11 offen sc0 sc1
  s_mov_b32 exec_lo, 0
  s_mov_b32 exec_hi, -1
  buffer_load_dwordx4 v[232:235], v11, s[40:43], s11 offen sc0 sc1
  s_mov_b64 exec, -1
  s_waitcnt vmcnt(0)
Lh_11:
  v_max3_u32 v2, v64, v65, v66
  v_max3_u32 v3, v232, v233, v234
  v_max3_u32 v2, v2, v67, v235
  v_max_u32_e64 v2, v2, v3
  v_cmp_eq_u32 vcc, -1, v2
  s_cbranch_vccz Lh_12
  s_sub_u32 s89, s89, 1
  s_cbranch_scc0 Lh_10
Lh_12:
  v_mfma_f32_16x16x32_bf16 v[160:163], v[64:67], v[32:35], v[20:23]
  v_mov_b64 v[68:69], v[232:233]
  v_mov_b64 v[78:79], v[234:235]
  v_mov_b64 v[236:237], -1
  v_mov_b64 v[238:239], -1
  buffer_store_dwordx4 v[236:239], v11, s[40:43], s11 offen sc0 sc1
  v_max3_f32 v88, v164, v165, v166
  s_nop 0
  s_nop 1
  v_max3_f32 v98, v167, v160, v161
  v_max3_f32 v88, v88, v162, v163
  v_max_f32 v88, v88, v98
  v_mov_b32 v98, v88
  s_nop 1
  v_permlane32_swap_b32 v88, v98
  v_max_f32 v88, v88, v98
  v_mov_b32 v98, v88
  s_nop 1
  v_permlane16_swap_b32 v88, v98
  v_max_f32_e64 v88, v88, v98
  s_mov_b32 s4, 0x3e8293ee
  v_mul_f32 v88, s4, v88
  v_mov_b32 v89, s4
  v_pk_fma_f32 v[160:161], v[160:161], v[88:89], v[88:89] op_sel:[0,1,0] op_sel_hi:[1,1,0] neg_lo:[0,0,1] neg_hi:[0,0,1]
  v_pk_fma_f32 v[162:163], v[162:163], v[88:89], v[88:89] op_sel:[0,1,0] op_sel_hi:[1,1,0] neg_lo:[0,0,1] neg_hi:[0,0,1]
  v_pk_fma_f32 v[164:165], v[164:165], v[88:89], v[88:89] op_sel:[0,1,0] op_sel_hi:[1,1,0] neg_lo:[0,0,1] neg_hi:[0,0,1]
  v_pk_fma_f32 v[166:167], v[166:167], v[88:89], v[88:89] op_sel:[0,1,0] op_sel_hi:[1,1,0] neg_lo:[0,0,1] neg_hi:[0,0,1]
  v_exp_f32 v160, v160
  v_exp_f32 v161, v161
  v_exp_f32 v162, v162
  v_exp_f32 v163, v163
  v_exp_f32 v164, v164
  v_exp_f32 v165, v165
  v_exp_f32 v166, v166
  v_exp_f32 v167, v167
  v_cvt_pk_bf16_f32 v32, v160, v161
  v_cvt_pk_bf16_f32 v33, v162, v163
  v_cvt_pk_bf16_f32 v34, v164, v165
  v_cvt_pk_bf16_f32 v35, v166, v167
  s_nop 0
  s_nop 1
  v_mfma_f32_16x16x32_bf16 v[128:131], v[120:123], v[32:35], 0
  v_mfma_f32_16x16x32_bf16 v[192:195], v[68:71], v[32:35], 0
  v_mfma_f32_16x16x32_bf16 v[196:199], v[78:81], v[32:35], 0
  s_nop 5
  v_rcp_f32_e64 v128, v128
  s_nop 0
  v_pk_mul_f32 v[192:193], v[192:193], v[128:129] op_sel_hi:[1,0]
  v_pk_mul_f32 v[194:195], v[194:195], v[128:129] op_sel_hi:[1,0]
  v_pk_mul_f32 v[196:197], v[196:197], v[128:129] op_sel_hi:[1,0]
  v_pk_mul_f32 v[198:199], v[198:199], v[128:129] op_sel_hi:[1,0]
  v_cvt_pk_bf16_f32 v48, v192, v193
  v_cvt_pk_bf16_f32 v49, v194, v195
  v_cvt_pk_bf16_f32 v50, v196, v197
  v_cvt_pk_bf16_f32 v51, v198, v199
  buffer_store_dwordx4 v[48:51], v0, s[40:43], s6 offen offset:0 sc0 sc1
  ds_write_b128 v0, v[48:51] offset:0
  ds_read_b32 v3, v28 offset:8
  s_cmp_lg_u32 s82, 0
  s_cbranch_scc1 L_14
  v_permlane16_swap_b32 v240, v242
  v_permlane16_swap_b32 v241, v243
  v_permlane16_swap_b32 v244, v246
  v_permlane16_swap_b32 v245, v247
  v_permlane16_swap_b32 v248, v250
  v_permlane16_swap_b32 v249, v251
  v_permlane16_swap_b32 v252, v254
  v_permlane16_swap_b32 v253, v255
L_14:
  s_mov_b32 s16, Lz1-Lz0+0
  s_mov_b32 s17, 16384
  s_mov_b32 s18, 0xffff4000
  s_mov_b32 s19, 32768
  s_mov_b32 s20, 8192
  s_mov_b32 s21, 0xfffee000
  s_mul_i32 s4, s85, 8192
  v_add_u32_e64 v4, s4, v11
  v_add_u32 v5, 1024, v4
  s_add_u32 s5, s19, 0
  s_lshl_b32 s4, s86, 1
  v_xor_b32_e64 v2, s4, v26
  v_lshl_add_u32 v6, v2, 5, v25
  v_add_u32 v6, s5, v6
  s_add_u32 s4, s4, 1
  v_xor_b32_e64 v2, s4, v26
  v_lshl_add_u32 v7, v2, 5, v25
  v_add_u32 v7, s5, v7
  s_lshl_b32 s5, s82, 1
  s_add_u32 s5, s5, Lz1-Lz0+2
  s_mov_b32 s89, 1600000
  s_branch Lw_16
Lw_15:
  ds_read_b32 v3, v28 offset:8
Lw_16:
  s_waitcnt lgkmcnt(0)
  v_readfirstlane_b32 s4, v3
  s_cmp_ge_u32 s4, s5
  s_cbranch_scc1 Lw_17
  s_sleep 1
  s_sub_u32 s89, s89, 1
  s_cbranch_scc0 Lw_15
Lw_17:
  ds_read_b64_tr_b16 v[48:49], v6 offset:0
  ds_read_b64_tr_b16 v[50:51], v6 offset:2048
  ds_read_b64_tr_b16 v[52:53], v7 offset:0
  ds_read_b64_tr_b16 v[54:55], v7 offset:2048
  ds_read_b64_tr_b16 v[80:81], v6 offset:4096
  ds_read_b64_tr_b16 v[82:83], v6 offset:6144
  ds_read_b64_tr_b16 v[84:85], v7 offset:4096
  ds_read_b64_tr_b16 v[86:87], v7 offset:6144
  ds_read_b64_tr_b16 v[112:113], v6 offset:8192
  ds_read_b64_tr_b16 v[114:115], v6 offset:10240
  ds_read_b64_tr_b16 v[116:117], v7 offset:8192
  ds_read_b64_tr_b16 v[118:119], v7 offset:10240
  s_nop 0
  s_waitcnt lgkmcnt(8)
  ds_read_b64_tr_b16 v[208:209], v6 offset:12288
  ds_read_b64_tr_b16 v[210:211], v6 offset:14336
  ds_read_b64_tr_b16 v[212:213], v7 offset:12288
  ds_read_b64_tr_b16 v[214:215], v7 offset:14336
  s_nop 0
  s_waitcnt lgkmcnt(8)
  ds_read_b64_tr_b16 v[160:161], v6 offset:16384
  ds_read_b64_tr_b16 v[162:163], v6 offset:18432
  ds_read_b64_tr_b16 v[164:165], v7 offset:16384
  ds_read_b64_tr_b16 v[166:167], v7 offset:18432
  s_nop 0
  s_waitcnt lgkmcnt(8)
  ds_read_b64_tr_b16 v[168:169], v6 offset:20480
  ds_read_b64_tr_b16 v[170:171], v6 offset:22528
  ds_read_b64_tr_b16 v[172:173], v7 offset:20480
  ds_read_b64_tr_b16 v[174:175], v7 offset:22528
  s_nop 0
  s_waitcnt lgkmcnt(8)
  ds_read_b64_tr_b16 v[176:177], v6 offset:24576
  ds_read_b64_tr_b16 v[178:179], v6 offset:26624
  ds_read_b64_tr_b16 v[180:181], v7 offset:24576
  ds_read_b64_tr_b16 v[182:183], v7 offset:26624
  s_nop 0
  s_waitcnt lgkmcnt(8)
  ds_read_b64_tr_b16 v[184:185], v6 offset:28672
  ds_read_b64_tr_b16 v[186:187], v6 offset:30720
  ds_read_b64_tr_b16 v[188:189], v7 offset:28672
  ds_read_b64_tr_b16 v[190:191], v7 offset:30720
  s_nop 0
  s_waitcnt lgkmcnt(8)
  ds_read_b64_tr_b16 v[224:225], v6 offset:32768
  ds_read_b64_tr_b16 v[226:227], v6 offset:34816
  ds_read_b64_tr_b16 v[228:229], v7 offset:32768
  ds_read_b64_tr_b16 v[230:231], v7 offset:34816
  s_nop 0
  s_waitcnt lgkmcnt(8)
  ds_read_b64_tr_b16 v[232:233], v6 offset:36864
  ds_read_b64_tr_b16 v[234:235], v6 offset:38912
  ds_read_b64_tr_b16 v[236:237], v7 offset:36864
  ds_read_b64_tr_b16 v[238:239], v7 offset:38912
  s_nop 0
  s_waitcnt lgkmcnt(8)
  ds_read_b64_tr_b16 v[56:57], v6 offset:40960
  ds_read_b64_tr_b16 v[58:59], v6 offset:43008
  ds_read_b64_tr_b16 v[60:61], v7 offset:40960
  ds_read_b64_tr_b16 v[62:63], v7 offset:43008
  s_nop 0
  s_waitcnt lgkmcnt(8)
  ds_read_b64_tr_b16 v[88:89], v6 offset:45056
  ds_read_b64_tr_b16 v[90:91], v6 offset:47104
  ds_read_b64_tr_b16 v[92:93], v7 offset:45056
  ds_read_b64_tr_b16 v[94:95], v7 offset:47104
  s_waitcnt lgkmcnt(8)
  s_mov_b32 s19, 0
  v_add_u32 v6, 0xffff8000, v6
  v_add_u32 v7, 0xffff8000, v7
  s_waitcnt lgkmcnt(0)
  s_mov_b64 exec, 1
  ds_add_u32 v28, v27 offset:12
  s_mov_b64 exec, -1
  s_add_u32 s5, s87, 0x0
  s_waitcnt vmcnt(0)
  s_mov_b64 exec, 1
  ds_add_rtn_u32 v2, v28, v27 offset:0
  s_waitcnt lgkmcnt(0)
  v_readfirstlane_b32 s4, v2
  s_and_b32 s4, s4, Lz1-Lz0+3
  s_cmp_lg_u32 s4, 3
  s_cbranch_scc1 Ls_18
  s_mov_b32 exec_lo, 0xffff
  buffer_store_dword v27, v24, s[40:43], s5 offen sc0 sc1
Ls_18:
  s_mov_b64 exec, -1
  s_mov_b32 s4, 0xffff0000
  v_lshlrev_b32 v128, 16, v240
  v_and_b32 v129, s4, v240
  v_lshlrev_b32 v130, 16, v241
  v_and_b32 v131, s4, v241
  v_lshlrev_b32 v132, 16, v242
  v_and_b32 v133, s4, v242
  v_lshlrev_b32 v134, 16, v243
  v_and_b32 v135, s4, v243
  v_lshlrev_b32 v136, 16, v244
  v_and_b32 v137, s4, v244
  v_lshlrev_b32 v138, 16, v245
  v_and_b32 v139, s4, v245
  v_lshlrev_b32 v140, 16, v246
  v_and_b32 v141, s4, v246
  v_lshlrev_b32 v142, 16, v247
  v_and_b32 v143, s4, v247
  v_lshlrev_b32 v144, 16, v248
  v_and_b32 v145, s4, v248
  v_lshlrev_b32 v146, 16, v249
  v_and_b32 v147, s4, v249
  v_lshlrev_b32 v148, 16, v250
  v_and_b32 v149, s4, v250
  v_lshlrev_b32 v150, 16, v251
  v_and_b32 v151, s4, v251
  v_lshlrev_b32 v152, 16, v252
  v_and_b32 v153, s4, v252
  v_lshlrev_b32 v154, 16, v253
  v_and_b32 v155, s4, v253
  v_lshlrev_b32 v156, 16, v254
  v_and_b32 v157, s4, v254
  v_lshlrev_b32 v158, 16, v255
  v_and_b32 v159, s4, v255
  s_lshl_b32 s4, s76, 4
  s_add_u32 s4, s4, s78
  s_lshl_b32 s6, s4, 14
  s_add_u32 s6, s6, 7340032
  s_add_u32 s7, s6, 4096
  s_mov_b32 s22, 5
  s_barrier
  ds_read_b128 v[32:35], v4 offset:0
  ds_read_b128 v[36:39], v4 offset:2048
  ds_read_b128 v[40:43], v4 offset:4096
  ds_read_b128 v[44:47], v4 offset:6144
  ds_read_b128 v[64:67], v5 offset:0
  ds_read_b128 v[68:71], v5 offset:2048
  ds_read_b128 v[72:75], v5 offset:4096
  ds_read_b128 v[76:79], v5 offset:6144
  s_add_u32 s16, s16, s17
  s_cmp_eq_u32 s16, 65536
  s_cselect_b32 s23, s18, s17
  s_cselect_b32 s16, 0, s16
  v_add_u32 v4, s23, v4
  v_add_u32 v5, s23, v5
  s_waitcnt lgkmcnt(0)
  v_mfma_f32_16x16x32_bf16 v[128:131], v[48:51], v[32:35], v[128:131]
  v_mfma_f32_16x16x32_bf16 v[128:131], v[80:83], v[64:67], v[128:131]
  v_mfma_f32_16x16x32_bf16 v[136:139], v[80:83], v[68:71], v[136:139]
  v_mfma_f32_16x16x32_bf16 v[136:139], v[48:51], v[36:39], v[136:139]
  v_mfma_f32_16x16x32_bf16 v[144:147], v[48:51], v[40:43], v[144:147]
  v_mfma_f32_16x16x32_bf16 v[144:147], v[80:83], v[72:75], v[144:147]
  v_mfma_f32_16x16x32_bf16 v[152:155], v[80:83], v[76:79], v[152:155]
  v_mfma_f32_16x16x32_bf16 v[152:155], v[48:51], v[44:47], v[152:155]
  v_mfma_f32_16x16x32_bf16 v[156:159], v[52:55], v[44:47], v[156:159]
  v_mfma_f32_16x16x32_bf16 v[156:159], v[84:87], v[76:79], v[156:159]
  v_mfma_f32_16x16x32_bf16 v[148:151], v[84:87], v[72:75], v[148:151]
  v_mfma_f32_16x16x32_bf16 v[148:151], v[52:55], v[40:43], v[148:151]
  v_mfma_f32_16x16x32_bf16 v[140:143], v[52:55], v[36:39], v[140:143]
  v_mfma_f32_16x16x32_bf16 v[140:143], v[84:87], v[68:71], v[140:143]
  v_mfma_f32_16x16x32_bf16 v[132:135], v[84:87], v[64:67], v[132:135]
  v_mfma_f32_16x16x32_bf16 v[132:135], v[52:55], v[32:35], v[132:135]
  s_nop 0
  s_barrier
  ds_read_b128 v[96:99], v4 offset:0
  ds_read_b128 v[192:195], v5 offset:0
  ds_read_b128 v[100:103], v4 offset:2048
  ds_read_b128 v[196:199], v5 offset:2048
  ds_read_b128 v[104:107], v4 offset:4096
  ds_read_b128 v[200:203], v5 offset:4096
  ds_read_b128 v[108:111], v4 offset:6144
  ds_read_b128 v[204:207], v5 offset:6144
  s_add_u32 s16, s16, s17
  s_cmp_eq_u32 s16, 65536
  s_cselect_b32 s23, s18, s17
  s_cselect_b32 s16, 0, s16
  v_add_u32 v4, s23, v4
  v_add_u32 v5, s23, v5
  s_waitcnt lgkmcnt(6)
  v_mfma_f32_16x16x32_bf16 v[128:131], v[112:115], v[96:99], v[128:131]
  v_mfma_f32_16x16x32_bf16 v[128:131], v[208:211], v[192:195], v[128:131]
  s_waitcnt lgkmcnt(4)
  v_mfma_f32_16x16x32_bf16 v[136:139], v[208:211], v[196:199], v[136:139]
  v_mfma_f32_16x16x32_bf16 v[136:139], v[112:115], v[100:103], v[136:139]
  s_waitcnt lgkmcnt(2)
  v_mfma_f32_16x16x32_bf16 v[144:147], v[112:115], v[104:107], v[144:147]
  v_mfma_f32_16x16x32_bf16 v[144:147], v[208:211], v[200:203], v[144:147]
  s_waitcnt lgkmcnt(0)
  v_mfma_f32_16x16x32_bf16 v[152:155], v[208:211], v[204:207], v[152:155]
  s_barrier
  v_mfma_f32_16x16x32_bf16 v[152:155], v[112:115], v[108:111], v[152:155]
  ds_read_b128 v[32:35], v4 offset:0
  ds_read_b128 v[36:39], v4 offset:2048
  v_mfma_f32_16x16x32_bf16 v[156:159], v[116:119], v[108:111], v[156:159]
  ds_read_b128 v[40:43], v4 offset:4096
  ds_read_b128 v[44:47], v4 offset:6144
  v_mfma_f32_16x16x32_bf16 v[156:159], v[212:215], v[204:207], v[156:159]
  ds_read_b128 v[64:67], v5 offset:0
  ds_read_b128 v[68:71], v5 offset:2048
  v_mfma_f32_16x16x32_bf16 v[148:151], v[212:215], v[200:203], v[148:151]
  ds_read_b128 v[72:75], v5 offset:4096
  ds_read_b128 v[76:79], v5 offset:6144
  v_mfma_f32_16x16x32_bf16 v[148:151], v[116:119], v[104:107], v[148:151]
  s_add_u32 s16, s16, s17
  s_cmp_eq_u32 s16, 65536
  s_cselect_b32 s23, s18, s17
  v_mfma_f32_16x16x32_bf16 v[140:143], v[116:119], v[100:103], v[140:143]
  s_cselect_b32 s16, 0, s16
  v_add_u32 v4, s23, v4
  v_add_u32_e64 v5, s23, v5
  v_mfma_f32_16x16x32_bf16 v[140:143], v[212:215], v[196:199], v[140:143]
  v_mfma_f32_16x16x32_bf16 v[132:135], v[212:215], v[192:195], v[132:135]
  s_waitcnt lgkmcnt(0)
  v_mfma_f32_16x16x32_bf16 v[132:135], v[116:119], v[96:99], v[132:135]
  s_barrier
  v_mfma_f32_16x16x32_bf16 v[128:131], v[160:163], v[32:35], v[128:131]
  ds_read_b128 v[96:99], v4 offset:0
  ds_read_b128 v[100:103], v4 offset:2048
  v_mfma_f32_16x16x32_bf16 v[128:131], v[168:171], v[64:67], v[128:131]
  ds_read_b128 v[104:107], v4 offset:4096
  ds_read_b128 v[108:111], v4 offset:6144
  v_mfma_f32_16x16x32_bf16 v[136:139], v[168:171], v[68:71], v[136:139]
  ds_read_b128 v[192:195], v5 offset:0
  ds_read_b128 v[196:199], v5 offset:2048
  v_mfma_f32_16x16x32_bf16 v[136:139], v[160:163], v[36:39], v[136:139]
  ds_read_b128 v[200:203], v5 offset:4096
  ds_read_b128 v[204:207], v5 offset:6144
  v_mfma_f32_16x16x32_bf16 v[144:147], v[160:163], v[40:43], v[144:147]
  s_add_u32 s16, s16, s17
  s_cmp_eq_u32 s16, 65536
  s_cselect_b32 s23, s18, s17
  v_mfma_f32_16x16x32_bf16 v[144:147], v[168:171], v[72:75], v[144:147]
  s_cselect_b32 s16, 0, s16
  v_add_u32 v4, s23, v4
  v_add_u32_e64 v5, s23, v5
  v_mfma_f32_16x16x32_bf16 v[152:155], v[168:171], v[76:79], v[152:155]
  v_mfma_f32_16x16x32_bf16 v[152:155], v[160:163], v[44:47], v[152:155]
  v_mfma_f32_16x16x32_bf16 v[156:159], v[164:167], v[44:47], v[156:159]
  v_mfma_f32_16x16x32_bf16 v[156:159], v[172:175], v[76:79], v[156:159]
  v_mfma_f32_16x16x32_bf16 v[148:151], v[172:175], v[72:75], v[148:151]
  v_mfma_f32_16x16x32_bf16 v[148:151], v[164:167], v[40:43], v[148:151]
  v_mfma_f32_16x16x32_bf16 v[140:143], v[164:167], v[36:39], v[140:143]
  v_mfma_f32_16x16x32_bf16 v[140:143], v[172:175], v[68:71], v[140:143]
  v_mfma_f32_16x16x32_bf16 v[132:135], v[172:175], v[64:67], v[132:135]
  s_waitcnt lgkmcnt(0)
  v_mfma_f32_16x16x32_bf16 v[132:135], v[164:167], v[32:35], v[132:135]
  s_barrier
  v_mfma_f32_16x16x32_bf16 v[128:131], v[176:179], v[96:99], v[128:131]
  ds_read_b128 v[32:35], v4 offset:0
  ds_read_b128 v[36:39], v4 offset:2048
  v_mfma_f32_16x16x32_bf16 v[128:131], v[184:187], v[192:195], v[128:131]
  ds_read_b128 v[40:43], v4 offset:4096
  ds_read_b128 v[44:47], v4 offset:6144
  v_mfma_f32_16x16x32_bf16 v[136:139], v[184:187], v[196:199], v[136:139]
  ds_read_b128 v[64:67], v5 offset:0
  ds_read_b128 v[68:71], v5 offset:2048
  v_mfma_f32_16x16x32_bf16 v[136:139], v[176:179], v[100:103], v[136:139]
  ds_read_b128 v[72:75], v5 offset:4096
  ds_read_b128 v[76:79], v5 offset:6144
  v_mfma_f32_16x16x32_bf16 v[144:147], v[176:179], v[104:107], v[144:147]
  s_add_u32 s16, s16, s17
  s_cmp_eq_u32 s16, 65536
  s_cselect_b32 s23, s18, s17
  v_mfma_f32_16x16x32_bf16 v[144:147], v[184:187], v[200:203], v[144:147]
  s_cselect_b32 s16, 0, s16
  v_add_u32 v4, s23, v4
  v_add_u32_e64 v5, s23, v5
  v_mfma_f32_16x16x32_bf16 v[152:155], v[184:187], v[204:207], v[152:155]
  v_mfma_f32_16x16x32_bf16 v[152:155], v[176:179], v[108:111], v[152:155]
  v_mfma_f32_16x16x32_bf16 v[156:159], v[180:183], v[108:111], v[156:159]
  v_mfma_f32_16x16x32_bf16 v[156:159], v[188:191], v[204:207], v[156:159]
  v_mfma_f32_16x16x32_bf16 v[148:151], v[188:191], v[200:203], v[148:151]
  v_mfma_f32_16x16x32_bf16 v[148:151], v[180:183], v[104:107], v[148:151]
  v_mfma_f32_16x16x32_bf16 v[140:143], v[180:183], v[100:103], v[140:143]
  v_mfma_f32_16x16x32_bf16 v[140:143], v[188:191], v[196:199], v[140:143]
  v_mfma_f32_16x16x32_bf16 v[132:135], v[188:191], v[192:195], v[132:135]
  s_waitcnt lgkmcnt(0)
  v_mfma_f32_16x16x32_bf16 v[132:135], v[180:183], v[96:99], v[132:135]
  s_barrier
  v_mfma_f32_16x16x32_bf16 v[128:131], v[224:227], v[32:35], v[128:131]
  ds_read_b128 v[96:99], v4 offset:0
  ds_read_b128 v[100:103], v4 offset:2048
  v_mfma_f32_16x16x32_bf16 v[128:131], v[232:235], v[64:67], v[128:131]
  ds_read_b128 v[104:107], v4 offset:4096
  ds_read_b128 v[108:111], v4 offset:6144
  v_mfma_f32_16x16x32_bf16 v[136:139], v[232:235], v[68:71], v[136:139]
  ds_read_b128 v[192:195], v5 offset:0
  ds_read_b128 v[196:199], v5 offset:2048
  v_mfma_f32_16x16x32_bf16 v[136:139], v[224:227], v[36:39], v[136:139]
  ds_read_b128 v[200:203], v5 offset:4096
  ds_read_b128 v[204:207], v5 offset:6144
  v_mfma_f32_16x16x32_bf16 v[144:147], v[224:227], v[40:43], v[144:147]
  s_add_u32 s16, s16, s17
  s_cmp_eq_u32 s16, 65536
  s_cselect_b32 s23, s18, s17
  v_mfma_f32_16x16x32_bf16 v[144:147], v[232:235], v[72:75], v[144:147]
  s_cselect_b32 s16, 0, s16
  v_add_u32 v4, s23, v4
  v_add_u32_e64 v5, s23, v5
  v_mfma_f32_16x16x32_bf16 v[152:155], v[232:235], v[76:79], v[152:155]
  v_mfma_f32_16x16x32_bf16 v[152:155], v[224:227], v[44:47], v[152:155]
  v_mfma_f32_16x16x32_bf16 v[156:159], v[228:231], v[44:47], v[156:159]
  v_mfma_f32_16x16x32_bf16 v[156:159], v[236:239], v[76:79], v[156:159]
  v_mfma_f32_16x16x32_bf16 v[148:151], v[236:239], v[72:75], v[148:151]
  v_mfma_f32_16x16x32_bf16 v[148:151], v[228:231], v[40:43], v[148:151]
  v_mfma_f32_16x16x32_bf16 v[140:143], v[228:231], v[36:39], v[140:143]
  v_mfma_f32_16x16x32_bf16 v[140:143], v[236:239], v[68:71], v[140:143]
  v_mfma_f32_16x16x32_bf16 v[132:135], v[236:239], v[64:67], v[132:135]
  s_waitcnt lgkmcnt(0)
  v_mfma_f32_16x16x32_bf16 v[132:135], v[228:231], v[32:35], v[132:135]
  s_barrier
  v_mfma_f32_16x16x32_bf16 v[128:131], v[56:59], v[96:99], v[128:131]
  ds_read_b64_tr_b16 v[48:49], v6 offset:0
  ds_read_b64_tr_b16 v[50:51], v6 offset:2048
  v_mfma_f32_16x16x32_bf16 v[128:131], v[88:91], v[192:195], v[128:131]
  ds_read_b128 v[32:35], v4 offset:0
  ds_read_b128 v[36:39], v4 offset:2048
  v_mfma_f32_16x16x32_bf16 v[136:139], v[88:91], v[196:199], v[136:139]
  ds_read_b128 v[40:43], v4 offset:4096
  ds_read_b128 v[44:47], v4 offset:6144
  v_mfma_f32_16x16x32_bf16 v[136:139], v[56:59], v[100:103], v[136:139]
  ds_read_b64_tr_b16 v[52:53], v7 offset:0
  ds_read_b64_tr_b16 v[54:55], v7 offset:2048
  v_mfma_f32_16x16x32_bf16 v[144:147], v[56:59], v[104:107], v[144:147]
  ds_read_b64_tr_b16 v[80:81], v6 offset:4096
  ds_read_b64_tr_b16 v[82:83], v6 offset:6144
  v_mfma_f32_16x16x32_bf16 v[144:147], v[88:91], v[200:203], v[144:147]
  ds_read_b128 v[64:67], v5 offset:0
  ds_read_b128 v[68:71], v5 offset:2048
  v_mfma_f32_16x16x32_bf16 v[152:155], v[88:91], v[204:207], v[152:155]
  ds_read_b128 v[72:75], v5 offset:4096
  ds_read_b128 v[76:79], v5 offset:6144
  v_mfma_f32_16x16x32_bf16 v[152:155], v[56:59], v[108:111], v[152:155]
  ds_read_b64_tr_b16 v[84:85], v7 offset:4096
  ds_read_b64_tr_b16 v[86:87], v7 offset:6144
  v_mfma_f32_16x16x32_bf16 v[156:159], v[60:63], v[108:111], v[156:159]
  s_add_u32 s16, s16, s17
  s_cmp_eq_u32 s16, 65536
  s_cselect_b32 s23, s18, s17
  v_mfma_f32_16x16x32_bf16 v[156:159], v[92:95], v[204:207], v[156:159]
  s_cselect_b32 s16, 0, s16
  v_add_u32 v4, s23, v4
  v_add_u32_e64 v5, s23, v5
  v_mfma_f32_16x16x32_bf16 v[148:151], v[92:95], v[200:203], v[148:151]
  s_add_u32 s19, s19, s20
  s_cmp_eq_u32 s19, 81920
  s_cselect_b32 s23, s21, s20
  v_mfma_f32_16x16x32_bf16 v[148:151], v[60:63], v[104:107], v[148:151]
  s_cselect_b32 s19, 0, s19
  v_add_u32 v6, s23, v6
  v_add_u32_e64 v7, s23, v7
  v_mfma_f32_16x16x32_bf16 v[140:143], v[60:63], v[100:103], v[140:143]
  v_mfma_f32_16x16x32_bf16 v[140:143], v[92:95], v[196:199], v[140:143]
  v_mfma_f32_16x16x32_bf16 v[132:135], v[92:95], v[192:195], v[132:135]
  s_waitcnt lgkmcnt(0)
  v_mfma_f32_16x16x32_bf16 v[132:135], v[60:63], v[96:99], v[132:135]
Lk_19:
  s_barrier
  v_mfma_f32_16x16x32_bf16 v[128:131], v[48:51], v[32:35], v[128:131]
  ds_read_b64_tr_b16 v[112:113], v6 offset:0
  ds_read_b64_tr_b16 v[114:115], v6 offset:2048
  v_mfma_f32_16x16x32_bf16 v[128:131], v[80:83], v[64:67], v[128:131]
  ds_read_b128 v[96:99], v4 offset:0
  ds_read_b128 v[100:103], v4 offset:2048
  v_mfma_f32_16x16x32_bf16 v[136:139], v[80:83], v[68:71], v[136:139]
  ds_read_b128 v[104:107], v4 offset:4096
  ds_read_b128 v[108:111], v4 offset:6144
  v_mfma_f32_16x16x32_bf16 v[136:139], v[48:51], v[36:39], v[136:139]
  ds_read_b64_tr_b16 v[116:117], v7 offset:0
  ds_read_b64_tr_b16 v[118:119], v7 offset:2048
  v_mfma_f32_16x16x32_bf16 v[144:147], v[48:51], v[40:43], v[144:147]
  ds_read_b64_tr_b16 v[208:209], v6 offset:4096
  ds_read_b64_tr_b16 v[210:211], v6 offset:6144
  v_mfma_f32_16x16x32_bf16 v[144:147], v[80:83], v[72:75], v[144:147]
  ds_read_b128 v[192:195], v5 offset:0
  ds_read_b128 v[196:199], v5 offset:2048
  v_mfma_f32_16x16x32_bf16 v[152:155], v[80:83], v[76:79], v[152:155]
  ds_read_b128 v[200:203], v5 offset:4096
  ds_read_b128 v[204:207], v5 offset:6144
  v_mfma_f32_16x16x32_bf16 v[152:155], v[48:51], v[44:47], v[152:155]
  ds_read_b64_tr_b16 v[212:213], v7 offset:4096
  ds_read_b64_tr_b16 v[214:215], v7 offset:6144
  v_mfma_f32_16x16x32_bf16 v[156:159], v[52:55], v[44:47], v[156:159]
  s_add_u32 s16, s16, s17
  s_cmp_eq_u32 s16, 65536
  s_cselect_b32 s23, s18, s17
  v_mfma_f32_16x16x32_bf16 v[156:159], v[84:87], v[76:79], v[156:159]
  s_cselect_b32 s16, 0, s16
  v_add_u32 v4, s23, v4
  v_add_u32_e64 v5, s23, v5
  v_mfma_f32_16x16x32_bf16 v[148:151], v[84:87], v[72:75], v[148:151]
  s_add_u32 s19, s19, s20
  s_cmp_eq_u32 s19, 81920
  s_cselect_b32 s23, s21, s20
  v_mfma_f32_16x16x32_bf16 v[148:151], v[52:55], v[40:43], v[148:151]
  s_cselect_b32 s19, 0, s19
  v_add_u32 v6, s23, v6
  v_add_u32_e64 v7, s23, v7
  v_mfma_f32_16x16x32_bf16 v[140:143], v[52:55], v[36:39], v[140:143]
  v_mfma_f32_16x16x32_bf16 v[140:143], v[84:87], v[68:71], v[140:143]
  v_mfma_f32_16x16x32_bf16 v[132:135], v[84:87], v[64:67], v[132:135]
  s_waitcnt lgkmcnt(0)
  v_mfma_f32_16x16x32_bf16 v[132:135], v[52:55], v[32:35], v[132:135]
  s_barrier
  v_mfma_f32_16x16x32_bf16 v[128:131], v[112:115], v[96:99], v[128:131]
  ds_read_b64_tr_b16 v[48:49], v6 offset:0
  ds_read_b64_tr_b16 v[50:51], v6 offset:2048
  v_mfma_f32_16x16x32_bf16 v[128:131], v[208:211], v[192:195], v[128:131]
  ds_read_b128 v[32:35], v4 offset:0
  ds_read_b128 v[36:39], v4 offset:2048
  v_mfma_f32_16x16x32_bf16 v[136:139], v[208:211], v[196:199], v[136:139]
  ds_read_b128 v[40:43], v4 offset:4096
  ds_read_b128 v[44:47], v4 offset:6144
  v_mfma_f32_16x16x32_bf16 v[136:139], v[112:115], v[100:103], v[136:139]
  ds_read_b64_tr_b16 v[52:53], v7 offset:0
  ds_read_b64_tr_b16 v[54:55], v7 offset:2048
  v_mfma_f32_16x16x32_bf16 v[144:147], v[112:115], v[104:107], v[144:147]
  ds_read_b64_tr_b16 v[80:81], v6 offset:4096
  ds_read_b64_tr_b16 v[82:83], v6 offset:6144
  v_mfma_f32_16x16x32_bf16 v[144:147], v[208:211], v[200:203], v[144:147]
  ds_read_b128 v[64:67], v5 offset:0
  ds_read_b128 v[68:71], v5 offset:2048
  v_mfma_f32_16x16x32_bf16 v[152:155], v[208:211], v[204:207], v[152:155]
  ds_read_b128 v[72:75], v5 offset:4096
  ds_read_b128 v[76:79], v5 offset:6144
  v_mfma_f32_16x16x32_bf16 v[152:155], v[112:115], v[108:111], v[152:155]
  ds_read_b64_tr_b16 v[84:85], v7 offset:4096
  ds_read_b64_tr_b16 v[86:87], v7 offset:6144
  v_mfma_f32_16x16x32_bf16 v[156:159], v[116:119], v[108:111], v[156:159]
  s_add_u32 s16, s16, s17
  s_cmp_eq_u32 s16, 65536
  s_cselect_b32 s23, s18, s17
  v_mfma_f32_16x16x32_bf16 v[156:159], v[212:215], v[204:207], v[156:159]
  s_cselect_b32 s16, 0, s16
  v_add_u32 v4, s23, v4
  v_add_u32_e64 v5, s23, v5
  v_mfma_f32_16x16x32_bf16 v[148:151], v[212:215], v[200:203], v[148:151]
  s_add_u32 s19, s19, s20
  s_cmp_eq_u32 s19, 81920
  s_cselect_b32 s23, s21, s20
  v_mfma_f32_16x16x32_bf16 v[148:151], v[116:119], v[104:107], v[148:151]
  s_cselect_b32 s19, 0, s19
  v_add_u32 v6, s23, v6
  v_add_u32_e64 v7, s23, v7
  v_mfma_f32_16x16x32_bf16 v[140:143], v[116:119], v[100:103], v[140:143]
  s_sub_u32 s22, s22, 1
  s_cmp_lg_u32 s22, 0
  v_mfma_f32_16x16x32_bf16 v[140:143], v[212:215], v[196:199], v[140:143]
  v_mfma_f32_16x16x32_bf16 v[132:135], v[212:215], v[192:195], v[132:135]
  s_nop 0
  s_waitcnt lgkmcnt(0)
  v_mfma_f32_16x16x32_bf16 v[132:135], v[116:119], v[96:99], v[132:135]
  s_cbranch_scc1 Lk_19
  s_waitcnt lgkmcnt(0)
  v_cvt_pk_bf16_f32 v252, v152, v153
  v_cvt_pk_bf16_f32 v253, v154, v155
  v_cvt_pk_bf16_f32 v254, v156, v157
  v_cvt_pk_bf16_f32 v255, v158, v159
  buffer_store_dwordx4 v[252:255], v0, s[40:43], s7 offen offset:2048 sc0 sc1
  v_cvt_pk_bf16_f32 v248, v144, v145
  v_cvt_pk_bf16_f32 v249, v146, v147
  v_cvt_pk_bf16_f32 v250, v148, v149
  v_cvt_pk_bf16_f32 v251, v150, v151
  buffer_store_dwordx4 v[248:251], v0, s[40:43], s7 offen offset:0 sc0 sc1
  v_cvt_pk_bf16_f32 v244, v136, v137
  v_cvt_pk_bf16_f32 v245, v138, v139
  v_cvt_pk_bf16_f32 v246, v140, v141
  v_cvt_pk_bf16_f32 v247, v142, v143
  buffer_store_dwordx4 v[244:247], v0, s[40:43], s6 offen offset:2048 sc0 sc1
  v_cvt_pk_bf16_f32 v240, v128, v129
  v_cvt_pk_bf16_f32 v241, v130, v131
  v_cvt_pk_bf16_f32 v242, v132, v133
  v_cvt_pk_bf16_f32 v243, v134, v135
  buffer_store_dwordx4 v[240:243], v0, s[40:43], s6 offen offset:0 sc0 sc1
  s_lshl_b32 s5, s78, Lz1-Lz0+1
  v_mov_b32 v40, 0x3f803f80
  v_dot2_f32_bf16 v32, v240, v40, 0
  v_dot2_f32_bf16 v36, v240, v240, 0
  v_dot2_f32_bf16 v33, v244, v40, 0
  v_dot2_f32_bf16 v37, v244, v244, 0
  v_dot2_f32_bf16 v34, v248, v40, 0
  v_dot2_f32_bf16 v38, v248, v248, 0
  v_dot2_f32_bf16 v35, v252, v40, 0
  v_dot2_f32_bf16 v39, v252, v252, 0
  v_dot2_f32_bf16 v32, v241, v40, v32
  v_dot2_f32_bf16 v36, v241, v241, v36
  v_dot2_f32_bf16 v33, v245, v40, v33
  v_dot2_f32_bf16 v37, v245, v245, v37
  v_dot2_f32_bf16 v34, v249, v40, v34
  v_dot2_f32_bf16 v38, v249, v249, v38
  v_dot2_f32_bf16 v35, v253, v40, v35
  v_dot2_f32_bf16 v39, v253, v253, v39
  v_dot2_f32_bf16 v32, v242, v40, v32
  v_dot2_f32_bf16 v36, v242, v242, v36
  v_dot2_f32_bf16 v33, v246, v40, v33
  v_dot2_f32_bf16 v37, v246, v246, v37
  v_dot2_f32_bf16 v34, v250, v40, v34
  v_dot2_f32_bf16 v38, v250, v250, v38
  v_dot2_f32_bf16 v35, v254, v40, v35
  v_dot2_f32_bf16 v39, v254, v254, v39
  v_dot2_f32_bf16 v32, v243, v40, v32
  v_dot2_f32_bf16 v36, v243, v243, v36
  v_dot2_f32_bf16 v33, v247, v40, v33
  v_dot2_f32_bf16 v37, v247, v247, v37
  v_dot2_f32_bf16 v34, v251, v40, v34
  v_dot2_f32_bf16 v38, v251, v251, v38
  v_dot2_f32_bf16 v35, v255, v40, v35
  v_dot2_f32_bf16 v39, v255, v255, v39
  s_lshl_b32 s6, s76, Lz1-Lz0+9
  s_lshl_b32 s7, s85, 8
  s_add_u32 s6, s6, s7
  s_add_u32 s6, s6, s5
  s_add_u32 s6, s6, s86
  s_lshl_b32 s6, s6, 6
  s_add_u32 s6, s6, s83
  s_add_u32 s6, s6, 31457280
  v_permlane32_swap_b32 v32, v34
  v_permlane32_swap_b32 v33, v35
  v_permlane32_swap_b32 v36, v38
  v_permlane32_swap_b32 v37, v39
  v_add_f32 v32, v32, v34
  v_add_f32 v33, v33, v35
  v_add_f32 v36, v36, v38
  v_add_f32 v37, v37, v39
  v_permlane16_swap_b32 v32, v33
  s_nop 0
  v_permlane16_swap_b32 v36, v37
  v_add_f32 v42, v32, v33
  v_add_f32_e64 v43, v36, v37
  buffer_store_dwordx2 v[42:43], v30, s[40:43], s6 offen sc0 sc1
  ds_write_b128 v0, v[240:243] offset:0
  ds_write_b128 v0, v[244:247] offset:2048
  ds_write_b128 v0, v[248:251] offset:4096
  ds_write_b128 v0, v[252:255] offset:6144
  s_add_u32 s5, s87, 0x4
  s_sub_u32 s4, s78, s77
  s_lshl_b32 s4, s4, 7
  s_add_u32 s5, s5, s4
  s_waitcnt vmcnt(0)
  s_mov_b64 exec, 1
  ds_add_rtn_u32 v2, v28, v27 offset:0
  s_waitcnt lgkmcnt(0)
  v_readfirstlane_b32 s4, v2
  s_and_b32 s4, s4, Lz1-Lz0+3
  s_cmp_lg_u32 s4, 3
  s_cbranch_scc1 Ls_20
  s_mov_b32 exec_lo, 0xffff
  buffer_store_dword v27, v24, s[40:43], s5 offen sc0 sc1
Ls_20:
  s_mov_b64 exec, -1
  s_mov_b32 s16, 0
  s_mov_b32 s17, 16384
  s_mov_b32 s18, 0xffff4000
  s_mov_b32 s19, Lz1-Lz0+0
  s_mov_b32 s20, 28672
  s_mov_b32 s21, 0xffff2000
  s_mul_i32 s4, s85, 8192
  v_add_u32_e64 v4, s4, v11
  v_add_u32 v5, 1024, v4
  s_mul_i32 s4, s86, 6
  s_add_u32 s4, s4, 0
  s_lshr_b32 s5, s4, 2
  s_lshl_b32 s5, s5, 13
  s_and_b32 s4, s4, 3
  v_xor_b32 v2, s4, v26
  v_lshl_add_u32 v6, v2, 5, v25
  v_add_u32 v6, s5, v6
  s_mul_i32 s4, s86, 6
  s_add_u32 s4, s4, 1
  s_lshr_b32 s5, s4, 2
  s_lshl_b32 s5, s5, 13
  s_and_b32 s4, s4, 3
  v_xor_b32_e64 v2, s4, v26
  v_lshl_add_u32 v7, v2, 5, v25
  v_add_u32 v7, s5, v7
  s_mul_i32 s4, s86, 6
  s_add_u32 s4, s4, 2
  s_lshr_b32 s5, s4, 2
  s_lshl_b32 s5, s5, 13
  s_and_b32 s4, s4, 3
  v_xor_b32_e64 v2, s4, v26
  v_lshl_add_u32 v8, v2, 5, v25
  v_add_u32 v8, s5, v8
  s_mul_i32 s4, s86, 6
  s_add_u32 s4, s4, 3
  s_lshr_b32 s5, s4, 2
  s_lshl_b32 s5, s5, 13
  s_and_b32 s4, s4, 3
  v_xor_b32_e64 v2, s4, v26
  v_lshl_add_u32 v9, v2, 5, v25
  v_add_u32 v9, s5, v9
  v_lshrrev_b32 v2, 2, v1
  v_lshlrev_b32 v3, 6, v2
  v_and_b32 v2, 3, v1
  v_lshl_add_u32 v3, v2, 3, v3
  v_bfe_u32 v2, v1, 4, 1
  v_xor_b32_e64 v2, s86, v2
  v_lshl_add_u32 v3, v2, 5, v3
  v_add_u32 v10, 90112, v3
  v_mov_b64 v[128:129], 0
  v_mov_b64 v[130:131], 0
  v_mov_b64 v[132:133], 0
  v_mov_b64 v[134:135], 0
  v_mov_b64 v[136:137], 0
  v_mov_b64 v[138:139], 0
  v_mov_b64 v[140:141], 0
  v_mov_b64 v[142:143], 0
  v_mov_b64 v[144:145], 0
  v_mov_b64 v[146:147], 0
  v_mov_b64 v[148:149], 0
  v_mov_b64 v[150:151], 0
  v_mov_b64 v[152:153], 0
  v_mov_b64 v[154:155], 0
  v_mov_b64 v[156:157], 0
  v_mov_b64 v[158:159], 0
  v_mov_b64 v[160:161], 0
  v_mov_b64 v[162:163], 0
  v_mov_b64 v[164:165], 0
  v_mov_b64 v[166:167], 0
  v_mov_b64 v[168:169], 0
  v_mov_b64 v[170:171], 0
  v_mov_b64 v[172:173], 0
  v_mov_b64 v[174:175], 0
  v_mov_b64 v[176:177], 0
  v_mov_b64 v[178:179], 0
  v_mov_b64 v[180:181], 0
  v_mov_b64 v[182:183], 0
  v_mov_b64 v[184:185], 0
  v_mov_b64 v[186:187], 0
  v_mov_b64 v[188:189], 0
  v_mov_b64 v[190:191], 0
  v_mov_b64 v[192:193], 0
  v_mov_b64 v[194:195], 0
  v_mov_b64 v[196:197], 0
  v_mov_b64 v[198:199], 0
  v_mov_b64 v[200:201], 0
  v_mov_b64 v[202:203], 0
  v_mov_b64 v[204:205], 0
  v_mov_b64 v[206:207], 0
  v_mov_b64 v[208:209], 0
  v_mov_b64 v[210:211], 0
  v_mov_b64 v[212:213], 0
  v_mov_b64 v[214:215], 0
  v_mov_b64 v[216:217], 0
  v_mov_b64 v[218:219], 0
  v_mov_b64 v[220:221], 0
  v_mov_b64 v[222:223], 0
  v_mov_b64 v[224:225], 0
  v_mov_b64 v[226:227], 0
  v_mov_b64 v[228:229], 0
  v_mov_b64 v[230:231], 0
  v_mov_b64 v[232:233], 0
  v_mov_b64 v[234:235], 0
  v_mov_b64 v[236:237], 0
  v_mov_b64 v[238:239], 0
  s_mul_i32 s5, s86, 384
  s_add_u32 s5, s5, 154112
  v_add_u32 v3, s5, v29
  s_mul_i32 s4, s76, 56
  s_mul_i32 s5, s79, 28
  s_add_u32 s4, s4, s5
  s_add_u32 s6, s4, s80
  s_lshl_b32 s6, s6, 14
  s_add_u32 s6, s6, 11599872
  s_add_u32 s7, s6, 4096
  s_lshr_b32 s5, s80, 1
  s_add_u32 s4, s4, s5
  s_lshl_b32 s4, s4, 1
  s_add_u32 s4, s4, s85
  s_lshl_b32 s4, s4, 3
  s_and_b32 s5, s80, 1
  s_add_u32 s4, s4, s5
  s_lshl_b32 s4, s4, 1
  s_add_u32 s4, s4, s86
  s_lshl_b32 s8, s4, 9
  s_add_u32 s8, s8, 11534336
  s_lshl_b32 s4, s79, Lz1-Lz0+3
  s_lshl_b32 s10, 0xff, s4
  s_mov_b32 s22, 8
  s_mov_b64 vcc, -1
  s_waitcnt lgkmcnt(0)
  s_barrier
  s_branch Lo_24
Lo_25:
  s_mov_b64 vcc, 0
  s_waitcnt lgkmcnt(0)
  s_barrier
  ds_read_b128 v[64:67], v4 offset:0
  ds_read_b128 v[80:83], v5 offset:0
  ds_read_b128 v[68:71], v4 offset:2048
  ds_read_b128 v[84:87], v5 offset:2048
  ds_read_b128 v[72:75], v4 offset:4096
  ds_read_b128 v[88:91], v5 offset:4096
  ds_read_b64_tr_b16 v[96:97], v6 offset:0
  ds_read_b64_tr_b16 v[98:99], v6 offset:2048
  ds_read_b64_tr_b16 v[100:101], v6 offset:4096
  ds_read_b64_tr_b16 v[102:103], v6 offset:6144
  ds_read_b128 v[76:79], v4 offset:6144
  ds_read_b128 v[92:95], v5 offset:6144
  ds_read_b64_tr_b16 v[104:105], v7 offset:0
  s_nop 0
  s_waitcnt lgkmcnt(8)
  ds_read_b64_tr_b16 v[106:107], v7 offset:2048
  ds_read_b64_tr_b16 v[108:109], v7 offset:4096
  ds_read_b64_tr_b16 v[110:111], v7 offset:6144
  s_waitcnt lgkmcnt(6)
  s_branch Lk_22
Lo_24:
  ds_read_b128 v[32:35], v4 offset:0
  ds_read_b128 v[48:51], v5 offset:0
  ds_read_b128 v[36:39], v4 offset:2048
  ds_read_b128 v[52:55], v5 offset:2048
  ds_read_b128 v[40:43], v4 offset:4096
  ds_read_b128 v[56:59], v5 offset:4096
  ds_read_b64_tr_b16 v[96:97], v6 offset:0
  ds_read_b64_tr_b16 v[98:99], v6 offset:2048
  ds_read_b64_tr_b16 v[100:101], v6 offset:4096
  ds_read_b64_tr_b16 v[102:103], v6 offset:6144
  ds_read_b128 v[44:47], v4 offset:6144
  ds_read_b128 v[60:63], v5 offset:6144
  ds_read_b64_tr_b16 v[104:105], v7 offset:0
  s_nop 0
  s_waitcnt lgkmcnt(8)
  ds_read_b64_tr_b16 v[106:107], v7 offset:2048
  ds_read_b64_tr_b16 v[108:109], v7 offset:4096
  ds_read_b64_tr_b16 v[110:111], v7 offset:6144
  s_nop 0
  s_waitcnt lgkmcnt(6)
  .p2align 6
Lk_21:
  v_mfma_f32_16x16x32_bf16 v[128:131], v[96:99], v[32:35], v[128:131]
  ds_read_b64_tr_b16 v[112:113], v8 offset:0
  v_mfma_f32_16x16x32_bf16 v[128:131], v[100:103], v[48:51], v[128:131]
  ds_read_b64_tr_b16 v[114:115], v8 offset:2048
  v_mfma_f32_16x16x32_bf16 v[132:135], v[100:103], v[52:55], v[132:135]
  ds_read_b64_tr_b16 v[116:117], v8 offset:4096
  v_mfma_f32_16x16x32_bf16 v[132:135], v[96:99], v[36:39], v[132:135]
  ds_read_b64_tr_b16 v[118:119], v8 offset:6144
  v_mfma_f32_16x16x32_bf16 v[136:139], v[96:99], v[40:43], v[136:139]
  s_add_u32 s16, s16, s17
  s_cmp_eq_u32 s16, 65536
  s_cselect_b32 s23, s18, s17
  s_cselect_b32 s16, Lz1-Lz0+0, s16
  v_mfma_f32_16x16x32_bf16 v[136:139], v[100:103], v[56:59], v[136:139]
  v_add_u32_e64 v4, s23, v4
  v_add_u32 v5, s23, v5
  s_add_u32 s19, s19, s20
  s_cmp_eq_u32 s19, 86016
  s_waitcnt lgkmcnt(8)
  v_mfma_f32_16x16x32_bf16 v[140:143], v[100:103], v[60:63], v[140:143]
  s_cselect_b32 s23, s21, s20
  s_cselect_b32 s19, 0, s19
  v_mfma_f32_16x16x32_bf16 v[140:143], v[96:99], v[44:47], v[140:143]
  s_waitcnt lgkmcnt(4)
  v_mfma_f32_16x16x32_bf16 v[156:159], v[104:107], v[44:47], v[156:159]
  ds_read_b64_tr_b16 v[120:121], v9 offset:0
  v_mfma_f32_16x16x32_bf16 v[156:159], v[108:111], v[60:63], v[156:159]
  ds_read_b64_tr_b16 v[122:123], v9 offset:2048
  v_mfma_f32_16x16x32_bf16 v[152:155], v[108:111], v[56:59], v[152:155]
  ds_read_b64_tr_b16 v[124:125], v9 offset:4096
  v_mfma_f32_16x16x32_bf16 v[152:155], v[104:107], v[40:43], v[152:155]
  ds_read_b64_tr_b16 v[126:127], v9 offset:6144
  v_mfma_f32_16x16x32_bf16 v[148:151], v[104:107], v[36:39], v[148:151]
  v_mfma_f32_16x16x32_bf16 v[148:151], v[108:111], v[52:55], v[148:151]
  v_mfma_f32_16x16x32_bf16 v[144:147], v[108:111], v[48:51], v[144:147]
  ds_read_b64_tr_b16 v[96:97], v6 offset:8192
  v_mfma_f32_16x16x32_bf16 v[144:147], v[104:107], v[32:35], v[144:147]
  ds_read_b64_tr_b16 v[98:99], v6 offset:10240
  s_nop 0
  s_waitcnt lgkmcnt(6)
  v_mfma_f32_16x16x32_bf16 v[160:163], v[112:115], v[32:35], v[160:163]
  ds_read_b64_tr_b16 v[100:101], v6 offset:12288
  v_mfma_f32_16x16x32_bf16 v[160:163], v[116:119], v[48:51], v[160:163]
  ds_read_b64_tr_b16 v[102:103], v6 offset:14336
  v_mfma_f32_16x16x32_bf16 v[164:167], v[116:119], v[52:55], v[164:167]
  v_mfma_f32_16x16x32_bf16 v[164:167], v[112:115], v[36:39], v[164:167]
  v_mfma_f32_16x16x32_bf16 v[168:171], v[112:115], v[40:43], v[168:171]
  ds_read_b64_tr_b16 v[104:105], v7 offset:8192
  v_mfma_f32_16x16x32_bf16 v[168:171], v[116:119], v[56:59], v[168:171]
  ds_read_b64_tr_b16 v[106:107], v7 offset:10240
  v_mfma_f32_16x16x32_bf16 v[172:175], v[116:119], v[60:63], v[172:175]
  ds_read_b64_tr_b16 v[108:109], v7 offset:12288
  v_mfma_f32_16x16x32_bf16 v[172:175], v[112:115], v[44:47], v[172:175]
  ds_read_b64_tr_b16 v[110:111], v7 offset:14336
  s_waitcnt lgkmcnt(8)
  v_mfma_f32_16x16x32_bf16 v[188:191], v[120:123], v[44:47], v[188:191]
  v_add_u32 v6, s23, v6
  v_add_u32_e64 v7, s23, v7
  v_mfma_f32_16x16x32_bf16 v[188:191], v[124:127], v[60:63], v[188:191]
  ds_read_b64_tr_b16 v[112:113], v10 offset:0
  v_mfma_f32_16x16x32_bf16 v[184:187], v[124:127], v[56:59], v[184:187]
  ds_read_b64_tr_b16 v[114:115], v10 offset:1024
  v_mfma_f32_16x16x32_bf16 v[184:187], v[120:123], v[40:43], v[184:187]
  ds_read_b64_tr_b16 v[116:117], v10 offset:2048
  v_mfma_f32_16x16x32_bf16 v[180:183], v[120:123], v[36:39], v[180:183]
  ds_read_b64_tr_b16 v[118:119], v10 offset:3072
  v_mfma_f32_16x16x32_bf16 v[180:183], v[124:127], v[52:55], v[180:183]
  v_add_u32 v8, s23, v8
  v_add_u32 v9, s23, v9
  v_mfma_f32_16x16x32_bf16 v[176:179], v[124:127], v[48:51], v[176:179]
  v_add_u32 v10, s23, v10
  v_mfma_f32_16x16x32_bf16 v[176:179], v[120:123], v[32:35], v[176:179]
  s_waitcnt lgkmcnt(0)
  s_cbranch_vccnz Lo_26
  s_barrier
Lo_26:
  v_mfma_f32_16x16x32_bf16 v[192:195], v[96:99], v[32:35], v[192:195]
  ds_read_b128 v[64:67], v4 offset:0
  v_mfma_f32_16x16x32_bf16 v[192:195], v[100:103], v[48:51], v[192:195]
  ds_read_b128 v[80:83], v5 offset:0
  v_mfma_f32_16x16x32_bf16 v[196:199], v[100:103], v[52:55], v[196:199]
  v_mfma_f32_16x16x32_bf16 v[196:199], v[96:99], v[36:39], v[196:199]
  ds_read_b128 v[68:71], v4 offset:2048
  v_mfma_f32_16x16x32_bf16 v[200:203], v[96:99], v[40:43], v[200:203]
  ds_read_b128 v[84:87], v5 offset:2048
  v_mfma_f32_16x16x32_bf16 v[200:203], v[100:103], v[56:59], v[200:203]
  v_mfma_f32_16x16x32_bf16 v[204:207], v[100:103], v[60:63], v[204:207]
  ds_read_b128 v[72:75], v4 offset:4096
  v_mfma_f32_16x16x32_bf16 v[204:207], v[96:99], v[44:47], v[204:207]
  ds_read_b128 v[88:91], v5 offset:4096
  v_mfma_f32_16x16x32_bf16 v[220:223], v[104:107], v[44:47], v[220:223]
  ds_read_b64_tr_b16 v[96:97], v6 offset:0
  v_mfma_f32_16x16x32_bf16 v[220:223], v[108:111], v[60:63], v[220:223]
  ds_read_b64_tr_b16 v[98:99], v6 offset:2048
  v_mfma_f32_16x16x32_bf16 v[216:219], v[108:111], v[56:59], v[216:219]
  ds_read_b64_tr_b16 v[100:101], v6 offset:4096
  v_mfma_f32_16x16x32_bf16 v[216:219], v[104:107], v[40:43], v[216:219]
  ds_read_b64_tr_b16 v[102:103], v6 offset:6144
  v_mfma_f32_16x16x32_bf16 v[212:215], v[104:107], v[36:39], v[212:215]
  ds_read_b128 v[76:79], v4 offset:6144
  v_mfma_f32_16x16x32_bf16 v[212:215], v[108:111], v[52:55], v[212:215]
  v_mfma_f32_16x16x32_bf16 v[208:211], v[108:111], v[48:51], v[208:211]
  ds_read_b128 v[92:95], v5 offset:6144
  v_mfma_f32_16x16x32_bf16 v[208:211], v[104:107], v[32:35], v[208:211]
  v_mfma_f32_16x16x32_bf16 v[224:227], v[112:115], v[32:35], v[224:227]
  ds_read_b64_tr_b16 v[104:105], v7 offset:0
  v_mfma_f32_16x16x32_bf16 v[224:227], v[116:119], v[48:51], v[224:227]
  v_mfma_f32_16x16x32_bf16 v[228:231], v[116:119], v[52:55], v[228:231]
  ds_read_b64_tr_b16 v[106:107], v7 offset:2048
  v_mfma_f32_16x16x32_bf16 v[228:231], v[112:115], v[36:39], v[228:231]
  v_mfma_f32_16x16x32_bf16 v[232:235], v[112:115], v[40:43], v[232:235]
  ds_read_b64_tr_b16 v[108:109], v7 offset:4096
  v_mfma_f32_16x16x32_bf16 v[232:235], v[116:119], v[56:59], v[232:235]
  v_mfma_f32_16x16x32_bf16 v[236:239], v[116:119], v[60:63], v[236:239]
  ds_read_b64_tr_b16 v[110:111], v7 offset:6144
  s_waitcnt lgkmcnt(6)
  v_mfma_f32_16x16x32_bf16 v[236:239], v[112:115], v[44:47], v[236:239]
  s_cbranch_vccnz Lo_25
Lk_22:
  v_mfma_f32_16x16x32_bf16 v[128:131], v[96:99], v[64:67], v[128:131]
  ds_read_b64_tr_b16 v[112:113], v8 offset:0
  v_mfma_f32_16x16x32_bf16 v[128:131], v[100:103], v[80:83], v[128:131]
  ds_read_b64_tr_b16 v[114:115], v8 offset:2048
  v_mfma_f32_16x16x32_bf16 v[132:135], v[100:103], v[84:87], v[132:135]
  ds_read_b64_tr_b16 v[116:117], v8 offset:4096
  v_mfma_f32_16x16x32_bf16 v[132:135], v[96:99], v[68:71], v[132:135]
  ds_read_b64_tr_b16 v[118:119], v8 offset:6144
  v_mfma_f32_16x16x32_bf16 v[136:139], v[96:99], v[72:75], v[136:139]
  s_add_u32 s16, s16, s17
  s_cmp_eq_u32 s16, 65536
  s_cselect_b32 s23, s18, s17
  s_cselect_b32 s16, Lz1-Lz0+0, s16
  v_mfma_f32_16x16x32_bf16 v[136:139], v[100:103], v[88:91], v[136:139]
  v_add_u32_e64 v4, s23, v4
  v_add_u32 v5, s23, v5
  s_add_u32 s19, s19, s20
  s_cmp_eq_u32 s19, 86016
  s_waitcnt lgkmcnt(8)
  v_mfma_f32_16x16x32_bf16 v[140:143], v[100:103], v[92:95], v[140:143]
  s_cselect_b32 s23, s21, s20
  s_cselect_b32 s19, 0, s19
  v_mfma_f32_16x16x32_bf16 v[140:143], v[96:99], v[76:79], v[140:143]
  s_waitcnt lgkmcnt(4)
  v_mfma_f32_16x16x32_bf16 v[156:159], v[104:107], v[76:79], v[156:159]
  ds_read_b64_tr_b16 v[120:121], v9 offset:0
  v_mfma_f32_16x16x32_bf16 v[156:159], v[108:111], v[92:95], v[156:159]
  ds_read_b64_tr_b16 v[122:123], v9 offset:2048
  v_mfma_f32_16x16x32_bf16 v[152:155], v[108:111], v[88:91], v[152:155]
  ds_read_b64_tr_b16 v[124:125], v9 offset:4096
  v_mfma_f32_16x16x32_bf16 v[152:155], v[104:107], v[72:75], v[152:155]
  ds_read_b64_tr_b16 v[126:127], v9 offset:6144
  v_mfma_f32_16x16x32_bf16 v[148:151], v[104:107], v[68:71], v[148:151]
  s_sub_u32 s22, s22, 1
  s_cmp_lg_u32 s22, 0
  v_mfma_f32_16x16x32_bf16 v[148:151], v[108:111], v[84:87], v[148:151]
  v_mfma_f32_16x16x32_bf16 v[144:147], v[108:111], v[80:83], v[144:147]
  ds_read_b64_tr_b16 v[96:97], v6 offset:8192
  v_mfma_f32_16x16x32_bf16 v[144:147], v[104:107], v[64:67], v[144:147]
  ds_read_b64_tr_b16 v[98:99], v6 offset:10240
  s_nop 0
  s_waitcnt lgkmcnt(6)
  v_mfma_f32_16x16x32_bf16 v[160:163], v[112:115], v[64:67], v[160:163]
  ds_read_b64_tr_b16 v[100:101], v6 offset:12288
  v_mfma_f32_16x16x32_bf16 v[160:163], v[116:119], v[80:83], v[160:163]
  ds_read_b64_tr_b16 v[102:103], v6 offset:14336
  v_mfma_f32_16x16x32_bf16 v[164:167], v[116:119], v[84:87], v[164:167]
  v_mfma_f32_16x16x32_bf16 v[164:167], v[112:115], v[68:71], v[164:167]
  v_mfma_f32_16x16x32_bf16 v[168:171], v[112:115], v[72:75], v[168:171]
  ds_read_b64_tr_b16 v[104:105], v7 offset:8192
  v_mfma_f32_16x16x32_bf16 v[168:171], v[116:119], v[88:91], v[168:171]
  ds_read_b64_tr_b16 v[106:107], v7 offset:10240
  v_mfma_f32_16x16x32_bf16 v[172:175], v[116:119], v[92:95], v[172:175]
  ds_read_b64_tr_b16 v[108:109], v7 offset:12288
  v_mfma_f32_16x16x32_bf16 v[172:175], v[112:115], v[76:79], v[172:175]
  ds_read_b64_tr_b16 v[110:111], v7 offset:14336
  s_waitcnt lgkmcnt(8)
  v_mfma_f32_16x16x32_bf16 v[188:191], v[120:123], v[76:79], v[188:191]
  v_add_u32 v6, s23, v6
  v_add_u32_e64 v7, s23, v7
  v_mfma_f32_16x16x32_bf16 v[188:191], v[124:127], v[92:95], v[188:191]
  ds_read_b64_tr_b16 v[112:113], v10 offset:0
  v_mfma_f32_16x16x32_bf16 v[184:187], v[124:127], v[88:91], v[184:187]
  ds_read_b64_tr_b16 v[114:115], v10 offset:1024
  v_mfma_f32_16x16x32_bf16 v[184:187], v[120:123], v[72:75], v[184:187]
  ds_read_b64_tr_b16 v[116:117], v10 offset:2048
  v_mfma_f32_16x16x32_bf16 v[180:183], v[120:123], v[68:71], v[180:183]
  ds_read_b64_tr_b16 v[118:119], v10 offset:3072
  v_mfma_f32_16x16x32_bf16 v[180:183], v[124:127], v[84:87], v[180:183]
  v_add_u32 v8, s23, v8
  v_add_u32 v9, s23, v9
  v_mfma_f32_16x16x32_bf16 v[176:179], v[124:127], v[80:83], v[176:179]
  v_add_u32 v10, s23, v10
  v_mfma_f32_16x16x32_bf16 v[176:179], v[120:123], v[64:67], v[176:179]
  s_waitcnt lgkmcnt(0)
  s_barrier
  s_cbranch_scc0 Lk_23
  v_mfma_f32_16x16x32_bf16 v[192:195], v[96:99], v[64:67], v[192:195]
  ds_read_b128 v[32:35], v4 offset:0
  v_mfma_f32_16x16x32_bf16 v[192:195], v[100:103], v[80:83], v[192:195]
  ds_read_b128 v[48:51], v5 offset:0
  v_mfma_f32_16x16x32_bf16 v[196:199], v[100:103], v[84:87], v[196:199]
  v_mfma_f32_16x16x32_bf16 v[196:199], v[96:99], v[68:71], v[196:199]
  ds_read_b128 v[36:39], v4 offset:2048
  v_mfma_f32_16x16x32_bf16 v[200:203], v[96:99], v[72:75], v[200:203]
  ds_read_b128 v[52:55], v5 offset:2048
  v_mfma_f32_16x16x32_bf16 v[200:203], v[100:103], v[88:91], v[200:203]
  v_mfma_f32_16x16x32_bf16 v[204:207], v[100:103], v[92:95], v[204:207]
  ds_read_b128 v[40:43], v4 offset:4096
  v_mfma_f32_16x16x32_bf16 v[204:207], v[96:99], v[76:79], v[204:207]
  ds_read_b128 v[56:59], v5 offset:4096
  v_mfma_f32_16x16x32_bf16 v[220:223], v[104:107], v[76:79], v[220:223]
  ds_read_b64_tr_b16 v[96:97], v6 offset:0
  v_mfma_f32_16x16x32_bf16 v[220:223], v[108:111], v[92:95], v[220:223]
  ds_read_b64_tr_b16 v[98:99], v6 offset:2048
  v_mfma_f32_16x16x32_bf16 v[216:219], v[108:111], v[88:91], v[216:219]
  ds_read_b64_tr_b16 v[100:101], v6 offset:4096
  v_mfma_f32_16x16x32_bf16 v[216:219], v[104:107], v[72:75], v[216:219]
  ds_read_b64_tr_b16 v[102:103], v6 offset:6144
  v_mfma_f32_16x16x32_bf16 v[212:215], v[104:107], v[68:71], v[212:215]
  ds_read_b128 v[44:47], v4 offset:6144
  v_mfma_f32_16x16x32_bf16 v[212:215], v[108:111], v[84:87], v[212:215]
  v_mfma_f32_16x16x32_bf16 v[208:211], v[108:111], v[80:83], v[208:211]
  ds_read_b128 v[60:63], v5 offset:6144
  v_mfma_f32_16x16x32_bf16 v[208:211], v[104:107], v[64:67], v[208:211]
  v_mfma_f32_16x16x32_bf16 v[224:227], v[112:115], v[64:67], v[224:227]
  ds_read_b64_tr_b16 v[104:105], v7 offset:0
  v_mfma_f32_16x16x32_bf16 v[224:227], v[116:119], v[80:83], v[224:227]
  v_mfma_f32_16x16x32_bf16 v[228:231], v[116:119], v[84:87], v[228:231]
  ds_read_b64_tr_b16 v[106:107], v7 offset:2048
  v_mfma_f32_16x16x32_bf16 v[228:231], v[112:115], v[68:71], v[228:231]
  v_mfma_f32_16x16x32_bf16 v[232:235], v[112:115], v[72:75], v[232:235]
  ds_read_b64_tr_b16 v[108:109], v7 offset:4096
  v_mfma_f32_16x16x32_bf16 v[232:235], v[116:119], v[88:91], v[232:235]
  v_mfma_f32_16x16x32_bf16 v[236:239], v[116:119], v[92:95], v[236:239]
  ds_read_b64_tr_b16 v[110:111], v7 offset:6144
  s_waitcnt lgkmcnt(6)
  v_mfma_f32_16x16x32_bf16 v[236:239], v[112:115], v[76:79], v[236:239]
  s_branch Lk_21
Lk_23:
  v_mfma_f32_16x16x32_bf16 v[192:195], v[96:99], v[64:67], v[192:195]
  ds_read_b128 v[32:35], v3 offset:0
  s_mul_i32 s4, s85, 320
  v_mfma_f32_16x16x32_bf16 v[192:195], v[100:103], v[80:83], v[192:195]
  ds_read_b128 v[36:39], v3 offset:1024
  s_add_u32 s4, s4, 151552
  v_mfma_f32_16x16x32_bf16 v[196:199], v[100:103], v[84:87], v[196:199]
  ds_read_b128 v[40:43], v3 offset:64
  v_and_b32_e64 v2, 15, v1
  v_mfma_f32_16x16x32_bf16 v[196:199], v[96:99], v[68:71], v[196:199]
  ds_read_b128 v[44:47], v3 offset:1088
  v_lshl_add_u32 v7, v2, 2, s4
  v_mfma_f32_16x16x32_bf16 v[200:203], v[96:99], v[72:75], v[200:203]
  ds_read_b128 v[48:51], v3 offset:128
  v_mov_b32 v4, 0x409d30fc
  v_mfma_f32_16x16x32_bf16 v[200:203], v[100:103], v[88:91], v[200:203]
  ds_read_b128 v[52:55], v3 offset:1152
  v_mov_b32 v5, 0x3eeff558
  v_mfma_f32_16x16x32_bf16 v[204:207], v[100:103], v[92:95], v[204:207]
  ds_read_b128 v[56:59], v3 offset:192
  v_and_b32_e64 v2, 32, v1
  v_mfma_f32_16x16x32_bf16 v[204:207], v[96:99], v[76:79], v[204:207]
  ds_read_b128 v[60:63], v3 offset:1216
  v_mad_u32_u24 v6, v2, 48, v11
  v_mfma_f32_16x16x32_bf16 v[220:223], v[104:107], v[76:79], v[220:223]
  v_mfma_f32_16x16x32_bf16 v[220:223], v[108:111], v[92:95], v[220:223]
  ds_read2_b32 v[96:97], v7 offset0:0 offset1:160
  ds_read2_b32 v[98:99], v7 offset0:16 offset1:176
  v_mfma_f32_16x16x32_bf16 v[216:219], v[108:111], v[88:91], v[216:219]
  ds_read2_b32 v[100:101], v7 offset0:32 offset1:192
  ds_read2_b32 v[102:103], v7 offset0:48 offset1:208
  v_mfma_f32_16x16x32_bf16 v[216:219], v[104:107], v[72:75], v[216:219]
  s_lshl_b32 s5, s86, Lz1-Lz0+6
  s_add_u32 s5, s5, 154880
  v_mfma_f32_16x16x32_bf16 v[212:215], v[104:107], v[68:71], v[212:215]
  v_add_u32_e64 v2, s5, v29
  v_mfma_f32_16x16x32_bf16 v[212:215], v[108:111], v[84:87], v[212:215]
  v_mfma_f32_16x16x32_bf16 v[208:211], v[108:111], v[80:83], v[208:211]
  v_mfma_f32_16x16x32_bf16 v[208:211], v[104:107], v[64:67], v[208:211]
  v_mfma_f32_16x16x32_bf16 v[224:227], v[112:115], v[64:67], v[224:227]
  v_mfma_f32_16x16x32_bf16 v[224:227], v[116:119], v[80:83], v[224:227]
  v_mfma_f32_16x16x32_bf16 v[228:231], v[116:119], v[84:87], v[228:231]
  v_mfma_f32_16x16x32_bf16 v[228:231], v[112:115], v[68:71], v[228:231]
  s_waitcnt lgkmcnt(0)
  v_mul_f32 v96, v5, v96
  v_mul_f32_e64 v97, v5, v97
  v_mfma_f32_16x16x32_bf16 v[232:235], v[112:115], v[72:75], v[232:235]
  v_mul_f32 v98, v5, v98
  v_mul_f32 v99, v5, v99
  v_mfma_f32_16x16x32_bf16 v[232:235], v[116:119], v[88:91], v[232:235]
  v_mul_f32 v100, v5, v100
  v_mul_f32 v101, v5, v101
  v_mfma_f32_16x16x32_bf16 v[236:239], v[116:119], v[92:95], v[236:239]
  v_mul_f32 v102, v5, v102
  v_mul_f32 v103, v5, v103
  v_mfma_f32_16x16x32_bf16 v[236:239], v[112:115], v[76:79], v[236:239]
  ds_read_b128 v[80:83], v2 offset:0
  ds_read_b128 v[84:87], v2 offset:1024
  ds_read_b128 v[64:67], v3 offset:256
  ds_read_b128 v[68:71], v3 offset:1280
  ds_read_b128 v[72:75], v3 offset:320
  ds_read_b128 v[76:79], v3 offset:1344
  v_pk_fma_f32 v[104:105], v[32:33], v[96:97], v[36:37] op_sel:[0,1,0] op_sel_hi:[1,1,1] neg_lo:[0,1,0] neg_hi:[0,1,0]
  v_pk_fma_f32 v[106:107], v[34:35], v[96:97], v[38:39] op_sel:[0,1,0] op_sel_hi:[1,1,1] neg_lo:[0,1,0] neg_hi:[0,1,0]
  v_pk_fma_f32 v[108:109], v[40:41], v[96:97], v[44:45] op_sel:[0,1,0] op_sel_hi:[1,1,1] neg_lo:[0,1,0] neg_hi:[0,1,0]
  v_pk_fma_f32 v[110:111], v[42:43], v[96:97], v[46:47] op_sel:[0,1,0] op_sel_hi:[1,1,1] neg_lo:[0,1,0] neg_hi:[0,1,0]
  v_pk_fma_f32 v[128:129], v[128:129], v[96:97], v[104:105] op_sel:[0,0,0] op_sel_hi:[1,0,1]
  v_pk_fma_f32 v[130:131], v[130:131], v[96:97], v[106:107] op_sel:[0,0,0] op_sel_hi:[1,0,1]
  v_pk_fma_f32 v[144:145], v[144:145], v[96:97], v[108:109] op_sel:[0,0,0] op_sel_hi:[1,0,1]
  v_pk_fma_f32 v[146:147], v[146:147], v[96:97], v[110:111] op_sel:[0,0,0] op_sel_hi:[1,0,1]
  v_pk_fma_f32 v[104:105], v[128:129], v[128:129], v[4:5] op_sel_hi:[1,1,0]
  v_pk_fma_f32 v[106:107], v[130:131], v[130:131], v[4:5] op_sel_hi:[1,1,0]
  v_pk_fma_f32 v[108:109], v[144:145], v[144:145], v[4:5] op_sel_hi:[1,1,0]
  v_pk_fma_f32 v[110:111], v[146:147], v[146:147], v[4:5] op_sel_hi:[1,1,0]
  v_pk_mul_f32 v[104:105], v[104:105], v[128:129] neg_lo:[0,1] neg_hi:[0,1]
  v_pk_mul_f32 v[106:107], v[106:107], v[130:131] neg_lo:[0,1] neg_hi:[0,1]
  v_pk_mul_f32 v[108:109], v[108:109], v[144:145] neg_lo:[0,1] neg_hi:[0,1]
  v_pk_mul_f32 v[110:111], v[110:111], v[146:147] neg_lo:[0,1] neg_hi:[0,1]
  v_exp_f32 v104, v104
  v_exp_f32 v105, v105
  v_exp_f32 v106, v106
  v_exp_f32 v107, v107
  v_exp_f32 v108, v108
  v_exp_f32 v109, v109
  v_exp_f32 v110, v110
  v_exp_f32 v111, v111
  v_pk_fma_f32 v[104:105], v[104:105], v[4:5], v[4:5] op_sel:[0,1,1] op_sel_hi:[1,1,1]
  v_pk_fma_f32 v[106:107], v[106:107], v[4:5], v[4:5] op_sel:[0,1,1] op_sel_hi:[1,1,1]
  v_pk_fma_f32 v[108:109], v[108:109], v[4:5], v[4:5] op_sel:[0,1,1] op_sel_hi:[1,1,1]
  v_pk_fma_f32 v[110:111], v[110:111], v[4:5], v[4:5] op_sel:[0,1,1] op_sel_hi:[1,1,1]
  v_rcp_f32 v104, v104
  v_rcp_f32 v105, v105
  v_rcp_f32 v106, v106
  v_rcp_f32 v107, v107
  v_rcp_f32 v108, v108
  v_rcp_f32 v109, v109
  v_rcp_f32 v110, v110
  v_rcp_f32 v111, v111
  v_pk_mul_f32 v[128:129], v[128:129], v[104:105]
  v_pk_mul_f32 v[130:131], v[130:131], v[106:107]
  v_pk_mul_f32 v[144:145], v[144:145], v[108:109]
  v_pk_mul_f32 v[146:147], v[146:147], v[110:111]
  v_cvt_pk_bf16_f32 v116, v128, v129
  v_cvt_pk_bf16_f32 v117, v130, v131
  v_cvt_pk_bf16_f32 v118, v144, v145
  v_cvt_pk_bf16_f32 v119, v146, v147
  buffer_store_dwordx4 v[116:119], v0, s[40:43], s6 offen offset:0 sc0 sc1
  ds_write_b128 v0, v[116:119] offset:0
  v_pk_fma_f32 v[104:105], v[32:33], v[98:99], v[36:37] op_sel:[0,1,0] op_sel_hi:[1,1,1] neg_lo:[0,1,0] neg_hi:[0,1,0]
  v_pk_fma_f32 v[106:107], v[34:35], v[98:99], v[38:39] op_sel:[0,1,0] op_sel_hi:[1,1,1] neg_lo:[0,1,0] neg_hi:[0,1,0]
  v_pk_fma_f32 v[108:109], v[40:41], v[98:99], v[44:45] op_sel:[0,1,0] op_sel_hi:[1,1,1] neg_lo:[0,1,0] neg_hi:[0,1,0]
  v_pk_fma_f32 v[110:111], v[42:43], v[98:99], v[46:47] op_sel:[0,1,0] op_sel_hi:[1,1,1] neg_lo:[0,1,0] neg_hi:[0,1,0]
  v_pk_fma_f32 v[132:133], v[132:133], v[98:99], v[104:105] op_sel:[0,0,0] op_sel_hi:[1,0,1]
  v_pk_fma_f32 v[134:135], v[134:135], v[98:99], v[106:107] op_sel:[0,0,0] op_sel_hi:[1,0,1]
  v_pk_fma_f32 v[148:149], v[148:149], v[98:99], v[108:109] op_sel:[0,0,0] op_sel_hi:[1,0,1]
  v_pk_fma_f32 v[150:151], v[150:151], v[98:99], v[110:111] op_sel:[0,0,0] op_sel_hi:[1,0,1]
  v_pk_fma_f32 v[104:105], v[132:133], v[132:133], v[4:5] op_sel_hi:[1,1,0]
  v_pk_fma_f32 v[106:107], v[134:135], v[134:135], v[4:5] op_sel_hi:[1,1,0]
  v_pk_fma_f32 v[108:109], v[148:149], v[148:149], v[4:5] op_sel_hi:[1,1,0]
  v_pk_fma_f32 v[110:111], v[150:151], v[150:151], v[4:5] op_sel_hi:[1,1,0]
  v_pk_mul_f32 v[104:105], v[104:105], v[132:133] neg_lo:[0,1] neg_hi:[0,1]
  v_pk_mul_f32 v[106:107], v[106:107], v[134:135] neg_lo:[0,1] neg_hi:[0,1]
  v_pk_mul_f32 v[108:109], v[108:109], v[148:149] neg_lo:[0,1] neg_hi:[0,1]
  v_pk_mul_f32 v[110:111], v[110:111], v[150:151] neg_lo:[0,1] neg_hi:[0,1]
  v_exp_f32 v104, v104
  v_exp_f32 v105, v105
  v_exp_f32 v106, v106
  v_exp_f32 v107, v107
  v_exp_f32 v108, v108
  v_exp_f32 v109, v109
  v_exp_f32 v110, v110
  v_exp_f32 v111, v111
  v_pk_fma_f32 v[104:105], v[104:105], v[4:5], v[4:5] op_sel:[0,1,1] op_sel_hi:[1,1,1]
  v_pk_fma_f32 v[106:107], v[106:107], v[4:5], v[4:5] op_sel:[0,1,1] op_sel_hi:[1,1,1]
  v_pk_fma_f32 v[108:109], v[108:109], v[4:5], v[4:5] op_sel:[0,1,1] op_sel_hi:[1,1,1]
  v_pk_fma_f32 v[110:111], v[110:111], v[4:5], v[4:5] op_sel:[0,1,1] op_sel_hi:[1,1,1]
  v_rcp_f32 v104, v104
  v_rcp_f32 v105, v105
  v_rcp_f32 v106, v106
  v_rcp_f32 v107, v107
  v_rcp_f32 v108, v108
  v_rcp_f32 v109, v109
  v_rcp_f32 v110, v110
  v_rcp_f32 v111, v111
  v_pk_mul_f32 v[132:133], v[132:133], v[104:105]
  v_pk_mul_f32 v[134:135], v[134:135], v[106:107]
  v_pk_mul_f32 v[148:149], v[148:149], v[108:109]
  v_pk_mul_f32 v[150:151], v[150:151], v[110:111]
  v_cvt_pk_bf16_f32 v120, v132, v133
  v_cvt_pk_bf16_f32 v121, v134, v135
  v_cvt_pk_bf16_f32 v122, v148, v149
  v_cvt_pk_bf16_f32 v123, v150, v151
  buffer_store_dwordx4 v[120:123], v0, s[40:43], s6 offen offset:2048 sc0 sc1
  ds_write_b128 v0, v[120:123] offset:2048
  s_add_u32 s6, s6, 0x20000
  v_pk_fma_f32 v[104:105], v[32:33], v[100:101], v[36:37] op_sel:[0,1,0] op_sel_hi:[1,1,1] neg_lo:[0,1,0] neg_hi:[0,1,0]
  v_pk_fma_f32 v[106:107], v[34:35], v[100:101], v[38:39] op_sel:[0,1,0] op_sel_hi:[1,1,1] neg_lo:[0,1,0] neg_hi:[0,1,0]
  v_pk_fma_f32 v[108:109], v[40:41], v[100:101], v[44:45] op_sel:[0,1,0] op_sel_hi:[1,1,1] neg_lo:[0,1,0] neg_hi:[0,1,0]
  v_pk_fma_f32 v[110:111], v[42:43], v[100:101], v[46:47] op_sel:[0,1,0] op_sel_hi:[1,1,1] neg_lo:[0,1,0] neg_hi:[0,1,0]
  v_pk_fma_f32 v[136:137], v[136:137], v[100:101], v[104:105] op_sel:[0,0,0] op_sel_hi:[1,0,1]
  v_pk_fma_f32 v[138:139], v[138:139], v[100:101], v[106:107] op_sel:[0,0,0] op_sel_hi:[1,0,1]
  v_pk_fma_f32 v[152:153], v[152:153], v[100:101], v[108:109] op_sel:[0,0,0] op_sel_hi:[1,0,1]
  v_pk_fma_f32 v[154:155], v[154:155], v[100:101], v[110:111] op_sel:[0,0,0] op_sel_hi:[1,0,1]
  v_pk_fma_f32 v[104:105], v[136:137], v[136:137], v[4:5] op_sel_hi:[1,1,0]
  v_pk_fma_f32 v[106:107], v[138:139], v[138:139], v[4:5] op_sel_hi:[1,1,0]
  v_pk_fma_f32 v[108:109], v[152:153], v[152:153], v[4:5] op_sel_hi:[1,1,0]
  v_pk_fma_f32 v[110:111], v[154:155], v[154:155], v[4:5] op_sel_hi:[1,1,0]
  v_pk_mul_f32 v[104:105], v[104:105], v[136:137] neg_lo:[0,1] neg_hi:[0,1]
  v_pk_mul_f32 v[106:107], v[106:107], v[138:139] neg_lo:[0,1] neg_hi:[0,1]
  v_pk_mul_f32 v[108:109], v[108:109], v[152:153] neg_lo:[0,1] neg_hi:[0,1]
  v_pk_mul_f32 v[110:111], v[110:111], v[154:155] neg_lo:[0,1] neg_hi:[0,1]
  v_exp_f32 v104, v104
  v_exp_f32 v105, v105
  v_exp_f32 v106, v106
  v_exp_f32 v107, v107
  v_exp_f32 v108, v108
  v_exp_f32 v109, v109
  v_exp_f32 v110, v110
  v_exp_f32 v111, v111
  v_pk_fma_f32 v[104:105], v[104:105], v[4:5], v[4:5] op_sel:[0,1,1] op_sel_hi:[1,1,1]
  v_pk_fma_f32 v[106:107], v[106:107], v[4:5], v[4:5] op_sel:[0,1,1] op_sel_hi:[1,1,1]
  v_pk_fma_f32 v[108:109], v[108:109], v[4:5], v[4:5] op_sel:[0,1,1] op_sel_hi:[1,1,1]
  v_pk_fma_f32 v[110:111], v[110:111], v[4:5], v[4:5] op_sel:[0,1,1] op_sel_hi:[1,1,1]
  v_rcp_f32 v104, v104
  v_rcp_f32 v105, v105
  v_rcp_f32 v106, v106
  v_rcp_f32 v107, v107
  v_rcp_f32 v108, v108
  v_rcp_f32 v109, v109
  v_rcp_f32 v110, v110
  v_rcp_f32 v111, v111
  v_pk_mul_f32 v[136:137], v[136:137], v[104:105]
  v_pk_mul_f32 v[138:139], v[138:139], v[106:107]
  v_pk_mul_f32 v[152:153], v[152:153], v[108:109]
  v_pk_mul_f32 v[154:155], v[154:155], v[110:111]
  v_cvt_pk_bf16_f32 v116, v136, v137
  v_cvt_pk_bf16_f32 v117, v138, v139
  v_cvt_pk_bf16_f32 v118, v152, v153
  v_cvt_pk_bf16_f32 v119, v154, v155
  buffer_store_dwordx4 v[116:119], v0, s[40:43], s7 offen offset:0 sc0 sc1
  ds_write_b128 v0, v[116:119] offset:4096
  v_pk_fma_f32 v[104:105], v[32:33], v[102:103], v[36:37] op_sel:[0,1,0] op_sel_hi:[1,1,1] neg_lo:[0,1,0] neg_hi:[0,1,0]
  v_pk_fma_f32 v[106:107], v[34:35], v[102:103], v[38:39] op_sel:[0,1,0] op_sel_hi:[1,1,1] neg_lo:[0,1,0] neg_hi:[0,1,0]
  v_pk_fma_f32 v[108:109], v[40:41], v[102:103], v[44:45] op_sel:[0,1,0] op_sel_hi:[1,1,1] neg_lo:[0,1,0] neg_hi:[0,1,0]
  v_pk_fma_f32 v[110:111], v[42:43], v[102:103], v[46:47] op_sel:[0,1,0] op_sel_hi:[1,1,1] neg_lo:[0,1,0] neg_hi:[0,1,0]
  v_pk_fma_f32 v[140:141], v[140:141], v[102:103], v[104:105] op_sel:[0,0,0] op_sel_hi:[1,0,1]
  v_pk_fma_f32 v[142:143], v[142:143], v[102:103], v[106:107] op_sel:[0,0,0] op_sel_hi:[1,0,1]
  v_pk_fma_f32 v[156:157], v[156:157], v[102:103], v[108:109] op_sel:[0,0,0] op_sel_hi:[1,0,1]
  v_pk_fma_f32 v[158:159], v[158:159], v[102:103], v[110:111] op_sel:[0,0,0] op_sel_hi:[1,0,1]
  v_pk_fma_f32 v[104:105], v[140:141], v[140:141], v[4:5] op_sel_hi:[1,1,0]
  v_pk_fma_f32 v[106:107], v[142:143], v[142:143], v[4:5] op_sel_hi:[1,1,0]
  v_pk_fma_f32 v[108:109], v[156:157], v[156:157], v[4:5] op_sel_hi:[1,1,0]
  v_pk_fma_f32 v[110:111], v[158:159], v[158:159], v[4:5] op_sel_hi:[1,1,0]
  v_pk_mul_f32 v[104:105], v[104:105], v[140:141] neg_lo:[0,1] neg_hi:[0,1]
  v_pk_mul_f32 v[106:107], v[106:107], v[142:143] neg_lo:[0,1] neg_hi:[0,1]
  v_pk_mul_f32 v[108:109], v[108:109], v[156:157] neg_lo:[0,1] neg_hi:[0,1]
  v_pk_mul_f32 v[110:111], v[110:111], v[158:159] neg_lo:[0,1] neg_hi:[0,1]
  v_exp_f32 v104, v104
  v_exp_f32 v105, v105
  v_exp_f32 v106, v106
  v_exp_f32 v107, v107
  v_exp_f32 v108, v108
  v_exp_f32 v109, v109
  v_exp_f32 v110, v110
  v_exp_f32 v111, v111
  v_pk_fma_f32 v[104:105], v[104:105], v[4:5], v[4:5] op_sel:[0,1,1] op_sel_hi:[1,1,1]
  v_pk_fma_f32 v[106:107], v[106:107], v[4:5], v[4:5] op_sel:[0,1,1] op_sel_hi:[1,1,1]
  v_pk_fma_f32 v[108:109], v[108:109], v[4:5], v[4:5] op_sel:[0,1,1] op_sel_hi:[1,1,1]
  v_pk_fma_f32 v[110:111], v[110:111], v[4:5], v[4:5] op_sel:[0,1,1] op_sel_hi:[1,1,1]
  v_rcp_f32 v104, v104
  v_rcp_f32 v105, v105
  v_rcp_f32 v106, v106
  v_rcp_f32 v107, v107
  v_rcp_f32 v108, v108
  v_rcp_f32 v109, v109
  v_rcp_f32 v110, v110
  v_rcp_f32 v111, v111
  v_pk_mul_f32 v[140:141], v[140:141], v[104:105]
  v_pk_mul_f32 v[142:143], v[142:143], v[106:107]
  v_pk_mul_f32 v[156:157], v[156:157], v[108:109]
  v_pk_mul_f32 v[158:159], v[158:159], v[110:111]
  v_cvt_pk_bf16_f32 v120, v140, v141
  v_cvt_pk_bf16_f32 v121, v142, v143
  v_cvt_pk_bf16_f32 v122, v156, v157
  v_cvt_pk_bf16_f32 v123, v158, v159
  buffer_store_dwordx4 v[120:123], v0, s[40:43], s7 offen offset:2048 sc0 sc1
  ds_write_b128 v0, v[120:123] offset:6144
  s_add_u32 s7, s7, 0x20000
  s_nop 0
  s_waitcnt lgkmcnt(0)
  v_pk_fma_f32 v[104:105], v[80:81], v[96:97], v[84:85] op_sel:[0,1,0] op_sel_hi:[1,1,1] neg_lo:[0,1,0] neg_hi:[0,1,0]
  v_pk_fma_f32 v[106:107], v[82:83], v[96:97], v[86:87] op_sel:[0,1,0] op_sel_hi:[1,1,1] neg_lo:[0,1,0] neg_hi:[0,1,0]
  v_pk_fma_f32 v[108:109], v[80:81], v[98:99], v[84:85] op_sel:[0,1,0] op_sel_hi:[1,1,1] neg_lo:[0,1,0] neg_hi:[0,1,0]
  v_pk_fma_f32 v[110:111], v[82:83], v[98:99], v[86:87] op_sel:[0,1,0] op_sel_hi:[1,1,1] neg_lo:[0,1,0] neg_hi:[0,1,0]
  v_pk_fma_f32 v[224:225], v[224:225], v[96:97], v[104:105] op_sel:[0,0,0] op_sel_hi:[1,0,1]
  v_pk_fma_f32 v[226:227], v[226:227], v[96:97], v[106:107] op_sel:[0,0,0] op_sel_hi:[1,0,1]
  v_pk_fma_f32 v[228:229], v[228:229], v[98:99], v[108:109] op_sel:[0,0,0] op_sel_hi:[1,0,1]
  v_pk_fma_f32 v[230:231], v[230:231], v[98:99], v[110:111] op_sel:[0,0,0] op_sel_hi:[1,0,1]
  v_pk_fma_f32 v[104:105], v[224:225], v[224:225], v[4:5] op_sel_hi:[1,1,0]
  v_pk_fma_f32 v[106:107], v[226:227], v[226:227], v[4:5] op_sel_hi:[1,1,0]
  v_pk_fma_f32 v[108:109], v[228:229], v[228:229], v[4:5] op_sel_hi:[1,1,0]
  v_pk_fma_f32 v[110:111], v[230:231], v[230:231], v[4:5] op_sel_hi:[1,1,0]
  v_pk_mul_f32 v[104:105], v[104:105], v[224:225] neg_lo:[0,1] neg_hi:[0,1]
  v_pk_mul_f32 v[106:107], v[106:107], v[226:227] neg_lo:[0,1] neg_hi:[0,1]
  v_pk_mul_f32 v[108:109], v[108:109], v[228:229] neg_lo:[0,1] neg_hi:[0,1]
  v_pk_mul_f32 v[110:111], v[110:111], v[230:231] neg_lo:[0,1] neg_hi:[0,1]
  v_exp_f32 v104, v104
  v_exp_f32 v105, v105
  v_exp_f32 v106, v106
  v_exp_f32 v107, v107
  v_exp_f32 v108, v108
  v_exp_f32 v109, v109
  v_exp_f32 v110, v110
  v_exp_f32 v111, v111
  v_pk_fma_f32 v[104:105], v[104:105], v[4:5], v[4:5] op_sel:[0,1,1] op_sel_hi:[1,1,1]
  v_pk_fma_f32 v[106:107], v[106:107], v[4:5], v[4:5] op_sel:[0,1,1] op_sel_hi:[1,1,1]
  v_pk_fma_f32 v[108:109], v[108:109], v[4:5], v[4:5] op_sel:[0,1,1] op_sel_hi:[1,1,1]
  v_pk_fma_f32 v[110:111], v[110:111], v[4:5], v[4:5] op_sel:[0,1,1] op_sel_hi:[1,1,1]
  v_rcp_f32 v104, v104
  v_rcp_f32 v105, v105
  v_rcp_f32 v106, v106
  v_rcp_f32 v107, v107
  v_rcp_f32 v108, v108
  v_rcp_f32 v109, v109
  v_rcp_f32 v110, v110
  v_rcp_f32 v111, v111
  v_pk_mul_f32 v[224:225], v[224:225], v[104:105]
  v_pk_mul_f32 v[226:227], v[226:227], v[106:107]
  v_pk_mul_f32 v[228:229], v[228:229], v[108:109]
  v_pk_mul_f32 v[230:231], v[230:231], v[110:111]
  v_cvt_pk_bf16_f32 v116, v224, v225
  v_cvt_pk_bf16_f32 v117, v226, v227
  v_cvt_pk_bf16_f32 v118, v228, v229
  v_cvt_pk_bf16_f32 v119, v230, v231
  s_nop 0
  v_permlane32_swap_b32 v116, v118
  v_permlane32_swap_b32_e64 v117, v119
  buffer_store_dwordx4 v[116:119], v6, s[40:43], s8 offen sc0 sc1
  s_add_u32 s8, s8, 4096
  v_pk_fma_f32 v[104:105], v[80:81], v[100:101], v[84:85] op_sel:[0,1,0] op_sel_hi:[1,1,1] neg_lo:[0,1,0] neg_hi:[0,1,0]
  v_pk_fma_f32 v[106:107], v[82:83], v[100:101], v[86:87] op_sel:[0,1,0] op_sel_hi:[1,1,1] neg_lo:[0,1,0] neg_hi:[0,1,0]
  v_pk_fma_f32 v[108:109], v[80:81], v[102:103], v[84:85] op_sel:[0,1,0] op_sel_hi:[1,1,1] neg_lo:[0,1,0] neg_hi:[0,1,0]
  v_pk_fma_f32 v[110:111], v[82:83], v[102:103], v[86:87] op_sel:[0,1,0] op_sel_hi:[1,1,1] neg_lo:[0,1,0] neg_hi:[0,1,0]
  v_pk_fma_f32 v[232:233], v[232:233], v[100:101], v[104:105] op_sel:[0,0,0] op_sel_hi:[1,0,1]
  v_pk_fma_f32 v[234:235], v[234:235], v[100:101], v[106:107] op_sel:[0,0,0] op_sel_hi:[1,0,1]
  v_pk_fma_f32 v[236:237], v[236:237], v[102:103], v[108:109] op_sel:[0,0,0] op_sel_hi:[1,0,1]
  v_pk_fma_f32 v[238:239], v[238:239], v[102:103], v[110:111] op_sel:[0,0,0] op_sel_hi:[1,0,1]
  v_pk_fma_f32 v[104:105], v[232:233], v[232:233], v[4:5] op_sel_hi:[1,1,0]
  v_pk_fma_f32 v[106:107], v[234:235], v[234:235], v[4:5] op_sel_hi:[1,1,0]
  v_pk_fma_f32 v[108:109], v[236:237], v[236:237], v[4:5] op_sel_hi:[1,1,0]
  v_pk_fma_f32 v[110:111], v[238:239], v[238:239], v[4:5] op_sel_hi:[1,1,0]
  v_pk_mul_f32 v[104:105], v[104:105], v[232:233] neg_lo:[0,1] neg_hi:[0,1]
  v_pk_mul_f32 v[106:107], v[106:107], v[234:235] neg_lo:[0,1] neg_hi:[0,1]
  v_pk_mul_f32 v[108:109], v[108:109], v[236:237] neg_lo:[0,1] neg_hi:[0,1]
  v_pk_mul_f32 v[110:111], v[110:111], v[238:239] neg_lo:[0,1] neg_hi:[0,1]
  v_exp_f32 v104, v104
  v_exp_f32 v105, v105
  v_exp_f32 v106, v106
  v_exp_f32 v107, v107
  v_exp_f32 v108, v108
  v_exp_f32 v109, v109
  v_exp_f32 v110, v110
  v_exp_f32 v111, v111
  v_pk_fma_f32 v[104:105], v[104:105], v[4:5], v[4:5] op_sel:[0,1,1] op_sel_hi:[1,1,1]
  v_pk_fma_f32 v[106:107], v[106:107], v[4:5], v[4:5] op_sel:[0,1,1] op_sel_hi:[1,1,1]
  v_pk_fma_f32 v[108:109], v[108:109], v[4:5], v[4:5] op_sel:[0,1,1] op_sel_hi:[1,1,1]
  v_pk_fma_f32 v[110:111], v[110:111], v[4:5], v[4:5] op_sel:[0,1,1] op_sel_hi:[1,1,1]
  v_rcp_f32 v104, v104
  v_rcp_f32 v105, v105
  v_rcp_f32 v106, v106
  v_rcp_f32 v107, v107
  v_rcp_f32 v108, v108
  v_rcp_f32 v109, v109
  v_rcp_f32 v110, v110
  v_rcp_f32 v111, v111
  v_pk_mul_f32 v[232:233], v[232:233], v[104:105]
  v_pk_mul_f32 v[234:235], v[234:235], v[106:107]
  v_pk_mul_f32 v[236:237], v[236:237], v[108:109]
  v_pk_mul_f32 v[238:239], v[238:239], v[110:111]
  v_cvt_pk_bf16_f32 v120, v232, v233
  v_cvt_pk_bf16_f32 v121, v234, v235
  v_cvt_pk_bf16_f32 v122, v236, v237
  v_cvt_pk_bf16_f32 v123, v238, v239
  s_add_u32 s9, s87, Lz1-Lz0+8
  s_waitcnt vmcnt(1)
  s_mov_b64 exec, 1
  ds_add_rtn_u32 v124, v28, v27 offset:0
  s_mov_b64 exec, -1
  v_permlane32_swap_b32 v120, v122
  v_permlane32_swap_b32_e64 v121, v123
  buffer_store_dwordx4 v[120:123], v6, s[40:43], s8 offen sc0 sc1
  v_pk_fma_f32 v[104:105], v[48:49], v[96:97], v[52:53] op_sel:[0,1,0] op_sel_hi:[1,1,1] neg_lo:[0,1,0] neg_hi:[0,1,0]
  v_pk_fma_f32 v[106:107], v[50:51], v[96:97], v[54:55] op_sel:[0,1,0] op_sel_hi:[1,1,1] neg_lo:[0,1,0] neg_hi:[0,1,0]
  v_pk_fma_f32 v[108:109], v[56:57], v[96:97], v[60:61] op_sel:[0,1,0] op_sel_hi:[1,1,1] neg_lo:[0,1,0] neg_hi:[0,1,0]
  v_pk_fma_f32 v[110:111], v[58:59], v[96:97], v[62:63] op_sel:[0,1,0] op_sel_hi:[1,1,1] neg_lo:[0,1,0] neg_hi:[0,1,0]
  v_pk_fma_f32 v[160:161], v[160:161], v[96:97], v[104:105] op_sel:[0,0,0] op_sel_hi:[1,0,1]
  v_pk_fma_f32 v[162:163], v[162:163], v[96:97], v[106:107] op_sel:[0,0,0] op_sel_hi:[1,0,1]
  v_pk_fma_f32 v[176:177], v[176:177], v[96:97], v[108:109] op_sel:[0,0,0] op_sel_hi:[1,0,1]
  v_pk_fma_f32 v[178:179], v[178:179], v[96:97], v[110:111] op_sel:[0,0,0] op_sel_hi:[1,0,1]
  v_pk_fma_f32 v[104:105], v[160:161], v[160:161], v[4:5] op_sel_hi:[1,1,0]
  v_pk_fma_f32 v[106:107], v[162:163], v[162:163], v[4:5] op_sel_hi:[1,1,0]
  v_pk_fma_f32 v[108:109], v[176:177], v[176:177], v[4:5] op_sel_hi:[1,1,0]
  v_pk_fma_f32 v[110:111], v[178:179], v[178:179], v[4:5] op_sel_hi:[1,1,0]
  v_pk_mul_f32 v[104:105], v[104:105], v[160:161] neg_lo:[0,1] neg_hi:[0,1]
  v_pk_mul_f32 v[106:107], v[106:107], v[162:163] neg_lo:[0,1] neg_hi:[0,1]
  v_pk_mul_f32 v[108:109], v[108:109], v[176:177] neg_lo:[0,1] neg_hi:[0,1]
  v_pk_mul_f32 v[110:111], v[110:111], v[178:179] neg_lo:[0,1] neg_hi:[0,1]
  v_exp_f32 v104, v104
  v_exp_f32 v105, v105
  v_exp_f32 v106, v106
  v_exp_f32 v107, v107
  v_exp_f32 v108, v108
  v_exp_f32 v109, v109
  v_exp_f32 v110, v110
  v_exp_f32 v111, v111
  v_pk_fma_f32 v[104:105], v[104:105], v[4:5], v[4:5] op_sel:[0,1,1] op_sel_hi:[1,1,1]
  v_pk_fma_f32 v[106:107], v[106:107], v[4:5], v[4:5] op_sel:[0,1,1] op_sel_hi:[1,1,1]
  v_pk_fma_f32 v[108:109], v[108:109], v[4:5], v[4:5] op_sel:[0,1,1] op_sel_hi:[1,1,1]
  v_pk_fma_f32 v[110:111], v[110:111], v[4:5], v[4:5] op_sel:[0,1,1] op_sel_hi:[1,1,1]
  v_rcp_f32 v104, v104
  v_rcp_f32 v105, v105
  v_rcp_f32 v106, v106
  v_rcp_f32 v107, v107
  v_rcp_f32 v108, v108
  v_rcp_f32 v109, v109
  v_rcp_f32 v110, v110
  v_rcp_f32 v111, v111
  v_pk_mul_f32 v[160:161], v[160:161], v[104:105]
  v_pk_mul_f32 v[162:163], v[162:163], v[106:107]
  v_pk_mul_f32 v[176:177], v[176:177], v[108:109]
  v_pk_mul_f32 v[178:179], v[178:179], v[110:111]
  v_cvt_pk_bf16_f32 v116, v160, v161
  v_cvt_pk_bf16_f32 v117, v162, v163
  v_cvt_pk_bf16_f32 v118, v176, v177
  v_cvt_pk_bf16_f32 v119, v178, v179
  s_waitcnt lgkmcnt(0)
  v_readfirstlane_b32 s4, v124
  s_and_b32 s4, s4, 3
  s_cmp_lg_u32 s4, 3
  s_cbranch_scc1 Ls_27
  s_mov_b32 exec_lo, s10
  s_mov_b32 exec_hi, 0
  buffer_store_dword v27, v24, s[40:43], s9 offen sc0 sc1
Ls_27:
  s_mov_b64 exec, -1
  buffer_store_dwordx4 v[116:119], v0, s[40:43], s6 offen offset:0 sc0 sc1
  ds_write_b128 v0, v[116:119] offset:16384
  v_pk_fma_f32 v[104:105], v[48:49], v[98:99], v[52:53] op_sel:[0,1,0] op_sel_hi:[1,1,1] neg_lo:[0,1,0] neg_hi:[0,1,0]
  v_pk_fma_f32 v[106:107], v[50:51], v[98:99], v[54:55] op_sel:[0,1,0] op_sel_hi:[1,1,1] neg_lo:[0,1,0] neg_hi:[0,1,0]
  v_pk_fma_f32 v[108:109], v[56:57], v[98:99], v[60:61] op_sel:[0,1,0] op_sel_hi:[1,1,1] neg_lo:[0,1,0] neg_hi:[0,1,0]
  v_pk_fma_f32 v[110:111], v[58:59], v[98:99], v[62:63] op_sel:[0,1,0] op_sel_hi:[1,1,1] neg_lo:[0,1,0] neg_hi:[0,1,0]
  v_pk_fma_f32 v[164:165], v[164:165], v[98:99], v[104:105] op_sel:[0,0,0] op_sel_hi:[1,0,1]
  v_pk_fma_f32 v[166:167], v[166:167], v[98:99], v[106:107] op_sel:[0,0,0] op_sel_hi:[1,0,1]
  v_pk_fma_f32 v[180:181], v[180:181], v[98:99], v[108:109] op_sel:[0,0,0] op_sel_hi:[1,0,1]
  v_pk_fma_f32 v[182:183], v[182:183], v[98:99], v[110:111] op_sel:[0,0,0] op_sel_hi:[1,0,1]
  v_pk_fma_f32 v[104:105], v[164:165], v[164:165], v[4:5] op_sel_hi:[1,1,0]
  v_pk_fma_f32 v[106:107], v[166:167], v[166:167], v[4:5] op_sel_hi:[1,1,0]
  v_pk_fma_f32 v[108:109], v[180:181], v[180:181], v[4:5] op_sel_hi:[1,1,0]
  v_pk_fma_f32 v[110:111], v[182:183], v[182:183], v[4:5] op_sel_hi:[1,1,0]
  v_pk_mul_f32 v[104:105], v[104:105], v[164:165] neg_lo:[0,1] neg_hi:[0,1]
  v_pk_mul_f32 v[106:107], v[106:107], v[166:167] neg_lo:[0,1] neg_hi:[0,1]
  v_pk_mul_f32 v[108:109], v[108:109], v[180:181] neg_lo:[0,1] neg_hi:[0,1]
  v_pk_mul_f32 v[110:111], v[110:111], v[182:183] neg_lo:[0,1] neg_hi:[0,1]
  v_exp_f32 v104, v104
  v_exp_f32 v105, v105
  v_exp_f32 v106, v106
  v_exp_f32 v107, v107
  v_exp_f32 v108, v108
  v_exp_f32 v109, v109
  v_exp_f32 v110, v110
  v_exp_f32 v111, v111
  v_pk_fma_f32 v[104:105], v[104:105], v[4:5], v[4:5] op_sel:[0,1,1] op_sel_hi:[1,1,1]
  v_pk_fma_f32 v[106:107], v[106:107], v[4:5], v[4:5] op_sel:[0,1,1] op_sel_hi:[1,1,1]
  v_pk_fma_f32 v[108:109], v[108:109], v[4:5], v[4:5] op_sel:[0,1,1] op_sel_hi:[1,1,1]
  v_pk_fma_f32 v[110:111], v[110:111], v[4:5], v[4:5] op_sel:[0,1,1] op_sel_hi:[1,1,1]
  v_rcp_f32 v104, v104
  v_rcp_f32 v105, v105
  v_rcp_f32 v106, v106
  v_rcp_f32 v107, v107
  v_rcp_f32 v108, v108
  v_rcp_f32 v109, v109
  v_rcp_f32 v110, v110
  v_rcp_f32 v111, v111
  v_pk_mul_f32 v[164:165], v[164:165], v[104:105]
  v_pk_mul_f32 v[166:167], v[166:167], v[106:107]
  v_pk_mul_f32 v[180:181], v[180:181], v[108:109]
  v_pk_mul_f32 v[182:183], v[182:183], v[110:111]
  v_cvt_pk_bf16_f32 v120, v164, v165
  v_cvt_pk_bf16_f32 v121, v166, v167
  v_cvt_pk_bf16_f32 v122, v180, v181
  v_cvt_pk_bf16_f32 v123, v182, v183
  buffer_store_dwordx4 v[120:123], v0, s[40:43], s6 offen offset:2048 sc0 sc1
  ds_write_b128 v0, v[120:123] offset:18432
  s_add_u32 s6, s6, 0x20000
  v_pk_fma_f32 v[104:105], v[48:49], v[100:101], v[52:53] op_sel:[0,1,0] op_sel_hi:[1,1,1] neg_lo:[0,1,0] neg_hi:[0,1,0]
  v_pk_fma_f32 v[106:107], v[50:51], v[100:101], v[54:55] op_sel:[0,1,0] op_sel_hi:[1,1,1] neg_lo:[0,1,0] neg_hi:[0,1,0]
  v_pk_fma_f32 v[108:109], v[56:57], v[100:101], v[60:61] op_sel:[0,1,0] op_sel_hi:[1,1,1] neg_lo:[0,1,0] neg_hi:[0,1,0]
  v_pk_fma_f32 v[110:111], v[58:59], v[100:101], v[62:63] op_sel:[0,1,0] op_sel_hi:[1,1,1] neg_lo:[0,1,0] neg_hi:[0,1,0]
  v_pk_fma_f32 v[168:169], v[168:169], v[100:101], v[104:105] op_sel:[0,0,0] op_sel_hi:[1,0,1]
  v_pk_fma_f32 v[170:171], v[170:171], v[100:101], v[106:107] op_sel:[0,0,0] op_sel_hi:[1,0,1]
  v_pk_fma_f32 v[184:185], v[184:185], v[100:101], v[108:109] op_sel:[0,0,0] op_sel_hi:[1,0,1]
  v_pk_fma_f32 v[186:187], v[186:187], v[100:101], v[110:111] op_sel:[0,0,0] op_sel_hi:[1,0,1]
  v_pk_fma_f32 v[104:105], v[168:169], v[168:169], v[4:5] op_sel_hi:[1,1,0]
  v_pk_fma_f32 v[106:107], v[170:171], v[170:171], v[4:5] op_sel_hi:[1,1,0]
  v_pk_fma_f32 v[108:109], v[184:185], v[184:185], v[4:5] op_sel_hi:[1,1,0]
  v_pk_fma_f32 v[110:111], v[186:187], v[186:187], v[4:5] op_sel_hi:[1,1,0]
  v_pk_mul_f32 v[104:105], v[104:105], v[168:169] neg_lo:[0,1] neg_hi:[0,1]
  v_pk_mul_f32 v[106:107], v[106:107], v[170:171] neg_lo:[0,1] neg_hi:[0,1]
  v_pk_mul_f32 v[108:109], v[108:109], v[184:185] neg_lo:[0,1] neg_hi:[0,1]
  v_pk_mul_f32 v[110:111], v[110:111], v[186:187] neg_lo:[0,1] neg_hi:[0,1]
  v_exp_f32 v104, v104
  v_exp_f32 v105, v105
  v_exp_f32 v106, v106
  v_exp_f32 v107, v107
  v_exp_f32 v108, v108
  v_exp_f32 v109, v109
  v_exp_f32 v110, v110
  v_exp_f32 v111, v111
  v_pk_fma_f32 v[104:105], v[104:105], v[4:5], v[4:5] op_sel:[0,1,1] op_sel_hi:[1,1,1]
  v_pk_fma_f32 v[106:107], v[106:107], v[4:5], v[4:5] op_sel:[0,1,1] op_sel_hi:[1,1,1]
  v_pk_fma_f32 v[108:109], v[108:109], v[4:5], v[4:5] op_sel:[0,1,1] op_sel_hi:[1,1,1]
  v_pk_fma_f32 v[110:111], v[110:111], v[4:5], v[4:5] op_sel:[0,1,1] op_sel_hi:[1,1,1]
  v_rcp_f32 v104, v104
  v_rcp_f32 v105, v105
  v_rcp_f32 v106, v106
  v_rcp_f32 v107, v107
  v_rcp_f32 v108, v108
  v_rcp_f32 v109, v109
  v_rcp_f32 v110, v110
  v_rcp_f32 v111, v111
  v_pk_mul_f32 v[168:169], v[168:169], v[104:105]
  v_pk_mul_f32 v[170:171], v[170:171], v[106:107]
  v_pk_mul_f32 v[184:185], v[184:185], v[108:109]
  v_pk_mul_f32 v[186:187], v[186:187], v[110:111]
  v_cvt_pk_bf16_f32 v116, v168, v169
  v_cvt_pk_bf16_f32 v117, v170, v171
  v_cvt_pk_bf16_f32 v118, v184, v185
  v_cvt_pk_bf16_f32 v119, v186, v187
  buffer_store_dwordx4 v[116:119], v0, s[40:43], s7 offen offset:0 sc0 sc1
  ds_write_b128 v0, v[116:119] offset:20480
  v_pk_fma_f32 v[104:105], v[48:49], v[102:103], v[52:53] op_sel:[0,1,0] op_sel_hi:[1,1,1] neg_lo:[0,1,0] neg_hi:[0,1,0]
  v_pk_fma_f32 v[106:107], v[50:51], v[102:103], v[54:55] op_sel:[0,1,0] op_sel_hi:[1,1,1] neg_lo:[0,1,0] neg_hi:[0,1,0]
  v_pk_fma_f32 v[108:109], v[56:57], v[102:103], v[60:61] op_sel:[0,1,0] op_sel_hi:[1,1,1] neg_lo:[0,1,0] neg_hi:[0,1,0]
  v_pk_fma_f32 v[110:111], v[58:59], v[102:103], v[62:63] op_sel:[0,1,0] op_sel_hi:[1,1,1] neg_lo:[0,1,0] neg_hi:[0,1,0]
  v_pk_fma_f32 v[172:173], v[172:173], v[102:103], v[104:105] op_sel:[0,0,0] op_sel_hi:[1,0,1]
  v_pk_fma_f32 v[174:175], v[174:175], v[102:103], v[106:107] op_sel:[0,0,0] op_sel_hi:[1,0,1]
  v_pk_fma_f32 v[188:189], v[188:189], v[102:103], v[108:109] op_sel:[0,0,0] op_sel_hi:[1,0,1]
  v_pk_fma_f32 v[190:191], v[190:191], v[102:103], v[110:111] op_sel:[0,0,0] op_sel_hi:[1,0,1]
  v_pk_fma_f32 v[104:105], v[172:173], v[172:173], v[4:5] op_sel_hi:[1,1,0]
  v_pk_fma_f32 v[106:107], v[174:175], v[174:175], v[4:5] op_sel_hi:[1,1,0]
  v_pk_fma_f32 v[108:109], v[188:189], v[188:189], v[4:5] op_sel_hi:[1,1,0]
  v_pk_fma_f32 v[110:111], v[190:191], v[190:191], v[4:5] op_sel_hi:[1,1,0]
  v_pk_mul_f32 v[104:105], v[104:105], v[172:173] neg_lo:[0,1] neg_hi:[0,1]
  v_pk_mul_f32 v[106:107], v[106:107], v[174:175] neg_lo:[0,1] neg_hi:[0,1]
  v_pk_mul_f32 v[108:109], v[108:109], v[188:189] neg_lo:[0,1] neg_hi:[0,1]
  v_pk_mul_f32 v[110:111], v[110:111], v[190:191] neg_lo:[0,1] neg_hi:[0,1]
  v_exp_f32 v104, v104
  v_exp_f32 v105, v105
  v_exp_f32 v106, v106
  v_exp_f32 v107, v107
  v_exp_f32 v108, v108
  v_exp_f32 v109, v109
  v_exp_f32 v110, v110
  v_exp_f32 v111, v111
  v_pk_fma_f32 v[104:105], v[104:105], v[4:5], v[4:5] op_sel:[0,1,1] op_sel_hi:[1,1,1]
  v_pk_fma_f32 v[106:107], v[106:107], v[4:5], v[4:5] op_sel:[0,1,1] op_sel_hi:[1,1,1]
  v_pk_fma_f32 v[108:109], v[108:109], v[4:5], v[4:5] op_sel:[0,1,1] op_sel_hi:[1,1,1]
  v_pk_fma_f32 v[110:111], v[110:111], v[4:5], v[4:5] op_sel:[0,1,1] op_sel_hi:[1,1,1]
  v_rcp_f32 v104, v104
  v_rcp_f32 v105, v105
  v_rcp_f32 v106, v106
  v_rcp_f32 v107, v107
  v_rcp_f32 v108, v108
  v_rcp_f32 v109, v109
  v_rcp_f32 v110, v110
  v_rcp_f32 v111, v111
  v_pk_mul_f32 v[172:173], v[172:173], v[104:105]
  v_pk_mul_f32 v[174:175], v[174:175], v[106:107]
  v_pk_mul_f32 v[188:189], v[188:189], v[108:109]
  v_pk_mul_f32 v[190:191], v[190:191], v[110:111]
  v_cvt_pk_bf16_f32 v120, v172, v173
  v_cvt_pk_bf16_f32 v121, v174, v175
  v_cvt_pk_bf16_f32 v122, v188, v189
  v_cvt_pk_bf16_f32 v123, v190, v191
  buffer_store_dwordx4 v[120:123], v0, s[40:43], s7 offen offset:2048 sc0 sc1
  ds_write_b128 v0, v[120:123] offset:22528
  s_add_u32 s7, s7, 0x20000
  v_pk_fma_f32 v[104:105], v[64:65], v[96:97], v[68:69] op_sel:[0,1,0] op_sel_hi:[1,1,1] neg_lo:[0,1,0] neg_hi:[0,1,0]
  v_pk_fma_f32 v[106:107], v[66:67], v[96:97], v[70:71] op_sel:[0,1,0] op_sel_hi:[1,1,1] neg_lo:[0,1,0] neg_hi:[0,1,0]
  v_pk_fma_f32 v[108:109], v[72:73], v[96:97], v[76:77] op_sel:[0,1,0] op_sel_hi:[1,1,1] neg_lo:[0,1,0] neg_hi:[0,1,0]
  v_pk_fma_f32 v[110:111], v[74:75], v[96:97], v[78:79] op_sel:[0,1,0] op_sel_hi:[1,1,1] neg_lo:[0,1,0] neg_hi:[0,1,0]
  v_pk_fma_f32 v[192:193], v[192:193], v[96:97], v[104:105] op_sel:[0,0,0] op_sel_hi:[1,0,1]
  v_pk_fma_f32 v[194:195], v[194:195], v[96:97], v[106:107] op_sel:[0,0,0] op_sel_hi:[1,0,1]
  v_pk_fma_f32 v[208:209], v[208:209], v[96:97], v[108:109] op_sel:[0,0,0] op_sel_hi:[1,0,1]
  v_pk_fma_f32 v[210:211], v[210:211], v[96:97], v[110:111] op_sel:[0,0,0] op_sel_hi:[1,0,1]
  v_pk_fma_f32 v[104:105], v[192:193], v[192:193], v[4:5] op_sel_hi:[1,1,0]
  v_pk_fma_f32 v[106:107], v[194:195], v[194:195], v[4:5] op_sel_hi:[1,1,0]
  v_pk_fma_f32 v[108:109], v[208:209], v[208:209], v[4:5] op_sel_hi:[1,1,0]
  v_pk_fma_f32 v[110:111], v[210:211], v[210:211], v[4:5] op_sel_hi:[1,1,0]
  v_pk_mul_f32 v[104:105], v[104:105], v[192:193] neg_lo:[0,1] neg_hi:[0,1]
  v_pk_mul_f32 v[106:107], v[106:107], v[194:195] neg_lo:[0,1] neg_hi:[0,1]
  v_pk_mul_f32 v[108:109], v[108:109], v[208:209] neg_lo:[0,1] neg_hi:[0,1]
  v_pk_mul_f32 v[110:111], v[110:111], v[210:211] neg_lo:[0,1] neg_hi:[0,1]
  v_exp_f32 v104, v104
  v_exp_f32 v105, v105
  v_exp_f32 v106, v106
  v_exp_f32 v107, v107
  v_exp_f32 v108, v108
  v_exp_f32 v109, v109
  v_exp_f32 v110, v110
  v_exp_f32 v111, v111
  v_pk_fma_f32 v[104:105], v[104:105], v[4:5], v[4:5] op_sel:[0,1,1] op_sel_hi:[1,1,1]
  v_pk_fma_f32 v[106:107], v[106:107], v[4:5], v[4:5] op_sel:[0,1,1] op_sel_hi:[1,1,1]
  v_pk_fma_f32 v[108:109], v[108:109], v[4:5], v[4:5] op_sel:[0,1,1] op_sel_hi:[1,1,1]
  v_pk_fma_f32 v[110:111], v[110:111], v[4:5], v[4:5] op_sel:[0,1,1] op_sel_hi:[1,1,1]
  v_rcp_f32 v104, v104
  v_rcp_f32 v105, v105
  v_rcp_f32 v106, v106
  v_rcp_f32 v107, v107
  v_rcp_f32 v108, v108
  v_rcp_f32 v109, v109
  v_rcp_f32 v110, v110
  v_rcp_f32 v111, v111
  v_pk_mul_f32 v[192:193], v[192:193], v[104:105]
  v_pk_mul_f32 v[194:195], v[194:195], v[106:107]
  v_pk_mul_f32 v[208:209], v[208:209], v[108:109]
  v_pk_mul_f32 v[210:211], v[210:211], v[110:111]
  v_cvt_pk_bf16_f32 v116, v192, v193
  v_cvt_pk_bf16_f32 v117, v194, v195
  v_cvt_pk_bf16_f32 v118, v208, v209
  v_cvt_pk_bf16_f32 v119, v210, v211
  buffer_store_dwordx4 v[116:119], v0, s[40:43], s6 offen offset:0 sc0 sc1
  ds_write_b128 v0, v[116:119] offset:32768
  v_pk_fma_f32 v[104:105], v[64:65], v[98:99], v[68:69] op_sel:[0,1,0] op_sel_hi:[1,1,1] neg_lo:[0,1,0] neg_hi:[0,1,0]
  v_pk_fma_f32 v[106:107], v[66:67], v[98:99], v[70:71] op_sel:[0,1,0] op_sel_hi:[1,1,1] neg_lo:[0,1,0] neg_hi:[0,1,0]
  v_pk_fma_f32 v[108:109], v[72:73], v[98:99], v[76:77] op_sel:[0,1,0] op_sel_hi:[1,1,1] neg_lo:[0,1,0] neg_hi:[0,1,0]
  v_pk_fma_f32 v[110:111], v[74:75], v[98:99], v[78:79] op_sel:[0,1,0] op_sel_hi:[1,1,1] neg_lo:[0,1,0] neg_hi:[0,1,0]
  v_pk_fma_f32 v[196:197], v[196:197], v[98:99], v[104:105] op_sel:[0,0,0] op_sel_hi:[1,0,1]
  v_pk_fma_f32 v[198:199], v[198:199], v[98:99], v[106:107] op_sel:[0,0,0] op_sel_hi:[1,0,1]
  v_pk_fma_f32 v[212:213], v[212:213], v[98:99], v[108:109] op_sel:[0,0,0] op_sel_hi:[1,0,1]
  v_pk_fma_f32 v[214:215], v[214:215], v[98:99], v[110:111] op_sel:[0,0,0] op_sel_hi:[1,0,1]
  v_pk_fma_f32 v[104:105], v[196:197], v[196:197], v[4:5] op_sel_hi:[1,1,0]
  v_pk_fma_f32 v[106:107], v[198:199], v[198:199], v[4:5] op_sel_hi:[1,1,0]
  v_pk_fma_f32 v[108:109], v[212:213], v[212:213], v[4:5] op_sel_hi:[1,1,0]
  v_pk_fma_f32 v[110:111], v[214:215], v[214:215], v[4:5] op_sel_hi:[1,1,0]
  v_pk_mul_f32 v[104:105], v[104:105], v[196:197] neg_lo:[0,1] neg_hi:[0,1]
  v_pk_mul_f32 v[106:107], v[106:107], v[198:199] neg_lo:[0,1] neg_hi:[0,1]
  v_pk_mul_f32 v[108:109], v[108:109], v[212:213] neg_lo:[0,1] neg_hi:[0,1]
  v_pk_mul_f32 v[110:111], v[110:111], v[214:215] neg_lo:[0,1] neg_hi:[0,1]
  v_exp_f32 v104, v104
  v_exp_f32 v105, v105
  v_exp_f32 v106, v106
  v_exp_f32 v107, v107
  v_exp_f32 v108, v108
  v_exp_f32 v109, v109
  v_exp_f32 v110, v110
  v_exp_f32 v111, v111
  v_pk_fma_f32 v[104:105], v[104:105], v[4:5], v[4:5] op_sel:[0,1,1] op_sel_hi:[1,1,1]
  v_pk_fma_f32 v[106:107], v[106:107], v[4:5], v[4:5] op_sel:[0,1,1] op_sel_hi:[1,1,1]
  v_pk_fma_f32 v[108:109], v[108:109], v[4:5], v[4:5] op_sel:[0,1,1] op_sel_hi:[1,1,1]
  v_pk_fma_f32 v[110:111], v[110:111], v[4:5], v[4:5] op_sel:[0,1,1] op_sel_hi:[1,1,1]
  v_rcp_f32 v104, v104
  v_rcp_f32 v105, v105
  v_rcp_f32 v106, v106
  v_rcp_f32 v107, v107
  v_rcp_f32 v108, v108
  v_rcp_f32 v109, v109
  v_rcp_f32 v110, v110
  v_rcp_f32 v111, v111
  v_pk_mul_f32 v[196:197], v[196:197], v[104:105]
  v_pk_mul_f32 v[198:199], v[198:199], v[106:107]
  v_pk_mul_f32 v[212:213], v[212:213], v[108:109]
  v_pk_mul_f32 v[214:215], v[214:215], v[110:111]
  v_cvt_pk_bf16_f32 v120, v196, v197
  v_cvt_pk_bf16_f32 v121, v198, v199
  v_cvt_pk_bf16_f32 v122, v212, v213
  v_cvt_pk_bf16_f32 v123, v214, v215
  buffer_store_dwordx4 v[120:123], v0, s[40:43], s6 offen offset:2048 sc0 sc1
  ds_write_b128 v0, v[120:123] offset:34816
  v_pk_fma_f32 v[104:105], v[64:65], v[100:101], v[68:69] op_sel:[0,1,0] op_sel_hi:[1,1,1] neg_lo:[0,1,0] neg_hi:[0,1,0]
  v_pk_fma_f32 v[106:107], v[66:67], v[100:101], v[70:71] op_sel:[0,1,0] op_sel_hi:[1,1,1] neg_lo:[0,1,0] neg_hi:[0,1,0]
  v_pk_fma_f32 v[108:109], v[72:73], v[100:101], v[76:77] op_sel:[0,1,0] op_sel_hi:[1,1,1] neg_lo:[0,1,0] neg_hi:[0,1,0]
  v_pk_fma_f32 v[110:111], v[74:75], v[100:101], v[78:79] op_sel:[0,1,0] op_sel_hi:[1,1,1] neg_lo:[0,1,0] neg_hi:[0,1,0]
  v_pk_fma_f32 v[200:201], v[200:201], v[100:101], v[104:105] op_sel:[0,0,0] op_sel_hi:[1,0,1]
  v_pk_fma_f32 v[202:203], v[202:203], v[100:101], v[106:107] op_sel:[0,0,0] op_sel_hi:[1,0,1]
  v_pk_fma_f32 v[216:217], v[216:217], v[100:101], v[108:109] op_sel:[0,0,0] op_sel_hi:[1,0,1]
  v_pk_fma_f32 v[218:219], v[218:219], v[100:101], v[110:111] op_sel:[0,0,0] op_sel_hi:[1,0,1]
  v_pk_fma_f32 v[104:105], v[200:201], v[200:201], v[4:5] op_sel_hi:[1,1,0]
  v_pk_fma_f32 v[106:107], v[202:203], v[202:203], v[4:5] op_sel_hi:[1,1,0]
  v_pk_fma_f32 v[108:109], v[216:217], v[216:217], v[4:5] op_sel_hi:[1,1,0]
  v_pk_fma_f32 v[110:111], v[218:219], v[218:219], v[4:5] op_sel_hi:[1,1,0]
  v_pk_mul_f32 v[104:105], v[104:105], v[200:201] neg_lo:[0,1] neg_hi:[0,1]
  v_pk_mul_f32 v[106:107], v[106:107], v[202:203] neg_lo:[0,1] neg_hi:[0,1]
  v_pk_mul_f32 v[108:109], v[108:109], v[216:217] neg_lo:[0,1] neg_hi:[0,1]
  v_pk_mul_f32 v[110:111], v[110:111], v[218:219] neg_lo:[0,1] neg_hi:[0,1]
  v_exp_f32 v104, v104
  v_exp_f32 v105, v105
  v_exp_f32 v106, v106
  v_exp_f32 v107, v107
  v_exp_f32 v108, v108
  v_exp_f32 v109, v109
  v_exp_f32 v110, v110
  v_exp_f32 v111, v111
  v_pk_fma_f32 v[104:105], v[104:105], v[4:5], v[4:5] op_sel:[0,1,1] op_sel_hi:[1,1,1]
  v_pk_fma_f32 v[106:107], v[106:107], v[4:5], v[4:5] op_sel:[0,1,1] op_sel_hi:[1,1,1]
  v_pk_fma_f32 v[108:109], v[108:109], v[4:5], v[4:5] op_sel:[0,1,1] op_sel_hi:[1,1,1]
  v_pk_fma_f32 v[110:111], v[110:111], v[4:5], v[4:5] op_sel:[0,1,1] op_sel_hi:[1,1,1]
  v_rcp_f32 v104, v104
  v_rcp_f32 v105, v105
  v_rcp_f32 v106, v106
  v_rcp_f32 v107, v107
  v_rcp_f32 v108, v108
  v_rcp_f32 v109, v109
  v_rcp_f32 v110, v110
  v_rcp_f32 v111, v111
  v_pk_mul_f32 v[200:201], v[200:201], v[104:105]
  v_pk_mul_f32 v[202:203], v[202:203], v[106:107]
  v_pk_mul_f32 v[216:217], v[216:217], v[108:109]
  v_pk_mul_f32 v[218:219], v[218:219], v[110:111]
  v_cvt_pk_bf16_f32 v116, v200, v201
  v_cvt_pk_bf16_f32 v117, v202, v203
  v_cvt_pk_bf16_f32 v118, v216, v217
  v_cvt_pk_bf16_f32 v119, v218, v219
  buffer_store_dwordx4 v[116:119], v0, s[40:43], s7 offen offset:0 sc0 sc1
  ds_write_b128 v0, v[116:119] offset:36864
  s_lshl_b32 s5, s86, Lz1-Lz0+7
  s_add_u32 s5, s5, 156160
  v_add_u32_e64 v3, s5, v29
  ds_read_b128 v[232:235], v3
  ds_read_b128 v[236:239], v3 offset:64
  v_pk_fma_f32 v[104:105], v[64:65], v[102:103], v[68:69] op_sel:[0,1,0] op_sel_hi:[1,1,1] neg_lo:[0,1,0] neg_hi:[0,1,0]
  v_pk_fma_f32 v[106:107], v[66:67], v[102:103], v[70:71] op_sel:[0,1,0] op_sel_hi:[1,1,1] neg_lo:[0,1,0] neg_hi:[0,1,0]
  v_pk_fma_f32 v[108:109], v[72:73], v[102:103], v[76:77] op_sel:[0,1,0] op_sel_hi:[1,1,1] neg_lo:[0,1,0] neg_hi:[0,1,0]
  v_pk_fma_f32 v[110:111], v[74:75], v[102:103], v[78:79] op_sel:[0,1,0] op_sel_hi:[1,1,1] neg_lo:[0,1,0] neg_hi:[0,1,0]
  v_pk_fma_f32 v[204:205], v[204:205], v[102:103], v[104:105] op_sel:[0,0,0] op_sel_hi:[1,0,1]
  v_pk_fma_f32 v[206:207], v[206:207], v[102:103], v[106:107] op_sel:[0,0,0] op_sel_hi:[1,0,1]
  v_pk_fma_f32 v[220:221], v[220:221], v[102:103], v[108:109] op_sel:[0,0,0] op_sel_hi:[1,0,1]
  v_pk_fma_f32 v[222:223], v[222:223], v[102:103], v[110:111] op_sel:[0,0,0] op_sel_hi:[1,0,1]
  v_pk_fma_f32 v[104:105], v[204:205], v[204:205], v[4:5] op_sel_hi:[1,1,0]
  v_pk_fma_f32 v[106:107], v[206:207], v[206:207], v[4:5] op_sel_hi:[1,1,0]
  v_pk_fma_f32 v[108:109], v[220:221], v[220:221], v[4:5] op_sel_hi:[1,1,0]
  v_pk_fma_f32 v[110:111], v[222:223], v[222:223], v[4:5] op_sel_hi:[1,1,0]
  v_pk_mul_f32 v[104:105], v[104:105], v[204:205] neg_lo:[0,1] neg_hi:[0,1]
  v_pk_mul_f32 v[106:107], v[106:107], v[206:207] neg_lo:[0,1] neg_hi:[0,1]
  v_pk_mul_f32 v[108:109], v[108:109], v[220:221] neg_lo:[0,1] neg_hi:[0,1]
  v_pk_mul_f32 v[110:111], v[110:111], v[222:223] neg_lo:[0,1] neg_hi:[0,1]
  v_exp_f32 v104, v104
  v_exp_f32 v105, v105
  v_exp_f32 v106, v106
  v_exp_f32 v107, v107
  v_exp_f32 v108, v108
  v_exp_f32 v109, v109
  v_exp_f32 v110, v110
  v_exp_f32 v111, v111
  v_pk_fma_f32 v[104:105], v[104:105], v[4:5], v[4:5] op_sel:[0,1,1] op_sel_hi:[1,1,1]
  v_pk_fma_f32 v[106:107], v[106:107], v[4:5], v[4:5] op_sel:[0,1,1] op_sel_hi:[1,1,1]
  v_pk_fma_f32 v[108:109], v[108:109], v[4:5], v[4:5] op_sel:[0,1,1] op_sel_hi:[1,1,1]
  v_pk_fma_f32 v[110:111], v[110:111], v[4:5], v[4:5] op_sel:[0,1,1] op_sel_hi:[1,1,1]
  v_rcp_f32 v104, v104
  v_rcp_f32 v105, v105
  v_rcp_f32 v106, v106
  v_rcp_f32 v107, v107
  v_rcp_f32 v108, v108
  v_rcp_f32 v109, v109
  v_rcp_f32 v110, v110
  v_rcp_f32 v111, v111
  v_pk_mul_f32 v[204:205], v[204:205], v[104:105]
  v_pk_mul_f32 v[206:207], v[206:207], v[106:107]
  v_pk_mul_f32 v[220:221], v[220:221], v[108:109]
  v_pk_mul_f32 v[222:223], v[222:223], v[110:111]
  v_cvt_pk_bf16_f32 v120, v204, v205
  v_cvt_pk_bf16_f32 v121, v206, v207
  v_cvt_pk_bf16_f32 v122, v220, v221
  v_cvt_pk_bf16_f32 v123, v222, v223
  buffer_store_dwordx4 v[120:123], v0, s[40:43], s7 offen offset:2048 sc0 sc1
  ds_write_b128 v0, v[120:123] offset:38912
  s_mov_b32 s16, Lz1-Lz0+0
  s_mov_b32 s17, 16384
  s_mov_b32 s18, 0xffff4000
  s_mov_b32 s19, 49152
  s_mov_b32 s20, 16384
  s_mov_b32 s21, 0xffff0000
  s_mul_i32 s4, s85, 8192
  v_add_u32_e64 v4, s4, v11
  v_add_u32 v5, 1024, v4
  s_lshl_b32 s4, s86, 1
  v_xor_b32 v2, s4, v26
  v_lshl_add_u32 v6, v2, 5, v25
  v_add_u32 v6, s19, v6
  s_add_u32 s4, s4, 1
  v_xor_b32_e64 v2, s4, v26
  v_lshl_add_u32 v7, v2, 5, v25
  v_add_u32 v7, s19, v7
  s_mov_b32 s22, 12
  s_waitcnt lgkmcnt(0)
  s_barrier
  ds_read_b64_tr_b16 v[48:49], v6 offset:0
  v_and_b32 v2, 15, v1
  v_lshrrev_b32 v3, 2, v29
  ds_read_b64_tr_b16 v[50:51], v6 offset:2048
  v_sub_u32 v2, v2, v3
  v_mov_b64 v[224:225], 0
  ds_read_b128 v[32:35], v4 offset:0
  v_lshlrev_b32_e64 v2, 4, v2
  v_mov_b32 v226, 0x3f80
  ds_read_b128 v[36:39], v4 offset:2048
  v_cmp_gt_u32 vcc, 64, v2
  v_mov_b32 v227, 0
  ds_read_b128 v[40:43], v4 offset:4096
  v_cndmask_b32 v226, 0, v226, vcc
  v_mov_b64 v[228:229], 0
  ds_read_b128 v[44:47], v4 offset:6144
  v_lshlrev_b64 v[226:227], v2, v[226:227]
  v_mov_b64_e64 v[160:161], 0
  ds_read_b64_tr_b16 v[52:53], v7 offset:0
  v_mov_b64 v[162:163], 0
  v_mov_b64 v[164:165], 0
  ds_read_b64_tr_b16 v[54:55], v7 offset:2048
  v_mov_b64 v[166:167], 0
  v_mov_b64 v[168:169], 0
  ds_read_b64_tr_b16 v[56:57], v6 offset:8192
  v_mov_b64 v[170:171], 0
  v_mov_b64 v[172:173], 0
  ds_read_b64_tr_b16 v[58:59], v6 offset:10240
  v_mov_b64 v[174:175], 0
  v_mov_b64 v[176:177], 0
  ds_read_b64_tr_b16 v[60:61], v7 offset:8192
  v_mov_b64 v[178:179], 0
  v_mov_b64 v[180:181], 0
  ds_read_b64_tr_b16 v[62:63], v7 offset:10240
  v_mov_b64 v[182:183], 0
  v_mov_b64 v[184:185], 0
  ds_read_b64_tr_b16 v[80:81], v6 offset:4096
  v_mov_b64_e64 v[186:187], 0
  v_mov_b64 v[188:189], 0
  s_waitcnt lgkmcnt(4)
  ds_read_b64_tr_b16 v[82:83], v6 offset:6144
  v_mov_b64_e64 v[190:191], 0
  v_mfma_f32_16x16x32_bf16 v[128:131], v[226:229], v[240:243], v[232:235]
  ds_read_b128 v[64:67], v5 offset:0
  s_lshl_b32 s4, s76, 4
  s_add_u32 s4, s4, s78
  ds_read_b128 v[68:71], v5 offset:2048
  v_mfma_f32_16x16x32_bf16 v[132:135], v[224:227], v[240:243], v[236:239]
  s_lshl_b32 s8, s4, Lz1-Lz0+14
  ds_read_b128 v[72:75], v5 offset:4096
  s_xor_b32 s6, s8, 16384
  v_mfma_f32_16x16x32_bf16 v[136:139], v[226:229], v[244:247], v[232:235]
  ds_read_b128 v[76:79], v5 offset:6144
  s_add_u32 s8, s8, 7340032
  s_add_u32 s6, s6, 7340032
  ds_read_b64_tr_b16 v[84:85], v7 offset:4096
  v_mfma_f32_16x16x32_bf16 v[140:143], v[224:227], v[244:247], v[236:239]
  s_add_u32 s7, s6, 4096
  ds_read_b64_tr_b16 v[86:87], v7 offset:6144
  s_add_u32 s9, s8, 4096
  v_mfma_f32_16x16x32_bf16 v[144:147], v[226:229], v[248:251], v[232:235]
  ds_read_b64_tr_b16 v[88:89], v6 offset:12288
  s_lshl_b32 s4, s81, 7
  s_add_u32 s4, s4, s87
  ds_read_b64_tr_b16 v[90:91], v6 offset:14336
  v_mfma_f32_16x16x32_bf16 v[148:151], v[224:227], v[248:251], v[236:239]
  s_add_u32 s4, s4, Lz1-Lz0+12
  ds_read_b64_tr_b16 v[92:93], v7 offset:12288
  s_lshl_b32 s13, s84, Lz1-Lz0+1
  v_mfma_f32_16x16x32_bf16 v[152:155], v[226:229], v[252:255], v[232:235]
  ds_read_b64_tr_b16 v[94:95], v7 offset:14336
  s_xor_b32 s14, s13, 32768
  s_nop 0
  s_add_u32 s13, s13, s4
  v_mfma_f32_16x16x32_bf16 v[156:159], v[224:227], v[252:255], v[236:239]
  s_add_u32 s14, s14, s4
  s_add_u32 s16, s16, s17
  s_cmp_eq_u32 s16, 65536
  s_cselect_b32 s23, s18, s17
  s_cselect_b32 s16, 0, s16
  v_add_u32_e64 v4, s23, v4
  v_add_u32 v5, s23, v5
  s_add_u32 s19, s19, s20
  s_cmp_eq_u32 s19, 81920
  s_cselect_b32 s23, s21, s20
  s_cselect_b32 s19, 0, s19
  v_add_u32 v6, s23, v6
  v_add_u32 v7, s23, v7
  s_waitcnt lgkmcnt(0)
Lk_28:
  s_barrier
  v_mfma_f32_16x16x32_bf16 v[128:131], v[48:51], v[32:35], v[128:131]
  ds_read_b64_tr_b16 v[112:113], v6 offset:0
  v_mfma_f32_16x16x32_bf16 v[128:131], v[80:83], v[64:67], v[128:131]
  ds_read_b64_tr_b16 v[114:115], v6 offset:2048
  v_mfma_f32_16x16x32_bf16 v[136:139], v[80:83], v[68:71], v[136:139]
  ds_read_b128 v[96:99], v4 offset:0
  v_mfma_f32_16x16x32_bf16 v[136:139], v[48:51], v[36:39], v[136:139]
  ds_read_b128 v[100:103], v4 offset:2048
  v_mfma_f32_16x16x32_bf16 v[144:147], v[48:51], v[40:43], v[144:147]
  ds_read_b128 v[104:107], v4 offset:4096
  v_mfma_f32_16x16x32_bf16 v[144:147], v[80:83], v[72:75], v[144:147]
  ds_read_b128 v[108:111], v4 offset:6144
  v_mfma_f32_16x16x32_bf16 v[152:155], v[80:83], v[76:79], v[152:155]
  ds_read_b64_tr_b16 v[116:117], v7 offset:0
  v_mfma_f32_16x16x32_bf16 v[152:155], v[48:51], v[44:47], v[152:155]
  ds_read_b64_tr_b16 v[118:119], v7 offset:2048
  v_mfma_f32_16x16x32_bf16 v[156:159], v[52:55], v[44:47], v[156:159]
  ds_read_b64_tr_b16 v[120:121], v6 offset:8192
  v_mfma_f32_16x16x32_bf16 v[156:159], v[84:87], v[76:79], v[156:159]
  ds_read_b64_tr_b16 v[122:123], v6 offset:10240
  v_mfma_f32_16x16x32_bf16 v[148:151], v[84:87], v[72:75], v[148:151]
  ds_read_b64_tr_b16 v[124:125], v7 offset:8192
  v_mfma_f32_16x16x32_bf16 v[148:151], v[52:55], v[40:43], v[148:151]
  ds_read_b64_tr_b16 v[126:127], v7 offset:10240
  v_mfma_f32_16x16x32_bf16 v[140:143], v[52:55], v[36:39], v[140:143]
  ds_read_b64_tr_b16 v[208:209], v6 offset:4096
  v_mfma_f32_16x16x32_bf16 v[140:143], v[84:87], v[68:71], v[140:143]
  ds_read_b64_tr_b16 v[210:211], v6 offset:6144
  v_mfma_f32_16x16x32_bf16 v[132:135], v[84:87], v[64:67], v[132:135]
  ds_read_b128 v[192:195], v5 offset:0
  v_mfma_f32_16x16x32_bf16 v[132:135], v[52:55], v[32:35], v[132:135]
  ds_read_b128 v[196:199], v5 offset:2048
  v_mfma_f32_16x16x32_bf16 v[160:163], v[56:59], v[32:35], v[160:163]
  ds_read_b128 v[200:203], v5 offset:4096
  v_mfma_f32_16x16x32_bf16 v[160:163], v[88:91], v[64:67], v[160:163]
  ds_read_b128 v[204:207], v5 offset:6144
  v_mfma_f32_16x16x32_bf16 v[168:171], v[88:91], v[68:71], v[168:171]
  ds_read_b64_tr_b16 v[212:213], v7 offset:4096
  v_mfma_f32_16x16x32_bf16 v[168:171], v[56:59], v[36:39], v[168:171]
  ds_read_b64_tr_b16 v[214:215], v7 offset:6144
  v_mfma_f32_16x16x32_bf16 v[176:179], v[56:59], v[40:43], v[176:179]
  ds_read_b64_tr_b16 v[216:217], v6 offset:12288
  v_mfma_f32_16x16x32_bf16 v[176:179], v[88:91], v[72:75], v[176:179]
  ds_read_b64_tr_b16 v[218:219], v6 offset:14336
  v_mfma_f32_16x16x32_bf16 v[184:187], v[88:91], v[76:79], v[184:187]
  ds_read_b64_tr_b16 v[220:221], v7 offset:12288
  v_mfma_f32_16x16x32_bf16 v[184:187], v[56:59], v[44:47], v[184:187]
  ds_read_b64_tr_b16 v[222:223], v7 offset:14336
  v_mfma_f32_16x16x32_bf16 v[188:191], v[60:63], v[44:47], v[188:191]
  s_add_u32 s16, s16, s17
  s_cmp_eq_u32 s16, 65536
  s_cselect_b32 s23, s18, s17
  v_mfma_f32_16x16x32_bf16 v[188:191], v[92:95], v[76:79], v[188:191]
  s_cselect_b32 s16, 0, s16
  v_add_u32 v4, s23, v4
  v_add_u32_e64 v5, s23, v5
  v_mfma_f32_16x16x32_bf16 v[180:183], v[92:95], v[72:75], v[180:183]
  s_add_u32 s19, s19, s20
  s_cmp_eq_u32 s19, 81920
  s_cselect_b32 s23, s21, s20
  v_mfma_f32_16x16x32_bf16 v[180:183], v[60:63], v[40:43], v[180:183]
  s_cselect_b32 s19, 0, s19
  v_add_u32 v6, s23, v6
  v_add_u32_e64 v7, s23, v7
  v_mfma_f32_16x16x32_bf16 v[172:175], v[60:63], v[36:39], v[172:175]
  v_mfma_f32_16x16x32_bf16 v[172:175], v[92:95], v[68:71], v[172:175]
  v_mfma_f32_16x16x32_bf16 v[164:167], v[92:95], v[64:67], v[164:167]
  s_nop 0
  s_waitcnt lgkmcnt(0)
  v_mfma_f32_16x16x32_bf16 v[164:167], v[60:63], v[32:35], v[164:167]
  s_waitcnt vmcnt(0)
  s_barrier
  v_mfma_f32_16x16x32_bf16 v[128:131], v[112:115], v[96:99], v[128:131]
  ds_read_b64_tr_b16 v[48:49], v6 offset:0
  v_mfma_f32_16x16x32_bf16 v[128:131], v[208:211], v[192:195], v[128:131]
  ds_read_b64_tr_b16 v[50:51], v6 offset:2048
  v_mfma_f32_16x16x32_bf16 v[136:139], v[208:211], v[196:199], v[136:139]
  ds_read_b128 v[32:35], v4 offset:0
  v_mfma_f32_16x16x32_bf16 v[136:139], v[112:115], v[100:103], v[136:139]
  ds_read_b128 v[36:39], v4 offset:2048
  v_mfma_f32_16x16x32_bf16 v[144:147], v[112:115], v[104:107], v[144:147]
  ds_read_b128 v[40:43], v4 offset:4096
  v_mfma_f32_16x16x32_bf16 v[144:147], v[208:211], v[200:203], v[144:147]
  ds_read_b128 v[44:47], v4 offset:6144
  v_mfma_f32_16x16x32_bf16 v[152:155], v[208:211], v[204:207], v[152:155]
  ds_read_b64_tr_b16 v[52:53], v7 offset:0
  v_mfma_f32_16x16x32_bf16 v[152:155], v[112:115], v[108:111], v[152:155]
  ds_read_b64_tr_b16 v[54:55], v7 offset:2048
  v_mfma_f32_16x16x32_bf16 v[156:159], v[116:119], v[108:111], v[156:159]
  ds_read_b64_tr_b16 v[56:57], v6 offset:8192
  v_mfma_f32_16x16x32_bf16 v[156:159], v[212:215], v[204:207], v[156:159]
  ds_read_b64_tr_b16 v[58:59], v6 offset:10240
  v_mfma_f32_16x16x32_bf16 v[148:151], v[212:215], v[200:203], v[148:151]
  ds_read_b64_tr_b16 v[60:61], v7 offset:8192
  v_mfma_f32_16x16x32_bf16 v[148:151], v[116:119], v[104:107], v[148:151]
  ds_read_b64_tr_b16 v[62:63], v7 offset:10240
  v_mfma_f32_16x16x32_bf16 v[140:143], v[116:119], v[100:103], v[140:143]
  ds_read_b64_tr_b16 v[80:81], v6 offset:4096
  v_mfma_f32_16x16x32_bf16 v[140:143], v[212:215], v[196:199], v[140:143]
  ds_read_b64_tr_b16 v[82:83], v6 offset:6144
  v_mfma_f32_16x16x32_bf16 v[132:135], v[212:215], v[192:195], v[132:135]
  ds_read_b128 v[64:67], v5 offset:0
  v_mfma_f32_16x16x32_bf16 v[132:135], v[116:119], v[96:99], v[132:135]
  ds_read_b128 v[68:71], v5 offset:2048
  v_mfma_f32_16x16x32_bf16 v[160:163], v[120:123], v[96:99], v[160:163]
  ds_read_b128 v[72:75], v5 offset:4096
  v_mfma_f32_16x16x32_bf16 v[160:163], v[216:219], v[192:195], v[160:163]
  ds_read_b128 v[76:79], v5 offset:6144
  v_mfma_f32_16x16x32_bf16 v[168:171], v[216:219], v[196:199], v[168:171]
  ds_read_b64_tr_b16 v[84:85], v7 offset:4096
  v_mfma_f32_16x16x32_bf16 v[168:171], v[120:123], v[100:103], v[168:171]
  ds_read_b64_tr_b16 v[86:87], v7 offset:6144
  v_mfma_f32_16x16x32_bf16 v[176:179], v[120:123], v[104:107], v[176:179]
  ds_read_b64_tr_b16 v[88:89], v6 offset:12288
  v_mfma_f32_16x16x32_bf16 v[176:179], v[216:219], v[200:203], v[176:179]
  ds_read_b64_tr_b16 v[90:91], v6 offset:14336
  v_mfma_f32_16x16x32_bf16 v[184:187], v[216:219], v[204:207], v[184:187]
  ds_read_b64_tr_b16 v[92:93], v7 offset:12288
  v_mfma_f32_16x16x32_bf16 v[184:187], v[120:123], v[108:111], v[184:187]
  ds_read_b64_tr_b16 v[94:95], v7 offset:14336
  v_mfma_f32_16x16x32_bf16 v[188:191], v[124:127], v[108:111], v[188:191]
  s_add_u32 s16, s16, s17
  s_cmp_eq_u32 s16, 65536
  s_cselect_b32 s23, s18, s17
  v_mfma_f32_16x16x32_bf16 v[188:191], v[220:223], v[204:207], v[188:191]
  s_cselect_b32 s16, 0, s16
  v_add_u32 v4, s23, v4
  v_add_u32_e64 v5, s23, v5
  v_mfma_f32_16x16x32_bf16 v[180:183], v[220:223], v[200:203], v[180:183]
  s_add_u32 s19, s19, s20
  s_cmp_eq_u32 s19, 81920
  s_cselect_b32 s23, s21, s20
  v_mfma_f32_16x16x32_bf16 v[180:183], v[124:127], v[104:107], v[180:183]
  s_cselect_b32 s19, 0, s19
  v_add_u32 v6, s23, v6
  v_add_u32_e64 v7, s23, v7
  v_mfma_f32_16x16x32_bf16 v[172:175], v[124:127], v[100:103], v[172:175]
  s_sub_u32 s22, s22, 1
  s_cmp_lg_u32 s22, 0
  v_mfma_f32_16x16x32_bf16 v[172:175], v[220:223], v[196:199], v[172:175]
  v_mfma_f32_16x16x32_bf16 v[164:167], v[220:223], v[192:195], v[164:167]
  s_nop 0
  s_waitcnt lgkmcnt(0)
  v_mfma_f32_16x16x32_bf16 v[164:167], v[124:127], v[96:99], v[164:167]
  s_cbranch_scc1 Lk_28
  s_barrier
  v_mfma_f32_16x16x32_bf16 v[128:131], v[48:51], v[32:35], v[128:131]
  ds_read_b64_tr_b16 v[112:113], v6 offset:0
  v_mfma_f32_16x16x32_bf16 v[128:131], v[80:83], v[64:67], v[128:131]
  ds_read_b64_tr_b16 v[114:115], v6 offset:2048
  v_mfma_f32_16x16x32_bf16 v[136:139], v[80:83], v[68:71], v[136:139]
  ds_read_b128 v[96:99], v4 offset:0
  v_mfma_f32_16x16x32_bf16 v[136:139], v[48:51], v[36:39], v[136:139]
  ds_read_b128 v[100:103], v4 offset:2048
  v_mfma_f32_16x16x32_bf16 v[144:147], v[48:51], v[40:43], v[144:147]
  ds_read_b128 v[104:107], v4 offset:4096
  v_mfma_f32_16x16x32_bf16 v[144:147], v[80:83], v[72:75], v[144:147]
  ds_read_b128 v[108:111], v4 offset:6144
  v_mfma_f32_16x16x32_bf16 v[152:155], v[80:83], v[76:79], v[152:155]
  ds_read_b64_tr_b16 v[116:117], v7 offset:0
  v_mfma_f32_16x16x32_bf16 v[152:155], v[48:51], v[44:47], v[152:155]
  ds_read_b64_tr_b16 v[118:119], v7 offset:2048
  v_mfma_f32_16x16x32_bf16 v[156:159], v[52:55], v[44:47], v[156:159]
  ds_read_b64_tr_b16 v[120:121], v6 offset:8192
  v_mfma_f32_16x16x32_bf16 v[156:159], v[84:87], v[76:79], v[156:159]
  ds_read_b64_tr_b16 v[122:123], v6 offset:10240
  v_mfma_f32_16x16x32_bf16 v[148:151], v[84:87], v[72:75], v[148:151]
  ds_read_b64_tr_b16 v[124:125], v7 offset:8192
  v_mfma_f32_16x16x32_bf16 v[148:151], v[52:55], v[40:43], v[148:151]
  ds_read_b64_tr_b16 v[126:127], v7 offset:10240
  v_mfma_f32_16x16x32_bf16 v[140:143], v[52:55], v[36:39], v[140:143]
  ds_read_b64_tr_b16 v[208:209], v6 offset:4096
  v_mfma_f32_16x16x32_bf16 v[140:143], v[84:87], v[68:71], v[140:143]
  ds_read_b64_tr_b16 v[210:211], v6 offset:6144
  v_mfma_f32_16x16x32_bf16 v[132:135], v[84:87], v[64:67], v[132:135]
  ds_read_b128 v[192:195], v5 offset:0
  v_mfma_f32_16x16x32_bf16 v[132:135], v[52:55], v[32:35], v[132:135]
  ds_read_b128 v[196:199], v5 offset:2048
  v_mfma_f32_16x16x32_bf16 v[160:163], v[56:59], v[32:35], v[160:163]
  ds_read_b128 v[200:203], v5 offset:4096
  v_mfma_f32_16x16x32_bf16 v[160:163], v[88:91], v[64:67], v[160:163]
  ds_read_b128 v[204:207], v5 offset:6144
  v_mfma_f32_16x16x32_bf16 v[168:171], v[88:91], v[68:71], v[168:171]
  ds_read_b64_tr_b16 v[212:213], v7 offset:4096
  v_mfma_f32_16x16x32_bf16 v[168:171], v[56:59], v[36:39], v[168:171]
  ds_read_b64_tr_b16 v[214:215], v7 offset:6144
  v_mfma_f32_16x16x32_bf16 v[176:179], v[56:59], v[40:43], v[176:179]
  ds_read_b64_tr_b16 v[216:217], v6 offset:12288
  v_mfma_f32_16x16x32_bf16 v[176:179], v[88:91], v[72:75], v[176:179]
  ds_read_b64_tr_b16 v[218:219], v6 offset:14336
  v_mfma_f32_16x16x32_bf16 v[184:187], v[88:91], v[76:79], v[184:187]
  ds_read_b64_tr_b16 v[220:221], v7 offset:12288
  v_mfma_f32_16x16x32_bf16 v[184:187], v[56:59], v[44:47], v[184:187]
  ds_read_b64_tr_b16 v[222:223], v7 offset:14336
  v_mfma_f32_16x16x32_bf16 v[188:191], v[60:63], v[44:47], v[188:191]
  s_add_u32 s16, s16, s17
  s_cmp_eq_u32 s16, 65536
  s_cselect_b32 s23, s18, s17
  v_mfma_f32_16x16x32_bf16 v[188:191], v[92:95], v[76:79], v[188:191]
  s_cselect_b32 s16, 0, s16
  v_add_u32 v4, s23, v4
  v_add_u32_e64 v5, s23, v5
  v_mfma_f32_16x16x32_bf16 v[180:183], v[92:95], v[72:75], v[180:183]
  s_add_u32 s19, s19, s20
  s_cmp_eq_u32 s19, 81920
  s_cselect_b32 s23, s21, s20
  v_mfma_f32_16x16x32_bf16 v[180:183], v[60:63], v[40:43], v[180:183]
  s_cselect_b32 s19, 0, s19
  v_add_u32 v6, s23, v6
  v_add_u32_e64 v7, s23, v7
  v_mfma_f32_16x16x32_bf16 v[172:175], v[60:63], v[36:39], v[172:175]
  v_mfma_f32_16x16x32_bf16 v[172:175], v[92:95], v[68:71], v[172:175]
  v_mfma_f32_16x16x32_bf16 v[164:167], v[92:95], v[64:67], v[164:167]
  s_waitcnt lgkmcnt(0)
  v_mfma_f32_16x16x32_bf16 v[164:167], v[60:63], v[32:35], v[164:167]
  s_barrier
  v_mfma_f32_16x16x32_bf16 v[160:163], v[120:123], v[96:99], v[160:163]
  ds_read_b64_tr_b16 v[48:49], v6 offset:0
  ds_read_b64_tr_b16 v[50:51], v6 offset:2048
  v_mfma_f32_16x16x32_bf16 v[160:163], v[216:219], v[192:195], v[160:163]
  ds_read_b128 v[32:35], v4 offset:0
  ds_read_b128 v[36:39], v4 offset:2048
  v_mfma_f32_16x16x32_bf16 v[164:167], v[220:223], v[192:195], v[164:167]
  ds_read_b128 v[40:43], v4 offset:4096
  ds_read_b128 v[44:47], v4 offset:6144
  v_mfma_f32_16x16x32_bf16 v[164:167], v[124:127], v[96:99], v[164:167]
  ds_read_b64_tr_b16 v[52:53], v7 offset:0
  ds_read_b64_tr_b16 v[54:55], v7 offset:2048
  v_mfma_f32_16x16x32_bf16 v[172:175], v[124:127], v[100:103], v[172:175]
  ds_read_b64_tr_b16 v[80:81], v6 offset:4096
  ds_read_b64_tr_b16 v[82:83], v6 offset:6144
  v_mfma_f32_16x16x32_bf16 v[172:175], v[220:223], v[196:199], v[172:175]
  v_cvt_pk_bf16_f32 v160, v160, v161
  v_cvt_pk_bf16_f32 v161, v162, v163
  v_mfma_f32_16x16x32_bf16 v[168:171], v[216:219], v[196:199], v[168:171]
  v_cvt_pk_bf16_f32 v162, v164, v165
  v_cvt_pk_bf16_f32 v163, v166, v167
  v_mfma_f32_16x16x32_bf16 v[168:171], v[120:123], v[100:103], v[168:171]
  buffer_store_dwordx4 v[160:163], v0, s[40:43], s6 offen offset:0 sc0 sc1
  v_mfma_f32_16x16x32_bf16 v[176:179], v[120:123], v[104:107], v[176:179]
  ds_read_b128 v[64:67], v5 offset:0
  v_mfma_f32_16x16x32_bf16 v[176:179], v[216:219], v[200:203], v[176:179]
  v_cvt_pk_bf16_f32 v166, v172, v173
  v_cvt_pk_bf16_f32 v167, v174, v175
  v_mfma_f32_16x16x32_bf16 v[180:183], v[220:223], v[200:203], v[180:183]
  s_nop 0
  s_nop 0
  v_cvt_pk_bf16_f32 v164, v168, v169
  v_cvt_pk_bf16_f32 v165, v170, v171
  v_mfma_f32_16x16x32_bf16 v[180:183], v[124:127], v[104:107], v[180:183]
  buffer_store_dwordx4 v[164:167], v0, s[40:43], s6 offen offset:2048 sc0 sc1
  ds_read_b128 v[68:71], v5 offset:2048
  v_mfma_f32_16x16x32_bf16 v[188:191], v[124:127], v[108:111], v[188:191]
  ds_read_b128 v[72:75], v5 offset:4096
  v_mfma_f32_16x16x32_bf16 v[188:191], v[220:223], v[204:207], v[188:191]
  v_cvt_pk_bf16_f32 v168, v176, v177
  v_cvt_pk_bf16_f32 v169, v178, v179
  v_mfma_f32_16x16x32_bf16 v[184:187], v[216:219], v[204:207], v[184:187]
  v_cvt_pk_bf16_f32 v170, v180, v181
  v_cvt_pk_bf16_f32 v171, v182, v183
  v_mfma_f32_16x16x32_bf16 v[184:187], v[120:123], v[108:111], v[184:187]
  buffer_store_dwordx4 v[168:171], v0, s[40:43], s7 offen offset:0 sc0 sc1
  ds_read_b128 v[76:79], v5 offset:6144
  v_mfma_f32_16x16x32_bf16 v[128:131], v[112:115], v[96:99], v[128:131]
  ds_read_b64_tr_b16 v[84:85], v7 offset:4096
  v_mfma_f32_16x16x32_bf16 v[128:131], v[208:211], v[192:195], v[128:131]
  v_cvt_pk_bf16_f32 v174, v188, v189
  v_cvt_pk_bf16_f32 v175, v190, v191
  v_mfma_f32_16x16x32_bf16 v[136:139], v[208:211], v[196:199], v[136:139]
  v_cvt_pk_bf16_f32 v172, v184, v185
  v_cvt_pk_bf16_f32 v173, v186, v187
  v_mfma_f32_16x16x32_bf16 v[136:139], v[112:115], v[100:103], v[136:139]
  buffer_store_dwordx4 v[172:175], v0, s[40:43], s7 offen offset:2048 sc0 sc1
  ds_read_b64_tr_b16 v[86:87], v7 offset:6144
  v_mfma_f32_16x16x32_bf16 v[144:147], v[112:115], v[104:107], v[144:147]
  v_subrev_u32 v4, 32768, v4
  v_mfma_f32_16x16x32_bf16 v[144:147], v[208:211], v[200:203], v[144:147]
  v_subrev_u32 v6, 0x10000, v6
  v_mfma_f32_16x16x32_bf16 v[152:155], v[208:211], v[204:207], v[152:155]
  v_subrev_u32 v7, 0x10000, v7
  v_mfma_f32_16x16x32_bf16 v[152:155], v[112:115], v[108:111], v[152:155]
  v_mfma_f32_16x16x32_bf16 v[156:159], v[116:119], v[108:111], v[156:159]
  v_mfma_f32_16x16x32_bf16 v[156:159], v[212:215], v[204:207], v[156:159]
  v_mfma_f32_16x16x32_bf16 v[148:151], v[212:215], v[200:203], v[148:151]
  v_mfma_f32_16x16x32_bf16 v[148:151], v[116:119], v[104:107], v[148:151]
  v_mfma_f32_16x16x32_bf16 v[140:143], v[116:119], v[100:103], v[140:143]
  v_mfma_f32_16x16x32_bf16 v[140:143], v[212:215], v[196:199], v[140:143]
  v_mfma_f32_16x16x32_bf16 v[132:135], v[212:215], v[192:195], v[132:135]
  s_waitcnt lgkmcnt(0)
  v_mfma_f32_16x16x32_bf16 v[132:135], v[116:119], v[96:99], v[132:135]
  s_barrier
  v_mfma_f32_16x16x32_bf16 v[128:131], v[48:51], v[32:35], v[128:131]
  ds_read_b64_tr_b16 v[112:113], v6 offset:0
  v_mfma_f32_16x16x32_bf16 v[128:131], v[80:83], v[64:67], v[128:131]
  ds_read_b64_tr_b16 v[114:115], v6 offset:2048
  v_mfma_f32_16x16x32_bf16 v[136:139], v[80:83], v[68:71], v[136:139]
  ds_read_b64_tr_b16 v[208:209], v6 offset:4096
  v_mfma_f32_16x16x32_bf16 v[136:139], v[48:51], v[36:39], v[136:139]
  ds_read_b64_tr_b16 v[210:211], v6 offset:6144
  v_mfma_f32_16x16x32_bf16 v[144:147], v[48:51], v[40:43], v[144:147]
  ds_read_b128 v[96:99], v4 offset:49152
  v_mfma_f32_16x16x32_bf16 v[144:147], v[80:83], v[72:75], v[144:147]
  ds_read_b128 v[192:195], v4 offset:50176
  v_mfma_f32_16x16x32_bf16 v[152:155], v[80:83], v[76:79], v[152:155]
  ds_read_b128 v[100:103], v4 offset:51200
  v_mfma_f32_16x16x32_bf16 v[152:155], v[48:51], v[44:47], v[152:155]
  ds_read_b128 v[196:199], v4 offset:52224
  v_mfma_f32_16x16x32_bf16 v[156:159], v[52:55], v[44:47], v[156:159]
  ds_read_b128 v[104:107], v4 offset:53248
  v_mfma_f32_16x16x32_bf16 v[156:159], v[84:87], v[76:79], v[156:159]
  ds_read_b128 v[200:203], v4 offset:54272
  v_mfma_f32_16x16x32_bf16 v[148:151], v[84:87], v[72:75], v[148:151]
  ds_read_b128 v[108:111], v4 offset:55296
  v_mfma_f32_16x16x32_bf16 v[148:151], v[52:55], v[40:43], v[148:151]
  ds_read_b128 v[204:207], v4 offset:56320
  v_mfma_f32_16x16x32_bf16 v[140:143], v[52:55], v[36:39], v[140:143]
  ds_read_b64_tr_b16 v[116:117], v7 offset:0
  v_mfma_f32_16x16x32_bf16 v[140:143], v[84:87], v[68:71], v[140:143]
  ds_read_b64_tr_b16 v[118:119], v7 offset:2048
  v_mfma_f32_16x16x32_bf16 v[132:135], v[84:87], v[64:67], v[132:135]
  ds_read_b64_tr_b16 v[212:213], v7 offset:4096
  ds_read_b64_tr_b16 v[214:215], v7 offset:6144
  v_mfma_f32_16x16x32_bf16 v[132:135], v[52:55], v[32:35], v[132:135]
  s_barrier
  s_waitcnt lgkmcnt(10)
  v_mfma_f32_16x16x32_bf16 v[128:131], v[112:115], v[96:99], v[128:131]
  ds_read_b64_tr_b16 v[48:49], v6 offset:16384
  v_mfma_f32_16x16x32_bf16 v[128:131], v[208:211], v[192:195], v[128:131]
  ds_read_b64_tr_b16 v[50:51], v6 offset:18432
  s_nop 0
  s_waitcnt lgkmcnt(10)
  v_mfma_f32_16x16x32_bf16 v[136:139], v[208:211], v[196:199], v[136:139]
  ds_read_b64_tr_b16 v[80:81], v6 offset:20480
  v_mfma_f32_16x16x32_bf16 v[136:139], v[112:115], v[100:103], v[136:139]
  ds_read_b64_tr_b16 v[82:83], v6 offset:22528
  s_nop 0
  s_waitcnt lgkmcnt(10)
  v_mfma_f32_16x16x32_bf16 v[144:147], v[112:115], v[104:107], v[144:147]
  ds_read_b128 v[32:35], v4 offset:0
  v_mfma_f32_16x16x32_bf16 v[144:147], v[208:211], v[200:203], v[144:147]
  ds_read_b128 v[64:67], v4 offset:1024
  s_nop 0
  s_waitcnt lgkmcnt(10)
  v_mfma_f32_16x16x32_bf16 v[152:155], v[208:211], v[204:207], v[152:155]
  ds_read_b128 v[36:39], v4 offset:2048
  v_mfma_f32_16x16x32_bf16 v[152:155], v[112:115], v[108:111], v[152:155]
  ds_read_b128 v[68:71], v4 offset:3072
  s_nop 0
  s_waitcnt lgkmcnt(8)
  v_mfma_f32_16x16x32_bf16 v[156:159], v[116:119], v[108:111], v[156:159]
  ds_read_b128 v[40:43], v4 offset:4096
  buffer_load_dwordx4 v[176:179], v0, s[40:43], s8 offen offset:0 sc0 sc1
  v_mfma_f32_16x16x32_bf16 v[156:159], v[212:215], v[204:207], v[156:159]
  ds_read_b128 v[72:75], v4 offset:5120
  v_mfma_f32_16x16x32_bf16 v[148:151], v[212:215], v[200:203], v[148:151]
  ds_read_b128 v[44:47], v4 offset:6144
  buffer_load_dwordx4 v[180:183], v0, s[40:43], s8 offen offset:2048 sc0 sc1
  v_mfma_f32_16x16x32_bf16 v[148:151], v[116:119], v[104:107], v[148:151]
  ds_read_b128 v[76:79], v4 offset:7168
  v_mfma_f32_16x16x32_bf16 v[140:143], v[116:119], v[100:103], v[140:143]
  ds_read_b64_tr_b16 v[52:53], v7 offset:16384
  buffer_load_dwordx4 v[184:187], v0, s[40:43], s9 offen offset:0 sc0 sc1
  v_mfma_f32_16x16x32_bf16 v[140:143], v[212:215], v[196:199], v[140:143]
  ds_read_b64_tr_b16 v[54:55], v7 offset:18432
  v_mfma_f32_16x16x32_bf16 v[132:135], v[212:215], v[192:195], v[132:135]
  ds_read_b64_tr_b16 v[84:85], v7 offset:20480
  ds_read_b64_tr_b16 v[86:87], v7 offset:22528
  buffer_load_dwordx4 v[188:191], v0, s[40:43], s9 offen offset:2048 sc0 sc1
  v_mfma_f32_16x16x32_bf16 v[132:135], v[116:119], v[96:99], v[132:135]
  s_barrier
  s_waitcnt lgkmcnt(10)
  v_mfma_f32_16x16x32_bf16 v[128:131], v[48:51], v[32:35], v[128:131]
  ds_read_b64_tr_b16 v[112:113], v6 offset:32768
  v_mfma_f32_16x16x32_bf16 v[128:131], v[80:83], v[64:67], v[128:131]
  ds_read_b64_tr_b16 v[114:115], v6 offset:34816
  s_nop 0
  s_waitcnt lgkmcnt(10)
  v_mfma_f32_16x16x32_bf16 v[136:139], v[80:83], v[68:71], v[136:139]
  ds_read_b64_tr_b16 v[208:209], v6 offset:36864
  v_mfma_f32_16x16x32_bf16 v[136:139], v[48:51], v[36:39], v[136:139]
  ds_read_b64_tr_b16 v[210:211], v6 offset:38912
  s_nop 0
  s_waitcnt lgkmcnt(10)
  v_mfma_f32_16x16x32_bf16 v[144:147], v[48:51], v[40:43], v[144:147]
  ds_read_b128 v[96:99], v4 offset:16384
  v_mfma_f32_16x16x32_bf16 v[144:147], v[80:83], v[72:75], v[144:147]
  ds_read_b128 v[192:195], v4 offset:17408
  s_nop 0
  s_waitcnt lgkmcnt(10)
  v_mfma_f32_16x16x32_bf16 v[152:155], v[80:83], v[76:79], v[152:155]
  ds_read_b128 v[100:103], v4 offset:18432
  v_mfma_f32_16x16x32_bf16 v[152:155], v[48:51], v[44:47], v[152:155]
  ds_read_b128 v[196:199], v4 offset:19456
  s_nop 0
  s_waitcnt lgkmcnt(8)
  v_mfma_f32_16x16x32_bf16 v[156:159], v[52:55], v[44:47], v[156:159]
  ds_read_b128 v[104:107], v4 offset:20480
  v_mfma_f32_16x16x32_bf16 v[156:159], v[84:87], v[76:79], v[156:159]
  ds_read_b128 v[200:203], v4 offset:21504
  v_mfma_f32_16x16x32_bf16 v[148:151], v[84:87], v[72:75], v[148:151]
  ds_read_b128 v[108:111], v4 offset:22528
  v_mfma_f32_16x16x32_bf16 v[148:151], v[52:55], v[40:43], v[148:151]
  ds_read_b128 v[204:207], v4 offset:23552
  v_mfma_f32_16x16x32_bf16 v[140:143], v[52:55], v[36:39], v[140:143]
  ds_read_b64_tr_b16 v[116:117], v7 offset:32768
  v_mfma_f32_16x16x32_bf16 v[140:143], v[84:87], v[68:71], v[140:143]
  ds_read_b64_tr_b16 v[118:119], v7 offset:34816
  v_mfma_f32_16x16x32_bf16 v[132:135], v[84:87], v[64:67], v[132:135]
  ds_read_b64_tr_b16 v[212:213], v7 offset:36864
  ds_read_b64_tr_b16 v[214:215], v7 offset:38912
  v_mfma_f32_16x16x32_bf16 v[132:135], v[52:55], v[32:35], v[132:135]
  s_waitcnt lgkmcnt(10)
  v_mfma_f32_16x16x32_bf16 v[128:131], v[112:115], v[96:99], v[128:131]
  v_mfma_f32_16x16x32_bf16 v[128:131], v[208:211], v[192:195], v[128:131]
  s_waitcnt lgkmcnt(8)
  v_mfma_f32_16x16x32_bf16 v[136:139], v[208:211], v[196:199], v[136:139]
  v_mfma_f32_16x16x32_bf16 v[136:139], v[112:115], v[100:103], v[136:139]
  s_waitcnt lgkmcnt(6)
  v_mfma_f32_16x16x32_bf16 v[144:147], v[112:115], v[104:107], v[144:147]
  v_mfma_f32_16x16x32_bf16 v[144:147], v[208:211], v[200:203], v[144:147]
  s_waitcnt lgkmcnt(4)
  v_mfma_f32_16x16x32_bf16 v[152:155], v[208:211], v[204:207], v[152:155]
  s_lshl_b32 s4, s76, Lz1-Lz0+4
  v_mfma_f32_16x16x32_bf16 v[152:155], v[112:115], v[108:111], v[152:155]
  s_add_u32 s4, s4, s78
  s_lshl_b32 s6, s4, 14
  s_waitcnt lgkmcnt(0)
  s_barrier
  v_mfma_f32_16x16x32_bf16 v[156:159], v[116:119], v[108:111], v[156:159]
  s_add_u32 s6, s6, 35651584
  s_add_u32 s7, s6, 4096
  v_mfma_f32_16x16x32_bf16 v[156:159], v[212:215], v[204:207], v[156:159]
  v_and_b32 v2, 15, v1
  v_lshlrev_b32 v3, 12, v2
  v_mfma_f32_16x16x32_bf16 v[148:151], v[212:215], v[200:203], v[148:151]
  v_and_b32_e64 v2, 16, v1
  v_lshl_add_u32 v3, v2, 1, v3
  v_mfma_f32_16x16x32_bf16 v[148:151], v[116:119], v[104:107], v[148:151]
  v_and_b32 v2, 32, v1
  v_lshrrev_b32 v2, 1, v2
  v_mfma_f32_16x16x32_bf16 v[140:143], v[116:119], v[100:103], v[140:143]
  v_add_u32 v3, v2, v3
  s_lshl_b32 s26, s76, 18
  v_mfma_f32_16x16x32_bf16 v[140:143], v[212:215], v[196:199], v[140:143]
  s_lshl_b32 s4, s85, 11
  s_add_u32 s26, s26, s4
  v_mfma_f32_16x16x32_bf16 v[132:135], v[212:215], v[192:195], v[132:135]
  s_lshl_b32 s4, s78, 7
  s_add_u32 s26, s26, s4
  v_mfma_f32_16x16x32_bf16 v[132:135], v[116:119], v[96:99], v[132:135]
  s_lshl_b32 s4, s86, 6
  s_add_u32 s26, s26, s4
  s_mov_b32 s89, 200000
  v_mov_b32_e64 v32, 0
  s_waitcnt vmcnt(0)
  s_mov_b64 exec, 1
  buffer_store_dword v27, off, s[40:43], s14 sc0 sc1
  s_mov_b64 exec, -1
Lx_30:
  v_cmpx_ne_u64 vcc, v[176:177], v[240:241]
  v_cmpx_ne_u64 vcc, v[178:179], v[242:243]
  v_cmpx_ne_u64 vcc, v[180:181], v[244:245]
  v_cmpx_ne_u64 vcc, v[182:183], v[246:247]
  v_cmpx_ne_u64 vcc, v[184:185], v[248:249]
  v_cmpx_ne_u64 vcc, v[186:187], v[250:251]
  v_cmpx_ne_u64 vcc, v[188:189], v[252:253]
  v_cmpx_ne_u64 vcc, v[190:191], v[254:255]
  s_cmp_eq_u64 exec, -1
  s_cbranch_scc0 Lx_29
Lx_31:
  s_nop 1
  v_mfma_f32_16x16x32_bf16 v[128:131], v[226:229], v[176:179], v[128:131]
  v_mfma_f32_16x16x32_bf16 v[132:135], v[224:227], v[176:179], v[132:135]
  v_mfma_f32_16x16x32_bf16 v[136:139], v[226:229], v[180:183], v[136:139]
  v_mfma_f32_16x16x32_bf16 v[140:143], v[224:227], v[180:183], v[140:143]
  v_mfma_f32_16x16x32_bf16 v[144:147], v[226:229], v[184:187], v[144:147]
  v_mfma_f32_16x16x32_bf16 v[148:151], v[224:227], v[184:187], v[148:151]
  v_mfma_f32_16x16x32_bf16 v[152:155], v[226:229], v[188:191], v[152:155]
  v_mfma_f32_16x16x32_bf16 v[156:159], v[224:227], v[188:191], v[156:159]
  s_cmp_lg_u32 s82, 0
  s_cbranch_scc1 L_cfinal
  v_cvt_pk_bf16_f32 v240, v128, v129
  v_cvt_pk_bf16_f32 v241, v130, v131
  v_cvt_pk_bf16_f32 v242, v132, v133
  v_cvt_pk_bf16_f32 v243, v134, v135
  buffer_store_dwordx4 v[240:243], v0, s[40:43], s6 offen offset:0 sc0 sc1
  v_cvt_pk_bf16_f32 v244, v136, v137
  v_cvt_pk_bf16_f32 v245, v138, v139
  v_cvt_pk_bf16_f32 v246, v140, v141
  v_cvt_pk_bf16_f32 v247, v142, v143
  buffer_store_dwordx4 v[244:247], v0, s[40:43], s6 offen offset:2048 sc0 sc1
  v_cvt_pk_bf16_f32 v248, v144, v145
  v_cvt_pk_bf16_f32 v249, v146, v147
  v_cvt_pk_bf16_f32 v250, v148, v149
  v_cvt_pk_bf16_f32 v251, v150, v151
  buffer_store_dwordx4 v[248:251], v0, s[40:43], s7 offen offset:0 sc0 sc1
  v_cvt_pk_bf16_f32 v252, v152, v153
  v_cvt_pk_bf16_f32 v253, v154, v155
  v_cvt_pk_bf16_f32 v254, v156, v157
  v_cvt_pk_bf16_f32 v255, v158, v159
  buffer_store_dwordx4 v[252:255], v0, s[40:43], s7 offen offset:2048 sc0 sc1
  s_lshl_b32 s5, s78, Lz1-Lz0+1
  v_mov_b32 v40, 0x3f803f80
  v_dot2_f32_bf16 v32, v240, v40, 0
  v_dot2_f32_bf16 v36, v240, v240, 0
  v_dot2_f32_bf16 v33, v244, v40, 0
  v_dot2_f32_bf16 v37, v244, v244, 0
  v_dot2_f32_bf16 v34, v248, v40, 0
  v_dot2_f32_bf16 v38, v248, v248, 0
  v_dot2_f32_bf16 v35, v252, v40, 0
  v_dot2_f32_bf16 v39, v252, v252, 0
  v_dot2_f32_bf16 v32, v241, v40, v32
  v_dot2_f32_bf16 v36, v241, v241, v36
  v_dot2_f32_bf16 v33, v245, v40, v33
  v_dot2_f32_bf16 v37, v245, v245, v37
  v_dot2_f32_bf16 v34, v249, v40, v34
  v_dot2_f32_bf16 v38, v249, v249, v38
  v_dot2_f32_bf16 v35, v253, v40, v35
  v_dot2_f32_bf16 v39, v253, v253, v39
  v_dot2_f32_bf16 v32, v242, v40, v32
  v_dot2_f32_bf16 v36, v242, v242, v36
  v_dot2_f32_bf16 v33, v246, v40, v33
  v_dot2_f32_bf16 v37, v246, v246, v37
  v_dot2_f32_bf16 v34, v250, v40, v34
  v_dot2_f32_bf16 v38, v250, v250, v38
  v_dot2_f32_bf16 v35, v254, v40, v35
  v_dot2_f32_bf16 v39, v254, v254, v39
  v_dot2_f32_bf16 v32, v243, v40, v32
  v_dot2_f32_bf16 v36, v243, v243, v36
  v_dot2_f32_bf16 v33, v247, v40, v33
  v_dot2_f32_bf16 v37, v247, v247, v37
  v_dot2_f32_bf16 v34, v251, v40, v34
  v_dot2_f32_bf16 v38, v251, v251, v38
  v_dot2_f32_bf16 v35, v255, v40, v35
  v_dot2_f32_bf16 v39, v255, v255, v39
  s_lshl_b32 s6, s76, Lz1-Lz0+9
  s_lshl_b32 s7, s85, 8
  s_add_u32 s6, s6, s7
  s_add_u32 s6, s6, s5
  s_add_u32 s6, s6, s86
  s_lshl_b32 s6, s6, 6
  s_add_u32 s6, s6, s83
  s_add_u32 s6, s6, 36700160
  v_permlane32_swap_b32 v32, v34
  v_permlane32_swap_b32 v33, v35
  v_permlane32_swap_b32 v36, v38
  v_permlane32_swap_b32 v37, v39
  v_add_f32 v32, v32, v34
  v_add_f32 v33, v33, v35
  v_add_f32 v36, v36, v38
  v_add_f32 v37, v37, v39
  v_permlane16_swap_b32 v32, v33
  s_nop 0
  v_permlane16_swap_b32 v36, v37
  v_add_f32 v42, v32, v33
  v_add_f32_e64 v43, v36, v37
  buffer_store_dwordx2 v[42:43], v30, s[40:43], s6 offen sc0 sc1
  s_add_u32 s5, s87, 0x10
  s_sub_u32 s4, s78, s77
  s_lshl_b32 s4, s4, 7
  s_add_u32 s5, s5, s4
  s_waitcnt vmcnt(0)
  s_mov_b64 exec, 1
  ds_add_rtn_u32 v2, v28, v27 offset:0
  s_waitcnt lgkmcnt(0)
  v_readfirstlane_b32 s4, v2
  s_and_b32 s4, s4, Lz1-Lz0+3
  s_cmp_lg_u32 s4, 3
  s_cbranch_scc1 Ls_32
  s_mov_b32 exec_lo, 0xffff
  buffer_store_dword v27, v24, s[40:43], s5 offen sc0 sc1
Ls_32:
  s_nop 0
  s_mov_b64 exec, -1
  ds_write_b128 v0, v[240:243] offset:0
  ds_write_b128 v0, v[244:247] offset:2048
  ds_write_b128 v0, v[248:251] offset:4096
  ds_write_b128 v0, v[252:255] offset:6144
  s_mov_b32 s82, 1
  s_add_u32 s83, s83, 0
  s_add_u32 s87, s87, 32
  s_branch L_clayer
  s_nop 0
L_cfinal:
  s_nop 1
  v_cvt_pk_bf16_f32 v240, v128, v129
  v_cvt_pk_bf16_f32 v241, v130, v131
  v_cvt_pk_bf16_f32 v242, v132, v133
  v_cvt_pk_bf16_f32 v243, v134, v135
  s_nop 0
  v_permlane16_swap_b32 v240, v242
  v_permlane16_swap_b32_e64 v241, v243
  buffer_store_dwordx4 v[240:243], v3, s[64:67], s26 offen sc0 sc1
  s_add_u32 s26, s26, 0x10000
  v_cvt_pk_bf16_f32 v244, v136, v137
  v_cvt_pk_bf16_f32 v245, v138, v139
  v_cvt_pk_bf16_f32 v246, v140, v141
  v_cvt_pk_bf16_f32 v247, v142, v143
  s_nop 0
  v_permlane16_swap_b32 v244, v246
  v_permlane16_swap_b32_e64 v245, v247
  buffer_store_dwordx4 v[244:247], v3, s[64:67], s26 offen sc0 sc1
  s_add_u32 s26, s26, 0x10000
  v_cvt_pk_bf16_f32 v248, v144, v145
  v_cvt_pk_bf16_f32 v249, v146, v147
  v_cvt_pk_bf16_f32 v250, v148, v149
  v_cvt_pk_bf16_f32 v251, v150, v151
  s_nop 0
  v_permlane16_swap_b32 v248, v250
  v_permlane16_swap_b32_e64 v249, v251
  buffer_store_dwordx4 v[248:251], v3, s[64:67], s26 offen sc0 sc1
  s_add_u32 s26, s26, 0x10000
  v_cvt_pk_bf16_f32 v252, v152, v153
  v_cvt_pk_bf16_f32 v253, v154, v155
  v_cvt_pk_bf16_f32 v254, v156, v157
  v_cvt_pk_bf16_f32 v255, v158, v159
  s_nop 0
  v_permlane16_swap_b32 v252, v254
  v_permlane16_swap_b32_e64 v253, v255
  buffer_store_dwordx4 v[252:255], v3, s[64:67], s26 offen sc0 sc1
  s_endpgm
Lo_7:
  s_mov_b64 vcc, 0
  s_waitcnt lgkmcnt(0)
  s_barrier
  ds_read_b128 v[64:67], v4 offset:0
  ds_read_b128 v[80:83], v5 offset:0
  ds_read_b128 v[68:71], v4 offset:2048
  ds_read_b128 v[84:87], v5 offset:2048
  ds_read_b128 v[72:75], v4 offset:4096
  ds_read_b128 v[88:91], v5 offset:4096
  ds_read_b64_tr_b16 v[96:97], v6 offset:0
  ds_read_b64_tr_b16 v[98:99], v6 offset:2048
  ds_read_b64_tr_b16 v[100:101], v6 offset:4096
  ds_read_b64_tr_b16 v[102:103], v6 offset:6144
  ds_read_b128 v[76:79], v4 offset:6144
  ds_read_b128 v[92:95], v5 offset:6144
  ds_read_b64_tr_b16 v[104:105], v7 offset:0
  s_nop 0
  s_waitcnt lgkmcnt(8)
  ds_read_b64_tr_b16 v[106:107], v7 offset:2048
  ds_read_b64_tr_b16 v[108:109], v7 offset:4096
  ds_read_b64_tr_b16 v[110:111], v7 offset:6144
  s_waitcnt lgkmcnt(6)
  s_branch Lk_4
Lx_29:
  s_mov_b64 exec, -1
  v_readfirstlane_b32 s5, v32
  s_sub_u32 s89, s89, 1
  s_cbranch_scc1 Lx_31
  buffer_load_dword v32, off, s[40:43], s13 sc0 sc1
  buffer_load_dwordx4 v[176:179], v0, s[40:43], s8 offen offset:0 sc0 sc1
  buffer_load_dwordx4 v[180:183], v0, s[40:43], s8 offen offset:2048 sc0 sc1
  buffer_load_dwordx4 v[184:187], v0, s[40:43], s9 offen offset:0 sc0 sc1
  buffer_load_dwordx4 v[188:191], v0, s[40:43], s9 offen offset:2048 sc0 sc1
  s_waitcnt vmcnt(0)
  s_cmp_lg_u32 s5, 0
  s_cbranch_scc1 Lx_31
  s_branch Lx_30
  s_nop 0
L_w1:
  s_and_b32 s80, s77, 7
  s_lshr_b32 s79, s77, 3
  s_lshl_b32 s78, s80, 1
  s_add_u32 s78, s78, s79
  s_lshl_b32 s5, s76, 4
  s_add_u32 s5, s5, s77
  s_lshl_b32 s84, s5, 11
  s_mov_b32 s83, 3145728
  s_mov_b32 s87, 1835016
  s_lshr_b32 s86, s81, 1
  s_mov_b32 s40, s38
  s_and_b32 s41, s39, 0xffff
  s_mov_b32 s42, 100663296
  s_mov_b32 s43, 0x00020000
  s_nop 0
  s_mov_b32 s52, s20
  s_and_b32 s53, s21, 0xffff
  s_mov_b32 s54, 2097152
  s_mov_b32 s55, 0x00020000
  s_nop 0
  s_mov_b32 s56, s24
  s_and_b32 s57, s25, 0xffff
  s_mov_b32 s58, 7340032
  s_mov_b32 s59, 0x00020000
  s_nop 0
  s_mov_b32 s60, s28
  s_and_b32 s61, s29, 0xffff
  s_mov_b32 s62, 7340032
  s_mov_b32 s63, 0x00020000
  v_lshrrev_b32 v2, 3, v1
  s_movk_i32 s4, 2048
  v_mad_u32_u24 v4, v2, s4, v10
  v_add_u32 v5, 15360, v4
  v_add_u32 v6, 30720, v4
  v_add_u32 v7, 46080, v4
  s_lshl_b32 s5, s78, 7
  s_mul_i32 s4, s85, 65536
  s_add_u32 s5, s5, s4
  s_mov_b32 s8, 131072
  s_mov_b32 s10, 2097152
  s_add_u32 s9, s5, s10
  s_mul_i32 s6, s76, s8
  s_add_u32 s7, s5, s6
  s_lshl_b32 s11, s85, 12
  s_add_u32 s11, s11, 65536
  s_add_u32 s15, s11, 81920
  s_add_u32 s11, s11, 32768
  s_mul_i32 s4, s76, 14
  s_lshr_b32 s4, s4, 4
  v_add_u32 v14, s4, v1
  v_subrev_u32 v2, 14, v14
  v_min_u32 v14, v14, v2
  v_cmp_le_u32 vcc, 14, v1
  s_nop 1
  v_cndmask_b32 v14, v14, v1, vcc
  v_lshlrev_b32_e64 v14, 2, v14
  v_mov_b32 v2, 0x87654210
  v_mov_b32 v3, 0xb3fedca9
  v_lshrrev_b64 v[2:3], v14, v[2:3]
  v_and_b32_e64 v14, 15, v2
  v_cmp_eq_u32 vcc, s77, v14
  s_nop 0
  v_mov_b32_dpp v2, v14 row_shr:1 row_mask:0xf bank_mask:0xf
  s_ff1_i32_b32 s4, vcc_lo
  v_cmp_ge_u32 vcc, s4, v1
  s_nop 1
  v_cndmask_b32 v14, v14, v2, vcc
  v_writelane_b32 v14, s77, 0
  v_lshl_add_u32 v12, v14, 17, s5
  s_nop 0
  v_readfirstlane_b32 s7, v12
  s_mov_b32 s12, 0
  s_mov_b32 m0, s11
  s_waitcnt vmcnt(12)
  s_barrier
  s_branch Ll_48
Lt_55:
  s_cmp_lg_u32 s12, 2
  s_cbranch_scc1 Lt_53
  s_waitcnt vmcnt(8)
  s_barrier
  s_branch Ll_48
  s_nop 0
Lt_53:
  s_cmp_lg_u32 s12, 3
  s_cbranch_scc1 Ll_48
  s_barrier
Ll_48:
  buffer_load_dwordx4 v4, s[52:55], s7 offen offset:0  lds
  s_mov_b32 s5, s7
  buffer_load_dwordx4 v5, s[52:55], s5 offen offset:1024  lds
  s_add_u32 s12, s12, 1
  v_readlane_b32 s7, v12, s12
  s_add_u32 s11, s11, 8192
  s_nop 0
  s_cmp_eq_u32 s11, s15
  buffer_load_dwordx4 v6, s[52:55], s5 offen offset:2048  lds
  s_cselect_b32 s4, 81920, 0
  s_sub_u32 s11, s11, s4
  s_cmp_lg_u32 s12, 10
  buffer_load_dwordx4 v7, s[52:55], s5 offen offset:3072  lds
  s_mov_b32 m0, s11
  s_cbranch_scc1 Lt_55
Lt_56:
  v_mov_b32 v2, 156416
  v_mov_b32_e64 v3, 1
  s_waitcnt vmcnt(16)
  s_mov_b64 exec, 1
  ds_add_u32 v2, v3 offset:8
  s_mov_b64 exec, -1
  s_barrier
Ll_50:
  buffer_load_dwordx4 v4, s[52:55], s7 offen offset:0  lds
  s_mov_b32 s5, s7
  buffer_load_dwordx4 v5, s[52:55], s5 offen offset:1024  lds
  s_add_u32 s12, s12, 1
  v_readlane_b32 s7, v12, s12
  s_add_u32 s11, s11, 8192
  s_nop 0
  s_cmp_eq_u32 s11, s15
  buffer_load_dwordx4 v6, s[52:55], s5 offen offset:2048  lds
  s_cselect_b32 s4, 81920, 0
  s_sub_u32 s11, s11, s4
  s_cmp_lg_u32 s12, 16
  buffer_load_dwordx4 v7, s[52:55], s5 offen offset:3072  lds
  s_mov_b32 m0, s11
  s_cbranch_scc1 Ll_50
  v_lshrrev_b32 v2, 3, v1
  s_movk_i32 s4, 7168
  v_mad_u32_u24 v4, v2, s4, v10
  v_add_u32 v5, 56320, v4
  v_add_u32 v6, 112640, v4
  v_add_u32 v7, 168960, v4
  v_lshrrev_b32 v2, 2, v1
  s_movk_i32 s4, 7168
  v_mul_u32_u24_e64 v2, s4, v2
  v_bfe_u32 v3, v10, 5, 1
  v_lshl_add_u32 v2, v3, 4, v2
  v_and_b32 v3, 1, v1
  v_lshlrev_b32 v3, 5, v3
  v_add_u32_e64 v8, v2, v3
  v_add_u32 v9, 113664, v8
  s_mul_i32 s5, s77, 448
  s_and_b32 s4, s77, Lz1-Lz0+1
  s_mul_i32 s94, s4, 448
  s_sub_u32 s94, 384, s94
  s_lshl_b32 s4, s4, 6
  s_add_u32 s5, s5, s4
  s_mul_i32 s4, s85, 229376
  s_add_u32 s5, s5, s4
  s_and_b32 s4, s76, 7
  s_add_u32 s6, s4, 1
  v_cmp_lt_u32 vcc, s6, v1
  v_add_u32 v12, s4, v1
  s_nop 0
  v_subbrev_co_u32 v12, vcc, 0, v12, vcc
  v_and_b32 v12, 7, v12
  v_subrev_u32 v2, 9, v1
  v_cmp_le_u32 vcc, s4, v2
  s_nop 1
  v_addc_co_u32 v2, vcc, 8, v2, vcc
  v_cmp_le_u32 vcc, 9, v1
  s_nop 1
  v_cndmask_b32 v12, v12, v2, vcc
  s_add_u32 s4, s4, 8
  s_mov_b32 m0, s6
  s_nop 0
  v_writelane_b32 v12, s4, m0
  s_and_b32 s4, s76, 8
  v_xor_b32 v12, s4, v12
  v_cmp_eq_u32 vcc, s78, v12
  s_nop 0
  v_mov_b32_dpp v2, v12 row_shr:1 row_mask:0xf bank_mask:0xf
  s_ff1_i32_b32 s4, vcc_lo
  v_cmp_ge_u32 vcc, s4, v1
  s_nop 1
  v_cndmask_b32 v12, v12, v2, vcc
  v_writelane_b32 v12, s78, 0
  s_mov_b32 s4, 458752
  v_mul_u32_u24 v12, s4, v12
  v_add_u32 v12, s5, v12
  s_nop 0
  v_readfirstlane_b32 s7, v12
  s_lshl_b32 s11, s85, Lz1-Lz0+12
  s_add_u32 s11, s11, 65536
  s_add_u32 s15, s11, 86016
  s_lshl_b32 s4, s85, Lz1-Lz0+11
  s_sub_u32 s13, 24576, s4
  s_mul_i32 s5, s85, 6144
  s_nop 0
  s_mov_b32 s68, s28
  s_and_b32 s69, s29, 0xffff
  s_mov_b32 s70, 7340032
  s_mov_b32 s71, 0x00020000
  s_lshl_b32 s4, s76, 4
  s_add_u32 s4, s4, s77
  s_mul_i32 s34, s4, 28672
  s_add_u32 s34, s34, s5
  v_lshlrev_b32 v15, 4, v1
  s_lshl_b32 s91, s85, Lz1-Lz0+13
  s_add_u32 s91, s91, 4096
  s_mul_i32 s4, s76, 262144
  s_add_u32 s4, s4, 3145728
  s_add_u32 s4, s4, s91
  v_lshl_add_u32 v14, v14, 14, s4
  s_mov_b32 s12, 4
Lh_57:
  v_readlane_b32 s90, v14, s12
  s_mov_b32 m0, s91
  s_cmp_lt_u32 s12, Lz1-Lz0+7
  s_cbranch_scc1 Lh_58
  s_waitcnt vmcnt(8)
Lh_58:
  s_barrier
  buffer_load_dwordx4 v15, s[40:43], s90 offen offset:0 sc1 lds
  s_add_u32 s91, s91, 16384
  s_and_b32 s91, s91, 0xffff
  buffer_load_dwordx4 v15, s[40:43], s90 offen offset:1024 sc1 lds
  s_add_u32 s12, s12, 1
  s_cmp_lg_u32 s12, 16
  buffer_load_dwordx4 v15, s[40:43], s90 offen offset:2048 sc1 lds
  buffer_load_dwordx4 v15, s[40:43], s90 offen offset:3072 sc1 lds
  s_cbranch_scc1 Lh_57
  s_mov_b32 s12, 0
  s_mov_b32 m0, s11
  s_branch Ll_59
Lt_65:
  s_cmp_lg_u32 s12, 1
  s_cbranch_scc1 Ll_59
  s_waitcnt vmcnt(18)
  s_barrier
Ll_59:
  buffer_load_dwordx4 v4, s[56:59], s7 offen offset:0  lds
  buffer_load_dwordx4 v5, s[56:59], s7 offen offset:1024  lds
  buffer_load_dwordx4 v6, s[56:59], s7 offen offset:2048  lds
  buffer_load_dwordx4 v7, s[56:59], s7 offen offset:3072  lds
  s_add_u32 m0, s11, s13
  s_add_u32 s5, s7, s94
  buffer_load_dwordx4 v8, s[56:59], s5 offen offset:0  lds
  buffer_load_dwordx4 v9, s[56:59], s5 offen offset:1024  lds
  s_cmp_ge_u32 s12, Lz1-Lz0+2
  s_cbranch_scc1 Lm_66
  s_waitcnt vmcnt(20)
  s_cmp_lg_u32 s12, 0
  s_cbranch_scc1 Lm_67
  s_waitcnt vmcnt(14)
Lm_67:
  s_barrier
Lm_66:
  s_add_u32 m0, s11, 8192
  s_add_u32 s5, s7, 128
  buffer_load_dwordx4 v4, s[56:59], s5 offen offset:0  lds
  buffer_load_dwordx4 v5, s[56:59], s5 offen offset:1024  lds
  buffer_load_dwordx4 v6, s[56:59], s5 offen offset:2048  lds
  buffer_load_dwordx4 v7, s[56:59], s5 offen offset:3072  lds
  s_add_u32 m0, s11, 16384
  s_add_u32 s5, s7, 256
  buffer_load_dwordx4 v4, s[56:59], s5 offen offset:0  lds
  s_add_u32 s12, s12, Lz1-Lz0+1
  v_readlane_b32 s7, v12, s12
  s_add_u32 s11, s11, 28672
  buffer_load_dwordx4 v5, s[56:59], s5 offen offset:1024  lds
  s_cmp_eq_u32 s11, s15
  s_cselect_b32 s4, 86016, 0
  s_sub_u32 s11, s11, s4
  buffer_load_dwordx4 v6, s[56:59], s5 offen offset:2048  lds
  s_cmp_lg_u32 s12, 2
  buffer_load_dwordx4 v7, s[56:59], s5 offen offset:3072  lds
  s_mov_b32 m0, s11
  s_cbranch_scc1 Ll_60
  s_barrier
Lt_68:
  s_waitcnt vmcnt(0)
  s_barrier
Ll_69:
Ll_60:
  s_cmp_lt_u32 s12, 3
  s_cbranch_scc1 Lt_65
  s_waitcnt vmcnt(14)
  s_barrier
  buffer_load_dwordx4 v4, s[56:59], s7 offen offset:0  lds
  buffer_load_dwordx4 v5, s[56:59], s7 offen offset:1024  lds
  buffer_load_dwordx4 v6, s[56:59], s7 offen offset:2048  lds
  buffer_load_dwordx4 v7, s[56:59], s7 offen offset:3072  lds
Ll_70:
  s_add_u32 m0, s11, s13
  s_add_u32 s5, s7, s94
  buffer_load_dwordx4 v8, s[56:59], s5 offen offset:0  lds
  buffer_load_dwordx4 v9, s[56:59], s5 offen offset:1024  lds
  s_add_u32 m0, s11, 8192
  s_add_u32 s5, s7, 128
  buffer_load_dwordx4 v4, s[56:59], s5 offen offset:0  lds
  buffer_load_dwordx4 v5, s[56:59], s5 offen offset:1024  lds
  buffer_load_dwordx4 v6, s[56:59], s5 offen offset:2048  lds
  buffer_load_dwordx4 v7, s[56:59], s5 offen offset:3072  lds
  s_add_u32 m0, s11, 16384
  s_add_u32 s5, s7, 256
  buffer_load_dwordx4 v4, s[56:59], s5 offen offset:0  lds
  s_add_u32 s12, s12, Lz1-Lz0+1
  v_readlane_b32 s7, v12, s12
  s_add_u32 s11, s11, 28672
  buffer_load_dwordx4 v5, s[56:59], s5 offen offset:1024  lds
  s_cmp_eq_u32 s11, s15
  s_cselect_b32 s4, 86016, 0
  s_sub_u32 s11, s11, s4
  buffer_load_dwordx4 v6, s[56:59], s5 offen offset:2048  lds
  s_cmp_eq_u32 s12, Lz1-Lz0+16
  buffer_load_dwordx4 v7, s[56:59], s5 offen offset:3072  lds
  s_mov_b32 m0, s11
  s_cbranch_scc1 Ll_71
  s_cmp_lg_u32 s82, 0
  s_cbranch_scc1 L_72
  s_buffer_load_dwordx2 s[98:99], s[68:71], s34 offset:60
  s_buffer_load_dwordx2 s[98:99], s[68:71], s34 offset:188
  s_buffer_load_dwordx2 s[98:99], s[68:71], s34 offset:316
  s_buffer_load_dwordx2 s[98:99], s[68:71], s34 offset:444
  s_add_u32 s34, s34, 512
L_72:
  s_waitcnt vmcnt(14)
  s_barrier
  buffer_load_dwordx4 v4, s[56:59], s7 offen offset:0  lds
  buffer_load_dwordx4 v5, s[56:59], s7 offen offset:1024  lds
  buffer_load_dwordx4 v6, s[56:59], s7 offen offset:2048  lds
  buffer_load_dwordx4 v7, s[56:59], s7 offen offset:3072  lds
  s_branch Ll_70
  s_nop 0
Ll_71:
  v_lshrrev_b32 v2, 3, v1
  s_movk_i32 s4, 2048
  v_mad_u32_u24 v4, v2, s4, v10
  v_add_u32 v5, 15360, v4
  v_add_u32 v6, 30720, v4
  v_add_u32 v7, 46080, v4
  s_lshl_b32 s5, s78, Lz1-Lz0+7
  s_mul_i32 s4, s79, 3670016
  s_add_u32 s5, s5, s4
  s_lshl_b32 s94, s79, 8
  s_sub_u32 s94, 128, s94
  v_subrev_u32 v2, 2, v1
  v_cmp_le_u32 vcc, 28, v1
  s_nop 1
  v_cndmask_b32 v13, v1, v2, vcc
  v_subrev_u32 v3, 3, v13
  v_mov_b32 v12, 4
  v_cmp_le_u32 vcc, 14, v13
  v_subrev_u32 v2, 14, v13
  s_nop 0
  v_cndmask_b32 v3, v3, v2, vcc
  v_cndmask_b32_e64 v12, v12, 12, vcc
  v_cmp_le_u32 vcc, 21, v13
  v_subrev_u32 v2, 21, v13
  s_nop 0
  v_cndmask_b32 v3, v3, v2, vcc
  v_cndmask_b32_e64 v12, v12, 20, vcc
  s_sub_u32 s4, s80, s76
  s_and_b32 s4, s4, 7
  v_cmp_le_u32 vcc, s4, v3
  v_mov_b32 v2, s76
  s_nop 0
  v_addc_co_u32 v3, vcc, v3, v2, vcc
  v_and_b32 v3, 7, v3
  v_add_u32 v12, v12, v3
  v_add_u32 v2, v2, v1
  v_and_b32 v2, 3, v2
  v_subrev_u32 v3, 10, v1
  v_cmp_gt_u32 vcc, 4, v3
  s_nop 1
  v_cndmask_b32 v12, v12, v2, vcc
  s_add_u32 s4, s80, Lz1-Lz0+4
  v_lshl_add_u32 v2, v1, 3, s4
  v_cmp_gt_u32 vcc, 3, v1
  s_nop 1
  v_cndmask_b32 v12, v12, v2, vcc
  v_subrev_u32 v2, 4, v12
  v_and_b32 v3, 7, v2
  v_lshrrev_b32 v2, 3, v2
  v_mad_u32_u24 v2, v3, 7, v2
  v_and_b32 v3, 1, v3
  v_add_u32 v2, v2, v3
  s_mul_i32 s4, s85, 3
  v_add_u32 v2, s4, v2
  s_add_u32 s4, s85, Lz1-Lz0+6
  v_mad_u32_u24 v3, v12, 14, s4
  v_cmp_gt_u32 vcc, 4, v12
  s_nop 1
  v_cndmask_b32_e64 v2, v2, v3, vcc
  v_lshl_add_u32 v12, v2, 16, s5
  s_mul_i32 s4, s79, 7340032
  s_sub_u32 s4, 3670016, s4
  v_add_u32 v2, s4, v12
  v_cmp_le_u32 vcc, 28, v1
  s_nop 1
  v_cndmask_b32 v12, v12, v2, vcc
  s_lshl_b32 s11, s85, Lz1-Lz0+12
  s_add_u32 s11, s11, 65536
  s_add_u32 s15, s11, 81920
  s_add_u32 s11, s11, 49152
  v_readfirstlane_b32 s7, v12
  s_mov_b32 s12, 0
  s_mov_b32 m0, s11
  s_waitcnt vmcnt(14)
  s_barrier
  s_waitcnt vmcnt(0)
  s_barrier
  s_branch Ll_73
  s_nop 0
Lt_79:
  s_cmp_lg_u32 s12, 2
  s_cbranch_scc1 Ll_73
  s_barrier
Ll_73:
  buffer_load_dwordx4 v4, s[60:63], s7 offen offset:0  lds
  buffer_load_dwordx4 v5, s[60:63], s7 offen offset:1024  lds
  buffer_load_dwordx4 v6, s[60:63], s7 offen offset:2048  lds
  buffer_load_dwordx4 v7, s[60:63], s7 offen offset:3072  lds
  s_add_u32 m0, s11, 8192
  s_add_u32 s5, s7, s94
  buffer_load_dwordx4 v4, s[60:63], s5 offen offset:0  lds
  s_add_u32 s12, s12, 1
  v_readlane_b32 s7, v12, s12
  s_add_u32 s11, s11, 16384
  buffer_load_dwordx4 v5, s[60:63], s5 offen offset:1024  lds
  s_cmp_eq_u32 s11, s15
  s_cselect_b32 s4, 81920, 0
  s_sub_u32 s11, s11, s4
  buffer_load_dwordx4 v6, s[60:63], s5 offen offset:2048  lds
  s_cmp_lg_u32 s12, Lz1-Lz0+5
  buffer_load_dwordx4 v7, s[60:63], s5 offen offset:3072  lds
  s_mov_b32 m0, s11
  s_cbranch_scc1 Lt_79
Lt_80:
  v_lshrrev_b32 v2, 3, v1
  s_movk_i32 s4, 6144
  v_mad_u32_u24 v16, v2, s4, v10
  v_add_u32 v17, 48128, v16
  v_add_u32 v18, 96256, v16
  v_add_u32 v19, 144384, v16
  s_lshl_b32 s5, s77, Lz1-Lz0+7
  s_mul_i32 s4, s85, 196608
  s_add_u32 s5, s5, s4
  s_and_b32 s4, s76, 7
  s_add_u32 s6, s4, 1
  v_cmp_lt_u32 vcc, s6, v1
  v_add_u32 v20, s4, v1
  s_nop 0
  v_subbrev_co_u32 v20, vcc, 0, v20, vcc
  v_and_b32 v20, 7, v20
  v_subrev_u32 v2, 9, v1
  v_cmp_le_u32 vcc, s4, v2
  s_nop 1
  v_addc_co_u32 v2, vcc, 8, v2, vcc
  v_cmp_le_u32 vcc, 9, v1
  s_nop 1
  v_cndmask_b32 v20, v20, v2, vcc
  s_add_u32 s4, s4, 8
  s_mov_b32 m0, s6
  s_nop 0
  v_writelane_b32 v20, s4, m0
  s_and_b32 s4, s76, 8
  v_xor_b32 v20, s4, v20
  v_cmp_eq_u32 vcc, s78, v20
  s_nop 0
  v_mov_b32_dpp v2, v20 row_shr:1 row_mask:0xf bank_mask:0xf
  s_ff1_i32_b32 s4, vcc_lo
  v_cmp_ge_u32 vcc, s4, v1
  s_nop 1
  v_cndmask_b32 v20, v20, v2, vcc
  v_writelane_b32 v20, s78, 0
  s_mov_b32 s4, 393216
  v_mul_u32_u24_e64 v20, s4, v20
  v_add_u32 v20, s5, v20
  s_mov_b32 m0, s11
  s_waitcnt vmcnt(32)
  s_barrier
Ll_81:
  s_waitcnt vmcnt(24)
  s_barrier
  buffer_load_dwordx4 v4, s[60:63], s7 offen offset:0  lds
  buffer_load_dwordx4 v5, s[60:63], s7 offen offset:1024  lds
  buffer_load_dwordx4 v6, s[60:63], s7 offen offset:2048  lds
  buffer_load_dwordx4 v7, s[60:63], s7 offen offset:3072  lds
Ll_82:
  s_add_u32 m0, s11, 8192
  s_add_u32 s5, s7, s94
  buffer_load_dwordx4 v4, s[60:63], s5 offen offset:0  lds
  s_add_u32 s12, s12, 1
  v_readlane_b32 s7, v12, s12
  s_add_u32 s11, s11, 16384
  buffer_load_dwordx4 v5, s[60:63], s5 offen offset:1024  lds
  s_cmp_eq_u32 s11, s15
  s_cselect_b32 s4, 81920, 0
  s_sub_u32 s11, s11, s4
  buffer_load_dwordx4 v6, s[60:63], s5 offen offset:2048  lds
  s_cmp_eq_u32 s12, Lz1-Lz0+26
  buffer_load_dwordx4 v7, s[60:63], s5 offen offset:3072  lds
  s_mov_b32 m0, s11
  s_cbranch_scc1 Ll_83
  s_waitcnt vmcnt(24)
  s_barrier
  buffer_load_dwordx4 v4, s[60:63], s7 offen offset:0  lds
  buffer_load_dwordx4 v5, s[60:63], s7 offen offset:1024  lds
  buffer_load_dwordx4 v6, s[60:63], s7 offen offset:2048  lds
  buffer_load_dwordx4 v7, s[60:63], s7 offen offset:3072  lds
  s_branch Ll_82
  s_nop 0
Ll_83:
  s_waitcnt vmcnt(24)
  s_barrier
  buffer_load_dwordx4 v4, s[60:63], s7 offen offset:0  lds
Ll_84:
  s_mov_b32 s5, s7
  buffer_load_dwordx4 v5, s[60:63], s5 offen offset:1024  lds
  s_add_u32 s12, s12, 1
  v_readlane_b32 s7, v12, s12
  s_add_u32 s11, s11, 16384
  s_nop 0
  s_cmp_eq_u32 s11, s15
  buffer_load_dwordx4 v6, s[60:63], s5 offen offset:2048  lds
  s_cselect_b32 s4, 81920, 0
  s_sub_u32 s11, s11, s4
  s_cmp_eq_u32 s12, 30
  buffer_load_dwordx4 v7, s[60:63], s5 offen offset:3072  lds
  s_mov_b32 m0, s11
  s_cbranch_scc1 Ll_85
  s_waitcnt vmcnt(12)
  s_barrier
  buffer_load_dwordx4 v4, s[60:63], s7 offen offset:0  lds
  s_branch Ll_84
  s_nop 0
Ll_85:
  v_readfirstlane_b32 s7, v20
  s_lshl_b32 s11, s85, 12
  s_add_u32 s11, s11, 65536
  s_add_u32 s15, s11, 73728
  s_cmp_eq_u32 s82, 0
  s_mov_b32 s82, 1
  s_cbranch_scc1 L_wlayer
  s_waitcnt vmcnt(12)
  s_barrier
  s_waitcnt vmcnt(8)
  s_barrier
  s_waitcnt vmcnt(4)
  s_barrier
  s_waitcnt vmcnt(0)
  s_barrier
  s_barrier
  s_branch L_lend
L_x1:
  s_cmp_lg_u32 s82, 0
  s_cbranch_scc1 L_95
  s_and_b32 s80, s77, 7
  s_lshr_b32 s79, s77, 3
  s_lshl_b32 s78, s80, 1
  s_add_u32 s78, s78, s79
  s_lshl_b32 s5, s76, 4
  s_add_u32 s5, s5, s77
  s_lshl_b32 s84, s5, 11
  s_mov_b32 s83, 3145728
  s_mov_b32 s87, 1835016
  s_lshr_b32 s86, s81, 1
  v_lshlrev_b32 v4, 4, v1
  v_lshlrev_b32 v5, 4, v1
  v_lshlrev_b32 v6, 4, v1
  v_lshlrev_b32 v7, 4, v1
  s_movk_i32 s13, 4096
  s_movk_i32 s95, 8192
  v_and_b32 v2, 31, v1
  v_lshlrev_b32 v8, 7, v2
L_95:
  s_mov_b32 s40, s38
  s_and_b32 s41, s39, 0xffff
  s_mov_b32 s42, 100663296
  s_mov_b32 s43, 0x00020000
  s_mov_b32 s72, s40
  s_mov_b32 s73, s41
  s_mov_b32 s74, s42
  s_mov_b32 s11, 0
  s_mov_b32 s15, 65536
  s_mul_i32 s5, s76, 16
  s_lshl_b32 s5, s5, 14
  s_add_u32 s5, s5, 3145728
  s_mul_i32 s4, s76, 14
  s_lshr_b32 s4, s4, 4
  v_add_u32 v9, s4, v1
  v_subrev_u32 v2, 14, v9
  v_min_u32 v9, v9, v2
  v_cmp_le_u32 vcc, 14, v1
  s_nop 1
  v_cndmask_b32 v9, v9, v1, vcc
  v_lshlrev_b32_e64 v9, 2, v9
  v_mov_b32 v2, 0x87654210
  v_mov_b32 v3, 0xb3fedca9
  v_lshrrev_b64 v[2:3], v9, v[2:3]
  v_and_b32_e64 v9, 15, v2
  v_cmp_eq_u32 vcc, s77, v9
  s_nop 0
  v_mov_b32_dpp v2, v9 row_shr:1 row_mask:0xf bank_mask:0xf
  s_ff1_i32_b32 s4, vcc_lo
  v_cmp_ge_u32 vcc, s4, v1
  s_nop 1
  v_cndmask_b32 v9, v9, v2, vcc
  v_writelane_b32 v9, s77, 0
  v_lshlrev_b32 v11, 7, v9
  v_lshl_add_u32 v9, v9, 14, s5
  s_nop 0
  v_readlane_b32 s7, v9, 1
  s_mov_b32 s11, 16384
  s_mov_b32 s90, 0xfe
  s_lshl_b32 s91, s84, Lz1-Lz0+1
  s_add_u32 s91, s91, s87
  s_barrier
  s_mov_b32 s89, 200000
  s_mov_b32 exec_lo, s90
  s_mov_b32 exec_hi, 0
  buffer_load_dword v12, v11, s[40:43], s91 offen sc0 sc1
Lp_96:
  s_waitcnt vmcnt(0)
  v_cmp_ne_u32 vcc, 0, v12
  s_andn2_b32 s3, exec_lo, vcc_lo
  s_cbranch_scc0 Lp_97
  s_mov_b32 exec_lo, s3
  s_sleep 1
  buffer_load_dword v12, v11, s[40:43], s91 offen sc0 sc1
  s_sub_u32 s89, s89, 1
  s_cbranch_scc0 Lp_96
Lp_97:
  s_mov_b64 exec, -1
  s_mov_b32 s12, 1
  s_mov_b32 m0, s11
Ll_99:
  s_nop 0
  buffer_load_dwordx4 v4, s[40:43], s7 offen offset:0 sc1 lds
  buffer_load_dwordx4 v5, s[40:43], s7 offen offset:1024 sc1 lds
  buffer_load_dwordx4 v6, s[40:43], s7 offen offset:2048 sc1 lds
  buffer_load_dwordx4 v7, s[40:43], s7 offen offset:3072 sc1 lds
  s_add_u32 m0, s11, 4096
  s_nop 0
  s_add_u32 s5, s7, s13
  buffer_load_dwordx4 v4, s[40:43], s5 offen offset:0 sc1 lds
  buffer_load_dwordx4 v5, s[40:43], s5 offen offset:1024 sc1 lds
  buffer_load_dwordx4 v6, s[40:43], s5 offen offset:2048 sc1 lds
  buffer_load_dwordx4 v7, s[40:43], s5 offen offset:3072 sc1 lds
  s_add_u32 m0, s11, 8192
  s_nop 0
  s_add_u32 s3, s7, s95
  buffer_load_dwordx4 v4, s[40:43], s3 offen offset:0 sc1 lds
  buffer_load_dwordx4 v5, s[40:43], s3 offen offset:1024 sc1 lds
  buffer_load_dwordx4 v6, s[40:43], s3 offen offset:2048 sc1 lds
  buffer_load_dwordx4 v7, s[40:43], s3 offen offset:3072 sc1 lds
  s_add_u32 m0, s11, 12288
  s_add_u32 s5, s3, s13
  buffer_load_dwordx4 v4, s[40:43], s5 offen offset:0 sc1 lds
  s_add_u32 s12, s12, 1
  v_readlane_b32 s7, v9, s12
  s_add_u32 s11, s11, 16384
  buffer_load_dwordx4 v5, s[40:43], s5 offen offset:1024 sc1 lds
  s_cmp_eq_u32 s11, s15
  s_cselect_b32 s4, 65536, 0
  s_sub_u32 s11, s11, s4
  buffer_load_dwordx4 v6, s[40:43], s5 offen offset:2048 sc1 lds
  s_cmp_lg_u32 s12, Lz1-Lz0+4
  buffer_load_dwordx4 v7, s[40:43], s5 offen offset:3072 sc1 lds
  s_mov_b32 m0, s11
  s_cbranch_scc1 Ll_99
  s_waitcnt vmcnt(32)
  s_barrier
  buffer_load_dwordx4 v4, s[40:43], s7 offen offset:0 sc1 lds
  buffer_load_dwordx4 v5, s[40:43], s7 offen offset:1024 sc1 lds
  buffer_load_dwordx4 v6, s[40:43], s7 offen offset:2048 sc1 lds
  buffer_load_dwordx4 v7, s[40:43], s7 offen offset:3072 sc1 lds
  s_add_u32 m0, s11, 8192
  s_add_u32 s3, s7, s95
  buffer_load_dwordx4 v4, s[40:43], s3 offen offset:0 sc1 lds
  s_add_u32 s12, s12, 1
  v_readlane_b32 s7, v9, s12
  buffer_load_dwordx4 v5, s[40:43], s3 offen offset:1024 sc1 lds
  s_add_u32 s11, s11, 16384
  s_nop 0
  s_cmp_eq_u32 s11, s15
  buffer_load_dwordx4 v6, s[40:43], s3 offen offset:2048 sc1 lds
  s_cselect_b32 s4, 65536, 0
  s_sub_u32 s11, s11, s4
  buffer_load_dwordx4 v7, s[40:43], s3 offen offset:3072 sc1 lds
  s_mov_b32 m0, s11
  s_waitcnt vmcnt(24)
  s_barrier
  buffer_load_dwordx4 v4, s[40:43], s7 offen offset:0 sc1 lds
  buffer_load_dwordx4 v5, s[40:43], s7 offen offset:1024 sc1 lds
  buffer_load_dwordx4 v6, s[40:43], s7 offen offset:2048 sc1 lds
  buffer_load_dwordx4 v7, s[40:43], s7 offen offset:3072 sc1 lds
Ll_104:
  s_add_u32 m0, s11, 8192
  s_add_u32 s3, s7, s95
  buffer_load_dwordx4 v4, s[40:43], s3 offen offset:0 sc1 lds
  s_add_u32 s12, s12, 1
  v_readlane_b32 s7, v9, s12
  s_add_u32 s11, s11, 16384
  buffer_load_dwordx4 v5, s[40:43], s3 offen offset:1024 sc1 lds
  s_cmp_eq_u32 s11, s15
  s_cselect_b32 s4, 65536, 0
  s_sub_u32 s11, s11, s4
  buffer_load_dwordx4 v6, s[40:43], s3 offen offset:2048 sc1 lds
  s_cmp_eq_u32 s12, Lz1-Lz0+16
  buffer_load_dwordx4 v7, s[40:43], s3 offen offset:3072 sc1 lds
  s_mov_b32 m0, s11
  s_cbranch_scc1 Ll_105
  s_waitcnt vmcnt(16)
  s_barrier
  buffer_load_dwordx4 v4, s[40:43], s7 offen offset:0 sc1 lds
  buffer_load_dwordx4 v5, s[40:43], s7 offen offset:1024 sc1 lds
  buffer_load_dwordx4 v6, s[40:43], s7 offen offset:2048 sc1 lds
  buffer_load_dwordx4 v7, s[40:43], s7 offen offset:3072 sc1 lds
  s_branch Ll_104
  s_nop 0
Ll_105:
  s_waitcnt vmcnt(16)
  s_barrier
  s_waitcnt vmcnt(8)
  s_barrier
  s_waitcnt vmcnt(0)
  s_barrier
  s_barrier
  s_mov_b32 s11, 0
  s_mov_b32 s15, 65536
  s_mul_i32 s5, s76, 16
  s_lshl_b32 s5, s5, 14
  s_add_u32 s5, s5, 7340032
  s_and_b32 s4, s76, 7
  s_add_u32 s6, s4, 1
  v_cmp_lt_u32 vcc, s6, v1
  v_add_u32 v9, s4, v1
  s_nop 0
  v_subbrev_co_u32 v9, vcc, 0, v9, vcc
  v_and_b32 v9, 7, v9
  v_subrev_u32 v2, 9, v1
  v_cmp_le_u32 vcc, s4, v2
  s_nop 1
  v_addc_co_u32 v2, vcc, 8, v2, vcc
  v_cmp_le_u32 vcc, 9, v1
  s_nop 1
  v_cndmask_b32 v9, v9, v2, vcc
  s_add_u32 s4, s4, Lz1-Lz0+8
  s_mov_b32 m0, s6
  s_nop 0
  v_writelane_b32 v9, s4, m0
  s_and_b32 s4, s76, 8
  v_xor_b32 v9, s4, v9
  v_cmp_eq_u32 vcc, s78, v9
  s_nop 0
  v_mov_b32_dpp v2, v9 row_shr:1 row_mask:0xf bank_mask:0xf
  s_ff1_i32_b32 s4, vcc_lo
  v_cmp_ge_u32 vcc, s4, v1
  s_nop 1
  v_cndmask_b32 v9, v9, v2, vcc
  v_writelane_b32 v9, s78, 0
  v_lshlrev_b32_e64 v11, 7, v9
  v_lshl_add_u32 v9, v9, 14, s5
  s_lshl_b32 s6, s76, Lz1-Lz0+14
  v_readlane_b32 s7, v9, 1
  s_mov_b32 s11, 16384
  s_mov_b32 s90, Lz1-Lz0+62
  s_add_u32 s91, s91, 4
  s_barrier
  s_mov_b32 s89, 200000
  s_mov_b32 exec_lo, s90
  s_mov_b32 exec_hi, 0
  buffer_load_dword v12, v11, s[40:43], s91 offen sc0 sc1
Lp_106:
  s_waitcnt vmcnt(0)
  v_cmp_ne_u32 vcc, 0, v12
  s_andn2_b32 s3, exec_lo, vcc_lo
  s_cbranch_scc0 Lp_107
  s_mov_b32 exec_lo, s3
  s_sleep 1
  buffer_load_dword v12, v11, s[40:43], s91 offen sc0 sc1
  s_sub_u32 s89, s89, 1
  s_cbranch_scc0 Lp_106
Lp_107:
  s_mov_b64 exec, -1
  s_mov_b32 s12, 1
  s_mov_b32 m0, s11
Ll_109:
  s_nop 0
  buffer_load_dwordx4 v4, s[72:75], s7 offen offset:0 sc1 lds
  buffer_load_dwordx4 v5, s[72:75], s7 offen offset:1024 sc1 lds
  buffer_load_dwordx4 v6, s[72:75], s7 offen offset:2048 sc1 lds
  buffer_load_dwordx4 v7, s[72:75], s7 offen offset:3072 sc1 lds
  s_add_u32 m0, s11, 4096
  s_nop 0
  s_add_u32 s5, s7, s13
  buffer_load_dwordx4 v4, s[72:75], s5 offen offset:0 sc1 lds
  buffer_load_dwordx4 v5, s[72:75], s5 offen offset:1024 sc1 lds
  buffer_load_dwordx4 v6, s[72:75], s5 offen offset:2048 sc1 lds
  buffer_load_dwordx4 v7, s[72:75], s5 offen offset:3072 sc1 lds
  s_add_u32 m0, s11, 8192
  s_nop 0
  s_add_u32 s3, s7, s95
  buffer_load_dwordx4 v4, s[72:75], s3 offen offset:0 sc1 lds
  buffer_load_dwordx4 v5, s[72:75], s3 offen offset:1024 sc1 lds
  buffer_load_dwordx4 v6, s[72:75], s3 offen offset:2048 sc1 lds
  buffer_load_dwordx4 v7, s[72:75], s3 offen offset:3072 sc1 lds
  s_add_u32 m0, s11, 12288
  s_add_u32 s5, s3, s13
  buffer_load_dwordx4 v4, s[72:75], s5 offen offset:0 sc1 lds
  s_add_u32 s12, s12, 1
  v_readlane_b32 s7, v9, s12
  s_add_u32 s11, s11, 16384
  buffer_load_dwordx4 v5, s[72:75], s5 offen offset:1024 sc1 lds
  s_cmp_eq_u32 s11, s15
  s_cselect_b32 s4, 65536, 0
  s_sub_u32 s11, s11, s4
  buffer_load_dwordx4 v6, s[72:75], s5 offen offset:2048 sc1 lds
  s_cmp_lg_u32 s12, Lz1-Lz0+4
  buffer_load_dwordx4 v7, s[72:75], s5 offen offset:3072 sc1 lds
  s_mov_b32 m0, s11
  s_cbranch_scc1 Ll_109
  s_waitcnt vmcnt(32)
  s_barrier
  buffer_load_dwordx4 v4, s[72:75], s7 offen offset:0 sc1 lds
  buffer_load_dwordx4 v5, s[72:75], s7 offen offset:1024 sc1 lds
  buffer_load_dwordx4 v6, s[72:75], s7 offen offset:2048 sc1 lds
  buffer_load_dwordx4 v7, s[72:75], s7 offen offset:3072 sc1 lds
Ll_114:
  s_add_u32 m0, s11, 4096
  s_nop 0
  s_add_u32 s5, s7, s13
  buffer_load_dwordx4 v4, s[72:75], s5 offen offset:0 sc1 lds
  buffer_load_dwordx4 v5, s[72:75], s5 offen offset:1024 sc1 lds
  buffer_load_dwordx4 v6, s[72:75], s5 offen offset:2048 sc1 lds
  buffer_load_dwordx4 v7, s[72:75], s5 offen offset:3072 sc1 lds
  s_add_u32 m0, s11, 8192
  s_nop 0
  s_add_u32 s3, s7, s95
  buffer_load_dwordx4 v4, s[72:75], s3 offen offset:0 sc1 lds
  buffer_load_dwordx4 v5, s[72:75], s3 offen offset:1024 sc1 lds
  buffer_load_dwordx4 v6, s[72:75], s3 offen offset:2048 sc1 lds
  buffer_load_dwordx4 v7, s[72:75], s3 offen offset:3072 sc1 lds
  s_add_u32 m0, s11, 12288
  s_add_u32 s5, s3, s13
  buffer_load_dwordx4 v4, s[72:75], s5 offen offset:0 sc1 lds
  s_add_u32 s12, s12, 1
  v_readlane_b32 s7, v9, s12
  s_add_u32 s11, s11, 16384
  buffer_load_dwordx4 v5, s[72:75], s5 offen offset:1024 sc1 lds
  s_cmp_eq_u32 s11, s15
  s_cselect_b32 s4, 65536, 0
  s_sub_u32 s11, s11, s4
  buffer_load_dwordx4 v6, s[72:75], s5 offen offset:2048 sc1 lds
  s_cmp_eq_u32 s12, Lz1-Lz0+16
  buffer_load_dwordx4 v7, s[72:75], s5 offen offset:3072 sc1 lds
  s_mov_b32 m0, s11
  s_cbranch_scc1 Ll_115
  s_waitcnt vmcnt(32)
  s_barrier
  buffer_load_dwordx4 v4, s[72:75], s7 offen offset:0 sc1 lds
  buffer_load_dwordx4 v5, s[72:75], s7 offen offset:1024 sc1 lds
  buffer_load_dwordx4 v6, s[72:75], s7 offen offset:2048 sc1 lds
  buffer_load_dwordx4 v7, s[72:75], s7 offen offset:3072 sc1 lds
  s_branch Ll_114
  s_nop 0
Ll_115:
  s_waitcnt vmcnt(32)
  s_barrier
  s_waitcnt vmcnt(16)
  s_barrier
  s_waitcnt vmcnt(0)
  s_barrier
  s_barrier
  s_mov_b32 s11, 0
  s_mov_b32 s15, 65536
  s_mul_i32 s5, s76, 56
  s_mul_i32 s4, s79, 28
  s_add_u32 s5, s5, s4
  s_lshl_b32 s5, s5, 14
  s_add_u32 s5, s5, 11534336
  v_subrev_u32 v2, 2, v1
  v_cmp_le_u32 vcc, 28, v1
  s_nop 1
  v_cndmask_b32 v10, v1, v2, vcc
  v_subrev_u32 v3, 3, v10
  v_mov_b32 v9, 4
  v_cmp_le_u32 vcc, 14, v10
  v_subrev_u32 v2, 14, v10
  s_nop 0
  v_cndmask_b32 v3, v3, v2, vcc
  v_cndmask_b32_e64 v9, v9, 12, vcc
  v_cmp_le_u32 vcc, 21, v10
  v_subrev_u32 v2, 21, v10
  s_nop 0
  v_cndmask_b32 v3, v3, v2, vcc
  v_cndmask_b32_e64 v9, v9, 20, vcc
  s_sub_u32 s4, s80, s76
  s_and_b32 s4, s4, 7
  v_cmp_le_u32 vcc, s4, v3
  v_mov_b32 v2, s76
  s_nop 0
  v_addc_co_u32 v3, vcc, v3, v2, vcc
  v_and_b32 v3, 7, v3
  v_add_u32 v9, v9, v3
  v_add_u32 v2, v2, v1
  v_and_b32 v2, 3, v2
  v_subrev_u32 v3, 10, v1
  v_cmp_gt_u32 vcc, 4, v3
  s_nop 1
  v_cndmask_b32 v9, v9, v2, vcc
  s_add_u32 s4, s80, Lz1-Lz0+4
  v_lshl_add_u32 v2, v1, 3, s4
  v_cmp_gt_u32 vcc, 3, v1
  s_nop 1
  v_cndmask_b32_e64 v9, v9, v2, vcc
  v_lshl_add_u32 v9, v9, 14, s5
  s_mul_i32 s4, s79, 917504
  s_sub_u32 s4, 458752, s4
  v_add_u32_e64 v2, s4, v9
  v_cmp_le_u32 vcc, 28, v1
  s_nop 1
  v_cndmask_b32 v9, v9, v2, vcc
  s_nop 0
  v_readlane_b32 s7, v9, 3
  s_mov_b32 s11, 49152
  s_add_u32 s91, s91, 4
  s_lshl_b32 s4, s79, 3
  s_lshl_b32 s90, 0xff, s4
  s_bitset0_b32 s90, s77
  s_mov_b32 s89, 200000
  s_mov_b32 exec_lo, s90
  s_mov_b32 exec_hi, Lz1-Lz0+0
  buffer_load_dword v12, v8, s[40:43], s91 offen sc0 sc1
Lp_116:
  s_waitcnt vmcnt(0)
  v_cmp_ne_u32 vcc, 0, v12
  s_andn2_b32 s3, exec_lo, vcc_lo
  s_cbranch_scc0 Lp_117
  s_mov_b32 exec_lo, s3
  s_sleep 1
  buffer_load_dword v12, v8, s[40:43], s91 offen sc0 sc1
  s_sub_u32 s89, s89, 1
  s_cbranch_scc0 Lp_116
Lp_117:
  s_mov_b64 exec, -1
  s_mov_b32 s12, 3
  s_mov_b32 m0, s11
Ll_119:
  s_nop 0
  buffer_load_dwordx4 v4, s[40:43], s7 offen offset:0 sc1 lds
  buffer_load_dwordx4 v5, s[40:43], s7 offen offset:1024 sc1 lds
  buffer_load_dwordx4 v6, s[40:43], s7 offen offset:2048 sc1 lds
  buffer_load_dwordx4 v7, s[40:43], s7 offen offset:3072 sc1 lds
  s_add_u32 m0, s11, 4096
  s_nop 0
  s_add_u32 s5, s7, s13
  buffer_load_dwordx4 v4, s[40:43], s5 offen offset:0 sc1 lds
  buffer_load_dwordx4 v5, s[40:43], s5 offen offset:1024 sc1 lds
  buffer_load_dwordx4 v6, s[40:43], s5 offen offset:2048 sc1 lds
  buffer_load_dwordx4 v7, s[40:43], s5 offen offset:3072 sc1 lds
  s_add_u32 m0, s11, 8192
  s_nop 0
  s_add_u32 s3, s7, s95
  buffer_load_dwordx4 v4, s[40:43], s3 offen offset:0 sc1 lds
  buffer_load_dwordx4 v5, s[40:43], s3 offen offset:1024 sc1 lds
  buffer_load_dwordx4 v6, s[40:43], s3 offen offset:2048 sc1 lds
  buffer_load_dwordx4 v7, s[40:43], s3 offen offset:3072 sc1 lds
  s_add_u32 m0, s11, 12288
  s_add_u32 s5, s3, s13
  buffer_load_dwordx4 v4, s[40:43], s5 offen offset:0 sc1 lds
  s_add_u32 s12, s12, 1
  v_readlane_b32 s7, v9, s12
  s_add_u32 s11, s11, 16384
  buffer_load_dwordx4 v5, s[40:43], s5 offen offset:1024 sc1 lds
  s_cmp_eq_u32 s11, s15
  s_cselect_b32 s4, 65536, 0
  s_sub_u32 s11, s11, s4
  buffer_load_dwordx4 v6, s[40:43], s5 offen offset:2048 sc1 lds
  s_cmp_lg_u32 s12, Lz1-Lz0+4
  buffer_load_dwordx4 v7, s[40:43], s5 offen offset:3072 sc1 lds
  s_mov_b32 m0, s11
  s_cbranch_scc1 Ll_119
  s_waitcnt vmcnt(48)
  s_barrier
Ll_124:
  s_waitcnt vmcnt(32)
  s_barrier
  buffer_load_dwordx4 v4, s[40:43], s7 offen offset:0 sc1 lds
  buffer_load_dwordx4 v5, s[40:43], s7 offen offset:1024 sc1 lds
  buffer_load_dwordx4 v6, s[40:43], s7 offen offset:2048 sc1 lds
  buffer_load_dwordx4 v7, s[40:43], s7 offen offset:3072 sc1 lds
Ll_125:
  s_add_u32 m0, s11, 4096
  s_nop 0
  s_add_u32 s5, s7, s13
  buffer_load_dwordx4 v4, s[40:43], s5 offen offset:0 sc1 lds
  buffer_load_dwordx4 v5, s[40:43], s5 offen offset:1024 sc1 lds
  buffer_load_dwordx4 v6, s[40:43], s5 offen offset:2048 sc1 lds
  buffer_load_dwordx4 v7, s[40:43], s5 offen offset:3072 sc1 lds
  s_add_u32 m0, s11, 8192
  s_nop 0
  s_add_u32 s3, s7, s95
  buffer_load_dwordx4 v4, s[40:43], s3 offen offset:0 sc1 lds
  buffer_load_dwordx4 v5, s[40:43], s3 offen offset:1024 sc1 lds
  buffer_load_dwordx4 v6, s[40:43], s3 offen offset:2048 sc1 lds
  buffer_load_dwordx4 v7, s[40:43], s3 offen offset:3072 sc1 lds
  s_add_u32 m0, s11, 12288
  s_add_u32 s5, s3, s13
  buffer_load_dwordx4 v4, s[40:43], s5 offen offset:0 sc1 lds
  s_add_u32 s12, s12, 1
  v_readlane_b32 s7, v9, s12
  s_add_u32 s11, s11, 16384
  buffer_load_dwordx4 v5, s[40:43], s5 offen offset:1024 sc1 lds
  s_cmp_eq_u32 s11, s15
  s_cselect_b32 s4, 65536, 0
  s_sub_u32 s11, s11, s4
  buffer_load_dwordx4 v6, s[40:43], s5 offen offset:2048 sc1 lds
  s_cmp_eq_u32 s12, Lz1-Lz0+30
  buffer_load_dwordx4 v7, s[40:43], s5 offen offset:3072 sc1 lds
  s_mov_b32 m0, s11
  s_cbranch_scc1 Ll_126
  s_waitcnt vmcnt(32)
  s_barrier
  buffer_load_dwordx4 v4, s[40:43], s7 offen offset:0 sc1 lds
  buffer_load_dwordx4 v5, s[40:43], s7 offen offset:1024 sc1 lds
  buffer_load_dwordx4 v6, s[40:43], s7 offen offset:2048 sc1 lds
  buffer_load_dwordx4 v7, s[40:43], s7 offen offset:3072 sc1 lds
  s_branch Ll_125
  s_nop 0
Ll_126:
  s_waitcnt vmcnt(32)
  s_barrier
  s_waitcnt vmcnt(16)
  s_barrier
  s_waitcnt vmcnt(0)
  s_barrier
  s_barrier
  s_cmp_lg_u32 s82, 0
  s_cbranch_scc1 L_lend
  s_mov_b32 s11, 0
  s_mov_b32 s15, 65536
  s_mul_i32 s5, s76, 16
  s_lshl_b32 s5, s5, 14
  s_add_u32 s5, s5, 35651584
  s_and_b32 s4, s76, 7
  s_add_u32 s6, s4, 1
  v_cmp_lt_u32 vcc, s6, v1
  v_add_u32 v9, s4, v1
  s_nop 0
  v_subbrev_co_u32 v9, vcc, 0, v9, vcc
  v_and_b32 v9, 7, v9
  v_subrev_u32 v2, 9, v1
  v_cmp_le_u32 vcc, s4, v2
  s_nop 1
  v_addc_co_u32 v2, vcc, 8, v2, vcc
  v_cmp_le_u32 vcc, 9, v1
  s_nop 1
  v_cndmask_b32 v9, v9, v2, vcc
  s_add_u32 s4, s4, Lz1-Lz0+8
  s_mov_b32 m0, s6
  s_nop 0
  v_writelane_b32 v9, s4, m0
  s_and_b32 s4, s76, 8
  v_xor_b32 v9, s4, v9
  v_cmp_eq_u32 vcc, s78, v9
  s_nop 0
  v_mov_b32_dpp v2, v9 row_shr:1 row_mask:0xf bank_mask:0xf
  s_ff1_i32_b32 s4, vcc_lo
  v_cmp_ge_u32 vcc, s4, v1
  s_nop 1
  v_cndmask_b32 v9, v9, v2, vcc
  v_writelane_b32 v9, s78, 0
  v_lshlrev_b32_e64 v11, 7, v9
  v_lshl_add_u32 v9, v9, 14, s5
  s_lshl_b32 s6, s76, Lz1-Lz0+14
  v_readlane_b32 s7, v9, 1
  s_mov_b32 s11, 16384
  s_add_u32 s91, s91, 8
  s_mov_b32 s90, 0x3e
  s_barrier
  s_mov_b32 s82, 1
  s_add_u32 s83, s83, 0
  s_add_u32 s87, s87, 32
  s_mov_b32 s89, 200000
  s_mov_b32 exec_lo, s90
  s_mov_b32 exec_hi, 0
  buffer_load_dword v12, v11, s[40:43], s91 offen sc0 sc1
Lp_127:
  s_waitcnt vmcnt(0)
  v_cmp_ne_u32 vcc, 0, v12
  s_andn2_b32 s3, exec_lo, vcc_lo
  s_cbranch_scc0 Lp_128
  s_mov_b32 exec_lo, s3
  s_sleep 1
  buffer_load_dword v12, v11, s[40:43], s91 offen sc0 sc1
  s_sub_u32 s89, s89, 1
  s_cbranch_scc0 Lp_127
Lp_128:
  s_mov_b64 exec, -1
  s_branch L_xlayer
  s_nop 0
L_s1:
  v_mov_b32 v11, 1
  v_mov_b32 v2, 156416
  ds_write_b128 v2, v[24:27]
  v_and_b32 v2, 31, v1
  v_lshlrev_b32 v5, 7, v2
  v_lshlrev_b32 v10, 3, v2
  v_lshrrev_b32 v3, 5, v1
  v_mul_u32_u24 v3, 320, v3
  v_add_u32_e64 v10, v3, v10
  v_add_u32 v10, 151552, v10
  v_bfe_u32 v3, v1, 3, 1
  v_and_b32 v2, 7, v1
  v_lshlrev_b32 v12, 9, v3
  v_lshl_add_u32 v12, v2, 4, v12
  v_mul_u32_u24 v3, 320, v3
  v_lshl_add_u32 v13, v2, 3, v3
  v_add_u32 v13, 151808, v13
  v_and_b32 v2, 15, v1
  v_lshlrev_b32 v8, 4, v2
  v_lshlrev_b32 v15, 6, v2
  v_and_b32 v3, 48, v1
  v_add_u32 v15, v15, v3
  v_and_b32 v2, 14, v1
  v_lshlrev_b32 v6, 2, v2
  v_lshlrev_b32 v14, 16, v1
  s_lshl_b32 s4, s77, 12
  s_lshl_b32 s5, s76, 7
  s_add_u32 s4, s4, s5
  v_add_u32 v14, s4, v14
  v_lshrrev_b32 v2, 2, v1
  v_lshlrev_b32 v22, 7, v2
  v_lshlrev_b32 v96, 6, v2
  v_and_b32 v2, 3, v1
  v_lshl_add_u32 v22, v2, 3, v22
  v_lshl_add_u32 v96, v2, 3, v96
  v_add_u32 v22, 65536, v22
  v_add_u32 v96, 90112, v96
  v_bfe_u32 v3, v1, 3, 2
  v_xor_b32_e64 v2, 0, v3
  v_lshl_add_u32 v16, v2, 5, v22
  v_xor_b32_e64 v2, 1, v3
  v_lshl_add_u32 v17, v2, 5, v22
  v_xor_b32_e64 v2, 2, v3
  v_lshl_add_u32 v18, v2, 5, v22
  v_xor_b32_e64 v2, 3, v3
  v_lshl_add_u32 v19, v2, 5, v22
  v_bfe_u32 v3, v1, 4, 1
  v_xor_b32_e64 v2, 0, v3
  v_lshl_add_u32 v20, v2, 5, v96
  v_xor_b32_e64 v2, 1, v3
  v_lshl_add_u32 v21, v2, 5, v96
  v_mov_b32 v22, 0x3f803f80
  s_mul_i32 s4, s76, 11
  s_lshr_b32 s4, s4, 5
  s_mul_i32 s4, s4, 3
  s_and_b32 s14, s76, 1
  s_mov_b32 s15, 32768
  s_mul_i32 s4, s14, 24576
  v_add_u32 v16, s4, v16
  v_add_u32 v17, s4, v17
  v_add_u32 v18, s4, v18
  v_add_u32 v19, s4, v19
  s_mov_b32 s98, 0x00010001
  s_mov_b32 s99, 0x00010001
  v_cndmask_b32_e64 v200, 0, v22, s[98:99]
  v_cndmask_b32_e64 v201, 0, v22, s[98:99]
  v_cndmask_b32_e64 v202, 0, v22, s[98:99]
  v_cndmask_b32_e64 v203, 0, v22, s[98:99]
  s_nop 0
  s_lshl_b64 s[98:99], s[98:99], 1
  v_cndmask_b32_e64 v204, 0, v22, s[98:99]
  v_cndmask_b32_e64 v205, 0, v22, s[98:99]
  v_cndmask_b32_e64 v206, 0, v22, s[98:99]
  v_cndmask_b32_e64 v207, 0, v22, s[98:99]
  s_nop 0
  s_lshl_b64 s[98:99], s[98:99], 1
  v_cndmask_b32_e64 v208, 0, v22, s[98:99]
  v_cndmask_b32_e64 v209, 0, v22, s[98:99]
  v_cndmask_b32_e64 v210, 0, v22, s[98:99]
  v_cndmask_b32_e64 v211, 0, v22, s[98:99]
  s_nop 0
  s_lshl_b64 s[98:99], s[98:99], 1
  v_cndmask_b32_e64 v212, 0, v22, s[98:99]
  v_cndmask_b32_e64 v213, 0, v22, s[98:99]
  v_cndmask_b32_e64 v214, 0, v22, s[98:99]
  v_cndmask_b32_e64 v215, 0, v22, s[98:99]
  s_nop 0
  s_lshl_b64 s[98:99], s[98:99], 1
  v_cndmask_b32_e64 v216, 0, v22, s[98:99]
  v_cndmask_b32_e64 v217, 0, v22, s[98:99]
  v_cndmask_b32_e64 v218, 0, v22, s[98:99]
  v_cndmask_b32_e64 v219, 0, v22, s[98:99]
  s_nop 0
  s_lshl_b64 s[98:99], s[98:99], 1
  v_cndmask_b32_e64 v220, 0, v22, s[98:99]
  v_cndmask_b32_e64 v221, 0, v22, s[98:99]
  v_cndmask_b32_e64 v222, 0, v22, s[98:99]
  v_cndmask_b32_e64 v223, 0, v22, s[98:99]
  s_nop 0
  s_lshl_b64 s[98:99], s[98:99], 1
  v_cndmask_b32_e64 v224, 0, v22, s[98:99]
  v_cndmask_b32_e64 v225, 0, v22, s[98:99]
  v_cndmask_b32_e64 v226, 0, v22, s[98:99]
  v_cndmask_b32_e64 v227, 0, v22, s[98:99]
  s_nop 0
  s_lshl_b64 s[98:99], s[98:99], 1
  v_cndmask_b32_e64 v228, 0, v22, s[98:99]
  v_cndmask_b32_e64 v229, 0, v22, s[98:99]
  v_cndmask_b32_e64 v230, 0, v22, s[98:99]
  v_cndmask_b32_e64 v231, 0, v22, s[98:99]
  s_nop 0
  s_lshl_b64 s[98:99], s[98:99], 1
  v_cndmask_b32_e64 v232, 0, v22, s[98:99]
  v_cndmask_b32_e64 v233, 0, v22, s[98:99]
  v_cndmask_b32_e64 v234, 0, v22, s[98:99]
  v_cndmask_b32_e64 v235, 0, v22, s[98:99]
  s_nop 0
  s_lshl_b64 s[98:99], s[98:99], 1
  v_cndmask_b32_e64 v236, 0, v22, s[98:99]
  v_cndmask_b32_e64 v237, 0, v22, s[98:99]
  v_cndmask_b32_e64 v238, 0, v22, s[98:99]
  v_cndmask_b32_e64 v239, 0, v22, s[98:99]
  s_nop 0
  s_lshl_b64 s[98:99], s[98:99], 1
  v_cndmask_b32_e64 v240, 0, v22, s[98:99]
  v_cndmask_b32_e64 v241, 0, v22, s[98:99]
  v_cndmask_b32_e64 v242, 0, v22, s[98:99]
  v_cndmask_b32_e64 v243, 0, v22, s[98:99]
  s_nop 0
  s_lshl_b64 s[98:99], s[98:99], 1
  v_cndmask_b32_e64 v244, 0, v22, s[98:99]
  v_cndmask_b32_e64 v245, 0, v22, s[98:99]
  v_cndmask_b32_e64 v246, 0, v22, s[98:99]
  v_cndmask_b32_e64 v247, 0, v22, s[98:99]
  s_lshl_b64 s[98:99], s[98:99], 1
  s_mov_b32 s56, s24
  s_and_b32 s57, s25, 0xffff
  s_mov_b32 s58, 7340032
  s_mov_b32 s59, 0x00020000
  s_nop 0
  s_mov_b32 s60, s28
  s_and_b32 s61, s29, 0xffff
  s_mov_b32 s62, 7340032
  s_mov_b32 s63, 0x00020000
  s_mul_i32 s12, s84, Lz1-Lz0+14
  s_add_u32 s12, s12, 20480
  s_mov_b32 s13, s12
  v_lshlrev_b32 v110, 7, v1
  s_mov_b32 s8, 0x00500005
  s_mov_b32 s9, 0x50000500
L_slayer:
  s_barrier
  s_cmp_lg_u32 s82, Lz1-Lz0+0
  s_cbranch_scc1 L_130
  buffer_load_dwordx4 v[128:131], v108, s[44:47], s7 offen offset:0
  buffer_load_dwordx4 v[132:135], v108, s[44:47], s7 offen offset:128
  buffer_load_dwordx4 v[136:139], v108, s[44:47], s7 offen offset:256
  buffer_load_dwordx4 v[140:143], v108, s[44:47], s7 offen offset:384
  buffer_load_dwordx4 v[144:147], v108, s[44:47], s7 offen offset:512
  buffer_load_dwordx4 v[148:151], v108, s[44:47], s7 offen offset:640
  buffer_load_dwordx4 v[152:155], v108, s[44:47], s7 offen offset:768
  buffer_load_dwordx4 v[156:159], v108, s[44:47], s7 offen offset:896
  buffer_load_dwordx4 v[160:163], v108, s[44:47], s7 offen offset:1024
  buffer_load_dwordx4 v[164:167], v108, s[44:47], s7 offen offset:1152
  buffer_load_dwordx4 v[168:171], v108, s[44:47], s7 offen offset:1280
  buffer_load_dwordx4 v[172:175], v108, s[44:47], s7 offen offset:1408
  buffer_load_dwordx4 v[176:179], v108, s[44:47], s7 offen offset:1536
  buffer_load_dwordx4 v[180:183], v108, s[44:47], s7 offen offset:1664
  buffer_load_dwordx4 v[184:187], v108, s[44:47], s7 offen offset:1792
  buffer_load_dwordx4 v[188:191], v108, s[44:47], s7 offen offset:1920
  s_waitcnt vmcnt(16)
  s_lshl_b32 s4, s76, 4
  s_mov_b64 exec, 1
  buffer_atomic_add v11, v24, s[68:71], s4 offen sc1
  s_mov_b64 exec, -1
L_130:
  s_cmp_le_u32 s14, 0
  s_cbranch_scc1 L_132
  s_barrier
L_132:
  s_cmp_le_u32 s14, 1
  s_cbranch_scc1 L_133
  s_barrier
L_133:
  s_cmp_lg_u32 s82, 0
  s_cbranch_scc1 L_134
  ds_read_b64_tr_b16 v[32:33], v16 offset:0
  ds_read_b64_tr_b16 v[34:35], v16 offset:2048
  ds_read_b64_tr_b16 v[36:37], v17 offset:0
  ds_read_b64_tr_b16 v[38:39], v17 offset:2048
  ds_read_b64_tr_b16 v[40:41], v18 offset:0
  ds_read_b64_tr_b16 v[42:43], v18 offset:2048
  ds_read_b64_tr_b16 v[44:45], v19 offset:0
  ds_read_b64_tr_b16 v[46:47], v19 offset:2048
  ds_read_b64_tr_b16 v[48:49], v16 offset:4096
  ds_read_b64_tr_b16 v[50:51], v16 offset:6144
  ds_read_b64_tr_b16 v[52:53], v17 offset:4096
  ds_read_b64_tr_b16 v[54:55], v17 offset:6144
  s_nop 0
  s_waitcnt lgkmcnt(4)
  ds_read_b64_tr_b16 v[56:57], v18 offset:4096
  ds_read_b64_tr_b16 v[58:59], v18 offset:6144
  ds_read_b64_tr_b16 v[60:61], v19 offset:4096
  ds_read_b64_tr_b16 v[62:63], v19 offset:6144
  v_add_u32 v16, 8192, v16
  v_add_u32 v17, 8192, v17
  v_add_u32 v18, 8192, v18
  v_add_u32 v19, 8192, v19
  s_nop 0
  s_waitcnt lgkmcnt(2)
  ds_read_b64_tr_b16 v[64:65], v16 offset:0
  ds_read_b64_tr_b16 v[66:67], v16 offset:2048
  ds_read_b64_tr_b16 v[68:69], v17 offset:0
  ds_read_b64_tr_b16 v[70:71], v17 offset:2048
  ds_read_b64_tr_b16 v[72:73], v18 offset:0
  ds_read_b64_tr_b16 v[74:75], v18 offset:2048
  ds_read_b64_tr_b16 v[76:77], v19 offset:0
  ds_read_b64_tr_b16 v[78:79], v19 offset:2048
  ds_read_b64_tr_b16 v[80:81], v16 offset:4096
  ds_read_b64_tr_b16 v[82:83], v16 offset:6144
  ds_read_b64_tr_b16 v[84:85], v17 offset:4096
  ds_read_b64_tr_b16 v[86:87], v17 offset:6144
  s_nop 0
  s_waitcnt lgkmcnt(4)
  ds_read_b64_tr_b16 v[88:89], v18 offset:4096
  ds_read_b64_tr_b16 v[90:91], v18 offset:6144
  ds_read_b64_tr_b16 v[92:93], v19 offset:4096
  ds_read_b64_tr_b16 v[94:95], v19 offset:6144
  v_add_u32 v16, 8192, v16
  v_add_u32 v17, 8192, v17
  v_add_u32 v18, 8192, v18
  v_add_u32 v19, 8192, v19
  v_mfma_f32_16x16x32_bf16 v[28:31], v[32:35], v[200:203], 0
  v_mfma_f32_16x16x32_bf16 v[28:31], v[36:39], v[204:207], v[28:31]
  v_mfma_f32_16x16x32_bf16 v[28:31], v[40:43], v[208:211], v[28:31]
  v_mfma_f32_16x16x32_bf16 v[28:31], v[44:47], v[212:215], v[28:31]
  v_mfma_f32_16x16x32_bf16 v[28:31], v[48:51], v[200:203], v[28:31]
  v_mfma_f32_16x16x32_bf16 v[28:31], v[52:55], v[204:207], v[28:31]
  v_mfma_f32_16x16x32_bf16 v[28:31], v[56:59], v[208:211], v[28:31]
  v_mfma_f32_16x16x32_bf16 v[28:31], v[60:63], v[212:215], v[28:31]
  s_nop 0
  s_waitcnt lgkmcnt(2)
  ds_read_b64_tr_b16 v[32:33], v16 offset:0
  ds_read_b64_tr_b16 v[34:35], v16 offset:2048
  ds_read_b64_tr_b16 v[36:37], v17 offset:0
  ds_read_b64_tr_b16 v[38:39], v17 offset:2048
  ds_read_b64_tr_b16 v[40:41], v18 offset:0
  ds_read_b64_tr_b16 v[42:43], v18 offset:2048
  ds_read_b64_tr_b16 v[44:45], v19 offset:0
  ds_read_b64_tr_b16 v[46:47], v19 offset:2048
  ds_read_b64_tr_b16 v[48:49], v16 offset:4096
  ds_read_b64_tr_b16 v[50:51], v16 offset:6144
  ds_read_b64_tr_b16 v[52:53], v17 offset:4096
  ds_read_b64_tr_b16 v[54:55], v17 offset:6144
  s_nop 0
  s_waitcnt lgkmcnt(4)
  ds_read_b64_tr_b16 v[56:57], v18 offset:4096
  ds_read_b64_tr_b16 v[58:59], v18 offset:6144
  ds_read_b64_tr_b16 v[60:61], v19 offset:4096
  ds_read_b64_tr_b16 v[62:63], v19 offset:6144
  v_mfma_f32_16x16x32_bf16 v[28:31], v[64:67], v[216:219], v[28:31]
  v_mfma_f32_16x16x32_bf16 v[28:31], v[68:71], v[220:223], v[28:31]
  v_mfma_f32_16x16x32_bf16 v[28:31], v[72:75], v[224:227], v[28:31]
  v_mfma_f32_16x16x32_bf16 v[28:31], v[76:79], v[228:231], v[28:31]
  v_mfma_f32_16x16x32_bf16 v[28:31], v[80:83], v[216:219], v[28:31]
  v_mfma_f32_16x16x32_bf16 v[28:31], v[84:87], v[220:223], v[28:31]
  v_mfma_f32_16x16x32_bf16 v[28:31], v[88:91], v[224:227], v[28:31]
  v_mfma_f32_16x16x32_bf16 v[28:31], v[92:95], v[228:231], v[28:31]
  s_waitcnt lgkmcnt(0)
L_134:
  s_barrier
  s_cmp_lg_u32 s82, 0
  s_cbranch_scc1 L_136
  v_mfma_f32_16x16x32_bf16 v[28:31], v[32:35], v[232:235], v[28:31]
  v_mfma_f32_16x16x32_bf16 v[28:31], v[36:39], v[236:239], v[28:31]
  v_mfma_f32_16x16x32_bf16 v[28:31], v[40:43], v[240:243], v[28:31]
  v_mfma_f32_16x16x32_bf16 v[28:31], v[44:47], v[244:247], v[28:31]
  v_mfma_f32_16x16x32_bf16 v[28:31], v[48:51], v[232:235], v[28:31]
  v_mfma_f32_16x16x32_bf16 v[28:31], v[52:55], v[236:239], v[28:31]
  v_mfma_f32_16x16x32_bf16 v[28:31], v[56:59], v[240:243], v[28:31]
  v_mfma_f32_16x16x32_bf16 v[28:31], v[60:63], v[244:247], v[28:31]
  s_lshl_b32 s5, s77, 14
  s_lshl_b32 s4, s76, 10
  s_add_u32 s5, s5, s4
  s_add_u32 s5, s5, 1114112
  s_nop 3
  buffer_store_dwordx4 v[28:31], v15, s[40:43], s5 offen sc0 sc1
  s_branch L_137
L_136:
  s_lshl_b32 s91, s84, 1
  s_add_u32 s91, s91, s87
  s_add_u32 s91, s91, 0xfffffff0
  s_mov_b32 s16, 0xffff
  s_mov_b32 exec_lo, s16
  s_mov_b32 exec_hi, 0
  buffer_load_dword v7, v5, s[40:43], s91 offen sc0 sc1
  s_mov_b64 exec, -1
L_137:
  s_barrier
  s_cmp_lg_u32 s82, 0
  s_cbranch_scc1 L_138
  s_branch L_139
L_138:
  s_waitcnt vmcnt(0)
  s_mov_b32 s89, 200000
  s_mov_b32 exec_lo, s16
  s_mov_b32 exec_hi, 0
  s_branch Lp_141
Lp_140:
  buffer_load_dword v7, v5, s[40:43], s91 offen sc0 sc1
  s_waitcnt vmcnt(0)
Lp_141:
  v_cmp_ne_u32 vcc, 0, v7
  s_andn2_b32 s3, s16, vcc_lo
  s_cbranch_scc0 Lp_142
  s_sleep 1
  s_sub_u32 s89, s89, 1
  s_cbranch_scc0 Lp_140
Lp_142:
  s_mov_b64 exec, -1
  s_add_u32 s5, s84, s92
  buffer_load_dwordx2 v[96:97], v6, s[40:43], s5 offen offset:0 sc1
  buffer_load_dwordx2 v[98:99], v6, s[40:43], s5 offen offset:512 sc1
  buffer_load_dwordx2 v[100:101], v6, s[40:43], s5 offen offset:1024 sc1
  buffer_load_dwordx2 v[102:103], v6, s[40:43], s5 offen offset:1536 sc1
L_139:
  s_barrier
  s_cmp_gt_u32 s14, 0
  s_cbranch_scc1 L_143
  s_barrier
L_143:
  s_cmp_gt_u32 s14, Lz1-Lz0+1
  s_cbranch_scc1 L_144
  s_barrier
L_144:
  s_cmp_lg_u32 s82, 0
  s_cbranch_scc1 L_145
  s_waitcnt vmcnt(2)
  buffer_load_dword v9, v8, s[68:71], 0 offen sc0 sc1
  s_mov_b32 s72, s26
  s_and_b32 s73, s27, 0xffff
  s_mov_b32 s74, 7168
  s_mov_b32 s75, 0x00020000
  s_mul_i32 s4, s77, 448
  s_and_b32 s5, s77, Lz1-Lz0+1
  s_lshl_b32 s6, s5, 6
  s_add_u32 s6, s6, s4
  s_mul_i32 s5, s5, 384
  s_sub_u32 s5, s4, s5
  v_lshlrev_b32 v2, 1, v1
  v_lshrrev_b32 v3, 1, v2
  v_xor_b32 v3, v3, v2
  v_and_b32 v3, 16, v3
  v_mul_u32_u24 v3, 3, v3
  v_xor_b32_e64 v3, v3, v2
  buffer_load_ushort v104, v2, s[72:75], s6 offen offset:0
  buffer_load_ushort v105, v2, s[72:75], s6 offen offset:128
  buffer_load_ushort v106, v2, s[72:75], s6 offen offset:256
  buffer_load_ushort v107, v3, s[72:75], s5 offen offset:384
  s_nop 0
  s_mov_b32 s64, s30
  s_and_b32 s65, s31, 0xffff
  s_mov_b32 s66, 2048
  s_mov_b32 s67, 0x00020000
  s_lshl_b32 s4, s78, Lz1-Lz0+7
  buffer_load_ushort v108, v2, s[64:67], s4 offen
  v_mov_b32 v32, v22
  v_mov_b32 v33, v22
  v_mov_b32_e64 v34, v22
  v_mov_b32 v35, v22
  s_nop 1
  v_mfma_f32_16x16x32_bf16 v[96:99], v[32:35], v[128:131], 0
  v_mfma_f32_16x16x32_bf16 v[100:103], v[128:131], v[128:131], 0
  v_mfma_f32_16x16x32_bf16 v[96:99], v[32:35], v[132:135], v[96:99]
  v_mfma_f32_16x16x32_bf16 v[100:103], v[132:135], v[132:135], v[100:103]
  v_mfma_f32_16x16x32_bf16 v[96:99], v[32:35], v[136:139], v[96:99]
  v_mfma_f32_16x16x32_bf16 v[100:103], v[136:139], v[136:139], v[100:103]
  v_mfma_f32_16x16x32_bf16 v[96:99], v[32:35], v[140:143], v[96:99]
  v_mfma_f32_16x16x32_bf16 v[100:103], v[140:143], v[140:143], v[100:103]
L_145:
  s_barrier
  s_cmp_lg_u32 s82, Lz1-Lz0+0
  s_cbranch_scc1 L_147
  v_mfma_f32_16x16x32_bf16 v[96:99], v[32:35], v[144:147], v[96:99]
  v_mfma_f32_16x16x32_bf16 v[100:103], v[144:147], v[144:147], v[100:103]
  v_mfma_f32_16x16x32_bf16 v[96:99], v[32:35], v[148:151], v[96:99]
  v_mfma_f32_16x16x32_bf16 v[100:103], v[148:151], v[148:151], v[100:103]
  v_mfma_f32_16x16x32_bf16 v[96:99], v[32:35], v[152:155], v[96:99]
  v_mfma_f32_16x16x32_bf16 v[100:103], v[152:155], v[152:155], v[100:103]
  v_mfma_f32_16x16x32_bf16 v[96:99], v[32:35], v[156:159], v[96:99]
  v_mfma_f32_16x16x32_bf16 v[100:103], v[156:159], v[156:159], v[100:103]
L_147:
  s_barrier
  s_cmp_lg_u32 s82, Lz1-Lz0+0
  s_cbranch_scc1 L_149
  v_mfma_f32_16x16x32_bf16 v[96:99], v[32:35], v[160:163], v[96:99]
  v_mfma_f32_16x16x32_bf16 v[100:103], v[160:163], v[160:163], v[100:103]
  v_mfma_f32_16x16x32_bf16 v[96:99], v[32:35], v[164:167], v[96:99]
  v_mfma_f32_16x16x32_bf16 v[100:103], v[164:167], v[164:167], v[100:103]
  v_mfma_f32_16x16x32_bf16 v[96:99], v[32:35], v[168:171], v[96:99]
  v_mfma_f32_16x16x32_bf16 v[100:103], v[168:171], v[168:171], v[100:103]
  v_mfma_f32_16x16x32_bf16 v[96:99], v[32:35], v[172:175], v[96:99]
  v_mfma_f32_16x16x32_bf16 v[100:103], v[172:175], v[172:175], v[100:103]
  s_waitcnt vmcnt(0)
  s_mov_b32 s89, 200000
  s_branch Lg_152
Lg_151:
  buffer_load_dword v9, v8, s[68:71], 0 offen sc0 sc1
  s_waitcnt vmcnt(0)
Lg_152:
  v_cmp_eq_u32 vcc, 16, v9
  s_andn2_b32 s3, 0xffff, vcc_lo
  s_cbranch_scc0 Lg_153
  s_sleep 2
  s_sub_u32 s89, s89, 1
  s_cbranch_scc0 Lg_151
Lg_153:
  s_mov_b32 s5, 1835008
  s_mov_b64 exec, 0x101
  buffer_store_dword v11, v14, s[40:43], s5 offen sc0 sc1
  s_mov_b64 exec, -1
  s_getpc_b64 s[4:5]
L_pc0:
  s_sub_u32 s4, s4, L_pc0-mega_kernel
  s_nop 0
  s_subb_u32 s5, s5, 0
  s_bfe_u32 s6, s2, 0x20003
  s_mul_i32 s6, s6, 10240
  v_lshl_add_u32 v3, v1, 4, s6
  v_mov_b32_e64 v119, s5
  v_min_u32 v118, L_end-mega_kernel-16, v3
  v_add_co_u32_e64 v116, vcc, s4, v118
  v_add_u32 v3, 0x400, v3
  s_nop 0
  v_addc_co_u32 v117, vcc, 0, v119, vcc
  global_load_dwordx4 v[112:115], v[116:117], off
  v_min_u32 v118, L_end-mega_kernel-16, v3
  v_add_co_u32_e64 v116, vcc, s4, v118
  v_add_u32 v3, 0x400, v3
  s_nop 0
  v_addc_co_u32 v117, vcc, 0, v119, vcc
  global_load_dwordx4 v[112:115], v[116:117], off
  v_min_u32 v118, L_end-mega_kernel-16, v3
  v_add_co_u32_e64 v116, vcc, s4, v118
  v_add_u32 v3, 0x400, v3
  s_nop 0
  v_addc_co_u32 v117, vcc, 0, v119, vcc
  global_load_dwordx4 v[112:115], v[116:117], off
  v_min_u32 v118, L_end-mega_kernel-16, v3
  v_add_co_u32_e64 v116, vcc, s4, v118
  v_add_u32 v3, 0x400, v3
  s_nop 0
  v_addc_co_u32 v117, vcc, 0, v119, vcc
  global_load_dwordx4 v[112:115], v[116:117], off
  v_min_u32 v118, L_end-mega_kernel-16, v3
  v_add_co_u32 v116, vcc, s4, v118
  s_nop 1
  v_addc_co_u32 v117, vcc, 0, v119, vcc
  global_load_dwordx4 v[112:115], v[116:117], off
L_149:
  s_barrier
  s_cmp_lg_u32 s82, 0
  s_cbranch_scc1 L_154
  v_mfma_f32_16x16x32_bf16 v[96:99], v[32:35], v[176:179], v[96:99]
  v_mfma_f32_16x16x32_bf16 v[100:103], v[176:179], v[176:179], v[100:103]
  v_mfma_f32_16x16x32_bf16 v[96:99], v[32:35], v[180:183], v[96:99]
  v_mfma_f32_16x16x32_bf16 v[100:103], v[180:183], v[180:183], v[100:103]
  v_mfma_f32_16x16x32_bf16 v[96:99], v[32:35], v[184:187], v[96:99]
  v_mfma_f32_16x16x32_bf16 v[100:103], v[184:187], v[184:187], v[100:103]
  v_mfma_f32_16x16x32_bf16 v[96:99], v[32:35], v[188:191], v[96:99]
  v_mfma_f32_16x16x32_bf16 v[100:103], v[188:191], v[188:191], v[100:103]
  s_getpc_b64 s[4:5]
L_pc1:
  s_sub_u32 s4, s4, L_pc1-mega_kernel
  s_subb_u32 s5, s5, 0
  s_bfe_u32 s6, s2, 0x20003
  s_mul_i32 s6, s6, 10240
  s_add_u32 s6, s6, 5120
  v_lshl_add_u32 v3, v1, 4, s6
  v_mov_b32_e64 v119, s5
  v_min_u32 v118, L_end-mega_kernel-16, v3
  v_add_co_u32_e64 v116, vcc, s4, v118
  v_add_u32 v3, 0x400, v3
  s_nop 0
  v_addc_co_u32 v117, vcc, 0, v119, vcc
  global_load_dwordx4 v[112:115], v[116:117], off
  v_min_u32 v118, L_end-mega_kernel-16, v3
  v_add_co_u32_e64 v116, vcc, s4, v118
  v_add_u32 v3, 0x400, v3
  s_nop 0
  v_addc_co_u32 v117, vcc, 0, v119, vcc
  global_load_dwordx4 v[112:115], v[116:117], off
  v_min_u32 v118, L_end-mega_kernel-16, v3
  v_add_co_u32_e64 v116, vcc, s4, v118
  v_add_u32 v3, 0x400, v3
  s_nop 0
  v_addc_co_u32 v117, vcc, 0, v119, vcc
  global_load_dwordx4 v[112:115], v[116:117], off
  v_min_u32 v118, L_end-mega_kernel-16, v3
  v_add_co_u32_e64 v116, vcc, s4, v118
  v_add_u32 v3, 0x400, v3
  s_nop 0
  v_addc_co_u32 v117, vcc, 0, v119, vcc
  global_load_dwordx4 v[112:115], v[116:117], off
  v_min_u32 v118, L_end-mega_kernel-16, v3
  v_add_co_u32 v116, vcc, s4, v118
  s_nop 1
  v_addc_co_u32_e64 v117, vcc, 0, v119, vcc
  global_load_dwordx4 v[112:115], v[116:117], off
  s_mov_b32 s98, 0xaaaaaaaa
  s_mov_b32 s99, 0xaaaaaaaa
  v_cndmask_b32_e64 v100, v100, v101, s[98:99]
  v_cndmask_b32_e64 v102, v102, v103, s[98:99]
  s_mov_b32 s98, 0xcccccccc
  s_mov_b32 s99, 0xcccccccc
  v_cndmask_b32_e64 v97, v100, v102, s[98:99]
  v_add_f32_dpp v96, v96, v96 quad_perm:[1,0,3,2] row_mask:0xf bank_mask:0xf
  s_nop 0
  v_add_f32_dpp v97, v97, v97 quad_perm:[1,0,3,2] row_mask:0xf bank_mask:0xf
  s_branch L_155
L_154:
  s_waitcnt vmcnt(0)
  v_add_f32 v96, v96, v100
  v_add_f32 v97, v97, v101
  v_add_f32 v98, v98, v102
  v_add_f32 v99, v99, v103
  v_add_f32 v96, v96, v98
  v_add_f32 v97, v97, v99
  s_nop 0
  v_add_f32_dpp v96, v96, v96 row_ror:8 row_mask:0xf bank_mask:0xf
  v_add_f32_dpp v97, v97, v97 row_ror:8 row_mask:0xf bank_mask:0xf
  v_mov_b32 v98, v96
  v_mov_b32 v99, v97
  s_nop 0
  v_permlane16_swap_b32 v96, v98
  v_permlane16_swap_b32 v97, v99
  v_add_f32 v96, v96, v98
  v_add_f32 v97, v97, v99
  v_mov_b32 v98, v96
  v_mov_b32 v99, v97
  s_nop 0
  v_permlane32_swap_b32 v96, v98
  v_permlane32_swap_b32 v97, v99
  v_add_f32 v96, v96, v98
  v_add_f32 v97, v97, v99
L_155:
  v_mul_f32 v96, 0x3a800000, v96
  v_mul_f32 v97, 0x3a800000, v97
  v_fma_f32 v98, -v96, v96, v97
  v_max_f32_e64 v98, 0, v98
  v_add_f32 v98, 0x3727c5ac, v98
  v_rsq_f32 v98, v98
  s_nop 0
  v_mul_f32 v99, v96, v98
  s_mov_b64 exec, s[8:9]
  buffer_store_dwordx2 v[98:99], v6, s[40:43], s10 offen sc0 sc1
  s_mov_b64 exec, -1
  s_barrier
  s_cmp_lg_u32 s82, 0
  s_cbranch_scc1 L_156
  v_lshlrev_b32_e64 v6, 3, v1
  s_mov_b64 s[8:9], 0xff
  s_lshl_b32 s91, s84, Lz1-Lz0+1
  s_and_b32 s91, s91, 0x8f000
  s_add_u32 s91, s91, 1835008
  s_mov_b32 exec_lo, 0xffff
  s_mov_b32 exec_hi, Lz1-Lz0+0
  buffer_load_dword v7, v5, s[40:43], s91 offen sc0 sc1
  s_mov_b64 exec, -1
L_156:
  s_barrier
  s_barrier
  s_waitcnt vmcnt(0)
  s_and_b32 s5, s10, 0xfffffc00
  buffer_load_dwordx4 v[120:123], v4, s[40:43], s5 offen sc1
  s_cmp_lg_u32 s82, 0
  s_cbranch_scc1 L_158
  s_mov_b32 s89, 200000
  s_mov_b32 exec_lo, 0xffff
  s_mov_b32 exec_hi, 0
  s_branch Lp_161
Lp_160:
  buffer_load_dword v7, v5, s[40:43], s91 offen sc0 sc1
  s_waitcnt vmcnt(0)
Lp_161:
  v_cmp_ne_u32 vcc, 0, v7
  s_andn2_b32 s3, 0xffff, vcc_lo
  s_cbranch_scc0 Lp_162
  s_sleep 1
  s_sub_u32 s89, s89, 1
  s_cbranch_scc0 Lp_160
Lp_162:
  s_mov_b64 exec, -1
  s_lshl_b32 s5, s77, 14
  s_add_u32 s5, s5, 1114112
  buffer_load_dwordx4 v[192:195], v4, s[40:43], s5 offen offset:0 sc1
  buffer_load_dwordx4 v[196:199], v4, s[40:43], s5 offen offset:1024 sc1
  buffer_load_dwordx4 v[200:203], v4, s[40:43], s5 offen offset:2048 sc1
  buffer_load_dwordx4 v[204:207], v4, s[40:43], s5 offen offset:3072 sc1
  s_add_u32 s5, s5, 4096
  buffer_load_dwordx4 v[208:211], v4, s[40:43], s5 offen offset:0 sc1
  buffer_load_dwordx4 v[212:215], v4, s[40:43], s5 offen offset:1024 sc1
  buffer_load_dwordx4 v[216:219], v4, s[40:43], s5 offen offset:2048 sc1
  buffer_load_dwordx4 v[220:223], v4, s[40:43], s5 offen offset:3072 sc1
L_158:
  s_barrier
  s_cmp_lg_u32 s82, 0
  s_cbranch_scc1 L_163
  s_lshl_b32 s5, s77, 14
  s_add_u32 s5, s5, 1122304
  buffer_load_dwordx4 v[224:227], v4, s[40:43], s5 offen offset:0 sc1
  buffer_load_dwordx4 v[228:231], v4, s[40:43], s5 offen offset:1024 sc1
  buffer_load_dwordx4 v[232:235], v4, s[40:43], s5 offen offset:2048 sc1
  buffer_load_dwordx4 v[236:239], v4, s[40:43], s5 offen offset:3072 sc1
  s_add_u32 s5, s5, 4096
  buffer_load_dwordx4 v[240:243], v4, s[40:43], s5 offen offset:0 sc1
  buffer_load_dwordx4 v[244:247], v4, s[40:43], s5 offen offset:1024 sc1
  buffer_load_dwordx4 v[248:251], v4, s[40:43], s5 offen offset:2048 sc1
  buffer_load_dwordx4 v[252:255], v4, s[40:43], s5 offen offset:3072 sc1
L_163:
  s_barrier
  s_cmp_lg_u32 s82, 0
  s_cbranch_scc1 L_165
  s_waitcnt vmcnt(16)
  s_branch L_166
L_165:
  s_waitcnt vmcnt(0)
L_166:
  s_mov_b32 s89, 200000
  s_branch Lp_168
  s_nop 0
Lp_167:
  s_and_b32 s5, s10, 0xfffffc00
  buffer_load_dwordx4 v[120:123], v4, s[40:43], s5 offen sc1
  s_waitcnt vmcnt(0)
Lp_168:
  v_min_u32 v2, v120, v122
  v_cmp_eq_u32 vcc, 0, v2
  s_cmp_eq_u64 vcc, 0
  s_cbranch_scc1 Lp_169
  s_sleep 1
  s_sub_u32 s89, s89, 1
  s_cbranch_scc0 Lp_167
Lp_169:
  s_and_b32 s5, s10, 0xfffffc00
  s_mov_b32 m0, 151552
  s_nop 0
  buffer_load_dword v6, s[40:43], s5 offen offset:0 sc1 lds
  s_mov_b32 m0, 152188
  s_nop 0
  buffer_load_dword v6, s[40:43], s5 offen offset:4 sc1 lds
  s_mov_b32 m0, 151360
  s_nop 0
  buffer_load_dword v6, s[40:43], s5 offen offset:512 sc1 lds
  s_mov_b32 m0, 151996
  s_nop 0
  buffer_load_dword v6, s[40:43], s5 offen offset:516 sc1 lds
  s_add_u32 s10, s10, 16384
  s_cmp_lg_u32 s82, 0
  s_cbranch_scc1 L_170
  buffer_load_dword v109, v110, s[56:59], s12 offen
  s_sub_u32 s12, s12, 8192
L_170:
  s_barrier
  s_cmp_lg_u32 s82, 0
  s_cbranch_scc1 L_172
  s_cmp_lg_u32 s82, 0
  s_cbranch_scc1 L_174
  s_waitcnt vmcnt(1)
  s_branch L_175
L_174:
  s_waitcnt vmcnt(0)
L_175:
  v_add_f32 v192, v192, v224
  v_add_f32 v193, v193, v225
  v_add_f32 v194, v194, v226
  v_add_f32 v195, v195, v227
  v_add_f32 v196, v196, v228
  v_add_f32 v197, v197, v229
  v_add_f32 v198, v198, v230
  v_add_f32 v199, v199, v231
  v_add_f32 v200, v200, v232
  v_add_f32 v201, v201, v233
  v_add_f32 v202, v202, v234
  v_add_f32 v203, v203, v235
  v_add_f32 v204, v204, v236
  v_add_f32 v205, v205, v237
  v_add_f32 v206, v206, v238
  v_add_f32 v207, v207, v239
  v_add_f32 v208, v208, v240
  v_add_f32 v209, v209, v241
  v_add_f32 v210, v210, v242
  v_add_f32 v211, v211, v243
  v_add_f32 v212, v212, v244
  v_add_f32 v213, v213, v245
  v_add_f32 v214, v214, v246
  v_add_f32 v215, v215, v247
  v_add_f32 v216, v216, v248
  v_add_f32 v217, v217, v249
  v_add_f32 v218, v218, v250
  v_add_f32 v219, v219, v251
  v_add_f32 v220, v220, v252
  v_add_f32 v221, v221, v253
  v_add_f32 v222, v222, v254
  v_add_f32 v223, v223, v255
  v_add_f32 v192, v192, v208
  v_add_f32 v193, v193, v209
  v_add_f32 v194, v194, v210
  v_add_f32 v195, v195, v211
  v_add_f32 v196, v196, v212
  v_add_f32 v197, v197, v213
  v_add_f32 v198, v198, v214
  v_add_f32 v199, v199, v215
  v_add_f32 v200, v200, v216
  v_add_f32 v201, v201, v217
  v_add_f32 v202, v202, v218
  v_add_f32 v203, v203, v219
  v_add_f32 v204, v204, v220
  v_add_f32 v205, v205, v221
  v_add_f32 v206, v206, v222
  v_add_f32 v207, v207, v223
  v_add_f32 v192, v192, v200
  v_add_f32 v193, v193, v201
  v_add_f32 v194, v194, v202
  v_add_f32 v195, v195, v203
  v_add_f32 v196, v196, v204
  v_add_f32 v197, v197, v205
  v_add_f32 v198, v198, v206
  v_add_f32 v199, v199, v207
  v_add_f32 v192, v192, v196
  v_add_f32 v193, v193, v197
  v_add_f32 v194, v194, v198
  v_add_f32 v195, v195, v199
  v_add_u32 v2, 153088, v4
  ds_write_b128 v2, v[192:195]
L_172:
  s_cmp_lg_u32 s82, 0
  s_cbranch_scc1 L_176
  buffer_load_dword v109, v110, s[56:59], s12 offen
  s_sub_u32 s12, s12, 8192
L_176:
  s_barrier
  s_cmp_lg_u32 s82, 0
  s_cbranch_scc1 L_178
  s_waitcnt vmcnt(2)
  s_branch L_179
  s_nop 0
L_178:
  s_waitcnt vmcnt(0)
L_179:
  s_waitcnt lgkmcnt(0)
  s_barrier
  s_cmp_lg_u32 s82, 0
  s_cbranch_scc1 L_180
  v_lshlrev_b32 v2, 2, v1
  v_add_u32 v2, 155136, v2
  v_lshlrev_b32_e64 v104, 16, v104
  v_mul_f32 v104, 0x3eeff558, v104
  ds_write_b32 v2, v104 offset:0
  v_lshlrev_b32_e64 v105, 16, v105
  v_mul_f32 v105, 0x3eeff558, v105
  ds_write_b32 v2, v105 offset:256
  v_lshlrev_b32_e64 v106, 16, v106
  v_mul_f32 v106, 0x3eeff558, v106
  ds_write_b32 v2, v106 offset:512
  v_lshlrev_b32_e64 v107, 16, v107
  v_mul_f32 v107, 0x3eeff558, v107
  ds_write_b32 v2, v107 offset:768
  v_lshlrev_b32_e64 v108, 16, v108
  ds_write_b32 v2, v108 offset:1024
  v_lshrrev_b32 v2, 2, v1
  v_lshlrev_b32 v22, 7, v2
  v_lshlrev_b32 v96, 6, v2
  v_and_b32 v2, 3, v1
  v_lshl_add_u32 v22, v2, 3, v22
  v_lshl_add_u32 v96, v2, 3, v96
  v_add_u32 v22, 65536, v22
  v_add_u32 v96, 90112, v96
  v_bfe_u32 v3, v1, 3, 2
  v_xor_b32_e64 v2, 0, v3
  v_lshl_add_u32 v16, v2, 5, v22
  v_xor_b32_e64 v2, 1, v3
  v_lshl_add_u32 v17, v2, 5, v22
  v_xor_b32_e64 v2, 2, v3
  v_lshl_add_u32 v18, v2, 5, v22
  v_xor_b32_e64 v2, 3, v3
  v_lshl_add_u32 v19, v2, 5, v22
  v_bfe_u32 v3, v1, 4, 1
  v_xor_b32_e64 v2, 0, v3
  v_lshl_add_u32 v20, v2, 5, v96
  v_xor_b32_e64 v2, 1, v3
  v_lshl_add_u32 v21, v2, 5, v96
  v_mov_b32 v22, 0x3f803f80
  s_mov_b32 s98, 0x00010001
  s_mov_b32 s99, 0x00010001
  v_cndmask_b32_e64 v200, 0, v22, s[98:99]
  v_cndmask_b32_e64 v201, 0, v22, s[98:99]
  v_cndmask_b32_e64 v202, 0, v22, s[98:99]
  v_cndmask_b32_e64 v203, 0, v22, s[98:99]
  s_nop 0
  s_lshl_b64 s[98:99], s[98:99], 1
  v_cndmask_b32_e64 v204, 0, v22, s[98:99]
  v_cndmask_b32_e64 v205, 0, v22, s[98:99]
  v_cndmask_b32_e64 v206, 0, v22, s[98:99]
  v_cndmask_b32_e64 v207, 0, v22, s[98:99]
  s_nop 0
  s_lshl_b64 s[98:99], s[98:99], 1
  v_cndmask_b32_e64 v208, 0, v22, s[98:99]
  v_cndmask_b32_e64 v209, 0, v22, s[98:99]
  v_cndmask_b32_e64 v210, 0, v22, s[98:99]
  v_cndmask_b32_e64 v211, 0, v22, s[98:99]
  s_nop 0
  s_lshl_b64 s[98:99], s[98:99], 1
  v_cndmask_b32_e64 v212, 0, v22, s[98:99]
  v_cndmask_b32_e64 v213, 0, v22, s[98:99]
  v_cndmask_b32_e64 v214, 0, v22, s[98:99]
  v_cndmask_b32_e64 v215, 0, v22, s[98:99]
  s_nop 0
  s_lshl_b64 s[98:99], s[98:99], 1
  v_cndmask_b32_e64 v216, 0, v22, s[98:99]
  v_cndmask_b32_e64 v217, 0, v22, s[98:99]
  v_cndmask_b32_e64 v218, 0, v22, s[98:99]
  v_cndmask_b32_e64 v219, 0, v22, s[98:99]
  s_nop 0
  s_lshl_b64 s[98:99], s[98:99], 1
  v_cndmask_b32_e64 v220, 0, v22, s[98:99]
  v_cndmask_b32_e64 v221, 0, v22, s[98:99]
  v_cndmask_b32_e64 v222, 0, v22, s[98:99]
  v_cndmask_b32_e64 v223, 0, v22, s[98:99]
  s_nop 0
  s_lshl_b64 s[98:99], s[98:99], 1
  v_cndmask_b32_e64 v224, 0, v22, s[98:99]
  v_cndmask_b32_e64 v225, 0, v22, s[98:99]
  v_cndmask_b32_e64 v226, 0, v22, s[98:99]
  v_cndmask_b32_e64 v227, 0, v22, s[98:99]
  s_nop 0
  s_lshl_b64 s[98:99], s[98:99], 1
  v_cndmask_b32_e64 v228, 0, v22, s[98:99]
  v_cndmask_b32_e64 v229, 0, v22, s[98:99]
  v_cndmask_b32_e64 v230, 0, v22, s[98:99]
  v_cndmask_b32_e64 v231, 0, v22, s[98:99]
  s_nop 0
  s_lshl_b64 s[98:99], s[98:99], 1
  v_cndmask_b32_e64 v232, 0, v22, s[98:99]
  v_cndmask_b32_e64 v233, 0, v22, s[98:99]
  v_cndmask_b32_e64 v234, 0, v22, s[98:99]
  v_cndmask_b32_e64 v235, 0, v22, s[98:99]
  s_nop 0
  s_lshl_b64 s[98:99], s[98:99], 1
  v_cndmask_b32_e64 v236, 0, v22, s[98:99]
  v_cndmask_b32_e64 v237, 0, v22, s[98:99]
  v_cndmask_b32_e64 v238, 0, v22, s[98:99]
  v_cndmask_b32_e64 v239, 0, v22, s[98:99]
  s_nop 0
  s_lshl_b64 s[98:99], s[98:99], 1
  v_cndmask_b32_e64 v240, 0, v22, s[98:99]
  v_cndmask_b32_e64 v241, 0, v22, s[98:99]
  v_cndmask_b32_e64 v242, 0, v22, s[98:99]
  v_cndmask_b32_e64 v243, 0, v22, s[98:99]
  s_nop 0
  s_lshl_b64 s[98:99], s[98:99], 1
  v_cndmask_b32_e64 v244, 0, v22, s[98:99]
  v_cndmask_b32_e64 v245, 0, v22, s[98:99]
  v_cndmask_b32_e64 v246, 0, v22, s[98:99]
  v_cndmask_b32_e64 v247, 0, v22, s[98:99]
  s_nop 0
  s_lshl_b64 s[98:99], s[98:99], 1
  v_cndmask_b32_e64 v248, 0, v22, s[98:99]
  v_cndmask_b32_e64 v249, 0, v22, s[98:99]
  v_cndmask_b32_e64 v250, 0, v22, s[98:99]
  v_cndmask_b32_e64 v251, 0, v22, s[98:99]
  s_nop 0
  s_lshl_b64 s[98:99], s[98:99], 1
  v_cndmask_b32_e64 v252, 0, v22, s[98:99]
  v_cndmask_b32_e64 v253, 0, v22, s[98:99]
  v_cndmask_b32_e64 v254, 0, v22, s[98:99]
  v_cndmask_b32_e64 v255, 0, v22, s[98:99]
  s_lshl_b64 s[98:99], s[98:99], 1
L_180:
  s_lshl_b32 s91, s84, Lz1-Lz0+1
  s_add_u32 s91, s91, s87
  s_barrier
  s_barrier
  s_mov_b32 exec_lo, 0xf7f7
  s_mov_b32 exec_hi, 0
  buffer_load_dword v7, v5, s[40:43], s91 offen sc0 sc1
  s_mov_b64 exec, -1
  s_barrier
  s_barrier
  s_barrier
  s_waitcnt vmcnt(0)
  s_mov_b32 s89, 200000
  s_mov_b32 exec_lo, 0xf7f7
  s_mov_b32 exec_hi, 0
  s_branch Lp_183
Lp_182:
  buffer_load_dword v7, v5, s[40:43], s91 offen sc0 sc1
  s_waitcnt vmcnt(0)
Lp_183:
  v_cmp_ne_u32 vcc, 0, v7
  s_andn2_b32 s3, 0xf7f7, vcc_lo
  s_cbranch_scc0 Lp_184
  s_sleep 1
  s_sub_u32 s89, s89, Lz1-Lz0+1
  s_cbranch_scc0 Lp_182
Lp_184:
  s_mov_b64 exec, -1
  s_barrier
  s_barrier
  s_mov_b32 exec_lo, 0x808
  s_mov_b32 exec_hi, Lz1-Lz0+0
  buffer_load_dword v7, v5, s[40:43], s91 offen sc0 sc1
  s_mov_b64 exec, -1
  s_barrier
  s_barrier
  s_barrier
  s_barrier
  s_waitcnt vmcnt(0)
  s_mov_b32 s89, 200000
  s_mov_b32 exec_lo, 0x808
  s_mov_b32 exec_hi, 0
  s_branch Lp_186
Lp_185:
  buffer_load_dword v7, v5, s[40:43], s91 offen sc0 sc1
  s_waitcnt vmcnt(0)
Lp_186:
  v_cmp_ne_u32 vcc, 0, v7
  s_andn2_b32 s3, 0x808, vcc_lo
  s_cbranch_scc0 Lp_187
  s_sleep 1
  s_sub_u32 s89, s89, Lz1-Lz0+1
  s_cbranch_scc0 Lp_185
Lp_187:
  s_mov_b64 exec, -1
  s_barrier
  s_barrier
  s_barrier
  s_barrier
  s_barrier
  s_barrier
  s_add_u32 s92, s83, 31457280
  s_add_u32 s91, s91, 4
  s_sub_u32 s16, s78, s76
  s_add_u32 s16, s16, 1
  s_and_b32 s16, s16, 15
  s_barrier
  s_cmp_lg_u32 s82, 0
  s_cbranch_scc1 L_188
  s_cmp_eq_u32 s16, 1
  s_cselect_b32 s4, 0, 28672
  v_add_u32 v112, s4, v16
  v_add_u32 v113, s4, v17
  v_add_u32 v114, s4, v18
  v_add_u32 v115, s4, v19
  v_add_u32 v116, s4, v20
  v_add_u32 v117, s4, v21
  ds_read_b64_tr_b16 v[32:33], v112 offset:0
  ds_read_b64_tr_b16 v[34:35], v112 offset:2048
  ds_read_b64_tr_b16 v[36:37], v113 offset:0
  ds_read_b64_tr_b16 v[38:39], v113 offset:2048
  ds_read_b64_tr_b16 v[40:41], v114 offset:0
  ds_read_b64_tr_b16 v[42:43], v114 offset:2048
  ds_read_b64_tr_b16 v[44:45], v115 offset:0
  ds_read_b64_tr_b16 v[46:47], v115 offset:2048
  ds_read_b64_tr_b16 v[48:49], v112 offset:4096
  ds_read_b64_tr_b16 v[50:51], v112 offset:6144
  ds_read_b64_tr_b16 v[52:53], v113 offset:4096
  ds_read_b64_tr_b16 v[54:55], v113 offset:6144
  s_nop 0
  s_waitcnt lgkmcnt(6)
  ds_read_b64_tr_b16 v[56:57], v114 offset:4096
  ds_read_b64_tr_b16 v[58:59], v114 offset:6144
  ds_read_b64_tr_b16 v[60:61], v115 offset:4096
  ds_read_b64_tr_b16 v[62:63], v115 offset:6144
  s_nop 0
  s_waitcnt lgkmcnt(6)
  ds_read_b64_tr_b16 v[64:65], v112 offset:8192
  ds_read_b64_tr_b16 v[66:67], v112 offset:10240
  ds_read_b64_tr_b16 v[68:69], v113 offset:8192
  ds_read_b64_tr_b16 v[70:71], v113 offset:10240
  ds_read_b64_tr_b16 v[72:73], v114 offset:8192
  ds_read_b64_tr_b16 v[74:75], v114 offset:10240
  ds_read_b64_tr_b16 v[76:77], v115 offset:8192
  ds_read_b64_tr_b16 v[78:79], v115 offset:10240
  s_nop 0
  s_waitcnt lgkmcnt(8)
  v_mfma_f32_16x16x32_bf16 v[28:31], v[32:35], v[200:203], 0
  v_mfma_f32_16x16x32_bf16 v[28:31], v[36:39], v[204:207], v[28:31]
  v_mfma_f32_16x16x32_bf16 v[28:31], v[40:43], v[208:211], v[28:31]
  v_mfma_f32_16x16x32_bf16 v[28:31], v[44:47], v[212:215], v[28:31]
  v_mfma_f32_16x16x32_bf16 v[28:31], v[48:51], v[200:203], v[28:31]
  v_mfma_f32_16x16x32_bf16 v[28:31], v[52:55], v[204:207], v[28:31]
  v_mfma_f32_16x16x32_bf16 v[28:31], v[56:59], v[208:211], v[28:31]
  v_mfma_f32_16x16x32_bf16 v[28:31], v[60:63], v[212:215], v[28:31]
  s_nop 0
  s_waitcnt lgkmcnt(7)
  ds_read_b64_tr_b16 v[80:81], v112 offset:12288
  ds_read_b64_tr_b16 v[82:83], v112 offset:14336
  ds_read_b64_tr_b16 v[84:85], v113 offset:12288
  ds_read_b64_tr_b16 v[86:87], v113 offset:14336
  ds_read_b64_tr_b16 v[88:89], v114 offset:12288
  ds_read_b64_tr_b16 v[90:91], v114 offset:14336
  ds_read_b64_tr_b16 v[92:93], v115 offset:12288
  ds_read_b64_tr_b16 v[94:95], v115 offset:14336
  s_nop 0
  s_waitcnt lgkmcnt(6)
  ds_read_b64_tr_b16 v[128:129], v112 offset:16384
  ds_read_b64_tr_b16 v[130:131], v112 offset:18432
  ds_read_b64_tr_b16 v[132:133], v113 offset:16384
  ds_read_b64_tr_b16 v[134:135], v113 offset:18432
  ds_read_b64_tr_b16 v[136:137], v114 offset:16384
  ds_read_b64_tr_b16 v[138:139], v114 offset:18432
  ds_read_b64_tr_b16 v[140:141], v115 offset:16384
  ds_read_b64_tr_b16 v[142:143], v115 offset:18432
  s_nop 0
  s_waitcnt lgkmcnt(8)
  v_mfma_f32_16x16x32_bf16 v[28:31], v[64:67], v[216:219], v[28:31]
  v_mfma_f32_16x16x32_bf16 v[28:31], v[68:71], v[220:223], v[28:31]
  v_mfma_f32_16x16x32_bf16 v[28:31], v[72:75], v[224:227], v[28:31]
  v_mfma_f32_16x16x32_bf16 v[28:31], v[76:79], v[228:231], v[28:31]
  v_mfma_f32_16x16x32_bf16 v[28:31], v[80:83], v[216:219], v[28:31]
  v_mfma_f32_16x16x32_bf16 v[28:31], v[84:87], v[220:223], v[28:31]
  v_mfma_f32_16x16x32_bf16 v[28:31], v[88:91], v[224:227], v[28:31]
  v_mfma_f32_16x16x32_bf16 v[28:31], v[92:95], v[228:231], v[28:31]
  s_nop 0
  s_waitcnt lgkmcnt(7)
  ds_read_b64_tr_b16 v[144:145], v112 offset:20480
  ds_read_b64_tr_b16 v[146:147], v112 offset:22528
  ds_read_b64_tr_b16 v[148:149], v113 offset:20480
  ds_read_b64_tr_b16 v[150:151], v113 offset:22528
  ds_read_b64_tr_b16 v[152:153], v114 offset:20480
  ds_read_b64_tr_b16 v[154:155], v114 offset:22528
  ds_read_b64_tr_b16 v[156:157], v115 offset:20480
  ds_read_b64_tr_b16 v[158:159], v115 offset:22528
  s_nop 0
  s_waitcnt lgkmcnt(6)
  ds_read_b64_tr_b16 v[160:161], v116 offset:0
  ds_read_b64_tr_b16 v[162:163], v116 offset:1024
  ds_read_b64_tr_b16 v[164:165], v117 offset:0
  ds_read_b64_tr_b16 v[166:167], v117 offset:1024
  ds_read_b64_tr_b16 v[176:177], v116 offset:2048
  ds_read_b64_tr_b16 v[178:179], v116 offset:3072
  ds_read_b64_tr_b16 v[180:181], v117 offset:2048
  ds_read_b64_tr_b16 v[182:183], v117 offset:3072
  s_nop 0
  s_waitcnt lgkmcnt(8)
  v_mfma_f32_16x16x32_bf16 v[28:31], v[128:131], v[232:235], v[28:31]
  v_mfma_f32_16x16x32_bf16 v[28:31], v[132:135], v[236:239], v[28:31]
  v_mfma_f32_16x16x32_bf16 v[28:31], v[136:139], v[240:243], v[28:31]
  v_mfma_f32_16x16x32_bf16 v[28:31], v[140:143], v[244:247], v[28:31]
  v_mfma_f32_16x16x32_bf16 v[28:31], v[144:147], v[232:235], v[28:31]
  v_mfma_f32_16x16x32_bf16 v[28:31], v[148:151], v[236:239], v[28:31]
  v_mfma_f32_16x16x32_bf16 v[28:31], v[152:155], v[240:243], v[28:31]
  v_mfma_f32_16x16x32_bf16 v[28:31], v[156:159], v[244:247], v[28:31]
  s_waitcnt lgkmcnt(7)
  s_waitcnt lgkmcnt(0)
  v_mfma_f32_16x16x32_bf16 v[28:31], v[160:163], v[248:251], v[28:31]
  v_mfma_f32_16x16x32_bf16 v[28:31], v[164:167], v[252:255], v[28:31]
  v_mfma_f32_16x16x32_bf16 v[28:31], v[176:179], v[248:251], v[28:31]
  v_mfma_f32_16x16x32_bf16 v[28:31], v[180:183], v[252:255], v[28:31]
  s_lshl_b32 s5, s77, Lz1-Lz0+14
  s_lshl_b32 s4, s76, 10
  s_add_u32 s5, s5, s4
  s_add_u32 s5, s5, 1376256
  s_nop 3
  buffer_store_dwordx4 v[28:31], v15, s[40:43], s5 offen sc0 sc1
L_188:
  s_barrier
  s_mov_b32 exec_lo, 0xffff
  s_mov_b32 exec_hi, 0
  buffer_load_dword v7, v5, s[40:43], s91 offen sc0 sc1
  s_mov_b64 exec, -1
  s_barrier
  s_waitcnt vmcnt(0)
  s_mov_b32 s89, 200000
  s_mov_b32 exec_lo, 0xffff
  s_mov_b32 exec_hi, 0
  s_branch Lp_191
Lp_190:
  buffer_load_dword v7, v5, s[40:43], s91 offen sc0 sc1
  s_waitcnt vmcnt(0)
Lp_191:
  v_cmp_ne_u32 vcc, 0, v7
  s_andn2_b32 s3, 0xffff, vcc_lo
  s_cbranch_scc0 Lp_192
  s_sleep 1
  s_sub_u32 s89, s89, Lz1-Lz0+1
  s_cbranch_scc0 Lp_190
Lp_192:
  s_mov_b64 exec, -1
  s_cmp_lg_u32 s82, 0
  s_cbranch_scc1 L_193
  s_mov_b32 s5, 1835012
  s_mov_b64 exec, 0x101
  buffer_store_dword v11, v14, s[40:43], s5 offen sc0 sc1
  s_mov_b64 exec, -1
L_193:
  s_add_u32 s5, s84, s92
  buffer_load_dwordx2 v[96:97], v6, s[40:43], s5 offen offset:0 sc1
  buffer_load_dwordx2 v[98:99], v6, s[40:43], s5 offen offset:512 sc1
  buffer_load_dwordx2 v[100:101], v6, s[40:43], s5 offen offset:1024 sc1
  buffer_load_dwordx2 v[102:103], v6, s[40:43], s5 offen offset:1536 sc1
  s_barrier
  s_barrier
  s_barrier
  s_waitcnt vmcnt(0)
  v_add_f32 v96, v96, v100
  v_add_f32 v97, v97, v101
  v_add_f32 v98, v98, v102
  v_add_f32 v99, v99, v103
  v_add_f32_e64 v96, v96, v98
  v_add_f32 v97, v97, v99
  s_nop 0
  v_add_f32_dpp v96, v96, v96 row_ror:8 row_mask:0xf bank_mask:0xf
  v_add_f32_dpp v97, v97, v97 row_ror:8 row_mask:0xf bank_mask:0xf
  v_mov_b32 v98, v96
  v_mov_b32 v99, v97
  s_nop 0
  v_permlane16_swap_b32 v96, v98
  v_permlane16_swap_b32 v97, v99
  v_add_f32 v96, v96, v98
  v_add_f32 v97, v97, v99
  v_mov_b32 v98, v96
  v_mov_b32 v99, v97
  s_nop 0
  v_permlane32_swap_b32 v96, v98
  v_permlane32_swap_b32 v97, v99
  v_add_f32 v96, v96, v98
  v_add_f32 v97, v97, v99
  v_mul_f32 v96, 0x3a800000, v96
  v_mul_f32 v97, 0x3a800000, v97
  v_fma_f32 v98, -v96, v96, v97
  v_max_f32_e64 v98, 0, v98
  v_add_f32 v98, 0x3727c5ac, v98
  v_rsq_f32 v98, v98
  s_nop 0
  v_mul_f32 v99, v96, v98
  s_mov_b64 exec, s[8:9]
  buffer_store_dwordx2 v[98:99], v6, s[40:43], s10 offen sc0 sc1
  s_mov_b64 exec, -1
  s_barrier
  s_barrier
  s_barrier
  s_barrier
  s_barrier
  s_cmp_lg_u32 s82, 0
  s_cbranch_scc1 L_195
  s_lshl_b32 s91, s84, Lz1-Lz0+1
  s_and_b32 s91, s91, 0x8f000
  s_add_u32 s91, s91, 1835012
  s_mov_b32 exec_lo, 0xffff
  s_mov_b32 exec_hi, 0
  buffer_load_dword v7, v5, s[40:43], s91 offen sc0 sc1
  s_mov_b64 exec, -1
L_195:
  s_and_b32 s5, s10, 0xfffffc00
  buffer_load_dwordx4 v[120:123], v4, s[40:43], s5 offen sc1
  s_barrier
  s_barrier
  s_waitcnt vmcnt(0)
  s_mov_b32 s89, 200000
  s_branch Lp_198
Lp_197:
  s_and_b32 s5, s10, 0xfffffc00
  buffer_load_dwordx4 v[120:123], v4, s[40:43], s5 offen sc1
  s_waitcnt vmcnt(0)
Lp_198:
  v_min_u32 v2, v120, v122
  v_cmp_eq_u32 vcc, 0, v2
  s_cmp_eq_u64 vcc, 0
  s_cbranch_scc1 Lp_199
  s_sleep 1
  s_sub_u32 s89, s89, 1
  s_cbranch_scc0 Lp_197
Lp_199:
  s_and_b32 s5, s10, 0xfffffc00
  s_mov_b32 m0, 151552
  s_nop 0
  buffer_load_dword v6, s[40:43], s5 offen offset:0 sc1 lds
  s_mov_b32 m0, 152188
  s_nop 0
  buffer_load_dword v6, s[40:43], s5 offen offset:4 sc1 lds
  s_mov_b32 m0, 151360
  s_nop 0
  buffer_load_dword v6, s[40:43], s5 offen offset:512 sc1 lds
  s_mov_b32 m0, 151996
  s_nop 0
  buffer_load_dword v6, s[40:43], s5 offen offset:516 sc1 lds
  s_add_u32 s10, s10, 16384
  s_cmp_lg_u32 s82, 0
  s_cbranch_scc1 L_200
  s_mov_b32 s89, 200000
  s_mov_b32 exec_lo, 0xffff
  s_mov_b32 exec_hi, 0
  s_branch Lp_203
Lp_202:
  buffer_load_dword v7, v5, s[40:43], s91 offen sc0 sc1
  s_waitcnt vmcnt(0)
Lp_203:
  v_cmp_ne_u32 vcc, 0, v7
  s_andn2_b32 s3, 0xffff, vcc_lo
  s_cbranch_scc0 Lp_204
  s_sleep 1
  s_sub_u32 s89, s89, 1
  s_cbranch_scc0 Lp_202
Lp_204:
  s_mov_b64 exec, -1
  s_lshl_b32 s5, s77, 14
  s_add_u32 s5, s5, 1376256
  buffer_load_dwordx4 v[192:195], v4, s[40:43], s5 offen offset:0 sc1
  buffer_load_dwordx4 v[196:199], v4, s[40:43], s5 offen offset:1024 sc1
  buffer_load_dwordx4 v[200:203], v4, s[40:43], s5 offen offset:2048 sc1
  buffer_load_dwordx4 v[204:207], v4, s[40:43], s5 offen offset:3072 sc1
  s_add_u32 s5, s5, 4096
  buffer_load_dwordx4 v[208:211], v4, s[40:43], s5 offen offset:0 sc1
  buffer_load_dwordx4 v[212:215], v4, s[40:43], s5 offen offset:1024 sc1
  buffer_load_dwordx4 v[216:219], v4, s[40:43], s5 offen offset:2048 sc1
  buffer_load_dwordx4 v[220:223], v4, s[40:43], s5 offen offset:3072 sc1
L_200:
  s_barrier
  s_cmp_lg_u32 s82, 0
  s_cbranch_scc1 L_205
  s_lshl_b32 s5, s77, 14
  s_add_u32 s5, s5, 1384448
  buffer_load_dwordx4 v[224:227], v4, s[40:43], s5 offen offset:0 sc1
  buffer_load_dwordx4 v[228:231], v4, s[40:43], s5 offen offset:1024 sc1
  buffer_load_dwordx4 v[232:235], v4, s[40:43], s5 offen offset:2048 sc1
  buffer_load_dwordx4 v[236:239], v4, s[40:43], s5 offen offset:3072 sc1
  s_add_u32 s5, s5, 4096
  buffer_load_dwordx4 v[240:243], v4, s[40:43], s5 offen offset:0 sc1
  buffer_load_dwordx4 v[244:247], v4, s[40:43], s5 offen offset:1024 sc1
  buffer_load_dwordx4 v[248:251], v4, s[40:43], s5 offen offset:2048 sc1
  buffer_load_dwordx4 v[252:255], v4, s[40:43], s5 offen offset:3072 sc1
L_205:
  s_cmp_lg_u32 s82, 0
  s_cbranch_scc1 L_207
  buffer_load_dword v109, v110, s[60:63], s13 offen
  s_sub_u32 s13, s13, 8192
  buffer_load_dword v109, v110, s[60:63], s13 offen
  s_sub_u32 s13, s13, 8192
L_207:
  s_barrier
  s_barrier
  s_cmp_lg_u32 s82, 0
  s_cbranch_scc1 L_209
  s_cmp_lg_u32 s82, 0
  s_cbranch_scc1 L_211
  s_waitcnt vmcnt(2)
  s_branch L_212
  s_nop 0
L_211:
  s_waitcnt vmcnt(0)
L_212:
  v_add_f32 v192, v192, v224
  v_add_f32 v193, v193, v225
  v_add_f32 v194, v194, v226
  v_add_f32 v195, v195, v227
  v_add_f32 v196, v196, v228
  v_add_f32 v197, v197, v229
  v_add_f32 v198, v198, v230
  v_add_f32 v199, v199, v231
  v_add_f32 v200, v200, v232
  v_add_f32 v201, v201, v233
  v_add_f32 v202, v202, v234
  v_add_f32 v203, v203, v235
  v_add_f32 v204, v204, v236
  v_add_f32 v205, v205, v237
  v_add_f32 v206, v206, v238
  v_add_f32 v207, v207, v239
  v_add_f32 v208, v208, v240
  v_add_f32 v209, v209, v241
  v_add_f32 v210, v210, v242
  v_add_f32 v211, v211, v243
  v_add_f32 v212, v212, v244
  v_add_f32 v213, v213, v245
  v_add_f32 v214, v214, v246
  v_add_f32 v215, v215, v247
  v_add_f32 v216, v216, v248
  v_add_f32 v217, v217, v249
  v_add_f32 v218, v218, v250
  v_add_f32 v219, v219, v251
  v_add_f32 v220, v220, v252
  v_add_f32 v221, v221, v253
  v_add_f32 v222, v222, v254
  v_add_f32 v223, v223, v255
  v_add_f32 v192, v192, v208
  v_add_f32 v193, v193, v209
  v_add_f32 v194, v194, v210
  v_add_f32 v195, v195, v211
  v_add_f32 v196, v196, v212
  v_add_f32 v197, v197, v213
  v_add_f32 v198, v198, v214
  v_add_f32 v199, v199, v215
  v_add_f32 v200, v200, v216
  v_add_f32 v201, v201, v217
  v_add_f32 v202, v202, v218
  v_add_f32 v203, v203, v219
  v_add_f32 v204, v204, v220
  v_add_f32 v205, v205, v221
  v_add_f32 v206, v206, v222
  v_add_f32 v207, v207, v223
  v_add_f32 v192, v192, v200
  v_add_f32 v193, v193, v201
  v_add_f32 v194, v194, v202
  v_add_f32 v195, v195, v203
  v_add_f32 v196, v196, v204
  v_add_f32 v197, v197, v205
  v_add_f32 v198, v198, v206
  v_add_f32 v199, v199, v207
  v_add_f32 v192, v192, v196
  v_add_f32 v193, v193, v197
  v_add_f32 v194, v194, v198
  v_add_f32 v195, v195, v199
  v_add_u32 v2, 154112, v4
  ds_write_b128 v2, v[192:195]
  s_branch L_210
  s_nop 0
L_209:
  s_waitcnt vmcnt(0)
L_210:
  s_waitcnt lgkmcnt(0)
  s_barrier
  v_lshlrev_b32 v2, 12, v1
  s_lshl_b32 s4, s76, 16
  s_lshl_b32 s5, s77, 7
  s_add_u32 s4, s4, s5
  s_add_u32 s4, s4, s87
  s_add_u32 s5, s4, 24
  s_lshl_b32 s4, s79, 3
  s_lshl_b32 s90, 0xff, s4
  s_lshl_b32 s91, s84, 1
  s_add_u32 s91, s91, s87
  s_add_u32 s91, s91, 24
  s_lshl_b32 s4, s82, 7
  s_add_u32 s4, s4, 1837056
  s_lshl_b32 s5, s84, 1
  s_add_u32 s5, s5, s4
  s_and_b32 s91, s5, 0xffff0fff
  s_barrier
  s_barrier
  s_barrier
  s_mov_b32 exec_lo, 1
  s_mov_b32 exec_hi, Lz1-Lz0+0
  buffer_store_dword v11, v2, s[40:43], s5 offen sc0 sc1
  s_mov_b64 exec, -1
  s_barrier
  s_barrier
  s_barrier
  s_mov_b32 exec_lo, s90
  s_mov_b32 exec_hi, 0
  buffer_load_dword v7, v2, s[40:43], s91 offen sc0 sc1
  s_mov_b64 exec, -1
  s_barrier
  s_waitcnt vmcnt(0)
  s_mov_b32 s89, 200000
  s_mov_b32 exec_lo, s90
  s_mov_b32 exec_hi, 0
  s_branch Lp_214
Lp_213:
  buffer_load_dword v7, v2, s[40:43], s91 offen sc0 sc1
  s_waitcnt vmcnt(0)
Lp_214:
  v_cmp_ne_u32 vcc, 0, v7
  s_andn2_b32 s3, s90, vcc_lo
  s_cbranch_scc0 Lp_215
  s_sleep 1
  s_sub_u32 s89, s89, 1
  s_cbranch_scc0 Lp_213
Lp_215:
  s_mov_b64 exec, -1
  s_xor_b32 s90, s90, 0xffff
  s_barrier
  s_barrier
  s_barrier
  s_barrier
  s_barrier
  s_barrier
  s_barrier
  s_barrier
  s_barrier
  s_barrier
  s_mov_b32 exec_lo, s90
  s_mov_b32 exec_hi, 0
  buffer_load_dword v7, v2, s[40:43], s91 offen sc0 sc1
  s_mov_b64 exec, -1
  s_barrier
  s_barrier
  s_barrier
  s_waitcnt vmcnt(0)
  s_mov_b32 s89, 200000
  s_mov_b32 exec_lo, s90
  s_mov_b32 exec_hi, 0
  s_branch Lp_217
Lp_216:
  buffer_load_dword v7, v2, s[40:43], s91 offen sc0 sc1
  s_waitcnt vmcnt(0)
Lp_217:
  v_cmp_ne_u32 vcc, 0, v7
  s_andn2_b32 s3, s90, vcc_lo
  s_cbranch_scc0 Lp_218
  s_sleep 1
  s_sub_u32 s89, s89, 1
  s_cbranch_scc0 Lp_216
Lp_218:
  s_mov_b64 exec, -1
  s_barrier
  s_barrier
  s_barrier
  s_barrier
  s_barrier
  s_barrier
  s_barrier
  s_barrier
  s_barrier
  s_barrier
  s_barrier
  s_cmp_lg_u32 s82, 0
  s_cbranch_scc1 L_lend
  s_add_u32 s92, s83, 36700160
  s_mov_b32 s82, 1
  s_mov_b32 s14, 0
  s_add_u32 s83, s83, 0
  s_add_u32 s87, s87, 32
  s_branch L_slayer
L_lend:
Lz0:
Lz1:
L_end:
  s_endpgm
.section .rodata,"a"
.p2align 6
.amdhsa_kernel mega_kernel
  .amdhsa_next_free_vgpr 256
  .amdhsa_next_free_sgpr 102
  .amdhsa_accum_offset 256
  .amdhsa_group_segment_fixed_size 0
  .amdhsa_kernarg_size 88
  .amdhsa_user_sgpr_count 2
  .amdhsa_user_sgpr_kernarg_segment_ptr 1
  .amdhsa_system_sgpr_workgroup_id_x 1
  .amdhsa_float_denorm_mode_32 3
  .amdhsa_float_denorm_mode_16_64 3
.end_amdhsa_kernel
.text
```

```asm
; @launch kernel=mega_kernel grid=(256,1,1) block=(512,1,1) lds=156672
.amdgcn_target "amdgcn-amd-amdhsa--gfx950"
.text
.globl mega_kernel
.p2align 8
.type mega_kernel,@function
mega_kernel:
  s_cmp_ge_u32 s2, 256
  s_nop 0
  s_cbranch_scc1 L_end
  s_load_dwordx16 s[16:31], s[0:1], 0
  s_load_dwordx2 s[32:33], s[0:1], 64
  s_load_dwordx4 s[36:39], s[0:1], 72
  v_lshrrev_b32 v2, 6, v0
  v_and_b32 v1, 63, v0
  v_readfirstlane_b32 s81, v2
  s_and_b32 s3, s2, 7
  s_lshr_b32 s4, s2, 3
  s_and_b32 s5, s3, 1
  s_lshl_b32 s5, s5, 3
  s_and_b32 s6, s4, 7
  s_add_u32 s76, s5, s6
  s_lshr_b32 s5, s3, 1
  s_lshl_b32 s5, s5, 2
  s_lshr_b32 s6, s4, 3
  s_add_u32 s77, s5, s6
  s_mov_b32 s82, 0
  s_mov_b32 s88, 0
  s_and_b32 s85, s81, 1
  s_cmp_lt_u32 s81, 4
  s_cbranch_scc1 L_comp
  s_cmp_eq_u32 s81, Lz1-Lz0+5
  s_cbranch_scc1 L_serv
  s_setprio 0
  s_cmp_eq_u32 s81, 4
  s_cbranch_scc1 L_xload
  v_bfe_u32 v2, v1, 1, 2
  v_bfe_u32 v3, v1, 4, 2
  v_xor_b32 v2, v2, v3
  v_lshlrev_b32 v10, 5, v2
  v_and_b32_e64 v2, 1, v1
  v_lshl_add_u32 v10, v2, 4, v10
  v_lshrrev_b32_e64 v2, 5, v1
  v_bfe_u32 v3, v1, 3, 2
  v_lshl_add_u32 v2, v2, 3, v3
  s_mov_b32 s4, 6144
  v_mad_u32_u24 v16, v2, s4, v10
  v_add_u32 v17, 97280, v16
  v_add_u32 v18, 22528, v16
  v_add_u32 v19, 119808, v16
  s_lshl_b32 s5, s77, Lz1-Lz0+7
  s_mul_i32 s4, s85, 196608
  s_add_u32 s5, s5, s4
  s_and_b32 s6, s76, 6
  s_lshr_b32 s4, s76, 3
  s_add_u32 s6, s6, s4
  s_lshl_b32 s6, s6, 1
  v_add_u32 v20, s6, v1
  v_and_b32_e64 v20, 15, v20
  s_mov_b32 s4, 393216
  v_mul_u32_u24 v20, s4, v20
  v_add_u32 v20, s5, v20
  s_nop 0
  v_readfirstlane_b32 s7, v20
  s_lshl_b32 s11, s85, Lz1-Lz0+12
  s_add_u32 s11, s11, 65536
  s_add_u32 s15, s11, 73728
  s_waitcnt lgkmcnt(0)
  s_mov_b32 s48, s18
  s_and_b32 s49, s19, 0xffff
  s_mov_b32 s50, 6291456
  s_mov_b32 s51, 0x00020000
L_wlayer:
  s_mov_b32 s12, 0
  s_mov_b32 m0, s11
  s_cmp_eq_u32 s82, 0
  s_cbranch_scc1 Ll_34
  s_waitcnt vmcnt(12)
  s_barrier
  s_waitcnt vmcnt(8)
  s_barrier
  s_waitcnt vmcnt(4)
  s_barrier
  s_waitcnt vmcnt(0)
  s_barrier
  s_barrier
  s_branch Ll_34
Lt_40:
  s_cmp_lg_u32 s12, 1
  s_cbranch_scc1 Ll_34
  s_cmp_eq_u32 s82, 0
  s_cbranch_scc1 Ll_34
  s_waitcnt vmcnt(0)
  s_barrier
Ll_34:
  buffer_load_dwordx4 v16, s[48:51], s7 offen offset:0  lds
  buffer_load_dwordx4 v17, s[48:51], s7 offen offset:1024  lds
  buffer_load_dwordx4 v18, s[48:51], s7 offen offset:2048  lds
  buffer_load_dwordx4 v19, s[48:51], s7 offen offset:3072  lds
  s_add_u32 m0, s11, 8192
  s_add_u32 s5, s7, 2048
  buffer_load_dwordx4 v16, s[48:51], s5 offen offset:0  lds
  buffer_load_dwordx4 v17, s[48:51], s5 offen offset:1024  lds
  buffer_load_dwordx4 v18, s[48:51], s5 offen offset:2048  lds
  buffer_load_dwordx4 v19, s[48:51], s5 offen offset:3072  lds
  s_add_u32 m0, s11, 16384
  s_add_u32 s5, s7, 4096
  buffer_load_dwordx4 v16, s[48:51], s5 offen offset:0  lds
  s_add_u32 s12, s12, Lz1-Lz0+1
  v_readlane_b32 s7, v20, s12
  s_add_u32 s11, s11, 24576
  buffer_load_dwordx4 v17, s[48:51], s5 offen offset:1024  lds
  s_cmp_eq_u32 s11, s15
  s_cselect_b32 s4, 73728, 0
  s_sub_u32 s11, s11, s4
  buffer_load_dwordx4 v18, s[48:51], s5 offen offset:2048  lds
  s_cmp_lg_u32 s12, Lz1-Lz0+3
  buffer_load_dwordx4 v19, s[48:51], s5 offen offset:3072  lds
  s_mov_b32 m0, s11
  s_cbranch_scc1 Lt_40
Lt_41:
  s_cmp_lg_u32 s82, Lz1-Lz0+0
  s_cbranch_scc1 Ll_42
  s_waitcnt vmcnt(24)
  s_barrier
Ll_42:
  s_mul_i32 s5, s85, 6144
  s_mov_b32 s68, s24
  s_and_b32 s69, s25, 0xffff
  s_mov_b32 s70, 7340032
  s_mov_b32 s71, 0x00020000
  s_lshl_b32 s4, s76, 4
  s_add_u32 s4, s4, s77
  s_mul_i32 s34, s4, 28672
  s_add_u32 s34, s34, s5
  s_mov_b32 s40, s38
  s_and_b32 s41, s39, 0xffff
  s_mov_b32 s42, 100663296
  s_mov_b32 s43, 0x00020000
  s_nop 0
  s_mov_b32 s52, s20
  s_and_b32 s53, s21, 0xffff
  s_mov_b32 s54, 2097152
  s_mov_b32 s55, 0x00020000
  s_nop 0
  s_mov_b32 s56, s24
  s_and_b32 s57, s25, 0xffff
  s_mov_b32 s58, 7340032
  s_mov_b32 s59, 0x00020000
  s_nop 0
  s_mov_b32 s60, s28
  s_and_b32 s61, s29, 0xffff
  s_mov_b32 s62, 7340032
  s_mov_b32 s63, 0x00020000
  s_cmp_lg_u32 s82, 0
  s_cbranch_scc1 L_43
  s_and_b32 s80, s77, 7
  s_lshr_b32 s79, s77, 3
  s_lshl_b32 s78, s80, 1
  s_add_u32 s78, s78, s79
  s_lshl_b32 s5, s76, 4
  s_add_u32 s5, s5, s77
  s_lshl_b32 s84, s5, Lz1-Lz0+11
  s_mov_b32 s83, 3145728
  s_mov_b32 s87, 1835016
  s_lshr_b32 s86, s81, 1
  v_lshrrev_b32 v2, 3, v1
  s_mov_b32 s4, 2048
  v_mad_u32_u24 v4, v2, s4, v10
  v_add_u32 v5, 15360, v4
  v_add_u32 v6, 30720, v4
  v_add_u32 v7, 46080, v4
  s_lshl_b32 s5, s78, Lz1-Lz0+7
  s_mul_i32 s4, s85, 65536
  s_add_u32 s5, s5, s4
  s_mul_i32 s4, s76, 14
  s_lshr_b32 s4, s4, 4
  v_add_u32 v39, s4, v1
  v_subrev_u32 v2, 14, v39
  v_min_u32 v39, v39, v2
  v_cmp_le_u32 vcc, 14, v1
  s_nop 1
  v_cndmask_b32 v39, v39, v1, vcc
  v_lshlrev_b32 v39, 2, v39
  v_mov_b32 v2, 0x87654210
  v_mov_b32 v3, 0xb3fedca9
  v_lshrrev_b64 v[2:3], v39, v[2:3]
  v_and_b32_e64 v39, 15, v2
  v_cmp_eq_u32 vcc, s77, v39
  s_nop 0
  v_mov_b32_dpp v2, v39 row_shr:1 row_mask:0xf bank_mask:0xf
  s_ff1_i32_b32 s4, vcc_lo
  v_cmp_ge_u32 vcc, s4, v1
  s_nop 1
  v_cndmask_b32 v39, v39, v2, vcc
  v_writelane_b32 v39, s77, 0
  v_lshl_add_u32 v38, v39, 17, s5
L_43:
  s_waitcnt vmcnt(12)
  s_barrier
  buffer_load_dwordx4 v16, s[48:51], s7 offen offset:0  lds
  buffer_load_dwordx4 v17, s[48:51], s7 offen offset:1024  lds
  buffer_load_dwordx4 v18, s[48:51], s7 offen offset:2048  lds
  buffer_load_dwordx4 v19, s[48:51], s7 offen offset:3072  lds
Ll_44:
  s_add_u32 m0, s11, 8192
  s_add_u32 s5, s7, 2048
  buffer_load_dwordx4 v16, s[48:51], s5 offen offset:0  lds
  buffer_load_dwordx4 v17, s[48:51], s5 offen offset:1024  lds
  buffer_load_dwordx4 v18, s[48:51], s5 offen offset:2048  lds
  buffer_load_dwordx4 v19, s[48:51], s5 offen offset:3072  lds
  s_add_u32 m0, s11, 16384
  s_add_u32 s5, s7, 4096
  buffer_load_dwordx4 v16, s[48:51], s5 offen offset:0  lds
  s_add_u32 s12, s12, Lz1-Lz0+1
  v_readlane_b32 s7, v20, s12
  s_add_u32 s11, s11, 24576
  buffer_load_dwordx4 v17, s[48:51], s5 offen offset:1024  lds
  s_cmp_eq_u32 s11, s15
  s_cselect_b32 s4, 73728, 0
  s_sub_u32 s11, s11, s4
  buffer_load_dwordx4 v18, s[48:51], s5 offen offset:2048  lds
  s_cmp_eq_u32 s12, Lz1-Lz0+16
  buffer_load_dwordx4 v19, s[48:51], s5 offen offset:3072  lds
  s_mov_b32 m0, s11
  s_cbranch_scc1 Ll_45
  s_cmp_lg_u32 s82, 0
  s_cbranch_scc1 L_46
  s_buffer_load_dwordx2 s[98:99], s[68:71], s34 offset:60
  s_buffer_load_dwordx2 s[98:99], s[68:71], s34 offset:188
  s_buffer_load_dwordx2 s[98:99], s[68:71], s34 offset:316
  s_buffer_load_dwordx2 s[98:99], s[68:71], s34 offset:444
  s_add_u32 s34, s34, 512
L_46:
  s_waitcnt vmcnt(12)
  s_barrier
  buffer_load_dwordx4 v16, s[48:51], s7 offen offset:0  lds
  buffer_load_dwordx4 v17, s[48:51], s7 offen offset:1024  lds
  buffer_load_dwordx4 v18, s[48:51], s7 offen offset:2048  lds
  buffer_load_dwordx4 v19, s[48:51], s7 offen offset:3072  lds
  s_branch Ll_44
Ll_45:
  s_branch L_w1
L_xload:
  s_setprio 0
  v_lshrrev_b32 v2, 4, v1
  v_and_b32 v3, 7, v1
  v_xor_b32 v2, v2, v3
  v_lshrrev_b32 v3, 3, v1
  v_lshlrev_b32 v3, 12, v3
  v_lshl_add_u32 v4, v2, 4, v3
  v_xor_b32_e64 v5, 64, v4
  v_add_u32 v5, 31744, v5
  v_add_u32 v6, 63488, v4
  v_add_u32 v7, 63488, v5
  s_mov_b32 s13, 0x20000
  s_movk_i32 s95, 2048
  s_lshl_b32 s5, s76, 18
  s_and_b32 s6, s76, 6
  s_lshr_b32 s4, s76, 3
  s_add_u32 s6, s6, s4
  s_lshl_b32 s6, s6, 1
  v_add_u32 v9, s6, v1
  v_and_b32 v9, 15, v9
  v_lshl_add_u32 v9, v9, 7, s5
  s_nop 0
  v_readfirstlane_b32 s7, v9
  s_waitcnt lgkmcnt(0)
  s_mov_b32 s72, s16
  s_and_b32 s73, s17, 0xffff
  s_mov_b32 s74, 4194304
  s_mov_b32 s75, 0x00020000
  s_mov_b32 s11, 0
  s_mov_b32 s15, 65536
L_xlayer:
  s_mov_b32 s12, s82
  s_mov_b32 m0, s11
Ll_87:
  s_nop 0
  buffer_load_dwordx4 v4, s[72:75], s7 offen offset:0 sc1 lds
  buffer_load_dwordx4 v5, s[72:75], s7 offen offset:1024 sc1 lds
  buffer_load_dwordx4 v6, s[72:75], s7 offen offset:2048 sc1 lds
  buffer_load_dwordx4 v7, s[72:75], s7 offen offset:3072 sc1 lds
  s_add_u32 m0, s11, 4096
  s_nop 0
  s_add_u32 s5, s7, s13
  buffer_load_dwordx4 v4, s[72:75], s5 offen offset:0 sc1 lds
  buffer_load_dwordx4 v5, s[72:75], s5 offen offset:1024 sc1 lds
  buffer_load_dwordx4 v6, s[72:75], s5 offen offset:2048 sc1 lds
  buffer_load_dwordx4 v7, s[72:75], s5 offen offset:3072 sc1 lds
  s_add_u32 m0, s11, 8192
  s_nop 0
  s_add_u32 s3, s7, s95
  buffer_load_dwordx4 v4, s[72:75], s3 offen offset:0 sc1 lds
  buffer_load_dwordx4 v5, s[72:75], s3 offen offset:1024 sc1 lds
  buffer_load_dwordx4 v6, s[72:75], s3 offen offset:2048 sc1 lds
  buffer_load_dwordx4 v7, s[72:75], s3 offen offset:3072 sc1 lds
  s_add_u32 m0, s11, 12288
  s_add_u32 s5, s3, s13
  buffer_load_dwordx4 v4, s[72:75], s5 offen offset:0 sc1 lds
  s_add_u32 s12, s12, 1
  v_readlane_b32 s7, v9, s12
  s_add_u32 s11, s11, 16384
  buffer_load_dwordx4 v5, s[72:75], s5 offen offset:1024 sc1 lds
  s_cmp_eq_u32 s11, s15
  s_cselect_b32 s4, 65536, 0
  s_sub_u32 s11, s11, s4
  buffer_load_dwordx4 v6, s[72:75], s5 offen offset:2048 sc1 lds
  s_cmp_lg_u32 s12, Lz1-Lz0+2
  buffer_load_dwordx4 v7, s[72:75], s5 offen offset:3072 sc1 lds
  s_mov_b32 m0, s11
  s_cbranch_scc1 Ll_88
  s_cmp_lg_u32 s82, 0
  s_cbranch_scc1 Ll_88
  s_waitcnt vmcnt(16)
  s_barrier
Ll_92:
Ll_88:
  s_cmp_lt_u32 s12, Lz1-Lz0+4
  s_cbranch_scc1 Ll_87
  s_mov_b32 s68, s20
  s_and_b32 s69, s21, 0xffff
  s_mov_b32 s70, 2097152
  s_mov_b32 s71, 0x00020000
  s_lshl_b32 s4, s76, 4
  s_add_u32 s4, s4, s77
  s_mul_i32 s34, s4, 8192
  s_waitcnt vmcnt(32)
  s_barrier
  buffer_load_dwordx4 v4, s[72:75], s7 offen offset:0 sc1 lds
  buffer_load_dwordx4 v5, s[72:75], s7 offen offset:1024 sc1 lds
  buffer_load_dwordx4 v6, s[72:75], s7 offen offset:2048 sc1 lds
  buffer_load_dwordx4 v7, s[72:75], s7 offen offset:3072 sc1 lds
Ll_93:
  s_add_u32 m0, s11, 4096
  s_nop 0
  s_add_u32 s5, s7, s13
  buffer_load_dwordx4 v4, s[72:75], s5 offen offset:0 sc1 lds
  buffer_load_dwordx4 v5, s[72:75], s5 offen offset:1024 sc1 lds
  buffer_load_dwordx4 v6, s[72:75], s5 offen offset:2048 sc1 lds
  buffer_load_dwordx4 v7, s[72:75], s5 offen offset:3072 sc1 lds
  s_add_u32 m0, s11, 8192
  s_nop 0
  s_add_u32 s3, s7, s95
  buffer_load_dwordx4 v4, s[72:75], s3 offen offset:0 sc1 lds
  buffer_load_dwordx4 v5, s[72:75], s3 offen offset:1024 sc1 lds
  buffer_load_dwordx4 v6, s[72:75], s3 offen offset:2048 sc1 lds
  buffer_load_dwordx4 v7, s[72:75], s3 offen offset:3072 sc1 lds
  s_add_u32 m0, s11, 12288
  s_add_u32 s5, s3, s13
  buffer_load_dwordx4 v4, s[72:75], s5 offen offset:0 sc1 lds
  s_add_u32 s12, s12, 1
  v_readlane_b32 s7, v9, s12
  s_add_u32 s11, s11, 16384
  buffer_load_dwordx4 v5, s[72:75], s5 offen offset:1024 sc1 lds
  s_cmp_eq_u32 s11, s15
  s_cselect_b32 s4, 65536, 0
  s_sub_u32 s11, s11, s4
  buffer_load_dwordx4 v6, s[72:75], s5 offen offset:2048 sc1 lds
  s_cmp_eq_u32 s12, Lz1-Lz0+16
  buffer_load_dwordx4 v7, s[72:75], s5 offen offset:3072 sc1 lds
  s_mov_b32 m0, s11
  s_cbranch_scc1 Ll_94
  s_cmp_lg_u32 s82, 0
  s_cbranch_scc1 L_95
  s_buffer_load_dwordx2 s[98:99], s[68:71], s34 offset:60
  s_buffer_load_dwordx2 s[98:99], s[68:71], s34 offset:188
  s_buffer_load_dwordx2 s[98:99], s[68:71], s34 offset:316
  s_buffer_load_dwordx2 s[98:99], s[68:71], s34 offset:444
  s_buffer_load_dwordx2 s[98:99], s[68:71], s34 offset:572
  s_add_u32 s34, s34, 640
L_95:
  s_waitcnt vmcnt(32)
  s_barrier
  buffer_load_dwordx4 v4, s[72:75], s7 offen offset:0 sc1 lds
  buffer_load_dwordx4 v5, s[72:75], s7 offen offset:1024 sc1 lds
  buffer_load_dwordx4 v6, s[72:75], s7 offen offset:2048 sc1 lds
  buffer_load_dwordx4 v7, s[72:75], s7 offen offset:3072 sc1 lds
  s_branch Ll_93
  s_nop 0
Ll_94:
  s_waitcnt vmcnt(32)
  s_barrier
  s_waitcnt vmcnt(16)
  s_barrier
  s_waitcnt vmcnt(0)
  s_barrier
  s_barrier
  s_branch L_x1
L_serv:
  s_setprio 3
  s_and_b32 s80, s77, 7
  s_lshr_b32 s79, s77, 3
  s_lshl_b32 s78, s80, 1
  s_add_u32 s78, s78, s79
  s_lshl_b32 s5, s76, 4
  s_add_u32 s5, s5, s77
  s_lshl_b32 s84, s5, 11
  s_mov_b32 s83, 3145728
  s_mov_b32 s87, 1835016
  s_lshr_b32 s86, s81, 1
  v_lshlrev_b32 v4, 4, v1
  v_mov_b32 v24, 0
  v_mov_b32 v25, 0
  v_mov_b32 v26, 0
  v_mov_b32 v27, 0
  v_and_b32 v2, 14, v1
  v_lshlrev_b32 v3, 11, v2
  v_and_b32_e64 v2, 1, v1
  v_lshl_add_u32 v3, v2, 4, v3
  v_and_b32_e64 v2, 48, v1
  v_lshl_add_u32 v3, v2, 1, v3
  v_bfe_u32 v2, v1, 3, 2
  v_and_b32 v22, 7, v1
  v_lshlrev_b32 v2, 14, v2
  v_lshl_add_u32 v2, v22, 3, v2
  s_lshl_b32 s5, s76, 7
  s_lshl_b32 s4, s80, 4
  s_add_u32 s6, s5, s4
  s_add_u32 s6, s6, s79
  s_lshl_b32 s6, s6, 11
  s_lshr_b32 s10, s84, 5
  s_add_u32 s10, s10, 1638400
  s_waitcnt lgkmcnt(0)
  s_mov_b32 s40, s38
  s_and_b32 s41, s39, 0xffff
  s_mov_b32 s42, 100663296
  s_mov_b32 s43, 0x00020000
  s_nop 0
  s_mov_b32 s44, s16
  s_and_b32 s45, s17, 0xffff
  s_mov_b32 s46, 4194304
  s_mov_b32 s47, 0x00020000
  s_nop 0
  s_mov_b32 s68, s36
  s_and_b32 s69, s37, 0xffff
  s_mov_b32 s70, 256
  s_mov_b32 s71, 0x00020000
  s_lshl_b32 s4, s84, Lz1-Lz0+1
  s_add_u32 s4, s4, 1835008
  buffer_store_dwordx4 v[24:27], v4, s[40:43], s4 offen offset:0 sc0 sc1
  buffer_store_dwordx4 v[24:27], v4, s[40:43], s4 offen offset:1024 sc0 sc1
  s_mov_b64 exec, 0xffff
  buffer_store_dwordx4 v[24:27], v4, s[40:43], s4 offen offset:2048 sc0 sc1
  s_mov_b64 exec, -1
  v_mov_b32 v28, -1
  v_mov_b32 v29, -1
  v_mov_b32 v30, -1
  v_mov_b32 v31, -1
  s_lshl_b32 s4, s84, 1
  s_add_u32 s4, s4, Lz1-Lz0+0
  buffer_store_dwordx4 v[28:31], v4, s[40:43], s4 offen offset:0 sc0 sc1
  buffer_store_dwordx4 v[28:31], v4, s[40:43], s4 offen offset:1024 sc0 sc1
  buffer_store_dwordx4 v[28:31], v4, s[40:43], s4 offen offset:2048 sc0 sc1
  buffer_store_dwordx4 v[28:31], v4, s[40:43], s4 offen offset:3072 sc0 sc1
  buffer_store_dwordx2 v[24:25], v2, s[40:43], s10 offen sc0 sc1
  v_mov_b32 v108, v3
  s_mov_b32 s7, s6
  s_branch L_s1
L_comp:
  s_and_b32 s80, s77, 7
  s_lshr_b32 s79, s77, 3
  s_lshl_b32 s78, s80, 1
  s_add_u32 s78, s78, s79
  s_lshl_b32 s5, s76, 4
  s_add_u32 s5, s5, s77
  s_lshl_b32 s84, s5, 11
  s_mov_b32 s83, 3145728
  s_mov_b32 s87, 1835016
  s_lshr_b32 s86, s81, Lz1-Lz0+1
  s_waitcnt lgkmcnt(0)
  s_mov_b32 s40, s38
  s_and_b32 s41, s39, 0xffff
  s_mov_b32 s42, 100663296
  s_mov_b32 s43, 0x00020000
  s_nop 0
  s_mov_b32 s44, s16
  s_and_b32 s45, s17, 0xffff
  s_mov_b32 s46, 4194304
  s_mov_b32 s47, 0x00020000
  s_nop 0
  s_mov_b32 s64, s32
  s_and_b32 s65, s33, 0xffff
  s_mov_b32 s66, 4194304
  s_mov_b32 s67, 0x00020000
  s_setprio 1
  v_lshlrev_b32 v11, 4, v1
  v_lshrrev_b32 v2, 3, v1
  v_and_b32 v3, 7, v1
  v_lshlrev_b32_e64 v3, 3, v3
  v_lshl_add_u32 v30, v2, 11, v3
  s_lshl_b32 s4, s85, 13
  s_lshl_b32 s5, s86, 10
  s_add_u32 s4, s4, s5
  v_add_u32 v0, s4, v11
  v_mov_b32_e64 v27, 1
  v_mov_b32 v28, 156416
  v_and_b32 v29, 48, v1
  s_lshl_b32 s4, s76, 16
  s_lshl_b32 s5, s77, 7
  s_add_u32 s4, s4, s5
  v_lshlrev_b32 v24, 12, v1
  v_and_b32 v2, 16, v1
  v_lshl_add_u32 v24, v2, 7, v24
  v_add_u32 v24, s4, v24
  v_lshrrev_b32 v2, 2, v1
  v_lshlrev_b32 v25, 7, v2
  v_and_b32 v2, 3, v1
  v_lshl_add_u32 v25, v2, 3, v25
  v_add_u32 v25, 65536, v25
  v_bfe_u32 v26, v1, 3, 2
  v_and_b32 v2, 15, v1
  v_lshrrev_b32 v3, 2, v29
  v_sub_u32_e64 v2, v2, v3
  s_mov_b32 s4, 0xf149f2ca
  v_mov_b32 v32, s4
  v_subrev_u32 v3, 0, v2
  v_cmp_gt_u32 vcc, 8, v3
  s_nop 1
  v_cndmask_b32_e64 v12, v32, 0, vcc
  v_cmp_ge_i32 vcc, -9, v3
  s_nop 1
  v_cndmask_b32_e64 v16, v32, 0, vcc
  v_mov_b32 v20, v16
  v_subrev_u32 v3, 1, v2
  v_cmp_gt_u32 vcc, 8, v3
  s_nop 1
  v_cndmask_b32_e64 v13, v32, 0, vcc
  v_cmp_ge_i32 vcc, -9, v3
  s_nop 1
  v_cndmask_b32_e64 v17, v32, 0, vcc
  v_mov_b32 v21, v17
  v_subrev_u32 v3, 2, v2
  v_cmp_gt_u32 vcc, 8, v3
  s_nop 1
  v_cndmask_b32_e64 v14, v32, 0, vcc
  v_cmp_ge_i32 vcc, -9, v3
  s_nop 1
  v_cndmask_b32_e64 v18, v32, 0, vcc
  v_mov_b32 v22, v18
  v_subrev_u32 v3, 3, v2
  v_cmp_gt_u32 vcc, 8, v3
  s_nop 1
  v_cndmask_b32_e64 v15, v32, 0, vcc
  v_cmp_ge_i32 vcc, -9, v3
  s_nop 1
  v_cndmask_b32_e64 v19, v32, 0, vcc
  v_mov_b32 v23, v19
  s_cmp_lg_u32 s76, 0
  s_cbranch_scc1 L_1
  v_mov_b32 v20, v32
  v_mov_b32 v21, v32
  v_mov_b32 v22, v32
  v_mov_b32 v23, v32
L_1:
  s_lshl_b32 s11, s84, 1
  s_lshl_b32 s4, s81, 10
  s_add_u32 s11, s11, s4
  v_and_b32 v2, 15, v1
  v_lshlrev_b32 v255, 12, v2
  v_and_b32_e64 v2, 16, v1
  v_lshl_add_u32 v255, v2, 1, v255
  v_and_b32 v2, 32, v1
  v_lshrrev_b32 v2, 1, v2
  v_add_u32 v255, v2, v255
  s_lshl_b32 s25, s76, 18
  s_lshl_b32 s4, s85, 11
  s_add_u32 s25, s25, s4
  s_lshl_b32 s4, s78, 7
  s_add_u32 s25, s25, s4
  s_lshl_b32 s4, s86, 6
  s_add_u32 s25, s25, s4
L_clayer:
  s_mov_b32 s16, Lz1-Lz0+0
  s_mov_b32 s17, 16384
  s_mov_b32 s18, 0xffff4000
  s_mov_b32 s19, Lz1-Lz0+0
  s_mov_b32 s20, 24576
  s_mov_b32 s21, 0xffff4000
  s_mul_i32 s4, s85, 8192
  v_add_u32_e64 v4, s4, v11
  v_add_u32 v5, 1024, v4
  s_cmp_lg_u32 s82, 0
  s_cbranch_scc1 L_2
  v_and_b32 v2, 15, v1
  v_lshrrev_b32 v3, 1, v2
  v_lshrrev_b32 v32, 4, v1
  v_xor_b32 v3, v3, v32
  v_lshlrev_b32_e64 v3, 4, v3
  v_lshl_add_u32 v3, v2, 7, v3
  v_add_u32 v4, s4, v3
  v_xor_b32 v3, 64, v3
  v_add_u32 v5, s4, v3
L_2:
  s_lshl_b32 s4, s86, 1
  v_xor_b32_e64 v2, s4, v26
  v_lshl_add_u32 v6, v2, 5, v25
  s_add_u32 s4, s4, 1
  v_xor_b32 v2, s4, v26
  v_lshl_add_u32 v7, v2, 5, v25
  v_mov_b64 v[128:129], 0
  v_mov_b64 v[130:131], 0
  v_mov_b64 v[132:133], 0
  v_mov_b64 v[134:135], 0
  v_mov_b64 v[136:137], 0
  v_mov_b64 v[138:139], 0
  v_mov_b64 v[140:141], 0
  v_mov_b64 v[142:143], 0
  v_mov_b64 v[144:145], 0
  v_mov_b64 v[146:147], 0
  v_mov_b64 v[148:149], 0
  v_mov_b64 v[150:151], 0
  v_mov_b64 v[152:153], 0
  v_mov_b64 v[154:155], 0
  v_mov_b64 v[156:157], 0
  v_mov_b64 v[158:159], 0
  v_mov_b64 v[160:161], 0
  v_mov_b64 v[162:163], 0
  v_mov_b64 v[164:165], 0
  v_mov_b64 v[166:167], 0
  v_mov_b64 v[168:169], 0
  v_mov_b64 v[170:171], 0
  v_mov_b64 v[172:173], 0
  v_mov_b64 v[174:175], 0
  v_mov_b64 v[176:177], 0
  v_mov_b64 v[178:179], 0
  v_mov_b64 v[180:181], 0
  v_mov_b64 v[182:183], 0
  v_mov_b64 v[184:185], 0
  v_mov_b64 v[186:187], 0
  v_mov_b64 v[188:189], 0
  v_mov_b64 v[190:191], 0
  v_mov_b64 v[192:193], 0
  v_mov_b64 v[194:195], 0
  v_mov_b64 v[196:197], 0
  v_mov_b64 v[198:199], 0
  v_mov_b64 v[200:201], 0
  v_mov_b64 v[202:203], 0
  v_mov_b64 v[204:205], 0
  v_mov_b64 v[206:207], 0
  v_mov_b64 v[208:209], 0
  v_mov_b64 v[210:211], 0
  v_mov_b64 v[212:213], 0
  v_mov_b64 v[214:215], 0
  v_mov_b64 v[216:217], 0
  v_mov_b64 v[218:219], 0
  v_mov_b64 v[220:221], 0
  v_mov_b64 v[222:223], 0
  s_mul_i32 s4, s85, 320
  s_add_u32 s4, s4, 151552
  v_and_b32_e64 v2, 15, v1
  v_lshl_add_u32 v3, v2, 2, s4
  v_add_u32 v10, s4, v29
  s_lshl_b32 s5, s86, 7
  s_add_u32 s5, s5, 153088
  v_add_u32_e64 v8, s5, v29
  v_lshl_add_u32 v2, v2, 2, s5
  s_mov_b32 s10, 0x7f
  s_mov_b32 s12, 0xff00ff00
  s_add_u32 s9, s11, 65536
  v_lshrrev_b32_e64 v9, 1, v11
  v_bfi_b32 v9, s10, v11, v9
  s_mov_b32 s22, Lz1-Lz0+8
  s_cmp_lg_u32 s82, 0
  s_cselect_b64 vcc, -1, 0
  s_waitcnt lgkmcnt(0)
  s_barrier
Lo_6:
  ds_read_b128 v[32:35], v4 offset:0
  ds_read_b128 v[48:51], v5 offset:0
  ds_read_b128 v[36:39], v4 offset:2048
  ds_read_b128 v[52:55], v5 offset:2048
  ds_read_b128 v[40:43], v4 offset:4096
  ds_read_b128 v[56:59], v5 offset:4096
  ds_read_b64_tr_b16 v[96:97], v6 offset:0
  ds_read_b64_tr_b16 v[98:99], v6 offset:2048
  ds_read_b64_tr_b16 v[100:101], v6 offset:4096
  ds_read_b64_tr_b16 v[102:103], v6 offset:6144
  ds_read_b128 v[44:47], v4 offset:6144
  ds_read_b128 v[60:63], v5 offset:6144
  ds_read_b64_tr_b16 v[104:105], v7 offset:0
  s_nop 0
  s_waitcnt lgkmcnt(8)
  ds_read_b64_tr_b16 v[106:107], v7 offset:2048
  ds_read_b64_tr_b16 v[108:109], v7 offset:4096
  ds_read_b64_tr_b16 v[110:111], v7 offset:6144
  s_nop 0
  s_waitcnt lgkmcnt(6)
  .p2align 6
Lk_3:
  v_mfma_f32_16x16x32_bf16 v[128:131], v[96:99], v[32:35], v[128:131]
  ds_read_b64_tr_b16 v[112:113], v6 offset:8192
  v_mfma_f32_16x16x32_bf16 v[128:131], v[100:103], v[48:51], v[128:131]
  ds_read_b64_tr_b16 v[114:115], v6 offset:10240
  v_mfma_f32_16x16x32_bf16 v[136:139], v[100:103], v[52:55], v[136:139]
  ds_read_b64_tr_b16 v[116:117], v6 offset:12288
  v_mfma_f32_16x16x32_bf16 v[136:139], v[96:99], v[36:39], v[136:139]
  ds_read_b64_tr_b16 v[118:119], v6 offset:14336
  v_mfma_f32_16x16x32_bf16 v[144:147], v[96:99], v[40:43], v[144:147]
  s_add_u32 s16, s16, s17
  s_cmp_eq_u32 s16, 65536
  s_cselect_b32 s23, s18, s17
  s_cselect_b32 s16, Lz1-Lz0+0, s16
  v_mfma_f32_16x16x32_bf16 v[144:147], v[100:103], v[56:59], v[144:147]
  v_add_u32_e64 v4, s23, v4
  v_add_u32 v5, s23, v5
  s_add_u32 s19, s19, s20
  s_cmp_eq_u32 s19, 73728
  s_waitcnt lgkmcnt(8)
  v_mfma_f32_16x16x32_bf16 v[152:155], v[100:103], v[60:63], v[152:155]
  s_cselect_b32 s23, s21, s20
  s_cselect_b32 s19, 0, s19
  v_mfma_f32_16x16x32_bf16 v[152:155], v[96:99], v[44:47], v[152:155]
  s_waitcnt lgkmcnt(4)
  v_mfma_f32_16x16x32_bf16 v[156:159], v[104:107], v[44:47], v[156:159]
  ds_read_b64_tr_b16 v[120:121], v7 offset:8192
  v_mfma_f32_16x16x32_bf16 v[156:159], v[108:111], v[60:63], v[156:159]
  ds_read_b64_tr_b16 v[122:123], v7 offset:10240
  v_mfma_f32_16x16x32_bf16 v[148:151], v[108:111], v[56:59], v[148:151]
  ds_read_b64_tr_b16 v[124:125], v7 offset:12288
  v_mfma_f32_16x16x32_bf16 v[148:151], v[104:107], v[40:43], v[148:151]
  ds_read_b64_tr_b16 v[126:127], v7 offset:14336
  v_mfma_f32_16x16x32_bf16 v[140:143], v[104:107], v[36:39], v[140:143]
  ds_read_b64_tr_b16 v[224:225], v6 offset:16384
  v_mfma_f32_16x16x32_bf16 v[140:143], v[108:111], v[52:55], v[140:143]
  ds_read_b64_tr_b16 v[226:227], v6 offset:18432
  v_mfma_f32_16x16x32_bf16 v[132:135], v[108:111], v[48:51], v[132:135]
  ds_read_b64_tr_b16 v[228:229], v6 offset:20480
  v_mfma_f32_16x16x32_bf16 v[132:135], v[104:107], v[32:35], v[132:135]
  ds_read_b64_tr_b16 v[230:231], v6 offset:22528
  s_nop 0
  s_waitcnt lgkmcnt(8)
  v_mfma_f32_16x16x32_bf16 v[160:163], v[112:115], v[32:35], v[160:163]
  ds_read_b64_tr_b16 v[232:233], v7 offset:16384
  v_mfma_f32_16x16x32_bf16 v[160:163], v[116:119], v[48:51], v[160:163]
  ds_read_b64_tr_b16 v[234:235], v7 offset:18432
  v_mfma_f32_16x16x32_bf16 v[168:171], v[116:119], v[52:55], v[168:171]
  ds_read_b64_tr_b16 v[236:237], v7 offset:20480
  v_mfma_f32_16x16x32_bf16 v[168:171], v[112:115], v[36:39], v[168:171]
  ds_read_b64_tr_b16 v[238:239], v7 offset:22528
  v_mfma_f32_16x16x32_bf16 v[176:179], v[112:115], v[40:43], v[176:179]
  v_add_u32_e64 v6, s23, v6
  v_mfma_f32_16x16x32_bf16 v[176:179], v[116:119], v[56:59], v[176:179]
  v_add_u32_e64 v7, s23, v7
  v_mfma_f32_16x16x32_bf16 v[184:187], v[116:119], v[60:63], v[184:187]
  v_mfma_f32_16x16x32_bf16 v[184:187], v[112:115], v[44:47], v[184:187]
  s_cbranch_vccnz Lo_9
  s_waitcnt lgkmcnt(0)
  s_nop 0
  s_barrier
Lo_8:
  v_mfma_f32_16x16x32_bf16 v[188:191], v[120:123], v[44:47], v[188:191]
  ds_read_b128 v[64:67], v4 offset:0
  v_mfma_f32_16x16x32_bf16 v[188:191], v[124:127], v[60:63], v[188:191]
  ds_read_b128 v[80:83], v5 offset:0
  v_mfma_f32_16x16x32_bf16 v[180:183], v[124:127], v[56:59], v[180:183]
  v_mfma_f32_16x16x32_bf16 v[180:183], v[120:123], v[40:43], v[180:183]
  ds_read_b128 v[68:71], v4 offset:2048
  v_mfma_f32_16x16x32_bf16 v[172:175], v[120:123], v[36:39], v[172:175]
  ds_read_b128 v[84:87], v5 offset:2048
  v_mfma_f32_16x16x32_bf16 v[172:175], v[124:127], v[52:55], v[172:175]
  v_mfma_f32_16x16x32_bf16 v[164:167], v[124:127], v[48:51], v[164:167]
  ds_read_b128 v[72:75], v4 offset:4096
  v_mfma_f32_16x16x32_bf16 v[164:167], v[120:123], v[32:35], v[164:167]
  ds_read_b128 v[88:91], v5 offset:4096
  v_mfma_f32_16x16x32_bf16 v[192:195], v[32:35], v[224:227], v[192:195]
  ds_read_b64_tr_b16 v[96:97], v6 offset:0
  v_mfma_f32_16x16x32_bf16 v[192:195], v[48:51], v[228:231], v[192:195]
  ds_read_b64_tr_b16 v[98:99], v6 offset:2048
  v_mfma_f32_16x16x32_bf16 v[200:203], v[52:55], v[228:231], v[200:203]
  ds_read_b64_tr_b16 v[100:101], v6 offset:4096
  v_mfma_f32_16x16x32_bf16 v[200:203], v[36:39], v[224:227], v[200:203]
  ds_read_b64_tr_b16 v[102:103], v6 offset:6144
  v_mfma_f32_16x16x32_bf16 v[208:211], v[40:43], v[224:227], v[208:211]
  ds_read_b128 v[76:79], v4 offset:6144
  v_mfma_f32_16x16x32_bf16 v[208:211], v[56:59], v[228:231], v[208:211]
  v_mfma_f32_16x16x32_bf16 v[216:219], v[60:63], v[228:231], v[216:219]
  ds_read_b128 v[92:95], v5 offset:6144
  v_mfma_f32_16x16x32_bf16 v[216:219], v[44:47], v[224:227], v[216:219]
  v_mfma_f32_16x16x32_bf16 v[220:223], v[44:47], v[232:235], v[220:223]
  ds_read_b64_tr_b16 v[104:105], v7 offset:0
  v_mfma_f32_16x16x32_bf16 v[220:223], v[60:63], v[236:239], v[220:223]
  v_mfma_f32_16x16x32_bf16 v[212:215], v[56:59], v[236:239], v[212:215]
  ds_read_b64_tr_b16 v[106:107], v7 offset:2048
  v_mfma_f32_16x16x32_bf16 v[212:215], v[40:43], v[232:235], v[212:215]
  v_mfma_f32_16x16x32_bf16 v[204:207], v[36:39], v[232:235], v[204:207]
  ds_read_b64_tr_b16 v[108:109], v7 offset:4096
  v_mfma_f32_16x16x32_bf16 v[204:207], v[52:55], v[236:239], v[204:207]
  v_mfma_f32_16x16x32_bf16 v[196:199], v[48:51], v[236:239], v[196:199]
  ds_read_b64_tr_b16 v[110:111], v7 offset:6144
  s_waitcnt lgkmcnt(6)
  v_mfma_f32_16x16x32_bf16 v[196:199], v[32:35], v[232:235], v[196:199]
  s_cbranch_vccnz Lo_7
Lk_4:
  v_mfma_f32_16x16x32_bf16 v[128:131], v[96:99], v[64:67], v[128:131]
  ds_read_b64_tr_b16 v[112:113], v6 offset:8192
  v_mfma_f32_16x16x32_bf16 v[128:131], v[100:103], v[80:83], v[128:131]
  ds_read_b64_tr_b16 v[114:115], v6 offset:10240
  v_mfma_f32_16x16x32_bf16 v[136:139], v[100:103], v[84:87], v[136:139]
  ds_read_b64_tr_b16 v[116:117], v6 offset:12288
  v_mfma_f32_16x16x32_bf16 v[136:139], v[96:99], v[68:71], v[136:139]
  ds_read_b64_tr_b16 v[118:119], v6 offset:14336
  v_mfma_f32_16x16x32_bf16 v[144:147], v[96:99], v[72:75], v[144:147]
  s_add_u32 s16, s16, s17
  s_cmp_eq_u32 s16, 65536
  s_cselect_b32 s23, s18, s17
  s_cselect_b32 s16, Lz1-Lz0+0, s16
  v_mfma_f32_16x16x32_bf16 v[144:147], v[100:103], v[88:91], v[144:147]
  v_add_u32_e64 v4, s23, v4
  v_add_u32 v5, s23, v5
  s_add_u32 s19, s19, s20
  s_cmp_eq_u32 s19, 73728
  s_waitcnt lgkmcnt(8)
  v_mfma_f32_16x16x32_bf16 v[152:155], v[100:103], v[92:95], v[152:155]
  s_cselect_b32 s23, s21, s20
  s_cselect_b32 s19, 0, s19
  v_mfma_f32_16x16x32_bf16 v[152:155], v[96:99], v[76:79], v[152:155]
  s_waitcnt lgkmcnt(4)
  v_mfma_f32_16x16x32_bf16 v[156:159], v[104:107], v[76:79], v[156:159]
  ds_read_b64_tr_b16 v[120:121], v7 offset:8192
  v_mfma_f32_16x16x32_bf16 v[156:159], v[108:111], v[92:95], v[156:159]
  ds_read_b64_tr_b16 v[122:123], v7 offset:10240
  v_mfma_f32_16x16x32_bf16 v[148:151], v[108:111], v[88:91], v[148:151]
  ds_read_b64_tr_b16 v[124:125], v7 offset:12288
  v_mfma_f32_16x16x32_bf16 v[148:151], v[104:107], v[72:75], v[148:151]
  ds_read_b64_tr_b16 v[126:127], v7 offset:14336
  v_mfma_f32_16x16x32_bf16 v[140:143], v[104:107], v[68:71], v[140:143]
  ds_read_b64_tr_b16 v[224:225], v6 offset:16384
  v_mfma_f32_16x16x32_bf16 v[140:143], v[108:111], v[84:87], v[140:143]
  ds_read_b64_tr_b16 v[226:227], v6 offset:18432
  v_mfma_f32_16x16x32_bf16 v[132:135], v[108:111], v[80:83], v[132:135]
  ds_read_b64_tr_b16 v[228:229], v6 offset:20480
  v_mfma_f32_16x16x32_bf16 v[132:135], v[104:107], v[64:67], v[132:135]
  ds_read_b64_tr_b16 v[230:231], v6 offset:22528
  s_nop 0
  s_waitcnt lgkmcnt(8)
  v_mfma_f32_16x16x32_bf16 v[160:163], v[112:115], v[64:67], v[160:163]
  ds_read_b64_tr_b16 v[232:233], v7 offset:16384
  v_mfma_f32_16x16x32_bf16 v[160:163], v[116:119], v[80:83], v[160:163]
  ds_read_b64_tr_b16 v[234:235], v7 offset:18432
  v_mfma_f32_16x16x32_bf16 v[168:171], v[116:119], v[84:87], v[168:171]
  ds_read_b64_tr_b16 v[236:237], v7 offset:20480
  v_mfma_f32_16x16x32_bf16 v[168:171], v[112:115], v[68:71], v[168:171]
  ds_read_b64_tr_b16 v[238:239], v7 offset:22528
  v_mfma_f32_16x16x32_bf16 v[176:179], v[112:115], v[72:75], v[176:179]
  v_add_u32_e64 v6, s23, v6
  v_mfma_f32_16x16x32_bf16 v[176:179], v[116:119], v[88:91], v[176:179]
  v_add_u32_e64 v7, s23, v7
  v_mfma_f32_16x16x32_bf16 v[184:187], v[116:119], v[92:95], v[184:187]
  s_sub_u32 s22, s22, 1
  s_cmp_lg_u32 s22, 0
  v_mfma_f32_16x16x32_bf16 v[184:187], v[112:115], v[76:79], v[184:187]
  s_waitcnt lgkmcnt(0)
  s_barrier
  v_mfma_f32_16x16x32_bf16 v[188:191], v[120:123], v[76:79], v[188:191]
  s_nop 0
  s_cbranch_scc0 Lk_5
  ds_read_b128 v[32:35], v4 offset:0
  v_mfma_f32_16x16x32_bf16 v[188:191], v[124:127], v[92:95], v[188:191]
  ds_read_b128 v[48:51], v5 offset:0
  v_mfma_f32_16x16x32_bf16 v[180:183], v[124:127], v[88:91], v[180:183]
  v_mfma_f32_16x16x32_bf16 v[180:183], v[120:123], v[72:75], v[180:183]
  ds_read_b128 v[36:39], v4 offset:2048
  v_mfma_f32_16x16x32_bf16 v[172:175], v[120:123], v[68:71], v[172:175]
  ds_read_b128 v[52:55], v5 offset:2048
  v_mfma_f32_16x16x32_bf16 v[172:175], v[124:127], v[84:87], v[172:175]
  v_mfma_f32_16x16x32_bf16 v[164:167], v[124:127], v[80:83], v[164:167]
  ds_read_b128 v[40:43], v4 offset:4096
  v_mfma_f32_16x16x32_bf16 v[164:167], v[120:123], v[64:67], v[164:167]
  ds_read_b128 v[56:59], v5 offset:4096
  v_mfma_f32_16x16x32_bf16 v[192:195], v[64:67], v[224:227], v[192:195]
  ds_read_b64_tr_b16 v[96:97], v6 offset:0
  v_mfma_f32_16x16x32_bf16 v[192:195], v[80:83], v[228:231], v[192:195]
  ds_read_b64_tr_b16 v[98:99], v6 offset:2048
  v_mfma_f32_16x16x32_bf16 v[200:203], v[84:87], v[228:231], v[200:203]
  ds_read_b64_tr_b16 v[100:101], v6 offset:4096
  v_mfma_f32_16x16x32_bf16 v[200:203], v[68:71], v[224:227], v[200:203]
  ds_read_b64_tr_b16 v[102:103], v6 offset:6144
  v_mfma_f32_16x16x32_bf16 v[208:211], v[72:75], v[224:227], v[208:211]
  ds_read_b128 v[44:47], v4 offset:6144
  v_mfma_f32_16x16x32_bf16 v[208:211], v[88:91], v[228:231], v[208:211]
  v_mfma_f32_16x16x32_bf16 v[216:219], v[92:95], v[228:231], v[216:219]
  ds_read_b128 v[60:63], v5 offset:6144
  v_mfma_f32_16x16x32_bf16 v[216:219], v[76:79], v[224:227], v[216:219]
  v_mfma_f32_16x16x32_bf16 v[220:223], v[76:79], v[232:235], v[220:223]
  ds_read_b64_tr_b16 v[104:105], v7 offset:0
  v_mfma_f32_16x16x32_bf16 v[220:223], v[92:95], v[236:239], v[220:223]
  v_mfma_f32_16x16x32_bf16 v[212:215], v[88:91], v[236:239], v[212:215]
  ds_read_b64_tr_b16 v[106:107], v7 offset:2048
  v_mfma_f32_16x16x32_bf16 v[212:215], v[72:75], v[232:235], v[212:215]
  v_mfma_f32_16x16x32_bf16 v[204:207], v[68:71], v[232:235], v[204:207]
  ds_read_b64_tr_b16 v[108:109], v7 offset:4096
  v_mfma_f32_16x16x32_bf16 v[204:207], v[84:87], v[236:239], v[204:207]
  v_mfma_f32_16x16x32_bf16 v[196:199], v[80:83], v[236:239], v[196:199]
  ds_read_b64_tr_b16 v[110:111], v7 offset:6144
  s_waitcnt lgkmcnt(6)
  v_mfma_f32_16x16x32_bf16 v[196:199], v[64:67], v[232:235], v[196:199]
  s_branch Lk_3
Lk_5:
  ds_read2_b32 v[4:5], v3 offset0:48 offset1:208
  ds_read_b128 v[106:109], v8 offset:256
  v_mfma_f32_16x16x32_bf16 v[188:191], v[124:127], v[92:95], v[188:191]
  ds_read_b128 v[110:113], v8 offset:320
  ds_read_b128 v[32:35], v10 offset:192
  v_mfma_f32_16x16x32_bf16 v[216:219], v[92:95], v[228:231], v[216:219]
  ds_read_b128 v[36:39], v10 offset:832
  ds_read2_b32 v[114:115], v2 offset0:128 offset1:144
  v_mfma_f32_16x16x32_bf16 v[216:219], v[76:79], v[224:227], v[216:219]
  ds_read_b128 v[98:101], v8 offset:0
  ds_read_b128 v[102:105], v8 offset:64
  v_mfma_f32_16x16x32_bf16 v[220:223], v[76:79], v[232:235], v[220:223]
  ds_read2_b32 v[6:7], v3 offset0:32 offset1:192
  ds_read2_b32 v[96:97], v3 offset0:16 offset1:176
  v_mfma_f32_16x16x32_bf16 v[220:223], v[92:95], v[236:239], v[220:223]
  v_mfma_f32_16x16x32_bf16 v[180:183], v[124:127], v[88:91], v[180:183]
  v_mfma_f32_16x16x32_bf16 v[180:183], v[120:123], v[72:75], v[180:183]
  v_mfma_f32_16x16x32_bf16 v[172:175], v[120:123], v[68:71], v[172:175]
  s_waitcnt lgkmcnt(4)
  v_mul_f32 v116, v106, v5
  v_mul_f32 v117, v107, v5
  v_mul_f32 v118, v108, v5
  v_mfma_f32_16x16x32_bf16 v[172:175], v[124:127], v[84:87], v[172:175]
  v_mul_f32_e64 v119, v109, v5
  v_fma_f32 v184, v184, v4, -v116
  v_fma_f32 v185, v185, v4, -v117
  v_mfma_f32_16x16x32_bf16 v[164:167], v[124:127], v[80:83], v[164:167]
  v_fma_f32 v186, v186, v4, -v118
  v_fma_f32 v187, v187, v4, -v119
  v_cvt_pk_bf16_f32 v60, v184, v185
  v_mfma_f32_16x16x32_bf16 v[164:167], v[120:123], v[64:67], v[164:167]
  v_cvt_pk_bf16_f32 v61, v186, v187
  v_mul_f32 v116, v110, v5
  v_mul_f32 v117, v111, v5
  v_mfma_f32_16x16x32_bf16 v[192:195], v[64:67], v[224:227], v[192:195]
  ds_read2_b32 v[124:125], v3 offset0:0 offset1:160
  v_mul_f32 v118, v112, v5
  v_mul_f32 v119, v113, v5
  v_fma_f32 v188, v188, v4, -v116
  v_mfma_f32_16x16x32_bf16 v[192:195], v[80:83], v[228:231], v[192:195]
  v_mov_b32 v120, 0x3f803f80
  v_fma_f32 v189, v189, v4, -v117
  v_fma_f32 v190, v190, v4, -v118
  v_fma_f32 v191, v191, v4, -v119
  v_mfma_f32_16x16x32_bf16 v[196:199], v[80:83], v[236:239], v[196:199]
  v_mov_b32 v121, 0x3f803f80
  v_cvt_pk_bf16_f32 v62, v188, v189
  v_cvt_pk_bf16_f32 v63, v190, v191
  v_mfma_f32_16x16x32_bf16 v[196:199], v[64:67], v[232:235], v[196:199]
  v_mov_b32 v122, 0x3f803f80
  s_mov_b32 exec_lo, s12
  s_mov_b32 exec_hi, s12
  buffer_store_dwordx4 v[60:63], v9, s[40:43], s9 offen sc0 sc1
  s_mov_b64 exec, -1
  v_mul_f32 v116, v36, v114
  v_mul_f32 v117, v37, v114
  v_mul_f32 v118, v38, v114
  v_mfma_f32_16x16x32_bf16 v[204:207], v[68:71], v[232:235], v[204:207]
  v_mov_b32 v123, 0x3f803f80
  v_mul_f32_e64 v119, v39, v114
  v_fma_f32 v216, v216, v32, -v116
  v_fma_f32 v217, v217, v33, -v117
  v_mfma_f32_16x16x32_bf16 v[204:207], v[84:87], v[236:239], v[204:207]
  v_fma_f32 v218, v218, v34, -v118
  v_fma_f32 v219, v219, v35, -v119
  v_cvt_pk_bf16_f32 v76, v216, v217
  v_mfma_f32_16x16x32_bf16 v[200:203], v[84:87], v[228:231], v[200:203]
  v_cvt_pk_bf16_f32 v77, v218, v219
  v_mul_f32 v116, v36, v115
  v_mul_f32 v117, v37, v115
  v_mfma_f32_16x16x32_bf16 v[200:203], v[68:71], v[224:227], v[200:203]
  v_mul_f32 v118, v38, v115
  v_mul_f32 v119, v39, v115
  v_fma_f32 v220, v220, v32, -v116
  v_mfma_f32_16x16x32_bf16 v[208:211], v[72:75], v[224:227], v[208:211]
  v_fma_f32 v221, v221, v33, -v117
  v_fma_f32 v222, v222, v34, -v118
  v_fma_f32 v223, v223, v35, -v119
  v_mfma_f32_16x16x32_bf16 v[208:211], v[88:91], v[228:231], v[208:211]
  v_cvt_pk_bf16_f32 v78, v220, v221
  v_cvt_pk_bf16_f32 v79, v222, v223
  v_mfma_f32_16x16x32_bf16 v[212:215], v[88:91], v[236:239], v[212:215]
  s_mov_b32 exec_lo, 0
  buffer_store_dwordx4 v[76:79], v11, s[40:43], s9 offen sc0 sc1
  s_mov_b64 exec, -1
  v_mfma_f32_16x16x32_bf16 v[212:215], v[72:75], v[232:235], v[212:215]
  v_mov_b64_e64 v[86:87], v[78:79]
  s_cmp_lg_u32 s82, 0
  s_cbranch_scc1 L_10
  buffer_load_dwordx4 v[240:243], v255, s[44:47], s25 offen
  s_add_u32 s25, s25, 0x10000
  buffer_load_dwordx4 v[244:247], v255, s[44:47], s25 offen
  s_add_u32 s25, s25, 0x10000
  buffer_load_dwordx4 v[248:251], v255, s[44:47], s25 offen
  s_add_u32 s25, s25, 0x10000
  buffer_load_dwordx4 v[252:255], v255, s[44:47], s25 offen
L_10:
  v_mov_b64 v[64:65], 0
  v_mov_b64 v[66:67], 0
  v_mov_b64_e64 v[232:233], 0
  v_mov_b64 v[234:235], 0
  s_waitcnt lgkmcnt(0)
  v_pk_mul_f32 v[116:117], v[98:99], v[124:125] op_sel:[0,1] op_sel_hi:[1,1]
  v_pk_mul_f32 v[118:119], v[100:101], v[124:125] op_sel:[0,1] op_sel_hi:[1,1]
  v_pk_fma_f32 v[128:129], v[128:129], v[124:125], v[116:117] op_sel:[0,0,0] op_sel_hi:[1,0,1] neg_lo:[0,0,1] neg_hi:[0,0,1]
  v_pk_fma_f32 v[130:131], v[130:131], v[124:125], v[118:119] op_sel:[0,0,0] op_sel_hi:[1,0,1] neg_lo:[0,0,1] neg_hi:[0,0,1]
  v_cvt_pk_bf16_f32 v32, v128, v129
  v_cvt_pk_bf16_f32 v33, v130, v131
  v_pk_mul_f32 v[116:117], v[102:103], v[124:125] op_sel:[0,1] op_sel_hi:[1,1]
  v_pk_mul_f32 v[118:119], v[104:105], v[124:125] op_sel:[0,1] op_sel_hi:[1,1]
  v_pk_fma_f32 v[132:133], v[132:133], v[124:125], v[116:117] op_sel:[0,0,0] op_sel_hi:[1,0,1] neg_lo:[0,0,1] neg_hi:[0,0,1]
  v_pk_fma_f32 v[134:135], v[134:135], v[124:125], v[118:119] op_sel:[0,0,0] op_sel_hi:[1,0,1] neg_lo:[0,0,1] neg_hi:[0,0,1]
  v_cvt_pk_bf16_f32 v34, v132, v133
  v_cvt_pk_bf16_f32 v35, v134, v135
  v_pk_mul_f32 v[116:117], v[98:99], v[96:97] op_sel:[0,1] op_sel_hi:[1,1]
  v_pk_mul_f32 v[118:119], v[100:101], v[96:97] op_sel:[0,1] op_sel_hi:[1,1]
  v_pk_fma_f32 v[136:137], v[136:137], v[96:97], v[116:117] op_sel:[0,0,0] op_sel_hi:[1,0,1] neg_lo:[0,0,1] neg_hi:[0,0,1]
  v_pk_fma_f32 v[138:139], v[138:139], v[96:97], v[118:119] op_sel:[0,0,0] op_sel_hi:[1,0,1] neg_lo:[0,0,1] neg_hi:[0,0,1]
  v_cvt_pk_bf16_f32 v36, v136, v137
  v_cvt_pk_bf16_f32 v37, v138, v139
  v_pk_mul_f32 v[116:117], v[102:103], v[96:97] op_sel:[0,1] op_sel_hi:[1,1]
  v_pk_mul_f32 v[118:119], v[104:105], v[96:97] op_sel:[0,1] op_sel_hi:[1,1]
  v_pk_fma_f32 v[140:141], v[140:141], v[96:97], v[116:117] op_sel:[0,0,0] op_sel_hi:[1,0,1] neg_lo:[0,0,1] neg_hi:[0,0,1]
  v_pk_fma_f32 v[142:143], v[142:143], v[96:97], v[118:119] op_sel:[0,0,0] op_sel_hi:[1,0,1] neg_lo:[0,0,1] neg_hi:[0,0,1]
  v_cvt_pk_bf16_f32 v38, v140, v141
  v_cvt_pk_bf16_f32 v39, v142, v143
  v_pk_mul_f32 v[116:117], v[98:99], v[6:7] op_sel:[0,1] op_sel_hi:[1,1]
  v_pk_mul_f32 v[118:119], v[100:101], v[6:7] op_sel:[0,1] op_sel_hi:[1,1]
  v_pk_fma_f32 v[144:145], v[144:145], v[6:7], v[116:117] op_sel:[0,0,0] op_sel_hi:[1,0,1] neg_lo:[0,0,1] neg_hi:[0,0,1]
  v_pk_fma_f32 v[146:147], v[146:147], v[6:7], v[118:119] op_sel:[0,0,0] op_sel_hi:[1,0,1] neg_lo:[0,0,1] neg_hi:[0,0,1]
  v_cvt_pk_bf16_f32 v40, v144, v145
  v_cvt_pk_bf16_f32 v41, v146, v147
  v_pk_mul_f32 v[116:117], v[102:103], v[6:7] op_sel:[0,1] op_sel_hi:[1,1]
  v_pk_mul_f32 v[118:119], v[104:105], v[6:7] op_sel:[0,1] op_sel_hi:[1,1]
  v_pk_fma_f32 v[148:149], v[148:149], v[6:7], v[116:117] op_sel:[0,0,0] op_sel_hi:[1,0,1] neg_lo:[0,0,1] neg_hi:[0,0,1]
  v_pk_fma_f32 v[150:151], v[150:151], v[6:7], v[118:119] op_sel:[0,0,0] op_sel_hi:[1,0,1] neg_lo:[0,0,1] neg_hi:[0,0,1]
  v_cvt_pk_bf16_f32 v42, v148, v149
  v_cvt_pk_bf16_f32 v43, v150, v151
  v_pk_mul_f32 v[116:117], v[98:99], v[4:5] op_sel:[0,1] op_sel_hi:[1,1]
  v_pk_mul_f32 v[118:119], v[100:101], v[4:5] op_sel:[0,1] op_sel_hi:[1,1]
  v_pk_fma_f32 v[152:153], v[152:153], v[4:5], v[116:117] op_sel:[0,0,0] op_sel_hi:[1,0,1] neg_lo:[0,0,1] neg_hi:[0,0,1]
  v_pk_fma_f32 v[154:155], v[154:155], v[4:5], v[118:119] op_sel:[0,0,0] op_sel_hi:[1,0,1] neg_lo:[0,0,1] neg_hi:[0,0,1]
  v_cvt_pk_bf16_f32 v44, v152, v153
  v_cvt_pk_bf16_f32 v45, v154, v155
  v_pk_mul_f32 v[116:117], v[102:103], v[4:5] op_sel:[0,1] op_sel_hi:[1,1]
  v_pk_mul_f32 v[118:119], v[104:105], v[4:5] op_sel:[0,1] op_sel_hi:[1,1]
  v_pk_fma_f32 v[156:157], v[156:157], v[4:5], v[116:117] op_sel:[0,0,0] op_sel_hi:[1,0,1] neg_lo:[0,0,1] neg_hi:[0,0,1]
  v_pk_fma_f32 v[158:159], v[158:159], v[4:5], v[118:119] op_sel:[0,0,0] op_sel_hi:[1,0,1] neg_lo:[0,0,1] neg_hi:[0,0,1]
  v_cvt_pk_bf16_f32 v46, v156, v157
  v_cvt_pk_bf16_f32 v47, v158, v159
  ds_read_b128 v[128:131], v10 offset:0
  ds_read_b128 v[132:135], v10 offset:640
  ds_read_b128 v[136:139], v10 offset:64
  ds_read_b128 v[140:143], v10 offset:704
  ds_read_b128 v[144:147], v10 offset:128
  ds_read_b128 v[148:151], v10 offset:768
  v_pk_mul_f32 v[116:117], v[106:107], v[124:125] op_sel:[0,1] op_sel_hi:[1,1]
  v_pk_mul_f32 v[118:119], v[108:109], v[124:125] op_sel:[0,1] op_sel_hi:[1,1]
  v_pk_fma_f32 v[160:161], v[160:161], v[124:125], v[116:117] op_sel:[0,0,0] op_sel_hi:[1,0,1] neg_lo:[0,0,1] neg_hi:[0,0,1]
  v_pk_fma_f32 v[162:163], v[162:163], v[124:125], v[118:119] op_sel:[0,0,0] op_sel_hi:[1,0,1] neg_lo:[0,0,1] neg_hi:[0,0,1]
  v_cvt_pk_bf16_f32 v48, v160, v161
  v_cvt_pk_bf16_f32 v49, v162, v163
  v_pk_mul_f32 v[116:117], v[110:111], v[124:125] op_sel:[0,1] op_sel_hi:[1,1]
  v_pk_mul_f32 v[118:119], v[112:113], v[124:125] op_sel:[0,1] op_sel_hi:[1,1]
  v_pk_fma_f32 v[164:165], v[164:165], v[124:125], v[116:117] op_sel:[0,0,0] op_sel_hi:[1,0,1] neg_lo:[0,0,1] neg_hi:[0,0,1]
  v_pk_fma_f32 v[166:167], v[166:167], v[124:125], v[118:119] op_sel:[0,0,0] op_sel_hi:[1,0,1] neg_lo:[0,0,1] neg_hi:[0,0,1]
  v_cvt_pk_bf16_f32 v50, v164, v165
  v_cvt_pk_bf16_f32 v51, v166, v167
  v_pk_mul_f32 v[116:117], v[106:107], v[96:97] op_sel:[0,1] op_sel_hi:[1,1]
  v_pk_mul_f32 v[118:119], v[108:109], v[96:97] op_sel:[0,1] op_sel_hi:[1,1]
  v_pk_fma_f32 v[168:169], v[168:169], v[96:97], v[116:117] op_sel:[0,0,0] op_sel_hi:[1,0,1] neg_lo:[0,0,1] neg_hi:[0,0,1]
  v_pk_fma_f32 v[170:171], v[170:171], v[96:97], v[118:119] op_sel:[0,0,0] op_sel_hi:[1,0,1] neg_lo:[0,0,1] neg_hi:[0,0,1]
  v_cvt_pk_bf16_f32 v52, v168, v169
  v_cvt_pk_bf16_f32 v53, v170, v171
  v_pk_mul_f32 v[116:117], v[110:111], v[96:97] op_sel:[0,1] op_sel_hi:[1,1]
  v_pk_mul_f32 v[118:119], v[112:113], v[96:97] op_sel:[0,1] op_sel_hi:[1,1]
  v_pk_fma_f32 v[172:173], v[172:173], v[96:97], v[116:117] op_sel:[0,0,0] op_sel_hi:[1,0,1] neg_lo:[0,0,1] neg_hi:[0,0,1]
  v_pk_fma_f32 v[174:175], v[174:175], v[96:97], v[118:119] op_sel:[0,0,0] op_sel_hi:[1,0,1] neg_lo:[0,0,1] neg_hi:[0,0,1]
  v_cvt_pk_bf16_f32 v54, v172, v173
  v_cvt_pk_bf16_f32 v55, v174, v175
  v_pk_mul_f32 v[116:117], v[106:107], v[6:7] op_sel:[0,1] op_sel_hi:[1,1]
  v_pk_mul_f32 v[118:119], v[108:109], v[6:7] op_sel:[0,1] op_sel_hi:[1,1]
  v_pk_fma_f32 v[176:177], v[176:177], v[6:7], v[116:117] op_sel:[0,0,0] op_sel_hi:[1,0,1] neg_lo:[0,0,1] neg_hi:[0,0,1]
  v_pk_fma_f32 v[178:179], v[178:179], v[6:7], v[118:119] op_sel:[0,0,0] op_sel_hi:[1,0,1] neg_lo:[0,0,1] neg_hi:[0,0,1]
  v_cvt_pk_bf16_f32 v56, v176, v177
  v_cvt_pk_bf16_f32 v57, v178, v179
  v_pk_mul_f32 v[116:117], v[110:111], v[6:7] op_sel:[0,1] op_sel_hi:[1,1]
  v_pk_mul_f32 v[118:119], v[112:113], v[6:7] op_sel:[0,1] op_sel_hi:[1,1]
  v_pk_fma_f32 v[180:181], v[180:181], v[6:7], v[116:117] op_sel:[0,0,0] op_sel_hi:[1,0,1] neg_lo:[0,0,1] neg_hi:[0,0,1]
  v_pk_fma_f32 v[182:183], v[182:183], v[6:7], v[118:119] op_sel:[0,0,0] op_sel_hi:[1,0,1] neg_lo:[0,0,1] neg_hi:[0,0,1]
  v_cvt_pk_bf16_f32 v58, v180, v181
  v_cvt_pk_bf16_f32 v59, v182, v183
  v_mfma_f32_16x16x32_bf16 v[164:167], v[48:51], v[32:35], v[12:15]
  v_mfma_f32_16x16x32_bf16 v[168:171], v[48:51], v[36:39], v[16:19]
  v_mfma_f32_16x16x32_bf16 v[172:175], v[52:55], v[36:39], v[12:15]
  v_mfma_f32_16x16x32_bf16 v[176:179], v[52:55], v[40:43], v[16:19]
  v_mfma_f32_16x16x32_bf16 v[180:183], v[56:59], v[40:43], v[12:15]
  v_mfma_f32_16x16x32_bf16 v[184:187], v[56:59], v[44:47], v[16:19]
  v_mfma_f32_16x16x32_bf16 v[188:191], v[60:63], v[44:47], v[12:15]
  s_nop 0
  s_waitcnt lgkmcnt(0)
  v_pk_mul_f32 v[116:117], v[132:133], v[114:115] op_sel:[0,0] op_sel_hi:[1,0]
  v_pk_mul_f32 v[118:119], v[134:135], v[114:115] op_sel:[0,0] op_sel_hi:[1,0]
  v_pk_fma_f32 v[192:193], v[192:193], v[128:129], v[116:117] neg_lo:[0,0,1] neg_hi:[0,0,1]
  v_pk_fma_f32 v[194:195], v[194:195], v[130:131], v[118:119] neg_lo:[0,0,1] neg_hi:[0,0,1]
  v_cvt_pk_bf16_f32 v70, v192, v193
  v_cvt_pk_bf16_f32 v71, v194, v195
  v_pk_mul_f32 v[116:117], v[132:133], v[114:115] op_sel:[0,1] op_sel_hi:[1,1]
  v_pk_mul_f32 v[118:119], v[134:135], v[114:115] op_sel:[0,1] op_sel_hi:[1,1]
  v_pk_fma_f32 v[196:197], v[196:197], v[128:129], v[116:117] neg_lo:[0,0,1] neg_hi:[0,0,1]
  v_pk_fma_f32 v[198:199], v[198:199], v[130:131], v[118:119] neg_lo:[0,0,1] neg_hi:[0,0,1]
  v_cvt_pk_bf16_f32 v80, v196, v197
  v_cvt_pk_bf16_f32 v81, v198, v199
  v_pk_mul_f32 v[116:117], v[140:141], v[114:115] op_sel:[0,0] op_sel_hi:[1,0]
  v_pk_mul_f32 v[118:119], v[142:143], v[114:115] op_sel:[0,0] op_sel_hi:[1,0]
  v_pk_fma_f32 v[200:201], v[200:201], v[136:137], v[116:117] neg_lo:[0,0,1] neg_hi:[0,0,1]
  v_pk_fma_f32 v[202:203], v[202:203], v[138:139], v[118:119] neg_lo:[0,0,1] neg_hi:[0,0,1]
  v_cvt_pk_bf16_f32 v72, v200, v201
  v_cvt_pk_bf16_f32 v73, v202, v203
  v_pk_mul_f32 v[116:117], v[140:141], v[114:115] op_sel:[0,1] op_sel_hi:[1,1]
  v_pk_mul_f32 v[118:119], v[142:143], v[114:115] op_sel:[0,1] op_sel_hi:[1,1]
  v_pk_fma_f32 v[204:205], v[204:205], v[136:137], v[116:117] neg_lo:[0,0,1] neg_hi:[0,0,1]
  v_pk_fma_f32 v[206:207], v[206:207], v[138:139], v[118:119] neg_lo:[0,0,1] neg_hi:[0,0,1]
  v_cvt_pk_bf16_f32 v82, v204, v205
  v_cvt_pk_bf16_f32 v83, v206, v207
  v_pk_mul_f32 v[116:117], v[148:149], v[114:115] op_sel:[0,0] op_sel_hi:[1,0]
  v_pk_mul_f32 v[118:119], v[150:151], v[114:115] op_sel:[0,0] op_sel_hi:[1,0]
  v_pk_fma_f32 v[208:209], v[208:209], v[144:145], v[116:117] neg_lo:[0,0,1] neg_hi:[0,0,1]
  v_pk_fma_f32 v[210:211], v[210:211], v[146:147], v[118:119] neg_lo:[0,0,1] neg_hi:[0,0,1]
  v_cvt_pk_bf16_f32 v74, v208, v209
  v_cvt_pk_bf16_f32 v75, v210, v211
  v_pk_mul_f32 v[116:117], v[148:149], v[114:115] op_sel:[0,1] op_sel_hi:[1,1]
  v_pk_mul_f32 v[118:119], v[150:151], v[114:115] op_sel:[0,1] op_sel_hi:[1,1]
  v_pk_fma_f32 v[212:213], v[212:213], v[144:145], v[116:117] neg_lo:[0,0,1] neg_hi:[0,0,1]
  v_pk_fma_f32 v[214:215], v[214:215], v[146:147], v[118:119] neg_lo:[0,0,1] neg_hi:[0,0,1]
  v_cvt_pk_bf16_f32 v84, v212, v213
  v_cvt_pk_bf16_f32 v85, v214, v215
  v_max3_f32 v90, v172, v173, v174
  v_max3_f32 v99, v175, v168, v169
  v_max3_f32 v92, v180, v181, v182
  v_max3_f32 v100, v183, v176, v177
  v_max3_f32 v94, v188, v189, v190
  v_max3_f32 v101, v191, v184, v185
  v_max3_f32 v90, v90, v170, v171
  v_max3_f32 v92, v92, v178, v179
  v_max3_f32 v94, v94, v186, v187
  v_max_f32 v90, v90, v99
  v_max_f32 v92, v92, v100
  v_max_f32 v94, v94, v101
  v_mov_b32 v99, v90
  v_mov_b32 v100, v92
  v_mov_b32 v101, v94
  v_permlane32_swap_b32 v90, v99
  v_permlane32_swap_b32 v92, v100
  v_permlane32_swap_b32 v94, v101
  v_max_f32 v90, v90, v99
  v_max_f32 v92, v92, v100
  v_max_f32 v94, v94, v101
  v_mov_b32 v99, v90
  v_mov_b32 v100, v92
  v_mov_b32 v101, v94
  v_permlane16_swap_b32 v90, v99
  v_permlane16_swap_b32 v92, v100
  v_permlane16_swap_b32 v94, v101
  v_max_f32 v90, v90, v99
  v_max_f32 v92, v92, v100
  v_max_f32_e64 v94, v94, v101
  s_mov_b32 s4, 0x3e8293ee
  v_mul_f32 v90, s4, v90
  v_mov_b32 v91, s4
  v_mul_f32 v92, s4, v92
  v_mov_b32 v93, s4
  v_mul_f32 v94, s4, v94
  v_mov_b32 v95, s4
  v_pk_fma_f32 v[168:169], v[168:169], v[90:91], v[90:91] op_sel:[0,1,0] op_sel_hi:[1,1,0] neg_lo:[0,0,1] neg_hi:[0,0,1]
  v_pk_fma_f32 v[170:171], v[170:171], v[90:91], v[90:91] op_sel:[0,1,0] op_sel_hi:[1,1,0] neg_lo:[0,0,1] neg_hi:[0,0,1]
  v_pk_fma_f32 v[172:173], v[172:173], v[90:91], v[90:91] op_sel:[0,1,0] op_sel_hi:[1,1,0] neg_lo:[0,0,1] neg_hi:[0,0,1]
  v_pk_fma_f32 v[174:175], v[174:175], v[90:91], v[90:91] op_sel:[0,1,0] op_sel_hi:[1,1,0] neg_lo:[0,0,1] neg_hi:[0,0,1]
  v_pk_fma_f32 v[176:177], v[176:177], v[92:93], v[92:93] op_sel:[0,1,0] op_sel_hi:[1,1,0] neg_lo:[0,0,1] neg_hi:[0,0,1]
  v_pk_fma_f32 v[178:179], v[178:179], v[92:93], v[92:93] op_sel:[0,1,0] op_sel_hi:[1,1,0] neg_lo:[0,0,1] neg_hi:[0,0,1]
  v_pk_fma_f32 v[180:181], v[180:181], v[92:93], v[92:93] op_sel:[0,1,0] op_sel_hi:[1,1,0] neg_lo:[0,0,1] neg_hi:[0,0,1]
  v_pk_fma_f32 v[182:183], v[182:183], v[92:93], v[92:93] op_sel:[0,1,0] op_sel_hi:[1,1,0] neg_lo:[0,0,1] neg_hi:[0,0,1]
  v_pk_fma_f32 v[184:185], v[184:185], v[94:95], v[94:95] op_sel:[0,1,0] op_sel_hi:[1,1,0] neg_lo:[0,0,1] neg_hi:[0,0,1]
  v_pk_fma_f32 v[186:187], v[186:187], v[94:95], v[94:95] op_sel:[0,1,0] op_sel_hi:[1,1,0] neg_lo:[0,0,1] neg_hi:[0,0,1]
  v_pk_fma_f32 v[188:189], v[188:189], v[94:95], v[94:95] op_sel:[0,1,0] op_sel_hi:[1,1,0] neg_lo:[0,0,1] neg_hi:[0,0,1]
  v_pk_fma_f32 v[190:191], v[190:191], v[94:95], v[94:95] op_sel:[0,1,0] op_sel_hi:[1,1,0] neg_lo:[0,0,1] neg_hi:[0,0,1]
  s_lshl_b32 s6, s84, Lz1-Lz0+3
  s_add_u32 s6, s6, 3145728
  s_add_u32 s7, s6, 4096
  s_mov_b32 exec_lo, s12
  s_mov_b32 exec_hi, s12
  buffer_load_dwordx4 v[64:67], v9, s[40:43], s11 offen sc0 sc1
  s_mov_b32 exec_lo, 0
  s_mov_b32 exec_hi, -1
  buffer_load_dwordx4 v[232:235], v11, s[40:43], s11 offen sc0 sc1
  s_mov_b64 exec, -1
  v_exp_f32 v168, v168
  v_exp_f32 v169, v169
  v_exp_f32 v170, v170
  v_exp_f32 v171, v171
  v_exp_f32 v172, v172
  v_exp_f32 v173, v173
  v_exp_f32 v174, v174
  v_exp_f32_e64 v175, v175
  v_cvt_pk_bf16_f32 v36, v168, v169
  v_cvt_pk_bf16_f32 v37, v170, v171
  v_cvt_pk_bf16_f32 v38, v172, v173
  v_cvt_pk_bf16_f32 v39, v174, v175
  v_exp_f32 v176, v176
  v_exp_f32 v177, v177
  v_exp_f32 v178, v178
  v_exp_f32 v179, v179
  v_exp_f32 v180, v180
  v_exp_f32 v181, v181
  v_exp_f32 v182, v182
  v_exp_f32 v183, v183
  v_cvt_pk_bf16_f32 v40, v176, v177
  v_cvt_pk_bf16_f32 v41, v178, v179
  v_cvt_pk_bf16_f32 v42, v180, v181
  v_cvt_pk_bf16_f32 v43, v182, v183
  v_mfma_f32_16x16x32_bf16 v[132:135], v[120:123], v[36:39], 0
  v_mfma_f32_16x16x32_bf16 v[200:203], v[70:73], v[36:39], 0
  v_mfma_f32_16x16x32_bf16 v[204:207], v[80:83], v[36:39], 0
  v_exp_f32 v184, v184
  v_exp_f32 v185, v185
  v_exp_f32 v186, v186
  v_exp_f32 v187, v187
  v_exp_f32 v188, v188
  v_exp_f32 v189, v189
  v_exp_f32 v190, v190
  v_exp_f32 v191, v191
  v_cvt_pk_bf16_f32 v44, v184, v185
  v_cvt_pk_bf16_f32 v45, v186, v187
  v_cvt_pk_bf16_f32 v46, v188, v189
  v_cvt_pk_bf16_f32 v47, v190, v191
  v_mfma_f32_16x16x32_bf16 v[136:139], v[120:123], v[40:43], 0
  v_mfma_f32_16x16x32_bf16 v[208:211], v[72:75], v[40:43], 0
  v_mfma_f32_16x16x32_bf16 v[212:215], v[82:85], v[40:43], 0
  v_mfma_f32_16x16x32_bf16 v[140:143], v[120:123], v[44:47], 0
  v_mfma_f32_16x16x32_bf16 v[216:219], v[74:77], v[44:47], 0
  v_mfma_f32_16x16x32_bf16 v[220:223], v[84:87], v[44:47], 0
  v_rcp_f32 v132, v132
  s_nop 0
  v_pk_mul_f32 v[200:201], v[200:201], v[132:133] op_sel_hi:[1,0]
  v_pk_mul_f32 v[202:203], v[202:203], v[132:133] op_sel_hi:[1,0]
  v_pk_mul_f32 v[204:205], v[204:205], v[132:133] op_sel_hi:[1,0]
  v_pk_mul_f32 v[206:207], v[206:207], v[132:133] op_sel_hi:[1,0]
  v_cvt_pk_bf16_f32 v52, v200, v201
  v_cvt_pk_bf16_f32 v53, v202, v203
  v_cvt_pk_bf16_f32 v54, v204, v205
  v_cvt_pk_bf16_f32 v55, v206, v207
  buffer_store_dwordx4 v[52:55], v0, s[40:43], s6 offen offset:2048 sc0 sc1
  ds_write_b128 v0, v[52:55] offset:2048
  v_rcp_f32 v136, v136
  s_nop 0
  v_pk_mul_f32 v[208:209], v[208:209], v[136:137] op_sel_hi:[1,0]
  v_pk_mul_f32 v[210:211], v[210:211], v[136:137] op_sel_hi:[1,0]
  v_pk_mul_f32 v[212:213], v[212:213], v[136:137] op_sel_hi:[1,0]
  v_pk_mul_f32 v[214:215], v[214:215], v[136:137] op_sel_hi:[1,0]
  v_cvt_pk_bf16_f32 v56, v208, v209
  v_cvt_pk_bf16_f32 v57, v210, v211
  v_cvt_pk_bf16_f32 v58, v212, v213
  v_cvt_pk_bf16_f32 v59, v214, v215
  buffer_store_dwordx4 v[56:59], v0, s[40:43], s7 offen offset:0 sc0 sc1
  ds_write_b128 v0, v[56:59] offset:4096
  v_rcp_f32 v140, v140
  s_nop 0
  v_pk_mul_f32 v[216:217], v[216:217], v[140:141] op_sel_hi:[1,0]
  v_pk_mul_f32 v[218:219], v[218:219], v[140:141] op_sel_hi:[1,0]
  v_pk_mul_f32 v[220:221], v[220:221], v[140:141] op_sel_hi:[1,0]
  v_pk_mul_f32 v[222:223], v[222:223], v[140:141] op_sel_hi:[1,0]
  v_cvt_pk_bf16_f32 v60, v216, v217
  v_cvt_pk_bf16_f32 v61, v218, v219
  v_cvt_pk_bf16_f32 v62, v220, v221
  v_cvt_pk_bf16_f32 v63, v222, v223
  buffer_store_dwordx4 v[60:63], v0, s[40:43], s7 offen offset:2048 sc0 sc1
  ds_write_b128 v0, v[60:63] offset:6144
  s_cmp_eq_u32 s76, Lz1-Lz0+0
  s_mov_b32 s89, 200000
  s_waitcnt vmcnt(3)
  s_cbranch_scc0 Lh_12
  v_mov_b64 v[64:65], 0
  v_mov_b64 v[66:67], 0
  v_mov_b64 v[232:233], 0
  v_mov_b64 v[234:235], 0
  s_branch Lh_13
  s_nop 0
Lh_11:
  s_mov_b32 exec_lo, s12
  s_mov_b32 exec_hi, s12
  buffer_load_dwordx4 v[64:67], v9, s[40:43], s11 offen sc0 sc1
  s_mov_b32 exec_lo, 0
  s_mov_b32 exec_hi, -1
  buffer_load_dwordx4 v[232:235], v11, s[40:43], s11 offen sc0 sc1
  s_mov_b64 exec, -1
  s_waitcnt vmcnt(0)
Lh_12:
  v_max3_u32 v2, v64, v65, v66
  v_max3_u32 v3, v232, v233, v234
  v_max3_u32 v2, v2, v67, v235
  v_max_u32_e64 v2, v2, v3
  v_cmp_eq_u32 vcc, -1, v2
  s_cbranch_vccz Lh_13
  s_sub_u32 s89, s89, 1
  s_cbranch_scc0 Lh_11
Lh_13:
  v_mfma_f32_16x16x32_bf16 v[160:163], v[64:67], v[32:35], v[20:23]
  v_mov_b64 v[68:69], v[232:233]
  v_mov_b64 v[78:79], v[234:235]
  v_mov_b64 v[236:237], -1
  v_mov_b64 v[238:239], -1
  buffer_store_dwordx4 v[236:239], v11, s[40:43], s11 offen sc0 sc1
  v_max3_f32 v88, v164, v165, v166
  s_nop 0
  s_nop 1
  v_max3_f32 v98, v167, v160, v161
  v_max3_f32 v88, v88, v162, v163
  v_max_f32 v88, v88, v98
  v_mov_b32 v98, v88
  s_nop 1
  v_permlane32_swap_b32 v88, v98
  v_max_f32 v88, v88, v98
  v_mov_b32 v98, v88
  s_nop 1
  v_permlane16_swap_b32 v88, v98
  v_max_f32_e64 v88, v88, v98
  s_mov_b32 s4, 0x3e8293ee
  v_mul_f32 v88, s4, v88
  v_mov_b32 v89, s4
  v_pk_fma_f32 v[160:161], v[160:161], v[88:89], v[88:89] op_sel:[0,1,0] op_sel_hi:[1,1,0] neg_lo:[0,0,1] neg_hi:[0,0,1]
  v_pk_fma_f32 v[162:163], v[162:163], v[88:89], v[88:89] op_sel:[0,1,0] op_sel_hi:[1,1,0] neg_lo:[0,0,1] neg_hi:[0,0,1]
  v_pk_fma_f32 v[164:165], v[164:165], v[88:89], v[88:89] op_sel:[0,1,0] op_sel_hi:[1,1,0] neg_lo:[0,0,1] neg_hi:[0,0,1]
  v_pk_fma_f32 v[166:167], v[166:167], v[88:89], v[88:89] op_sel:[0,1,0] op_sel_hi:[1,1,0] neg_lo:[0,0,1] neg_hi:[0,0,1]
  v_exp_f32 v160, v160
  v_exp_f32 v161, v161
  v_exp_f32 v162, v162
  v_exp_f32 v163, v163
  v_exp_f32 v164, v164
  v_exp_f32 v165, v165
  v_exp_f32 v166, v166
  v_exp_f32 v167, v167
  v_cvt_pk_bf16_f32 v32, v160, v161
  v_cvt_pk_bf16_f32 v33, v162, v163
  v_cvt_pk_bf16_f32 v34, v164, v165
  v_cvt_pk_bf16_f32 v35, v166, v167
  s_nop 0
  s_nop 1
  v_mfma_f32_16x16x32_bf16 v[128:131], v[120:123], v[32:35], 0
  v_mfma_f32_16x16x32_bf16 v[192:195], v[68:71], v[32:35], 0
  v_mfma_f32_16x16x32_bf16 v[196:199], v[78:81], v[32:35], 0
  s_nop 5
  v_rcp_f32_e64 v128, v128
  s_nop 0
  v_pk_mul_f32 v[192:193], v[192:193], v[128:129] op_sel_hi:[1,0]
  v_pk_mul_f32 v[194:195], v[194:195], v[128:129] op_sel_hi:[1,0]
  v_pk_mul_f32 v[196:197], v[196:197], v[128:129] op_sel_hi:[1,0]
  v_pk_mul_f32 v[198:199], v[198:199], v[128:129] op_sel_hi:[1,0]
  v_cvt_pk_bf16_f32 v48, v192, v193
  v_cvt_pk_bf16_f32 v49, v194, v195
  v_cvt_pk_bf16_f32 v50, v196, v197
  v_cvt_pk_bf16_f32 v51, v198, v199
  buffer_store_dwordx4 v[48:51], v0, s[40:43], s6 offen offset:0 sc0 sc1
  ds_write_b128 v0, v[48:51] offset:0
  ds_read_b32 v3, v28 offset:8
  s_cmp_lg_u32 s82, 0
  s_cbranch_scc1 L_15
  v_permlane16_swap_b32 v240, v242
  v_permlane16_swap_b32 v241, v243
  v_permlane16_swap_b32 v244, v246
  v_permlane16_swap_b32 v245, v247
  v_permlane16_swap_b32 v248, v250
  v_permlane16_swap_b32 v249, v251
  v_permlane16_swap_b32 v252, v254
  v_permlane16_swap_b32 v253, v255
L_15:
  s_mov_b32 s16, Lz1-Lz0+0
  s_mov_b32 s17, 16384
  s_mov_b32 s18, 0xffff4000
  s_mov_b32 s19, 32768
  s_mov_b32 s20, 8192
  s_mov_b32 s21, 0xfffee000
  s_mul_i32 s4, s85, 8192
  v_add_u32_e64 v4, s4, v11
  v_add_u32 v5, 1024, v4
  s_add_u32 s5, s19, 0
  s_lshl_b32 s4, s86, 1
  v_xor_b32_e64 v2, s4, v26
  v_lshl_add_u32 v6, v2, 5, v25
  v_add_u32 v6, s5, v6
  s_add_u32 s4, s4, 1
  v_xor_b32_e64 v2, s4, v26
  v_lshl_add_u32 v7, v2, 5, v25
  v_add_u32 v7, s5, v7
  s_lshl_b32 s5, s82, 1
  s_add_u32 s5, s5, Lz1-Lz0+2
  s_mov_b32 s89, 1600000
  s_branch Lw_17
Lw_16:
  ds_read_b32 v3, v28 offset:8
Lw_17:
  s_waitcnt lgkmcnt(0)
  v_readfirstlane_b32 s4, v3
  s_cmp_ge_u32 s4, s5
  s_cbranch_scc1 Lw_18
  s_sleep 1
  s_sub_u32 s89, s89, 1
  s_cbranch_scc0 Lw_16
Lw_18:
  ds_read_b64_tr_b16 v[48:49], v6 offset:0
  ds_read_b64_tr_b16 v[50:51], v6 offset:2048
  ds_read_b64_tr_b16 v[52:53], v7 offset:0
  ds_read_b64_tr_b16 v[54:55], v7 offset:2048
  ds_read_b64_tr_b16 v[80:81], v6 offset:4096
  ds_read_b64_tr_b16 v[82:83], v6 offset:6144
  ds_read_b64_tr_b16 v[84:85], v7 offset:4096
  ds_read_b64_tr_b16 v[86:87], v7 offset:6144
  ds_read_b64_tr_b16 v[112:113], v6 offset:8192
  ds_read_b64_tr_b16 v[114:115], v6 offset:10240
  ds_read_b64_tr_b16 v[116:117], v7 offset:8192
  ds_read_b64_tr_b16 v[118:119], v7 offset:10240
  s_nop 0
  s_waitcnt lgkmcnt(8)
  ds_read_b64_tr_b16 v[208:209], v6 offset:12288
  ds_read_b64_tr_b16 v[210:211], v6 offset:14336
  ds_read_b64_tr_b16 v[212:213], v7 offset:12288
  ds_read_b64_tr_b16 v[214:215], v7 offset:14336
  s_nop 0
  s_waitcnt lgkmcnt(8)
  ds_read_b64_tr_b16 v[160:161], v6 offset:16384
  ds_read_b64_tr_b16 v[162:163], v6 offset:18432
  ds_read_b64_tr_b16 v[164:165], v7 offset:16384
  ds_read_b64_tr_b16 v[166:167], v7 offset:18432
  s_nop 0
  s_waitcnt lgkmcnt(8)
  ds_read_b64_tr_b16 v[168:169], v6 offset:20480
  ds_read_b64_tr_b16 v[170:171], v6 offset:22528
  ds_read_b64_tr_b16 v[172:173], v7 offset:20480
  ds_read_b64_tr_b16 v[174:175], v7 offset:22528
  s_waitcnt lgkmcnt(8)
  s_add_u32 s5, s87, 0x0
  s_waitcnt vmcnt(0)
  s_mov_b64 exec, 1
  ds_add_rtn_u32 v2, v28, v27 offset:0
  s_waitcnt lgkmcnt(0)
  v_readfirstlane_b32 s4, v2
  s_and_b32 s4, s4, Lz1-Lz0+3
  s_cmp_lg_u32 s4, 3
  s_cbranch_scc1 Ls_19
  s_mov_b32 exec_lo, 0xffff
  buffer_store_dword v27, v24, s[40:43], s5 offen sc0 sc1
Ls_19:
  s_nop 0
  s_mov_b64 exec, -1
  ds_read_b64_tr_b16 v[176:177], v6 offset:24576
  ds_read_b64_tr_b16 v[178:179], v6 offset:26624
  ds_read_b64_tr_b16 v[180:181], v7 offset:24576
  ds_read_b64_tr_b16 v[182:183], v7 offset:26624
  ds_read_b64_tr_b16 v[184:185], v6 offset:28672
  ds_read_b64_tr_b16 v[186:187], v6 offset:30720
  ds_read_b64_tr_b16 v[188:189], v7 offset:28672
  ds_read_b64_tr_b16 v[190:191], v7 offset:30720
  ds_read_b64_tr_b16 v[224:225], v6 offset:32768
  ds_read_b64_tr_b16 v[226:227], v6 offset:34816
  ds_read_b64_tr_b16 v[228:229], v7 offset:32768
  ds_read_b64_tr_b16 v[230:231], v7 offset:34816
  s_nop 0
  s_waitcnt lgkmcnt(8)
  ds_read_b64_tr_b16 v[232:233], v6 offset:36864
  ds_read_b64_tr_b16 v[234:235], v6 offset:38912
  ds_read_b64_tr_b16 v[236:237], v7 offset:36864
  ds_read_b64_tr_b16 v[238:239], v7 offset:38912
  s_nop 0
  s_waitcnt lgkmcnt(8)
  ds_read_b64_tr_b16 v[56:57], v6 offset:40960
  ds_read_b64_tr_b16 v[58:59], v6 offset:43008
  ds_read_b64_tr_b16 v[60:61], v7 offset:40960
  ds_read_b64_tr_b16 v[62:63], v7 offset:43008
  s_nop 0
  s_waitcnt lgkmcnt(8)
  ds_read_b64_tr_b16 v[88:89], v6 offset:45056
  ds_read_b64_tr_b16 v[90:91], v6 offset:47104
  ds_read_b64_tr_b16 v[92:93], v7 offset:45056
  ds_read_b64_tr_b16 v[94:95], v7 offset:47104
  s_waitcnt lgkmcnt(8)
  s_mov_b32 s19, 0
  v_add_u32 v6, 0xffff8000, v6
  v_add_u32 v7, 0xffff8000, v7
  s_waitcnt lgkmcnt(0)
  s_mov_b64 exec, 1
  ds_add_u32 v28, v27 offset:12
  s_mov_b64 exec, -1
  s_mov_b32 s4, 0xffff0000
  v_lshlrev_b32 v128, 16, v240
  v_and_b32 v129, s4, v240
  v_lshlrev_b32 v130, 16, v241
  v_and_b32 v131, s4, v241
  v_lshlrev_b32 v132, 16, v242
  v_and_b32 v133, s4, v242
  v_lshlrev_b32 v134, 16, v243
  v_and_b32 v135, s4, v243
  v_lshlrev_b32 v136, 16, v244
  v_and_b32 v137, s4, v244
  v_lshlrev_b32 v138, 16, v245
  v_and_b32 v139, s4, v245
  v_lshlrev_b32 v140, 16, v246
  v_and_b32 v141, s4, v246
  v_lshlrev_b32 v142, 16, v247
  v_and_b32 v143, s4, v247
  v_lshlrev_b32 v144, 16, v248
  v_and_b32 v145, s4, v248
  v_lshlrev_b32 v146, 16, v249
  v_and_b32 v147, s4, v249
  v_lshlrev_b32 v148, 16, v250
  v_and_b32 v149, s4, v250
  v_lshlrev_b32 v150, 16, v251
  v_and_b32 v151, s4, v251
  v_lshlrev_b32 v152, 16, v252
  v_and_b32 v153, s4, v252
  v_lshlrev_b32 v154, 16, v253
  v_and_b32 v155, s4, v253
  v_lshlrev_b32 v156, 16, v254
  v_and_b32 v157, s4, v254
  v_lshlrev_b32 v158, 16, v255
  v_and_b32 v159, s4, v255
  s_lshl_b32 s4, s76, 4
  s_add_u32 s4, s4, s78
  s_lshl_b32 s6, s4, 14
  s_add_u32 s6, s6, 7340032
  s_add_u32 s7, s6, 4096
  s_mov_b32 s22, 5
  s_barrier
  ds_read_b128 v[32:35], v4 offset:0
  ds_read_b128 v[36:39], v4 offset:2048
  ds_read_b128 v[40:43], v4 offset:4096
  ds_read_b128 v[44:47], v4 offset:6144
  ds_read_b128 v[64:67], v5 offset:0
  ds_read_b128 v[68:71], v5 offset:2048
  ds_read_b128 v[72:75], v5 offset:4096
  ds_read_b128 v[76:79], v5 offset:6144
  s_add_u32 s16, s16, s17
  s_cmp_eq_u32 s16, 65536
  s_cselect_b32 s23, s18, s17
  s_cselect_b32 s16, 0, s16
  v_add_u32 v4, s23, v4
  v_add_u32 v5, s23, v5
  s_waitcnt lgkmcnt(0)
  v_mfma_f32_16x16x32_bf16 v[128:131], v[48:51], v[32:35], v[128:131]
  v_mfma_f32_16x16x32_bf16 v[128:131], v[80:83], v[64:67], v[128:131]
  v_mfma_f32_16x16x32_bf16 v[136:139], v[80:83], v[68:71], v[136:139]
  v_mfma_f32_16x16x32_bf16 v[136:139], v[48:51], v[36:39], v[136:139]
  v_mfma_f32_16x16x32_bf16 v[144:147], v[48:51], v[40:43], v[144:147]
  v_mfma_f32_16x16x32_bf16 v[144:147], v[80:83], v[72:75], v[144:147]
  v_mfma_f32_16x16x32_bf16 v[152:155], v[80:83], v[76:79], v[152:155]
  v_mfma_f32_16x16x32_bf16 v[152:155], v[48:51], v[44:47], v[152:155]
  v_mfma_f32_16x16x32_bf16 v[156:159], v[52:55], v[44:47], v[156:159]
  v_mfma_f32_16x16x32_bf16 v[156:159], v[84:87], v[76:79], v[156:159]
  v_mfma_f32_16x16x32_bf16 v[148:151], v[84:87], v[72:75], v[148:151]
  v_mfma_f32_16x16x32_bf16 v[148:151], v[52:55], v[40:43], v[148:151]
  v_mfma_f32_16x16x32_bf16 v[140:143], v[52:55], v[36:39], v[140:143]
  v_mfma_f32_16x16x32_bf16 v[140:143], v[84:87], v[68:71], v[140:143]
  v_mfma_f32_16x16x32_bf16 v[132:135], v[84:87], v[64:67], v[132:135]
  v_mfma_f32_16x16x32_bf16 v[132:135], v[52:55], v[32:35], v[132:135]
  s_nop 0
  s_barrier
  ds_read_b128 v[96:99], v4 offset:0
  ds_read_b128 v[192:195], v5 offset:0
  ds_read_b128 v[100:103], v4 offset:2048
  ds_read_b128 v[196:199], v5 offset:2048
  ds_read_b128 v[104:107], v4 offset:4096
  ds_read_b128 v[200:203], v5 offset:4096
  ds_read_b128 v[108:111], v4 offset:6144
  ds_read_b128 v[204:207], v5 offset:6144
  s_add_u32 s16, s16, s17
  s_cmp_eq_u32 s16, 65536
  s_cselect_b32 s23, s18, s17
  s_cselect_b32 s16, 0, s16
  v_add_u32 v4, s23, v4
  v_add_u32 v5, s23, v5
  s_waitcnt lgkmcnt(6)
  v_mfma_f32_16x16x32_bf16 v[128:131], v[112:115], v[96:99], v[128:131]
  v_mfma_f32_16x16x32_bf16 v[128:131], v[208:211], v[192:195], v[128:131]
  s_waitcnt lgkmcnt(4)
  v_mfma_f32_16x16x32_bf16 v[136:139], v[208:211], v[196:199], v[136:139]
  v_mfma_f32_16x16x32_bf16 v[136:139], v[112:115], v[100:103], v[136:139]
  s_waitcnt lgkmcnt(2)
  v_mfma_f32_16x16x32_bf16 v[144:147], v[112:115], v[104:107], v[144:147]
  v_mfma_f32_16x16x32_bf16 v[144:147], v[208:211], v[200:203], v[144:147]
  s_waitcnt lgkmcnt(0)
  v_mfma_f32_16x16x32_bf16 v[152:155], v[208:211], v[204:207], v[152:155]
  s_barrier
  v_mfma_f32_16x16x32_bf16 v[152:155], v[112:115], v[108:111], v[152:155]
  ds_read_b128 v[32:35], v4 offset:0
  ds_read_b128 v[36:39], v4 offset:2048
  v_mfma_f32_16x16x32_bf16 v[156:159], v[116:119], v[108:111], v[156:159]
  ds_read_b128 v[40:43], v4 offset:4096
  ds_read_b128 v[44:47], v4 offset:6144
  v_mfma_f32_16x16x32_bf16 v[156:159], v[212:215], v[204:207], v[156:159]
  ds_read_b128 v[64:67], v5 offset:0
  ds_read_b128 v[68:71], v5 offset:2048
  v_mfma_f32_16x16x32_bf16 v[148:151], v[212:215], v[200:203], v[148:151]
  ds_read_b128 v[72:75], v5 offset:4096
  ds_read_b128 v[76:79], v5 offset:6144
  v_mfma_f32_16x16x32_bf16 v[148:151], v[116:119], v[104:107], v[148:151]
  s_add_u32 s16, s16, s17
  s_cmp_eq_u32 s16, 65536
  s_cselect_b32 s23, s18, s17
  v_mfma_f32_16x16x32_bf16 v[140:143], v[116:119], v[100:103], v[140:143]
  s_cselect_b32 s16, 0, s16
  v_add_u32 v4, s23, v4
  v_add_u32_e64 v5, s23, v5
  v_mfma_f32_16x16x32_bf16 v[140:143], v[212:215], v[196:199], v[140:143]
  v_mfma_f32_16x16x32_bf16 v[132:135], v[212:215], v[192:195], v[132:135]
  s_waitcnt lgkmcnt(0)
  v_mfma_f32_16x16x32_bf16 v[132:135], v[116:119], v[96:99], v[132:135]
  s_barrier
  v_mfma_f32_16x16x32_bf16 v[128:131], v[160:163], v[32:35], v[128:131]
  ds_read_b128 v[96:99], v4 offset:0
  ds_read_b128 v[100:103], v4 offset:2048
  v_mfma_f32_16x16x32_bf16 v[128:131], v[168:171], v[64:67], v[128:131]
  ds_read_b128 v[104:107], v4 offset:4096
  ds_read_b128 v[108:111], v4 offset:6144
  v_mfma_f32_16x16x32_bf16 v[136:139], v[168:171], v[68:71], v[136:139]
  ds_read_b128 v[192:195], v5 offset:0
  ds_read_b128 v[196:199], v5 offset:2048
  v_mfma_f32_16x16x32_bf16 v[136:139], v[160:163], v[36:39], v[136:139]
  ds_read_b128 v[200:203], v5 offset:4096
  ds_read_b128 v[204:207], v5 offset:6144
  v_mfma_f32_16x16x32_bf16 v[144:147], v[160:163], v[40:43], v[144:147]
  s_add_u32 s16, s16, s17
  s_cmp_eq_u32 s16, 65536
  s_cselect_b32 s23, s18, s17
  v_mfma_f32_16x16x32_bf16 v[144:147], v[168:171], v[72:75], v[144:147]
  s_cselect_b32 s16, 0, s16
  v_add_u32 v4, s23, v4
  v_add_u32_e64 v5, s23, v5
  v_mfma_f32_16x16x32_bf16 v[152:155], v[168:171], v[76:79], v[152:155]
  v_mfma_f32_16x16x32_bf16 v[152:155], v[160:163], v[44:47], v[152:155]
  v_mfma_f32_16x16x32_bf16 v[156:159], v[164:167], v[44:47], v[156:159]
  v_mfma_f32_16x16x32_bf16 v[156:159], v[172:175], v[76:79], v[156:159]
  v_mfma_f32_16x16x32_bf16 v[148:151], v[172:175], v[72:75], v[148:151]
  v_mfma_f32_16x16x32_bf16 v[148:151], v[164:167], v[40:43], v[148:151]
  v_mfma_f32_16x16x32_bf16 v[140:143], v[164:167], v[36:39], v[140:143]
  v_mfma_f32_16x16x32_bf16 v[140:143], v[172:175], v[68:71], v[140:143]
  v_mfma_f32_16x16x32_bf16 v[132:135], v[172:175], v[64:67], v[132:135]
  s_waitcnt lgkmcnt(0)
  v_mfma_f32_16x16x32_bf16 v[132:135], v[164:167], v[32:35], v[132:135]
  s_barrier
  v_mfma_f32_16x16x32_bf16 v[128:131], v[176:179], v[96:99], v[128:131]
  ds_read_b128 v[32:35], v4 offset:0
  ds_read_b128 v[36:39], v4 offset:2048
  v_mfma_f32_16x16x32_bf16 v[128:131], v[184:187], v[192:195], v[128:131]
  ds_read_b128 v[40:43], v4 offset:4096
  ds_read_b128 v[44:47], v4 offset:6144
  v_mfma_f32_16x16x32_bf16 v[136:139], v[184:187], v[196:199], v[136:139]
  ds_read_b128 v[64:67], v5 offset:0
  ds_read_b128 v[68:71], v5 offset:2048
  v_mfma_f32_16x16x32_bf16 v[136:139], v[176:179], v[100:103], v[136:139]
  ds_read_b128 v[72:75], v5 offset:4096
  ds_read_b128 v[76:79], v5 offset:6144
  v_mfma_f32_16x16x32_bf16 v[144:147], v[176:179], v[104:107], v[144:147]
  s_add_u32 s16, s16, s17
  s_cmp_eq_u32 s16, 65536
  s_cselect_b32 s23, s18, s17
  v_mfma_f32_16x16x32_bf16 v[144:147], v[184:187], v[200:203], v[144:147]
  s_cselect_b32 s16, 0, s16
  v_add_u32 v4, s23, v4
  v_add_u32_e64 v5, s23, v5
  v_mfma_f32_16x16x32_bf16 v[152:155], v[184:187], v[204:207], v[152:155]
  v_mfma_f32_16x16x32_bf16 v[152:155], v[176:179], v[108:111], v[152:155]
  v_mfma_f32_16x16x32_bf16 v[156:159], v[180:183], v[108:111], v[156:159]
  v_mfma_f32_16x16x32_bf16 v[156:159], v[188:191], v[204:207], v[156:159]
  v_mfma_f32_16x16x32_bf16 v[148:151], v[188:191], v[200:203], v[148:151]
  v_mfma_f32_16x16x32_bf16 v[148:151], v[180:183], v[104:107], v[148:151]
  v_mfma_f32_16x16x32_bf16 v[140:143], v[180:183], v[100:103], v[140:143]
  v_mfma_f32_16x16x32_bf16 v[140:143], v[188:191], v[196:199], v[140:143]
  v_mfma_f32_16x16x32_bf16 v[132:135], v[188:191], v[192:195], v[132:135]
  s_waitcnt lgkmcnt(0)
  v_mfma_f32_16x16x32_bf16 v[132:135], v[180:183], v[96:99], v[132:135]
  s_barrier
  v_mfma_f32_16x16x32_bf16 v[128:131], v[224:227], v[32:35], v[128:131]
  ds_read_b128 v[96:99], v4 offset:0
  ds_read_b128 v[100:103], v4 offset:2048
  v_mfma_f32_16x16x32_bf16 v[128:131], v[232:235], v[64:67], v[128:131]
  ds_read_b128 v[104:107], v4 offset:4096
  ds_read_b128 v[108:111], v4 offset:6144
  v_mfma_f32_16x16x32_bf16 v[136:139], v[232:235], v[68:71], v[136:139]
  ds_read_b128 v[192:195], v5 offset:0
  ds_read_b128 v[196:199], v5 offset:2048
  v_mfma_f32_16x16x32_bf16 v[136:139], v[224:227], v[36:39], v[136:139]
  ds_read_b128 v[200:203], v5 offset:4096
  ds_read_b128 v[204:207], v5 offset:6144
  v_mfma_f32_16x16x32_bf16 v[144:147], v[224:227], v[40:43], v[144:147]
  s_add_u32 s16, s16, s17
  s_cmp_eq_u32 s16, 65536
  s_cselect_b32 s23, s18, s17
  v_mfma_f32_16x16x32_bf16 v[144:147], v[232:235], v[72:75], v[144:147]
  s_cselect_b32 s16, 0, s16
  v_add_u32 v4, s23, v4
  v_add_u32_e64 v5, s23, v5
  v_mfma_f32_16x16x32_bf16 v[152:155], v[232:235], v[76:79], v[152:155]
  v_mfma_f32_16x16x32_bf16 v[152:155], v[224:227], v[44:47], v[152:155]
  v_mfma_f32_16x16x32_bf16 v[156:159], v[228:231], v[44:47], v[156:159]
  v_mfma_f32_16x16x32_bf16 v[156:159], v[236:239], v[76:79], v[156:159]
  v_mfma_f32_16x16x32_bf16 v[148:151], v[236:239], v[72:75], v[148:151]
  v_mfma_f32_16x16x32_bf16 v[148:151], v[228:231], v[40:43], v[148:151]
  v_mfma_f32_16x16x32_bf16 v[140:143], v[228:231], v[36:39], v[140:143]
  v_mfma_f32_16x16x32_bf16 v[140:143], v[236:239], v[68:71], v[140:143]
  v_mfma_f32_16x16x32_bf16 v[132:135], v[236:239], v[64:67], v[132:135]
  s_waitcnt lgkmcnt(0)
  v_mfma_f32_16x16x32_bf16 v[132:135], v[228:231], v[32:35], v[132:135]
  s_barrier
  v_mfma_f32_16x16x32_bf16 v[128:131], v[56:59], v[96:99], v[128:131]
  ds_read_b64_tr_b16 v[48:49], v6 offset:0
  ds_read_b64_tr_b16 v[50:51], v6 offset:2048
  v_mfma_f32_16x16x32_bf16 v[128:131], v[88:91], v[192:195], v[128:131]
  ds_read_b128 v[32:35], v4 offset:0
  ds_read_b128 v[36:39], v4 offset:2048
  v_mfma_f32_16x16x32_bf16 v[136:139], v[88:91], v[196:199], v[136:139]
  ds_read_b128 v[40:43], v4 offset:4096
  ds_read_b128 v[44:47], v4 offset:6144
  v_mfma_f32_16x16x32_bf16 v[136:139], v[56:59], v[100:103], v[136:139]
  ds_read_b64_tr_b16 v[52:53], v7 offset:0
  ds_read_b64_tr_b16 v[54:55], v7 offset:2048
  v_mfma_f32_16x16x32_bf16 v[144:147], v[56:59], v[104:107], v[144:147]
  ds_read_b64_tr_b16 v[80:81], v6 offset:4096
  ds_read_b64_tr_b16 v[82:83], v6 offset:6144
  v_mfma_f32_16x16x32_bf16 v[144:147], v[88:91], v[200:203], v[144:147]
  ds_read_b128 v[64:67], v5 offset:0
  ds_read_b128 v[68:71], v5 offset:2048
  v_mfma_f32_16x16x32_bf16 v[152:155], v[88:91], v[204:207], v[152:155]
  ds_read_b128 v[72:75], v5 offset:4096
  ds_read_b128 v[76:79], v5 offset:6144
  v_mfma_f32_16x16x32_bf16 v[152:155], v[56:59], v[108:111], v[152:155]
  ds_read_b64_tr_b16 v[84:85], v7 offset:4096
  ds_read_b64_tr_b16 v[86:87], v7 offset:6144
  v_mfma_f32_16x16x32_bf16 v[156:159], v[60:63], v[108:111], v[156:159]
  s_add_u32 s16, s16, s17
  s_cmp_eq_u32 s16, 65536
  s_cselect_b32 s23, s18, s17
  v_mfma_f32_16x16x32_bf16 v[156:159], v[92:95], v[204:207], v[156:159]
  s_cselect_b32 s16, 0, s16
  v_add_u32 v4, s23, v4
  v_add_u32_e64 v5, s23, v5
  v_mfma_f32_16x16x32_bf16 v[148:151], v[92:95], v[200:203], v[148:151]
  s_add_u32 s19, s19, s20
  s_cmp_eq_u32 s19, 81920
  s_cselect_b32 s23, s21, s20
  v_mfma_f32_16x16x32_bf16 v[148:151], v[60:63], v[104:107], v[148:151]
  s_cselect_b32 s19, 0, s19
  v_add_u32 v6, s23, v6
  v_add_u32_e64 v7, s23, v7
  v_mfma_f32_16x16x32_bf16 v[140:143], v[60:63], v[100:103], v[140:143]
  v_mfma_f32_16x16x32_bf16 v[140:143], v[92:95], v[196:199], v[140:143]
  v_mfma_f32_16x16x32_bf16 v[132:135], v[92:95], v[192:195], v[132:135]
  s_waitcnt lgkmcnt(0)
  v_mfma_f32_16x16x32_bf16 v[132:135], v[60:63], v[96:99], v[132:135]
Lk_20:
  s_barrier
  v_mfma_f32_16x16x32_bf16 v[128:131], v[48:51], v[32:35], v[128:131]
  ds_read_b64_tr_b16 v[112:113], v6 offset:0
  ds_read_b64_tr_b16 v[114:115], v6 offset:2048
  v_mfma_f32_16x16x32_bf16 v[128:131], v[80:83], v[64:67], v[128:131]
  ds_read_b128 v[96:99], v4 offset:0
  ds_read_b128 v[100:103], v4 offset:2048
  v_mfma_f32_16x16x32_bf16 v[136:139], v[80:83], v[68:71], v[136:139]
  ds_read_b128 v[104:107], v4 offset:4096
  ds_read_b128 v[108:111], v4 offset:6144
  v_mfma_f32_16x16x32_bf16 v[136:139], v[48:51], v[36:39], v[136:139]
  ds_read_b64_tr_b16 v[116:117], v7 offset:0
  ds_read_b64_tr_b16 v[118:119], v7 offset:2048
  v_mfma_f32_16x16x32_bf16 v[144:147], v[48:51], v[40:43], v[144:147]
  ds_read_b64_tr_b16 v[208:209], v6 offset:4096
  ds_read_b64_tr_b16 v[210:211], v6 offset:6144
  v_mfma_f32_16x16x32_bf16 v[144:147], v[80:83], v[72:75], v[144:147]
  ds_read_b128 v[192:195], v5 offset:0
  ds_read_b128 v[196:199], v5 offset:2048
  v_mfma_f32_16x16x32_bf16 v[152:155], v[80:83], v[76:79], v[152:155]
  ds_read_b128 v[200:203], v5 offset:4096
  ds_read_b128 v[204:207], v5 offset:6144
  v_mfma_f32_16x16x32_bf16 v[152:155], v[48:51], v[44:47], v[152:155]
  ds_read_b64_tr_b16 v[212:213], v7 offset:4096
  ds_read_b64_tr_b16 v[214:215], v7 offset:6144
  v_mfma_f32_16x16x32_bf16 v[156:159], v[52:55], v[44:47], v[156:159]
  s_add_u32 s16, s16, s17
  s_cmp_eq_u32 s16, 65536
  s_cselect_b32 s23, s18, s17
  v_mfma_f32_16x16x32_bf16 v[156:159], v[84:87], v[76:79], v[156:159]
  s_cselect_b32 s16, 0, s16
  v_add_u32 v4, s23, v4
  v_add_u32_e64 v5, s23, v5
  v_mfma_f32_16x16x32_bf16 v[148:151], v[84:87], v[72:75], v[148:151]
  s_add_u32 s19, s19, s20
  s_cmp_eq_u32 s19, 81920
  s_cselect_b32 s23, s21, s20
  v_mfma_f32_16x16x32_bf16 v[148:151], v[52:55], v[40:43], v[148:151]
  s_cselect_b32 s19, 0, s19
  v_add_u32 v6, s23, v6
  v_add_u32_e64 v7, s23, v7
  v_mfma_f32_16x16x32_bf16 v[140:143], v[52:55], v[36:39], v[140:143]
  v_mfma_f32_16x16x32_bf16 v[140:143], v[84:87], v[68:71], v[140:143]
  v_mfma_f32_16x16x32_bf16 v[132:135], v[84:87], v[64:67], v[132:135]
  s_waitcnt lgkmcnt(0)
  v_mfma_f32_16x16x32_bf16 v[132:135], v[52:55], v[32:35], v[132:135]
  s_barrier
  v_mfma_f32_16x16x32_bf16 v[128:131], v[112:115], v[96:99], v[128:131]
  ds_read_b64_tr_b16 v[48:49], v6 offset:0
  ds_read_b64_tr_b16 v[50:51], v6 offset:2048
  v_mfma_f32_16x16x32_bf16 v[128:131], v[208:211], v[192:195], v[128:131]
  ds_read_b128 v[32:35], v4 offset:0
  ds_read_b128 v[36:39], v4 offset:2048
  v_mfma_f32_16x16x32_bf16 v[136:139], v[208:211], v[196:199], v[136:139]
  ds_read_b128 v[40:43], v4 offset:4096
  ds_read_b128 v[44:47], v4 offset:6144
  v_mfma_f32_16x16x32_bf16 v[136:139], v[112:115], v[100:103], v[136:139]
  ds_read_b64_tr_b16 v[52:53], v7 offset:0
  ds_read_b64_tr_b16 v[54:55], v7 offset:2048
  v_mfma_f32_16x16x32_bf16 v[144:147], v[112:115], v[104:107], v[144:147]
  ds_read_b64_tr_b16 v[80:81], v6 offset:4096
  ds_read_b64_tr_b16 v[82:83], v6 offset:6144
  v_mfma_f32_16x16x32_bf16 v[144:147], v[208:211], v[200:203], v[144:147]
  ds_read_b128 v[64:67], v5 offset:0
  ds_read_b128 v[68:71], v5 offset:2048
  v_mfma_f32_16x16x32_bf16 v[152:155], v[208:211], v[204:207], v[152:155]
  ds_read_b128 v[72:75], v5 offset:4096
  ds_read_b128 v[76:79], v5 offset:6144
  v_mfma_f32_16x16x32_bf16 v[152:155], v[112:115], v[108:111], v[152:155]
  ds_read_b64_tr_b16 v[84:85], v7 offset:4096
  ds_read_b64_tr_b16 v[86:87], v7 offset:6144
  v_mfma_f32_16x16x32_bf16 v[156:159], v[116:119], v[108:111], v[156:159]
  s_add_u32 s16, s16, s17
  s_cmp_eq_u32 s16, 65536
  s_cselect_b32 s23, s18, s17
  v_mfma_f32_16x16x32_bf16 v[156:159], v[212:215], v[204:207], v[156:159]
  s_cselect_b32 s16, 0, s16
  v_add_u32 v4, s23, v4
  v_add_u32_e64 v5, s23, v5
  v_mfma_f32_16x16x32_bf16 v[148:151], v[212:215], v[200:203], v[148:151]
  s_add_u32 s19, s19, s20
  s_cmp_eq_u32 s19, 81920
  s_cselect_b32 s23, s21, s20
  v_mfma_f32_16x16x32_bf16 v[148:151], v[116:119], v[104:107], v[148:151]
  s_cselect_b32 s19, 0, s19
  v_add_u32 v6, s23, v6
  v_add_u32_e64 v7, s23, v7
  v_mfma_f32_16x16x32_bf16 v[140:143], v[116:119], v[100:103], v[140:143]
  s_sub_u32 s22, s22, 1
  s_cmp_lg_u32 s22, 0
  v_mfma_f32_16x16x32_bf16 v[140:143], v[212:215], v[196:199], v[140:143]
  v_mfma_f32_16x16x32_bf16 v[132:135], v[212:215], v[192:195], v[132:135]
  s_nop 0
  s_waitcnt lgkmcnt(0)
  v_mfma_f32_16x16x32_bf16 v[132:135], v[116:119], v[96:99], v[132:135]
  s_cbranch_scc1 Lk_20
  s_waitcnt lgkmcnt(0)
  v_cvt_pk_bf16_f32 v252, v152, v153
  v_cvt_pk_bf16_f32 v253, v154, v155
  v_cvt_pk_bf16_f32 v254, v156, v157
  v_cvt_pk_bf16_f32 v255, v158, v159
  buffer_store_dwordx4 v[252:255], v0, s[40:43], s7 offen offset:2048 sc0 sc1
  v_cvt_pk_bf16_f32 v248, v144, v145
  v_cvt_pk_bf16_f32 v249, v146, v147
  v_cvt_pk_bf16_f32 v250, v148, v149
  v_cvt_pk_bf16_f32 v251, v150, v151
  buffer_store_dwordx4 v[248:251], v0, s[40:43], s7 offen offset:0 sc0 sc1
  v_cvt_pk_bf16_f32 v244, v136, v137
  v_cvt_pk_bf16_f32 v245, v138, v139
  v_cvt_pk_bf16_f32 v246, v140, v141
  v_cvt_pk_bf16_f32 v247, v142, v143
  buffer_store_dwordx4 v[244:247], v0, s[40:43], s6 offen offset:2048 sc0 sc1
  v_cvt_pk_bf16_f32 v240, v128, v129
  v_cvt_pk_bf16_f32 v241, v130, v131
  v_cvt_pk_bf16_f32 v242, v132, v133
  v_cvt_pk_bf16_f32 v243, v134, v135
  buffer_store_dwordx4 v[240:243], v0, s[40:43], s6 offen offset:0 sc0 sc1
  s_lshl_b32 s5, s78, Lz1-Lz0+1
  v_mov_b32 v40, 0x3f803f80
  v_dot2_f32_bf16 v32, v240, v40, 0
  v_dot2_f32_bf16 v36, v240, v240, 0
  v_dot2_f32_bf16 v33, v244, v40, 0
  v_dot2_f32_bf16 v37, v244, v244, 0
  v_dot2_f32_bf16 v34, v248, v40, 0
  v_dot2_f32_bf16 v38, v248, v248, 0
  v_dot2_f32_bf16 v35, v252, v40, 0
  v_dot2_f32_bf16 v39, v252, v252, 0
  v_dot2_f32_bf16 v32, v241, v40, v32
  v_dot2_f32_bf16 v36, v241, v241, v36
  v_dot2_f32_bf16 v33, v245, v40, v33
  v_dot2_f32_bf16 v37, v245, v245, v37
  v_dot2_f32_bf16 v34, v249, v40, v34
  v_dot2_f32_bf16 v38, v249, v249, v38
  v_dot2_f32_bf16 v35, v253, v40, v35
  v_dot2_f32_bf16 v39, v253, v253, v39
  v_dot2_f32_bf16 v32, v242, v40, v32
  v_dot2_f32_bf16 v36, v242, v242, v36
  v_dot2_f32_bf16 v33, v246, v40, v33
  v_dot2_f32_bf16 v37, v246, v246, v37
  v_dot2_f32_bf16 v34, v250, v40, v34
  v_dot2_f32_bf16 v38, v250, v250, v38
  v_dot2_f32_bf16 v35, v254, v40, v35
  v_dot2_f32_bf16 v39, v254, v254, v39
  v_dot2_f32_bf16 v32, v243, v40, v32
  v_dot2_f32_bf16 v36, v243, v243, v36
  v_dot2_f32_bf16 v33, v247, v40, v33
  v_dot2_f32_bf16 v37, v247, v247, v37
  v_dot2_f32_bf16 v34, v251, v40, v34
  v_dot2_f32_bf16 v38, v251, v251, v38
  v_dot2_f32_bf16 v35, v255, v40, v35
  v_dot2_f32_bf16 v39, v255, v255, v39
  s_lshl_b32 s6, s76, Lz1-Lz0+9
  s_lshl_b32 s7, s85, 8
  s_add_u32 s6, s6, s7
  s_add_u32 s6, s6, s5
  s_add_u32 s6, s6, s86
  s_lshl_b32 s6, s6, 6
  s_add_u32 s6, s6, s83
  s_add_u32 s6, s6, 31457280
  v_permlane32_swap_b32 v32, v34
  v_permlane32_swap_b32 v33, v35
  v_permlane32_swap_b32 v36, v38
  v_permlane32_swap_b32 v37, v39
  v_add_f32 v32, v32, v34
  v_add_f32 v33, v33, v35
  v_add_f32 v36, v36, v38
  v_add_f32 v37, v37, v39
  v_permlane16_swap_b32 v32, v33
  s_nop 0
  v_permlane16_swap_b32 v36, v37
  v_add_f32 v42, v32, v33
  v_add_f32_e64 v43, v36, v37
  buffer_store_dwordx2 v[42:43], v30, s[40:43], s6 offen sc0 sc1
  ds_write_b128 v0, v[240:243] offset:0
  ds_write_b128 v0, v[244:247] offset:2048
  ds_write_b128 v0, v[248:251] offset:4096
  ds_write_b128 v0, v[252:255] offset:6144
  s_add_u32 s5, s87, 0x4
  s_sub_u32 s4, s78, s77
  s_lshl_b32 s4, s4, 7
  s_add_u32 s5, s5, s4
  s_waitcnt vmcnt(0)
  s_mov_b64 exec, 1
  ds_add_rtn_u32 v2, v28, v27 offset:0
  s_waitcnt lgkmcnt(0)
  v_readfirstlane_b32 s4, v2
  s_and_b32 s4, s4, Lz1-Lz0+3
  s_cmp_lg_u32 s4, 3
  s_cbranch_scc1 Ls_21
  s_mov_b32 exec_lo, 0xffff
  buffer_store_dword v27, v24, s[40:43], s5 offen sc0 sc1
Ls_21:
  s_mov_b64 exec, -1
  s_mov_b32 s16, 0
  s_mov_b32 s17, 16384
  s_mov_b32 s18, 0xffff4000
  s_mov_b32 s19, Lz1-Lz0+0
  s_mov_b32 s20, 28672
  s_mov_b32 s21, 0xffff2000
  s_mul_i32 s4, s85, 8192
  v_add_u32_e64 v4, s4, v11
  v_add_u32 v5, 1024, v4
  s_mul_i32 s4, s86, 6
  s_add_u32 s4, s4, 0
  s_lshr_b32 s5, s4, 2
  s_lshl_b32 s5, s5, 13
  s_and_b32 s4, s4, 3
  v_xor_b32 v2, s4, v26
  v_lshl_add_u32 v6, v2, 5, v25
  v_add_u32 v6, s5, v6
  s_mul_i32 s4, s86, 6
  s_add_u32 s4, s4, 1
  s_lshr_b32 s5, s4, 2
  s_lshl_b32 s5, s5, 13
  s_and_b32 s4, s4, 3
  v_xor_b32_e64 v2, s4, v26
  v_lshl_add_u32 v7, v2, 5, v25
  v_add_u32 v7, s5, v7
  s_mul_i32 s4, s86, 6
  s_add_u32 s4, s4, 2
  s_lshr_b32 s5, s4, 2
  s_lshl_b32 s5, s5, 13
  s_and_b32 s4, s4, 3
  v_xor_b32_e64 v2, s4, v26
  v_lshl_add_u32 v8, v2, 5, v25
  v_add_u32 v8, s5, v8
  s_mul_i32 s4, s86, 6
  s_add_u32 s4, s4, 3
  s_lshr_b32 s5, s4, 2
  s_lshl_b32 s5, s5, 13
  s_and_b32 s4, s4, 3
  v_xor_b32_e64 v2, s4, v26
  v_lshl_add_u32 v9, v2, 5, v25
  v_add_u32 v9, s5, v9
  v_lshrrev_b32 v2, 2, v1
  v_lshlrev_b32 v3, 6, v2
  v_and_b32 v2, 3, v1
  v_lshl_add_u32 v3, v2, 3, v3
  v_bfe_u32 v2, v1, 4, 1
  v_xor_b32_e64 v2, s86, v2
  v_lshl_add_u32 v3, v2, 5, v3
  v_add_u32 v10, 90112, v3
  v_mov_b64 v[128:129], 0
  v_mov_b64 v[130:131], 0
  v_mov_b64 v[132:133], 0
  v_mov_b64 v[134:135], 0
  v_mov_b64 v[136:137], 0
  v_mov_b64 v[138:139], 0
  v_mov_b64 v[140:141], 0
  v_mov_b64 v[142:143], 0
  v_mov_b64 v[144:145], 0
  v_mov_b64 v[146:147], 0
  v_mov_b64 v[148:149], 0
  v_mov_b64 v[150:151], 0
  v_mov_b64 v[152:153], 0
  v_mov_b64 v[154:155], 0
  v_mov_b64 v[156:157], 0
  v_mov_b64 v[158:159], 0
  v_mov_b64 v[160:161], 0
  v_mov_b64 v[162:163], 0
  v_mov_b64 v[164:165], 0
  v_mov_b64 v[166:167], 0
  v_mov_b64 v[168:169], 0
  v_mov_b64 v[170:171], 0
  v_mov_b64 v[172:173], 0
  v_mov_b64 v[174:175], 0
  v_mov_b64 v[176:177], 0
  v_mov_b64 v[178:179], 0
  v_mov_b64 v[180:181], 0
  v_mov_b64 v[182:183], 0
  v_mov_b64 v[184:185], 0
  v_mov_b64 v[186:187], 0
  v_mov_b64 v[188:189], 0
  v_mov_b64 v[190:191], 0
  v_mov_b64 v[192:193], 0
  v_mov_b64 v[194:195], 0
  v_mov_b64 v[196:197], 0
  v_mov_b64 v[198:199], 0
  v_mov_b64 v[200:201], 0
  v_mov_b64 v[202:203], 0
  v_mov_b64 v[204:205], 0
  v_mov_b64 v[206:207], 0
  v_mov_b64 v[208:209], 0
  v_mov_b64 v[210:211], 0
  v_mov_b64 v[212:213], 0
  v_mov_b64 v[214:215], 0
  v_mov_b64 v[216:217], 0
  v_mov_b64 v[218:219], 0
  v_mov_b64 v[220:221], 0
  v_mov_b64 v[222:223], 0
  v_mov_b64 v[224:225], 0
  v_mov_b64 v[226:227], 0
  v_mov_b64 v[228:229], 0
  v_mov_b64 v[230:231], 0
  v_mov_b64 v[232:233], 0
  v_mov_b64 v[234:235], 0
  v_mov_b64 v[236:237], 0
  v_mov_b64 v[238:239], 0
  s_mul_i32 s5, s86, 384
  s_add_u32 s5, s5, 154112
  v_add_u32 v3, s5, v29
  s_mul_i32 s4, s76, 56
  s_mul_i32 s5, s79, 28
  s_add_u32 s4, s4, s5
  s_add_u32 s6, s4, s80
  s_lshl_b32 s6, s6, 14
  s_add_u32 s6, s6, 11599872
  s_add_u32 s7, s6, 4096
  s_lshr_b32 s5, s80, 1
  s_add_u32 s4, s4, s5
  s_lshl_b32 s4, s4, 1
  s_add_u32 s4, s4, s85
  s_lshl_b32 s4, s4, 3
  s_and_b32 s5, s80, 1
  s_add_u32 s4, s4, s5
  s_lshl_b32 s4, s4, 1
  s_add_u32 s4, s4, s86
  s_lshl_b32 s8, s4, 9
  s_add_u32 s8, s8, 11534336
  s_lshl_b32 s4, s79, Lz1-Lz0+3
  s_lshl_b32 s10, 0xff, s4
  s_mov_b32 s22, 8
  s_mov_b64 vcc, -1
  s_waitcnt lgkmcnt(0)
  s_barrier
  s_branch Lo_25
Lo_26:
  s_mov_b64 vcc, 0
  s_waitcnt lgkmcnt(0)
  s_barrier
  ds_read_b128 v[64:67], v4 offset:0
  ds_read_b128 v[80:83], v5 offset:0
  ds_read_b128 v[68:71], v4 offset:2048
  ds_read_b128 v[84:87], v5 offset:2048
  ds_read_b128 v[72:75], v4 offset:4096
  ds_read_b128 v[88:91], v5 offset:4096
  ds_read_b64_tr_b16 v[96:97], v6 offset:0
  ds_read_b64_tr_b16 v[98:99], v6 offset:2048
  ds_read_b64_tr_b16 v[100:101], v6 offset:4096
  ds_read_b64_tr_b16 v[102:103], v6 offset:6144
  ds_read_b128 v[76:79], v4 offset:6144
  ds_read_b128 v[92:95], v5 offset:6144
  ds_read_b64_tr_b16 v[104:105], v7 offset:0
  s_nop 0
  s_waitcnt lgkmcnt(8)
  ds_read_b64_tr_b16 v[106:107], v7 offset:2048
  ds_read_b64_tr_b16 v[108:109], v7 offset:4096
  ds_read_b64_tr_b16 v[110:111], v7 offset:6144
  s_waitcnt lgkmcnt(6)
  s_branch Lk_23
Lo_25:
  ds_read_b128 v[32:35], v4 offset:0
  ds_read_b128 v[48:51], v5 offset:0
  ds_read_b128 v[36:39], v4 offset:2048
  ds_read_b128 v[52:55], v5 offset:2048
  ds_read_b128 v[40:43], v4 offset:4096
  ds_read_b128 v[56:59], v5 offset:4096
  ds_read_b64_tr_b16 v[96:97], v6 offset:0
  ds_read_b64_tr_b16 v[98:99], v6 offset:2048
  ds_read_b64_tr_b16 v[100:101], v6 offset:4096
  ds_read_b64_tr_b16 v[102:103], v6 offset:6144
  ds_read_b128 v[44:47], v4 offset:6144
  ds_read_b128 v[60:63], v5 offset:6144
  ds_read_b64_tr_b16 v[104:105], v7 offset:0
  s_nop 0
  s_waitcnt lgkmcnt(8)
  ds_read_b64_tr_b16 v[106:107], v7 offset:2048
  ds_read_b64_tr_b16 v[108:109], v7 offset:4096
  ds_read_b64_tr_b16 v[110:111], v7 offset:6144
  s_nop 0
  s_waitcnt lgkmcnt(6)
  .p2align 6
Lk_22:
  v_mfma_f32_16x16x32_bf16 v[128:131], v[96:99], v[32:35], v[128:131]
  ds_read_b64_tr_b16 v[112:113], v8 offset:0
  v_mfma_f32_16x16x32_bf16 v[128:131], v[100:103], v[48:51], v[128:131]
  ds_read_b64_tr_b16 v[114:115], v8 offset:2048
  v_mfma_f32_16x16x32_bf16 v[132:135], v[100:103], v[52:55], v[132:135]
  ds_read_b64_tr_b16 v[116:117], v8 offset:4096
  v_mfma_f32_16x16x32_bf16 v[132:135], v[96:99], v[36:39], v[132:135]
  ds_read_b64_tr_b16 v[118:119], v8 offset:6144
  v_mfma_f32_16x16x32_bf16 v[136:139], v[96:99], v[40:43], v[136:139]
  s_add_u32 s16, s16, s17
  s_cmp_eq_u32 s16, 65536
  s_cselect_b32 s23, s18, s17
  s_cselect_b32 s16, Lz1-Lz0+0, s16
  v_mfma_f32_16x16x32_bf16 v[136:139], v[100:103], v[56:59], v[136:139]
  v_add_u32_e64 v4, s23, v4
  v_add_u32 v5, s23, v5
  s_add_u32 s19, s19, s20
  s_cmp_eq_u32 s19, 86016
  s_waitcnt lgkmcnt(8)
  v_mfma_f32_16x16x32_bf16 v[140:143], v[100:103], v[60:63], v[140:143]
  s_cselect_b32 s23, s21, s20
  s_cselect_b32 s19, 0, s19
  v_mfma_f32_16x16x32_bf16 v[140:143], v[96:99], v[44:47], v[140:143]
  s_waitcnt lgkmcnt(4)
  v_mfma_f32_16x16x32_bf16 v[156:159], v[104:107], v[44:47], v[156:159]
  ds_read_b64_tr_b16 v[120:121], v9 offset:0
  v_mfma_f32_16x16x32_bf16 v[156:159], v[108:111], v[60:63], v[156:159]
  ds_read_b64_tr_b16 v[122:123], v9 offset:2048
  v_mfma_f32_16x16x32_bf16 v[152:155], v[108:111], v[56:59], v[152:155]
  ds_read_b64_tr_b16 v[124:125], v9 offset:4096
  v_mfma_f32_16x16x32_bf16 v[152:155], v[104:107], v[40:43], v[152:155]
  ds_read_b64_tr_b16 v[126:127], v9 offset:6144
  v_mfma_f32_16x16x32_bf16 v[148:151], v[104:107], v[36:39], v[148:151]
  v_mfma_f32_16x16x32_bf16 v[148:151], v[108:111], v[52:55], v[148:151]
  v_mfma_f32_16x16x32_bf16 v[144:147], v[108:111], v[48:51], v[144:147]
  ds_read_b64_tr_b16 v[96:97], v6 offset:8192
  v_mfma_f32_16x16x32_bf16 v[144:147], v[104:107], v[32:35], v[144:147]
  ds_read_b64_tr_b16 v[98:99], v6 offset:10240
  s_nop 0
  s_waitcnt lgkmcnt(6)
  v_mfma_f32_16x16x32_bf16 v[160:163], v[112:115], v[32:35], v[160:163]
  ds_read_b64_tr_b16 v[100:101], v6 offset:12288
  v_mfma_f32_16x16x32_bf16 v[160:163], v[116:119], v[48:51], v[160:163]
  ds_read_b64_tr_b16 v[102:103], v6 offset:14336
  v_mfma_f32_16x16x32_bf16 v[164:167], v[116:119], v[52:55], v[164:167]
  v_mfma_f32_16x16x32_bf16 v[164:167], v[112:115], v[36:39], v[164:167]
  v_mfma_f32_16x16x32_bf16 v[168:171], v[112:115], v[40:43], v[168:171]
  ds_read_b64_tr_b16 v[104:105], v7 offset:8192
  v_mfma_f32_16x16x32_bf16 v[168:171], v[116:119], v[56:59], v[168:171]
  ds_read_b64_tr_b16 v[106:107], v7 offset:10240
  v_mfma_f32_16x16x32_bf16 v[172:175], v[116:119], v[60:63], v[172:175]
  ds_read_b64_tr_b16 v[108:109], v7 offset:12288
  v_mfma_f32_16x16x32_bf16 v[172:175], v[112:115], v[44:47], v[172:175]
  ds_read_b64_tr_b16 v[110:111], v7 offset:14336
  s_waitcnt lgkmcnt(8)
  v_mfma_f32_16x16x32_bf16 v[188:191], v[120:123], v[44:47], v[188:191]
  v_add_u32 v6, s23, v6
  v_add_u32_e64 v7, s23, v7
  v_mfma_f32_16x16x32_bf16 v[188:191], v[124:127], v[60:63], v[188:191]
  ds_read_b64_tr_b16 v[112:113], v10 offset:0
  v_mfma_f32_16x16x32_bf16 v[184:187], v[124:127], v[56:59], v[184:187]
  ds_read_b64_tr_b16 v[114:115], v10 offset:1024
  v_mfma_f32_16x16x32_bf16 v[184:187], v[120:123], v[40:43], v[184:187]
  ds_read_b64_tr_b16 v[116:117], v10 offset:2048
  v_mfma_f32_16x16x32_bf16 v[180:183], v[120:123], v[36:39], v[180:183]
  ds_read_b64_tr_b16 v[118:119], v10 offset:3072
  v_mfma_f32_16x16x32_bf16 v[180:183], v[124:127], v[52:55], v[180:183]
  v_add_u32 v8, s23, v8
  v_add_u32 v9, s23, v9
  v_mfma_f32_16x16x32_bf16 v[176:179], v[124:127], v[48:51], v[176:179]
  v_add_u32 v10, s23, v10
  v_mfma_f32_16x16x32_bf16 v[176:179], v[120:123], v[32:35], v[176:179]
  s_waitcnt lgkmcnt(0)
  s_cbranch_vccnz Lo_27
  s_barrier
Lo_27:
  v_mfma_f32_16x16x32_bf16 v[192:195], v[96:99], v[32:35], v[192:195]
  ds_read_b128 v[64:67], v4 offset:0
  v_mfma_f32_16x16x32_bf16 v[192:195], v[100:103], v[48:51], v[192:195]
  ds_read_b128 v[80:83], v5 offset:0
  v_mfma_f32_16x16x32_bf16 v[196:199], v[100:103], v[52:55], v[196:199]
  v_mfma_f32_16x16x32_bf16 v[196:199], v[96:99], v[36:39], v[196:199]
  ds_read_b128 v[68:71], v4 offset:2048
  v_mfma_f32_16x16x32_bf16 v[200:203], v[96:99], v[40:43], v[200:203]
  ds_read_b128 v[84:87], v5 offset:2048
  v_mfma_f32_16x16x32_bf16 v[200:203], v[100:103], v[56:59], v[200:203]
  v_mfma_f32_16x16x32_bf16 v[204:207], v[100:103], v[60:63], v[204:207]
  ds_read_b128 v[72:75], v4 offset:4096
  v_mfma_f32_16x16x32_bf16 v[204:207], v[96:99], v[44:47], v[204:207]
  ds_read_b128 v[88:91], v5 offset:4096
  v_mfma_f32_16x16x32_bf16 v[220:223], v[104:107], v[44:47], v[220:223]
  ds_read_b64_tr_b16 v[96:97], v6 offset:0
  v_mfma_f32_16x16x32_bf16 v[220:223], v[108:111], v[60:63], v[220:223]
  ds_read_b64_tr_b16 v[98:99], v6 offset:2048
  v_mfma_f32_16x16x32_bf16 v[216:219], v[108:111], v[56:59], v[216:219]
  ds_read_b64_tr_b16 v[100:101], v6 offset:4096
  v_mfma_f32_16x16x32_bf16 v[216:219], v[104:107], v[40:43], v[216:219]
  ds_read_b64_tr_b16 v[102:103], v6 offset:6144
  v_mfma_f32_16x16x32_bf16 v[212:215], v[104:107], v[36:39], v[212:215]
  ds_read_b128 v[76:79], v4 offset:6144
  v_mfma_f32_16x16x32_bf16 v[212:215], v[108:111], v[52:55], v[212:215]
  v_mfma_f32_16x16x32_bf16 v[208:211], v[108:111], v[48:51], v[208:211]
  ds_read_b128 v[92:95], v5 offset:6144
  v_mfma_f32_16x16x32_bf16 v[208:211], v[104:107], v[32:35], v[208:211]
  v_mfma_f32_16x16x32_bf16 v[224:227], v[112:115], v[32:35], v[224:227]
  ds_read_b64_tr_b16 v[104:105], v7 offset:0
  v_mfma_f32_16x16x32_bf16 v[224:227], v[116:119], v[48:51], v[224:227]
  v_mfma_f32_16x16x32_bf16 v[228:231], v[116:119], v[52:55], v[228:231]
  ds_read_b64_tr_b16 v[106:107], v7 offset:2048
  v_mfma_f32_16x16x32_bf16 v[228:231], v[112:115], v[36:39], v[228:231]
  v_mfma_f32_16x16x32_bf16 v[232:235], v[112:115], v[40:43], v[232:235]
  ds_read_b64_tr_b16 v[108:109], v7 offset:4096
  v_mfma_f32_16x16x32_bf16 v[232:235], v[116:119], v[56:59], v[232:235]
  v_mfma_f32_16x16x32_bf16 v[236:239], v[116:119], v[60:63], v[236:239]
  ds_read_b64_tr_b16 v[110:111], v7 offset:6144
  s_waitcnt lgkmcnt(6)
  v_mfma_f32_16x16x32_bf16 v[236:239], v[112:115], v[44:47], v[236:239]
  s_cbranch_vccnz Lo_26
Lk_23:
  v_mfma_f32_16x16x32_bf16 v[128:131], v[96:99], v[64:67], v[128:131]
  ds_read_b64_tr_b16 v[112:113], v8 offset:0
  v_mfma_f32_16x16x32_bf16 v[128:131], v[100:103], v[80:83], v[128:131]
  ds_read_b64_tr_b16 v[114:115], v8 offset:2048
  v_mfma_f32_16x16x32_bf16 v[132:135], v[100:103], v[84:87], v[132:135]
  ds_read_b64_tr_b16 v[116:117], v8 offset:4096
  v_mfma_f32_16x16x32_bf16 v[132:135], v[96:99], v[68:71], v[132:135]
  ds_read_b64_tr_b16 v[118:119], v8 offset:6144
  v_mfma_f32_16x16x32_bf16 v[136:139], v[96:99], v[72:75], v[136:139]
  s_add_u32 s16, s16, s17
  s_cmp_eq_u32 s16, 65536
  s_cselect_b32 s23, s18, s17
  s_cselect_b32 s16, Lz1-Lz0+0, s16
  v_mfma_f32_16x16x32_bf16 v[136:139], v[100:103], v[88:91], v[136:139]
  v_add_u32_e64 v4, s23, v4
  v_add_u32 v5, s23, v5
  s_add_u32 s19, s19, s20
  s_cmp_eq_u32 s19, 86016
  s_waitcnt lgkmcnt(8)
  v_mfma_f32_16x16x32_bf16 v[140:143], v[100:103], v[92:95], v[140:143]
  s_cselect_b32 s23, s21, s20
  s_cselect_b32 s19, 0, s19
  v_mfma_f32_16x16x32_bf16 v[140:143], v[96:99], v[76:79], v[140:143]
  s_waitcnt lgkmcnt(4)
  v_mfma_f32_16x16x32_bf16 v[156:159], v[104:107], v[76:79], v[156:159]
  ds_read_b64_tr_b16 v[120:121], v9 offset:0
  v_mfma_f32_16x16x32_bf16 v[156:159], v[108:111], v[92:95], v[156:159]
  ds_read_b64_tr_b16 v[122:123], v9 offset:2048
  v_mfma_f32_16x16x32_bf16 v[152:155], v[108:111], v[88:91], v[152:155]
  ds_read_b64_tr_b16 v[124:125], v9 offset:4096
  v_mfma_f32_16x16x32_bf16 v[152:155], v[104:107], v[72:75], v[152:155]
  ds_read_b64_tr_b16 v[126:127], v9 offset:6144
  v_mfma_f32_16x16x32_bf16 v[148:151], v[104:107], v[68:71], v[148:151]
  s_sub_u32 s22, s22, 1
  s_cmp_lg_u32 s22, 0
  v_mfma_f32_16x16x32_bf16 v[148:151], v[108:111], v[84:87], v[148:151]
  v_mfma_f32_16x16x32_bf16 v[144:147], v[108:111], v[80:83], v[144:147]
  ds_read_b64_tr_b16 v[96:97], v6 offset:8192
  v_mfma_f32_16x16x32_bf16 v[144:147], v[104:107], v[64:67], v[144:147]
  ds_read_b64_tr_b16 v[98:99], v6 offset:10240
  s_nop 0
  s_waitcnt lgkmcnt(6)
  v_mfma_f32_16x16x32_bf16 v[160:163], v[112:115], v[64:67], v[160:163]
  ds_read_b64_tr_b16 v[100:101], v6 offset:12288
  v_mfma_f32_16x16x32_bf16 v[160:163], v[116:119], v[80:83], v[160:163]
  ds_read_b64_tr_b16 v[102:103], v6 offset:14336
  v_mfma_f32_16x16x32_bf16 v[164:167], v[116:119], v[84:87], v[164:167]
  v_mfma_f32_16x16x32_bf16 v[164:167], v[112:115], v[68:71], v[164:167]
  v_mfma_f32_16x16x32_bf16 v[168:171], v[112:115], v[72:75], v[168:171]
  ds_read_b64_tr_b16 v[104:105], v7 offset:8192
  v_mfma_f32_16x16x32_bf16 v[168:171], v[116:119], v[88:91], v[168:171]
  ds_read_b64_tr_b16 v[106:107], v7 offset:10240
  v_mfma_f32_16x16x32_bf16 v[172:175], v[116:119], v[92:95], v[172:175]
  ds_read_b64_tr_b16 v[108:109], v7 offset:12288
  v_mfma_f32_16x16x32_bf16 v[172:175], v[112:115], v[76:79], v[172:175]
  ds_read_b64_tr_b16 v[110:111], v7 offset:14336
  s_waitcnt lgkmcnt(8)
  v_mfma_f32_16x16x32_bf16 v[188:191], v[120:123], v[76:79], v[188:191]
  v_add_u32 v6, s23, v6
  v_add_u32_e64 v7, s23, v7
  v_mfma_f32_16x16x32_bf16 v[188:191], v[124:127], v[92:95], v[188:191]
  ds_read_b64_tr_b16 v[112:113], v10 offset:0
  v_mfma_f32_16x16x32_bf16 v[184:187], v[124:127], v[88:91], v[184:187]
  ds_read_b64_tr_b16 v[114:115], v10 offset:1024
  v_mfma_f32_16x16x32_bf16 v[184:187], v[120:123], v[72:75], v[184:187]
  ds_read_b64_tr_b16 v[116:117], v10 offset:2048
  v_mfma_f32_16x16x32_bf16 v[180:183], v[120:123], v[68:71], v[180:183]
  ds_read_b64_tr_b16 v[118:119], v10 offset:3072
  v_mfma_f32_16x16x32_bf16 v[180:183], v[124:127], v[84:87], v[180:183]
  v_add_u32 v8, s23, v8
  v_add_u32 v9, s23, v9
  v_mfma_f32_16x16x32_bf16 v[176:179], v[124:127], v[80:83], v[176:179]
  v_add_u32 v10, s23, v10
  v_mfma_f32_16x16x32_bf16 v[176:179], v[120:123], v[64:67], v[176:179]
  s_waitcnt lgkmcnt(0)
  s_barrier
  s_cbranch_scc0 Lk_24
  v_mfma_f32_16x16x32_bf16 v[192:195], v[96:99], v[64:67], v[192:195]
  ds_read_b128 v[32:35], v4 offset:0
  v_mfma_f32_16x16x32_bf16 v[192:195], v[100:103], v[80:83], v[192:195]
  ds_read_b128 v[48:51], v5 offset:0
  v_mfma_f32_16x16x32_bf16 v[196:199], v[100:103], v[84:87], v[196:199]
  v_mfma_f32_16x16x32_bf16 v[196:199], v[96:99], v[68:71], v[196:199]
  ds_read_b128 v[36:39], v4 offset:2048
  v_mfma_f32_16x16x32_bf16 v[200:203], v[96:99], v[72:75], v[200:203]
  ds_read_b128 v[52:55], v5 offset:2048
  v_mfma_f32_16x16x32_bf16 v[200:203], v[100:103], v[88:91], v[200:203]
  v_mfma_f32_16x16x32_bf16 v[204:207], v[100:103], v[92:95], v[204:207]
  ds_read_b128 v[40:43], v4 offset:4096
  v_mfma_f32_16x16x32_bf16 v[204:207], v[96:99], v[76:79], v[204:207]
  ds_read_b128 v[56:59], v5 offset:4096
  v_mfma_f32_16x16x32_bf16 v[220:223], v[104:107], v[76:79], v[220:223]
  ds_read_b64_tr_b16 v[96:97], v6 offset:0
  v_mfma_f32_16x16x32_bf16 v[220:223], v[108:111], v[92:95], v[220:223]
  ds_read_b64_tr_b16 v[98:99], v6 offset:2048
  v_mfma_f32_16x16x32_bf16 v[216:219], v[108:111], v[88:91], v[216:219]
  ds_read_b64_tr_b16 v[100:101], v6 offset:4096
  v_mfma_f32_16x16x32_bf16 v[216:219], v[104:107], v[72:75], v[216:219]
  ds_read_b64_tr_b16 v[102:103], v6 offset:6144
  v_mfma_f32_16x16x32_bf16 v[212:215], v[104:107], v[68:71], v[212:215]
  ds_read_b128 v[44:47], v4 offset:6144
  v_mfma_f32_16x16x32_bf16 v[212:215], v[108:111], v[84:87], v[212:215]
  v_mfma_f32_16x16x32_bf16 v[208:211], v[108:111], v[80:83], v[208:211]
  ds_read_b128 v[60:63], v5 offset:6144
  v_mfma_f32_16x16x32_bf16 v[208:211], v[104:107], v[64:67], v[208:211]
  v_mfma_f32_16x16x32_bf16 v[224:227], v[112:115], v[64:67], v[224:227]
  ds_read_b64_tr_b16 v[104:105], v7 offset:0
  v_mfma_f32_16x16x32_bf16 v[224:227], v[116:119], v[80:83], v[224:227]
  v_mfma_f32_16x16x32_bf16 v[228:231], v[116:119], v[84:87], v[228:231]
  ds_read_b64_tr_b16 v[106:107], v7 offset:2048
  v_mfma_f32_16x16x32_bf16 v[228:231], v[112:115], v[68:71], v[228:231]
  v_mfma_f32_16x16x32_bf16 v[232:235], v[112:115], v[72:75], v[232:235]
  ds_read_b64_tr_b16 v[108:109], v7 offset:4096
  v_mfma_f32_16x16x32_bf16 v[232:235], v[116:119], v[88:91], v[232:235]
  v_mfma_f32_16x16x32_bf16 v[236:239], v[116:119], v[92:95], v[236:239]
  ds_read_b64_tr_b16 v[110:111], v7 offset:6144
  s_waitcnt lgkmcnt(6)
  v_mfma_f32_16x16x32_bf16 v[236:239], v[112:115], v[76:79], v[236:239]
  s_branch Lk_22
Lk_24:
  v_mfma_f32_16x16x32_bf16 v[192:195], v[96:99], v[64:67], v[192:195]
  ds_read_b128 v[32:35], v3 offset:0
  s_mul_i32 s4, s85, 320
  v_mfma_f32_16x16x32_bf16 v[192:195], v[100:103], v[80:83], v[192:195]
  ds_read_b128 v[36:39], v3 offset:1024
  s_add_u32 s4, s4, 151552
  v_mfma_f32_16x16x32_bf16 v[196:199], v[100:103], v[84:87], v[196:199]
  ds_read_b128 v[40:43], v3 offset:64
  v_and_b32_e64 v2, 15, v1
  v_mfma_f32_16x16x32_bf16 v[196:199], v[96:99], v[68:71], v[196:199]
  ds_read_b128 v[44:47], v3 offset:1088
  v_lshl_add_u32 v7, v2, 2, s4
  v_mfma_f32_16x16x32_bf16 v[200:203], v[96:99], v[72:75], v[200:203]
  ds_read_b128 v[48:51], v3 offset:128
  v_mov_b32 v4, 0x409d30fc
  v_mfma_f32_16x16x32_bf16 v[200:203], v[100:103], v[88:91], v[200:203]
  ds_read_b128 v[52:55], v3 offset:1152
  v_mov_b32 v5, 0x3eeff558
  v_mfma_f32_16x16x32_bf16 v[204:207], v[100:103], v[92:95], v[204:207]
  ds_read_b128 v[56:59], v3 offset:192
  v_and_b32_e64 v2, 32, v1
  v_mfma_f32_16x16x32_bf16 v[204:207], v[96:99], v[76:79], v[204:207]
  ds_read_b128 v[60:63], v3 offset:1216
  v_mad_u32_u24 v6, v2, 48, v11
  v_mfma_f32_16x16x32_bf16 v[220:223], v[104:107], v[76:79], v[220:223]
  v_mfma_f32_16x16x32_bf16 v[220:223], v[108:111], v[92:95], v[220:223]
  ds_read2_b32 v[96:97], v7 offset0:0 offset1:160
  ds_read2_b32 v[98:99], v7 offset0:16 offset1:176
  v_mfma_f32_16x16x32_bf16 v[216:219], v[108:111], v[88:91], v[216:219]
  ds_read2_b32 v[100:101], v7 offset0:32 offset1:192
  ds_read2_b32 v[102:103], v7 offset0:48 offset1:208
  v_mfma_f32_16x16x32_bf16 v[216:219], v[104:107], v[72:75], v[216:219]
  s_lshl_b32 s5, s86, Lz1-Lz0+6
  s_add_u32 s5, s5, 154880
  v_mfma_f32_16x16x32_bf16 v[212:215], v[104:107], v[68:71], v[212:215]
  v_add_u32_e64 v2, s5, v29
  v_mfma_f32_16x16x32_bf16 v[212:215], v[108:111], v[84:87], v[212:215]
  v_mfma_f32_16x16x32_bf16 v[208:211], v[108:111], v[80:83], v[208:211]
  v_mfma_f32_16x16x32_bf16 v[208:211], v[104:107], v[64:67], v[208:211]
  v_mfma_f32_16x16x32_bf16 v[224:227], v[112:115], v[64:67], v[224:227]
  v_mfma_f32_16x16x32_bf16 v[224:227], v[116:119], v[80:83], v[224:227]
  v_mfma_f32_16x16x32_bf16 v[228:231], v[116:119], v[84:87], v[228:231]
  v_mfma_f32_16x16x32_bf16 v[228:231], v[112:115], v[68:71], v[228:231]
  s_waitcnt lgkmcnt(0)
  v_mul_f32 v96, v5, v96
  v_mul_f32_e64 v97, v5, v97
  v_mfma_f32_16x16x32_bf16 v[232:235], v[112:115], v[72:75], v[232:235]
  v_mul_f32 v98, v5, v98
  v_mul_f32 v99, v5, v99
  v_mfma_f32_16x16x32_bf16 v[232:235], v[116:119], v[88:91], v[232:235]
  v_mul_f32 v100, v5, v100
  v_mul_f32 v101, v5, v101
  v_mfma_f32_16x16x32_bf16 v[236:239], v[116:119], v[92:95], v[236:239]
  v_mul_f32 v102, v5, v102
  v_mul_f32 v103, v5, v103
  v_mfma_f32_16x16x32_bf16 v[236:239], v[112:115], v[76:79], v[236:239]
  ds_read_b128 v[80:83], v2 offset:0
  ds_read_b128 v[84:87], v2 offset:1024
  ds_read_b128 v[64:67], v3 offset:256
  ds_read_b128 v[68:71], v3 offset:1280
  ds_read_b128 v[72:75], v3 offset:320
  ds_read_b128 v[76:79], v3 offset:1344
  v_pk_fma_f32 v[104:105], v[32:33], v[96:97], v[36:37] op_sel:[0,1,0] op_sel_hi:[1,1,1] neg_lo:[0,1,0] neg_hi:[0,1,0]
  v_pk_fma_f32 v[106:107], v[34:35], v[96:97], v[38:39] op_sel:[0,1,0] op_sel_hi:[1,1,1] neg_lo:[0,1,0] neg_hi:[0,1,0]
  v_pk_fma_f32 v[108:109], v[40:41], v[96:97], v[44:45] op_sel:[0,1,0] op_sel_hi:[1,1,1] neg_lo:[0,1,0] neg_hi:[0,1,0]
  v_pk_fma_f32 v[110:111], v[42:43], v[96:97], v[46:47] op_sel:[0,1,0] op_sel_hi:[1,1,1] neg_lo:[0,1,0] neg_hi:[0,1,0]
  v_pk_fma_f32 v[128:129], v[128:129], v[96:97], v[104:105] op_sel:[0,0,0] op_sel_hi:[1,0,1]
  v_pk_fma_f32 v[130:131], v[130:131], v[96:97], v[106:107] op_sel:[0,0,0] op_sel_hi:[1,0,1]
  v_pk_fma_f32 v[144:145], v[144:145], v[96:97], v[108:109] op_sel:[0,0,0] op_sel_hi:[1,0,1]
  v_pk_fma_f32 v[146:147], v[146:147], v[96:97], v[110:111] op_sel:[0,0,0] op_sel_hi:[1,0,1]
  v_pk_fma_f32 v[104:105], v[128:129], v[128:129], v[4:5] op_sel_hi:[1,1,0]
  v_pk_fma_f32 v[106:107], v[130:131], v[130:131], v[4:5] op_sel_hi:[1,1,0]
  v_pk_fma_f32 v[108:109], v[144:145], v[144:145], v[4:5] op_sel_hi:[1,1,0]
  v_pk_fma_f32 v[110:111], v[146:147], v[146:147], v[4:5] op_sel_hi:[1,1,0]
  v_pk_mul_f32 v[104:105], v[104:105], v[128:129] neg_lo:[0,1] neg_hi:[0,1]
  v_pk_mul_f32 v[106:107], v[106:107], v[130:131] neg_lo:[0,1] neg_hi:[0,1]
  v_pk_mul_f32 v[108:109], v[108:109], v[144:145] neg_lo:[0,1] neg_hi:[0,1]
  v_pk_mul_f32 v[110:111], v[110:111], v[146:147] neg_lo:[0,1] neg_hi:[0,1]
  v_exp_f32 v104, v104
  v_exp_f32 v105, v105
  v_exp_f32 v106, v106
  v_exp_f32 v107, v107
  v_exp_f32 v108, v108
  v_exp_f32 v109, v109
  v_exp_f32 v110, v110
  v_exp_f32 v111, v111
  v_pk_fma_f32 v[104:105], v[104:105], v[4:5], v[4:5] op_sel:[0,1,1] op_sel_hi:[1,1,1]
  v_pk_fma_f32 v[106:107], v[106:107], v[4:5], v[4:5] op_sel:[0,1,1] op_sel_hi:[1,1,1]
  v_pk_fma_f32 v[108:109], v[108:109], v[4:5], v[4:5] op_sel:[0,1,1] op_sel_hi:[1,1,1]
  v_pk_fma_f32 v[110:111], v[110:111], v[4:5], v[4:5] op_sel:[0,1,1] op_sel_hi:[1,1,1]
  v_rcp_f32 v104, v104
  v_rcp_f32 v105, v105
  v_rcp_f32 v106, v106
  v_rcp_f32 v107, v107
  v_rcp_f32 v108, v108
  v_rcp_f32 v109, v109
  v_rcp_f32 v110, v110
  v_rcp_f32 v111, v111
  v_pk_mul_f32 v[128:129], v[128:129], v[104:105]
  v_pk_mul_f32 v[130:131], v[130:131], v[106:107]
  v_pk_mul_f32 v[144:145], v[144:145], v[108:109]
  v_pk_mul_f32 v[146:147], v[146:147], v[110:111]
  v_cvt_pk_bf16_f32 v116, v128, v129
  v_cvt_pk_bf16_f32 v117, v130, v131
  v_cvt_pk_bf16_f32 v118, v144, v145
  v_cvt_pk_bf16_f32 v119, v146, v147
  buffer_store_dwordx4 v[116:119], v0, s[40:43], s6 offen offset:0 sc0 sc1
  ds_write_b128 v0, v[116:119] offset:0
  v_pk_fma_f32 v[104:105], v[32:33], v[98:99], v[36:37] op_sel:[0,1,0] op_sel_hi:[1,1,1] neg_lo:[0,1,0] neg_hi:[0,1,0]
  v_pk_fma_f32 v[106:107], v[34:35], v[98:99], v[38:39] op_sel:[0,1,0] op_sel_hi:[1,1,1] neg_lo:[0,1,0] neg_hi:[0,1,0]
  v_pk_fma_f32 v[108:109], v[40:41], v[98:99], v[44:45] op_sel:[0,1,0] op_sel_hi:[1,1,1] neg_lo:[0,1,0] neg_hi:[0,1,0]
  v_pk_fma_f32 v[110:111], v[42:43], v[98:99], v[46:47] op_sel:[0,1,0] op_sel_hi:[1,1,1] neg_lo:[0,1,0] neg_hi:[0,1,0]
  v_pk_fma_f32 v[132:133], v[132:133], v[98:99], v[104:105] op_sel:[0,0,0] op_sel_hi:[1,0,1]
  v_pk_fma_f32 v[134:135], v[134:135], v[98:99], v[106:107] op_sel:[0,0,0] op_sel_hi:[1,0,1]
  v_pk_fma_f32 v[148:149], v[148:149], v[98:99], v[108:109] op_sel:[0,0,0] op_sel_hi:[1,0,1]
  v_pk_fma_f32 v[150:151], v[150:151], v[98:99], v[110:111] op_sel:[0,0,0] op_sel_hi:[1,0,1]
  v_pk_fma_f32 v[104:105], v[132:133], v[132:133], v[4:5] op_sel_hi:[1,1,0]
  v_pk_fma_f32 v[106:107], v[134:135], v[134:135], v[4:5] op_sel_hi:[1,1,0]
  v_pk_fma_f32 v[108:109], v[148:149], v[148:149], v[4:5] op_sel_hi:[1,1,0]
  v_pk_fma_f32 v[110:111], v[150:151], v[150:151], v[4:5] op_sel_hi:[1,1,0]
  v_pk_mul_f32 v[104:105], v[104:105], v[132:133] neg_lo:[0,1] neg_hi:[0,1]
  v_pk_mul_f32 v[106:107], v[106:107], v[134:135] neg_lo:[0,1] neg_hi:[0,1]
  v_pk_mul_f32 v[108:109], v[108:109], v[148:149] neg_lo:[0,1] neg_hi:[0,1]
  v_pk_mul_f32 v[110:111], v[110:111], v[150:151] neg_lo:[0,1] neg_hi:[0,1]
  v_exp_f32 v104, v104
  v_exp_f32 v105, v105
  v_exp_f32 v106, v106
  v_exp_f32 v107, v107
  v_exp_f32 v108, v108
  v_exp_f32 v109, v109
  v_exp_f32 v110, v110
  v_exp_f32 v111, v111
  v_pk_fma_f32 v[104:105], v[104:105], v[4:5], v[4:5] op_sel:[0,1,1] op_sel_hi:[1,1,1]
  v_pk_fma_f32 v[106:107], v[106:107], v[4:5], v[4:5] op_sel:[0,1,1] op_sel_hi:[1,1,1]
  v_pk_fma_f32 v[108:109], v[108:109], v[4:5], v[4:5] op_sel:[0,1,1] op_sel_hi:[1,1,1]
  v_pk_fma_f32 v[110:111], v[110:111], v[4:5], v[4:5] op_sel:[0,1,1] op_sel_hi:[1,1,1]
  v_rcp_f32 v104, v104
  v_rcp_f32 v105, v105
  v_rcp_f32 v106, v106
  v_rcp_f32 v107, v107
  v_rcp_f32 v108, v108
  v_rcp_f32 v109, v109
  v_rcp_f32 v110, v110
  v_rcp_f32 v111, v111
  v_pk_mul_f32 v[132:133], v[132:133], v[104:105]
  v_pk_mul_f32 v[134:135], v[134:135], v[106:107]
  v_pk_mul_f32 v[148:149], v[148:149], v[108:109]
  v_pk_mul_f32 v[150:151], v[150:151], v[110:111]
  v_cvt_pk_bf16_f32 v120, v132, v133
  v_cvt_pk_bf16_f32 v121, v134, v135
  v_cvt_pk_bf16_f32 v122, v148, v149
  v_cvt_pk_bf16_f32 v123, v150, v151
  buffer_store_dwordx4 v[120:123], v0, s[40:43], s6 offen offset:2048 sc0 sc1
  ds_write_b128 v0, v[120:123] offset:2048
  s_add_u32 s6, s6, 0x20000
  v_pk_fma_f32 v[104:105], v[32:33], v[100:101], v[36:37] op_sel:[0,1,0] op_sel_hi:[1,1,1] neg_lo:[0,1,0] neg_hi:[0,1,0]
  v_pk_fma_f32 v[106:107], v[34:35], v[100:101], v[38:39] op_sel:[0,1,0] op_sel_hi:[1,1,1] neg_lo:[0,1,0] neg_hi:[0,1,0]
  v_pk_fma_f32 v[108:109], v[40:41], v[100:101], v[44:45] op_sel:[0,1,0] op_sel_hi:[1,1,1] neg_lo:[0,1,0] neg_hi:[0,1,0]
  v_pk_fma_f32 v[110:111], v[42:43], v[100:101], v[46:47] op_sel:[0,1,0] op_sel_hi:[1,1,1] neg_lo:[0,1,0] neg_hi:[0,1,0]
  v_pk_fma_f32 v[136:137], v[136:137], v[100:101], v[104:105] op_sel:[0,0,0] op_sel_hi:[1,0,1]
  v_pk_fma_f32 v[138:139], v[138:139], v[100:101], v[106:107] op_sel:[0,0,0] op_sel_hi:[1,0,1]
  v_pk_fma_f32 v[152:153], v[152:153], v[100:101], v[108:109] op_sel:[0,0,0] op_sel_hi:[1,0,1]
  v_pk_fma_f32 v[154:155], v[154:155], v[100:101], v[110:111] op_sel:[0,0,0] op_sel_hi:[1,0,1]
  v_pk_fma_f32 v[104:105], v[136:137], v[136:137], v[4:5] op_sel_hi:[1,1,0]
  v_pk_fma_f32 v[106:107], v[138:139], v[138:139], v[4:5] op_sel_hi:[1,1,0]
  v_pk_fma_f32 v[108:109], v[152:153], v[152:153], v[4:5] op_sel_hi:[1,1,0]
  v_pk_fma_f32 v[110:111], v[154:155], v[154:155], v[4:5] op_sel_hi:[1,1,0]
  v_pk_mul_f32 v[104:105], v[104:105], v[136:137] neg_lo:[0,1] neg_hi:[0,1]
  v_pk_mul_f32 v[106:107], v[106:107], v[138:139] neg_lo:[0,1] neg_hi:[0,1]
  v_pk_mul_f32 v[108:109], v[108:109], v[152:153] neg_lo:[0,1] neg_hi:[0,1]
  v_pk_mul_f32 v[110:111], v[110:111], v[154:155] neg_lo:[0,1] neg_hi:[0,1]
  v_exp_f32 v104, v104
  v_exp_f32 v105, v105
  v_exp_f32 v106, v106
  v_exp_f32 v107, v107
  v_exp_f32 v108, v108
  v_exp_f32 v109, v109
  v_exp_f32 v110, v110
  v_exp_f32 v111, v111
  v_pk_fma_f32 v[104:105], v[104:105], v[4:5], v[4:5] op_sel:[0,1,1] op_sel_hi:[1,1,1]
  v_pk_fma_f32 v[106:107], v[106:107], v[4:5], v[4:5] op_sel:[0,1,1] op_sel_hi:[1,1,1]
  v_pk_fma_f32 v[108:109], v[108:109], v[4:5], v[4:5] op_sel:[0,1,1] op_sel_hi:[1,1,1]
  v_pk_fma_f32 v[110:111], v[110:111], v[4:5], v[4:5] op_sel:[0,1,1] op_sel_hi:[1,1,1]
  v_rcp_f32 v104, v104
  v_rcp_f32 v105, v105
  v_rcp_f32 v106, v106
  v_rcp_f32 v107, v107
  v_rcp_f32 v108, v108
  v_rcp_f32 v109, v109
  v_rcp_f32 v110, v110
  v_rcp_f32 v111, v111
  v_pk_mul_f32 v[136:137], v[136:137], v[104:105]
  v_pk_mul_f32 v[138:139], v[138:139], v[106:107]
  v_pk_mul_f32 v[152:153], v[152:153], v[108:109]
  v_pk_mul_f32 v[154:155], v[154:155], v[110:111]
  v_cvt_pk_bf16_f32 v116, v136, v137
  v_cvt_pk_bf16_f32 v117, v138, v139
  v_cvt_pk_bf16_f32 v118, v152, v153
  v_cvt_pk_bf16_f32 v119, v154, v155
  buffer_store_dwordx4 v[116:119], v0, s[40:43], s7 offen offset:0 sc0 sc1
  ds_write_b128 v0, v[116:119] offset:4096
  v_pk_fma_f32 v[104:105], v[32:33], v[102:103], v[36:37] op_sel:[0,1,0] op_sel_hi:[1,1,1] neg_lo:[0,1,0] neg_hi:[0,1,0]
  v_pk_fma_f32 v[106:107], v[34:35], v[102:103], v[38:39] op_sel:[0,1,0] op_sel_hi:[1,1,1] neg_lo:[0,1,0] neg_hi:[0,1,0]
  v_pk_fma_f32 v[108:109], v[40:41], v[102:103], v[44:45] op_sel:[0,1,0] op_sel_hi:[1,1,1] neg_lo:[0,1,0] neg_hi:[0,1,0]
  v_pk_fma_f32 v[110:111], v[42:43], v[102:103], v[46:47] op_sel:[0,1,0] op_sel_hi:[1,1,1] neg_lo:[0,1,0] neg_hi:[0,1,0]
  v_pk_fma_f32 v[140:141], v[140:141], v[102:103], v[104:105] op_sel:[0,0,0] op_sel_hi:[1,0,1]
  v_pk_fma_f32 v[142:143], v[142:143], v[102:103], v[106:107] op_sel:[0,0,0] op_sel_hi:[1,0,1]
  v_pk_fma_f32 v[156:157], v[156:157], v[102:103], v[108:109] op_sel:[0,0,0] op_sel_hi:[1,0,1]
  v_pk_fma_f32 v[158:159], v[158:159], v[102:103], v[110:111] op_sel:[0,0,0] op_sel_hi:[1,0,1]
  v_pk_fma_f32 v[104:105], v[140:141], v[140:141], v[4:5] op_sel_hi:[1,1,0]
  v_pk_fma_f32 v[106:107], v[142:143], v[142:143], v[4:5] op_sel_hi:[1,1,0]
  v_pk_fma_f32 v[108:109], v[156:157], v[156:157], v[4:5] op_sel_hi:[1,1,0]
  v_pk_fma_f32 v[110:111], v[158:159], v[158:159], v[4:5] op_sel_hi:[1,1,0]
  v_pk_mul_f32 v[104:105], v[104:105], v[140:141] neg_lo:[0,1] neg_hi:[0,1]
  v_pk_mul_f32 v[106:107], v[106:107], v[142:143] neg_lo:[0,1] neg_hi:[0,1]
  v_pk_mul_f32 v[108:109], v[108:109], v[156:157] neg_lo:[0,1] neg_hi:[0,1]
  v_pk_mul_f32 v[110:111], v[110:111], v[158:159] neg_lo:[0,1] neg_hi:[0,1]
  v_exp_f32 v104, v104
  v_exp_f32 v105, v105
  v_exp_f32 v106, v106
  v_exp_f32 v107, v107
  v_exp_f32 v108, v108
  v_exp_f32 v109, v109
  v_exp_f32 v110, v110
  v_exp_f32 v111, v111
  v_pk_fma_f32 v[104:105], v[104:105], v[4:5], v[4:5] op_sel:[0,1,1] op_sel_hi:[1,1,1]
  v_pk_fma_f32 v[106:107], v[106:107], v[4:5], v[4:5] op_sel:[0,1,1] op_sel_hi:[1,1,1]
  v_pk_fma_f32 v[108:109], v[108:109], v[4:5], v[4:5] op_sel:[0,1,1] op_sel_hi:[1,1,1]
  v_pk_fma_f32 v[110:111], v[110:111], v[4:5], v[4:5] op_sel:[0,1,1] op_sel_hi:[1,1,1]
  v_rcp_f32 v104, v104
  v_rcp_f32 v105, v105
  v_rcp_f32 v106, v106
  v_rcp_f32 v107, v107
  v_rcp_f32 v108, v108
  v_rcp_f32 v109, v109
  v_rcp_f32 v110, v110
  v_rcp_f32 v111, v111
  v_pk_mul_f32 v[140:141], v[140:141], v[104:105]
  v_pk_mul_f32 v[142:143], v[142:143], v[106:107]
  v_pk_mul_f32 v[156:157], v[156:157], v[108:109]
  v_pk_mul_f32 v[158:159], v[158:159], v[110:111]
  v_cvt_pk_bf16_f32 v120, v140, v141
  v_cvt_pk_bf16_f32 v121, v142, v143
  v_cvt_pk_bf16_f32 v122, v156, v157
  v_cvt_pk_bf16_f32 v123, v158, v159
  buffer_store_dwordx4 v[120:123], v0, s[40:43], s7 offen offset:2048 sc0 sc1
  ds_write_b128 v0, v[120:123] offset:6144
  s_add_u32 s7, s7, 0x20000
  s_nop 0
  s_waitcnt lgkmcnt(0)
  v_pk_fma_f32 v[104:105], v[80:81], v[96:97], v[84:85] op_sel:[0,1,0] op_sel_hi:[1,1,1] neg_lo:[0,1,0] neg_hi:[0,1,0]
  v_pk_fma_f32 v[106:107], v[82:83], v[96:97], v[86:87] op_sel:[0,1,0] op_sel_hi:[1,1,1] neg_lo:[0,1,0] neg_hi:[0,1,0]
  v_pk_fma_f32 v[108:109], v[80:81], v[98:99], v[84:85] op_sel:[0,1,0] op_sel_hi:[1,1,1] neg_lo:[0,1,0] neg_hi:[0,1,0]
  v_pk_fma_f32 v[110:111], v[82:83], v[98:99], v[86:87] op_sel:[0,1,0] op_sel_hi:[1,1,1] neg_lo:[0,1,0] neg_hi:[0,1,0]
  v_pk_fma_f32 v[224:225], v[224:225], v[96:97], v[104:105] op_sel:[0,0,0] op_sel_hi:[1,0,1]
  v_pk_fma_f32 v[226:227], v[226:227], v[96:97], v[106:107] op_sel:[0,0,0] op_sel_hi:[1,0,1]
  v_pk_fma_f32 v[228:229], v[228:229], v[98:99], v[108:109] op_sel:[0,0,0] op_sel_hi:[1,0,1]
  v_pk_fma_f32 v[230:231], v[230:231], v[98:99], v[110:111] op_sel:[0,0,0] op_sel_hi:[1,0,1]
  v_pk_fma_f32 v[104:105], v[224:225], v[224:225], v[4:5] op_sel_hi:[1,1,0]
  v_pk_fma_f32 v[106:107], v[226:227], v[226:227], v[4:5] op_sel_hi:[1,1,0]
  v_pk_fma_f32 v[108:109], v[228:229], v[228:229], v[4:5] op_sel_hi:[1,1,0]
  v_pk_fma_f32 v[110:111], v[230:231], v[230:231], v[4:5] op_sel_hi:[1,1,0]
  v_pk_mul_f32 v[104:105], v[104:105], v[224:225] neg_lo:[0,1] neg_hi:[0,1]
  v_pk_mul_f32 v[106:107], v[106:107], v[226:227] neg_lo:[0,1] neg_hi:[0,1]
  v_pk_mul_f32 v[108:109], v[108:109], v[228:229] neg_lo:[0,1] neg_hi:[0,1]
  v_pk_mul_f32 v[110:111], v[110:111], v[230:231] neg_lo:[0,1] neg_hi:[0,1]
  v_exp_f32 v104, v104
  v_exp_f32 v105, v105
  v_exp_f32 v106, v106
  v_exp_f32 v107, v107
  v_exp_f32 v108, v108
  v_exp_f32 v109, v109
  v_exp_f32 v110, v110
  v_exp_f32 v111, v111
  v_pk_fma_f32 v[104:105], v[104:105], v[4:5], v[4:5] op_sel:[0,1,1] op_sel_hi:[1,1,1]
  v_pk_fma_f32 v[106:107], v[106:107], v[4:5], v[4:5] op_sel:[0,1,1] op_sel_hi:[1,1,1]
  v_pk_fma_f32 v[108:109], v[108:109], v[4:5], v[4:5] op_sel:[0,1,1] op_sel_hi:[1,1,1]
  v_pk_fma_f32 v[110:111], v[110:111], v[4:5], v[4:5] op_sel:[0,1,1] op_sel_hi:[1,1,1]
  v_rcp_f32 v104, v104
  v_rcp_f32 v105, v105
  v_rcp_f32 v106, v106
  v_rcp_f32 v107, v107
  v_rcp_f32 v108, v108
  v_rcp_f32 v109, v109
  v_rcp_f32 v110, v110
  v_rcp_f32 v111, v111
  v_pk_mul_f32 v[224:225], v[224:225], v[104:105]
  v_pk_mul_f32 v[226:227], v[226:227], v[106:107]
  v_pk_mul_f32 v[228:229], v[228:229], v[108:109]
  v_pk_mul_f32 v[230:231], v[230:231], v[110:111]
  v_cvt_pk_bf16_f32 v116, v224, v225
  v_cvt_pk_bf16_f32 v117, v226, v227
  v_cvt_pk_bf16_f32 v118, v228, v229
  v_cvt_pk_bf16_f32 v119, v230, v231
  s_nop 0
  v_permlane32_swap_b32 v116, v118
  v_permlane32_swap_b32_e64 v117, v119
  buffer_store_dwordx4 v[116:119], v6, s[40:43], s8 offen sc0 sc1
  s_add_u32 s8, s8, 4096
  v_pk_fma_f32 v[104:105], v[80:81], v[100:101], v[84:85] op_sel:[0,1,0] op_sel_hi:[1,1,1] neg_lo:[0,1,0] neg_hi:[0,1,0]
  v_pk_fma_f32 v[106:107], v[82:83], v[100:101], v[86:87] op_sel:[0,1,0] op_sel_hi:[1,1,1] neg_lo:[0,1,0] neg_hi:[0,1,0]
  v_pk_fma_f32 v[108:109], v[80:81], v[102:103], v[84:85] op_sel:[0,1,0] op_sel_hi:[1,1,1] neg_lo:[0,1,0] neg_hi:[0,1,0]
  v_pk_fma_f32 v[110:111], v[82:83], v[102:103], v[86:87] op_sel:[0,1,0] op_sel_hi:[1,1,1] neg_lo:[0,1,0] neg_hi:[0,1,0]
  v_pk_fma_f32 v[232:233], v[232:233], v[100:101], v[104:105] op_sel:[0,0,0] op_sel_hi:[1,0,1]
  v_pk_fma_f32 v[234:235], v[234:235], v[100:101], v[106:107] op_sel:[0,0,0] op_sel_hi:[1,0,1]
  v_pk_fma_f32 v[236:237], v[236:237], v[102:103], v[108:109] op_sel:[0,0,0] op_sel_hi:[1,0,1]
  v_pk_fma_f32 v[238:239], v[238:239], v[102:103], v[110:111] op_sel:[0,0,0] op_sel_hi:[1,0,1]
  v_pk_fma_f32 v[104:105], v[232:233], v[232:233], v[4:5] op_sel_hi:[1,1,0]
  v_pk_fma_f32 v[106:107], v[234:235], v[234:235], v[4:5] op_sel_hi:[1,1,0]
  v_pk_fma_f32 v[108:109], v[236:237], v[236:237], v[4:5] op_sel_hi:[1,1,0]
  v_pk_fma_f32 v[110:111], v[238:239], v[238:239], v[4:5] op_sel_hi:[1,1,0]
  v_pk_mul_f32 v[104:105], v[104:105], v[232:233] neg_lo:[0,1] neg_hi:[0,1]
  v_pk_mul_f32 v[106:107], v[106:107], v[234:235] neg_lo:[0,1] neg_hi:[0,1]
  v_pk_mul_f32 v[108:109], v[108:109], v[236:237] neg_lo:[0,1] neg_hi:[0,1]
  v_pk_mul_f32 v[110:111], v[110:111], v[238:239] neg_lo:[0,1] neg_hi:[0,1]
  v_exp_f32 v104, v104
  v_exp_f32 v105, v105
  v_exp_f32 v106, v106
  v_exp_f32 v107, v107
  v_exp_f32 v108, v108
  v_exp_f32 v109, v109
  v_exp_f32 v110, v110
  v_exp_f32 v111, v111
  v_pk_fma_f32 v[104:105], v[104:105], v[4:5], v[4:5] op_sel:[0,1,1] op_sel_hi:[1,1,1]
  v_pk_fma_f32 v[106:107], v[106:107], v[4:5], v[4:5] op_sel:[0,1,1] op_sel_hi:[1,1,1]
  v_pk_fma_f32 v[108:109], v[108:109], v[4:5], v[4:5] op_sel:[0,1,1] op_sel_hi:[1,1,1]
  v_pk_fma_f32 v[110:111], v[110:111], v[4:5], v[4:5] op_sel:[0,1,1] op_sel_hi:[1,1,1]
  v_rcp_f32 v104, v104
  v_rcp_f32 v105, v105
  v_rcp_f32 v106, v106
  v_rcp_f32 v107, v107
  v_rcp_f32 v108, v108
  v_rcp_f32 v109, v109
  v_rcp_f32 v110, v110
  v_rcp_f32 v111, v111
  v_pk_mul_f32 v[232:233], v[232:233], v[104:105]
  v_pk_mul_f32 v[234:235], v[234:235], v[106:107]
  v_pk_mul_f32 v[236:237], v[236:237], v[108:109]
  v_pk_mul_f32 v[238:239], v[238:239], v[110:111]
  v_cvt_pk_bf16_f32 v120, v232, v233
  v_cvt_pk_bf16_f32 v121, v234, v235
  v_cvt_pk_bf16_f32 v122, v236, v237
  v_cvt_pk_bf16_f32 v123, v238, v239
  s_add_u32 s9, s87, Lz1-Lz0+8
  s_waitcnt vmcnt(1)
  s_mov_b64 exec, 1
  ds_add_rtn_u32 v124, v28, v27 offset:0
  s_mov_b64 exec, -1
  v_permlane32_swap_b32 v120, v122
  v_permlane32_swap_b32_e64 v121, v123
  buffer_store_dwordx4 v[120:123], v6, s[40:43], s8 offen sc0 sc1
  v_pk_fma_f32 v[104:105], v[48:49], v[96:97], v[52:53] op_sel:[0,1,0] op_sel_hi:[1,1,1] neg_lo:[0,1,0] neg_hi:[0,1,0]
  v_pk_fma_f32 v[106:107], v[50:51], v[96:97], v[54:55] op_sel:[0,1,0] op_sel_hi:[1,1,1] neg_lo:[0,1,0] neg_hi:[0,1,0]
  v_pk_fma_f32 v[108:109], v[56:57], v[96:97], v[60:61] op_sel:[0,1,0] op_sel_hi:[1,1,1] neg_lo:[0,1,0] neg_hi:[0,1,0]
  v_pk_fma_f32 v[110:111], v[58:59], v[96:97], v[62:63] op_sel:[0,1,0] op_sel_hi:[1,1,1] neg_lo:[0,1,0] neg_hi:[0,1,0]
  v_pk_fma_f32 v[160:161], v[160:161], v[96:97], v[104:105] op_sel:[0,0,0] op_sel_hi:[1,0,1]
  v_pk_fma_f32 v[162:163], v[162:163], v[96:97], v[106:107] op_sel:[0,0,0] op_sel_hi:[1,0,1]
  v_pk_fma_f32 v[176:177], v[176:177], v[96:97], v[108:109] op_sel:[0,0,0] op_sel_hi:[1,0,1]
  v_pk_fma_f32 v[178:179], v[178:179], v[96:97], v[110:111] op_sel:[0,0,0] op_sel_hi:[1,0,1]
  v_pk_fma_f32 v[104:105], v[160:161], v[160:161], v[4:5] op_sel_hi:[1,1,0]
  v_pk_fma_f32 v[106:107], v[162:163], v[162:163], v[4:5] op_sel_hi:[1,1,0]
  v_pk_fma_f32 v[108:109], v[176:177], v[176:177], v[4:5] op_sel_hi:[1,1,0]
  v_pk_fma_f32 v[110:111], v[178:179], v[178:179], v[4:5] op_sel_hi:[1,1,0]
  v_pk_mul_f32 v[104:105], v[104:105], v[160:161] neg_lo:[0,1] neg_hi:[0,1]
  v_pk_mul_f32 v[106:107], v[106:107], v[162:163] neg_lo:[0,1] neg_hi:[0,1]
  v_pk_mul_f32 v[108:109], v[108:109], v[176:177] neg_lo:[0,1] neg_hi:[0,1]
  v_pk_mul_f32 v[110:111], v[110:111], v[178:179] neg_lo:[0,1] neg_hi:[0,1]
  v_exp_f32 v104, v104
  v_exp_f32 v105, v105
  v_exp_f32 v106, v106
  v_exp_f32 v107, v107
  v_exp_f32 v108, v108
  v_exp_f32 v109, v109
  v_exp_f32 v110, v110
  v_exp_f32 v111, v111
  v_pk_fma_f32 v[104:105], v[104:105], v[4:5], v[4:5] op_sel:[0,1,1] op_sel_hi:[1,1,1]
  v_pk_fma_f32 v[106:107], v[106:107], v[4:5], v[4:5] op_sel:[0,1,1] op_sel_hi:[1,1,1]
  v_pk_fma_f32 v[108:109], v[108:109], v[4:5], v[4:5] op_sel:[0,1,1] op_sel_hi:[1,1,1]
  v_pk_fma_f32 v[110:111], v[110:111], v[4:5], v[4:5] op_sel:[0,1,1] op_sel_hi:[1,1,1]
  v_rcp_f32 v104, v104
  v_rcp_f32 v105, v105
  v_rcp_f32 v106, v106
  v_rcp_f32 v107, v107
  v_rcp_f32 v108, v108
  v_rcp_f32 v109, v109
  v_rcp_f32 v110, v110
  v_rcp_f32 v111, v111
  v_pk_mul_f32 v[160:161], v[160:161], v[104:105]
  v_pk_mul_f32 v[162:163], v[162:163], v[106:107]
  v_pk_mul_f32 v[176:177], v[176:177], v[108:109]
  v_pk_mul_f32 v[178:179], v[178:179], v[110:111]
  v_cvt_pk_bf16_f32 v116, v160, v161
  v_cvt_pk_bf16_f32 v117, v162, v163
  v_cvt_pk_bf16_f32 v118, v176, v177
  v_cvt_pk_bf16_f32 v119, v178, v179
  s_waitcnt lgkmcnt(0)
  v_readfirstlane_b32 s4, v124
  s_and_b32 s4, s4, 3
  s_cmp_lg_u32 s4, 3
  s_cbranch_scc1 Ls_28
  s_mov_b32 exec_lo, s10
  s_mov_b32 exec_hi, 0
  buffer_store_dword v27, v24, s[40:43], s9 offen sc0 sc1
Ls_28:
  s_mov_b64 exec, -1
  buffer_store_dwordx4 v[116:119], v0, s[40:43], s6 offen offset:0 sc0 sc1
  ds_write_b128 v0, v[116:119] offset:16384
  v_pk_fma_f32 v[104:105], v[48:49], v[98:99], v[52:53] op_sel:[0,1,0] op_sel_hi:[1,1,1] neg_lo:[0,1,0] neg_hi:[0,1,0]
  v_pk_fma_f32 v[106:107], v[50:51], v[98:99], v[54:55] op_sel:[0,1,0] op_sel_hi:[1,1,1] neg_lo:[0,1,0] neg_hi:[0,1,0]
  v_pk_fma_f32 v[108:109], v[56:57], v[98:99], v[60:61] op_sel:[0,1,0] op_sel_hi:[1,1,1] neg_lo:[0,1,0] neg_hi:[0,1,0]
  v_pk_fma_f32 v[110:111], v[58:59], v[98:99], v[62:63] op_sel:[0,1,0] op_sel_hi:[1,1,1] neg_lo:[0,1,0] neg_hi:[0,1,0]
  v_pk_fma_f32 v[164:165], v[164:165], v[98:99], v[104:105] op_sel:[0,0,0] op_sel_hi:[1,0,1]
  v_pk_fma_f32 v[166:167], v[166:167], v[98:99], v[106:107] op_sel:[0,0,0] op_sel_hi:[1,0,1]
  v_pk_fma_f32 v[180:181], v[180:181], v[98:99], v[108:109] op_sel:[0,0,0] op_sel_hi:[1,0,1]
  v_pk_fma_f32 v[182:183], v[182:183], v[98:99], v[110:111] op_sel:[0,0,0] op_sel_hi:[1,0,1]
  v_pk_fma_f32 v[104:105], v[164:165], v[164:165], v[4:5] op_sel_hi:[1,1,0]
  v_pk_fma_f32 v[106:107], v[166:167], v[166:167], v[4:5] op_sel_hi:[1,1,0]
  v_pk_fma_f32 v[108:109], v[180:181], v[180:181], v[4:5] op_sel_hi:[1,1,0]
  v_pk_fma_f32 v[110:111], v[182:183], v[182:183], v[4:5] op_sel_hi:[1,1,0]
  v_pk_mul_f32 v[104:105], v[104:105], v[164:165] neg_lo:[0,1] neg_hi:[0,1]
  v_pk_mul_f32 v[106:107], v[106:107], v[166:167] neg_lo:[0,1] neg_hi:[0,1]
  v_pk_mul_f32 v[108:109], v[108:109], v[180:181] neg_lo:[0,1] neg_hi:[0,1]
  v_pk_mul_f32 v[110:111], v[110:111], v[182:183] neg_lo:[0,1] neg_hi:[0,1]
  v_exp_f32 v104, v104
  v_exp_f32 v105, v105
  v_exp_f32 v106, v106
  v_exp_f32 v107, v107
  v_exp_f32 v108, v108
  v_exp_f32 v109, v109
  v_exp_f32 v110, v110
  v_exp_f32 v111, v111
  v_pk_fma_f32 v[104:105], v[104:105], v[4:5], v[4:5] op_sel:[0,1,1] op_sel_hi:[1,1,1]
  v_pk_fma_f32 v[106:107], v[106:107], v[4:5], v[4:5] op_sel:[0,1,1] op_sel_hi:[1,1,1]
  v_pk_fma_f32 v[108:109], v[108:109], v[4:5], v[4:5] op_sel:[0,1,1] op_sel_hi:[1,1,1]
  v_pk_fma_f32 v[110:111], v[110:111], v[4:5], v[4:5] op_sel:[0,1,1] op_sel_hi:[1,1,1]
  v_rcp_f32 v104, v104
  v_rcp_f32 v105, v105
  v_rcp_f32 v106, v106
  v_rcp_f32 v107, v107
  v_rcp_f32 v108, v108
  v_rcp_f32 v109, v109
  v_rcp_f32 v110, v110
  v_rcp_f32 v111, v111
  v_pk_mul_f32 v[164:165], v[164:165], v[104:105]
  v_pk_mul_f32 v[166:167], v[166:167], v[106:107]
  v_pk_mul_f32 v[180:181], v[180:181], v[108:109]
  v_pk_mul_f32 v[182:183], v[182:183], v[110:111]
  v_cvt_pk_bf16_f32 v120, v164, v165
  v_cvt_pk_bf16_f32 v121, v166, v167
  v_cvt_pk_bf16_f32 v122, v180, v181
  v_cvt_pk_bf16_f32 v123, v182, v183
  buffer_store_dwordx4 v[120:123], v0, s[40:43], s6 offen offset:2048 sc0 sc1
  ds_write_b128 v0, v[120:123] offset:18432
  s_add_u32 s6, s6, 0x20000
  v_pk_fma_f32 v[104:105], v[48:49], v[100:101], v[52:53] op_sel:[0,1,0] op_sel_hi:[1,1,1] neg_lo:[0,1,0] neg_hi:[0,1,0]
  v_pk_fma_f32 v[106:107], v[50:51], v[100:101], v[54:55] op_sel:[0,1,0] op_sel_hi:[1,1,1] neg_lo:[0,1,0] neg_hi:[0,1,0]
  v_pk_fma_f32 v[108:109], v[56:57], v[100:101], v[60:61] op_sel:[0,1,0] op_sel_hi:[1,1,1] neg_lo:[0,1,0] neg_hi:[0,1,0]
  v_pk_fma_f32 v[110:111], v[58:59], v[100:101], v[62:63] op_sel:[0,1,0] op_sel_hi:[1,1,1] neg_lo:[0,1,0] neg_hi:[0,1,0]
  v_pk_fma_f32 v[168:169], v[168:169], v[100:101], v[104:105] op_sel:[0,0,0] op_sel_hi:[1,0,1]
  v_pk_fma_f32 v[170:171], v[170:171], v[100:101], v[106:107] op_sel:[0,0,0] op_sel_hi:[1,0,1]
  v_pk_fma_f32 v[184:185], v[184:185], v[100:101], v[108:109] op_sel:[0,0,0] op_sel_hi:[1,0,1]
  v_pk_fma_f32 v[186:187], v[186:187], v[100:101], v[110:111] op_sel:[0,0,0] op_sel_hi:[1,0,1]
  v_pk_fma_f32 v[104:105], v[168:169], v[168:169], v[4:5] op_sel_hi:[1,1,0]
  v_pk_fma_f32 v[106:107], v[170:171], v[170:171], v[4:5] op_sel_hi:[1,1,0]
  v_pk_fma_f32 v[108:109], v[184:185], v[184:185], v[4:5] op_sel_hi:[1,1,0]
  v_pk_fma_f32 v[110:111], v[186:187], v[186:187], v[4:5] op_sel_hi:[1,1,0]
  v_pk_mul_f32 v[104:105], v[104:105], v[168:169] neg_lo:[0,1] neg_hi:[0,1]
  v_pk_mul_f32 v[106:107], v[106:107], v[170:171] neg_lo:[0,1] neg_hi:[0,1]
  v_pk_mul_f32 v[108:109], v[108:109], v[184:185] neg_lo:[0,1] neg_hi:[0,1]
  v_pk_mul_f32 v[110:111], v[110:111], v[186:187] neg_lo:[0,1] neg_hi:[0,1]
  v_exp_f32 v104, v104
  v_exp_f32 v105, v105
  v_exp_f32 v106, v106
  v_exp_f32 v107, v107
  v_exp_f32 v108, v108
  v_exp_f32 v109, v109
  v_exp_f32 v110, v110
  v_exp_f32 v111, v111
  v_pk_fma_f32 v[104:105], v[104:105], v[4:5], v[4:5] op_sel:[0,1,1] op_sel_hi:[1,1,1]
  v_pk_fma_f32 v[106:107], v[106:107], v[4:5], v[4:5] op_sel:[0,1,1] op_sel_hi:[1,1,1]
  v_pk_fma_f32 v[108:109], v[108:109], v[4:5], v[4:5] op_sel:[0,1,1] op_sel_hi:[1,1,1]
  v_pk_fma_f32 v[110:111], v[110:111], v[4:5], v[4:5] op_sel:[0,1,1] op_sel_hi:[1,1,1]
  v_rcp_f32 v104, v104
  v_rcp_f32 v105, v105
  v_rcp_f32 v106, v106
  v_rcp_f32 v107, v107
  v_rcp_f32 v108, v108
  v_rcp_f32 v109, v109
  v_rcp_f32 v110, v110
  v_rcp_f32 v111, v111
  v_pk_mul_f32 v[168:169], v[168:169], v[104:105]
  v_pk_mul_f32 v[170:171], v[170:171], v[106:107]
  v_pk_mul_f32 v[184:185], v[184:185], v[108:109]
  v_pk_mul_f32 v[186:187], v[186:187], v[110:111]
  v_cvt_pk_bf16_f32 v116, v168, v169
  v_cvt_pk_bf16_f32 v117, v170, v171
  v_cvt_pk_bf16_f32 v118, v184, v185
  v_cvt_pk_bf16_f32 v119, v186, v187
  buffer_store_dwordx4 v[116:119], v0, s[40:43], s7 offen offset:0 sc0 sc1
  ds_write_b128 v0, v[116:119] offset:20480
  v_pk_fma_f32 v[104:105], v[48:49], v[102:103], v[52:53] op_sel:[0,1,0] op_sel_hi:[1,1,1] neg_lo:[0,1,0] neg_hi:[0,1,0]
  v_pk_fma_f32 v[106:107], v[50:51], v[102:103], v[54:55] op_sel:[0,1,0] op_sel_hi:[1,1,1] neg_lo:[0,1,0] neg_hi:[0,1,0]
  v_pk_fma_f32 v[108:109], v[56:57], v[102:103], v[60:61] op_sel:[0,1,0] op_sel_hi:[1,1,1] neg_lo:[0,1,0] neg_hi:[0,1,0]
  v_pk_fma_f32 v[110:111], v[58:59], v[102:103], v[62:63] op_sel:[0,1,0] op_sel_hi:[1,1,1] neg_lo:[0,1,0] neg_hi:[0,1,0]
  v_pk_fma_f32 v[172:173], v[172:173], v[102:103], v[104:105] op_sel:[0,0,0] op_sel_hi:[1,0,1]
  v_pk_fma_f32 v[174:175], v[174:175], v[102:103], v[106:107] op_sel:[0,0,0] op_sel_hi:[1,0,1]
  v_pk_fma_f32 v[188:189], v[188:189], v[102:103], v[108:109] op_sel:[0,0,0] op_sel_hi:[1,0,1]
  v_pk_fma_f32 v[190:191], v[190:191], v[102:103], v[110:111] op_sel:[0,0,0] op_sel_hi:[1,0,1]
  v_pk_fma_f32 v[104:105], v[172:173], v[172:173], v[4:5] op_sel_hi:[1,1,0]
  v_pk_fma_f32 v[106:107], v[174:175], v[174:175], v[4:5] op_sel_hi:[1,1,0]
  v_pk_fma_f32 v[108:109], v[188:189], v[188:189], v[4:5] op_sel_hi:[1,1,0]
  v_pk_fma_f32 v[110:111], v[190:191], v[190:191], v[4:5] op_sel_hi:[1,1,0]
  v_pk_mul_f32 v[104:105], v[104:105], v[172:173] neg_lo:[0,1] neg_hi:[0,1]
  v_pk_mul_f32 v[106:107], v[106:107], v[174:175] neg_lo:[0,1] neg_hi:[0,1]
  v_pk_mul_f32 v[108:109], v[108:109], v[188:189] neg_lo:[0,1] neg_hi:[0,1]
  v_pk_mul_f32 v[110:111], v[110:111], v[190:191] neg_lo:[0,1] neg_hi:[0,1]
  v_exp_f32 v104, v104
  v_exp_f32 v105, v105
  v_exp_f32 v106, v106
  v_exp_f32 v107, v107
  v_exp_f32 v108, v108
  v_exp_f32 v109, v109
  v_exp_f32 v110, v110
  v_exp_f32 v111, v111
  v_pk_fma_f32 v[104:105], v[104:105], v[4:5], v[4:5] op_sel:[0,1,1] op_sel_hi:[1,1,1]
  v_pk_fma_f32 v[106:107], v[106:107], v[4:5], v[4:5] op_sel:[0,1,1] op_sel_hi:[1,1,1]
  v_pk_fma_f32 v[108:109], v[108:109], v[4:5], v[4:5] op_sel:[0,1,1] op_sel_hi:[1,1,1]
  v_pk_fma_f32 v[110:111], v[110:111], v[4:5], v[4:5] op_sel:[0,1,1] op_sel_hi:[1,1,1]
  v_rcp_f32 v104, v104
  v_rcp_f32 v105, v105
  v_rcp_f32 v106, v106
  v_rcp_f32 v107, v107
  v_rcp_f32 v108, v108
  v_rcp_f32 v109, v109
  v_rcp_f32 v110, v110
  v_rcp_f32 v111, v111
  v_pk_mul_f32 v[172:173], v[172:173], v[104:105]
  v_pk_mul_f32 v[174:175], v[174:175], v[106:107]
  v_pk_mul_f32 v[188:189], v[188:189], v[108:109]
  v_pk_mul_f32 v[190:191], v[190:191], v[110:111]
  v_cvt_pk_bf16_f32 v120, v172, v173
  v_cvt_pk_bf16_f32 v121, v174, v175
  v_cvt_pk_bf16_f32 v122, v188, v189
  v_cvt_pk_bf16_f32 v123, v190, v191
  buffer_store_dwordx4 v[120:123], v0, s[40:43], s7 offen offset:2048 sc0 sc1
  ds_write_b128 v0, v[120:123] offset:22528
  s_add_u32 s7, s7, 0x20000
  v_pk_fma_f32 v[104:105], v[64:65], v[96:97], v[68:69] op_sel:[0,1,0] op_sel_hi:[1,1,1] neg_lo:[0,1,0] neg_hi:[0,1,0]
  v_pk_fma_f32 v[106:107], v[66:67], v[96:97], v[70:71] op_sel:[0,1,0] op_sel_hi:[1,1,1] neg_lo:[0,1,0] neg_hi:[0,1,0]
  v_pk_fma_f32 v[108:109], v[72:73], v[96:97], v[76:77] op_sel:[0,1,0] op_sel_hi:[1,1,1] neg_lo:[0,1,0] neg_hi:[0,1,0]
  v_pk_fma_f32 v[110:111], v[74:75], v[96:97], v[78:79] op_sel:[0,1,0] op_sel_hi:[1,1,1] neg_lo:[0,1,0] neg_hi:[0,1,0]
  v_pk_fma_f32 v[192:193], v[192:193], v[96:97], v[104:105] op_sel:[0,0,0] op_sel_hi:[1,0,1]
  v_pk_fma_f32 v[194:195], v[194:195], v[96:97], v[106:107] op_sel:[0,0,0] op_sel_hi:[1,0,1]
  v_pk_fma_f32 v[208:209], v[208:209], v[96:97], v[108:109] op_sel:[0,0,0] op_sel_hi:[1,0,1]
  v_pk_fma_f32 v[210:211], v[210:211], v[96:97], v[110:111] op_sel:[0,0,0] op_sel_hi:[1,0,1]
  v_pk_fma_f32 v[104:105], v[192:193], v[192:193], v[4:5] op_sel_hi:[1,1,0]
  v_pk_fma_f32 v[106:107], v[194:195], v[194:195], v[4:5] op_sel_hi:[1,1,0]
  v_pk_fma_f32 v[108:109], v[208:209], v[208:209], v[4:5] op_sel_hi:[1,1,0]
  v_pk_fma_f32 v[110:111], v[210:211], v[210:211], v[4:5] op_sel_hi:[1,1,0]
  v_pk_mul_f32 v[104:105], v[104:105], v[192:193] neg_lo:[0,1] neg_hi:[0,1]
  v_pk_mul_f32 v[106:107], v[106:107], v[194:195] neg_lo:[0,1] neg_hi:[0,1]
  v_pk_mul_f32 v[108:109], v[108:109], v[208:209] neg_lo:[0,1] neg_hi:[0,1]
  v_pk_mul_f32 v[110:111], v[110:111], v[210:211] neg_lo:[0,1] neg_hi:[0,1]
  v_exp_f32 v104, v104
  v_exp_f32 v105, v105
  v_exp_f32 v106, v106
  v_exp_f32 v107, v107
  v_exp_f32 v108, v108
  v_exp_f32 v109, v109
  v_exp_f32 v110, v110
  v_exp_f32 v111, v111
  v_pk_fma_f32 v[104:105], v[104:105], v[4:5], v[4:5] op_sel:[0,1,1] op_sel_hi:[1,1,1]
  v_pk_fma_f32 v[106:107], v[106:107], v[4:5], v[4:5] op_sel:[0,1,1] op_sel_hi:[1,1,1]
  v_pk_fma_f32 v[108:109], v[108:109], v[4:5], v[4:5] op_sel:[0,1,1] op_sel_hi:[1,1,1]
  v_pk_fma_f32 v[110:111], v[110:111], v[4:5], v[4:5] op_sel:[0,1,1] op_sel_hi:[1,1,1]
  v_rcp_f32 v104, v104
  v_rcp_f32 v105, v105
  v_rcp_f32 v106, v106
  v_rcp_f32 v107, v107
  v_rcp_f32 v108, v108
  v_rcp_f32 v109, v109
  v_rcp_f32 v110, v110
  v_rcp_f32 v111, v111
  v_pk_mul_f32 v[192:193], v[192:193], v[104:105]
  v_pk_mul_f32 v[194:195], v[194:195], v[106:107]
  v_pk_mul_f32 v[208:209], v[208:209], v[108:109]
  v_pk_mul_f32 v[210:211], v[210:211], v[110:111]
  v_cvt_pk_bf16_f32 v116, v192, v193
  v_cvt_pk_bf16_f32 v117, v194, v195
  v_cvt_pk_bf16_f32 v118, v208, v209
  v_cvt_pk_bf16_f32 v119, v210, v211
  buffer_store_dwordx4 v[116:119], v0, s[40:43], s6 offen offset:0 sc0 sc1
  ds_write_b128 v0, v[116:119] offset:32768
  v_pk_fma_f32 v[104:105], v[64:65], v[98:99], v[68:69] op_sel:[0,1,0] op_sel_hi:[1,1,1] neg_lo:[0,1,0] neg_hi:[0,1,0]
  v_pk_fma_f32 v[106:107], v[66:67], v[98:99], v[70:71] op_sel:[0,1,0] op_sel_hi:[1,1,1] neg_lo:[0,1,0] neg_hi:[0,1,0]
  v_pk_fma_f32 v[108:109], v[72:73], v[98:99], v[76:77] op_sel:[0,1,0] op_sel_hi:[1,1,1] neg_lo:[0,1,0] neg_hi:[0,1,0]
  v_pk_fma_f32 v[110:111], v[74:75], v[98:99], v[78:79] op_sel:[0,1,0] op_sel_hi:[1,1,1] neg_lo:[0,1,0] neg_hi:[0,1,0]
  v_pk_fma_f32 v[196:197], v[196:197], v[98:99], v[104:105] op_sel:[0,0,0] op_sel_hi:[1,0,1]
  v_pk_fma_f32 v[198:199], v[198:199], v[98:99], v[106:107] op_sel:[0,0,0] op_sel_hi:[1,0,1]
  v_pk_fma_f32 v[212:213], v[212:213], v[98:99], v[108:109] op_sel:[0,0,0] op_sel_hi:[1,0,1]
  v_pk_fma_f32 v[214:215], v[214:215], v[98:99], v[110:111] op_sel:[0,0,0] op_sel_hi:[1,0,1]
  v_pk_fma_f32 v[104:105], v[196:197], v[196:197], v[4:5] op_sel_hi:[1,1,0]
  v_pk_fma_f32 v[106:107], v[198:199], v[198:199], v[4:5] op_sel_hi:[1,1,0]
  v_pk_fma_f32 v[108:109], v[212:213], v[212:213], v[4:5] op_sel_hi:[1,1,0]
  v_pk_fma_f32 v[110:111], v[214:215], v[214:215], v[4:5] op_sel_hi:[1,1,0]
  v_pk_mul_f32 v[104:105], v[104:105], v[196:197] neg_lo:[0,1] neg_hi:[0,1]
  v_pk_mul_f32 v[106:107], v[106:107], v[198:199] neg_lo:[0,1] neg_hi:[0,1]
  v_pk_mul_f32 v[108:109], v[108:109], v[212:213] neg_lo:[0,1] neg_hi:[0,1]
  v_pk_mul_f32 v[110:111], v[110:111], v[214:215] neg_lo:[0,1] neg_hi:[0,1]
  v_exp_f32 v104, v104
  v_exp_f32 v105, v105
  v_exp_f32 v106, v106
  v_exp_f32 v107, v107
  v_exp_f32 v108, v108
  v_exp_f32 v109, v109
  v_exp_f32 v110, v110
  v_exp_f32 v111, v111
  v_pk_fma_f32 v[104:105], v[104:105], v[4:5], v[4:5] op_sel:[0,1,1] op_sel_hi:[1,1,1]
  v_pk_fma_f32 v[106:107], v[106:107], v[4:5], v[4:5] op_sel:[0,1,1] op_sel_hi:[1,1,1]
  v_pk_fma_f32 v[108:109], v[108:109], v[4:5], v[4:5] op_sel:[0,1,1] op_sel_hi:[1,1,1]
  v_pk_fma_f32 v[110:111], v[110:111], v[4:5], v[4:5] op_sel:[0,1,1] op_sel_hi:[1,1,1]
  v_rcp_f32 v104, v104
  v_rcp_f32 v105, v105
  v_rcp_f32 v106, v106
  v_rcp_f32 v107, v107
  v_rcp_f32 v108, v108
  v_rcp_f32 v109, v109
  v_rcp_f32 v110, v110
  v_rcp_f32 v111, v111
  v_pk_mul_f32 v[196:197], v[196:197], v[104:105]
  v_pk_mul_f32 v[198:199], v[198:199], v[106:107]
  v_pk_mul_f32 v[212:213], v[212:213], v[108:109]
  v_pk_mul_f32 v[214:215], v[214:215], v[110:111]
  v_cvt_pk_bf16_f32 v120, v196, v197
  v_cvt_pk_bf16_f32 v121, v198, v199
  v_cvt_pk_bf16_f32 v122, v212, v213
  v_cvt_pk_bf16_f32 v123, v214, v215
  buffer_store_dwordx4 v[120:123], v0, s[40:43], s6 offen offset:2048 sc0 sc1
  ds_write_b128 v0, v[120:123] offset:34816
  v_pk_fma_f32 v[104:105], v[64:65], v[100:101], v[68:69] op_sel:[0,1,0] op_sel_hi:[1,1,1] neg_lo:[0,1,0] neg_hi:[0,1,0]
  v_pk_fma_f32 v[106:107], v[66:67], v[100:101], v[70:71] op_sel:[0,1,0] op_sel_hi:[1,1,1] neg_lo:[0,1,0] neg_hi:[0,1,0]
  v_pk_fma_f32 v[108:109], v[72:73], v[100:101], v[76:77] op_sel:[0,1,0] op_sel_hi:[1,1,1] neg_lo:[0,1,0] neg_hi:[0,1,0]
  v_pk_fma_f32 v[110:111], v[74:75], v[100:101], v[78:79] op_sel:[0,1,0] op_sel_hi:[1,1,1] neg_lo:[0,1,0] neg_hi:[0,1,0]
  v_pk_fma_f32 v[200:201], v[200:201], v[100:101], v[104:105] op_sel:[0,0,0] op_sel_hi:[1,0,1]
  v_pk_fma_f32 v[202:203], v[202:203], v[100:101], v[106:107] op_sel:[0,0,0] op_sel_hi:[1,0,1]
  v_pk_fma_f32 v[216:217], v[216:217], v[100:101], v[108:109] op_sel:[0,0,0] op_sel_hi:[1,0,1]
  v_pk_fma_f32 v[218:219], v[218:219], v[100:101], v[110:111] op_sel:[0,0,0] op_sel_hi:[1,0,1]
  v_pk_fma_f32 v[104:105], v[200:201], v[200:201], v[4:5] op_sel_hi:[1,1,0]
  v_pk_fma_f32 v[106:107], v[202:203], v[202:203], v[4:5] op_sel_hi:[1,1,0]
  v_pk_fma_f32 v[108:109], v[216:217], v[216:217], v[4:5] op_sel_hi:[1,1,0]
  v_pk_fma_f32 v[110:111], v[218:219], v[218:219], v[4:5] op_sel_hi:[1,1,0]
  v_pk_mul_f32 v[104:105], v[104:105], v[200:201] neg_lo:[0,1] neg_hi:[0,1]
  v_pk_mul_f32 v[106:107], v[106:107], v[202:203] neg_lo:[0,1] neg_hi:[0,1]
  v_pk_mul_f32 v[108:109], v[108:109], v[216:217] neg_lo:[0,1] neg_hi:[0,1]
  v_pk_mul_f32 v[110:111], v[110:111], v[218:219] neg_lo:[0,1] neg_hi:[0,1]
  v_exp_f32 v104, v104
  v_exp_f32 v105, v105
  v_exp_f32 v106, v106
  v_exp_f32 v107, v107
  v_exp_f32 v108, v108
  v_exp_f32 v109, v109
  v_exp_f32 v110, v110
  v_exp_f32 v111, v111
  v_pk_fma_f32 v[104:105], v[104:105], v[4:5], v[4:5] op_sel:[0,1,1] op_sel_hi:[1,1,1]
  v_pk_fma_f32 v[106:107], v[106:107], v[4:5], v[4:5] op_sel:[0,1,1] op_sel_hi:[1,1,1]
  v_pk_fma_f32 v[108:109], v[108:109], v[4:5], v[4:5] op_sel:[0,1,1] op_sel_hi:[1,1,1]
  v_pk_fma_f32 v[110:111], v[110:111], v[4:5], v[4:5] op_sel:[0,1,1] op_sel_hi:[1,1,1]
  v_rcp_f32 v104, v104
  v_rcp_f32 v105, v105
  v_rcp_f32 v106, v106
  v_rcp_f32 v107, v107
  v_rcp_f32 v108, v108
  v_rcp_f32 v109, v109
  v_rcp_f32 v110, v110
  v_rcp_f32 v111, v111
  v_pk_mul_f32 v[200:201], v[200:201], v[104:105]
  v_pk_mul_f32 v[202:203], v[202:203], v[106:107]
  v_pk_mul_f32 v[216:217], v[216:217], v[108:109]
  v_pk_mul_f32 v[218:219], v[218:219], v[110:111]
  v_cvt_pk_bf16_f32 v116, v200, v201
  v_cvt_pk_bf16_f32 v117, v202, v203
  v_cvt_pk_bf16_f32 v118, v216, v217
  v_cvt_pk_bf16_f32 v119, v218, v219
  buffer_store_dwordx4 v[116:119], v0, s[40:43], s7 offen offset:0 sc0 sc1
  ds_write_b128 v0, v[116:119] offset:36864
  s_lshl_b32 s5, s86, Lz1-Lz0+7
  s_add_u32 s5, s5, 156160
  v_add_u32_e64 v3, s5, v29
  ds_read_b128 v[232:235], v3
  ds_read_b128 v[236:239], v3 offset:64
  v_pk_fma_f32 v[104:105], v[64:65], v[102:103], v[68:69] op_sel:[0,1,0] op_sel_hi:[1,1,1] neg_lo:[0,1,0] neg_hi:[0,1,0]
  v_pk_fma_f32 v[106:107], v[66:67], v[102:103], v[70:71] op_sel:[0,1,0] op_sel_hi:[1,1,1] neg_lo:[0,1,0] neg_hi:[0,1,0]
  v_pk_fma_f32 v[108:109], v[72:73], v[102:103], v[76:77] op_sel:[0,1,0] op_sel_hi:[1,1,1] neg_lo:[0,1,0] neg_hi:[0,1,0]
  v_pk_fma_f32 v[110:111], v[74:75], v[102:103], v[78:79] op_sel:[0,1,0] op_sel_hi:[1,1,1] neg_lo:[0,1,0] neg_hi:[0,1,0]
  v_pk_fma_f32 v[204:205], v[204:205], v[102:103], v[104:105] op_sel:[0,0,0] op_sel_hi:[1,0,1]
  v_pk_fma_f32 v[206:207], v[206:207], v[102:103], v[106:107] op_sel:[0,0,0] op_sel_hi:[1,0,1]
  v_pk_fma_f32 v[220:221], v[220:221], v[102:103], v[108:109] op_sel:[0,0,0] op_sel_hi:[1,0,1]
  v_pk_fma_f32 v[222:223], v[222:223], v[102:103], v[110:111] op_sel:[0,0,0] op_sel_hi:[1,0,1]
  v_pk_fma_f32 v[104:105], v[204:205], v[204:205], v[4:5] op_sel_hi:[1,1,0]
  v_pk_fma_f32 v[106:107], v[206:207], v[206:207], v[4:5] op_sel_hi:[1,1,0]
  v_pk_fma_f32 v[108:109], v[220:221], v[220:221], v[4:5] op_sel_hi:[1,1,0]
  v_pk_fma_f32 v[110:111], v[222:223], v[222:223], v[4:5] op_sel_hi:[1,1,0]
  v_pk_mul_f32 v[104:105], v[104:105], v[204:205] neg_lo:[0,1] neg_hi:[0,1]
  v_pk_mul_f32 v[106:107], v[106:107], v[206:207] neg_lo:[0,1] neg_hi:[0,1]
  v_pk_mul_f32 v[108:109], v[108:109], v[220:221] neg_lo:[0,1] neg_hi:[0,1]
  v_pk_mul_f32 v[110:111], v[110:111], v[222:223] neg_lo:[0,1] neg_hi:[0,1]
  v_exp_f32 v104, v104
  v_exp_f32 v105, v105
  v_exp_f32 v106, v106
  v_exp_f32 v107, v107
  v_exp_f32 v108, v108
  v_exp_f32 v109, v109
  v_exp_f32 v110, v110
  v_exp_f32 v111, v111
  v_pk_fma_f32 v[104:105], v[104:105], v[4:5], v[4:5] op_sel:[0,1,1] op_sel_hi:[1,1,1]
  v_pk_fma_f32 v[106:107], v[106:107], v[4:5], v[4:5] op_sel:[0,1,1] op_sel_hi:[1,1,1]
  v_pk_fma_f32 v[108:109], v[108:109], v[4:5], v[4:5] op_sel:[0,1,1] op_sel_hi:[1,1,1]
  v_pk_fma_f32 v[110:111], v[110:111], v[4:5], v[4:5] op_sel:[0,1,1] op_sel_hi:[1,1,1]
  v_rcp_f32 v104, v104
  v_rcp_f32 v105, v105
  v_rcp_f32 v106, v106
  v_rcp_f32 v107, v107
  v_rcp_f32 v108, v108
  v_rcp_f32 v109, v109
  v_rcp_f32 v110, v110
  v_rcp_f32 v111, v111
  v_pk_mul_f32 v[204:205], v[204:205], v[104:105]
  v_pk_mul_f32 v[206:207], v[206:207], v[106:107]
  v_pk_mul_f32 v[220:221], v[220:221], v[108:109]
  v_pk_mul_f32 v[222:223], v[222:223], v[110:111]
  v_cvt_pk_bf16_f32 v120, v204, v205
  v_cvt_pk_bf16_f32 v121, v206, v207
  v_cvt_pk_bf16_f32 v122, v220, v221
  v_cvt_pk_bf16_f32 v123, v222, v223
  buffer_store_dwordx4 v[120:123], v0, s[40:43], s7 offen offset:2048 sc0 sc1
  ds_write_b128 v0, v[120:123] offset:38912
  s_mov_b32 s16, Lz1-Lz0+0
  s_mov_b32 s17, 16384
  s_mov_b32 s18, 0xffff4000
  s_mov_b32 s19, 49152
  s_mov_b32 s20, 16384
  s_mov_b32 s21, 0xffff0000
  s_mul_i32 s4, s85, 8192
  v_add_u32_e64 v4, s4, v11
  v_add_u32 v5, 1024, v4
  s_lshl_b32 s4, s86, 1
  v_xor_b32 v2, s4, v26
  v_lshl_add_u32 v6, v2, 5, v25
  v_add_u32 v6, s19, v6
  s_add_u32 s4, s4, 1
  v_xor_b32_e64 v2, s4, v26
  v_lshl_add_u32 v7, v2, 5, v25
  v_add_u32 v7, s19, v7
  s_mov_b32 s22, 12
  s_waitcnt lgkmcnt(0)
  s_barrier
  ds_read_b64_tr_b16 v[48:49], v6 offset:0
  v_and_b32 v2, 15, v1
  v_lshrrev_b32 v3, 2, v29
  ds_read_b64_tr_b16 v[50:51], v6 offset:2048
  v_sub_u32 v2, v2, v3
  v_mov_b64 v[224:225], 0
  ds_read_b128 v[32:35], v4 offset:0
  v_lshlrev_b32_e64 v2, 4, v2
  v_mov_b32 v226, 0x3f80
  ds_read_b128 v[36:39], v4 offset:2048
  v_cmp_gt_u32 vcc, 64, v2
  v_mov_b32 v227, 0
  ds_read_b128 v[40:43], v4 offset:4096
  v_cndmask_b32 v226, 0, v226, vcc
  v_mov_b64 v[228:229], 0
  ds_read_b128 v[44:47], v4 offset:6144
  v_lshlrev_b64 v[226:227], v2, v[226:227]
  v_mov_b64_e64 v[160:161], 0
  ds_read_b64_tr_b16 v[52:53], v7 offset:0
  v_mov_b64 v[162:163], 0
  v_mov_b64 v[164:165], 0
  ds_read_b64_tr_b16 v[54:55], v7 offset:2048
  v_mov_b64 v[166:167], 0
  v_mov_b64 v[168:169], 0
  ds_read_b64_tr_b16 v[56:57], v6 offset:8192
  v_mov_b64 v[170:171], 0
  v_mov_b64 v[172:173], 0
  ds_read_b64_tr_b16 v[58:59], v6 offset:10240
  v_mov_b64 v[174:175], 0
  v_mov_b64 v[176:177], 0
  ds_read_b64_tr_b16 v[60:61], v7 offset:8192
  v_mov_b64 v[178:179], 0
  v_mov_b64 v[180:181], 0
  ds_read_b64_tr_b16 v[62:63], v7 offset:10240
  v_mov_b64 v[182:183], 0
  v_mov_b64 v[184:185], 0
  ds_read_b64_tr_b16 v[80:81], v6 offset:4096
  v_mov_b64_e64 v[186:187], 0
  v_mov_b64 v[188:189], 0
  s_waitcnt lgkmcnt(4)
  ds_read_b64_tr_b16 v[82:83], v6 offset:6144
  v_mov_b64_e64 v[190:191], 0
  v_mfma_f32_16x16x32_bf16 v[128:131], v[226:229], v[240:243], v[232:235]
  ds_read_b128 v[64:67], v5 offset:0
  s_lshl_b32 s4, s76, 4
  s_add_u32 s4, s4, s78
  ds_read_b128 v[68:71], v5 offset:2048
  v_mfma_f32_16x16x32_bf16 v[132:135], v[224:227], v[240:243], v[236:239]
  s_lshl_b32 s8, s4, Lz1-Lz0+14
  ds_read_b128 v[72:75], v5 offset:4096
  s_xor_b32 s6, s8, 16384
  v_mfma_f32_16x16x32_bf16 v[136:139], v[226:229], v[244:247], v[232:235]
  ds_read_b128 v[76:79], v5 offset:6144
  s_add_u32 s8, s8, 7340032
  s_add_u32 s6, s6, 7340032
  ds_read_b64_tr_b16 v[84:85], v7 offset:4096
  v_mfma_f32_16x16x32_bf16 v[140:143], v[224:227], v[244:247], v[236:239]
  s_add_u32 s7, s6, 4096
  ds_read_b64_tr_b16 v[86:87], v7 offset:6144
  s_add_u32 s9, s8, 4096
  v_mfma_f32_16x16x32_bf16 v[144:147], v[226:229], v[248:251], v[232:235]
  ds_read_b64_tr_b16 v[88:89], v6 offset:12288
  s_lshl_b32 s4, s81, 7
  s_add_u32 s4, s4, s87
  ds_read_b64_tr_b16 v[90:91], v6 offset:14336
  v_mfma_f32_16x16x32_bf16 v[148:151], v[224:227], v[248:251], v[236:239]
  s_add_u32 s4, s4, Lz1-Lz0+12
  ds_read_b64_tr_b16 v[92:93], v7 offset:12288
  s_lshl_b32 s13, s84, Lz1-Lz0+1
  v_mfma_f32_16x16x32_bf16 v[152:155], v[226:229], v[252:255], v[232:235]
  ds_read_b64_tr_b16 v[94:95], v7 offset:14336
  s_xor_b32 s14, s13, 32768
  s_nop 0
  s_add_u32 s13, s13, s4
  v_mfma_f32_16x16x32_bf16 v[156:159], v[224:227], v[252:255], v[236:239]
  s_add_u32 s14, s14, s4
  s_add_u32 s16, s16, s17
  s_cmp_eq_u32 s16, 65536
  s_cselect_b32 s23, s18, s17
  s_cselect_b32 s16, 0, s16
  v_add_u32_e64 v4, s23, v4
  v_add_u32 v5, s23, v5
  s_add_u32 s19, s19, s20
  s_cmp_eq_u32 s19, 81920
  s_cselect_b32 s23, s21, s20
  s_cselect_b32 s19, 0, s19
  v_add_u32 v6, s23, v6
  v_add_u32 v7, s23, v7
  s_waitcnt lgkmcnt(0)
Lk_29:
  s_barrier
  v_mfma_f32_16x16x32_bf16 v[128:131], v[48:51], v[32:35], v[128:131]
  ds_read_b64_tr_b16 v[112:113], v6 offset:0
  v_mfma_f32_16x16x32_bf16 v[128:131], v[80:83], v[64:67], v[128:131]
  ds_read_b64_tr_b16 v[114:115], v6 offset:2048
  v_mfma_f32_16x16x32_bf16 v[136:139], v[80:83], v[68:71], v[136:139]
  ds_read_b128 v[96:99], v4 offset:0
  v_mfma_f32_16x16x32_bf16 v[136:139], v[48:51], v[36:39], v[136:139]
  ds_read_b128 v[100:103], v4 offset:2048
  v_mfma_f32_16x16x32_bf16 v[144:147], v[48:51], v[40:43], v[144:147]
  ds_read_b128 v[104:107], v4 offset:4096
  v_mfma_f32_16x16x32_bf16 v[144:147], v[80:83], v[72:75], v[144:147]
  ds_read_b128 v[108:111], v4 offset:6144
  v_mfma_f32_16x16x32_bf16 v[152:155], v[80:83], v[76:79], v[152:155]
  ds_read_b64_tr_b16 v[116:117], v7 offset:0
  v_mfma_f32_16x16x32_bf16 v[152:155], v[48:51], v[44:47], v[152:155]
  ds_read_b64_tr_b16 v[118:119], v7 offset:2048
  v_mfma_f32_16x16x32_bf16 v[156:159], v[52:55], v[44:47], v[156:159]
  ds_read_b64_tr_b16 v[120:121], v6 offset:8192
  v_mfma_f32_16x16x32_bf16 v[156:159], v[84:87], v[76:79], v[156:159]
  ds_read_b64_tr_b16 v[122:123], v6 offset:10240
  v_mfma_f32_16x16x32_bf16 v[148:151], v[84:87], v[72:75], v[148:151]
  ds_read_b64_tr_b16 v[124:125], v7 offset:8192
  v_mfma_f32_16x16x32_bf16 v[148:151], v[52:55], v[40:43], v[148:151]
  ds_read_b64_tr_b16 v[126:127], v7 offset:10240
  v_mfma_f32_16x16x32_bf16 v[140:143], v[52:55], v[36:39], v[140:143]
  ds_read_b64_tr_b16 v[208:209], v6 offset:4096
  v_mfma_f32_16x16x32_bf16 v[140:143], v[84:87], v[68:71], v[140:143]
  ds_read_b64_tr_b16 v[210:211], v6 offset:6144
  v_mfma_f32_16x16x32_bf16 v[132:135], v[84:87], v[64:67], v[132:135]
  ds_read_b128 v[192:195], v5 offset:0
  v_mfma_f32_16x16x32_bf16 v[132:135], v[52:55], v[32:35], v[132:135]
  ds_read_b128 v[196:199], v5 offset:2048
  v_mfma_f32_16x16x32_bf16 v[160:163], v[56:59], v[32:35], v[160:163]
  ds_read_b128 v[200:203], v5 offset:4096
  v_mfma_f32_16x16x32_bf16 v[160:163], v[88:91], v[64:67], v[160:163]
  ds_read_b128 v[204:207], v5 offset:6144
  v_mfma_f32_16x16x32_bf16 v[168:171], v[88:91], v[68:71], v[168:171]
  ds_read_b64_tr_b16 v[212:213], v7 offset:4096
  v_mfma_f32_16x16x32_bf16 v[168:171], v[56:59], v[36:39], v[168:171]
  ds_read_b64_tr_b16 v[214:215], v7 offset:6144
  v_mfma_f32_16x16x32_bf16 v[176:179], v[56:59], v[40:43], v[176:179]
  ds_read_b64_tr_b16 v[216:217], v6 offset:12288
  v_mfma_f32_16x16x32_bf16 v[176:179], v[88:91], v[72:75], v[176:179]
  ds_read_b64_tr_b16 v[218:219], v6 offset:14336
  v_mfma_f32_16x16x32_bf16 v[184:187], v[88:91], v[76:79], v[184:187]
  ds_read_b64_tr_b16 v[220:221], v7 offset:12288
  v_mfma_f32_16x16x32_bf16 v[184:187], v[56:59], v[44:47], v[184:187]
  ds_read_b64_tr_b16 v[222:223], v7 offset:14336
  v_mfma_f32_16x16x32_bf16 v[188:191], v[60:63], v[44:47], v[188:191]
  s_add_u32 s16, s16, s17
  s_cmp_eq_u32 s16, 65536
  s_cselect_b32 s23, s18, s17
  v_mfma_f32_16x16x32_bf16 v[188:191], v[92:95], v[76:79], v[188:191]
  s_cselect_b32 s16, 0, s16
  v_add_u32 v4, s23, v4
  v_add_u32_e64 v5, s23, v5
  v_mfma_f32_16x16x32_bf16 v[180:183], v[92:95], v[72:75], v[180:183]
  s_add_u32 s19, s19, s20
  s_cmp_eq_u32 s19, 81920
  s_cselect_b32 s23, s21, s20
  v_mfma_f32_16x16x32_bf16 v[180:183], v[60:63], v[40:43], v[180:183]
  s_cselect_b32 s19, 0, s19
  v_add_u32 v6, s23, v6
  v_add_u32_e64 v7, s23, v7
  v_mfma_f32_16x16x32_bf16 v[172:175], v[60:63], v[36:39], v[172:175]
  v_mfma_f32_16x16x32_bf16 v[172:175], v[92:95], v[68:71], v[172:175]
  v_mfma_f32_16x16x32_bf16 v[164:167], v[92:95], v[64:67], v[164:167]
  s_nop 0
  s_waitcnt lgkmcnt(0)
  v_mfma_f32_16x16x32_bf16 v[164:167], v[60:63], v[32:35], v[164:167]
  s_waitcnt vmcnt(0)
  s_barrier
  v_mfma_f32_16x16x32_bf16 v[128:131], v[112:115], v[96:99], v[128:131]
  ds_read_b64_tr_b16 v[48:49], v6 offset:0
  v_mfma_f32_16x16x32_bf16 v[128:131], v[208:211], v[192:195], v[128:131]
  ds_read_b64_tr_b16 v[50:51], v6 offset:2048
  v_mfma_f32_16x16x32_bf16 v[136:139], v[208:211], v[196:199], v[136:139]
  ds_read_b128 v[32:35], v4 offset:0
  v_mfma_f32_16x16x32_bf16 v[136:139], v[112:115], v[100:103], v[136:139]
  ds_read_b128 v[36:39], v4 offset:2048
  v_mfma_f32_16x16x32_bf16 v[144:147], v[112:115], v[104:107], v[144:147]
  ds_read_b128 v[40:43], v4 offset:4096
  v_mfma_f32_16x16x32_bf16 v[144:147], v[208:211], v[200:203], v[144:147]
  ds_read_b128 v[44:47], v4 offset:6144
  v_mfma_f32_16x16x32_bf16 v[152:155], v[208:211], v[204:207], v[152:155]
  ds_read_b64_tr_b16 v[52:53], v7 offset:0
  v_mfma_f32_16x16x32_bf16 v[152:155], v[112:115], v[108:111], v[152:155]
  ds_read_b64_tr_b16 v[54:55], v7 offset:2048
  v_mfma_f32_16x16x32_bf16 v[156:159], v[116:119], v[108:111], v[156:159]
  ds_read_b64_tr_b16 v[56:57], v6 offset:8192
  v_mfma_f32_16x16x32_bf16 v[156:159], v[212:215], v[204:207], v[156:159]
  ds_read_b64_tr_b16 v[58:59], v6 offset:10240
  v_mfma_f32_16x16x32_bf16 v[148:151], v[212:215], v[200:203], v[148:151]
  ds_read_b64_tr_b16 v[60:61], v7 offset:8192
  v_mfma_f32_16x16x32_bf16 v[148:151], v[116:119], v[104:107], v[148:151]
  ds_read_b64_tr_b16 v[62:63], v7 offset:10240
  v_mfma_f32_16x16x32_bf16 v[140:143], v[116:119], v[100:103], v[140:143]
  ds_read_b64_tr_b16 v[80:81], v6 offset:4096
  v_mfma_f32_16x16x32_bf16 v[140:143], v[212:215], v[196:199], v[140:143]
  ds_read_b64_tr_b16 v[82:83], v6 offset:6144
  v_mfma_f32_16x16x32_bf16 v[132:135], v[212:215], v[192:195], v[132:135]
  ds_read_b128 v[64:67], v5 offset:0
  v_mfma_f32_16x16x32_bf16 v[132:135], v[116:119], v[96:99], v[132:135]
  ds_read_b128 v[68:71], v5 offset:2048
  v_mfma_f32_16x16x32_bf16 v[160:163], v[120:123], v[96:99], v[160:163]
  ds_read_b128 v[72:75], v5 offset:4096
  v_mfma_f32_16x16x32_bf16 v[160:163], v[216:219], v[192:195], v[160:163]
  ds_read_b128 v[76:79], v5 offset:6144
  v_mfma_f32_16x16x32_bf16 v[168:171], v[216:219], v[196:199], v[168:171]
  ds_read_b64_tr_b16 v[84:85], v7 offset:4096
  v_mfma_f32_16x16x32_bf16 v[168:171], v[120:123], v[100:103], v[168:171]
  ds_read_b64_tr_b16 v[86:87], v7 offset:6144
  v_mfma_f32_16x16x32_bf16 v[176:179], v[120:123], v[104:107], v[176:179]
  ds_read_b64_tr_b16 v[88:89], v6 offset:12288
  v_mfma_f32_16x16x32_bf16 v[176:179], v[216:219], v[200:203], v[176:179]
  ds_read_b64_tr_b16 v[90:91], v6 offset:14336
  v_mfma_f32_16x16x32_bf16 v[184:187], v[216:219], v[204:207], v[184:187]
  ds_read_b64_tr_b16 v[92:93], v7 offset:12288
  v_mfma_f32_16x16x32_bf16 v[184:187], v[120:123], v[108:111], v[184:187]
  ds_read_b64_tr_b16 v[94:95], v7 offset:14336
  v_mfma_f32_16x16x32_bf16 v[188:191], v[124:127], v[108:111], v[188:191]
  s_add_u32 s16, s16, s17
  s_cmp_eq_u32 s16, 65536
  s_cselect_b32 s23, s18, s17
  v_mfma_f32_16x16x32_bf16 v[188:191], v[220:223], v[204:207], v[188:191]
  s_cselect_b32 s16, 0, s16
  v_add_u32 v4, s23, v4
  v_add_u32_e64 v5, s23, v5
  v_mfma_f32_16x16x32_bf16 v[180:183], v[220:223], v[200:203], v[180:183]
  s_add_u32 s19, s19, s20
  s_cmp_eq_u32 s19, 81920
  s_cselect_b32 s23, s21, s20
  v_mfma_f32_16x16x32_bf16 v[180:183], v[124:127], v[104:107], v[180:183]
  s_cselect_b32 s19, 0, s19
  v_add_u32 v6, s23, v6
  v_add_u32_e64 v7, s23, v7
  v_mfma_f32_16x16x32_bf16 v[172:175], v[124:127], v[100:103], v[172:175]
  s_sub_u32 s22, s22, 1
  s_cmp_lg_u32 s22, 0
  v_mfma_f32_16x16x32_bf16 v[172:175], v[220:223], v[196:199], v[172:175]
  v_mfma_f32_16x16x32_bf16 v[164:167], v[220:223], v[192:195], v[164:167]
  s_nop 0
  s_waitcnt lgkmcnt(0)
  v_mfma_f32_16x16x32_bf16 v[164:167], v[124:127], v[96:99], v[164:167]
  s_cbranch_scc1 Lk_29
  s_barrier
  v_mfma_f32_16x16x32_bf16 v[128:131], v[48:51], v[32:35], v[128:131]
  ds_read_b64_tr_b16 v[112:113], v6 offset:0
  v_mfma_f32_16x16x32_bf16 v[128:131], v[80:83], v[64:67], v[128:131]
  ds_read_b64_tr_b16 v[114:115], v6 offset:2048
  v_mfma_f32_16x16x32_bf16 v[136:139], v[80:83], v[68:71], v[136:139]
  ds_read_b128 v[96:99], v4 offset:0
  v_mfma_f32_16x16x32_bf16 v[136:139], v[48:51], v[36:39], v[136:139]
  ds_read_b128 v[100:103], v4 offset:2048
  v_mfma_f32_16x16x32_bf16 v[144:147], v[48:51], v[40:43], v[144:147]
  ds_read_b128 v[104:107], v4 offset:4096
  v_mfma_f32_16x16x32_bf16 v[144:147], v[80:83], v[72:75], v[144:147]
  ds_read_b128 v[108:111], v4 offset:6144
  v_mfma_f32_16x16x32_bf16 v[152:155], v[80:83], v[76:79], v[152:155]
  ds_read_b64_tr_b16 v[116:117], v7 offset:0
  v_mfma_f32_16x16x32_bf16 v[152:155], v[48:51], v[44:47], v[152:155]
  ds_read_b64_tr_b16 v[118:119], v7 offset:2048
  v_mfma_f32_16x16x32_bf16 v[156:159], v[52:55], v[44:47], v[156:159]
  ds_read_b64_tr_b16 v[120:121], v6 offset:8192
  v_mfma_f32_16x16x32_bf16 v[156:159], v[84:87], v[76:79], v[156:159]
  ds_read_b64_tr_b16 v[122:123], v6 offset:10240
  v_mfma_f32_16x16x32_bf16 v[148:151], v[84:87], v[72:75], v[148:151]
  ds_read_b64_tr_b16 v[124:125], v7 offset:8192
  v_mfma_f32_16x16x32_bf16 v[148:151], v[52:55], v[40:43], v[148:151]
  ds_read_b64_tr_b16 v[126:127], v7 offset:10240
  v_mfma_f32_16x16x32_bf16 v[140:143], v[52:55], v[36:39], v[140:143]
  ds_read_b64_tr_b16 v[208:209], v6 offset:4096
  v_mfma_f32_16x16x32_bf16 v[140:143], v[84:87], v[68:71], v[140:143]
  ds_read_b64_tr_b16 v[210:211], v6 offset:6144
  v_mfma_f32_16x16x32_bf16 v[132:135], v[84:87], v[64:67], v[132:135]
  ds_read_b128 v[192:195], v5 offset:0
  v_mfma_f32_16x16x32_bf16 v[132:135], v[52:55], v[32:35], v[132:135]
  ds_read_b128 v[196:199], v5 offset:2048
  v_mfma_f32_16x16x32_bf16 v[160:163], v[56:59], v[32:35], v[160:163]
  ds_read_b128 v[200:203], v5 offset:4096
  v_mfma_f32_16x16x32_bf16 v[160:163], v[88:91], v[64:67], v[160:163]
  ds_read_b128 v[204:207], v5 offset:6144
  v_mfma_f32_16x16x32_bf16 v[168:171], v[88:91], v[68:71], v[168:171]
  ds_read_b64_tr_b16 v[212:213], v7 offset:4096
  v_mfma_f32_16x16x32_bf16 v[168:171], v[56:59], v[36:39], v[168:171]
  ds_read_b64_tr_b16 v[214:215], v7 offset:6144
  v_mfma_f32_16x16x32_bf16 v[176:179], v[56:59], v[40:43], v[176:179]
  ds_read_b64_tr_b16 v[216:217], v6 offset:12288
  v_mfma_f32_16x16x32_bf16 v[176:179], v[88:91], v[72:75], v[176:179]
  ds_read_b64_tr_b16 v[218:219], v6 offset:14336
  v_mfma_f32_16x16x32_bf16 v[184:187], v[88:91], v[76:79], v[184:187]
  ds_read_b64_tr_b16 v[220:221], v7 offset:12288
  v_mfma_f32_16x16x32_bf16 v[184:187], v[56:59], v[44:47], v[184:187]
  ds_read_b64_tr_b16 v[222:223], v7 offset:14336
  v_mfma_f32_16x16x32_bf16 v[188:191], v[60:63], v[44:47], v[188:191]
  s_add_u32 s16, s16, s17
  s_cmp_eq_u32 s16, 65536
  s_cselect_b32 s23, s18, s17
  v_mfma_f32_16x16x32_bf16 v[188:191], v[92:95], v[76:79], v[188:191]
  s_cselect_b32 s16, 0, s16
  v_add_u32 v4, s23, v4
  v_add_u32_e64 v5, s23, v5
  v_mfma_f32_16x16x32_bf16 v[180:183], v[92:95], v[72:75], v[180:183]
  s_add_u32 s19, s19, s20
  s_cmp_eq_u32 s19, 81920
  s_cselect_b32 s23, s21, s20
  v_mfma_f32_16x16x32_bf16 v[180:183], v[60:63], v[40:43], v[180:183]
  s_cselect_b32 s19, 0, s19
  v_add_u32 v6, s23, v6
  v_add_u32_e64 v7, s23, v7
  v_mfma_f32_16x16x32_bf16 v[172:175], v[60:63], v[36:39], v[172:175]
  v_mfma_f32_16x16x32_bf16 v[172:175], v[92:95], v[68:71], v[172:175]
  v_mfma_f32_16x16x32_bf16 v[164:167], v[92:95], v[64:67], v[164:167]
  s_waitcnt lgkmcnt(0)
  v_mfma_f32_16x16x32_bf16 v[164:167], v[60:63], v[32:35], v[164:167]
  s_barrier
  v_mfma_f32_16x16x32_bf16 v[160:163], v[120:123], v[96:99], v[160:163]
  ds_read_b64_tr_b16 v[48:49], v6 offset:0
  ds_read_b64_tr_b16 v[50:51], v6 offset:2048
  v_mfma_f32_16x16x32_bf16 v[160:163], v[216:219], v[192:195], v[160:163]
  ds_read_b128 v[32:35], v4 offset:0
  ds_read_b128 v[36:39], v4 offset:2048
  v_mfma_f32_16x16x32_bf16 v[164:167], v[220:223], v[192:195], v[164:167]
  ds_read_b128 v[40:43], v4 offset:4096
  ds_read_b128 v[44:47], v4 offset:6144
  v_mfma_f32_16x16x32_bf16 v[164:167], v[124:127], v[96:99], v[164:167]
  ds_read_b64_tr_b16 v[52:53], v7 offset:0
  ds_read_b64_tr_b16 v[54:55], v7 offset:2048
  v_mfma_f32_16x16x32_bf16 v[172:175], v[124:127], v[100:103], v[172:175]
  ds_read_b64_tr_b16 v[80:81], v6 offset:4096
  ds_read_b64_tr_b16 v[82:83], v6 offset:6144
  v_mfma_f32_16x16x32_bf16 v[172:175], v[220:223], v[196:199], v[172:175]
  v_cvt_pk_bf16_f32 v160, v160, v161
  v_cvt_pk_bf16_f32 v161, v162, v163
  v_mfma_f32_16x16x32_bf16 v[168:171], v[216:219], v[196:199], v[168:171]
  v_cvt_pk_bf16_f32 v162, v164, v165
  v_cvt_pk_bf16_f32 v163, v166, v167
  v_mfma_f32_16x16x32_bf16 v[168:171], v[120:123], v[100:103], v[168:171]
  buffer_store_dwordx4 v[160:163], v0, s[40:43], s6 offen offset:0 sc0 sc1
  v_mfma_f32_16x16x32_bf16 v[176:179], v[120:123], v[104:107], v[176:179]
  ds_read_b128 v[64:67], v5 offset:0
  v_mfma_f32_16x16x32_bf16 v[176:179], v[216:219], v[200:203], v[176:179]
  v_cvt_pk_bf16_f32 v166, v172, v173
  v_cvt_pk_bf16_f32 v167, v174, v175
  v_mfma_f32_16x16x32_bf16 v[180:183], v[220:223], v[200:203], v[180:183]
  s_nop 0
  s_nop 0
  v_cvt_pk_bf16_f32 v164, v168, v169
  v_cvt_pk_bf16_f32 v165, v170, v171
  v_mfma_f32_16x16x32_bf16 v[180:183], v[124:127], v[104:107], v[180:183]
  buffer_store_dwordx4 v[164:167], v0, s[40:43], s6 offen offset:2048 sc0 sc1
  ds_read_b128 v[68:71], v5 offset:2048
  v_mfma_f32_16x16x32_bf16 v[188:191], v[124:127], v[108:111], v[188:191]
  ds_read_b128 v[72:75], v5 offset:4096
  v_mfma_f32_16x16x32_bf16 v[188:191], v[220:223], v[204:207], v[188:191]
  v_cvt_pk_bf16_f32 v168, v176, v177
  v_cvt_pk_bf16_f32 v169, v178, v179
  v_mfma_f32_16x16x32_bf16 v[184:187], v[216:219], v[204:207], v[184:187]
  v_cvt_pk_bf16_f32 v170, v180, v181
  v_cvt_pk_bf16_f32 v171, v182, v183
  v_mfma_f32_16x16x32_bf16 v[184:187], v[120:123], v[108:111], v[184:187]
  buffer_store_dwordx4 v[168:171], v0, s[40:43], s7 offen offset:0 sc0 sc1
  ds_read_b128 v[76:79], v5 offset:6144
  v_mfma_f32_16x16x32_bf16 v[128:131], v[112:115], v[96:99], v[128:131]
  ds_read_b64_tr_b16 v[84:85], v7 offset:4096
  v_mfma_f32_16x16x32_bf16 v[128:131], v[208:211], v[192:195], v[128:131]
  v_cvt_pk_bf16_f32 v174, v188, v189
  v_cvt_pk_bf16_f32 v175, v190, v191
  v_mfma_f32_16x16x32_bf16 v[136:139], v[208:211], v[196:199], v[136:139]
  v_cvt_pk_bf16_f32 v172, v184, v185
  v_cvt_pk_bf16_f32 v173, v186, v187
  v_mfma_f32_16x16x32_bf16 v[136:139], v[112:115], v[100:103], v[136:139]
  buffer_store_dwordx4 v[172:175], v0, s[40:43], s7 offen offset:2048 sc0 sc1
  ds_read_b64_tr_b16 v[86:87], v7 offset:6144
  v_mfma_f32_16x16x32_bf16 v[144:147], v[112:115], v[104:107], v[144:147]
  v_subrev_u32 v4, 32768, v4
  v_mfma_f32_16x16x32_bf16 v[144:147], v[208:211], v[200:203], v[144:147]
  v_subrev_u32 v6, 0x10000, v6
  v_mfma_f32_16x16x32_bf16 v[152:155], v[208:211], v[204:207], v[152:155]
  v_subrev_u32 v7, 0x10000, v7
  v_mfma_f32_16x16x32_bf16 v[152:155], v[112:115], v[108:111], v[152:155]
  v_mfma_f32_16x16x32_bf16 v[156:159], v[116:119], v[108:111], v[156:159]
  v_mfma_f32_16x16x32_bf16 v[156:159], v[212:215], v[204:207], v[156:159]
  v_mfma_f32_16x16x32_bf16 v[148:151], v[212:215], v[200:203], v[148:151]
  v_mfma_f32_16x16x32_bf16 v[148:151], v[116:119], v[104:107], v[148:151]
  v_mfma_f32_16x16x32_bf16 v[140:143], v[116:119], v[100:103], v[140:143]
  v_mfma_f32_16x16x32_bf16 v[140:143], v[212:215], v[196:199], v[140:143]
  v_mfma_f32_16x16x32_bf16 v[132:135], v[212:215], v[192:195], v[132:135]
  s_waitcnt lgkmcnt(0)
  v_mfma_f32_16x16x32_bf16 v[132:135], v[116:119], v[96:99], v[132:135]
  s_barrier
  v_mfma_f32_16x16x32_bf16 v[128:131], v[48:51], v[32:35], v[128:131]
  ds_read_b64_tr_b16 v[112:113], v6 offset:0
  v_mfma_f32_16x16x32_bf16 v[128:131], v[80:83], v[64:67], v[128:131]
  ds_read_b64_tr_b16 v[114:115], v6 offset:2048
  v_mfma_f32_16x16x32_bf16 v[136:139], v[80:83], v[68:71], v[136:139]
  ds_read_b64_tr_b16 v[208:209], v6 offset:4096
  v_mfma_f32_16x16x32_bf16 v[136:139], v[48:51], v[36:39], v[136:139]
  ds_read_b64_tr_b16 v[210:211], v6 offset:6144
  v_mfma_f32_16x16x32_bf16 v[144:147], v[48:51], v[40:43], v[144:147]
  ds_read_b128 v[96:99], v4 offset:49152
  v_mfma_f32_16x16x32_bf16 v[144:147], v[80:83], v[72:75], v[144:147]
  ds_read_b128 v[192:195], v4 offset:50176
  v_mfma_f32_16x16x32_bf16 v[152:155], v[80:83], v[76:79], v[152:155]
  ds_read_b128 v[100:103], v4 offset:51200
  v_mfma_f32_16x16x32_bf16 v[152:155], v[48:51], v[44:47], v[152:155]
  ds_read_b128 v[196:199], v4 offset:52224
  v_mfma_f32_16x16x32_bf16 v[156:159], v[52:55], v[44:47], v[156:159]
  ds_read_b128 v[104:107], v4 offset:53248
  v_mfma_f32_16x16x32_bf16 v[156:159], v[84:87], v[76:79], v[156:159]
  ds_read_b128 v[200:203], v4 offset:54272
  v_mfma_f32_16x16x32_bf16 v[148:151], v[84:87], v[72:75], v[148:151]
  ds_read_b128 v[108:111], v4 offset:55296
  v_mfma_f32_16x16x32_bf16 v[148:151], v[52:55], v[40:43], v[148:151]
  ds_read_b128 v[204:207], v4 offset:56320
  v_mfma_f32_16x16x32_bf16 v[140:143], v[52:55], v[36:39], v[140:143]
  ds_read_b64_tr_b16 v[116:117], v7 offset:0
  v_mfma_f32_16x16x32_bf16 v[140:143], v[84:87], v[68:71], v[140:143]
  ds_read_b64_tr_b16 v[118:119], v7 offset:2048
  v_mfma_f32_16x16x32_bf16 v[132:135], v[84:87], v[64:67], v[132:135]
  ds_read_b64_tr_b16 v[212:213], v7 offset:4096
  ds_read_b64_tr_b16 v[214:215], v7 offset:6144
  v_mfma_f32_16x16x32_bf16 v[132:135], v[52:55], v[32:35], v[132:135]
  s_barrier
  s_waitcnt lgkmcnt(10)
  v_mfma_f32_16x16x32_bf16 v[128:131], v[112:115], v[96:99], v[128:131]
  ds_read_b64_tr_b16 v[48:49], v6 offset:16384
  v_mfma_f32_16x16x32_bf16 v[128:131], v[208:211], v[192:195], v[128:131]
  ds_read_b64_tr_b16 v[50:51], v6 offset:18432
  s_nop 0
  s_waitcnt lgkmcnt(10)
  v_mfma_f32_16x16x32_bf16 v[136:139], v[208:211], v[196:199], v[136:139]
  ds_read_b64_tr_b16 v[80:81], v6 offset:20480
  v_mfma_f32_16x16x32_bf16 v[136:139], v[112:115], v[100:103], v[136:139]
  ds_read_b64_tr_b16 v[82:83], v6 offset:22528
  s_nop 0
  s_waitcnt lgkmcnt(10)
  v_mfma_f32_16x16x32_bf16 v[144:147], v[112:115], v[104:107], v[144:147]
  ds_read_b128 v[32:35], v4 offset:0
  v_mfma_f32_16x16x32_bf16 v[144:147], v[208:211], v[200:203], v[144:147]
  ds_read_b128 v[64:67], v4 offset:1024
  s_nop 0
  s_waitcnt lgkmcnt(10)
  v_mfma_f32_16x16x32_bf16 v[152:155], v[208:211], v[204:207], v[152:155]
  ds_read_b128 v[36:39], v4 offset:2048
  v_mfma_f32_16x16x32_bf16 v[152:155], v[112:115], v[108:111], v[152:155]
  ds_read_b128 v[68:71], v4 offset:3072
  s_nop 0
  s_waitcnt lgkmcnt(8)
  v_mfma_f32_16x16x32_bf16 v[156:159], v[116:119], v[108:111], v[156:159]
  ds_read_b128 v[40:43], v4 offset:4096
  buffer_load_dwordx4 v[176:179], v0, s[40:43], s8 offen offset:0 sc0 sc1
  v_mfma_f32_16x16x32_bf16 v[156:159], v[212:215], v[204:207], v[156:159]
  ds_read_b128 v[72:75], v4 offset:5120
  v_mfma_f32_16x16x32_bf16 v[148:151], v[212:215], v[200:203], v[148:151]
  ds_read_b128 v[44:47], v4 offset:6144
  buffer_load_dwordx4 v[180:183], v0, s[40:43], s8 offen offset:2048 sc0 sc1
  v_mfma_f32_16x16x32_bf16 v[148:151], v[116:119], v[104:107], v[148:151]
  ds_read_b128 v[76:79], v4 offset:7168
  v_mfma_f32_16x16x32_bf16 v[140:143], v[116:119], v[100:103], v[140:143]
  ds_read_b64_tr_b16 v[52:53], v7 offset:16384
  buffer_load_dwordx4 v[184:187], v0, s[40:43], s9 offen offset:0 sc0 sc1
  v_mfma_f32_16x16x32_bf16 v[140:143], v[212:215], v[196:199], v[140:143]
  ds_read_b64_tr_b16 v[54:55], v7 offset:18432
  v_mfma_f32_16x16x32_bf16 v[132:135], v[212:215], v[192:195], v[132:135]
  ds_read_b64_tr_b16 v[84:85], v7 offset:20480
  ds_read_b64_tr_b16 v[86:87], v7 offset:22528
  buffer_load_dwordx4 v[188:191], v0, s[40:43], s9 offen offset:2048 sc0 sc1
  v_mfma_f32_16x16x32_bf16 v[132:135], v[116:119], v[96:99], v[132:135]
  s_barrier
  s_waitcnt lgkmcnt(10)
  v_mfma_f32_16x16x32_bf16 v[128:131], v[48:51], v[32:35], v[128:131]
  ds_read_b64_tr_b16 v[112:113], v6 offset:32768
  v_mfma_f32_16x16x32_bf16 v[128:131], v[80:83], v[64:67], v[128:131]
  ds_read_b64_tr_b16 v[114:115], v6 offset:34816
  s_nop 0
  s_waitcnt lgkmcnt(10)
  v_mfma_f32_16x16x32_bf16 v[136:139], v[80:83], v[68:71], v[136:139]
  ds_read_b64_tr_b16 v[208:209], v6 offset:36864
  v_mfma_f32_16x16x32_bf16 v[136:139], v[48:51], v[36:39], v[136:139]
  ds_read_b64_tr_b16 v[210:211], v6 offset:38912
  s_nop 0
  s_waitcnt lgkmcnt(10)
  v_mfma_f32_16x16x32_bf16 v[144:147], v[48:51], v[40:43], v[144:147]
  ds_read_b128 v[96:99], v4 offset:16384
  v_mfma_f32_16x16x32_bf16 v[144:147], v[80:83], v[72:75], v[144:147]
  ds_read_b128 v[192:195], v4 offset:17408
  s_nop 0
  s_waitcnt lgkmcnt(10)
  v_mfma_f32_16x16x32_bf16 v[152:155], v[80:83], v[76:79], v[152:155]
  ds_read_b128 v[100:103], v4 offset:18432
  v_mfma_f32_16x16x32_bf16 v[152:155], v[48:51], v[44:47], v[152:155]
  ds_read_b128 v[196:199], v4 offset:19456
  s_nop 0
  s_waitcnt lgkmcnt(8)
  v_mfma_f32_16x16x32_bf16 v[156:159], v[52:55], v[44:47], v[156:159]
  ds_read_b128 v[104:107], v4 offset:20480
  v_mfma_f32_16x16x32_bf16 v[156:159], v[84:87], v[76:79], v[156:159]
  ds_read_b128 v[200:203], v4 offset:21504
  v_mfma_f32_16x16x32_bf16 v[148:151], v[84:87], v[72:75], v[148:151]
  ds_read_b128 v[108:111], v4 offset:22528
  v_mfma_f32_16x16x32_bf16 v[148:151], v[52:55], v[40:43], v[148:151]
  ds_read_b128 v[204:207], v4 offset:23552
  v_mfma_f32_16x16x32_bf16 v[140:143], v[52:55], v[36:39], v[140:143]
  ds_read_b64_tr_b16 v[116:117], v7 offset:32768
  v_mfma_f32_16x16x32_bf16 v[140:143], v[84:87], v[68:71], v[140:143]
  ds_read_b64_tr_b16 v[118:119], v7 offset:34816
  v_mfma_f32_16x16x32_bf16 v[132:135], v[84:87], v[64:67], v[132:135]
  ds_read_b64_tr_b16 v[212:213], v7 offset:36864
  ds_read_b64_tr_b16 v[214:215], v7 offset:38912
  v_mfma_f32_16x16x32_bf16 v[132:135], v[52:55], v[32:35], v[132:135]
  s_waitcnt lgkmcnt(10)
  v_mfma_f32_16x16x32_bf16 v[128:131], v[112:115], v[96:99], v[128:131]
  v_mfma_f32_16x16x32_bf16 v[128:131], v[208:211], v[192:195], v[128:131]
  s_waitcnt lgkmcnt(8)
  v_mfma_f32_16x16x32_bf16 v[136:139], v[208:211], v[196:199], v[136:139]
  v_mfma_f32_16x16x32_bf16 v[136:139], v[112:115], v[100:103], v[136:139]
  s_waitcnt lgkmcnt(6)
  v_mfma_f32_16x16x32_bf16 v[144:147], v[112:115], v[104:107], v[144:147]
  v_mfma_f32_16x16x32_bf16 v[144:147], v[208:211], v[200:203], v[144:147]
  s_waitcnt lgkmcnt(4)
  v_mfma_f32_16x16x32_bf16 v[152:155], v[208:211], v[204:207], v[152:155]
  s_lshl_b32 s4, s76, Lz1-Lz0+4
  v_mfma_f32_16x16x32_bf16 v[152:155], v[112:115], v[108:111], v[152:155]
  s_add_u32 s4, s4, s78
  s_lshl_b32 s6, s4, 14
  s_waitcnt lgkmcnt(0)
  s_barrier
  v_mfma_f32_16x16x32_bf16 v[156:159], v[116:119], v[108:111], v[156:159]
  s_add_u32 s6, s6, 35651584
  s_add_u32 s7, s6, 4096
  v_mfma_f32_16x16x32_bf16 v[156:159], v[212:215], v[204:207], v[156:159]
  v_and_b32 v2, 15, v1
  v_lshlrev_b32 v3, 12, v2
  v_mfma_f32_16x16x32_bf16 v[148:151], v[212:215], v[200:203], v[148:151]
  v_and_b32_e64 v2, 16, v1
  v_lshl_add_u32 v3, v2, 1, v3
  v_mfma_f32_16x16x32_bf16 v[148:151], v[116:119], v[104:107], v[148:151]
  v_and_b32 v2, 32, v1
  v_lshrrev_b32 v2, 1, v2
  v_mfma_f32_16x16x32_bf16 v[140:143], v[116:119], v[100:103], v[140:143]
  v_add_u32 v3, v2, v3
  s_lshl_b32 s26, s76, 18
  v_mfma_f32_16x16x32_bf16 v[140:143], v[212:215], v[196:199], v[140:143]
  s_lshl_b32 s4, s85, 11
  s_add_u32 s26, s26, s4
  v_mfma_f32_16x16x32_bf16 v[132:135], v[212:215], v[192:195], v[132:135]
  s_lshl_b32 s4, s78, 7
  s_add_u32 s26, s26, s4
  v_mfma_f32_16x16x32_bf16 v[132:135], v[116:119], v[96:99], v[132:135]
  s_lshl_b32 s4, s86, 6
  s_add_u32 s26, s26, s4
  s_mov_b32 s89, 200000
  v_mov_b32_e64 v32, 0
  s_waitcnt vmcnt(0)
  s_mov_b64 exec, 1
  buffer_store_dword v27, off, s[40:43], s14 sc0 sc1
  s_mov_b64 exec, -1
Lx_31:
  v_cmpx_ne_u64 vcc, v[176:177], v[240:241]
  v_cmpx_ne_u64 vcc, v[178:179], v[242:243]
  v_cmpx_ne_u64 vcc, v[180:181], v[244:245]
  v_cmpx_ne_u64 vcc, v[182:183], v[246:247]
  v_cmpx_ne_u64 vcc, v[184:185], v[248:249]
  v_cmpx_ne_u64 vcc, v[186:187], v[250:251]
  v_cmpx_ne_u64 vcc, v[188:189], v[252:253]
  v_cmpx_ne_u64 vcc, v[190:191], v[254:255]
  s_cmp_eq_u64 exec, -1
  s_cbranch_scc0 Lx_30
Lx_32:
  s_nop 1
  v_mfma_f32_16x16x32_bf16 v[128:131], v[226:229], v[176:179], v[128:131]
  v_mfma_f32_16x16x32_bf16 v[132:135], v[224:227], v[176:179], v[132:135]
  v_mfma_f32_16x16x32_bf16 v[136:139], v[226:229], v[180:183], v[136:139]
  v_mfma_f32_16x16x32_bf16 v[140:143], v[224:227], v[180:183], v[140:143]
  v_mfma_f32_16x16x32_bf16 v[144:147], v[226:229], v[184:187], v[144:147]
  v_mfma_f32_16x16x32_bf16 v[148:151], v[224:227], v[184:187], v[148:151]
  v_mfma_f32_16x16x32_bf16 v[152:155], v[226:229], v[188:191], v[152:155]
  v_mfma_f32_16x16x32_bf16 v[156:159], v[224:227], v[188:191], v[156:159]
  s_cmp_lg_u32 s82, 0
  s_cbranch_scc1 L_cfinal
  v_cvt_pk_bf16_f32 v240, v128, v129
  v_cvt_pk_bf16_f32 v241, v130, v131
  v_cvt_pk_bf16_f32 v242, v132, v133
  v_cvt_pk_bf16_f32 v243, v134, v135
  buffer_store_dwordx4 v[240:243], v0, s[40:43], s6 offen offset:0 sc0 sc1
  v_cvt_pk_bf16_f32 v244, v136, v137
  v_cvt_pk_bf16_f32 v245, v138, v139
  v_cvt_pk_bf16_f32 v246, v140, v141
  v_cvt_pk_bf16_f32 v247, v142, v143
  buffer_store_dwordx4 v[244:247], v0, s[40:43], s6 offen offset:2048 sc0 sc1
  v_cvt_pk_bf16_f32 v248, v144, v145
  v_cvt_pk_bf16_f32 v249, v146, v147
  v_cvt_pk_bf16_f32 v250, v148, v149
  v_cvt_pk_bf16_f32 v251, v150, v151
  buffer_store_dwordx4 v[248:251], v0, s[40:43], s7 offen offset:0 sc0 sc1
  v_cvt_pk_bf16_f32 v252, v152, v153
  v_cvt_pk_bf16_f32 v253, v154, v155
  v_cvt_pk_bf16_f32 v254, v156, v157
  v_cvt_pk_bf16_f32 v255, v158, v159
  buffer_store_dwordx4 v[252:255], v0, s[40:43], s7 offen offset:2048 sc0 sc1
  s_lshl_b32 s5, s78, Lz1-Lz0+1
  v_mov_b32 v40, 0x3f803f80
  v_dot2_f32_bf16 v32, v240, v40, 0
  v_dot2_f32_bf16 v36, v240, v240, 0
  v_dot2_f32_bf16 v33, v244, v40, 0
  v_dot2_f32_bf16 v37, v244, v244, 0
  v_dot2_f32_bf16 v34, v248, v40, 0
  v_dot2_f32_bf16 v38, v248, v248, 0
  v_dot2_f32_bf16 v35, v252, v40, 0
  v_dot2_f32_bf16 v39, v252, v252, 0
  v_dot2_f32_bf16 v32, v241, v40, v32
  v_dot2_f32_bf16 v36, v241, v241, v36
  v_dot2_f32_bf16 v33, v245, v40, v33
  v_dot2_f32_bf16 v37, v245, v245, v37
  v_dot2_f32_bf16 v34, v249, v40, v34
  v_dot2_f32_bf16 v38, v249, v249, v38
  v_dot2_f32_bf16 v35, v253, v40, v35
  v_dot2_f32_bf16 v39, v253, v253, v39
  v_dot2_f32_bf16 v32, v242, v40, v32
  v_dot2_f32_bf16 v36, v242, v242, v36
  v_dot2_f32_bf16 v33, v246, v40, v33
  v_dot2_f32_bf16 v37, v246, v246, v37
  v_dot2_f32_bf16 v34, v250, v40, v34
  v_dot2_f32_bf16 v38, v250, v250, v38
  v_dot2_f32_bf16 v35, v254, v40, v35
  v_dot2_f32_bf16 v39, v254, v254, v39
  v_dot2_f32_bf16 v32, v243, v40, v32
  v_dot2_f32_bf16 v36, v243, v243, v36
  v_dot2_f32_bf16 v33, v247, v40, v33
  v_dot2_f32_bf16 v37, v247, v247, v37
  v_dot2_f32_bf16 v34, v251, v40, v34
  v_dot2_f32_bf16 v38, v251, v251, v38
  v_dot2_f32_bf16 v35, v255, v40, v35
  v_dot2_f32_bf16 v39, v255, v255, v39
  s_lshl_b32 s6, s76, Lz1-Lz0+9
  s_lshl_b32 s7, s85, 8
  s_add_u32 s6, s6, s7
  s_add_u32 s6, s6, s5
  s_add_u32 s6, s6, s86
  s_lshl_b32 s6, s6, 6
  s_add_u32 s6, s6, s83
  s_add_u32 s6, s6, 36700160
  v_permlane32_swap_b32 v32, v34
  v_permlane32_swap_b32 v33, v35
  v_permlane32_swap_b32 v36, v38
  v_permlane32_swap_b32 v37, v39
  v_add_f32 v32, v32, v34
  v_add_f32 v33, v33, v35
  v_add_f32 v36, v36, v38
  v_add_f32 v37, v37, v39
  v_permlane16_swap_b32 v32, v33
  s_nop 0
  v_permlane16_swap_b32 v36, v37
  v_add_f32 v42, v32, v33
  v_add_f32_e64 v43, v36, v37
  buffer_store_dwordx2 v[42:43], v30, s[40:43], s6 offen sc0 sc1
  s_add_u32 s5, s87, 0x10
  s_sub_u32 s4, s78, s77
  s_lshl_b32 s4, s4, 7
  s_add_u32 s5, s5, s4
  s_waitcnt vmcnt(0)
  s_mov_b64 exec, 1
  ds_add_rtn_u32 v2, v28, v27 offset:0
  s_waitcnt lgkmcnt(0)
  v_readfirstlane_b32 s4, v2
  s_and_b32 s4, s4, Lz1-Lz0+3
  s_cmp_lg_u32 s4, 3
  s_cbranch_scc1 Ls_33
  s_mov_b32 exec_lo, 0xffff
  buffer_store_dword v27, v24, s[40:43], s5 offen sc0 sc1
Ls_33:
  s_nop 0
  s_mov_b64 exec, -1
  ds_write_b128 v0, v[240:243] offset:0
  ds_write_b128 v0, v[244:247] offset:2048
  ds_write_b128 v0, v[248:251] offset:4096
  ds_write_b128 v0, v[252:255] offset:6144
  s_mov_b32 s82, 1
  s_add_u32 s83, s83, 0
  s_add_u32 s87, s87, 32
  s_branch L_clayer
  s_nop 0
L_cfinal:
  s_nop 1
  v_cvt_pk_bf16_f32 v240, v128, v129
  v_cvt_pk_bf16_f32 v241, v130, v131
  v_cvt_pk_bf16_f32 v242, v132, v133
  v_cvt_pk_bf16_f32 v243, v134, v135
  s_nop 0
  v_permlane16_swap_b32 v240, v242
  v_permlane16_swap_b32_e64 v241, v243
  buffer_store_dwordx4 v[240:243], v3, s[64:67], s26 offen sc0 sc1
  s_add_u32 s26, s26, 0x10000
  v_cvt_pk_bf16_f32 v244, v136, v137
  v_cvt_pk_bf16_f32 v245, v138, v139
  v_cvt_pk_bf16_f32 v246, v140, v141
  v_cvt_pk_bf16_f32 v247, v142, v143
  s_nop 0
  v_permlane16_swap_b32 v244, v246
  v_permlane16_swap_b32_e64 v245, v247
  buffer_store_dwordx4 v[244:247], v3, s[64:67], s26 offen sc0 sc1
  s_add_u32 s26, s26, 0x10000
  v_cvt_pk_bf16_f32 v248, v144, v145
  v_cvt_pk_bf16_f32 v249, v146, v147
  v_cvt_pk_bf16_f32 v250, v148, v149
  v_cvt_pk_bf16_f32 v251, v150, v151
  s_nop 0
  v_permlane16_swap_b32 v248, v250
  v_permlane16_swap_b32_e64 v249, v251
  buffer_store_dwordx4 v[248:251], v3, s[64:67], s26 offen sc0 sc1
  s_add_u32 s26, s26, 0x10000
  v_cvt_pk_bf16_f32 v252, v152, v153
  v_cvt_pk_bf16_f32 v253, v154, v155
  v_cvt_pk_bf16_f32 v254, v156, v157
  v_cvt_pk_bf16_f32 v255, v158, v159
  s_nop 0
  v_permlane16_swap_b32 v252, v254
  v_permlane16_swap_b32_e64 v253, v255
  buffer_store_dwordx4 v[252:255], v3, s[64:67], s26 offen sc0 sc1
  s_endpgm
Lo_7:
  s_mov_b64 vcc, 0
  s_waitcnt lgkmcnt(0)
  s_barrier
  ds_read_b128 v[64:67], v4 offset:0
  ds_read_b128 v[80:83], v5 offset:0
  ds_read_b128 v[68:71], v4 offset:2048
  ds_read_b128 v[84:87], v5 offset:2048
  ds_read_b128 v[72:75], v4 offset:4096
  ds_read_b128 v[88:91], v5 offset:4096
  ds_read_b64_tr_b16 v[96:97], v6 offset:0
  ds_read_b64_tr_b16 v[98:99], v6 offset:2048
  ds_read_b64_tr_b16 v[100:101], v6 offset:4096
  ds_read_b64_tr_b16 v[102:103], v6 offset:6144
  ds_read_b128 v[76:79], v4 offset:6144
  ds_read_b128 v[92:95], v5 offset:6144
  ds_read_b64_tr_b16 v[104:105], v7 offset:0
  s_nop 0
  s_waitcnt lgkmcnt(8)
  ds_read_b64_tr_b16 v[106:107], v7 offset:2048
  ds_read_b64_tr_b16 v[108:109], v7 offset:4096
  ds_read_b64_tr_b16 v[110:111], v7 offset:6144
  s_waitcnt lgkmcnt(6)
  s_branch Lk_4
Lo_9:
  s_waitcnt lgkmcnt(0)
  s_branch Lo_8
Lx_30:
  s_mov_b64 exec, -1
  v_readfirstlane_b32 s5, v32
  s_sub_u32 s89, s89, 1
  s_cbranch_scc1 Lx_32
  buffer_load_dword v32, off, s[40:43], s13 sc0 sc1
  buffer_load_dwordx4 v[176:179], v0, s[40:43], s8 offen offset:0 sc0 sc1
  buffer_load_dwordx4 v[180:183], v0, s[40:43], s8 offen offset:2048 sc0 sc1
  buffer_load_dwordx4 v[184:187], v0, s[40:43], s9 offen offset:0 sc0 sc1
  buffer_load_dwordx4 v[188:191], v0, s[40:43], s9 offen offset:2048 sc0 sc1
  s_waitcnt vmcnt(0)
  s_cmp_lg_u32 s5, 0
  s_cbranch_scc1 Lx_32
  s_branch Lx_31
  s_nop 0
L_w1:
  s_lshl_b32 s11, s85, 12
  s_add_u32 s11, s11, 65536
  s_add_u32 s15, s11, 81920
  s_add_u32 s11, s11, 32768
  v_readfirstlane_b32 s7, v38
  s_mov_b32 s12, 0
  s_mov_b32 m0, s11
  s_waitcnt vmcnt(12)
  s_barrier
  s_branch Ll_47
Lt_54:
  s_cmp_lg_u32 s12, 2
  s_cbranch_scc1 Lt_52
  s_waitcnt vmcnt(8)
  s_barrier
  s_branch Ll_47
Lt_52:
  s_cmp_lg_u32 s12, 4
  s_cbranch_scc1 Ll_47
  s_barrier
Ll_47:
  buffer_load_dwordx4 v4, s[52:55], s7 offen offset:0  lds
  s_mov_b32 s5, s7
  buffer_load_dwordx4 v5, s[52:55], s5 offen offset:1024  lds
  s_add_u32 s12, s12, 1
  v_readlane_b32 s7, v38, s12
  s_add_u32 s11, s11, 8192
  s_nop 0
  s_cmp_eq_u32 s11, s15
  buffer_load_dwordx4 v6, s[52:55], s5 offen offset:2048  lds
  s_cselect_b32 s4, 81920, 0
  s_sub_u32 s11, s11, s4
  s_cmp_lg_u32 s12, 10
  buffer_load_dwordx4 v7, s[52:55], s5 offen offset:3072  lds
  s_mov_b32 m0, s11
  s_cbranch_scc1 Lt_54
Lt_55:
  v_mov_b32 v2, 156416
  v_mov_b32_e64 v3, 1
  s_waitcnt vmcnt(16)
  s_mov_b64 exec, 1
  ds_add_u32 v2, v3 offset:8
  s_mov_b64 exec, -1
  s_barrier
Ll_49:
  buffer_load_dwordx4 v4, s[52:55], s7 offen offset:0  lds
  s_mov_b32 s5, s7
  buffer_load_dwordx4 v5, s[52:55], s5 offen offset:1024  lds
  s_add_u32 s12, s12, 1
  v_readlane_b32 s7, v38, s12
  s_add_u32 s11, s11, 8192
  s_nop 0
  s_cmp_eq_u32 s11, s15
  buffer_load_dwordx4 v6, s[52:55], s5 offen offset:2048  lds
  s_cselect_b32 s4, 81920, 0
  s_sub_u32 s11, s11, s4
  s_cmp_lg_u32 s12, 16
  buffer_load_dwordx4 v7, s[52:55], s5 offen offset:3072  lds
  s_mov_b32 m0, s11
  s_cbranch_scc1 Ll_49
  v_lshrrev_b32 v2, 3, v1
  s_movk_i32 s4, 7168
  v_mad_u32_u24 v32, v2, s4, v10
  v_add_u32 v33, 56320, v32
  v_add_u32 v34, 112640, v32
  v_add_u32 v35, 168960, v32
  v_lshrrev_b32 v2, 2, v1
  s_movk_i32 s4, 7168
  v_mul_u32_u24_e64 v2, s4, v2
  v_bfe_u32 v3, v10, 5, 1
  v_lshl_add_u32 v2, v3, 4, v2
  v_and_b32 v3, 1, v1
  v_lshlrev_b32 v3, 5, v3
  v_add_u32_e64 v8, v2, v3
  v_add_u32 v9, 113664, v8
  s_mul_i32 s5, s77, 448
  s_and_b32 s4, s77, Lz1-Lz0+1
  s_mul_i32 s94, s4, 448
  s_sub_u32 s94, 384, s94
  s_lshl_b32 s4, s4, 6
  s_add_u32 s5, s5, s4
  s_mul_i32 s4, s85, 229376
  s_add_u32 s5, s5, s4
  s_and_b32 s4, s76, 7
  s_add_u32 s6, s4, 1
  v_cmp_lt_u32 vcc, s6, v1
  v_add_u32 v12, s4, v1
  s_nop 0
  v_subbrev_co_u32 v12, vcc, 0, v12, vcc
  v_and_b32 v12, 7, v12
  v_subrev_u32 v2, 9, v1
  v_cmp_le_u32 vcc, s4, v2
  s_nop 1
  v_addc_co_u32 v2, vcc, 8, v2, vcc
  v_cmp_le_u32 vcc, 9, v1
  s_nop 1
  v_cndmask_b32 v12, v12, v2, vcc
  s_add_u32 s4, s4, 8
  s_mov_b32 m0, s6
  s_nop 0
  v_writelane_b32 v12, s4, m0
  s_and_b32 s4, s76, 8
  v_xor_b32 v12, s4, v12
  v_cmp_eq_u32 vcc, s78, v12
  s_nop 0
  v_mov_b32_dpp v2, v12 row_shr:1 row_mask:0xf bank_mask:0xf
  s_ff1_i32_b32 s4, vcc_lo
  v_cmp_ge_u32 vcc, s4, v1
  s_nop 1
  v_cndmask_b32 v12, v12, v2, vcc
  v_writelane_b32 v12, s78, 0
  s_mov_b32 s4, 458752
  v_mul_u32_u24 v12, s4, v12
  v_add_u32 v12, s5, v12
  s_nop 0
  v_readfirstlane_b32 s7, v12
  s_lshl_b32 s11, s85, Lz1-Lz0+12
  s_add_u32 s11, s11, 65536
  s_add_u32 s15, s11, 86016
  s_lshl_b32 s4, s85, Lz1-Lz0+11
  s_sub_u32 s13, 24576, s4
  s_mul_i32 s5, s85, 6144
  s_nop 0
  s_mov_b32 s68, s28
  s_and_b32 s69, s29, 0xffff
  s_mov_b32 s70, 7340032
  s_mov_b32 s71, 0x00020000
  s_lshl_b32 s4, s76, 4
  s_add_u32 s4, s4, s77
  s_mul_i32 s34, s4, 28672
  s_add_u32 s34, s34, s5
  v_lshlrev_b32 v15, 4, v1
  s_lshl_b32 s91, s85, Lz1-Lz0+13
  s_add_u32 s91, s91, 4096
  s_mul_i32 s4, s76, 262144
  s_add_u32 s4, s4, 3145728
  s_add_u32 s4, s4, s91
  v_lshl_add_u32 v14, v39, 14, s4
  s_mov_b32 s12, 4
Lh_56:
  v_readlane_b32 s90, v14, s12
  s_mov_b32 m0, s91
  s_cmp_lt_u32 s12, Lz1-Lz0+7
  s_cbranch_scc1 Lh_57
  s_waitcnt vmcnt(8)
Lh_57:
  s_barrier
  buffer_load_dwordx4 v15, s[40:43], s90 offen offset:0 sc1 lds
  s_add_u32 s91, s91, 16384
  s_and_b32 s91, s91, 0xffff
  buffer_load_dwordx4 v15, s[40:43], s90 offen offset:1024 sc1 lds
  s_add_u32 s12, s12, 1
  s_cmp_lg_u32 s12, 16
  buffer_load_dwordx4 v15, s[40:43], s90 offen offset:2048 sc1 lds
  buffer_load_dwordx4 v15, s[40:43], s90 offen offset:3072 sc1 lds
  s_cbranch_scc1 Lh_56
  s_mov_b32 s12, 0
  s_mov_b32 m0, s11
  s_branch Ll_58
Lt_64:
  s_cmp_lg_u32 s12, 1
  s_cbranch_scc1 Ll_58
  s_waitcnt vmcnt(18)
  s_barrier
Ll_58:
  buffer_load_dwordx4 v32, s[56:59], s7 offen offset:0  lds
  buffer_load_dwordx4 v33, s[56:59], s7 offen offset:1024  lds
  buffer_load_dwordx4 v34, s[56:59], s7 offen offset:2048  lds
  buffer_load_dwordx4 v35, s[56:59], s7 offen offset:3072  lds
  s_add_u32 m0, s11, s13
  s_add_u32 s5, s7, s94
  buffer_load_dwordx4 v8, s[56:59], s5 offen offset:0  lds
  buffer_load_dwordx4 v9, s[56:59], s5 offen offset:1024  lds
  s_cmp_ge_u32 s12, Lz1-Lz0+2
  s_cbranch_scc1 Lm_65
  s_waitcnt vmcnt(20)
  s_cmp_lg_u32 s12, 0
  s_cbranch_scc1 Lm_66
  s_waitcnt vmcnt(14)
Lm_66:
  s_barrier
Lm_65:
  s_add_u32 m0, s11, 8192
  s_add_u32 s5, s7, 128
  buffer_load_dwordx4 v32, s[56:59], s5 offen offset:0  lds
  buffer_load_dwordx4 v33, s[56:59], s5 offen offset:1024  lds
  buffer_load_dwordx4 v34, s[56:59], s5 offen offset:2048  lds
  buffer_load_dwordx4 v35, s[56:59], s5 offen offset:3072  lds
  s_add_u32 m0, s11, 16384
  s_add_u32 s5, s7, 256
  buffer_load_dwordx4 v32, s[56:59], s5 offen offset:0  lds
  s_add_u32 s12, s12, Lz1-Lz0+1
  v_readlane_b32 s7, v12, s12
  s_add_u32 s11, s11, 28672
  buffer_load_dwordx4 v33, s[56:59], s5 offen offset:1024  lds
  s_cmp_eq_u32 s11, s15
  s_cselect_b32 s4, 86016, 0
  s_sub_u32 s11, s11, s4
  buffer_load_dwordx4 v34, s[56:59], s5 offen offset:2048  lds
  s_cmp_lg_u32 s12, Lz1-Lz0+2
  buffer_load_dwordx4 v35, s[56:59], s5 offen offset:3072  lds
  s_mov_b32 m0, s11
  s_cbranch_scc1 Ll_59
  s_barrier
Lt_67:
  s_waitcnt vmcnt(0)
  s_barrier
Ll_68:
Ll_59:
  s_cmp_lt_u32 s12, 3
  s_cbranch_scc1 Lt_64
  s_cmp_lg_u32 s82, 0
  s_cbranch_scc1 L_69
  s_lshl_b32 s5, s78, 7
  s_mul_i32 s4, s79, 3670016
  s_add_u32 s5, s5, s4
  v_subrev_u32 v2, 2, v1
  v_cmp_le_u32 vcc, 28, v1
  s_nop 1
  v_cndmask_b32 v37, v1, v2, vcc
  v_subrev_u32 v3, 3, v37
  v_mov_b32 v36, 4
  v_cmp_le_u32 vcc, 14, v37
  v_subrev_u32 v2, 14, v37
  s_nop 0
  v_cndmask_b32_e64 v3, v3, v2, vcc
  v_cndmask_b32_e64 v36, v36, 12, vcc
  v_cmp_le_u32 vcc, 21, v37
  v_subrev_u32 v2, 21, v37
  s_nop 0
  v_cndmask_b32 v3, v3, v2, vcc
  v_cndmask_b32_e64 v36, v36, 20, vcc
  s_sub_u32 s4, s80, s76
  s_and_b32 s4, s4, 7
  v_cmp_le_u32 vcc, s4, v3
  v_mov_b32 v2, s76
  s_nop 0
  v_addc_co_u32 v3, vcc, v3, v2, vcc
  v_and_b32 v3, 7, v3
  v_add_u32 v36, v36, v3
  v_add_u32 v2, v2, v1
  v_and_b32 v2, 3, v2
  v_subrev_u32 v3, 10, v1
  v_cmp_gt_u32 vcc, 4, v3
  s_nop 1
  v_cndmask_b32 v36, v36, v2, vcc
  s_add_u32 s4, s80, Lz1-Lz0+4
  v_lshl_add_u32 v2, v1, 3, s4
  v_cmp_gt_u32 vcc, 3, v1
  s_nop 1
  v_cndmask_b32 v36, v36, v2, vcc
  v_subrev_u32 v2, 4, v36
  v_and_b32 v3, 7, v2
  v_lshrrev_b32 v2, 3, v2
  v_mad_u32_u24 v2, v3, 7, v2
  v_and_b32 v3, 1, v3
  v_add_u32 v2, v2, v3
  s_mul_i32 s4, s85, 3
  v_add_u32 v2, s4, v2
  s_add_u32 s4, s85, Lz1-Lz0+6
  v_mad_u32_u24 v3, v36, 14, s4
  v_cmp_gt_u32 vcc, 4, v36
  s_nop 1
  v_cndmask_b32_e64 v2, v2, v3, vcc
  v_lshl_add_u32 v36, v2, 16, s5
  s_mul_i32 s4, s79, 7340032
  s_sub_u32 s4, 3670016, s4
  v_add_u32 v2, s4, v36
  v_cmp_le_u32 vcc, 28, v1
  s_nop 1
  v_cndmask_b32 v36, v36, v2, vcc
L_69:
  s_waitcnt vmcnt(14)
  s_barrier
  buffer_load_dwordx4 v32, s[56:59], s7 offen offset:0  lds
  buffer_load_dwordx4 v33, s[56:59], s7 offen offset:1024  lds
  buffer_load_dwordx4 v34, s[56:59], s7 offen offset:2048  lds
  buffer_load_dwordx4 v35, s[56:59], s7 offen offset:3072  lds
Ll_70:
  s_add_u32 m0, s11, s13
  s_add_u32 s5, s7, s94
  buffer_load_dwordx4 v8, s[56:59], s5 offen offset:0  lds
  buffer_load_dwordx4 v9, s[56:59], s5 offen offset:1024  lds
  s_add_u32 m0, s11, 8192
  s_add_u32 s5, s7, 128
  buffer_load_dwordx4 v32, s[56:59], s5 offen offset:0  lds
  buffer_load_dwordx4 v33, s[56:59], s5 offen offset:1024  lds
  buffer_load_dwordx4 v34, s[56:59], s5 offen offset:2048  lds
  buffer_load_dwordx4 v35, s[56:59], s5 offen offset:3072  lds
  s_add_u32 m0, s11, 16384
  s_add_u32 s5, s7, 256
  buffer_load_dwordx4 v32, s[56:59], s5 offen offset:0  lds
  s_add_u32 s12, s12, Lz1-Lz0+1
  v_readlane_b32 s7, v12, s12
  s_add_u32 s11, s11, 28672
  buffer_load_dwordx4 v33, s[56:59], s5 offen offset:1024  lds
  s_cmp_eq_u32 s11, s15
  s_cselect_b32 s4, 86016, 0
  s_sub_u32 s11, s11, s4
  buffer_load_dwordx4 v34, s[56:59], s5 offen offset:2048  lds
  s_cmp_eq_u32 s12, Lz1-Lz0+16
  buffer_load_dwordx4 v35, s[56:59], s5 offen offset:3072  lds
  s_mov_b32 m0, s11
  s_cbranch_scc1 Ll_71
  s_cmp_lg_u32 s82, 0
  s_cbranch_scc1 L_72
  s_buffer_load_dwordx2 s[98:99], s[68:71], s34 offset:60
  s_buffer_load_dwordx2 s[98:99], s[68:71], s34 offset:188
  s_buffer_load_dwordx2 s[98:99], s[68:71], s34 offset:316
  s_buffer_load_dwordx2 s[98:99], s[68:71], s34 offset:444
  s_add_u32 s34, s34, 512
L_72:
  s_waitcnt vmcnt(14)
  s_barrier
  buffer_load_dwordx4 v32, s[56:59], s7 offen offset:0  lds
  buffer_load_dwordx4 v33, s[56:59], s7 offen offset:1024  lds
  buffer_load_dwordx4 v34, s[56:59], s7 offen offset:2048  lds
  buffer_load_dwordx4 v35, s[56:59], s7 offen offset:3072  lds
  s_branch Ll_70
Ll_71:
  s_lshl_b32 s94, s79, 8
  s_sub_u32 s94, 128, s94
  s_lshl_b32 s11, s85, Lz1-Lz0+12
  s_add_u32 s11, s11, 65536
  s_add_u32 s15, s11, 81920
  s_add_u32 s11, s11, 49152
  v_readfirstlane_b32 s7, v36
  s_mov_b32 s12, 0
  s_mov_b32 m0, s11
  s_waitcnt vmcnt(14)
  s_barrier
  s_waitcnt vmcnt(0)
  s_barrier
  s_branch Ll_73
  s_nop 0
Lt_79:
  s_cmp_lg_u32 s12, 2
  s_cbranch_scc1 Ll_73
  s_barrier
Ll_73:
  buffer_load_dwordx4 v4, s[60:63], s7 offen offset:0  lds
  buffer_load_dwordx4 v5, s[60:63], s7 offen offset:1024  lds
  buffer_load_dwordx4 v6, s[60:63], s7 offen offset:2048  lds
  buffer_load_dwordx4 v7, s[60:63], s7 offen offset:3072  lds
  s_add_u32 m0, s11, 8192
  s_add_u32 s5, s7, s94
  buffer_load_dwordx4 v4, s[60:63], s5 offen offset:0  lds
  s_add_u32 s12, s12, 1
  v_readlane_b32 s7, v36, s12
  s_add_u32 s11, s11, 16384
  buffer_load_dwordx4 v5, s[60:63], s5 offen offset:1024  lds
  s_cmp_eq_u32 s11, s15
  s_cselect_b32 s4, 81920, 0
  s_sub_u32 s11, s11, s4
  buffer_load_dwordx4 v6, s[60:63], s5 offen offset:2048  lds
  s_cmp_lg_u32 s12, Lz1-Lz0+5
  buffer_load_dwordx4 v7, s[60:63], s5 offen offset:3072  lds
  s_mov_b32 m0, s11
  s_cbranch_scc1 Lt_79
Lt_80:
  s_cmp_lg_u32 s82, 0
  s_cbranch_scc1 L_81
  v_lshrrev_b32 v2, 3, v1
  s_movk_i32 s4, 6144
  v_mad_u32_u24 v16, v2, s4, v10
  v_add_u32 v17, 48128, v16
  v_add_u32 v18, 96256, v16
  v_add_u32 v19, 144384, v16
  s_lshl_b32 s5, s77, Lz1-Lz0+7
  s_mul_i32 s4, s85, 196608
  s_add_u32 s5, s5, s4
  s_and_b32 s4, s76, 7
  s_add_u32 s6, s4, 1
  v_cmp_lt_u32 vcc, s6, v1
  v_add_u32 v20, s4, v1
  s_nop 0
  v_subbrev_co_u32 v20, vcc, 0, v20, vcc
  v_and_b32 v20, 7, v20
  v_subrev_u32 v2, 9, v1
  v_cmp_le_u32 vcc, s4, v2
  s_nop 1
  v_addc_co_u32 v2, vcc, 8, v2, vcc
  v_cmp_le_u32 vcc, 9, v1
  s_nop 1
  v_cndmask_b32 v20, v20, v2, vcc
  s_add_u32 s4, s4, 8
  s_mov_b32 m0, s6
  s_nop 0
  v_writelane_b32 v20, s4, m0
  s_and_b32 s4, s76, 8
  v_xor_b32 v20, s4, v20
  v_cmp_eq_u32 vcc, s78, v20
  s_nop 0
  v_mov_b32_dpp v2, v20 row_shr:1 row_mask:0xf bank_mask:0xf
  s_ff1_i32_b32 s4, vcc_lo
  v_cmp_ge_u32 vcc, s4, v1
  s_nop 1
  v_cndmask_b32 v20, v20, v2, vcc
  v_writelane_b32 v20, s78, 0
  s_mov_b32 s4, 393216
  v_mul_u32_u24_e64 v20, s4, v20
  v_add_u32 v20, s5, v20
  s_mov_b32 m0, s11
L_81:
  s_waitcnt vmcnt(32)
  s_barrier
Ll_82:
  s_waitcnt vmcnt(24)
  s_barrier
  buffer_load_dwordx4 v4, s[60:63], s7 offen offset:0  lds
  buffer_load_dwordx4 v5, s[60:63], s7 offen offset:1024  lds
  buffer_load_dwordx4 v6, s[60:63], s7 offen offset:2048  lds
  buffer_load_dwordx4 v7, s[60:63], s7 offen offset:3072  lds
Ll_83:
  s_add_u32 m0, s11, 8192
  s_add_u32 s5, s7, s94
  buffer_load_dwordx4 v4, s[60:63], s5 offen offset:0  lds
  s_add_u32 s12, s12, 1
  v_readlane_b32 s7, v36, s12
  s_add_u32 s11, s11, 16384
  buffer_load_dwordx4 v5, s[60:63], s5 offen offset:1024  lds
  s_cmp_eq_u32 s11, s15
  s_cselect_b32 s4, 81920, 0
  s_sub_u32 s11, s11, s4
  buffer_load_dwordx4 v6, s[60:63], s5 offen offset:2048  lds
  s_cmp_eq_u32 s12, Lz1-Lz0+26
  buffer_load_dwordx4 v7, s[60:63], s5 offen offset:3072  lds
  s_mov_b32 m0, s11
  s_cbranch_scc1 Ll_84
  s_waitcnt vmcnt(24)
  s_barrier
  buffer_load_dwordx4 v4, s[60:63], s7 offen offset:0  lds
  buffer_load_dwordx4 v5, s[60:63], s7 offen offset:1024  lds
  buffer_load_dwordx4 v6, s[60:63], s7 offen offset:2048  lds
  buffer_load_dwordx4 v7, s[60:63], s7 offen offset:3072  lds
  s_branch Ll_83
  s_nop 0
Ll_84:
  s_waitcnt vmcnt(24)
  s_barrier
  buffer_load_dwordx4 v4, s[60:63], s7 offen offset:0  lds
Ll_85:
  s_mov_b32 s5, s7
  buffer_load_dwordx4 v5, s[60:63], s5 offen offset:1024  lds
  s_add_u32 s12, s12, 1
  v_readlane_b32 s7, v36, s12
  s_add_u32 s11, s11, 16384
  s_nop 0
  s_cmp_eq_u32 s11, s15
  buffer_load_dwordx4 v6, s[60:63], s5 offen offset:2048  lds
  s_cselect_b32 s4, 81920, 0
  s_sub_u32 s11, s11, s4
  s_cmp_eq_u32 s12, 30
  buffer_load_dwordx4 v7, s[60:63], s5 offen offset:3072  lds
  s_mov_b32 m0, s11
  s_cbranch_scc1 Ll_86
  s_waitcnt vmcnt(12)
  s_barrier
  buffer_load_dwordx4 v4, s[60:63], s7 offen offset:0  lds
  s_branch Ll_85
  s_nop 0
Ll_86:
  v_readfirstlane_b32 s7, v20
  s_lshl_b32 s11, s85, 12
  s_add_u32 s11, s11, 65536
  s_add_u32 s15, s11, 73728
  s_cmp_eq_u32 s82, 0
  s_mov_b32 s82, 1
  s_cbranch_scc1 L_wlayer
  s_waitcnt vmcnt(12)
  s_barrier
  s_waitcnt vmcnt(8)
  s_barrier
  s_waitcnt vmcnt(4)
  s_barrier
  s_waitcnt vmcnt(0)
  s_barrier
  s_barrier
  s_branch L_lend
L_x1:
  s_cmp_lg_u32 s82, 0
  s_cbranch_scc1 L_96
  s_and_b32 s80, s77, 7
  s_lshr_b32 s79, s77, 3
  s_lshl_b32 s78, s80, 1
  s_add_u32 s78, s78, s79
  s_lshl_b32 s5, s76, 4
  s_add_u32 s5, s5, s77
  s_lshl_b32 s84, s5, 11
  s_mov_b32 s83, 3145728
  s_mov_b32 s87, 1835016
  s_lshr_b32 s86, s81, 1
  v_lshlrev_b32 v4, 4, v1
  v_lshlrev_b32 v5, 4, v1
  v_lshlrev_b32 v6, 4, v1
  v_lshlrev_b32 v7, 4, v1
  s_movk_i32 s13, 4096
  s_movk_i32 s95, 8192
  v_and_b32 v2, 31, v1
  v_lshlrev_b32 v8, 7, v2
L_96:
  s_mov_b32 s40, s38
  s_and_b32 s41, s39, 0xffff
  s_mov_b32 s42, 100663296
  s_mov_b32 s43, 0x00020000
  s_mov_b32 s72, s40
  s_mov_b32 s73, s41
  s_mov_b32 s74, s42
  s_mov_b32 s11, 0
  s_mov_b32 s15, 65536
  s_mul_i32 s5, s76, 16
  s_lshl_b32 s5, s5, 14
  s_add_u32 s5, s5, 3145728
  s_mul_i32 s4, s76, 14
  s_lshr_b32 s4, s4, 4
  v_add_u32 v9, s4, v1
  v_subrev_u32 v2, 14, v9
  v_min_u32 v9, v9, v2
  v_cmp_le_u32 vcc, 14, v1
  s_nop 1
  v_cndmask_b32 v9, v9, v1, vcc
  v_lshlrev_b32_e64 v9, 2, v9
  v_mov_b32 v2, 0x87654210
  v_mov_b32 v3, 0xb3fedca9
  v_lshrrev_b64 v[2:3], v9, v[2:3]
  v_and_b32_e64 v9, 15, v2
  v_cmp_eq_u32 vcc, s77, v9
  s_nop 0
  v_mov_b32_dpp v2, v9 row_shr:1 row_mask:0xf bank_mask:0xf
  s_ff1_i32_b32 s4, vcc_lo
  v_cmp_ge_u32 vcc, s4, v1
  s_nop 1
  v_cndmask_b32 v9, v9, v2, vcc
  v_writelane_b32 v9, s77, 0
  v_lshlrev_b32 v11, 7, v9
  v_lshl_add_u32 v9, v9, 14, s5
  s_nop 0
  v_readlane_b32 s7, v9, 1
  s_mov_b32 s11, 16384
  s_mov_b32 s90, 0xfe
  s_lshl_b32 s91, s84, Lz1-Lz0+1
  s_add_u32 s91, s91, s87
  s_barrier
  s_mov_b32 s89, 200000
  s_mov_b32 exec_lo, s90
  s_mov_b32 exec_hi, 0
  buffer_load_dword v12, v11, s[40:43], s91 offen sc0 sc1
Lp_97:
  s_waitcnt vmcnt(0)
  v_cmp_ne_u32 vcc, 0, v12
  s_andn2_b32 s3, exec_lo, vcc_lo
  s_cbranch_scc0 Lp_98
  s_mov_b32 exec_lo, s3
  s_sleep 1
  buffer_load_dword v12, v11, s[40:43], s91 offen sc0 sc1
  s_sub_u32 s89, s89, 1
  s_cbranch_scc0 Lp_97
Lp_98:
  s_mov_b64 exec, -1
  s_mov_b32 s12, 1
  s_mov_b32 m0, s11
Ll_100:
  s_nop 0
  buffer_load_dwordx4 v4, s[40:43], s7 offen offset:0 sc1 lds
  buffer_load_dwordx4 v5, s[40:43], s7 offen offset:1024 sc1 lds
  buffer_load_dwordx4 v6, s[40:43], s7 offen offset:2048 sc1 lds
  buffer_load_dwordx4 v7, s[40:43], s7 offen offset:3072 sc1 lds
  s_add_u32 m0, s11, 4096
  s_nop 0
  s_add_u32 s5, s7, s13
  buffer_load_dwordx4 v4, s[40:43], s5 offen offset:0 sc1 lds
  buffer_load_dwordx4 v5, s[40:43], s5 offen offset:1024 sc1 lds
  buffer_load_dwordx4 v6, s[40:43], s5 offen offset:2048 sc1 lds
  buffer_load_dwordx4 v7, s[40:43], s5 offen offset:3072 sc1 lds
  s_add_u32 m0, s11, 8192
  s_nop 0
  s_add_u32 s3, s7, s95
  buffer_load_dwordx4 v4, s[40:43], s3 offen offset:0 sc1 lds
  buffer_load_dwordx4 v5, s[40:43], s3 offen offset:1024 sc1 lds
  buffer_load_dwordx4 v6, s[40:43], s3 offen offset:2048 sc1 lds
  buffer_load_dwordx4 v7, s[40:43], s3 offen offset:3072 sc1 lds
  s_add_u32 m0, s11, 12288
  s_add_u32 s5, s3, s13
  buffer_load_dwordx4 v4, s[40:43], s5 offen offset:0 sc1 lds
  s_add_u32 s12, s12, 1
  v_readlane_b32 s7, v9, s12
  s_add_u32 s11, s11, 16384
  buffer_load_dwordx4 v5, s[40:43], s5 offen offset:1024 sc1 lds
  s_cmp_eq_u32 s11, s15
  s_cselect_b32 s4, 65536, 0
  s_sub_u32 s11, s11, s4
  buffer_load_dwordx4 v6, s[40:43], s5 offen offset:2048 sc1 lds
  s_cmp_lg_u32 s12, Lz1-Lz0+4
  buffer_load_dwordx4 v7, s[40:43], s5 offen offset:3072 sc1 lds
  s_mov_b32 m0, s11
  s_cbranch_scc1 Ll_100
  s_waitcnt vmcnt(32)
  s_barrier
  buffer_load_dwordx4 v4, s[40:43], s7 offen offset:0 sc1 lds
  buffer_load_dwordx4 v5, s[40:43], s7 offen offset:1024 sc1 lds
  buffer_load_dwordx4 v6, s[40:43], s7 offen offset:2048 sc1 lds
  buffer_load_dwordx4 v7, s[40:43], s7 offen offset:3072 sc1 lds
  s_add_u32 m0, s11, 8192
  s_add_u32 s3, s7, s95
  buffer_load_dwordx4 v4, s[40:43], s3 offen offset:0 sc1 lds
  s_add_u32 s12, s12, 1
  v_readlane_b32 s7, v9, s12
  buffer_load_dwordx4 v5, s[40:43], s3 offen offset:1024 sc1 lds
  s_add_u32 s11, s11, 16384
  s_nop 0
  s_cmp_eq_u32 s11, s15
  buffer_load_dwordx4 v6, s[40:43], s3 offen offset:2048 sc1 lds
  s_cselect_b32 s4, 65536, 0
  s_sub_u32 s11, s11, s4
  buffer_load_dwordx4 v7, s[40:43], s3 offen offset:3072 sc1 lds
  s_mov_b32 m0, s11
  s_waitcnt vmcnt(24)
  s_barrier
  buffer_load_dwordx4 v4, s[40:43], s7 offen offset:0 sc1 lds
  buffer_load_dwordx4 v5, s[40:43], s7 offen offset:1024 sc1 lds
  buffer_load_dwordx4 v6, s[40:43], s7 offen offset:2048 sc1 lds
  buffer_load_dwordx4 v7, s[40:43], s7 offen offset:3072 sc1 lds
Ll_105:
  s_add_u32 m0, s11, 8192
  s_add_u32 s3, s7, s95
  buffer_load_dwordx4 v4, s[40:43], s3 offen offset:0 sc1 lds
  s_add_u32 s12, s12, 1
  v_readlane_b32 s7, v9, s12
  s_add_u32 s11, s11, 16384
  buffer_load_dwordx4 v5, s[40:43], s3 offen offset:1024 sc1 lds
  s_cmp_eq_u32 s11, s15
  s_cselect_b32 s4, 65536, 0
  s_sub_u32 s11, s11, s4
  buffer_load_dwordx4 v6, s[40:43], s3 offen offset:2048 sc1 lds
  s_cmp_eq_u32 s12, Lz1-Lz0+16
  buffer_load_dwordx4 v7, s[40:43], s3 offen offset:3072 sc1 lds
  s_mov_b32 m0, s11
  s_cbranch_scc1 Ll_106
  s_waitcnt vmcnt(16)
  s_barrier
  buffer_load_dwordx4 v4, s[40:43], s7 offen offset:0 sc1 lds
  buffer_load_dwordx4 v5, s[40:43], s7 offen offset:1024 sc1 lds
  buffer_load_dwordx4 v6, s[40:43], s7 offen offset:2048 sc1 lds
  buffer_load_dwordx4 v7, s[40:43], s7 offen offset:3072 sc1 lds
  s_branch Ll_105
  s_nop 0
Ll_106:
  s_waitcnt vmcnt(16)
  s_barrier
  s_waitcnt vmcnt(8)
  s_barrier
  s_waitcnt vmcnt(0)
  s_barrier
  s_barrier
  s_mov_b32 s11, 0
  s_mov_b32 s15, 65536
  s_mul_i32 s5, s76, 16
  s_lshl_b32 s5, s5, 14
  s_add_u32 s5, s5, 7340032
  s_and_b32 s4, s76, 7
  s_add_u32 s6, s4, 1
  v_cmp_lt_u32 vcc, s6, v1
  v_add_u32 v9, s4, v1
  s_nop 0
  v_subbrev_co_u32 v9, vcc, 0, v9, vcc
  v_and_b32 v9, 7, v9
  v_subrev_u32 v2, 9, v1
  v_cmp_le_u32 vcc, s4, v2
  s_nop 1
  v_addc_co_u32 v2, vcc, 8, v2, vcc
  v_cmp_le_u32 vcc, 9, v1
  s_nop 1
  v_cndmask_b32 v9, v9, v2, vcc
  s_add_u32 s4, s4, Lz1-Lz0+8
  s_mov_b32 m0, s6
  s_nop 0
  v_writelane_b32 v9, s4, m0
  s_and_b32 s4, s76, 8
  v_xor_b32 v9, s4, v9
  v_cmp_eq_u32 vcc, s78, v9
  s_nop 0
  v_mov_b32_dpp v2, v9 row_shr:1 row_mask:0xf bank_mask:0xf
  s_ff1_i32_b32 s4, vcc_lo
  v_cmp_ge_u32 vcc, s4, v1
  s_nop 1
  v_cndmask_b32 v9, v9, v2, vcc
  v_writelane_b32 v9, s78, 0
  v_lshlrev_b32_e64 v11, 7, v9
  v_lshl_add_u32 v9, v9, 14, s5
  s_lshl_b32 s6, s76, Lz1-Lz0+14
  v_readlane_b32 s7, v9, 1
  s_mov_b32 s11, 16384
  s_mov_b32 s90, Lz1-Lz0+62
  s_add_u32 s91, s91, 4
  s_barrier
  s_mov_b32 s89, 200000
  s_mov_b32 exec_lo, s90
  s_mov_b32 exec_hi, 0
  buffer_load_dword v12, v11, s[40:43], s91 offen sc0 sc1
Lp_107:
  s_waitcnt vmcnt(0)
  v_cmp_ne_u32 vcc, 0, v12
  s_andn2_b32 s3, exec_lo, vcc_lo
  s_cbranch_scc0 Lp_108
  s_mov_b32 exec_lo, s3
  s_sleep 1
  buffer_load_dword v12, v11, s[40:43], s91 offen sc0 sc1
  s_sub_u32 s89, s89, 1
  s_cbranch_scc0 Lp_107
Lp_108:
  s_mov_b64 exec, -1
  s_mov_b32 s12, 1
  s_mov_b32 m0, s11
Ll_110:
  s_nop 0
  buffer_load_dwordx4 v4, s[72:75], s7 offen offset:0 sc1 lds
  buffer_load_dwordx4 v5, s[72:75], s7 offen offset:1024 sc1 lds
  buffer_load_dwordx4 v6, s[72:75], s7 offen offset:2048 sc1 lds
  buffer_load_dwordx4 v7, s[72:75], s7 offen offset:3072 sc1 lds
  s_add_u32 m0, s11, 4096
  s_nop 0
  s_add_u32 s5, s7, s13
  buffer_load_dwordx4 v4, s[72:75], s5 offen offset:0 sc1 lds
  buffer_load_dwordx4 v5, s[72:75], s5 offen offset:1024 sc1 lds
  buffer_load_dwordx4 v6, s[72:75], s5 offen offset:2048 sc1 lds
  buffer_load_dwordx4 v7, s[72:75], s5 offen offset:3072 sc1 lds
  s_add_u32 m0, s11, 8192
  s_nop 0
  s_add_u32 s3, s7, s95
  buffer_load_dwordx4 v4, s[72:75], s3 offen offset:0 sc1 lds
  buffer_load_dwordx4 v5, s[72:75], s3 offen offset:1024 sc1 lds
  buffer_load_dwordx4 v6, s[72:75], s3 offen offset:2048 sc1 lds
  buffer_load_dwordx4 v7, s[72:75], s3 offen offset:3072 sc1 lds
  s_add_u32 m0, s11, 12288
  s_add_u32 s5, s3, s13
  buffer_load_dwordx4 v4, s[72:75], s5 offen offset:0 sc1 lds
  s_add_u32 s12, s12, 1
  v_readlane_b32 s7, v9, s12
  s_add_u32 s11, s11, 16384
  buffer_load_dwordx4 v5, s[72:75], s5 offen offset:1024 sc1 lds
  s_cmp_eq_u32 s11, s15
  s_cselect_b32 s4, 65536, 0
  s_sub_u32 s11, s11, s4
  buffer_load_dwordx4 v6, s[72:75], s5 offen offset:2048 sc1 lds
  s_cmp_lg_u32 s12, Lz1-Lz0+4
  buffer_load_dwordx4 v7, s[72:75], s5 offen offset:3072 sc1 lds
  s_mov_b32 m0, s11
  s_cbranch_scc1 Ll_110
  s_waitcnt vmcnt(32)
  s_barrier
  buffer_load_dwordx4 v4, s[72:75], s7 offen offset:0 sc1 lds
  buffer_load_dwordx4 v5, s[72:75], s7 offen offset:1024 sc1 lds
  buffer_load_dwordx4 v6, s[72:75], s7 offen offset:2048 sc1 lds
  buffer_load_dwordx4 v7, s[72:75], s7 offen offset:3072 sc1 lds
Ll_115:
  s_add_u32 m0, s11, 4096
  s_nop 0
  s_add_u32 s5, s7, s13
  buffer_load_dwordx4 v4, s[72:75], s5 offen offset:0 sc1 lds
  buffer_load_dwordx4 v5, s[72:75], s5 offen offset:1024 sc1 lds
  buffer_load_dwordx4 v6, s[72:75], s5 offen offset:2048 sc1 lds
  buffer_load_dwordx4 v7, s[72:75], s5 offen offset:3072 sc1 lds
  s_add_u32 m0, s11, 8192
  s_nop 0
  s_add_u32 s3, s7, s95
  buffer_load_dwordx4 v4, s[72:75], s3 offen offset:0 sc1 lds
  buffer_load_dwordx4 v5, s[72:75], s3 offen offset:1024 sc1 lds
  buffer_load_dwordx4 v6, s[72:75], s3 offen offset:2048 sc1 lds
  buffer_load_dwordx4 v7, s[72:75], s3 offen offset:3072 sc1 lds
  s_add_u32 m0, s11, 12288
  s_add_u32 s5, s3, s13
  buffer_load_dwordx4 v4, s[72:75], s5 offen offset:0 sc1 lds
  s_add_u32 s12, s12, 1
  v_readlane_b32 s7, v9, s12
  s_add_u32 s11, s11, 16384
  buffer_load_dwordx4 v5, s[72:75], s5 offen offset:1024 sc1 lds
  s_cmp_eq_u32 s11, s15
  s_cselect_b32 s4, 65536, 0
  s_sub_u32 s11, s11, s4
  buffer_load_dwordx4 v6, s[72:75], s5 offen offset:2048 sc1 lds
  s_cmp_eq_u32 s12, Lz1-Lz0+16
  buffer_load_dwordx4 v7, s[72:75], s5 offen offset:3072 sc1 lds
  s_mov_b32 m0, s11
  s_cbranch_scc1 Ll_116
  s_waitcnt vmcnt(32)
  s_barrier
  buffer_load_dwordx4 v4, s[72:75], s7 offen offset:0 sc1 lds
  buffer_load_dwordx4 v5, s[72:75], s7 offen offset:1024 sc1 lds
  buffer_load_dwordx4 v6, s[72:75], s7 offen offset:2048 sc1 lds
  buffer_load_dwordx4 v7, s[72:75], s7 offen offset:3072 sc1 lds
  s_branch Ll_115
  s_nop 0
Ll_116:
  s_waitcnt vmcnt(32)
  s_barrier
  s_waitcnt vmcnt(16)
  s_barrier
  s_waitcnt vmcnt(0)
  s_barrier
  s_barrier
  s_mov_b32 s11, 0
  s_mov_b32 s15, 65536
  s_mul_i32 s5, s76, 56
  s_mul_i32 s4, s79, 28
  s_add_u32 s5, s5, s4
  s_lshl_b32 s5, s5, 14
  s_add_u32 s5, s5, 11534336
  v_subrev_u32 v2, 2, v1
  v_cmp_le_u32 vcc, 28, v1
  s_nop 1
  v_cndmask_b32 v10, v1, v2, vcc
  v_subrev_u32 v3, 3, v10
  v_mov_b32 v9, 4
  v_cmp_le_u32 vcc, 14, v10
  v_subrev_u32 v2, 14, v10
  s_nop 0
  v_cndmask_b32 v3, v3, v2, vcc
  v_cndmask_b32_e64 v9, v9, 12, vcc
  v_cmp_le_u32 vcc, 21, v10
  v_subrev_u32 v2, 21, v10
  s_nop 0
  v_cndmask_b32 v3, v3, v2, vcc
  v_cndmask_b32_e64 v9, v9, 20, vcc
  s_sub_u32 s4, s80, s76
  s_and_b32 s4, s4, 7
  v_cmp_le_u32 vcc, s4, v3
  v_mov_b32 v2, s76
  s_nop 0
  v_addc_co_u32 v3, vcc, v3, v2, vcc
  v_and_b32 v3, 7, v3
  v_add_u32 v9, v9, v3
  v_add_u32 v2, v2, v1
  v_and_b32 v2, 3, v2
  v_subrev_u32 v3, 10, v1
  v_cmp_gt_u32 vcc, 4, v3
  s_nop 1
  v_cndmask_b32 v9, v9, v2, vcc
  s_add_u32 s4, s80, Lz1-Lz0+4
  v_lshl_add_u32 v2, v1, 3, s4
  v_cmp_gt_u32 vcc, 3, v1
  s_nop 1
  v_cndmask_b32_e64 v9, v9, v2, vcc
  v_lshl_add_u32 v9, v9, 14, s5
  s_mul_i32 s4, s79, 917504
  s_sub_u32 s4, 458752, s4
  v_add_u32_e64 v2, s4, v9
  v_cmp_le_u32 vcc, 28, v1
  s_nop 1
  v_cndmask_b32 v9, v9, v2, vcc
  s_nop 0
  v_readlane_b32 s7, v9, 3
  s_mov_b32 s11, 49152
  s_add_u32 s91, s91, 4
  s_lshl_b32 s4, s79, 3
  s_lshl_b32 s90, 0xff, s4
  s_bitset0_b32 s90, s77
  s_mov_b32 s89, 200000
  s_mov_b32 exec_lo, s90
  s_mov_b32 exec_hi, Lz1-Lz0+0
  buffer_load_dword v12, v8, s[40:43], s91 offen sc0 sc1
Lp_117:
  s_waitcnt vmcnt(0)
  v_cmp_ne_u32 vcc, 0, v12
  s_andn2_b32 s3, exec_lo, vcc_lo
  s_cbranch_scc0 Lp_118
  s_mov_b32 exec_lo, s3
  s_sleep 1
  buffer_load_dword v12, v8, s[40:43], s91 offen sc0 sc1
  s_sub_u32 s89, s89, 1
  s_cbranch_scc0 Lp_117
Lp_118:
  s_mov_b64 exec, -1
  s_mov_b32 s12, 3
  s_mov_b32 m0, s11
Ll_120:
  s_nop 0
  buffer_load_dwordx4 v4, s[40:43], s7 offen offset:0 sc1 lds
  buffer_load_dwordx4 v5, s[40:43], s7 offen offset:1024 sc1 lds
  buffer_load_dwordx4 v6, s[40:43], s7 offen offset:2048 sc1 lds
  buffer_load_dwordx4 v7, s[40:43], s7 offen offset:3072 sc1 lds
  s_add_u32 m0, s11, 4096
  s_nop 0
  s_add_u32 s5, s7, s13
  buffer_load_dwordx4 v4, s[40:43], s5 offen offset:0 sc1 lds
  buffer_load_dwordx4 v5, s[40:43], s5 offen offset:1024 sc1 lds
  buffer_load_dwordx4 v6, s[40:43], s5 offen offset:2048 sc1 lds
  buffer_load_dwordx4 v7, s[40:43], s5 offen offset:3072 sc1 lds
  s_add_u32 m0, s11, 8192
  s_nop 0
  s_add_u32 s3, s7, s95
  buffer_load_dwordx4 v4, s[40:43], s3 offen offset:0 sc1 lds
  buffer_load_dwordx4 v5, s[40:43], s3 offen offset:1024 sc1 lds
  buffer_load_dwordx4 v6, s[40:43], s3 offen offset:2048 sc1 lds
  buffer_load_dwordx4 v7, s[40:43], s3 offen offset:3072 sc1 lds
  s_add_u32 m0, s11, 12288
  s_add_u32 s5, s3, s13
  buffer_load_dwordx4 v4, s[40:43], s5 offen offset:0 sc1 lds
  s_add_u32 s12, s12, 1
  v_readlane_b32 s7, v9, s12
  s_add_u32 s11, s11, 16384
  buffer_load_dwordx4 v5, s[40:43], s5 offen offset:1024 sc1 lds
  s_cmp_eq_u32 s11, s15
  s_cselect_b32 s4, 65536, 0
  s_sub_u32 s11, s11, s4
  buffer_load_dwordx4 v6, s[40:43], s5 offen offset:2048 sc1 lds
  s_cmp_lg_u32 s12, Lz1-Lz0+4
  buffer_load_dwordx4 v7, s[40:43], s5 offen offset:3072 sc1 lds
  s_mov_b32 m0, s11
  s_cbranch_scc1 Ll_120
  s_waitcnt vmcnt(48)
  s_barrier
Ll_125:
  s_waitcnt vmcnt(32)
  s_barrier
  buffer_load_dwordx4 v4, s[40:43], s7 offen offset:0 sc1 lds
  buffer_load_dwordx4 v5, s[40:43], s7 offen offset:1024 sc1 lds
  buffer_load_dwordx4 v6, s[40:43], s7 offen offset:2048 sc1 lds
  buffer_load_dwordx4 v7, s[40:43], s7 offen offset:3072 sc1 lds
Ll_126:
  s_add_u32 m0, s11, 4096
  s_nop 0
  s_add_u32 s5, s7, s13
  buffer_load_dwordx4 v4, s[40:43], s5 offen offset:0 sc1 lds
  buffer_load_dwordx4 v5, s[40:43], s5 offen offset:1024 sc1 lds
  buffer_load_dwordx4 v6, s[40:43], s5 offen offset:2048 sc1 lds
  buffer_load_dwordx4 v7, s[40:43], s5 offen offset:3072 sc1 lds
  s_add_u32 m0, s11, 8192
  s_nop 0
  s_add_u32 s3, s7, s95
  buffer_load_dwordx4 v4, s[40:43], s3 offen offset:0 sc1 lds
  buffer_load_dwordx4 v5, s[40:43], s3 offen offset:1024 sc1 lds
  buffer_load_dwordx4 v6, s[40:43], s3 offen offset:2048 sc1 lds
  buffer_load_dwordx4 v7, s[40:43], s3 offen offset:3072 sc1 lds
  s_add_u32 m0, s11, 12288
  s_add_u32 s5, s3, s13
  buffer_load_dwordx4 v4, s[40:43], s5 offen offset:0 sc1 lds
  s_add_u32 s12, s12, 1
  v_readlane_b32 s7, v9, s12
  s_add_u32 s11, s11, 16384
  buffer_load_dwordx4 v5, s[40:43], s5 offen offset:1024 sc1 lds
  s_cmp_eq_u32 s11, s15
  s_cselect_b32 s4, 65536, 0
  s_sub_u32 s11, s11, s4
  buffer_load_dwordx4 v6, s[40:43], s5 offen offset:2048 sc1 lds
  s_cmp_eq_u32 s12, Lz1-Lz0+30
  buffer_load_dwordx4 v7, s[40:43], s5 offen offset:3072 sc1 lds
  s_mov_b32 m0, s11
  s_cbranch_scc1 Ll_127
  s_waitcnt vmcnt(32)
  s_barrier
  buffer_load_dwordx4 v4, s[40:43], s7 offen offset:0 sc1 lds
  buffer_load_dwordx4 v5, s[40:43], s7 offen offset:1024 sc1 lds
  buffer_load_dwordx4 v6, s[40:43], s7 offen offset:2048 sc1 lds
  buffer_load_dwordx4 v7, s[40:43], s7 offen offset:3072 sc1 lds
  s_branch Ll_126
  s_nop 0
Ll_127:
  s_waitcnt vmcnt(32)
  s_barrier
  s_waitcnt vmcnt(16)
  s_barrier
  s_waitcnt vmcnt(0)
  s_barrier
  s_barrier
  s_cmp_lg_u32 s82, 0
  s_cbranch_scc1 L_lend
  s_mov_b32 s11, 0
  s_mov_b32 s15, 65536
  s_mul_i32 s5, s76, 16
  s_lshl_b32 s5, s5, 14
  s_add_u32 s5, s5, 35651584
  s_and_b32 s4, s76, 7
  s_add_u32 s6, s4, 1
  v_cmp_lt_u32 vcc, s6, v1
  v_add_u32 v9, s4, v1
  s_nop 0
  v_subbrev_co_u32 v9, vcc, 0, v9, vcc
  v_and_b32 v9, 7, v9
  v_subrev_u32 v2, 9, v1
  v_cmp_le_u32 vcc, s4, v2
  s_nop 1
  v_addc_co_u32 v2, vcc, 8, v2, vcc
  v_cmp_le_u32 vcc, 9, v1
  s_nop 1
  v_cndmask_b32 v9, v9, v2, vcc
  s_add_u32 s4, s4, Lz1-Lz0+8
  s_mov_b32 m0, s6
  s_nop 0
  v_writelane_b32 v9, s4, m0
  s_and_b32 s4, s76, 8
  v_xor_b32 v9, s4, v9
  v_cmp_eq_u32 vcc, s78, v9
  s_nop 0
  v_mov_b32_dpp v2, v9 row_shr:1 row_mask:0xf bank_mask:0xf
  s_ff1_i32_b32 s4, vcc_lo
  v_cmp_ge_u32 vcc, s4, v1
  s_nop 1
  v_cndmask_b32 v9, v9, v2, vcc
  v_writelane_b32 v9, s78, 0
  v_lshlrev_b32_e64 v11, 7, v9
  v_lshl_add_u32 v9, v9, 14, s5
  s_lshl_b32 s6, s76, Lz1-Lz0+14
  v_readlane_b32 s7, v9, 1
  s_mov_b32 s11, 16384
  s_add_u32 s91, s91, 8
  s_mov_b32 s90, 0x3e
  s_barrier
  s_mov_b32 s82, 1
  s_add_u32 s83, s83, 0
  s_add_u32 s87, s87, 32
  s_mov_b32 s89, 200000
  s_mov_b32 exec_lo, s90
  s_mov_b32 exec_hi, 0
  buffer_load_dword v12, v11, s[40:43], s91 offen sc0 sc1
Lp_128:
  s_waitcnt vmcnt(0)
  v_cmp_ne_u32 vcc, 0, v12
  s_andn2_b32 s3, exec_lo, vcc_lo
  s_cbranch_scc0 Lp_129
  s_mov_b32 exec_lo, s3
  s_sleep 1
  buffer_load_dword v12, v11, s[40:43], s91 offen sc0 sc1
  s_sub_u32 s89, s89, 1
  s_cbranch_scc0 Lp_128
Lp_129:
  s_mov_b64 exec, -1
  s_branch L_xlayer
  s_nop 0
L_s1:
  v_mov_b32 v11, 1
  v_mov_b32 v2, 156416
  ds_write_b128 v2, v[24:27]
  v_and_b32 v2, 31, v1
  v_lshlrev_b32 v5, 7, v2
  v_lshlrev_b32 v10, 3, v2
  v_lshrrev_b32 v3, 5, v1
  v_mul_u32_u24 v3, 320, v3
  v_add_u32_e64 v10, v3, v10
  v_add_u32 v10, 151552, v10
  v_bfe_u32 v3, v1, 3, 1
  v_and_b32 v2, 7, v1
  v_lshlrev_b32 v12, 9, v3
  v_lshl_add_u32 v12, v2, 4, v12
  v_mul_u32_u24 v3, 320, v3
  v_lshl_add_u32 v13, v2, 3, v3
  v_add_u32 v13, 151808, v13
  v_and_b32 v2, 15, v1
  v_lshlrev_b32 v8, 4, v2
  v_lshlrev_b32 v15, 6, v2
  v_and_b32 v3, 48, v1
  v_add_u32 v15, v15, v3
  v_and_b32 v2, 14, v1
  v_lshlrev_b32 v6, 2, v2
  v_lshlrev_b32 v14, 16, v1
  s_lshl_b32 s4, s77, 12
  s_lshl_b32 s5, s76, 7
  s_add_u32 s4, s4, s5
  v_add_u32 v14, s4, v14
  v_lshrrev_b32 v2, 2, v1
  v_lshlrev_b32 v22, 7, v2
  v_lshlrev_b32 v96, 6, v2
  v_and_b32 v2, 3, v1
  v_lshl_add_u32 v22, v2, 3, v22
  v_lshl_add_u32 v96, v2, 3, v96
  v_add_u32 v22, 65536, v22
  v_add_u32 v96, 90112, v96
  v_bfe_u32 v3, v1, 3, 2
  v_xor_b32_e64 v2, 0, v3
  v_lshl_add_u32 v16, v2, 5, v22
  v_xor_b32_e64 v2, 1, v3
  v_lshl_add_u32 v17, v2, 5, v22
  v_xor_b32_e64 v2, 2, v3
  v_lshl_add_u32 v18, v2, 5, v22
  v_xor_b32_e64 v2, 3, v3
  v_lshl_add_u32 v19, v2, 5, v22
  v_bfe_u32 v3, v1, 4, 1
  v_xor_b32_e64 v2, 0, v3
  v_lshl_add_u32 v20, v2, 5, v96
  v_xor_b32_e64 v2, 1, v3
  v_lshl_add_u32 v21, v2, 5, v96
  v_mov_b32 v22, 0x3f803f80
  s_mul_i32 s4, s76, 11
  s_lshr_b32 s4, s4, 5
  s_mul_i32 s4, s4, 3
  s_and_b32 s14, s76, 1
  s_mov_b32 s15, 32768
  s_mul_i32 s4, s14, 24576
  v_add_u32 v16, s4, v16
  v_add_u32 v17, s4, v17
  v_add_u32 v18, s4, v18
  v_add_u32 v19, s4, v19
  s_mov_b32 s98, 0x00010001
  s_mov_b32 s99, 0x00010001
  v_cndmask_b32_e64 v200, 0, v22, s[98:99]
  v_cndmask_b32_e64 v201, 0, v22, s[98:99]
  v_cndmask_b32_e64 v202, 0, v22, s[98:99]
  v_cndmask_b32_e64 v203, 0, v22, s[98:99]
  s_nop 0
  s_lshl_b64 s[98:99], s[98:99], 1
  v_cndmask_b32_e64 v204, 0, v22, s[98:99]
  v_cndmask_b32_e64 v205, 0, v22, s[98:99]
  v_cndmask_b32_e64 v206, 0, v22, s[98:99]
  v_cndmask_b32_e64 v207, 0, v22, s[98:99]
  s_nop 0
  s_lshl_b64 s[98:99], s[98:99], 1
  v_cndmask_b32_e64 v208, 0, v22, s[98:99]
  v_cndmask_b32_e64 v209, 0, v22, s[98:99]
  v_cndmask_b32_e64 v210, 0, v22, s[98:99]
  v_cndmask_b32_e64 v211, 0, v22, s[98:99]
  s_nop 0
  s_lshl_b64 s[98:99], s[98:99], 1
  v_cndmask_b32_e64 v212, 0, v22, s[98:99]
  v_cndmask_b32_e64 v213, 0, v22, s[98:99]
  v_cndmask_b32_e64 v214, 0, v22, s[98:99]
  v_cndmask_b32_e64 v215, 0, v22, s[98:99]
  s_nop 0
  s_lshl_b64 s[98:99], s[98:99], 1
  v_cndmask_b32_e64 v216, 0, v22, s[98:99]
  v_cndmask_b32_e64 v217, 0, v22, s[98:99]
  v_cndmask_b32_e64 v218, 0, v22, s[98:99]
  v_cndmask_b32_e64 v219, 0, v22, s[98:99]
  s_nop 0
  s_lshl_b64 s[98:99], s[98:99], 1
  v_cndmask_b32_e64 v220, 0, v22, s[98:99]
  v_cndmask_b32_e64 v221, 0, v22, s[98:99]
  v_cndmask_b32_e64 v222, 0, v22, s[98:99]
  v_cndmask_b32_e64 v223, 0, v22, s[98:99]
  s_nop 0
  s_lshl_b64 s[98:99], s[98:99], 1
  v_cndmask_b32_e64 v224, 0, v22, s[98:99]
  v_cndmask_b32_e64 v225, 0, v22, s[98:99]
  v_cndmask_b32_e64 v226, 0, v22, s[98:99]
  v_cndmask_b32_e64 v227, 0, v22, s[98:99]
  s_nop 0
  s_lshl_b64 s[98:99], s[98:99], 1
  v_cndmask_b32_e64 v228, 0, v22, s[98:99]
  v_cndmask_b32_e64 v229, 0, v22, s[98:99]
  v_cndmask_b32_e64 v230, 0, v22, s[98:99]
  v_cndmask_b32_e64 v231, 0, v22, s[98:99]
  s_nop 0
  s_lshl_b64 s[98:99], s[98:99], 1
  v_cndmask_b32_e64 v232, 0, v22, s[98:99]
  v_cndmask_b32_e64 v233, 0, v22, s[98:99]
  v_cndmask_b32_e64 v234, 0, v22, s[98:99]
  v_cndmask_b32_e64 v235, 0, v22, s[98:99]
  s_nop 0
  s_lshl_b64 s[98:99], s[98:99], 1
  v_cndmask_b32_e64 v236, 0, v22, s[98:99]
  v_cndmask_b32_e64 v237, 0, v22, s[98:99]
  v_cndmask_b32_e64 v238, 0, v22, s[98:99]
  v_cndmask_b32_e64 v239, 0, v22, s[98:99]
  s_nop 0
  s_lshl_b64 s[98:99], s[98:99], 1
  v_cndmask_b32_e64 v240, 0, v22, s[98:99]
  v_cndmask_b32_e64 v241, 0, v22, s[98:99]
  v_cndmask_b32_e64 v242, 0, v22, s[98:99]
  v_cndmask_b32_e64 v243, 0, v22, s[98:99]
  s_nop 0
  s_lshl_b64 s[98:99], s[98:99], 1
  v_cndmask_b32_e64 v244, 0, v22, s[98:99]
  v_cndmask_b32_e64 v245, 0, v22, s[98:99]
  v_cndmask_b32_e64 v246, 0, v22, s[98:99]
  v_cndmask_b32_e64 v247, 0, v22, s[98:99]
  s_lshl_b64 s[98:99], s[98:99], 1
  s_mov_b32 s56, s24
  s_and_b32 s57, s25, 0xffff
  s_mov_b32 s58, 7340032
  s_mov_b32 s59, 0x00020000
  s_nop 0
  s_mov_b32 s60, s28
  s_and_b32 s61, s29, 0xffff
  s_mov_b32 s62, 7340032
  s_mov_b32 s63, 0x00020000
  s_mul_i32 s12, s84, Lz1-Lz0+14
  s_add_u32 s12, s12, 20480
  s_mov_b32 s13, s12
  v_lshlrev_b32 v110, 7, v1
  s_mov_b32 s8, 0x00500005
  s_mov_b32 s9, 0x50000500
L_slayer:
  s_barrier
  s_cmp_lg_u32 s82, Lz1-Lz0+0
  s_cbranch_scc1 L_131
  buffer_load_dwordx4 v[128:131], v108, s[44:47], s7 offen offset:0
  buffer_load_dwordx4 v[132:135], v108, s[44:47], s7 offen offset:128
  buffer_load_dwordx4 v[136:139], v108, s[44:47], s7 offen offset:256
  buffer_load_dwordx4 v[140:143], v108, s[44:47], s7 offen offset:384
  buffer_load_dwordx4 v[144:147], v108, s[44:47], s7 offen offset:512
  buffer_load_dwordx4 v[148:151], v108, s[44:47], s7 offen offset:640
  buffer_load_dwordx4 v[152:155], v108, s[44:47], s7 offen offset:768
  buffer_load_dwordx4 v[156:159], v108, s[44:47], s7 offen offset:896
  buffer_load_dwordx4 v[160:163], v108, s[44:47], s7 offen offset:1024
  buffer_load_dwordx4 v[164:167], v108, s[44:47], s7 offen offset:1152
  buffer_load_dwordx4 v[168:171], v108, s[44:47], s7 offen offset:1280
  buffer_load_dwordx4 v[172:175], v108, s[44:47], s7 offen offset:1408
  buffer_load_dwordx4 v[176:179], v108, s[44:47], s7 offen offset:1536
  buffer_load_dwordx4 v[180:183], v108, s[44:47], s7 offen offset:1664
  buffer_load_dwordx4 v[184:187], v108, s[44:47], s7 offen offset:1792
  buffer_load_dwordx4 v[188:191], v108, s[44:47], s7 offen offset:1920
  s_waitcnt vmcnt(16)
  s_lshl_b32 s4, s76, 4
  s_mov_b64 exec, 1
  buffer_atomic_add v11, v24, s[68:71], s4 offen sc1
  s_mov_b64 exec, -1
L_131:
  s_cmp_le_u32 s14, 0
  s_cbranch_scc1 L_133
  s_barrier
L_133:
  s_cmp_le_u32 s14, 1
  s_cbranch_scc1 L_134
  s_barrier
L_134:
  s_cmp_lg_u32 s82, 0
  s_cbranch_scc1 L_135
  ds_read_b64_tr_b16 v[32:33], v16 offset:0
  ds_read_b64_tr_b16 v[34:35], v16 offset:2048
  ds_read_b64_tr_b16 v[36:37], v17 offset:0
  ds_read_b64_tr_b16 v[38:39], v17 offset:2048
  ds_read_b64_tr_b16 v[40:41], v18 offset:0
  ds_read_b64_tr_b16 v[42:43], v18 offset:2048
  ds_read_b64_tr_b16 v[44:45], v19 offset:0
  ds_read_b64_tr_b16 v[46:47], v19 offset:2048
  ds_read_b64_tr_b16 v[48:49], v16 offset:4096
  ds_read_b64_tr_b16 v[50:51], v16 offset:6144
  ds_read_b64_tr_b16 v[52:53], v17 offset:4096
  ds_read_b64_tr_b16 v[54:55], v17 offset:6144
  s_nop 0
  s_waitcnt lgkmcnt(4)
  ds_read_b64_tr_b16 v[56:57], v18 offset:4096
  ds_read_b64_tr_b16 v[58:59], v18 offset:6144
  ds_read_b64_tr_b16 v[60:61], v19 offset:4096
  ds_read_b64_tr_b16 v[62:63], v19 offset:6144
  v_add_u32 v16, 8192, v16
  v_add_u32 v17, 8192, v17
  v_add_u32 v18, 8192, v18
  v_add_u32 v19, 8192, v19
  s_nop 0
  s_waitcnt lgkmcnt(2)
  ds_read_b64_tr_b16 v[64:65], v16 offset:0
  ds_read_b64_tr_b16 v[66:67], v16 offset:2048
  ds_read_b64_tr_b16 v[68:69], v17 offset:0
  ds_read_b64_tr_b16 v[70:71], v17 offset:2048
  ds_read_b64_tr_b16 v[72:73], v18 offset:0
  ds_read_b64_tr_b16 v[74:75], v18 offset:2048
  ds_read_b64_tr_b16 v[76:77], v19 offset:0
  ds_read_b64_tr_b16 v[78:79], v19 offset:2048
  ds_read_b64_tr_b16 v[80:81], v16 offset:4096
  ds_read_b64_tr_b16 v[82:83], v16 offset:6144
  ds_read_b64_tr_b16 v[84:85], v17 offset:4096
  ds_read_b64_tr_b16 v[86:87], v17 offset:6144
  s_nop 0
  s_waitcnt lgkmcnt(4)
  ds_read_b64_tr_b16 v[88:89], v18 offset:4096
  ds_read_b64_tr_b16 v[90:91], v18 offset:6144
  ds_read_b64_tr_b16 v[92:93], v19 offset:4096
  ds_read_b64_tr_b16 v[94:95], v19 offset:6144
  v_add_u32 v16, 8192, v16
  v_add_u32 v17, 8192, v17
  v_add_u32 v18, 8192, v18
  v_add_u32 v19, 8192, v19
  v_mfma_f32_16x16x32_bf16 v[28:31], v[32:35], v[200:203], 0
  v_mfma_f32_16x16x32_bf16 v[28:31], v[36:39], v[204:207], v[28:31]
  v_mfma_f32_16x16x32_bf16 v[28:31], v[40:43], v[208:211], v[28:31]
  v_mfma_f32_16x16x32_bf16 v[28:31], v[44:47], v[212:215], v[28:31]
  v_mfma_f32_16x16x32_bf16 v[28:31], v[48:51], v[200:203], v[28:31]
  v_mfma_f32_16x16x32_bf16 v[28:31], v[52:55], v[204:207], v[28:31]
  v_mfma_f32_16x16x32_bf16 v[28:31], v[56:59], v[208:211], v[28:31]
  v_mfma_f32_16x16x32_bf16 v[28:31], v[60:63], v[212:215], v[28:31]
  s_nop 0
  s_waitcnt lgkmcnt(2)
  ds_read_b64_tr_b16 v[32:33], v16 offset:0
  ds_read_b64_tr_b16 v[34:35], v16 offset:2048
  ds_read_b64_tr_b16 v[36:37], v17 offset:0
  ds_read_b64_tr_b16 v[38:39], v17 offset:2048
  ds_read_b64_tr_b16 v[40:41], v18 offset:0
  ds_read_b64_tr_b16 v[42:43], v18 offset:2048
  ds_read_b64_tr_b16 v[44:45], v19 offset:0
  ds_read_b64_tr_b16 v[46:47], v19 offset:2048
  ds_read_b64_tr_b16 v[48:49], v16 offset:4096
  ds_read_b64_tr_b16 v[50:51], v16 offset:6144
  ds_read_b64_tr_b16 v[52:53], v17 offset:4096
  ds_read_b64_tr_b16 v[54:55], v17 offset:6144
  s_nop 0
  s_waitcnt lgkmcnt(4)
  ds_read_b64_tr_b16 v[56:57], v18 offset:4096
  ds_read_b64_tr_b16 v[58:59], v18 offset:6144
  ds_read_b64_tr_b16 v[60:61], v19 offset:4096
  ds_read_b64_tr_b16 v[62:63], v19 offset:6144
  v_mfma_f32_16x16x32_bf16 v[28:31], v[64:67], v[216:219], v[28:31]
  v_mfma_f32_16x16x32_bf16 v[28:31], v[68:71], v[220:223], v[28:31]
  v_mfma_f32_16x16x32_bf16 v[28:31], v[72:75], v[224:227], v[28:31]
  v_mfma_f32_16x16x32_bf16 v[28:31], v[76:79], v[228:231], v[28:31]
  v_mfma_f32_16x16x32_bf16 v[28:31], v[80:83], v[216:219], v[28:31]
  v_mfma_f32_16x16x32_bf16 v[28:31], v[84:87], v[220:223], v[28:31]
  v_mfma_f32_16x16x32_bf16 v[28:31], v[88:91], v[224:227], v[28:31]
  v_mfma_f32_16x16x32_bf16 v[28:31], v[92:95], v[228:231], v[28:31]
  s_waitcnt lgkmcnt(0)
L_135:
  s_barrier
  s_cmp_lg_u32 s82, 0
  s_cbranch_scc1 L_137
  v_mfma_f32_16x16x32_bf16 v[28:31], v[32:35], v[232:235], v[28:31]
  v_mfma_f32_16x16x32_bf16 v[28:31], v[36:39], v[236:239], v[28:31]
  v_mfma_f32_16x16x32_bf16 v[28:31], v[40:43], v[240:243], v[28:31]
  v_mfma_f32_16x16x32_bf16 v[28:31], v[44:47], v[244:247], v[28:31]
  v_mfma_f32_16x16x32_bf16 v[28:31], v[48:51], v[232:235], v[28:31]
  v_mfma_f32_16x16x32_bf16 v[28:31], v[52:55], v[236:239], v[28:31]
  v_mfma_f32_16x16x32_bf16 v[28:31], v[56:59], v[240:243], v[28:31]
  v_mfma_f32_16x16x32_bf16 v[28:31], v[60:63], v[244:247], v[28:31]
  s_lshl_b32 s5, s77, 14
  s_lshl_b32 s4, s76, 10
  s_add_u32 s5, s5, s4
  s_add_u32 s5, s5, 1114112
  s_nop 3
  buffer_store_dwordx4 v[28:31], v15, s[40:43], s5 offen sc0 sc1
  s_branch L_138
L_137:
  s_lshl_b32 s91, s84, 1
  s_add_u32 s91, s91, s87
  s_add_u32 s91, s91, 0xfffffff0
  s_mov_b32 s16, 0xffff
  s_mov_b32 exec_lo, s16
  s_mov_b32 exec_hi, 0
  buffer_load_dword v7, v5, s[40:43], s91 offen sc0 sc1
  s_mov_b64 exec, -1
L_138:
  s_barrier
  s_cmp_lg_u32 s82, 0
  s_cbranch_scc1 L_139
  s_branch L_140
L_139:
  s_waitcnt vmcnt(0)
  s_mov_b32 s89, 200000
  s_mov_b32 exec_lo, s16
  s_mov_b32 exec_hi, 0
  s_branch Lp_142
Lp_141:
  buffer_load_dword v7, v5, s[40:43], s91 offen sc0 sc1
  s_waitcnt vmcnt(0)
Lp_142:
  v_cmp_ne_u32 vcc, 0, v7
  s_andn2_b32 s3, s16, vcc_lo
  s_cbranch_scc0 Lp_143
  s_sleep 1
  s_sub_u32 s89, s89, 1
  s_cbranch_scc0 Lp_141
Lp_143:
  s_mov_b64 exec, -1
  s_add_u32 s5, s84, s92
  buffer_load_dwordx2 v[96:97], v6, s[40:43], s5 offen offset:0 sc1
  buffer_load_dwordx2 v[98:99], v6, s[40:43], s5 offen offset:512 sc1
  buffer_load_dwordx2 v[100:101], v6, s[40:43], s5 offen offset:1024 sc1
  buffer_load_dwordx2 v[102:103], v6, s[40:43], s5 offen offset:1536 sc1
L_140:
  s_barrier
  s_cmp_gt_u32 s14, 0
  s_cbranch_scc1 L_144
  s_barrier
L_144:
  s_cmp_gt_u32 s14, Lz1-Lz0+1
  s_cbranch_scc1 L_145
  s_barrier
L_145:
  s_cmp_lg_u32 s82, 0
  s_cbranch_scc1 L_146
  s_waitcnt vmcnt(2)
  buffer_load_dword v9, v8, s[68:71], 0 offen sc0 sc1
  s_mov_b32 s72, s26
  s_and_b32 s73, s27, 0xffff
  s_mov_b32 s74, 7168
  s_mov_b32 s75, 0x00020000
  s_mul_i32 s4, s77, 448
  s_and_b32 s5, s77, Lz1-Lz0+1
  s_lshl_b32 s6, s5, 6
  s_add_u32 s6, s6, s4
  s_mul_i32 s5, s5, 384
  s_sub_u32 s5, s4, s5
  v_lshlrev_b32 v2, 1, v1
  v_lshrrev_b32 v3, 1, v2
  v_xor_b32 v3, v3, v2
  v_and_b32 v3, 16, v3
  v_mul_u32_u24 v3, 3, v3
  v_xor_b32_e64 v3, v3, v2
  buffer_load_ushort v104, v2, s[72:75], s6 offen offset:0
  buffer_load_ushort v105, v2, s[72:75], s6 offen offset:128
  buffer_load_ushort v106, v2, s[72:75], s6 offen offset:256
  buffer_load_ushort v107, v3, s[72:75], s5 offen offset:384
  s_nop 0
  s_mov_b32 s64, s30
  s_and_b32 s65, s31, 0xffff
  s_mov_b32 s66, 2048
  s_mov_b32 s67, 0x00020000
  s_lshl_b32 s4, s78, Lz1-Lz0+7
  buffer_load_ushort v108, v2, s[64:67], s4 offen
  v_mov_b32 v32, v22
  v_mov_b32 v33, v22
  v_mov_b32_e64 v34, v22
  v_mov_b32 v35, v22
  s_nop 1
  v_mfma_f32_16x16x32_bf16 v[96:99], v[32:35], v[128:131], 0
  v_mfma_f32_16x16x32_bf16 v[100:103], v[128:131], v[128:131], 0
  v_mfma_f32_16x16x32_bf16 v[96:99], v[32:35], v[132:135], v[96:99]
  v_mfma_f32_16x16x32_bf16 v[100:103], v[132:135], v[132:135], v[100:103]
  v_mfma_f32_16x16x32_bf16 v[96:99], v[32:35], v[136:139], v[96:99]
  v_mfma_f32_16x16x32_bf16 v[100:103], v[136:139], v[136:139], v[100:103]
  v_mfma_f32_16x16x32_bf16 v[96:99], v[32:35], v[140:143], v[96:99]
  v_mfma_f32_16x16x32_bf16 v[100:103], v[140:143], v[140:143], v[100:103]
L_146:
  s_barrier
  s_cmp_lg_u32 s82, Lz1-Lz0+0
  s_cbranch_scc1 L_148
  v_mfma_f32_16x16x32_bf16 v[96:99], v[32:35], v[144:147], v[96:99]
  v_mfma_f32_16x16x32_bf16 v[100:103], v[144:147], v[144:147], v[100:103]
  v_mfma_f32_16x16x32_bf16 v[96:99], v[32:35], v[148:151], v[96:99]
  v_mfma_f32_16x16x32_bf16 v[100:103], v[148:151], v[148:151], v[100:103]
  v_mfma_f32_16x16x32_bf16 v[96:99], v[32:35], v[152:155], v[96:99]
  v_mfma_f32_16x16x32_bf16 v[100:103], v[152:155], v[152:155], v[100:103]
  v_mfma_f32_16x16x32_bf16 v[96:99], v[32:35], v[156:159], v[96:99]
  v_mfma_f32_16x16x32_bf16 v[100:103], v[156:159], v[156:159], v[100:103]
L_148:
  s_barrier
  s_cmp_lg_u32 s82, Lz1-Lz0+0
  s_cbranch_scc1 L_150
  v_mfma_f32_16x16x32_bf16 v[96:99], v[32:35], v[160:163], v[96:99]
  v_mfma_f32_16x16x32_bf16 v[100:103], v[160:163], v[160:163], v[100:103]
  v_mfma_f32_16x16x32_bf16 v[96:99], v[32:35], v[164:167], v[96:99]
  v_mfma_f32_16x16x32_bf16 v[100:103], v[164:167], v[164:167], v[100:103]
  v_mfma_f32_16x16x32_bf16 v[96:99], v[32:35], v[168:171], v[96:99]
  v_mfma_f32_16x16x32_bf16 v[100:103], v[168:171], v[168:171], v[100:103]
  v_mfma_f32_16x16x32_bf16 v[96:99], v[32:35], v[172:175], v[96:99]
  v_mfma_f32_16x16x32_bf16 v[100:103], v[172:175], v[172:175], v[100:103]
  s_waitcnt vmcnt(0)
  s_mov_b32 s89, 200000
  s_branch Lg_153
Lg_152:
  buffer_load_dword v9, v8, s[68:71], 0 offen sc0 sc1
  s_waitcnt vmcnt(0)
Lg_153:
  v_cmp_eq_u32 vcc, 16, v9
  s_andn2_b32 s3, 0xffff, vcc_lo
  s_cbranch_scc0 Lg_154
  s_sleep 2
  s_sub_u32 s89, s89, 1
  s_cbranch_scc0 Lg_152
Lg_154:
  s_mov_b32 s5, 1835008
  s_mov_b64 exec, 0x101
  buffer_store_dword v11, v14, s[40:43], s5 offen sc0 sc1
  s_mov_b64 exec, -1
  s_getpc_b64 s[4:5]
L_pc0:
  s_sub_u32 s4, s4, L_pc0-mega_kernel
  s_nop 0
  s_subb_u32 s5, s5, 0
  s_bfe_u32 s6, s2, 0x20003
  s_mul_i32 s6, s6, 10240
  v_lshl_add_u32 v3, v1, 4, s6
  v_mov_b32_e64 v119, s5
  v_min_u32 v118, L_end-mega_kernel-16, v3
  v_add_co_u32_e64 v116, vcc, s4, v118
  v_add_u32 v3, 0x400, v3
  s_nop 0
  v_addc_co_u32 v117, vcc, 0, v119, vcc
  global_load_dwordx4 v[112:115], v[116:117], off
  v_min_u32 v118, L_end-mega_kernel-16, v3
  v_add_co_u32_e64 v116, vcc, s4, v118
  v_add_u32 v3, 0x400, v3
  s_nop 0
  v_addc_co_u32 v117, vcc, 0, v119, vcc
  global_load_dwordx4 v[112:115], v[116:117], off
  v_min_u32 v118, L_end-mega_kernel-16, v3
  v_add_co_u32_e64 v116, vcc, s4, v118
  v_add_u32 v3, 0x400, v3
  s_nop 0
  v_addc_co_u32 v117, vcc, 0, v119, vcc
  global_load_dwordx4 v[112:115], v[116:117], off
  v_min_u32 v118, L_end-mega_kernel-16, v3
  v_add_co_u32_e64 v116, vcc, s4, v118
  v_add_u32 v3, 0x400, v3
  s_nop 0
  v_addc_co_u32 v117, vcc, 0, v119, vcc
  global_load_dwordx4 v[112:115], v[116:117], off
  v_min_u32 v118, L_end-mega_kernel-16, v3
  v_add_co_u32 v116, vcc, s4, v118
  s_nop 1
  v_addc_co_u32 v117, vcc, 0, v119, vcc
  global_load_dwordx4 v[112:115], v[116:117], off
L_150:
  s_barrier
  s_cmp_lg_u32 s82, 0
  s_cbranch_scc1 L_155
  v_mfma_f32_16x16x32_bf16 v[96:99], v[32:35], v[176:179], v[96:99]
  v_mfma_f32_16x16x32_bf16 v[100:103], v[176:179], v[176:179], v[100:103]
  v_mfma_f32_16x16x32_bf16 v[96:99], v[32:35], v[180:183], v[96:99]
  v_mfma_f32_16x16x32_bf16 v[100:103], v[180:183], v[180:183], v[100:103]
  v_mfma_f32_16x16x32_bf16 v[96:99], v[32:35], v[184:187], v[96:99]
  v_mfma_f32_16x16x32_bf16 v[100:103], v[184:187], v[184:187], v[100:103]
  v_mfma_f32_16x16x32_bf16 v[96:99], v[32:35], v[188:191], v[96:99]
  v_mfma_f32_16x16x32_bf16 v[100:103], v[188:191], v[188:191], v[100:103]
  s_getpc_b64 s[4:5]
L_pc1:
  s_sub_u32 s4, s4, L_pc1-mega_kernel
  s_subb_u32 s5, s5, 0
  s_bfe_u32 s6, s2, 0x20003
  s_mul_i32 s6, s6, 10240
  s_add_u32 s6, s6, 5120
  v_lshl_add_u32 v3, v1, 4, s6
  v_mov_b32_e64 v119, s5
  v_min_u32 v118, L_end-mega_kernel-16, v3
  v_add_co_u32_e64 v116, vcc, s4, v118
  v_add_u32 v3, 0x400, v3
  s_nop 0
  v_addc_co_u32 v117, vcc, 0, v119, vcc
  global_load_dwordx4 v[112:115], v[116:117], off
  v_min_u32 v118, L_end-mega_kernel-16, v3
  v_add_co_u32_e64 v116, vcc, s4, v118
  v_add_u32 v3, 0x400, v3
  s_nop 0
  v_addc_co_u32 v117, vcc, 0, v119, vcc
  global_load_dwordx4 v[112:115], v[116:117], off
  v_min_u32 v118, L_end-mega_kernel-16, v3
  v_add_co_u32_e64 v116, vcc, s4, v118
  v_add_u32 v3, 0x400, v3
  s_nop 0
  v_addc_co_u32 v117, vcc, 0, v119, vcc
  global_load_dwordx4 v[112:115], v[116:117], off
  v_min_u32 v118, L_end-mega_kernel-16, v3
  v_add_co_u32_e64 v116, vcc, s4, v118
  v_add_u32 v3, 0x400, v3
  s_nop 0
  v_addc_co_u32 v117, vcc, 0, v119, vcc
  global_load_dwordx4 v[112:115], v[116:117], off
  v_min_u32 v118, L_end-mega_kernel-16, v3
  v_add_co_u32 v116, vcc, s4, v118
  s_nop 1
  v_addc_co_u32_e64 v117, vcc, 0, v119, vcc
  global_load_dwordx4 v[112:115], v[116:117], off
  s_mov_b32 s98, 0xaaaaaaaa
  s_mov_b32 s99, 0xaaaaaaaa
  v_cndmask_b32_e64 v100, v100, v101, s[98:99]
  v_cndmask_b32_e64 v102, v102, v103, s[98:99]
  s_mov_b32 s98, 0xcccccccc
  s_mov_b32 s99, 0xcccccccc
  v_cndmask_b32_e64 v97, v100, v102, s[98:99]
  v_add_f32_dpp v96, v96, v96 quad_perm:[1,0,3,2] row_mask:0xf bank_mask:0xf
  s_nop 0
  v_add_f32_dpp v97, v97, v97 quad_perm:[1,0,3,2] row_mask:0xf bank_mask:0xf
  s_branch L_156
L_155:
  s_waitcnt vmcnt(0)
  v_add_f32 v96, v96, v100
  v_add_f32 v97, v97, v101
  v_add_f32 v98, v98, v102
  v_add_f32 v99, v99, v103
  v_add_f32 v96, v96, v98
  v_add_f32 v97, v97, v99
  s_nop 0
  v_add_f32_dpp v96, v96, v96 row_ror:8 row_mask:0xf bank_mask:0xf
  v_add_f32_dpp v97, v97, v97 row_ror:8 row_mask:0xf bank_mask:0xf
  v_mov_b32 v98, v96
  v_mov_b32 v99, v97
  s_nop 0
  v_permlane16_swap_b32 v96, v98
  v_permlane16_swap_b32 v97, v99
  v_add_f32 v96, v96, v98
  v_add_f32 v97, v97, v99
  v_mov_b32 v98, v96
  v_mov_b32 v99, v97
  s_nop 0
  v_permlane32_swap_b32 v96, v98
  v_permlane32_swap_b32 v97, v99
  v_add_f32 v96, v96, v98
  v_add_f32 v97, v97, v99
L_156:
  v_mul_f32 v96, 0x3a800000, v96
  v_mul_f32 v97, 0x3a800000, v97
  v_fma_f32 v98, -v96, v96, v97
  v_max_f32_e64 v98, 0, v98
  v_add_f32 v98, 0x3727c5ac, v98
  v_rsq_f32 v98, v98
  s_nop 0
  v_mul_f32 v99, v96, v98
  s_mov_b64 exec, s[8:9]
  buffer_store_dwordx2 v[98:99], v6, s[40:43], s10 offen sc0 sc1
  s_mov_b64 exec, -1
  s_barrier
  s_cmp_lg_u32 s82, 0
  s_cbranch_scc1 L_157
  v_lshlrev_b32_e64 v6, 3, v1
  s_mov_b64 s[8:9], 0xff
  s_lshl_b32 s91, s84, Lz1-Lz0+1
  s_and_b32 s91, s91, 0x8f000
  s_add_u32 s91, s91, 1835008
  s_mov_b32 exec_lo, 0xffff
  s_mov_b32 exec_hi, Lz1-Lz0+0
  buffer_load_dword v7, v5, s[40:43], s91 offen sc0 sc1
  s_mov_b64 exec, -1
L_157:
  s_barrier
  s_barrier
  s_waitcnt vmcnt(0)
  s_and_b32 s5, s10, 0xfffffc00
  buffer_load_dwordx4 v[120:123], v4, s[40:43], s5 offen sc1
  s_cmp_lg_u32 s82, 0
  s_cbranch_scc1 L_159
  s_mov_b32 s89, 200000
  s_mov_b32 exec_lo, 0xffff
  s_mov_b32 exec_hi, 0
  s_branch Lp_162
Lp_161:
  buffer_load_dword v7, v5, s[40:43], s91 offen sc0 sc1
  s_waitcnt vmcnt(0)
Lp_162:
  v_cmp_ne_u32 vcc, 0, v7
  s_andn2_b32 s3, 0xffff, vcc_lo
  s_cbranch_scc0 Lp_163
  s_sleep 1
  s_sub_u32 s89, s89, 1
  s_cbranch_scc0 Lp_161
Lp_163:
  s_mov_b64 exec, -1
  s_lshl_b32 s5, s77, 14
  s_add_u32 s5, s5, 1114112
  buffer_load_dwordx4 v[192:195], v4, s[40:43], s5 offen offset:0 sc1
  buffer_load_dwordx4 v[196:199], v4, s[40:43], s5 offen offset:1024 sc1
  buffer_load_dwordx4 v[200:203], v4, s[40:43], s5 offen offset:2048 sc1
  buffer_load_dwordx4 v[204:207], v4, s[40:43], s5 offen offset:3072 sc1
  s_add_u32 s5, s5, 4096
  buffer_load_dwordx4 v[208:211], v4, s[40:43], s5 offen offset:0 sc1
  buffer_load_dwordx4 v[212:215], v4, s[40:43], s5 offen offset:1024 sc1
  buffer_load_dwordx4 v[216:219], v4, s[40:43], s5 offen offset:2048 sc1
  buffer_load_dwordx4 v[220:223], v4, s[40:43], s5 offen offset:3072 sc1
L_159:
  s_barrier
  s_cmp_lg_u32 s82, 0
  s_cbranch_scc1 L_164
  s_lshl_b32 s5, s77, 14
  s_add_u32 s5, s5, 1122304
  buffer_load_dwordx4 v[224:227], v4, s[40:43], s5 offen offset:0 sc1
  buffer_load_dwordx4 v[228:231], v4, s[40:43], s5 offen offset:1024 sc1
  buffer_load_dwordx4 v[232:235], v4, s[40:43], s5 offen offset:2048 sc1
  buffer_load_dwordx4 v[236:239], v4, s[40:43], s5 offen offset:3072 sc1
  s_add_u32 s5, s5, 4096
  buffer_load_dwordx4 v[240:243], v4, s[40:43], s5 offen offset:0 sc1
  buffer_load_dwordx4 v[244:247], v4, s[40:43], s5 offen offset:1024 sc1
  buffer_load_dwordx4 v[248:251], v4, s[40:43], s5 offen offset:2048 sc1
  buffer_load_dwordx4 v[252:255], v4, s[40:43], s5 offen offset:3072 sc1
L_164:
  s_barrier
  s_cmp_lg_u32 s82, 0
  s_cbranch_scc1 L_166
  s_waitcnt vmcnt(16)
  s_branch L_167
L_166:
  s_waitcnt vmcnt(0)
L_167:
  s_mov_b32 s89, 200000
  s_branch Lp_169
  s_nop 0
Lp_168:
  s_and_b32 s5, s10, 0xfffffc00
  buffer_load_dwordx4 v[120:123], v4, s[40:43], s5 offen sc1
  s_waitcnt vmcnt(0)
Lp_169:
  v_min_u32 v2, v120, v122
  v_cmp_eq_u32 vcc, 0, v2
  s_cmp_eq_u64 vcc, 0
  s_cbranch_scc1 Lp_170
  s_sleep 1
  s_sub_u32 s89, s89, 1
  s_cbranch_scc0 Lp_168
Lp_170:
  s_and_b32 s5, s10, 0xfffffc00
  s_mov_b32 m0, 151552
  s_nop 0
  buffer_load_dword v6, s[40:43], s5 offen offset:0 sc1 lds
  s_mov_b32 m0, 152188
  s_nop 0
  buffer_load_dword v6, s[40:43], s5 offen offset:4 sc1 lds
  s_mov_b32 m0, 151360
  s_nop 0
  buffer_load_dword v6, s[40:43], s5 offen offset:512 sc1 lds
  s_mov_b32 m0, 151996
  s_nop 0
  buffer_load_dword v6, s[40:43], s5 offen offset:516 sc1 lds
  s_add_u32 s10, s10, 16384
  s_cmp_lg_u32 s82, 0
  s_cbranch_scc1 L_171
  buffer_load_dword v109, v110, s[56:59], s12 offen
  s_sub_u32 s12, s12, 8192
L_171:
  s_barrier
  s_cmp_lg_u32 s82, 0
  s_cbranch_scc1 L_173
  s_cmp_lg_u32 s82, 0
  s_cbranch_scc1 L_175
  s_waitcnt vmcnt(1)
  s_branch L_176
L_175:
  s_waitcnt vmcnt(0)
L_176:
  v_add_f32 v192, v192, v224
  v_add_f32 v193, v193, v225
  v_add_f32 v194, v194, v226
  v_add_f32 v195, v195, v227
  v_add_f32 v196, v196, v228
  v_add_f32 v197, v197, v229
  v_add_f32 v198, v198, v230
  v_add_f32 v199, v199, v231
  v_add_f32 v200, v200, v232
  v_add_f32 v201, v201, v233
  v_add_f32 v202, v202, v234
  v_add_f32 v203, v203, v235
  v_add_f32 v204, v204, v236
  v_add_f32 v205, v205, v237
  v_add_f32 v206, v206, v238
  v_add_f32 v207, v207, v239
  v_add_f32 v208, v208, v240
  v_add_f32 v209, v209, v241
  v_add_f32 v210, v210, v242
  v_add_f32 v211, v211, v243
  v_add_f32 v212, v212, v244
  v_add_f32 v213, v213, v245
  v_add_f32 v214, v214, v246
  v_add_f32 v215, v215, v247
  v_add_f32 v216, v216, v248
  v_add_f32 v217, v217, v249
  v_add_f32 v218, v218, v250
  v_add_f32 v219, v219, v251
  v_add_f32 v220, v220, v252
  v_add_f32 v221, v221, v253
  v_add_f32 v222, v222, v254
  v_add_f32 v223, v223, v255
  v_add_f32 v192, v192, v208
  v_add_f32 v193, v193, v209
  v_add_f32 v194, v194, v210
  v_add_f32 v195, v195, v211
  v_add_f32 v196, v196, v212
  v_add_f32 v197, v197, v213
  v_add_f32 v198, v198, v214
  v_add_f32 v199, v199, v215
  v_add_f32 v200, v200, v216
  v_add_f32 v201, v201, v217
  v_add_f32 v202, v202, v218
  v_add_f32 v203, v203, v219
  v_add_f32 v204, v204, v220
  v_add_f32 v205, v205, v221
  v_add_f32 v206, v206, v222
  v_add_f32 v207, v207, v223
  v_add_f32 v192, v192, v200
  v_add_f32 v193, v193, v201
  v_add_f32 v194, v194, v202
  v_add_f32 v195, v195, v203
  v_add_f32 v196, v196, v204
  v_add_f32 v197, v197, v205
  v_add_f32 v198, v198, v206
  v_add_f32 v199, v199, v207
  v_add_f32 v192, v192, v196
  v_add_f32 v193, v193, v197
  v_add_f32 v194, v194, v198
  v_add_f32 v195, v195, v199
  v_add_u32 v2, 153088, v4
  ds_write_b128 v2, v[192:195]
L_173:
  s_cmp_lg_u32 s82, 0
  s_cbranch_scc1 L_177
  buffer_load_dword v109, v110, s[56:59], s12 offen
  s_sub_u32 s12, s12, 8192
L_177:
  s_barrier
  s_cmp_lg_u32 s82, 0
  s_cbranch_scc1 L_179
  s_waitcnt vmcnt(2)
  s_branch L_180
  s_nop 0
L_179:
  s_waitcnt vmcnt(0)
L_180:
  s_waitcnt lgkmcnt(0)
  s_barrier
  s_cmp_lg_u32 s82, 0
  s_cbranch_scc1 L_181
  v_lshlrev_b32 v2, 2, v1
  v_add_u32 v2, 155136, v2
  v_lshlrev_b32_e64 v104, 16, v104
  v_mul_f32 v104, 0x3eeff558, v104
  ds_write_b32 v2, v104 offset:0
  v_lshlrev_b32_e64 v105, 16, v105
  v_mul_f32 v105, 0x3eeff558, v105
  ds_write_b32 v2, v105 offset:256
  v_lshlrev_b32_e64 v106, 16, v106
  v_mul_f32 v106, 0x3eeff558, v106
  ds_write_b32 v2, v106 offset:512
  v_lshlrev_b32_e64 v107, 16, v107
  v_mul_f32 v107, 0x3eeff558, v107
  ds_write_b32 v2, v107 offset:768
  v_lshlrev_b32_e64 v108, 16, v108
  ds_write_b32 v2, v108 offset:1024
  v_lshrrev_b32 v2, 2, v1
  v_lshlrev_b32 v22, 7, v2
  v_lshlrev_b32 v96, 6, v2
  v_and_b32 v2, 3, v1
  v_lshl_add_u32 v22, v2, 3, v22
  v_lshl_add_u32 v96, v2, 3, v96
  v_add_u32 v22, 65536, v22
  v_add_u32 v96, 90112, v96
  v_bfe_u32 v3, v1, 3, 2
  v_xor_b32_e64 v2, 0, v3
  v_lshl_add_u32 v16, v2, 5, v22
  v_xor_b32_e64 v2, 1, v3
  v_lshl_add_u32 v17, v2, 5, v22
  v_xor_b32_e64 v2, 2, v3
  v_lshl_add_u32 v18, v2, 5, v22
  v_xor_b32_e64 v2, 3, v3
  v_lshl_add_u32 v19, v2, 5, v22
  v_bfe_u32 v3, v1, 4, 1
  v_xor_b32_e64 v2, 0, v3
  v_lshl_add_u32 v20, v2, 5, v96
  v_xor_b32_e64 v2, 1, v3
  v_lshl_add_u32 v21, v2, 5, v96
  v_mov_b32 v22, 0x3f803f80
  s_mov_b32 s98, 0x00010001
  s_mov_b32 s99, 0x00010001
  v_cndmask_b32_e64 v200, 0, v22, s[98:99]
  v_cndmask_b32_e64 v201, 0, v22, s[98:99]
  v_cndmask_b32_e64 v202, 0, v22, s[98:99]
  v_cndmask_b32_e64 v203, 0, v22, s[98:99]
  s_nop 0
  s_lshl_b64 s[98:99], s[98:99], 1
  v_cndmask_b32_e64 v204, 0, v22, s[98:99]
  v_cndmask_b32_e64 v205, 0, v22, s[98:99]
  v_cndmask_b32_e64 v206, 0, v22, s[98:99]
  v_cndmask_b32_e64 v207, 0, v22, s[98:99]
  s_nop 0
  s_lshl_b64 s[98:99], s[98:99], 1
  v_cndmask_b32_e64 v208, 0, v22, s[98:99]
  v_cndmask_b32_e64 v209, 0, v22, s[98:99]
  v_cndmask_b32_e64 v210, 0, v22, s[98:99]
  v_cndmask_b32_e64 v211, 0, v22, s[98:99]
  s_nop 0
  s_lshl_b64 s[98:99], s[98:99], 1
  v_cndmask_b32_e64 v212, 0, v22, s[98:99]
  v_cndmask_b32_e64 v213, 0, v22, s[98:99]
  v_cndmask_b32_e64 v214, 0, v22, s[98:99]
  v_cndmask_b32_e64 v215, 0, v22, s[98:99]
  s_nop 0
  s_lshl_b64 s[98:99], s[98:99], 1
  v_cndmask_b32_e64 v216, 0, v22, s[98:99]
  v_cndmask_b32_e64 v217, 0, v22, s[98:99]
  v_cndmask_b32_e64 v218, 0, v22, s[98:99]
  v_cndmask_b32_e64 v219, 0, v22, s[98:99]
  s_nop 0
  s_lshl_b64 s[98:99], s[98:99], 1
  v_cndmask_b32_e64 v220, 0, v22, s[98:99]
  v_cndmask_b32_e64 v221, 0, v22, s[98:99]
  v_cndmask_b32_e64 v222, 0, v22, s[98:99]
  v_cndmask_b32_e64 v223, 0, v22, s[98:99]
  s_nop 0
  s_lshl_b64 s[98:99], s[98:99], 1
  v_cndmask_b32_e64 v224, 0, v22, s[98:99]
  v_cndmask_b32_e64 v225, 0, v22, s[98:99]
  v_cndmask_b32_e64 v226, 0, v22, s[98:99]
  v_cndmask_b32_e64 v227, 0, v22, s[98:99]
  s_nop 0
  s_lshl_b64 s[98:99], s[98:99], 1
  v_cndmask_b32_e64 v228, 0, v22, s[98:99]
  v_cndmask_b32_e64 v229, 0, v22, s[98:99]
  v_cndmask_b32_e64 v230, 0, v22, s[98:99]
  v_cndmask_b32_e64 v231, 0, v22, s[98:99]
  s_nop 0
  s_lshl_b64 s[98:99], s[98:99], 1
  v_cndmask_b32_e64 v232, 0, v22, s[98:99]
  v_cndmask_b32_e64 v233, 0, v22, s[98:99]
  v_cndmask_b32_e64 v234, 0, v22, s[98:99]
  v_cndmask_b32_e64 v235, 0, v22, s[98:99]
  s_nop 0
  s_lshl_b64 s[98:99], s[98:99], 1
  v_cndmask_b32_e64 v236, 0, v22, s[98:99]
  v_cndmask_b32_e64 v237, 0, v22, s[98:99]
  v_cndmask_b32_e64 v238, 0, v22, s[98:99]
  v_cndmask_b32_e64 v239, 0, v22, s[98:99]
  s_nop 0
  s_lshl_b64 s[98:99], s[98:99], 1
  v_cndmask_b32_e64 v240, 0, v22, s[98:99]
  v_cndmask_b32_e64 v241, 0, v22, s[98:99]
  v_cndmask_b32_e64 v242, 0, v22, s[98:99]
  v_cndmask_b32_e64 v243, 0, v22, s[98:99]
  s_nop 0
  s_lshl_b64 s[98:99], s[98:99], 1
  v_cndmask_b32_e64 v244, 0, v22, s[98:99]
  v_cndmask_b32_e64 v245, 0, v22, s[98:99]
  v_cndmask_b32_e64 v246, 0, v22, s[98:99]
  v_cndmask_b32_e64 v247, 0, v22, s[98:99]
  s_nop 0
  s_lshl_b64 s[98:99], s[98:99], 1
  v_cndmask_b32_e64 v248, 0, v22, s[98:99]
  v_cndmask_b32_e64 v249, 0, v22, s[98:99]
  v_cndmask_b32_e64 v250, 0, v22, s[98:99]
  v_cndmask_b32_e64 v251, 0, v22, s[98:99]
  s_nop 0
  s_lshl_b64 s[98:99], s[98:99], 1
  v_cndmask_b32_e64 v252, 0, v22, s[98:99]
  v_cndmask_b32_e64 v253, 0, v22, s[98:99]
  v_cndmask_b32_e64 v254, 0, v22, s[98:99]
  v_cndmask_b32_e64 v255, 0, v22, s[98:99]
  s_lshl_b64 s[98:99], s[98:99], 1
L_181:
  s_lshl_b32 s91, s84, Lz1-Lz0+1
  s_add_u32 s91, s91, s87
  s_barrier
  s_barrier
  s_mov_b32 exec_lo, 0xf7f7
  s_mov_b32 exec_hi, 0
  buffer_load_dword v7, v5, s[40:43], s91 offen sc0 sc1
  s_mov_b64 exec, -1
  s_barrier
  s_barrier
  s_barrier
  s_waitcnt vmcnt(0)
  s_mov_b32 s89, 200000
  s_mov_b32 exec_lo, 0xf7f7
  s_mov_b32 exec_hi, 0
  s_branch Lp_184
Lp_183:
  buffer_load_dword v7, v5, s[40:43], s91 offen sc0 sc1
  s_waitcnt vmcnt(0)
Lp_184:
  v_cmp_ne_u32 vcc, 0, v7
  s_andn2_b32 s3, 0xf7f7, vcc_lo
  s_cbranch_scc0 Lp_185
  s_sleep 1
  s_sub_u32 s89, s89, Lz1-Lz0+1
  s_cbranch_scc0 Lp_183
Lp_185:
  s_mov_b64 exec, -1
  s_barrier
  s_barrier
  s_mov_b32 exec_lo, 0x808
  s_mov_b32 exec_hi, Lz1-Lz0+0
  buffer_load_dword v7, v5, s[40:43], s91 offen sc0 sc1
  s_mov_b64 exec, -1
  s_barrier
  s_barrier
  s_barrier
  s_barrier
  s_waitcnt vmcnt(0)
  s_mov_b32 s89, 200000
  s_mov_b32 exec_lo, 0x808
  s_mov_b32 exec_hi, 0
  s_branch Lp_187
Lp_186:
  buffer_load_dword v7, v5, s[40:43], s91 offen sc0 sc1
  s_waitcnt vmcnt(0)
Lp_187:
  v_cmp_ne_u32 vcc, 0, v7
  s_andn2_b32 s3, 0x808, vcc_lo
  s_cbranch_scc0 Lp_188
  s_sleep 1
  s_sub_u32 s89, s89, Lz1-Lz0+1
  s_cbranch_scc0 Lp_186
Lp_188:
  s_mov_b64 exec, -1
  s_barrier
  s_barrier
  s_barrier
  s_barrier
  s_barrier
  s_barrier
  s_add_u32 s92, s83, 31457280
  s_add_u32 s91, s91, 4
  s_sub_u32 s16, s78, s76
  s_add_u32 s16, s16, 1
  s_and_b32 s16, s16, 15
  s_barrier
  s_cmp_lg_u32 s82, 0
  s_cbranch_scc1 L_189
  s_cmp_eq_u32 s16, 1
  s_cselect_b32 s4, 0, 28672
  v_add_u32 v112, s4, v16
  v_add_u32 v113, s4, v17
  v_add_u32 v114, s4, v18
  v_add_u32 v115, s4, v19
  v_add_u32 v116, s4, v20
  v_add_u32 v117, s4, v21
  ds_read_b64_tr_b16 v[32:33], v112 offset:0
  ds_read_b64_tr_b16 v[34:35], v112 offset:2048
  ds_read_b64_tr_b16 v[36:37], v113 offset:0
  ds_read_b64_tr_b16 v[38:39], v113 offset:2048
  ds_read_b64_tr_b16 v[40:41], v114 offset:0
  ds_read_b64_tr_b16 v[42:43], v114 offset:2048
  ds_read_b64_tr_b16 v[44:45], v115 offset:0
  ds_read_b64_tr_b16 v[46:47], v115 offset:2048
  ds_read_b64_tr_b16 v[48:49], v112 offset:4096
  ds_read_b64_tr_b16 v[50:51], v112 offset:6144
  ds_read_b64_tr_b16 v[52:53], v113 offset:4096
  ds_read_b64_tr_b16 v[54:55], v113 offset:6144
  s_nop 0
  s_waitcnt lgkmcnt(6)
  ds_read_b64_tr_b16 v[56:57], v114 offset:4096
  ds_read_b64_tr_b16 v[58:59], v114 offset:6144
  ds_read_b64_tr_b16 v[60:61], v115 offset:4096
  ds_read_b64_tr_b16 v[62:63], v115 offset:6144
  s_nop 0
  s_waitcnt lgkmcnt(6)
  ds_read_b64_tr_b16 v[64:65], v112 offset:8192
  ds_read_b64_tr_b16 v[66:67], v112 offset:10240
  ds_read_b64_tr_b16 v[68:69], v113 offset:8192
  ds_read_b64_tr_b16 v[70:71], v113 offset:10240
  ds_read_b64_tr_b16 v[72:73], v114 offset:8192
  ds_read_b64_tr_b16 v[74:75], v114 offset:10240
  ds_read_b64_tr_b16 v[76:77], v115 offset:8192
  ds_read_b64_tr_b16 v[78:79], v115 offset:10240
  s_nop 0
  s_waitcnt lgkmcnt(8)
  v_mfma_f32_16x16x32_bf16 v[28:31], v[32:35], v[200:203], 0
  v_mfma_f32_16x16x32_bf16 v[28:31], v[36:39], v[204:207], v[28:31]
  v_mfma_f32_16x16x32_bf16 v[28:31], v[40:43], v[208:211], v[28:31]
  v_mfma_f32_16x16x32_bf16 v[28:31], v[44:47], v[212:215], v[28:31]
  v_mfma_f32_16x16x32_bf16 v[28:31], v[48:51], v[200:203], v[28:31]
  v_mfma_f32_16x16x32_bf16 v[28:31], v[52:55], v[204:207], v[28:31]
  v_mfma_f32_16x16x32_bf16 v[28:31], v[56:59], v[208:211], v[28:31]
  v_mfma_f32_16x16x32_bf16 v[28:31], v[60:63], v[212:215], v[28:31]
  s_nop 0
  s_waitcnt lgkmcnt(7)
  ds_read_b64_tr_b16 v[80:81], v112 offset:12288
  ds_read_b64_tr_b16 v[82:83], v112 offset:14336
  ds_read_b64_tr_b16 v[84:85], v113 offset:12288
  ds_read_b64_tr_b16 v[86:87], v113 offset:14336
  ds_read_b64_tr_b16 v[88:89], v114 offset:12288
  ds_read_b64_tr_b16 v[90:91], v114 offset:14336
  ds_read_b64_tr_b16 v[92:93], v115 offset:12288
  ds_read_b64_tr_b16 v[94:95], v115 offset:14336
  s_nop 0
  s_waitcnt lgkmcnt(6)
  ds_read_b64_tr_b16 v[128:129], v112 offset:16384
  ds_read_b64_tr_b16 v[130:131], v112 offset:18432
  ds_read_b64_tr_b16 v[132:133], v113 offset:16384
  ds_read_b64_tr_b16 v[134:135], v113 offset:18432
  ds_read_b64_tr_b16 v[136:137], v114 offset:16384
  ds_read_b64_tr_b16 v[138:139], v114 offset:18432
  ds_read_b64_tr_b16 v[140:141], v115 offset:16384
  ds_read_b64_tr_b16 v[142:143], v115 offset:18432
  s_nop 0
  s_waitcnt lgkmcnt(8)
  v_mfma_f32_16x16x32_bf16 v[28:31], v[64:67], v[216:219], v[28:31]
  v_mfma_f32_16x16x32_bf16 v[28:31], v[68:71], v[220:223], v[28:31]
  v_mfma_f32_16x16x32_bf16 v[28:31], v[72:75], v[224:227], v[28:31]
  v_mfma_f32_16x16x32_bf16 v[28:31], v[76:79], v[228:231], v[28:31]
  v_mfma_f32_16x16x32_bf16 v[28:31], v[80:83], v[216:219], v[28:31]
  v_mfma_f32_16x16x32_bf16 v[28:31], v[84:87], v[220:223], v[28:31]
  v_mfma_f32_16x16x32_bf16 v[28:31], v[88:91], v[224:227], v[28:31]
  v_mfma_f32_16x16x32_bf16 v[28:31], v[92:95], v[228:231], v[28:31]
  s_nop 0
  s_waitcnt lgkmcnt(7)
  ds_read_b64_tr_b16 v[144:145], v112 offset:20480
  ds_read_b64_tr_b16 v[146:147], v112 offset:22528
  ds_read_b64_tr_b16 v[148:149], v113 offset:20480
  ds_read_b64_tr_b16 v[150:151], v113 offset:22528
  ds_read_b64_tr_b16 v[152:153], v114 offset:20480
  ds_read_b64_tr_b16 v[154:155], v114 offset:22528
  ds_read_b64_tr_b16 v[156:157], v115 offset:20480
  ds_read_b64_tr_b16 v[158:159], v115 offset:22528
  s_nop 0
  s_waitcnt lgkmcnt(6)
  ds_read_b64_tr_b16 v[160:161], v116 offset:0
  ds_read_b64_tr_b16 v[162:163], v116 offset:1024
  ds_read_b64_tr_b16 v[164:165], v117 offset:0
  ds_read_b64_tr_b16 v[166:167], v117 offset:1024
  ds_read_b64_tr_b16 v[176:177], v116 offset:2048
  ds_read_b64_tr_b16 v[178:179], v116 offset:3072
  ds_read_b64_tr_b16 v[180:181], v117 offset:2048
  ds_read_b64_tr_b16 v[182:183], v117 offset:3072
  s_nop 0
  s_waitcnt lgkmcnt(8)
  v_mfma_f32_16x16x32_bf16 v[28:31], v[128:131], v[232:235], v[28:31]
  v_mfma_f32_16x16x32_bf16 v[28:31], v[132:135], v[236:239], v[28:31]
  v_mfma_f32_16x16x32_bf16 v[28:31], v[136:139], v[240:243], v[28:31]
  v_mfma_f32_16x16x32_bf16 v[28:31], v[140:143], v[244:247], v[28:31]
  v_mfma_f32_16x16x32_bf16 v[28:31], v[144:147], v[232:235], v[28:31]
  v_mfma_f32_16x16x32_bf16 v[28:31], v[148:151], v[236:239], v[28:31]
  v_mfma_f32_16x16x32_bf16 v[28:31], v[152:155], v[240:243], v[28:31]
  v_mfma_f32_16x16x32_bf16 v[28:31], v[156:159], v[244:247], v[28:31]
  s_waitcnt lgkmcnt(7)
  s_waitcnt lgkmcnt(0)
  v_mfma_f32_16x16x32_bf16 v[28:31], v[160:163], v[248:251], v[28:31]
  v_mfma_f32_16x16x32_bf16 v[28:31], v[164:167], v[252:255], v[28:31]
  v_mfma_f32_16x16x32_bf16 v[28:31], v[176:179], v[248:251], v[28:31]
  v_mfma_f32_16x16x32_bf16 v[28:31], v[180:183], v[252:255], v[28:31]
  s_lshl_b32 s5, s77, Lz1-Lz0+14
  s_lshl_b32 s4, s76, 10
  s_add_u32 s5, s5, s4
  s_add_u32 s5, s5, 1376256
  s_nop 3
  buffer_store_dwordx4 v[28:31], v15, s[40:43], s5 offen sc0 sc1
L_189:
  s_barrier
  s_mov_b32 exec_lo, 0xffff
  s_mov_b32 exec_hi, 0
  buffer_load_dword v7, v5, s[40:43], s91 offen sc0 sc1
  s_mov_b64 exec, -1
  s_barrier
  s_waitcnt vmcnt(0)
  s_mov_b32 s89, 200000
  s_mov_b32 exec_lo, 0xffff
  s_mov_b32 exec_hi, 0
  s_branch Lp_192
Lp_191:
  buffer_load_dword v7, v5, s[40:43], s91 offen sc0 sc1
  s_waitcnt vmcnt(0)
Lp_192:
  v_cmp_ne_u32 vcc, 0, v7
  s_andn2_b32 s3, 0xffff, vcc_lo
  s_cbranch_scc0 Lp_193
  s_sleep 1
  s_sub_u32 s89, s89, Lz1-Lz0+1
  s_cbranch_scc0 Lp_191
Lp_193:
  s_mov_b64 exec, -1
  s_cmp_lg_u32 s82, 0
  s_cbranch_scc1 L_194
  s_mov_b32 s5, 1835012
  s_mov_b64 exec, 0x101
  buffer_store_dword v11, v14, s[40:43], s5 offen sc0 sc1
  s_mov_b64 exec, -1
L_194:
  s_add_u32 s5, s84, s92
  buffer_load_dwordx2 v[96:97], v6, s[40:43], s5 offen offset:0 sc1
  buffer_load_dwordx2 v[98:99], v6, s[40:43], s5 offen offset:512 sc1
  buffer_load_dwordx2 v[100:101], v6, s[40:43], s5 offen offset:1024 sc1
  buffer_load_dwordx2 v[102:103], v6, s[40:43], s5 offen offset:1536 sc1
  s_barrier
  s_barrier
  s_barrier
  s_waitcnt vmcnt(0)
  v_add_f32 v96, v96, v100
  v_add_f32 v97, v97, v101
  v_add_f32 v98, v98, v102
  v_add_f32 v99, v99, v103
  v_add_f32_e64 v96, v96, v98
  v_add_f32 v97, v97, v99
  s_nop 0
  v_add_f32_dpp v96, v96, v96 row_ror:8 row_mask:0xf bank_mask:0xf
  v_add_f32_dpp v97, v97, v97 row_ror:8 row_mask:0xf bank_mask:0xf
  v_mov_b32 v98, v96
  v_mov_b32 v99, v97
  s_nop 0
  v_permlane16_swap_b32 v96, v98
  v_permlane16_swap_b32 v97, v99
  v_add_f32 v96, v96, v98
  v_add_f32 v97, v97, v99
  v_mov_b32 v98, v96
  v_mov_b32 v99, v97
  s_nop 0
  v_permlane32_swap_b32 v96, v98
  v_permlane32_swap_b32 v97, v99
  v_add_f32 v96, v96, v98
  v_add_f32 v97, v97, v99
  v_mul_f32 v96, 0x3a800000, v96
  v_mul_f32 v97, 0x3a800000, v97
  v_fma_f32 v98, -v96, v96, v97
  v_max_f32_e64 v98, 0, v98
  v_add_f32 v98, 0x3727c5ac, v98
  v_rsq_f32 v98, v98
  s_nop 0
  v_mul_f32 v99, v96, v98
  s_mov_b64 exec, s[8:9]
  buffer_store_dwordx2 v[98:99], v6, s[40:43], s10 offen sc0 sc1
  s_mov_b64 exec, -1
  s_barrier
  s_barrier
  s_barrier
  s_barrier
  s_barrier
  s_cmp_lg_u32 s82, 0
  s_cbranch_scc1 L_196
  s_lshl_b32 s91, s84, Lz1-Lz0+1
  s_and_b32 s91, s91, 0x8f000
  s_add_u32 s91, s91, 1835012
  s_mov_b32 exec_lo, 0xffff
  s_mov_b32 exec_hi, 0
  buffer_load_dword v7, v5, s[40:43], s91 offen sc0 sc1
  s_mov_b64 exec, -1
L_196:
  s_and_b32 s5, s10, 0xfffffc00
  buffer_load_dwordx4 v[120:123], v4, s[40:43], s5 offen sc1
  s_barrier
  s_barrier
  s_waitcnt vmcnt(0)
  s_mov_b32 s89, 200000
  s_branch Lp_199
Lp_198:
  s_and_b32 s5, s10, 0xfffffc00
  buffer_load_dwordx4 v[120:123], v4, s[40:43], s5 offen sc1
  s_waitcnt vmcnt(0)
Lp_199:
  v_min_u32 v2, v120, v122
  v_cmp_eq_u32 vcc, 0, v2
  s_cmp_eq_u64 vcc, 0
  s_cbranch_scc1 Lp_200
  s_sleep 1
  s_sub_u32 s89, s89, 1
  s_cbranch_scc0 Lp_198
Lp_200:
  s_and_b32 s5, s10, 0xfffffc00
  s_mov_b32 m0, 151552
  s_nop 0
  buffer_load_dword v6, s[40:43], s5 offen offset:0 sc1 lds
  s_mov_b32 m0, 152188
  s_nop 0
  buffer_load_dword v6, s[40:43], s5 offen offset:4 sc1 lds
  s_mov_b32 m0, 151360
  s_nop 0
  buffer_load_dword v6, s[40:43], s5 offen offset:512 sc1 lds
  s_mov_b32 m0, 151996
  s_nop 0
  buffer_load_dword v6, s[40:43], s5 offen offset:516 sc1 lds
  s_add_u32 s10, s10, 16384
  s_cmp_lg_u32 s82, 0
  s_cbranch_scc1 L_201
  s_mov_b32 s89, 200000
  s_mov_b32 exec_lo, 0xffff
  s_mov_b32 exec_hi, 0
  s_branch Lp_204
Lp_203:
  buffer_load_dword v7, v5, s[40:43], s91 offen sc0 sc1
  s_waitcnt vmcnt(0)
Lp_204:
  v_cmp_ne_u32 vcc, 0, v7
  s_andn2_b32 s3, 0xffff, vcc_lo
  s_cbranch_scc0 Lp_205
  s_sleep 1
  s_sub_u32 s89, s89, 1
  s_cbranch_scc0 Lp_203
Lp_205:
  s_mov_b64 exec, -1
  s_lshl_b32 s5, s77, 14
  s_add_u32 s5, s5, 1376256
  buffer_load_dwordx4 v[192:195], v4, s[40:43], s5 offen offset:0 sc1
  buffer_load_dwordx4 v[196:199], v4, s[40:43], s5 offen offset:1024 sc1
  buffer_load_dwordx4 v[200:203], v4, s[40:43], s5 offen offset:2048 sc1
  buffer_load_dwordx4 v[204:207], v4, s[40:43], s5 offen offset:3072 sc1
  s_add_u32 s5, s5, 4096
  buffer_load_dwordx4 v[208:211], v4, s[40:43], s5 offen offset:0 sc1
  buffer_load_dwordx4 v[212:215], v4, s[40:43], s5 offen offset:1024 sc1
  buffer_load_dwordx4 v[216:219], v4, s[40:43], s5 offen offset:2048 sc1
  buffer_load_dwordx4 v[220:223], v4, s[40:43], s5 offen offset:3072 sc1
L_201:
  s_barrier
  s_cmp_lg_u32 s82, 0
  s_cbranch_scc1 L_206
  s_lshl_b32 s5, s77, 14
  s_add_u32 s5, s5, 1384448
  buffer_load_dwordx4 v[224:227], v4, s[40:43], s5 offen offset:0 sc1
  buffer_load_dwordx4 v[228:231], v4, s[40:43], s5 offen offset:1024 sc1
  buffer_load_dwordx4 v[232:235], v4, s[40:43], s5 offen offset:2048 sc1
  buffer_load_dwordx4 v[236:239], v4, s[40:43], s5 offen offset:3072 sc1
  s_add_u32 s5, s5, 4096
  buffer_load_dwordx4 v[240:243], v4, s[40:43], s5 offen offset:0 sc1
  buffer_load_dwordx4 v[244:247], v4, s[40:43], s5 offen offset:1024 sc1
  buffer_load_dwordx4 v[248:251], v4, s[40:43], s5 offen offset:2048 sc1
  buffer_load_dwordx4 v[252:255], v4, s[40:43], s5 offen offset:3072 sc1
L_206:
  s_barrier
  s_cmp_lg_u32 s82, Lz1-Lz0+0
  s_cbranch_scc1 L_208
  buffer_load_dword v109, v110, s[60:63], s13 offen
  s_sub_u32 s13, s13, 8192
  buffer_load_dword v109, v110, s[60:63], s13 offen
  s_sub_u32 s13, s13, 8192
L_208:
  s_barrier
  s_cmp_lg_u32 s82, 0
  s_cbranch_scc1 L_210
  s_cmp_lg_u32 s82, 0
  s_cbranch_scc1 L_212
  s_waitcnt vmcnt(2)
  s_branch L_213
L_212:
  s_waitcnt vmcnt(0)
L_213:
  v_add_f32 v192, v192, v224
  v_add_f32 v193, v193, v225
  v_add_f32 v194, v194, v226
  v_add_f32 v195, v195, v227
  v_add_f32 v196, v196, v228
  v_add_f32 v197, v197, v229
  v_add_f32 v198, v198, v230
  v_add_f32 v199, v199, v231
  v_add_f32 v200, v200, v232
  v_add_f32 v201, v201, v233
  v_add_f32 v202, v202, v234
  v_add_f32 v203, v203, v235
  v_add_f32 v204, v204, v236
  v_add_f32 v205, v205, v237
  v_add_f32 v206, v206, v238
  v_add_f32 v207, v207, v239
  v_add_f32 v208, v208, v240
  v_add_f32 v209, v209, v241
  v_add_f32 v210, v210, v242
  v_add_f32 v211, v211, v243
  v_add_f32 v212, v212, v244
  v_add_f32 v213, v213, v245
  v_add_f32 v214, v214, v246
  v_add_f32 v215, v215, v247
  v_add_f32 v216, v216, v248
  v_add_f32 v217, v217, v249
  v_add_f32 v218, v218, v250
  v_add_f32 v219, v219, v251
  v_add_f32 v220, v220, v252
  v_add_f32 v221, v221, v253
  v_add_f32 v222, v222, v254
  v_add_f32 v223, v223, v255
  v_add_f32 v192, v192, v208
  v_add_f32 v193, v193, v209
  v_add_f32 v194, v194, v210
  v_add_f32 v195, v195, v211
  v_add_f32 v196, v196, v212
  v_add_f32 v197, v197, v213
  v_add_f32 v198, v198, v214
  v_add_f32 v199, v199, v215
  v_add_f32 v200, v200, v216
  v_add_f32 v201, v201, v217
  v_add_f32 v202, v202, v218
  v_add_f32 v203, v203, v219
  v_add_f32 v204, v204, v220
  v_add_f32 v205, v205, v221
  v_add_f32 v206, v206, v222
  v_add_f32 v207, v207, v223
  v_add_f32 v192, v192, v200
  v_add_f32 v193, v193, v201
  v_add_f32 v194, v194, v202
  v_add_f32 v195, v195, v203
  v_add_f32 v196, v196, v204
  v_add_f32 v197, v197, v205
  v_add_f32 v198, v198, v206
  v_add_f32 v199, v199, v207
  v_add_f32 v192, v192, v196
  v_add_f32 v193, v193, v197
  v_add_f32 v194, v194, v198
  v_add_f32 v195, v195, v199
  v_add_u32 v2, 154112, v4
  ds_write_b128 v2, v[192:195]
  s_branch L_211
  s_nop 0
L_210:
  s_waitcnt vmcnt(0)
L_211:
  s_waitcnt lgkmcnt(0)
  s_barrier
  v_lshlrev_b32 v2, 12, v1
  s_lshl_b32 s4, s76, 16
  s_lshl_b32 s5, s77, 7
  s_add_u32 s4, s4, s5
  s_add_u32 s4, s4, s87
  s_add_u32 s5, s4, 24
  s_lshl_b32 s4, s79, 3
  s_lshl_b32 s90, 0xff, s4
  s_lshl_b32 s91, s84, 1
  s_add_u32 s91, s91, s87
  s_add_u32 s91, s91, 24
  s_lshl_b32 s4, s82, 7
  s_add_u32 s4, s4, 1837056
  s_lshl_b32 s5, s84, 1
  s_add_u32 s5, s5, s4
  s_and_b32 s91, s5, 0xffff0fff
  s_barrier
  s_barrier
  s_barrier
  s_mov_b32 exec_lo, 1
  s_mov_b32 exec_hi, Lz1-Lz0+0
  buffer_store_dword v11, v2, s[40:43], s5 offen sc0 sc1
  s_mov_b64 exec, -1
  s_barrier
  s_barrier
  s_barrier
  s_mov_b32 exec_lo, s90
  s_mov_b32 exec_hi, 0
  buffer_load_dword v7, v2, s[40:43], s91 offen sc0 sc1
  s_mov_b64 exec, -1
  s_barrier
  s_waitcnt vmcnt(0)
  s_mov_b32 s89, 200000
  s_mov_b32 exec_lo, s90
  s_mov_b32 exec_hi, 0
  s_branch Lp_215
Lp_214:
  buffer_load_dword v7, v2, s[40:43], s91 offen sc0 sc1
  s_waitcnt vmcnt(0)
Lp_215:
  v_cmp_ne_u32 vcc, 0, v7
  s_andn2_b32 s3, s90, vcc_lo
  s_cbranch_scc0 Lp_216
  s_sleep 1
  s_sub_u32 s89, s89, 1
  s_cbranch_scc0 Lp_214
Lp_216:
  s_mov_b64 exec, -1
  s_xor_b32 s90, s90, 0xffff
  s_barrier
  s_barrier
  s_barrier
  s_barrier
  s_barrier
  s_barrier
  s_barrier
  s_barrier
  s_barrier
  s_barrier
  s_mov_b32 exec_lo, s90
  s_mov_b32 exec_hi, 0
  buffer_load_dword v7, v2, s[40:43], s91 offen sc0 sc1
  s_mov_b64 exec, -1
  s_barrier
  s_barrier
  s_barrier
  s_waitcnt vmcnt(0)
  s_mov_b32 s89, 200000
  s_mov_b32 exec_lo, s90
  s_mov_b32 exec_hi, 0
  s_branch Lp_218
Lp_217:
  buffer_load_dword v7, v2, s[40:43], s91 offen sc0 sc1
  s_waitcnt vmcnt(0)
Lp_218:
  v_cmp_ne_u32 vcc, 0, v7
  s_andn2_b32 s3, s90, vcc_lo
  s_cbranch_scc0 Lp_219
  s_sleep 1
  s_sub_u32 s89, s89, 1
  s_cbranch_scc0 Lp_217
Lp_219:
  s_mov_b64 exec, -1
  s_barrier
  s_barrier
  s_barrier
  s_barrier
  s_barrier
  s_barrier
  s_barrier
  s_barrier
  s_barrier
  s_barrier
  s_barrier
  s_cmp_lg_u32 s82, 0
  s_cbranch_scc1 L_lend
  s_add_u32 s92, s83, 36700160
  s_mov_b32 s82, 1
  s_mov_b32 s14, 0
  s_add_u32 s83, s83, 0
  s_add_u32 s87, s87, 32
  s_branch L_slayer
L_lend:
Lz0:
Lz1:
L_end:
  s_endpgm
.section .rodata,"a"
.p2align 6
.amdhsa_kernel mega_kernel
  .amdhsa_next_free_vgpr 256
  .amdhsa_next_free_sgpr 102
  .amdhsa_accum_offset 256
  .amdhsa_group_segment_fixed_size 0
  .amdhsa_kernarg_size 88
  .amdhsa_user_sgpr_count 2
  .amdhsa_user_sgpr_kernarg_segment_ptr 1
  .amdhsa_system_sgpr_workgroup_id_x 1
  .amdhsa_float_denorm_mode_32 3
  .amdhsa_float_denorm_mode_16_64 3
.end_amdhsa_kernel
.text
```

```asm
; @launch kernel=mega_kernel grid=(256,1,1) block=(512,1,1) lds=156672
.amdgcn_target "amdgcn-amd-amdhsa--gfx950"
.text
.globl mega_kernel
.p2align 8
.type mega_kernel,@function
mega_kernel:
  s_cmp_ge_u32 s2, 256
  s_nop 0
  s_cbranch_scc1 L_end
  s_load_dwordx16 s[16:31], s[0:1], 0
  s_load_dwordx2 s[32:33], s[0:1], 64
  s_load_dwordx4 s[36:39], s[0:1], 72
  v_lshrrev_b32 v2, 6, v0
  v_and_b32 v1, 63, v0
  v_readfirstlane_b32 s81, v2
  s_and_b32 s3, s2, 7
  s_lshr_b32 s4, s2, 3
  s_and_b32 s5, s3, 1
  s_lshl_b32 s5, s5, 3
  s_and_b32 s6, s4, 7
  s_add_u32 s76, s5, s6
  s_lshr_b32 s5, s3, 1
  s_lshl_b32 s5, s5, 2
  s_lshr_b32 s6, s4, 3
  s_add_u32 s77, s5, s6
  s_mov_b32 s82, 0
  s_mov_b32 s88, 0
  s_and_b32 s85, s81, 1
  s_cmp_lt_u32 s81, 4
  s_cbranch_scc1 L_comp
  s_cmp_eq_u32 s81, Lz1-Lz0+5
  s_cbranch_scc1 L_serv
  s_setprio 0
  s_cmp_eq_u32 s81, 4
  s_cbranch_scc1 L_xload
  v_bfe_u32 v2, v1, 1, 2
  v_bfe_u32 v3, v1, 4, 2
  v_xor_b32 v2, v2, v3
  v_lshlrev_b32 v10, 5, v2
  v_and_b32_e64 v2, 1, v1
  v_lshl_add_u32 v10, v2, 4, v10
  v_lshrrev_b32_e64 v2, 5, v1
  v_bfe_u32 v3, v1, 3, 2
  v_lshl_add_u32 v2, v2, 3, v3
  s_mov_b32 s4, 6144
  v_mad_u32_u24 v16, v2, s4, v10
  v_add_u32 v17, 97280, v16
  v_add_u32 v18, 22528, v16
  v_add_u32 v19, 119808, v16
  s_lshl_b32 s5, s77, Lz1-Lz0+7
  s_mul_i32 s4, s85, 196608
  s_add_u32 s5, s5, s4
  s_and_b32 s6, s76, 6
  s_lshr_b32 s4, s76, 3
  s_add_u32 s6, s6, s4
  s_lshl_b32 s6, s6, 1
  v_add_u32 v20, s6, v1
  v_and_b32_e64 v20, 15, v20
  s_mov_b32 s4, 393216
  v_mul_u32_u24 v20, s4, v20
  v_add_u32 v20, s5, v20
  s_nop 0
  v_readfirstlane_b32 s7, v20
  s_lshl_b32 s11, s85, Lz1-Lz0+12
  s_add_u32 s11, s11, 65536
  s_add_u32 s15, s11, 73728
  s_waitcnt lgkmcnt(0)
  s_mov_b32 s48, s18
  s_and_b32 s49, s19, 0xffff
  s_mov_b32 s50, 6291456
  s_mov_b32 s51, 0x00020000
L_wlayer:
  s_mov_b32 s12, 0
  s_mov_b32 m0, s11
  s_cmp_eq_u32 s82, 0
  s_cbranch_scc1 Ll_34
  s_waitcnt vmcnt(12)
  s_barrier
  s_waitcnt vmcnt(8)
  s_barrier
  s_waitcnt vmcnt(4)
  s_barrier
  s_waitcnt vmcnt(0)
  s_barrier
  s_barrier
  s_branch Ll_34
Lt_40:
  s_cmp_lg_u32 s12, 1
  s_cbranch_scc1 Ll_34
  s_cmp_eq_u32 s82, 0
  s_cbranch_scc1 Ll_34
  s_waitcnt vmcnt(0)
  s_barrier
Ll_34:
  buffer_load_dwordx4 v16, s[48:51], s7 offen offset:0  lds
  buffer_load_dwordx4 v17, s[48:51], s7 offen offset:1024  lds
  buffer_load_dwordx4 v18, s[48:51], s7 offen offset:2048  lds
  buffer_load_dwordx4 v19, s[48:51], s7 offen offset:3072  lds
  s_add_u32 m0, s11, 8192
  s_add_u32 s5, s7, 2048
  buffer_load_dwordx4 v16, s[48:51], s5 offen offset:0  lds
  buffer_load_dwordx4 v17, s[48:51], s5 offen offset:1024  lds
  buffer_load_dwordx4 v18, s[48:51], s5 offen offset:2048  lds
  buffer_load_dwordx4 v19, s[48:51], s5 offen offset:3072  lds
  s_add_u32 m0, s11, 16384
  s_add_u32 s5, s7, 4096
  buffer_load_dwordx4 v16, s[48:51], s5 offen offset:0  lds
  s_add_u32 s12, s12, Lz1-Lz0+1
  v_readlane_b32 s7, v20, s12
  s_add_u32 s11, s11, 24576
  buffer_load_dwordx4 v17, s[48:51], s5 offen offset:1024  lds
  s_cmp_eq_u32 s11, s15
  s_cselect_b32 s4, 73728, 0
  s_sub_u32 s11, s11, s4
  buffer_load_dwordx4 v18, s[48:51], s5 offen offset:2048  lds
  s_cmp_lg_u32 s12, Lz1-Lz0+3
  buffer_load_dwordx4 v19, s[48:51], s5 offen offset:3072  lds
  s_mov_b32 m0, s11
  s_cbranch_scc1 Lt_40
Lt_41:
  s_cmp_lg_u32 s82, Lz1-Lz0+0
  s_cbranch_scc1 Ll_42
  s_waitcnt vmcnt(24)
  s_barrier
Ll_42:
  s_mul_i32 s5, s85, 6144
  s_mov_b32 s68, s24
  s_and_b32 s69, s25, 0xffff
  s_mov_b32 s70, 7340032
  s_mov_b32 s71, 0x00020000
  s_lshl_b32 s4, s76, 4
  s_add_u32 s4, s4, s77
  s_mul_i32 s34, s4, 28672
  s_add_u32 s34, s34, s5
  s_mov_b32 s40, s38
  s_and_b32 s41, s39, 0xffff
  s_mov_b32 s42, 100663296
  s_mov_b32 s43, 0x00020000
  s_nop 0
  s_mov_b32 s52, s20
  s_and_b32 s53, s21, 0xffff
  s_mov_b32 s54, 2097152
  s_mov_b32 s55, 0x00020000
  s_nop 0
  s_mov_b32 s56, s24
  s_and_b32 s57, s25, 0xffff
  s_mov_b32 s58, 7340032
  s_mov_b32 s59, 0x00020000
  s_nop 0
  s_mov_b32 s60, s28
  s_and_b32 s61, s29, 0xffff
  s_mov_b32 s62, 7340032
  s_mov_b32 s63, 0x00020000
  s_cmp_lg_u32 s82, 0
  s_cbranch_scc1 L_43
  s_and_b32 s80, s77, 7
  s_lshr_b32 s79, s77, 3
  s_lshl_b32 s78, s80, 1
  s_add_u32 s78, s78, s79
  s_lshl_b32 s5, s76, 4
  s_add_u32 s5, s5, s77
  s_lshl_b32 s84, s5, Lz1-Lz0+11
  s_mov_b32 s83, 3145728
  s_mov_b32 s87, 1835016
  s_lshr_b32 s86, s81, 1
  v_lshrrev_b32 v2, 3, v1
  s_mov_b32 s4, 2048
  v_mad_u32_u24 v4, v2, s4, v10
  v_add_u32 v5, 15360, v4
  v_add_u32 v6, 30720, v4
  v_add_u32 v7, 46080, v4
  s_lshl_b32 s5, s78, Lz1-Lz0+7
  s_mul_i32 s4, s85, 65536
  s_add_u32 s5, s5, s4
  s_mul_i32 s4, s76, 14
  s_lshr_b32 s4, s4, 4
  v_add_u32 v39, s4, v1
  v_subrev_u32 v2, 14, v39
  v_min_u32 v39, v39, v2
  v_cmp_le_u32 vcc, 14, v1
  s_nop 1
  v_cndmask_b32 v39, v39, v1, vcc
  v_lshlrev_b32 v39, 2, v39
  v_mov_b32 v2, 0x87654210
  v_mov_b32 v3, 0xb3fedca9
  v_lshrrev_b64 v[2:3], v39, v[2:3]
  v_and_b32_e64 v39, 15, v2
  v_cmp_eq_u32 vcc, s77, v39
  s_nop 0
  v_mov_b32_dpp v2, v39 row_shr:1 row_mask:0xf bank_mask:0xf
  s_ff1_i32_b32 s4, vcc_lo
  v_cmp_ge_u32 vcc, s4, v1
  s_nop 1
  v_cndmask_b32 v39, v39, v2, vcc
  v_writelane_b32 v39, s77, 0
  v_lshl_add_u32 v38, v39, 17, s5
L_43:
  s_waitcnt vmcnt(12)
  s_barrier
  buffer_load_dwordx4 v16, s[48:51], s7 offen offset:0  lds
  buffer_load_dwordx4 v17, s[48:51], s7 offen offset:1024  lds
  buffer_load_dwordx4 v18, s[48:51], s7 offen offset:2048  lds
  buffer_load_dwordx4 v19, s[48:51], s7 offen offset:3072  lds
Ll_44:
  s_add_u32 m0, s11, 8192
  s_add_u32 s5, s7, 2048
  buffer_load_dwordx4 v16, s[48:51], s5 offen offset:0  lds
  buffer_load_dwordx4 v17, s[48:51], s5 offen offset:1024  lds
  buffer_load_dwordx4 v18, s[48:51], s5 offen offset:2048  lds
  buffer_load_dwordx4 v19, s[48:51], s5 offen offset:3072  lds
  s_add_u32 m0, s11, 16384
  s_add_u32 s5, s7, 4096
  buffer_load_dwordx4 v16, s[48:51], s5 offen offset:0  lds
  s_add_u32 s12, s12, Lz1-Lz0+1
  v_readlane_b32 s7, v20, s12
  s_add_u32 s11, s11, 24576
  buffer_load_dwordx4 v17, s[48:51], s5 offen offset:1024  lds
  s_cmp_eq_u32 s11, s15
  s_cselect_b32 s4, 73728, 0
  s_sub_u32 s11, s11, s4
  buffer_load_dwordx4 v18, s[48:51], s5 offen offset:2048  lds
  s_cmp_eq_u32 s12, Lz1-Lz0+16
  buffer_load_dwordx4 v19, s[48:51], s5 offen offset:3072  lds
  s_mov_b32 m0, s11
  s_cbranch_scc1 Ll_45
  s_cmp_lg_u32 s82, 0
  s_cbranch_scc1 L_46
  s_buffer_load_dwordx2 s[98:99], s[68:71], s34 offset:60
  s_buffer_load_dwordx2 s[98:99], s[68:71], s34 offset:188
  s_buffer_load_dwordx2 s[98:99], s[68:71], s34 offset:316
  s_buffer_load_dwordx2 s[98:99], s[68:71], s34 offset:444
  s_add_u32 s34, s34, 512
L_46:
  s_waitcnt vmcnt(12)
  s_barrier
  buffer_load_dwordx4 v16, s[48:51], s7 offen offset:0  lds
  buffer_load_dwordx4 v17, s[48:51], s7 offen offset:1024  lds
  buffer_load_dwordx4 v18, s[48:51], s7 offen offset:2048  lds
  buffer_load_dwordx4 v19, s[48:51], s7 offen offset:3072  lds
  s_branch Ll_44
Ll_45:
  s_branch L_w1
L_xload:
  s_setprio 0
  v_lshrrev_b32 v2, 4, v1
  v_and_b32 v3, 7, v1
  v_xor_b32 v2, v2, v3
  v_lshrrev_b32 v3, 3, v1
  v_lshlrev_b32 v3, 12, v3
  v_lshl_add_u32 v4, v2, 4, v3
  v_xor_b32_e64 v5, 64, v4
  v_add_u32 v5, 31744, v5
  v_add_u32 v6, 63488, v4
  v_add_u32 v7, 63488, v5
  s_mov_b32 s13, 0x20000
  s_movk_i32 s95, 2048
  s_lshl_b32 s5, s76, 18
  s_and_b32 s6, s76, 6
  s_lshr_b32 s4, s76, 3
  s_add_u32 s6, s6, s4
  s_lshl_b32 s6, s6, 1
  v_add_u32 v9, s6, v1
  v_and_b32 v9, 15, v9
  v_lshl_add_u32 v9, v9, 7, s5
  s_nop 0
  v_readfirstlane_b32 s7, v9
  s_waitcnt lgkmcnt(0)
  s_mov_b32 s72, s16
  s_and_b32 s73, s17, 0xffff
  s_mov_b32 s74, 4194304
  s_mov_b32 s75, 0x00020000
  s_mov_b32 s11, 0
  s_mov_b32 s15, 65536
L_xlayer:
  s_mov_b32 s12, s82
  s_mov_b32 m0, s11
Ll_87:
  s_nop 0
  buffer_load_dwordx4 v4, s[72:75], s7 offen offset:0 sc1 lds
  buffer_load_dwordx4 v5, s[72:75], s7 offen offset:1024 sc1 lds
  buffer_load_dwordx4 v6, s[72:75], s7 offen offset:2048 sc1 lds
  buffer_load_dwordx4 v7, s[72:75], s7 offen offset:3072 sc1 lds
  s_add_u32 m0, s11, 4096
  s_nop 0
  s_add_u32 s5, s7, s13
  buffer_load_dwordx4 v4, s[72:75], s5 offen offset:0 sc1 lds
  buffer_load_dwordx4 v5, s[72:75], s5 offen offset:1024 sc1 lds
  buffer_load_dwordx4 v6, s[72:75], s5 offen offset:2048 sc1 lds
  buffer_load_dwordx4 v7, s[72:75], s5 offen offset:3072 sc1 lds
  s_add_u32 m0, s11, 8192
  s_nop 0
  s_add_u32 s3, s7, s95
  buffer_load_dwordx4 v4, s[72:75], s3 offen offset:0 sc1 lds
  buffer_load_dwordx4 v5, s[72:75], s3 offen offset:1024 sc1 lds
  buffer_load_dwordx4 v6, s[72:75], s3 offen offset:2048 sc1 lds
  buffer_load_dwordx4 v7, s[72:75], s3 offen offset:3072 sc1 lds
  s_add_u32 m0, s11, 12288
  s_add_u32 s5, s3, s13
  buffer_load_dwordx4 v4, s[72:75], s5 offen offset:0 sc1 lds
  s_add_u32 s12, s12, 1
  v_readlane_b32 s7, v9, s12
  s_add_u32 s11, s11, 16384
  buffer_load_dwordx4 v5, s[72:75], s5 offen offset:1024 sc1 lds
  s_cmp_eq_u32 s11, s15
  s_cselect_b32 s4, 65536, 0
  s_sub_u32 s11, s11, s4
  buffer_load_dwordx4 v6, s[72:75], s5 offen offset:2048 sc1 lds
  s_cmp_lg_u32 s12, Lz1-Lz0+2
  buffer_load_dwordx4 v7, s[72:75], s5 offen offset:3072 sc1 lds
  s_mov_b32 m0, s11
  s_cbranch_scc1 Ll_88
  s_cmp_lg_u32 s82, 0
  s_cbranch_scc1 Ll_88
  s_waitcnt vmcnt(16)
  s_barrier
Ll_92:
Ll_88:
  s_cmp_lt_u32 s12, Lz1-Lz0+4
  s_cbranch_scc1 Ll_87
  s_mov_b32 s68, s20
  s_and_b32 s69, s21, 0xffff
  s_mov_b32 s70, 2097152
  s_mov_b32 s71, 0x00020000
  s_lshl_b32 s4, s76, 4
  s_add_u32 s4, s4, s77
  s_mul_i32 s34, s4, 8192
  s_waitcnt vmcnt(32)
  s_barrier
  buffer_load_dwordx4 v4, s[72:75], s7 offen offset:0 sc1 lds
  buffer_load_dwordx4 v5, s[72:75], s7 offen offset:1024 sc1 lds
  buffer_load_dwordx4 v6, s[72:75], s7 offen offset:2048 sc1 lds
  buffer_load_dwordx4 v7, s[72:75], s7 offen offset:3072 sc1 lds
Ll_93:
  s_add_u32 m0, s11, 4096
  s_nop 0
  s_add_u32 s5, s7, s13
  buffer_load_dwordx4 v4, s[72:75], s5 offen offset:0 sc1 lds
  buffer_load_dwordx4 v5, s[72:75], s5 offen offset:1024 sc1 lds
  buffer_load_dwordx4 v6, s[72:75], s5 offen offset:2048 sc1 lds
  buffer_load_dwordx4 v7, s[72:75], s5 offen offset:3072 sc1 lds
  s_add_u32 m0, s11, 8192
  s_nop 0
  s_add_u32 s3, s7, s95
  buffer_load_dwordx4 v4, s[72:75], s3 offen offset:0 sc1 lds
  buffer_load_dwordx4 v5, s[72:75], s3 offen offset:1024 sc1 lds
  buffer_load_dwordx4 v6, s[72:75], s3 offen offset:2048 sc1 lds
  buffer_load_dwordx4 v7, s[72:75], s3 offen offset:3072 sc1 lds
  s_add_u32 m0, s11, 12288
  s_add_u32 s5, s3, s13
  buffer_load_dwordx4 v4, s[72:75], s5 offen offset:0 sc1 lds
  s_add_u32 s12, s12, 1
  v_readlane_b32 s7, v9, s12
  s_add_u32 s11, s11, 16384
  buffer_load_dwordx4 v5, s[72:75], s5 offen offset:1024 sc1 lds
  s_cmp_eq_u32 s11, s15
  s_cselect_b32 s4, 65536, 0
  s_sub_u32 s11, s11, s4
  buffer_load_dwordx4 v6, s[72:75], s5 offen offset:2048 sc1 lds
  s_cmp_eq_u32 s12, Lz1-Lz0+16
  buffer_load_dwordx4 v7, s[72:75], s5 offen offset:3072 sc1 lds
  s_mov_b32 m0, s11
  s_cbranch_scc1 Ll_94
  s_cmp_lg_u32 s82, 0
  s_cbranch_scc1 L_95
  s_buffer_load_dwordx2 s[98:99], s[68:71], s34 offset:60
  s_buffer_load_dwordx2 s[98:99], s[68:71], s34 offset:188
  s_buffer_load_dwordx2 s[98:99], s[68:71], s34 offset:316
  s_buffer_load_dwordx2 s[98:99], s[68:71], s34 offset:444
  s_buffer_load_dwordx2 s[98:99], s[68:71], s34 offset:572
  s_add_u32 s34, s34, 640
L_95:
  s_waitcnt vmcnt(32)
  s_barrier
  buffer_load_dwordx4 v4, s[72:75], s7 offen offset:0 sc1 lds
  buffer_load_dwordx4 v5, s[72:75], s7 offen offset:1024 sc1 lds
  buffer_load_dwordx4 v6, s[72:75], s7 offen offset:2048 sc1 lds
  buffer_load_dwordx4 v7, s[72:75], s7 offen offset:3072 sc1 lds
  s_branch Ll_93
Ll_94:
  s_branch L_x1
L_serv:
  s_setprio 3
  s_and_b32 s80, s77, 7
  s_lshr_b32 s79, s77, 3
  s_lshl_b32 s78, s80, 1
  s_add_u32 s78, s78, s79
  s_lshl_b32 s5, s76, 4
  s_add_u32 s5, s5, s77
  s_lshl_b32 s84, s5, 11
  s_mov_b32 s83, 3145728
  s_mov_b32 s87, 1835016
  s_lshr_b32 s86, s81, 1
  v_lshlrev_b32 v4, 4, v1
  v_mov_b32 v24, 0
  v_mov_b32 v25, 0
  v_mov_b32 v26, 0
  v_mov_b32 v27, 0
  v_and_b32 v2, 14, v1
  v_lshlrev_b32 v3, 11, v2
  v_and_b32_e64 v2, 1, v1
  v_lshl_add_u32 v3, v2, 4, v3
  v_and_b32_e64 v2, 48, v1
  v_lshl_add_u32 v3, v2, 1, v3
  v_bfe_u32 v2, v1, 3, 2
  v_and_b32 v22, 7, v1
  v_lshlrev_b32 v2, 14, v2
  v_lshl_add_u32 v2, v22, 3, v2
  s_lshl_b32 s5, s76, 7
  s_lshl_b32 s4, s80, 4
  s_add_u32 s6, s5, s4
  s_add_u32 s6, s6, s79
  s_lshl_b32 s6, s6, 11
  s_lshr_b32 s10, s84, 5
  s_add_u32 s10, s10, 1638400
  s_waitcnt lgkmcnt(0)
  s_mov_b32 s40, s38
  s_and_b32 s41, s39, 0xffff
  s_mov_b32 s42, 100663296
  s_mov_b32 s43, 0x00020000
  s_nop 0
  s_mov_b32 s44, s16
  s_and_b32 s45, s17, 0xffff
  s_mov_b32 s46, 4194304
  s_mov_b32 s47, 0x00020000
  s_nop 0
  s_mov_b32 s68, s36
  s_and_b32 s69, s37, 0xffff
  s_mov_b32 s70, 256
  s_mov_b32 s71, 0x00020000
  s_lshl_b32 s4, s84, Lz1-Lz0+1
  s_add_u32 s4, s4, 1835008
  buffer_store_dwordx4 v[24:27], v4, s[40:43], s4 offen offset:0 sc0 sc1
  buffer_store_dwordx4 v[24:27], v4, s[40:43], s4 offen offset:1024 sc0 sc1
  s_mov_b64 exec, 0xffff
  buffer_store_dwordx4 v[24:27], v4, s[40:43], s4 offen offset:2048 sc0 sc1
  s_mov_b64 exec, -1
  v_mov_b32 v28, -1
  v_mov_b32 v29, -1
  v_mov_b32 v30, -1
  v_mov_b32 v31, -1
  s_lshl_b32 s4, s84, 1
  s_add_u32 s4, s4, Lz1-Lz0+0
  buffer_store_dwordx4 v[28:31], v4, s[40:43], s4 offen offset:0 sc0 sc1
  buffer_store_dwordx4 v[28:31], v4, s[40:43], s4 offen offset:1024 sc0 sc1
  buffer_store_dwordx4 v[28:31], v4, s[40:43], s4 offen offset:2048 sc0 sc1
  buffer_store_dwordx4 v[28:31], v4, s[40:43], s4 offen offset:3072 sc0 sc1
  buffer_store_dwordx2 v[24:25], v2, s[40:43], s10 offen sc0 sc1
  v_mov_b32 v108, v3
  s_mov_b32 s7, s6
  s_branch L_s1
L_comp:
  s_and_b32 s80, s77, 7
  s_lshr_b32 s79, s77, 3
  s_lshl_b32 s78, s80, 1
  s_add_u32 s78, s78, s79
  s_lshl_b32 s5, s76, 4
  s_add_u32 s5, s5, s77
  s_lshl_b32 s84, s5, 11
  s_mov_b32 s83, 3145728
  s_mov_b32 s87, 1835016
  s_lshr_b32 s86, s81, Lz1-Lz0+1
  s_waitcnt lgkmcnt(0)
  s_mov_b32 s40, s38
  s_and_b32 s41, s39, 0xffff
  s_mov_b32 s42, 100663296
  s_mov_b32 s43, 0x00020000
  s_nop 0
  s_mov_b32 s64, s32
  s_and_b32 s65, s33, 0xffff
  s_mov_b32 s66, 4194304
  s_mov_b32 s67, 0x00020000
  s_setprio 1
  v_lshlrev_b32 v11, 4, v1
  v_lshrrev_b32 v2, 3, v1
  v_and_b32 v3, 7, v1
  v_lshlrev_b32_e64 v3, 3, v3
  v_lshl_add_u32 v30, v2, 11, v3
  s_lshl_b32 s4, s85, 13
  s_lshl_b32 s5, s86, 10
  s_add_u32 s4, s4, s5
  v_add_u32 v0, s4, v11
  v_mov_b32_e64 v27, 1
  v_mov_b32 v28, 156416
  v_and_b32 v29, 48, v1
  s_lshl_b32 s4, s76, 16
  s_lshl_b32 s5, s77, 7
  s_add_u32 s4, s4, s5
  v_lshlrev_b32 v24, 12, v1
  v_and_b32 v2, 16, v1
  v_lshl_add_u32 v24, v2, 7, v24
  v_add_u32 v24, s4, v24
  v_lshrrev_b32 v2, 2, v1
  v_lshlrev_b32 v25, 7, v2
  v_and_b32 v2, 3, v1
  v_lshl_add_u32 v25, v2, 3, v25
  v_add_u32 v25, 65536, v25
  v_bfe_u32 v26, v1, 3, 2
  v_and_b32 v2, 15, v1
  v_lshrrev_b32 v3, 2, v29
  v_sub_u32_e64 v2, v2, v3
  s_mov_b32 s4, 0xf149f2ca
  v_mov_b32 v32, s4
  v_subrev_u32 v3, 0, v2
  v_cmp_gt_u32 vcc, 8, v3
  s_nop 1
  v_cndmask_b32_e64 v12, v32, 0, vcc
  v_cmp_ge_i32 vcc, -9, v3
  s_nop 1
  v_cndmask_b32_e64 v16, v32, 0, vcc
  v_cndmask_b32_e64 v20, 0, -1, vcc
  v_subrev_u32_e64 v3, 1, v2
  v_cmp_gt_u32 vcc, 8, v3
  s_nop 1
  v_cndmask_b32_e64 v13, v32, 0, vcc
  v_cmp_ge_i32 vcc, -9, v3
  s_nop 1
  v_cndmask_b32_e64 v17, v32, 0, vcc
  v_cndmask_b32_e64 v21, 0, -1, vcc
  v_subrev_u32_e64 v3, 2, v2
  v_cmp_gt_u32 vcc, 8, v3
  s_nop 1
  v_cndmask_b32_e64 v14, v32, 0, vcc
  v_cmp_ge_i32 vcc, -9, v3
  s_nop 1
  v_cndmask_b32_e64 v18, v32, 0, vcc
  v_cndmask_b32_e64 v22, 0, -1, vcc
  v_subrev_u32_e64 v3, 3, v2
  v_cmp_gt_u32 vcc, 8, v3
  s_nop 1
  v_cndmask_b32_e64 v15, v32, 0, vcc
  v_cmp_ge_i32 vcc, -9, v3
  s_nop 1
  v_cndmask_b32_e64 v19, v32, 0, vcc
  v_cndmask_b32_e64 v23, 0, -1, vcc
  v_alignbit_b32 v20, v21, v20, 16
  v_alignbit_b32 v21, v23, v22, 16
  s_lshl_b32 s11, s84, Lz1-Lz0+1
  s_lshl_b32 s4, s81, 10
  s_add_u32 s11, s11, s4
  v_bfe_u32 v2, v1, 4, 1
  v_lshrrev_b32_e64 v3, 5, v1
  v_lshl_add_u32 v2, v2, 1, v3
  v_lshl_add_u32 v2, s86, 2, v2
  v_bfe_u32 v3, v1, 1, 3
  v_xor_b32 v2, v2, v3
  v_and_b32 v3, 15, v1
  v_lshl_add_u32 v2, v3, 3, v2
  s_lshl_b32 s4, s85, Lz1-Lz0+13
  v_lshl_add_u32 v255, v2, 4, s4
L_clayer:
  s_mov_b32 s16, Lz1-Lz0+0
  s_mov_b32 s17, 16384
  s_mov_b32 s18, 0xffff4000
  s_mov_b32 s19, Lz1-Lz0+0
  s_mov_b32 s20, 24576
  s_mov_b32 s21, 0xffff4000
  s_mul_i32 s4, s85, 8192
  v_add_u32_e64 v4, s4, v11
  v_add_u32 v5, 1024, v4
  s_cmp_lg_u32 s82, 0
  s_cbranch_scc1 L_1
  v_and_b32 v2, 15, v1
  v_lshrrev_b32 v3, 1, v2
  v_lshrrev_b32 v32, 4, v1
  v_xor_b32 v3, v3, v32
  v_lshlrev_b32_e64 v3, 4, v3
  v_lshl_add_u32 v3, v2, 7, v3
  v_add_u32 v4, s4, v3
  v_xor_b32 v3, 64, v3
  v_add_u32 v5, s4, v3
L_1:
  s_lshl_b32 s4, s86, 1
  v_xor_b32_e64 v2, s4, v26
  v_lshl_add_u32 v6, v2, 5, v25
  s_add_u32 s4, s4, 1
  v_xor_b32 v2, s4, v26
  v_lshl_add_u32 v7, v2, 5, v25
  v_mov_b64 v[128:129], 0
  v_mov_b64 v[130:131], 0
  v_mov_b64 v[132:133], 0
  v_mov_b64 v[134:135], 0
  v_mov_b64 v[136:137], 0
  v_mov_b64 v[138:139], 0
  v_mov_b64 v[140:141], 0
  v_mov_b64 v[142:143], 0
  v_mov_b64 v[144:145], 0
  v_mov_b64 v[146:147], 0
  v_mov_b64 v[148:149], 0
  v_mov_b64 v[150:151], 0
  v_mov_b64 v[152:153], 0
  v_mov_b64 v[154:155], 0
  v_mov_b64 v[156:157], 0
  v_mov_b64 v[158:159], 0
  v_mov_b64 v[160:161], 0
  v_mov_b64 v[162:163], 0
  v_mov_b64 v[164:165], 0
  v_mov_b64 v[166:167], 0
  v_mov_b64 v[168:169], 0
  v_mov_b64 v[170:171], 0
  v_mov_b64 v[172:173], 0
  v_mov_b64 v[174:175], 0
  v_mov_b64 v[176:177], 0
  v_mov_b64 v[178:179], 0
  v_mov_b64 v[180:181], 0
  v_mov_b64 v[182:183], 0
  v_mov_b64 v[184:185], 0
  v_mov_b64 v[186:187], 0
  v_mov_b64 v[188:189], 0
  v_mov_b64 v[190:191], 0
  v_mov_b64 v[192:193], 0
  v_mov_b64 v[194:195], 0
  v_mov_b64 v[196:197], 0
  v_mov_b64 v[198:199], 0
  v_mov_b64 v[200:201], 0
  v_mov_b64 v[202:203], 0
  v_mov_b64 v[204:205], 0
  v_mov_b64 v[206:207], 0
  v_mov_b64 v[208:209], 0
  v_mov_b64 v[210:211], 0
  v_mov_b64 v[212:213], 0
  v_mov_b64 v[214:215], 0
  v_mov_b64 v[216:217], 0
  v_mov_b64 v[218:219], 0
  v_mov_b64 v[220:221], 0
  v_mov_b64 v[222:223], 0
  s_mul_i32 s4, s85, 320
  s_add_u32 s4, s4, 151552
  v_and_b32_e64 v2, 15, v1
  v_lshl_add_u32 v3, v2, 2, s4
  v_add_u32 v10, s4, v29
  s_lshl_b32 s5, s86, 7
  s_add_u32 s5, s5, 153088
  v_add_u32_e64 v8, s5, v29
  v_lshl_add_u32 v2, v2, 2, s5
  s_mov_b32 s10, 0x7f
  s_mov_b32 s12, 0xff00ff00
  s_add_u32 s9, s11, 65536
  v_lshrrev_b32_e64 v9, 1, v11
  v_bfi_b32 v9, s10, v11, v9
  s_mov_b32 s22, Lz1-Lz0+8
  s_cmp_lg_u32 s82, 0
  s_cselect_b64 vcc, -1, 0
  s_waitcnt lgkmcnt(0)
  s_barrier
Lo_5:
  ds_read_b128 v[32:35], v4 offset:0
  ds_read_b128 v[48:51], v5 offset:0
  ds_read_b128 v[36:39], v4 offset:2048
  ds_read_b128 v[52:55], v5 offset:2048
  ds_read_b128 v[40:43], v4 offset:4096
  ds_read_b128 v[56:59], v5 offset:4096
  ds_read_b64_tr_b16 v[96:97], v6 offset:0
  ds_read_b64_tr_b16 v[98:99], v6 offset:2048
  ds_read_b64_tr_b16 v[100:101], v6 offset:4096
  ds_read_b64_tr_b16 v[102:103], v6 offset:6144
  ds_read_b128 v[44:47], v4 offset:6144
  ds_read_b128 v[60:63], v5 offset:6144
  ds_read_b64_tr_b16 v[104:105], v7 offset:0
  s_nop 0
  s_waitcnt lgkmcnt(8)
  ds_read_b64_tr_b16 v[106:107], v7 offset:2048
  ds_read_b64_tr_b16 v[108:109], v7 offset:4096
  ds_read_b64_tr_b16 v[110:111], v7 offset:6144
  s_nop 0
  s_waitcnt lgkmcnt(6)
  .p2align 7
Lk_2:
  v_mfma_f32_16x16x32_bf16 v[128:131], v[96:99], v[32:35], v[128:131]
  ds_read_b64_tr_b16 v[112:113], v6 offset:8192
  v_mfma_f32_16x16x32_bf16 v[128:131], v[100:103], v[48:51], v[128:131]
  ds_read_b64_tr_b16 v[114:115], v6 offset:10240
  v_mfma_f32_16x16x32_bf16 v[136:139], v[100:103], v[52:55], v[136:139]
  ds_read_b64_tr_b16 v[116:117], v6 offset:12288
  v_mfma_f32_16x16x32_bf16 v[136:139], v[96:99], v[36:39], v[136:139]
  ds_read_b64_tr_b16 v[118:119], v6 offset:14336
  v_mfma_f32_16x16x32_bf16 v[144:147], v[96:99], v[40:43], v[144:147]
  s_add_u32 s16, s16, s17
  s_cmp_eq_u32 s16, 65536
  s_cselect_b32 s23, s18, s17
  s_cselect_b32 s16, Lz1-Lz0+0, s16
  v_mfma_f32_16x16x32_bf16 v[144:147], v[100:103], v[56:59], v[144:147]
  v_add_u32_e64 v4, s23, v4
  v_add_u32 v5, s23, v5
  s_add_u32 s19, s19, s20
  s_cmp_eq_u32 s19, 73728
  s_waitcnt lgkmcnt(8)
  v_mfma_f32_16x16x32_bf16 v[152:155], v[100:103], v[60:63], v[152:155]
  s_cselect_b32 s23, s21, s20
  s_cselect_b32 s19, 0, s19
  v_mfma_f32_16x16x32_bf16 v[152:155], v[96:99], v[44:47], v[152:155]
  s_waitcnt lgkmcnt(4)
  v_mfma_f32_16x16x32_bf16 v[156:159], v[104:107], v[44:47], v[156:159]
  ds_read_b64_tr_b16 v[120:121], v7 offset:8192
  v_mfma_f32_16x16x32_bf16 v[156:159], v[108:111], v[60:63], v[156:159]
  ds_read_b64_tr_b16 v[122:123], v7 offset:10240
  v_mfma_f32_16x16x32_bf16 v[148:151], v[108:111], v[56:59], v[148:151]
  ds_read_b64_tr_b16 v[124:125], v7 offset:12288
  v_mfma_f32_16x16x32_bf16 v[148:151], v[104:107], v[40:43], v[148:151]
  ds_read_b64_tr_b16 v[126:127], v7 offset:14336
  v_mfma_f32_16x16x32_bf16 v[140:143], v[104:107], v[36:39], v[140:143]
  ds_read_b64_tr_b16 v[224:225], v6 offset:16384
  v_mfma_f32_16x16x32_bf16 v[140:143], v[108:111], v[52:55], v[140:143]
  ds_read_b64_tr_b16 v[226:227], v6 offset:18432
  v_mfma_f32_16x16x32_bf16 v[132:135], v[108:111], v[48:51], v[132:135]
  ds_read_b64_tr_b16 v[228:229], v6 offset:20480
  v_mfma_f32_16x16x32_bf16 v[132:135], v[104:107], v[32:35], v[132:135]
  ds_read_b64_tr_b16 v[230:231], v6 offset:22528
  s_nop 0
  s_waitcnt lgkmcnt(8)
  v_mfma_f32_16x16x32_bf16 v[160:163], v[112:115], v[32:35], v[160:163]
  ds_read_b64_tr_b16 v[232:233], v7 offset:16384
  v_mfma_f32_16x16x32_bf16 v[160:163], v[116:119], v[48:51], v[160:163]
  ds_read_b64_tr_b16 v[234:235], v7 offset:18432
  v_mfma_f32_16x16x32_bf16 v[168:171], v[116:119], v[52:55], v[168:171]
  ds_read_b64_tr_b16 v[236:237], v7 offset:20480
  v_mfma_f32_16x16x32_bf16 v[168:171], v[112:115], v[36:39], v[168:171]
  ds_read_b64_tr_b16 v[238:239], v7 offset:22528
  v_mfma_f32_16x16x32_bf16 v[176:179], v[112:115], v[40:43], v[176:179]
  v_add_u32_e64 v6, s23, v6
  v_mfma_f32_16x16x32_bf16 v[176:179], v[116:119], v[56:59], v[176:179]
  v_add_u32_e64 v7, s23, v7
  v_mfma_f32_16x16x32_bf16 v[184:187], v[116:119], v[60:63], v[184:187]
  v_mfma_f32_16x16x32_bf16 v[184:187], v[112:115], v[44:47], v[184:187]
  s_cbranch_vccnz Lo_8
  s_waitcnt lgkmcnt(0)
  s_nop 0
  s_barrier
Lo_7:
  v_mfma_f32_16x16x32_bf16 v[188:191], v[120:123], v[44:47], v[188:191]
  ds_read_b128 v[64:67], v4 offset:0
  v_mfma_f32_16x16x32_bf16 v[188:191], v[124:127], v[60:63], v[188:191]
  ds_read_b128 v[80:83], v5 offset:0
  v_mfma_f32_16x16x32_bf16 v[180:183], v[124:127], v[56:59], v[180:183]
  v_mfma_f32_16x16x32_bf16 v[180:183], v[120:123], v[40:43], v[180:183]
  ds_read_b128 v[68:71], v4 offset:2048
  v_mfma_f32_16x16x32_bf16 v[172:175], v[120:123], v[36:39], v[172:175]
  ds_read_b128 v[84:87], v5 offset:2048
  v_mfma_f32_16x16x32_bf16 v[172:175], v[124:127], v[52:55], v[172:175]
  v_mfma_f32_16x16x32_bf16 v[164:167], v[124:127], v[48:51], v[164:167]
  ds_read_b128 v[72:75], v4 offset:4096
  v_mfma_f32_16x16x32_bf16 v[164:167], v[120:123], v[32:35], v[164:167]
  ds_read_b128 v[88:91], v5 offset:4096
  v_mfma_f32_16x16x32_bf16 v[192:195], v[32:35], v[224:227], v[192:195]
  ds_read_b64_tr_b16 v[96:97], v6 offset:0
  v_mfma_f32_16x16x32_bf16 v[192:195], v[48:51], v[228:231], v[192:195]
  ds_read_b64_tr_b16 v[98:99], v6 offset:2048
  v_mfma_f32_16x16x32_bf16 v[200:203], v[52:55], v[228:231], v[200:203]
  ds_read_b64_tr_b16 v[100:101], v6 offset:4096
  v_mfma_f32_16x16x32_bf16 v[200:203], v[36:39], v[224:227], v[200:203]
  ds_read_b64_tr_b16 v[102:103], v6 offset:6144
  v_mfma_f32_16x16x32_bf16 v[208:211], v[40:43], v[224:227], v[208:211]
  ds_read_b128 v[76:79], v4 offset:6144
  v_mfma_f32_16x16x32_bf16 v[208:211], v[56:59], v[228:231], v[208:211]
  v_mfma_f32_16x16x32_bf16 v[216:219], v[60:63], v[228:231], v[216:219]
  ds_read_b128 v[92:95], v5 offset:6144
  v_mfma_f32_16x16x32_bf16 v[216:219], v[44:47], v[224:227], v[216:219]
  v_mfma_f32_16x16x32_bf16 v[220:223], v[44:47], v[232:235], v[220:223]
  ds_read_b64_tr_b16 v[104:105], v7 offset:0
  v_mfma_f32_16x16x32_bf16 v[220:223], v[60:63], v[236:239], v[220:223]
  v_mfma_f32_16x16x32_bf16 v[212:215], v[56:59], v[236:239], v[212:215]
  ds_read_b64_tr_b16 v[106:107], v7 offset:2048
  v_mfma_f32_16x16x32_bf16 v[212:215], v[40:43], v[232:235], v[212:215]
  v_mfma_f32_16x16x32_bf16 v[204:207], v[36:39], v[232:235], v[204:207]
  ds_read_b64_tr_b16 v[108:109], v7 offset:4096
  v_mfma_f32_16x16x32_bf16 v[204:207], v[52:55], v[236:239], v[204:207]
  v_mfma_f32_16x16x32_bf16 v[196:199], v[48:51], v[236:239], v[196:199]
  ds_read_b64_tr_b16 v[110:111], v7 offset:6144
  s_waitcnt lgkmcnt(6)
  v_mfma_f32_16x16x32_bf16 v[196:199], v[32:35], v[232:235], v[196:199]
  s_cbranch_vccnz Lo_6
Lk_3:
  v_mfma_f32_16x16x32_bf16 v[128:131], v[96:99], v[64:67], v[128:131]
  ds_read_b64_tr_b16 v[112:113], v6 offset:8192
  v_mfma_f32_16x16x32_bf16 v[128:131], v[100:103], v[80:83], v[128:131]
  ds_read_b64_tr_b16 v[114:115], v6 offset:10240
  v_mfma_f32_16x16x32_bf16 v[136:139], v[100:103], v[84:87], v[136:139]
  ds_read_b64_tr_b16 v[116:117], v6 offset:12288
  v_mfma_f32_16x16x32_bf16 v[136:139], v[96:99], v[68:71], v[136:139]
  ds_read_b64_tr_b16 v[118:119], v6 offset:14336
  v_mfma_f32_16x16x32_bf16 v[144:147], v[96:99], v[72:75], v[144:147]
  s_add_u32 s16, s16, s17
  s_cmp_eq_u32 s16, 65536
  s_cselect_b32 s23, s18, s17
  s_cselect_b32 s16, Lz1-Lz0+0, s16
  v_mfma_f32_16x16x32_bf16 v[144:147], v[100:103], v[88:91], v[144:147]
  v_add_u32_e64 v4, s23, v4
  v_add_u32 v5, s23, v5
  s_add_u32 s19, s19, s20
  s_cmp_eq_u32 s19, 73728
  s_waitcnt lgkmcnt(8)
  v_mfma_f32_16x16x32_bf16 v[152:155], v[100:103], v[92:95], v[152:155]
  s_cselect_b32 s23, s21, s20
  s_cselect_b32 s19, 0, s19
  v_mfma_f32_16x16x32_bf16 v[152:155], v[96:99], v[76:79], v[152:155]
  s_waitcnt lgkmcnt(4)
  v_mfma_f32_16x16x32_bf16 v[156:159], v[104:107], v[76:79], v[156:159]
  ds_read_b64_tr_b16 v[120:121], v7 offset:8192
  v_mfma_f32_16x16x32_bf16 v[156:159], v[108:111], v[92:95], v[156:159]
  ds_read_b64_tr_b16 v[122:123], v7 offset:10240
  v_mfma_f32_16x16x32_bf16 v[148:151], v[108:111], v[88:91], v[148:151]
  ds_read_b64_tr_b16 v[124:125], v7 offset:12288
  v_mfma_f32_16x16x32_bf16 v[148:151], v[104:107], v[72:75], v[148:151]
  ds_read_b64_tr_b16 v[126:127], v7 offset:14336
  v_mfma_f32_16x16x32_bf16 v[140:143], v[104:107], v[68:71], v[140:143]
  ds_read_b64_tr_b16 v[224:225], v6 offset:16384
  v_mfma_f32_16x16x32_bf16 v[140:143], v[108:111], v[84:87], v[140:143]
  ds_read_b64_tr_b16 v[226:227], v6 offset:18432
  v_mfma_f32_16x16x32_bf16 v[132:135], v[108:111], v[80:83], v[132:135]
  ds_read_b64_tr_b16 v[228:229], v6 offset:20480
  v_mfma_f32_16x16x32_bf16 v[132:135], v[104:107], v[64:67], v[132:135]
  ds_read_b64_tr_b16 v[230:231], v6 offset:22528
  s_nop 0
  s_waitcnt lgkmcnt(8)
  v_mfma_f32_16x16x32_bf16 v[160:163], v[112:115], v[64:67], v[160:163]
  ds_read_b64_tr_b16 v[232:233], v7 offset:16384
  v_mfma_f32_16x16x32_bf16 v[160:163], v[116:119], v[80:83], v[160:163]
  ds_read_b64_tr_b16 v[234:235], v7 offset:18432
  v_mfma_f32_16x16x32_bf16 v[168:171], v[116:119], v[84:87], v[168:171]
  ds_read_b64_tr_b16 v[236:237], v7 offset:20480
  v_mfma_f32_16x16x32_bf16 v[168:171], v[112:115], v[68:71], v[168:171]
  ds_read_b64_tr_b16 v[238:239], v7 offset:22528
  v_mfma_f32_16x16x32_bf16 v[176:179], v[112:115], v[72:75], v[176:179]
  v_add_u32_e64 v6, s23, v6
  v_mfma_f32_16x16x32_bf16 v[176:179], v[116:119], v[88:91], v[176:179]
  v_add_u32_e64 v7, s23, v7
  v_mfma_f32_16x16x32_bf16 v[184:187], v[116:119], v[92:95], v[184:187]
  s_sub_u32 s22, s22, 1
  s_cmp_lg_u32 s22, 0
  v_mfma_f32_16x16x32_bf16 v[184:187], v[112:115], v[76:79], v[184:187]
  s_waitcnt lgkmcnt(0)
  s_barrier
  v_mfma_f32_16x16x32_bf16 v[188:191], v[120:123], v[76:79], v[188:191]
  s_nop 0
  s_cbranch_scc0 Lk_4
  ds_read_b128 v[32:35], v4 offset:0
  v_mfma_f32_16x16x32_bf16 v[188:191], v[124:127], v[92:95], v[188:191]
  ds_read_b128 v[48:51], v5 offset:0
  v_mfma_f32_16x16x32_bf16 v[180:183], v[124:127], v[88:91], v[180:183]
  v_mfma_f32_16x16x32_bf16 v[180:183], v[120:123], v[72:75], v[180:183]
  ds_read_b128 v[36:39], v4 offset:2048
  v_mfma_f32_16x16x32_bf16 v[172:175], v[120:123], v[68:71], v[172:175]
  ds_read_b128 v[52:55], v5 offset:2048
  v_mfma_f32_16x16x32_bf16 v[172:175], v[124:127], v[84:87], v[172:175]
  v_mfma_f32_16x16x32_bf16 v[164:167], v[124:127], v[80:83], v[164:167]
  ds_read_b128 v[40:43], v4 offset:4096
  v_mfma_f32_16x16x32_bf16 v[164:167], v[120:123], v[64:67], v[164:167]
  ds_read_b128 v[56:59], v5 offset:4096
  v_mfma_f32_16x16x32_bf16 v[192:195], v[64:67], v[224:227], v[192:195]
  ds_read_b64_tr_b16 v[96:97], v6 offset:0
  v_mfma_f32_16x16x32_bf16 v[192:195], v[80:83], v[228:231], v[192:195]
  ds_read_b64_tr_b16 v[98:99], v6 offset:2048
  v_mfma_f32_16x16x32_bf16 v[200:203], v[84:87], v[228:231], v[200:203]
  ds_read_b64_tr_b16 v[100:101], v6 offset:4096
  v_mfma_f32_16x16x32_bf16 v[200:203], v[68:71], v[224:227], v[200:203]
  ds_read_b64_tr_b16 v[102:103], v6 offset:6144
  v_mfma_f32_16x16x32_bf16 v[208:211], v[72:75], v[224:227], v[208:211]
  ds_read_b128 v[44:47], v4 offset:6144
  v_mfma_f32_16x16x32_bf16 v[208:211], v[88:91], v[228:231], v[208:211]
  v_mfma_f32_16x16x32_bf16 v[216:219], v[92:95], v[228:231], v[216:219]
  ds_read_b128 v[60:63], v5 offset:6144
  v_mfma_f32_16x16x32_bf16 v[216:219], v[76:79], v[224:227], v[216:219]
  v_mfma_f32_16x16x32_bf16 v[220:223], v[76:79], v[232:235], v[220:223]
  ds_read_b64_tr_b16 v[104:105], v7 offset:0
  v_mfma_f32_16x16x32_bf16 v[220:223], v[92:95], v[236:239], v[220:223]
  v_mfma_f32_16x16x32_bf16 v[212:215], v[88:91], v[236:239], v[212:215]
  ds_read_b64_tr_b16 v[106:107], v7 offset:2048
  v_mfma_f32_16x16x32_bf16 v[212:215], v[72:75], v[232:235], v[212:215]
  v_mfma_f32_16x16x32_bf16 v[204:207], v[68:71], v[232:235], v[204:207]
  ds_read_b64_tr_b16 v[108:109], v7 offset:4096
  v_mfma_f32_16x16x32_bf16 v[204:207], v[84:87], v[236:239], v[204:207]
  v_mfma_f32_16x16x32_bf16 v[196:199], v[80:83], v[236:239], v[196:199]
  ds_read_b64_tr_b16 v[110:111], v7 offset:6144
  s_waitcnt lgkmcnt(6)
  v_mfma_f32_16x16x32_bf16 v[196:199], v[64:67], v[232:235], v[196:199]
  s_branch Lk_2
Lk_4:
  ds_read2_b32 v[4:5], v3 offset0:48 offset1:208
  ds_read_b128 v[106:109], v8 offset:256
  v_mfma_f32_16x16x32_bf16 v[188:191], v[124:127], v[92:95], v[188:191]
  ds_read_b128 v[110:113], v8 offset:320
  ds_read_b128 v[32:35], v10 offset:192
  v_mfma_f32_16x16x32_bf16 v[216:219], v[92:95], v[228:231], v[216:219]
  ds_read_b128 v[36:39], v10 offset:832
  ds_read2_b32 v[114:115], v2 offset0:128 offset1:144
  v_mfma_f32_16x16x32_bf16 v[216:219], v[76:79], v[224:227], v[216:219]
  ds_read_b128 v[98:101], v8 offset:0
  ds_read_b128 v[102:105], v8 offset:64
  v_mfma_f32_16x16x32_bf16 v[220:223], v[76:79], v[232:235], v[220:223]
  ds_read2_b32 v[6:7], v3 offset0:32 offset1:192
  ds_read2_b32 v[96:97], v3 offset0:16 offset1:176
  v_mfma_f32_16x16x32_bf16 v[220:223], v[92:95], v[236:239], v[220:223]
  v_mfma_f32_16x16x32_bf16 v[180:183], v[124:127], v[88:91], v[180:183]
  v_mfma_f32_16x16x32_bf16 v[180:183], v[120:123], v[72:75], v[180:183]
  v_mfma_f32_16x16x32_bf16 v[172:175], v[120:123], v[68:71], v[172:175]
  s_nop 0
  s_waitcnt lgkmcnt(4)
  v_fma_f32 v184, -v106, v5, v184
  v_fma_f32 v185, -v107, v5, v185
  v_fma_f32 v186, -v108, v5, v186
  v_mfma_f32_16x16x32_bf16 v[172:175], v[124:127], v[84:87], v[172:175]
  v_fma_f32 v187, -v109, v5, v187
  v_mul_f32 v184, v184, v4
  v_mul_f32 v185, v185, v4
  v_mfma_f32_16x16x32_bf16 v[164:167], v[124:127], v[80:83], v[164:167]
  v_mul_f32 v186, v186, v4
  v_mul_f32 v187, v187, v4
  v_cvt_pk_bf16_f32 v60, v184, v185
  v_mfma_f32_16x16x32_bf16 v[164:167], v[120:123], v[64:67], v[164:167]
  v_cvt_pk_bf16_f32 v61, v186, v187
  v_fma_f32 v188, -v110, v5, v188
  v_fma_f32 v189, -v111, v5, v189
  v_mfma_f32_16x16x32_bf16 v[192:195], v[64:67], v[224:227], v[192:195]
  ds_read2_b32 v[124:125], v3 offset0:0 offset1:160
  v_fma_f32 v190, -v112, v5, v190
  v_fma_f32 v191, -v113, v5, v191
  v_mul_f32_e64 v188, v188, v4
  v_mfma_f32_16x16x32_bf16 v[192:195], v[80:83], v[228:231], v[192:195]
  v_mov_b32 v120, 0x3f803f80
  v_mul_f32 v189, v189, v4
  v_mul_f32 v190, v190, v4
  v_mul_f32_e64 v191, v191, v4
  v_mfma_f32_16x16x32_bf16 v[196:199], v[80:83], v[236:239], v[196:199]
  v_mov_b32 v121, 0x3f803f80
  v_cvt_pk_bf16_f32 v62, v188, v189
  v_cvt_pk_bf16_f32 v63, v190, v191
  v_mfma_f32_16x16x32_bf16 v[196:199], v[64:67], v[232:235], v[196:199]
  v_mov_b32 v122, 0x3f803f80
  s_mov_b32 exec_lo, s12
  s_mov_b32 exec_hi, s12
  buffer_store_dwordx4 v[60:63], v9, s[40:43], s9 offen sc0 sc1
  s_nop 0
  s_mov_b64 exec, -1
  v_fma_f32 v216, -v36, v114, v216
  v_fma_f32 v217, -v37, v114, v217
  v_fma_f32 v218, -v38, v114, v218
  v_mfma_f32_16x16x32_bf16 v[204:207], v[68:71], v[232:235], v[204:207]
  v_mov_b32 v123, 0x3f803f80
  v_fma_f32 v219, -v39, v114, v219
  v_mul_f32 v216, v216, v32
  v_mul_f32 v217, v217, v33
  v_mfma_f32_16x16x32_bf16 v[204:207], v[84:87], v[236:239], v[204:207]
  v_mul_f32 v218, v218, v34
  v_mul_f32 v219, v219, v35
  v_cvt_pk_bf16_f32 v76, v216, v217
  v_mfma_f32_16x16x32_bf16 v[200:203], v[84:87], v[228:231], v[200:203]
  v_cvt_pk_bf16_f32 v77, v218, v219
  v_fma_f32 v220, -v36, v115, v220
  v_fma_f32 v221, -v37, v115, v221
  v_mfma_f32_16x16x32_bf16 v[200:203], v[68:71], v[224:227], v[200:203]
  v_fma_f32 v222, -v38, v115, v222
  v_fma_f32 v223, -v39, v115, v223
  v_mul_f32_e64 v220, v220, v32
  v_mfma_f32_16x16x32_bf16 v[208:211], v[72:75], v[224:227], v[208:211]
  v_mul_f32 v221, v221, v33
  v_mul_f32 v222, v222, v34
  v_mul_f32_e64 v223, v223, v35
  v_mfma_f32_16x16x32_bf16 v[208:211], v[88:91], v[228:231], v[208:211]
  v_cvt_pk_bf16_f32 v78, v220, v221
  v_cvt_pk_bf16_f32 v79, v222, v223
  v_mfma_f32_16x16x32_bf16 v[212:215], v[88:91], v[236:239], v[212:215]
  s_mov_b32 exec_lo, 0
  buffer_store_dwordx4 v[76:79], v11, s[40:43], s9 offen sc0 sc1
  s_mov_b64 exec, -1
  v_mfma_f32_16x16x32_bf16 v[212:215], v[72:75], v[232:235], v[212:215]
  v_mov_b64_e64 v[86:87], v[78:79]
  s_cmp_lg_u32 s82, 0
  s_cbranch_scc1 L_9
  ds_read_b128 v[240:243], v255 offset:16384
  ds_read_b128 v[244:247], v255 offset:18432
  ds_read_b128 v[248:251], v255 offset:20480
  ds_read_b128 v[252:255], v255 offset:22528
L_9:
  v_mov_b64 v[64:65], 0
  v_mov_b64 v[66:67], 0
  v_mov_b64_e64 v[232:233], 0
  v_mov_b64 v[234:235], 0
  s_waitcnt lgkmcnt(0)
  v_pk_fma_f32 v[128:129], v[98:99], v[124:125], v[128:129] op_sel:[0,1,0] op_sel_hi:[1,1,1] neg_lo:[1,0,0] neg_hi:[1,0,0]
  v_pk_fma_f32 v[130:131], v[100:101], v[124:125], v[130:131] op_sel:[0,1,0] op_sel_hi:[1,1,1] neg_lo:[1,0,0] neg_hi:[1,0,0]
  v_pk_fma_f32 v[132:133], v[102:103], v[124:125], v[132:133] op_sel:[0,1,0] op_sel_hi:[1,1,1] neg_lo:[1,0,0] neg_hi:[1,0,0]
  v_pk_fma_f32 v[134:135], v[104:105], v[124:125], v[134:135] op_sel:[0,1,0] op_sel_hi:[1,1,1] neg_lo:[1,0,0] neg_hi:[1,0,0]
  v_cvt_pk_bf16_f32 v32, v128, v129
  v_cvt_pk_bf16_f32 v33, v130, v131
  v_cvt_pk_bf16_f32 v34, v132, v133
  v_cvt_pk_bf16_f32 v35, v134, v135
  v_pk_fma_f32 v[136:137], v[98:99], v[96:97], v[136:137] op_sel:[0,1,0] op_sel_hi:[1,1,1] neg_lo:[1,0,0] neg_hi:[1,0,0]
  v_pk_fma_f32 v[138:139], v[100:101], v[96:97], v[138:139] op_sel:[0,1,0] op_sel_hi:[1,1,1] neg_lo:[1,0,0] neg_hi:[1,0,0]
  v_pk_fma_f32 v[140:141], v[102:103], v[96:97], v[140:141] op_sel:[0,1,0] op_sel_hi:[1,1,1] neg_lo:[1,0,0] neg_hi:[1,0,0]
  v_pk_fma_f32 v[142:143], v[104:105], v[96:97], v[142:143] op_sel:[0,1,0] op_sel_hi:[1,1,1] neg_lo:[1,0,0] neg_hi:[1,0,0]
  v_cvt_pk_bf16_f32 v36, v136, v137
  v_cvt_pk_bf16_f32 v37, v138, v139
  v_cvt_pk_bf16_f32 v38, v140, v141
  v_cvt_pk_bf16_f32 v39, v142, v143
  v_pk_fma_f32 v[144:145], v[98:99], v[6:7], v[144:145] op_sel:[0,1,0] op_sel_hi:[1,1,1] neg_lo:[1,0,0] neg_hi:[1,0,0]
  v_pk_fma_f32 v[146:147], v[100:101], v[6:7], v[146:147] op_sel:[0,1,0] op_sel_hi:[1,1,1] neg_lo:[1,0,0] neg_hi:[1,0,0]
  v_pk_fma_f32 v[148:149], v[102:103], v[6:7], v[148:149] op_sel:[0,1,0] op_sel_hi:[1,1,1] neg_lo:[1,0,0] neg_hi:[1,0,0]
  v_pk_fma_f32 v[150:151], v[104:105], v[6:7], v[150:151] op_sel:[0,1,0] op_sel_hi:[1,1,1] neg_lo:[1,0,0] neg_hi:[1,0,0]
  v_cvt_pk_bf16_f32 v40, v144, v145
  v_cvt_pk_bf16_f32 v41, v146, v147
  v_cvt_pk_bf16_f32 v42, v148, v149
  v_cvt_pk_bf16_f32 v43, v150, v151
  v_pk_fma_f32 v[152:153], v[98:99], v[4:5], v[152:153] op_sel:[0,1,0] op_sel_hi:[1,1,1] neg_lo:[1,0,0] neg_hi:[1,0,0]
  v_pk_fma_f32 v[154:155], v[100:101], v[4:5], v[154:155] op_sel:[0,1,0] op_sel_hi:[1,1,1] neg_lo:[1,0,0] neg_hi:[1,0,0]
  v_pk_fma_f32 v[156:157], v[102:103], v[4:5], v[156:157] op_sel:[0,1,0] op_sel_hi:[1,1,1] neg_lo:[1,0,0] neg_hi:[1,0,0]
  v_pk_fma_f32 v[158:159], v[104:105], v[4:5], v[158:159] op_sel:[0,1,0] op_sel_hi:[1,1,1] neg_lo:[1,0,0] neg_hi:[1,0,0]
  v_cvt_pk_bf16_f32 v44, v152, v153
  v_cvt_pk_bf16_f32 v45, v154, v155
  v_cvt_pk_bf16_f32 v46, v156, v157
  v_cvt_pk_bf16_f32 v47, v158, v159
  ds_read_b128 v[128:131], v10 offset:0
  ds_read_b128 v[132:135], v10 offset:640
  ds_read_b128 v[136:139], v10 offset:64
  ds_read_b128 v[140:143], v10 offset:704
  ds_read_b128 v[144:147], v10 offset:128
  ds_read_b128 v[148:151], v10 offset:768
  v_pk_fma_f32 v[160:161], v[106:107], v[124:125], v[160:161] op_sel:[0,1,0] op_sel_hi:[1,1,1] neg_lo:[1,0,0] neg_hi:[1,0,0]
  v_pk_fma_f32 v[162:163], v[108:109], v[124:125], v[162:163] op_sel:[0,1,0] op_sel_hi:[1,1,1] neg_lo:[1,0,0] neg_hi:[1,0,0]
  v_pk_fma_f32 v[164:165], v[110:111], v[124:125], v[164:165] op_sel:[0,1,0] op_sel_hi:[1,1,1] neg_lo:[1,0,0] neg_hi:[1,0,0]
  v_pk_fma_f32 v[166:167], v[112:113], v[124:125], v[166:167] op_sel:[0,1,0] op_sel_hi:[1,1,1] neg_lo:[1,0,0] neg_hi:[1,0,0]
  v_pk_mul_f32 v[160:161], v[160:161], v[124:125] op_sel_hi:[1,0]
  v_pk_mul_f32 v[162:163], v[162:163], v[124:125] op_sel_hi:[1,0]
  v_pk_mul_f32 v[164:165], v[164:165], v[124:125] op_sel_hi:[1,0]
  v_pk_mul_f32 v[166:167], v[166:167], v[124:125] op_sel_hi:[1,0]
  v_cvt_pk_bf16_f32 v48, v160, v161
  v_cvt_pk_bf16_f32 v49, v162, v163
  v_cvt_pk_bf16_f32 v50, v164, v165
  v_cvt_pk_bf16_f32 v51, v166, v167
  v_pk_fma_f32 v[168:169], v[106:107], v[96:97], v[168:169] op_sel:[0,1,0] op_sel_hi:[1,1,1] neg_lo:[1,0,0] neg_hi:[1,0,0]
  v_pk_fma_f32 v[170:171], v[108:109], v[96:97], v[170:171] op_sel:[0,1,0] op_sel_hi:[1,1,1] neg_lo:[1,0,0] neg_hi:[1,0,0]
  v_pk_fma_f32 v[172:173], v[110:111], v[96:97], v[172:173] op_sel:[0,1,0] op_sel_hi:[1,1,1] neg_lo:[1,0,0] neg_hi:[1,0,0]
  v_pk_fma_f32 v[174:175], v[112:113], v[96:97], v[174:175] op_sel:[0,1,0] op_sel_hi:[1,1,1] neg_lo:[1,0,0] neg_hi:[1,0,0]
  v_pk_mul_f32 v[168:169], v[168:169], v[96:97] op_sel_hi:[1,0]
  v_pk_mul_f32 v[170:171], v[170:171], v[96:97] op_sel_hi:[1,0]
  v_pk_mul_f32 v[172:173], v[172:173], v[96:97] op_sel_hi:[1,0]
  v_pk_mul_f32 v[174:175], v[174:175], v[96:97] op_sel_hi:[1,0]
  v_cvt_pk_bf16_f32 v52, v168, v169
  v_cvt_pk_bf16_f32 v53, v170, v171
  v_cvt_pk_bf16_f32 v54, v172, v173
  v_cvt_pk_bf16_f32 v55, v174, v175
  v_pk_fma_f32 v[176:177], v[106:107], v[6:7], v[176:177] op_sel:[0,1,0] op_sel_hi:[1,1,1] neg_lo:[1,0,0] neg_hi:[1,0,0]
  v_pk_fma_f32 v[178:179], v[108:109], v[6:7], v[178:179] op_sel:[0,1,0] op_sel_hi:[1,1,1] neg_lo:[1,0,0] neg_hi:[1,0,0]
  v_pk_fma_f32 v[180:181], v[110:111], v[6:7], v[180:181] op_sel:[0,1,0] op_sel_hi:[1,1,1] neg_lo:[1,0,0] neg_hi:[1,0,0]
  v_pk_fma_f32 v[182:183], v[112:113], v[6:7], v[182:183] op_sel:[0,1,0] op_sel_hi:[1,1,1] neg_lo:[1,0,0] neg_hi:[1,0,0]
  v_pk_mul_f32 v[176:177], v[176:177], v[6:7] op_sel_hi:[1,0]
  v_pk_mul_f32 v[178:179], v[178:179], v[6:7] op_sel_hi:[1,0]
  v_pk_mul_f32 v[180:181], v[180:181], v[6:7] op_sel_hi:[1,0]
  v_pk_mul_f32 v[182:183], v[182:183], v[6:7] op_sel_hi:[1,0]
  v_cvt_pk_bf16_f32 v56, v176, v177
  v_cvt_pk_bf16_f32 v57, v178, v179
  v_cvt_pk_bf16_f32 v58, v180, v181
  v_cvt_pk_bf16_f32 v59, v182, v183
  v_mfma_f32_16x16x32_bf16 v[164:167], v[48:51], v[32:35], v[12:15]
  v_mfma_f32_16x16x32_bf16 v[168:171], v[48:51], v[36:39], v[16:19]
  v_mfma_f32_16x16x32_bf16 v[172:175], v[52:55], v[36:39], v[12:15]
  v_mfma_f32_16x16x32_bf16 v[176:179], v[52:55], v[40:43], v[16:19]
  v_mfma_f32_16x16x32_bf16 v[180:183], v[56:59], v[40:43], v[12:15]
  v_mfma_f32_16x16x32_bf16 v[184:187], v[56:59], v[44:47], v[16:19]
  v_mfma_f32_16x16x32_bf16 v[188:191], v[60:63], v[44:47], v[12:15]
  s_nop 0
  s_waitcnt lgkmcnt(0)
  v_pk_fma_f32 v[192:193], v[132:133], v[114:115], v[192:193] op_sel:[0,0,0] op_sel_hi:[1,0,1] neg_lo:[1,0,0] neg_hi:[1,0,0]
  v_pk_fma_f32 v[194:195], v[134:135], v[114:115], v[194:195] op_sel:[0,0,0] op_sel_hi:[1,0,1] neg_lo:[1,0,0] neg_hi:[1,0,0]
  v_pk_fma_f32 v[196:197], v[132:133], v[114:115], v[196:197] op_sel:[0,1,0] op_sel_hi:[1,1,1] neg_lo:[1,0,0] neg_hi:[1,0,0]
  v_pk_fma_f32 v[198:199], v[134:135], v[114:115], v[198:199] op_sel:[0,1,0] op_sel_hi:[1,1,1] neg_lo:[1,0,0] neg_hi:[1,0,0]
  v_pk_mul_f32 v[192:193], v[192:193], v[128:129]
  v_pk_mul_f32 v[194:195], v[194:195], v[130:131]
  v_pk_mul_f32 v[196:197], v[196:197], v[128:129]
  v_pk_mul_f32 v[198:199], v[198:199], v[130:131]
  v_cvt_pk_bf16_f32 v70, v192, v193
  v_cvt_pk_bf16_f32 v71, v194, v195
  v_cvt_pk_bf16_f32 v80, v196, v197
  v_cvt_pk_bf16_f32 v81, v198, v199
  v_pk_fma_f32 v[200:201], v[140:141], v[114:115], v[200:201] op_sel:[0,0,0] op_sel_hi:[1,0,1] neg_lo:[1,0,0] neg_hi:[1,0,0]
  v_pk_fma_f32 v[202:203], v[142:143], v[114:115], v[202:203] op_sel:[0,0,0] op_sel_hi:[1,0,1] neg_lo:[1,0,0] neg_hi:[1,0,0]
  v_pk_fma_f32 v[204:205], v[140:141], v[114:115], v[204:205] op_sel:[0,1,0] op_sel_hi:[1,1,1] neg_lo:[1,0,0] neg_hi:[1,0,0]
  v_pk_fma_f32 v[206:207], v[142:143], v[114:115], v[206:207] op_sel:[0,1,0] op_sel_hi:[1,1,1] neg_lo:[1,0,0] neg_hi:[1,0,0]
  v_pk_mul_f32 v[200:201], v[200:201], v[136:137]
  v_pk_mul_f32 v[202:203], v[202:203], v[138:139]
  v_pk_mul_f32 v[204:205], v[204:205], v[136:137]
  v_pk_mul_f32 v[206:207], v[206:207], v[138:139]
  v_cvt_pk_bf16_f32 v72, v200, v201
  v_cvt_pk_bf16_f32 v73, v202, v203
  v_cvt_pk_bf16_f32 v82, v204, v205
  v_cvt_pk_bf16_f32 v83, v206, v207
  v_pk_fma_f32 v[208:209], v[148:149], v[114:115], v[208:209] op_sel:[0,0,0] op_sel_hi:[1,0,1] neg_lo:[1,0,0] neg_hi:[1,0,0]
  v_pk_fma_f32 v[210:211], v[150:151], v[114:115], v[210:211] op_sel:[0,0,0] op_sel_hi:[1,0,1] neg_lo:[1,0,0] neg_hi:[1,0,0]
  v_pk_fma_f32 v[212:213], v[148:149], v[114:115], v[212:213] op_sel:[0,1,0] op_sel_hi:[1,1,1] neg_lo:[1,0,0] neg_hi:[1,0,0]
  v_pk_fma_f32 v[214:215], v[150:151], v[114:115], v[214:215] op_sel:[0,1,0] op_sel_hi:[1,1,1] neg_lo:[1,0,0] neg_hi:[1,0,0]
  v_pk_mul_f32 v[208:209], v[208:209], v[144:145]
  v_pk_mul_f32 v[210:211], v[210:211], v[146:147]
  v_pk_mul_f32 v[212:213], v[212:213], v[144:145]
  v_pk_mul_f32 v[214:215], v[214:215], v[146:147]
  v_cvt_pk_bf16_f32 v74, v208, v209
  v_cvt_pk_bf16_f32 v75, v210, v211
  v_cvt_pk_bf16_f32 v84, v212, v213
  v_cvt_pk_bf16_f32 v85, v214, v215
  v_max_f32 v172, v172, v168
  v_max_f32 v173, v173, v169
  v_max_f32 v174, v174, v170
  v_max_f32 v175, v175, v171
  v_max_f32 v180, v180, v176
  v_max_f32 v181, v181, v177
  v_max_f32 v182, v182, v178
  v_max_f32 v183, v183, v179
  v_max_f32 v188, v188, v184
  v_max_f32 v189, v189, v185
  v_max_f32 v190, v190, v186
  v_max_f32 v191, v191, v187
  v_max3_f32 v90, v172, v173, v174
  v_max3_f32 v92, v180, v181, v182
  v_max3_f32 v94, v188, v189, v190
  v_max_f32 v90, v90, v175
  v_max_f32 v92, v92, v183
  v_max_f32 v94, v94, v191
  v_mov_b32 v99, v90
  v_mov_b32 v100, v92
  v_mov_b32 v101, v94
  v_permlane32_swap_b32 v90, v99
  v_permlane32_swap_b32 v92, v100
  v_permlane32_swap_b32 v94, v101
  v_max_f32 v90, v90, v99
  v_max_f32 v92, v92, v100
  v_max_f32 v94, v94, v101
  v_mov_b32 v99, v90
  v_mov_b32 v100, v92
  v_mov_b32 v101, v94
  v_permlane16_swap_b32 v90, v99
  v_permlane16_swap_b32 v92, v100
  v_permlane16_swap_b32 v94, v101
  v_max_f32 v90, v90, v99
  v_max_f32 v92, v92, v100
  v_max_f32_e64 v94, v94, v101
  s_mov_b32 s4, 0x3e8293ee
  v_mul_f32 v91, s4, v96
  v_mul_f32 v90, v91, v90
  v_mul_f32 v93, s4, v6
  v_mul_f32 v92, v93, v92
  v_mul_f32 v95, s4, v4
  v_mul_f32 v94, v95, v94
  v_pk_fma_f32 v[172:173], v[172:173], v[90:91], v[90:91] op_sel:[0,1,0] op_sel_hi:[1,1,0] neg_lo:[0,0,1] neg_hi:[0,0,1]
  v_pk_fma_f32 v[174:175], v[174:175], v[90:91], v[90:91] op_sel:[0,1,0] op_sel_hi:[1,1,0] neg_lo:[0,0,1] neg_hi:[0,0,1]
  v_pk_fma_f32 v[180:181], v[180:181], v[92:93], v[92:93] op_sel:[0,1,0] op_sel_hi:[1,1,0] neg_lo:[0,0,1] neg_hi:[0,0,1]
  v_pk_fma_f32 v[182:183], v[182:183], v[92:93], v[92:93] op_sel:[0,1,0] op_sel_hi:[1,1,0] neg_lo:[0,0,1] neg_hi:[0,0,1]
  v_pk_fma_f32 v[188:189], v[188:189], v[94:95], v[94:95] op_sel:[0,1,0] op_sel_hi:[1,1,0] neg_lo:[0,0,1] neg_hi:[0,0,1]
  v_pk_fma_f32 v[190:191], v[190:191], v[94:95], v[94:95] op_sel:[0,1,0] op_sel_hi:[1,1,0] neg_lo:[0,0,1] neg_hi:[0,0,1]
  s_lshl_b32 s6, s84, Lz1-Lz0+3
  s_add_u32 s6, s6, 3145728
  s_add_u32 s7, s6, 4096
  s_mov_b32 exec_lo, s12
  s_mov_b32 exec_hi, s12
  buffer_load_dwordx4 v[64:67], v9, s[40:43], s11 offen sc0 sc1
  s_mov_b32 exec_lo, 0
  s_mov_b32 exec_hi, -1
  buffer_load_dwordx4 v[232:235], v11, s[40:43], s11 offen sc0 sc1
  s_mov_b64 exec, -1
  v_exp_f32 v172, v172
  v_exp_f32 v173, v173
  v_exp_f32 v174, v174
  v_exp_f32_e64 v175, v175
  v_cvt_pk_bf16_f32 v38, v172, v173
  v_cvt_pk_bf16_f32 v39, v174, v175
  v_and_b32 v36, v38, v20
  v_and_b32 v37, v39, v21
  v_xor_b32 v38, v38, v36
  v_xor_b32 v39, v39, v37
  v_exp_f32 v180, v180
  v_exp_f32 v181, v181
  v_exp_f32 v182, v182
  v_exp_f32 v183, v183
  v_cvt_pk_bf16_f32 v42, v180, v181
  v_cvt_pk_bf16_f32 v43, v182, v183
  v_and_b32 v40, v42, v20
  v_and_b32 v41, v43, v21
  v_xor_b32 v42, v42, v40
  v_xor_b32 v43, v43, v41
  v_mfma_f32_16x16x32_bf16 v[132:135], v[120:123], v[36:39], 0
  v_mfma_f32_16x16x32_bf16 v[200:203], v[70:73], v[36:39], 0
  v_mfma_f32_16x16x32_bf16 v[204:207], v[80:83], v[36:39], 0
  v_exp_f32 v188, v188
  v_exp_f32 v189, v189
  v_exp_f32 v190, v190
  v_exp_f32 v191, v191
  v_cvt_pk_bf16_f32 v46, v188, v189
  v_cvt_pk_bf16_f32 v47, v190, v191
  v_and_b32 v44, v46, v20
  v_and_b32 v45, v47, v21
  v_xor_b32 v46, v46, v44
  v_xor_b32 v47, v47, v45
  v_mfma_f32_16x16x32_bf16 v[136:139], v[120:123], v[40:43], 0
  v_mfma_f32_16x16x32_bf16 v[208:211], v[72:75], v[40:43], 0
  v_mfma_f32_16x16x32_bf16 v[212:215], v[82:85], v[40:43], 0
  v_mfma_f32_16x16x32_bf16 v[140:143], v[120:123], v[44:47], 0
  v_mfma_f32_16x16x32_bf16 v[216:219], v[74:77], v[44:47], 0
  v_mfma_f32_16x16x32_bf16 v[220:223], v[84:87], v[44:47], 0
  v_rcp_f32 v132, v132
  s_nop 0
  v_pk_mul_f32 v[200:201], v[200:201], v[132:133] op_sel_hi:[1,0]
  v_pk_mul_f32 v[202:203], v[202:203], v[132:133] op_sel_hi:[1,0]
  v_pk_mul_f32 v[204:205], v[204:205], v[132:133] op_sel_hi:[1,0]
  v_pk_mul_f32 v[206:207], v[206:207], v[132:133] op_sel_hi:[1,0]
  v_cvt_pk_bf16_f32 v52, v200, v201
  v_cvt_pk_bf16_f32 v53, v202, v203
  v_cvt_pk_bf16_f32 v54, v204, v205
  v_cvt_pk_bf16_f32 v55, v206, v207
  buffer_store_dwordx4 v[52:55], v0, s[40:43], s6 offen offset:2048 sc0 sc1
  ds_write_b128 v0, v[52:55] offset:2048
  v_rcp_f32 v136, v136
  s_nop 0
  v_pk_mul_f32 v[208:209], v[208:209], v[136:137] op_sel_hi:[1,0]
  v_pk_mul_f32 v[210:211], v[210:211], v[136:137] op_sel_hi:[1,0]
  v_pk_mul_f32 v[212:213], v[212:213], v[136:137] op_sel_hi:[1,0]
  v_pk_mul_f32 v[214:215], v[214:215], v[136:137] op_sel_hi:[1,0]
  v_cvt_pk_bf16_f32 v56, v208, v209
  v_cvt_pk_bf16_f32 v57, v210, v211
  v_cvt_pk_bf16_f32 v58, v212, v213
  v_cvt_pk_bf16_f32 v59, v214, v215
  buffer_store_dwordx4 v[56:59], v0, s[40:43], s7 offen offset:0 sc0 sc1
  ds_write_b128 v0, v[56:59] offset:4096
  v_rcp_f32 v140, v140
  s_nop 0
  v_pk_mul_f32 v[216:217], v[216:217], v[140:141] op_sel_hi:[1,0]
  v_pk_mul_f32 v[218:219], v[218:219], v[140:141] op_sel_hi:[1,0]
  v_pk_mul_f32 v[220:221], v[220:221], v[140:141] op_sel_hi:[1,0]
  v_pk_mul_f32 v[222:223], v[222:223], v[140:141] op_sel_hi:[1,0]
  v_cvt_pk_bf16_f32 v60, v216, v217
  v_cvt_pk_bf16_f32 v61, v218, v219
  v_cvt_pk_bf16_f32 v62, v220, v221
  v_cvt_pk_bf16_f32 v63, v222, v223
  buffer_store_dwordx4 v[60:63], v0, s[40:43], s7 offen offset:2048 sc0 sc1
  ds_write_b128 v0, v[60:63] offset:6144
  s_cmp_eq_u32 s76, Lz1-Lz0+0
  s_mov_b32 s89, 200000
  s_waitcnt vmcnt(3)
  s_cbranch_scc0 Lh_11
  v_mov_b64 v[64:65], 0
  v_mov_b64 v[66:67], 0
  v_mov_b64 v[232:233], 0
  v_mov_b64 v[234:235], 0
  s_branch Lh_12
  s_nop 0
Lh_10:
  s_mov_b32 exec_lo, s12
  s_mov_b32 exec_hi, s12
  buffer_load_dwordx4 v[64:67], v9, s[40:43], s11 offen sc0 sc1
  s_mov_b32 exec_lo, 0
  s_mov_b32 exec_hi, -1
  buffer_load_dwordx4 v[232:235], v11, s[40:43], s11 offen sc0 sc1
  s_mov_b64 exec, -1
  s_waitcnt vmcnt(0)
Lh_11:
  v_max3_u32 v2, v64, v65, v66
  v_max3_u32 v3, v232, v233, v234
  v_max3_u32 v2, v2, v67, v235
  v_max_u32_e64 v2, v2, v3
  v_cmp_eq_u32 vcc, -1, v2
  s_cbranch_vccz Lh_12
  s_sub_u32 s89, s89, 1
  s_cbranch_scc0 Lh_10
Lh_12:
  v_mfma_f32_16x16x32_bf16 v[160:163], v[64:67], v[32:35], v[16:19]
  v_mov_b64 v[68:69], v[232:233]
  v_mov_b64 v[78:79], v[234:235]
  v_mov_b64 v[236:237], -1
  v_mov_b64 v[238:239], -1
  buffer_store_dwordx4 v[236:239], v11, s[40:43], s11 offen sc0 sc1
  s_cmp_eq_u32 s76, 0
  s_cbranch_scc1 L_14
  s_nop 0
  v_max_f32 v164, v164, v160
  v_max_f32 v165, v165, v161
  v_max_f32 v166, v166, v162
  v_max_f32_e64 v167, v167, v163
L_14:
  v_max3_f32 v88, v164, v165, v166
  v_max_f32 v88, v88, v167
  v_mov_b32 v98, v88
  s_nop 1
  v_permlane32_swap_b32 v88, v98
  v_max_f32 v88, v88, v98
  v_mov_b32 v98, v88
  s_nop 1
  v_permlane16_swap_b32 v88, v98
  v_max_f32_e64 v88, v88, v98
  s_mov_b32 s4, 0x3e8293ee
  v_mul_f32 v89, s4, v124
  v_mul_f32 v88, v89, v88
  v_pk_fma_f32 v[164:165], v[164:165], v[88:89], v[88:89] op_sel:[0,1,0] op_sel_hi:[1,1,0] neg_lo:[0,0,1] neg_hi:[0,0,1]
  v_pk_fma_f32 v[166:167], v[166:167], v[88:89], v[88:89] op_sel:[0,1,0] op_sel_hi:[1,1,0] neg_lo:[0,0,1] neg_hi:[0,0,1]
  v_exp_f32 v164, v164
  v_exp_f32 v165, v165
  v_exp_f32 v166, v166
  v_exp_f32 v167, v167
  v_cvt_pk_bf16_f32 v34, v164, v165
  v_cvt_pk_bf16_f32 v35, v166, v167
  v_and_b32 v32, v34, v20
  v_and_b32 v33, v35, v21
  v_xor_b32_e64 v34, v34, v32
  v_xor_b32 v35, v35, v33
  s_nop 1
  v_mfma_f32_16x16x32_bf16 v[128:131], v[120:123], v[32:35], 0
  v_mfma_f32_16x16x32_bf16 v[192:195], v[68:71], v[32:35], 0
  v_mfma_f32_16x16x32_bf16 v[196:199], v[78:81], v[32:35], 0
  s_nop 5
  v_rcp_f32_e64 v128, v128
  s_nop 0
  v_pk_mul_f32 v[192:193], v[192:193], v[128:129] op_sel_hi:[1,0]
  v_pk_mul_f32 v[194:195], v[194:195], v[128:129] op_sel_hi:[1,0]
  v_pk_mul_f32 v[196:197], v[196:197], v[128:129] op_sel_hi:[1,0]
  v_pk_mul_f32 v[198:199], v[198:199], v[128:129] op_sel_hi:[1,0]
  v_cvt_pk_bf16_f32 v48, v192, v193
  v_cvt_pk_bf16_f32 v49, v194, v195
  v_cvt_pk_bf16_f32 v50, v196, v197
  v_cvt_pk_bf16_f32 v51, v198, v199
  buffer_store_dwordx4 v[48:51], v0, s[40:43], s6 offen offset:0 sc0 sc1
  ds_write_b128 v0, v[48:51] offset:0
  ds_read_b32 v3, v28 offset:8
  s_cmp_lg_u32 s82, 0
  s_cbranch_scc1 L_15
  v_permlane16_swap_b32 v240, v242
  v_permlane16_swap_b32 v241, v243
  v_permlane16_swap_b32 v244, v246
  v_permlane16_swap_b32 v245, v247
  v_permlane16_swap_b32 v248, v250
  v_permlane16_swap_b32 v249, v251
  v_permlane16_swap_b32 v252, v254
  v_permlane16_swap_b32 v253, v255
L_15:
  s_mov_b32 s16, Lz1-Lz0+0
  s_mov_b32 s17, 16384
  s_mov_b32 s18, 0xffff4000
  s_mov_b32 s19, 32768
  s_mov_b32 s20, 8192
  s_mov_b32 s21, 0xfffee000
  s_mul_i32 s4, s85, 8192
  v_add_u32_e64 v4, s4, v11
  v_add_u32 v5, 1024, v4
  s_add_u32 s5, s19, 0
  s_lshl_b32 s4, s86, 1
  v_xor_b32_e64 v2, s4, v26
  v_lshl_add_u32 v6, v2, 5, v25
  v_add_u32 v6, s5, v6
  s_add_u32 s4, s4, 1
  v_xor_b32_e64 v2, s4, v26
  v_lshl_add_u32 v7, v2, 5, v25
  v_add_u32 v7, s5, v7
  s_lshl_b32 s5, s82, 1
  s_add_u32 s5, s5, Lz1-Lz0+2
  s_mov_b32 s89, 1600000
  s_branch Lw_17
Lw_16:
  ds_read_b32 v3, v28 offset:8
Lw_17:
  s_waitcnt lgkmcnt(0)
  v_readfirstlane_b32 s4, v3
  s_cmp_ge_u32 s4, s5
  s_cbranch_scc1 Lw_18
  s_sleep 1
  s_sub_u32 s89, s89, 1
  s_cbranch_scc0 Lw_16
Lw_18:
  ds_read_b64_tr_b16 v[48:49], v6 offset:0
  ds_read_b64_tr_b16 v[50:51], v6 offset:2048
  ds_read_b64_tr_b16 v[52:53], v7 offset:0
  ds_read_b64_tr_b16 v[54:55], v7 offset:2048
  ds_read_b64_tr_b16 v[80:81], v6 offset:4096
  ds_read_b64_tr_b16 v[82:83], v6 offset:6144
  ds_read_b64_tr_b16 v[84:85], v7 offset:4096
  ds_read_b64_tr_b16 v[86:87], v7 offset:6144
  ds_read_b64_tr_b16 v[112:113], v6 offset:8192
  ds_read_b64_tr_b16 v[114:115], v6 offset:10240
  ds_read_b64_tr_b16 v[116:117], v7 offset:8192
  ds_read_b64_tr_b16 v[118:119], v7 offset:10240
  s_nop 0
  s_waitcnt lgkmcnt(8)
  ds_read_b64_tr_b16 v[208:209], v6 offset:12288
  ds_read_b64_tr_b16 v[210:211], v6 offset:14336
  ds_read_b64_tr_b16 v[212:213], v7 offset:12288
  ds_read_b64_tr_b16 v[214:215], v7 offset:14336
  s_nop 0
  s_waitcnt lgkmcnt(8)
  ds_read_b64_tr_b16 v[160:161], v6 offset:16384
  ds_read_b64_tr_b16 v[162:163], v6 offset:18432
  ds_read_b64_tr_b16 v[164:165], v7 offset:16384
  ds_read_b64_tr_b16 v[166:167], v7 offset:18432
  s_nop 0
  s_waitcnt lgkmcnt(8)
  ds_read_b64_tr_b16 v[168:169], v6 offset:20480
  ds_read_b64_tr_b16 v[170:171], v6 offset:22528
  ds_read_b64_tr_b16 v[172:173], v7 offset:20480
  ds_read_b64_tr_b16 v[174:175], v7 offset:22528
  s_waitcnt lgkmcnt(8)
  s_add_u32 s5, s87, 0x0
  s_waitcnt vmcnt(0)
  s_mov_b64 exec, 1
  ds_add_rtn_u32 v2, v28, v27 offset:0
  s_waitcnt lgkmcnt(0)
  v_readfirstlane_b32 s4, v2
  s_and_b32 s4, s4, Lz1-Lz0+3
  s_cmp_lg_u32 s4, 3
  s_cbranch_scc1 Ls_19
  s_mov_b32 exec_lo, 0xffff
  buffer_store_dword v27, v24, s[40:43], s5 offen sc0 sc1
Ls_19:
  s_nop 0
  s_mov_b64 exec, -1
  ds_read_b64_tr_b16 v[176:177], v6 offset:24576
  ds_read_b64_tr_b16 v[178:179], v6 offset:26624
  ds_read_b64_tr_b16 v[180:181], v7 offset:24576
  ds_read_b64_tr_b16 v[182:183], v7 offset:26624
  ds_read_b64_tr_b16 v[184:185], v6 offset:28672
  ds_read_b64_tr_b16 v[186:187], v6 offset:30720
  ds_read_b64_tr_b16 v[188:189], v7 offset:28672
  ds_read_b64_tr_b16 v[190:191], v7 offset:30720
  ds_read_b64_tr_b16 v[224:225], v6 offset:32768
  ds_read_b64_tr_b16 v[226:227], v6 offset:34816
  ds_read_b64_tr_b16 v[228:229], v7 offset:32768
  ds_read_b64_tr_b16 v[230:231], v7 offset:34816
  s_nop 0
  s_waitcnt lgkmcnt(8)
  ds_read_b64_tr_b16 v[232:233], v6 offset:36864
  ds_read_b64_tr_b16 v[234:235], v6 offset:38912
  ds_read_b64_tr_b16 v[236:237], v7 offset:36864
  ds_read_b64_tr_b16 v[238:239], v7 offset:38912
  s_nop 0
  s_waitcnt lgkmcnt(8)
  ds_read_b64_tr_b16 v[56:57], v6 offset:40960
  ds_read_b64_tr_b16 v[58:59], v6 offset:43008
  ds_read_b64_tr_b16 v[60:61], v7 offset:40960
  ds_read_b64_tr_b16 v[62:63], v7 offset:43008
  s_nop 0
  s_waitcnt lgkmcnt(8)
  ds_read_b64_tr_b16 v[88:89], v6 offset:45056
  ds_read_b64_tr_b16 v[90:91], v6 offset:47104
  ds_read_b64_tr_b16 v[92:93], v7 offset:45056
  ds_read_b64_tr_b16 v[94:95], v7 offset:47104
  s_waitcnt lgkmcnt(8)
  s_mov_b32 s19, 0
  v_add_u32 v6, 0xffff8000, v6
  v_add_u32 v7, 0xffff8000, v7
  s_waitcnt lgkmcnt(0)
  s_mov_b64 exec, 1
  ds_add_u32 v28, v27 offset:12
  s_mov_b64 exec, -1
  s_mov_b32 s4, 0xffff0000
  v_lshlrev_b32 v128, 16, v240
  v_and_b32 v129, s4, v240
  v_lshlrev_b32 v130, 16, v241
  v_and_b32 v131, s4, v241
  v_lshlrev_b32 v132, 16, v242
  v_and_b32 v133, s4, v242
  v_lshlrev_b32 v134, 16, v243
  v_and_b32 v135, s4, v243
  v_lshlrev_b32 v136, 16, v244
  v_and_b32 v137, s4, v244
  v_lshlrev_b32 v138, 16, v245
  v_and_b32 v139, s4, v245
  v_lshlrev_b32 v140, 16, v246
  v_and_b32 v141, s4, v246
  v_lshlrev_b32 v142, 16, v247
  v_and_b32 v143, s4, v247
  v_lshlrev_b32 v144, 16, v248
  v_and_b32 v145, s4, v248
  v_lshlrev_b32 v146, 16, v249
  v_and_b32 v147, s4, v249
  v_lshlrev_b32 v148, 16, v250
  v_and_b32 v149, s4, v250
  v_lshlrev_b32 v150, 16, v251
  v_and_b32 v151, s4, v251
  v_lshlrev_b32 v152, 16, v252
  v_and_b32 v153, s4, v252
  v_lshlrev_b32 v154, 16, v253
  v_and_b32 v155, s4, v253
  v_lshlrev_b32 v156, 16, v254
  v_and_b32 v157, s4, v254
  v_lshlrev_b32 v158, 16, v255
  v_and_b32 v159, s4, v255
  s_lshl_b32 s4, s76, 4
  s_add_u32 s4, s4, s78
  s_lshl_b32 s6, s4, 14
  s_add_u32 s6, s6, 7340032
  s_add_u32 s7, s6, 4096
  s_mov_b32 s22, 5
  s_barrier
  ds_read_b128 v[32:35], v4 offset:0
  ds_read_b128 v[36:39], v4 offset:2048
  ds_read_b128 v[40:43], v4 offset:4096
  ds_read_b128 v[44:47], v4 offset:6144
  ds_read_b128 v[64:67], v5 offset:0
  ds_read_b128 v[68:71], v5 offset:2048
  ds_read_b128 v[72:75], v5 offset:4096
  ds_read_b128 v[76:79], v5 offset:6144
  s_add_u32 s16, s16, s17
  s_cmp_eq_u32 s16, 65536
  s_cselect_b32 s23, s18, s17
  s_cselect_b32 s16, 0, s16
  v_add_u32 v4, s23, v4
  v_add_u32 v5, s23, v5
  s_waitcnt lgkmcnt(0)
  v_mfma_f32_16x16x32_bf16 v[128:131], v[48:51], v[32:35], v[128:131]
  v_mfma_f32_16x16x32_bf16 v[128:131], v[80:83], v[64:67], v[128:131]
  v_mfma_f32_16x16x32_bf16 v[136:139], v[80:83], v[68:71], v[136:139]
  v_mfma_f32_16x16x32_bf16 v[136:139], v[48:51], v[36:39], v[136:139]
  v_mfma_f32_16x16x32_bf16 v[144:147], v[48:51], v[40:43], v[144:147]
  v_mfma_f32_16x16x32_bf16 v[144:147], v[80:83], v[72:75], v[144:147]
  v_mfma_f32_16x16x32_bf16 v[152:155], v[80:83], v[76:79], v[152:155]
  v_mfma_f32_16x16x32_bf16 v[152:155], v[48:51], v[44:47], v[152:155]
  v_mfma_f32_16x16x32_bf16 v[156:159], v[52:55], v[44:47], v[156:159]
  v_mfma_f32_16x16x32_bf16 v[156:159], v[84:87], v[76:79], v[156:159]
  v_mfma_f32_16x16x32_bf16 v[148:151], v[84:87], v[72:75], v[148:151]
  v_mfma_f32_16x16x32_bf16 v[148:151], v[52:55], v[40:43], v[148:151]
  v_mfma_f32_16x16x32_bf16 v[140:143], v[52:55], v[36:39], v[140:143]
  v_mfma_f32_16x16x32_bf16 v[140:143], v[84:87], v[68:71], v[140:143]
  v_mfma_f32_16x16x32_bf16 v[132:135], v[84:87], v[64:67], v[132:135]
  v_mfma_f32_16x16x32_bf16 v[132:135], v[52:55], v[32:35], v[132:135]
  s_nop 0
  s_barrier
  ds_read_b128 v[96:99], v4 offset:0
  ds_read_b128 v[192:195], v5 offset:0
  ds_read_b128 v[100:103], v4 offset:2048
  ds_read_b128 v[196:199], v5 offset:2048
  ds_read_b128 v[104:107], v4 offset:4096
  ds_read_b128 v[200:203], v5 offset:4096
  ds_read_b128 v[108:111], v4 offset:6144
  ds_read_b128 v[204:207], v5 offset:6144
  s_add_u32 s16, s16, s17
  s_cmp_eq_u32 s16, 65536
  s_cselect_b32 s23, s18, s17
  s_cselect_b32 s16, 0, s16
  v_add_u32 v4, s23, v4
  v_add_u32 v5, s23, v5
  s_waitcnt lgkmcnt(6)
  v_mfma_f32_16x16x32_bf16 v[128:131], v[112:115], v[96:99], v[128:131]
  v_mfma_f32_16x16x32_bf16 v[128:131], v[208:211], v[192:195], v[128:131]
  s_waitcnt lgkmcnt(4)
  v_mfma_f32_16x16x32_bf16 v[136:139], v[208:211], v[196:199], v[136:139]
  v_mfma_f32_16x16x32_bf16 v[136:139], v[112:115], v[100:103], v[136:139]
  s_waitcnt lgkmcnt(2)
  v_mfma_f32_16x16x32_bf16 v[144:147], v[112:115], v[104:107], v[144:147]
  v_mfma_f32_16x16x32_bf16 v[144:147], v[208:211], v[200:203], v[144:147]
  s_waitcnt lgkmcnt(0)
  v_mfma_f32_16x16x32_bf16 v[152:155], v[208:211], v[204:207], v[152:155]
  s_barrier
  v_mfma_f32_16x16x32_bf16 v[152:155], v[112:115], v[108:111], v[152:155]
  ds_read_b128 v[32:35], v4 offset:0
  ds_read_b128 v[36:39], v4 offset:2048
  v_mfma_f32_16x16x32_bf16 v[156:159], v[116:119], v[108:111], v[156:159]
  ds_read_b128 v[40:43], v4 offset:4096
  ds_read_b128 v[44:47], v4 offset:6144
  v_mfma_f32_16x16x32_bf16 v[156:159], v[212:215], v[204:207], v[156:159]
  ds_read_b128 v[64:67], v5 offset:0
  ds_read_b128 v[68:71], v5 offset:2048
  v_mfma_f32_16x16x32_bf16 v[148:151], v[212:215], v[200:203], v[148:151]
  ds_read_b128 v[72:75], v5 offset:4096
  ds_read_b128 v[76:79], v5 offset:6144
  v_mfma_f32_16x16x32_bf16 v[148:151], v[116:119], v[104:107], v[148:151]
  s_add_u32 s16, s16, s17
  s_cmp_eq_u32 s16, 65536
  s_cselect_b32 s23, s18, s17
  v_mfma_f32_16x16x32_bf16 v[140:143], v[116:119], v[100:103], v[140:143]
  s_cselect_b32 s16, 0, s16
  v_add_u32 v4, s23, v4
  v_add_u32_e64 v5, s23, v5
  v_mfma_f32_16x16x32_bf16 v[140:143], v[212:215], v[196:199], v[140:143]
  v_mfma_f32_16x16x32_bf16 v[132:135], v[212:215], v[192:195], v[132:135]
  s_waitcnt lgkmcnt(0)
  v_mfma_f32_16x16x32_bf16 v[132:135], v[116:119], v[96:99], v[132:135]
  s_barrier
  v_mfma_f32_16x16x32_bf16 v[128:131], v[160:163], v[32:35], v[128:131]
  ds_read_b128 v[96:99], v4 offset:0
  ds_read_b128 v[100:103], v4 offset:2048
  v_mfma_f32_16x16x32_bf16 v[128:131], v[168:171], v[64:67], v[128:131]
  ds_read_b128 v[104:107], v4 offset:4096
  ds_read_b128 v[108:111], v4 offset:6144
  v_mfma_f32_16x16x32_bf16 v[136:139], v[168:171], v[68:71], v[136:139]
  ds_read_b128 v[192:195], v5 offset:0
  ds_read_b128 v[196:199], v5 offset:2048
  v_mfma_f32_16x16x32_bf16 v[136:139], v[160:163], v[36:39], v[136:139]
  ds_read_b128 v[200:203], v5 offset:4096
  ds_read_b128 v[204:207], v5 offset:6144
  v_mfma_f32_16x16x32_bf16 v[144:147], v[160:163], v[40:43], v[144:147]
  s_add_u32 s16, s16, s17
  s_cmp_eq_u32 s16, 65536
  s_cselect_b32 s23, s18, s17
  v_mfma_f32_16x16x32_bf16 v[144:147], v[168:171], v[72:75], v[144:147]
  s_cselect_b32 s16, 0, s16
  v_add_u32 v4, s23, v4
  v_add_u32_e64 v5, s23, v5
  v_mfma_f32_16x16x32_bf16 v[152:155], v[168:171], v[76:79], v[152:155]
  v_mfma_f32_16x16x32_bf16 v[152:155], v[160:163], v[44:47], v[152:155]
  v_mfma_f32_16x16x32_bf16 v[156:159], v[164:167], v[44:47], v[156:159]
  v_mfma_f32_16x16x32_bf16 v[156:159], v[172:175], v[76:79], v[156:159]
  v_mfma_f32_16x16x32_bf16 v[148:151], v[172:175], v[72:75], v[148:151]
  v_mfma_f32_16x16x32_bf16 v[148:151], v[164:167], v[40:43], v[148:151]
  v_mfma_f32_16x16x32_bf16 v[140:143], v[164:167], v[36:39], v[140:143]
  v_mfma_f32_16x16x32_bf16 v[140:143], v[172:175], v[68:71], v[140:143]
  v_mfma_f32_16x16x32_bf16 v[132:135], v[172:175], v[64:67], v[132:135]
  s_waitcnt lgkmcnt(0)
  v_mfma_f32_16x16x32_bf16 v[132:135], v[164:167], v[32:35], v[132:135]
  s_barrier
  v_mfma_f32_16x16x32_bf16 v[128:131], v[176:179], v[96:99], v[128:131]
  ds_read_b128 v[32:35], v4 offset:0
  ds_read_b128 v[36:39], v4 offset:2048
  v_mfma_f32_16x16x32_bf16 v[128:131], v[184:187], v[192:195], v[128:131]
  ds_read_b128 v[40:43], v4 offset:4096
  ds_read_b128 v[44:47], v4 offset:6144
  v_mfma_f32_16x16x32_bf16 v[136:139], v[184:187], v[196:199], v[136:139]
  ds_read_b128 v[64:67], v5 offset:0
  ds_read_b128 v[68:71], v5 offset:2048
  v_mfma_f32_16x16x32_bf16 v[136:139], v[176:179], v[100:103], v[136:139]
  ds_read_b128 v[72:75], v5 offset:4096
  ds_read_b128 v[76:79], v5 offset:6144
  v_mfma_f32_16x16x32_bf16 v[144:147], v[176:179], v[104:107], v[144:147]
  s_add_u32 s16, s16, s17
  s_cmp_eq_u32 s16, 65536
  s_cselect_b32 s23, s18, s17
  v_mfma_f32_16x16x32_bf16 v[144:147], v[184:187], v[200:203], v[144:147]
  s_cselect_b32 s16, 0, s16
  v_add_u32 v4, s23, v4
  v_add_u32_e64 v5, s23, v5
  v_mfma_f32_16x16x32_bf16 v[152:155], v[184:187], v[204:207], v[152:155]
  v_mfma_f32_16x16x32_bf16 v[152:155], v[176:179], v[108:111], v[152:155]
  v_mfma_f32_16x16x32_bf16 v[156:159], v[180:183], v[108:111], v[156:159]
  v_mfma_f32_16x16x32_bf16 v[156:159], v[188:191], v[204:207], v[156:159]
  v_mfma_f32_16x16x32_bf16 v[148:151], v[188:191], v[200:203], v[148:151]
  v_mfma_f32_16x16x32_bf16 v[148:151], v[180:183], v[104:107], v[148:151]
  v_mfma_f32_16x16x32_bf16 v[140:143], v[180:183], v[100:103], v[140:143]
  v_mfma_f32_16x16x32_bf16 v[140:143], v[188:191], v[196:199], v[140:143]
  v_mfma_f32_16x16x32_bf16 v[132:135], v[188:191], v[192:195], v[132:135]
  s_waitcnt lgkmcnt(0)
  v_mfma_f32_16x16x32_bf16 v[132:135], v[180:183], v[96:99], v[132:135]
  s_barrier
  v_mfma_f32_16x16x32_bf16 v[128:131], v[224:227], v[32:35], v[128:131]
  ds_read_b128 v[96:99], v4 offset:0
  ds_read_b128 v[100:103], v4 offset:2048
  v_mfma_f32_16x16x32_bf16 v[128:131], v[232:235], v[64:67], v[128:131]
  ds_read_b128 v[104:107], v4 offset:4096
  ds_read_b128 v[108:111], v4 offset:6144
  v_mfma_f32_16x16x32_bf16 v[136:139], v[232:235], v[68:71], v[136:139]
  ds_read_b128 v[192:195], v5 offset:0
  ds_read_b128 v[196:199], v5 offset:2048
  v_mfma_f32_16x16x32_bf16 v[136:139], v[224:227], v[36:39], v[136:139]
  ds_read_b128 v[200:203], v5 offset:4096
  ds_read_b128 v[204:207], v5 offset:6144
  v_mfma_f32_16x16x32_bf16 v[144:147], v[224:227], v[40:43], v[144:147]
  s_add_u32 s16, s16, s17
  s_cmp_eq_u32 s16, 65536
  s_cselect_b32 s23, s18, s17
  v_mfma_f32_16x16x32_bf16 v[144:147], v[232:235], v[72:75], v[144:147]
  s_cselect_b32 s16, 0, s16
  v_add_u32 v4, s23, v4
  v_add_u32_e64 v5, s23, v5
  v_mfma_f32_16x16x32_bf16 v[152:155], v[232:235], v[76:79], v[152:155]
  v_mfma_f32_16x16x32_bf16 v[152:155], v[224:227], v[44:47], v[152:155]
  v_mfma_f32_16x16x32_bf16 v[156:159], v[228:231], v[44:47], v[156:159]
  v_mfma_f32_16x16x32_bf16 v[156:159], v[236:239], v[76:79], v[156:159]
  v_mfma_f32_16x16x32_bf16 v[148:151], v[236:239], v[72:75], v[148:151]
  v_mfma_f32_16x16x32_bf16 v[148:151], v[228:231], v[40:43], v[148:151]
  v_mfma_f32_16x16x32_bf16 v[140:143], v[228:231], v[36:39], v[140:143]
  v_mfma_f32_16x16x32_bf16 v[140:143], v[236:239], v[68:71], v[140:143]
  v_mfma_f32_16x16x32_bf16 v[132:135], v[236:239], v[64:67], v[132:135]
  s_waitcnt lgkmcnt(0)
  v_mfma_f32_16x16x32_bf16 v[132:135], v[228:231], v[32:35], v[132:135]
  s_barrier
  v_mfma_f32_16x16x32_bf16 v[128:131], v[56:59], v[96:99], v[128:131]
  ds_read_b64_tr_b16 v[48:49], v6 offset:0
  ds_read_b64_tr_b16 v[50:51], v6 offset:2048
  v_mfma_f32_16x16x32_bf16 v[128:131], v[88:91], v[192:195], v[128:131]
  ds_read_b128 v[32:35], v4 offset:0
  ds_read_b128 v[36:39], v4 offset:2048
  v_mfma_f32_16x16x32_bf16 v[136:139], v[88:91], v[196:199], v[136:139]
  ds_read_b128 v[40:43], v4 offset:4096
  ds_read_b128 v[44:47], v4 offset:6144
  v_mfma_f32_16x16x32_bf16 v[136:139], v[56:59], v[100:103], v[136:139]
  ds_read_b64_tr_b16 v[52:53], v7 offset:0
  ds_read_b64_tr_b16 v[54:55], v7 offset:2048
  v_mfma_f32_16x16x32_bf16 v[144:147], v[56:59], v[104:107], v[144:147]
  ds_read_b64_tr_b16 v[80:81], v6 offset:4096
  ds_read_b64_tr_b16 v[82:83], v6 offset:6144
  v_mfma_f32_16x16x32_bf16 v[144:147], v[88:91], v[200:203], v[144:147]
  ds_read_b128 v[64:67], v5 offset:0
  ds_read_b128 v[68:71], v5 offset:2048
  v_mfma_f32_16x16x32_bf16 v[152:155], v[88:91], v[204:207], v[152:155]
  ds_read_b128 v[72:75], v5 offset:4096
  ds_read_b128 v[76:79], v5 offset:6144
  v_mfma_f32_16x16x32_bf16 v[152:155], v[56:59], v[108:111], v[152:155]
  ds_read_b64_tr_b16 v[84:85], v7 offset:4096
  ds_read_b64_tr_b16 v[86:87], v7 offset:6144
  v_mfma_f32_16x16x32_bf16 v[156:159], v[60:63], v[108:111], v[156:159]
  s_add_u32 s16, s16, s17
  s_cmp_eq_u32 s16, 65536
  s_cselect_b32 s23, s18, s17
  v_mfma_f32_16x16x32_bf16 v[156:159], v[92:95], v[204:207], v[156:159]
  s_cselect_b32 s16, 0, s16
  v_add_u32 v4, s23, v4
  v_add_u32_e64 v5, s23, v5
  v_mfma_f32_16x16x32_bf16 v[148:151], v[92:95], v[200:203], v[148:151]
  s_add_u32 s19, s19, s20
  s_cmp_eq_u32 s19, 81920
  s_cselect_b32 s23, s21, s20
  v_mfma_f32_16x16x32_bf16 v[148:151], v[60:63], v[104:107], v[148:151]
  s_cselect_b32 s19, 0, s19
  v_add_u32 v6, s23, v6
  v_add_u32_e64 v7, s23, v7
  v_mfma_f32_16x16x32_bf16 v[140:143], v[60:63], v[100:103], v[140:143]
  v_mfma_f32_16x16x32_bf16 v[140:143], v[92:95], v[196:199], v[140:143]
  v_mfma_f32_16x16x32_bf16 v[132:135], v[92:95], v[192:195], v[132:135]
  s_waitcnt lgkmcnt(0)
  v_mfma_f32_16x16x32_bf16 v[132:135], v[60:63], v[96:99], v[132:135]
Lk_20:
  s_barrier
  v_mfma_f32_16x16x32_bf16 v[128:131], v[48:51], v[32:35], v[128:131]
  ds_read_b64_tr_b16 v[112:113], v6 offset:0
  ds_read_b64_tr_b16 v[114:115], v6 offset:2048
  v_mfma_f32_16x16x32_bf16 v[128:131], v[80:83], v[64:67], v[128:131]
  ds_read_b128 v[96:99], v4 offset:0
  ds_read_b128 v[100:103], v4 offset:2048
  v_mfma_f32_16x16x32_bf16 v[136:139], v[80:83], v[68:71], v[136:139]
  ds_read_b128 v[104:107], v4 offset:4096
  ds_read_b128 v[108:111], v4 offset:6144
  v_mfma_f32_16x16x32_bf16 v[136:139], v[48:51], v[36:39], v[136:139]
  ds_read_b64_tr_b16 v[116:117], v7 offset:0
  ds_read_b64_tr_b16 v[118:119], v7 offset:2048
  v_mfma_f32_16x16x32_bf16 v[144:147], v[48:51], v[40:43], v[144:147]
  ds_read_b64_tr_b16 v[208:209], v6 offset:4096
  ds_read_b64_tr_b16 v[210:211], v6 offset:6144
  v_mfma_f32_16x16x32_bf16 v[144:147], v[80:83], v[72:75], v[144:147]
  ds_read_b128 v[192:195], v5 offset:0
  ds_read_b128 v[196:199], v5 offset:2048
  v_mfma_f32_16x16x32_bf16 v[152:155], v[80:83], v[76:79], v[152:155]
  ds_read_b128 v[200:203], v5 offset:4096
  ds_read_b128 v[204:207], v5 offset:6144
  v_mfma_f32_16x16x32_bf16 v[152:155], v[48:51], v[44:47], v[152:155]
  ds_read_b64_tr_b16 v[212:213], v7 offset:4096
  ds_read_b64_tr_b16 v[214:215], v7 offset:6144
  v_mfma_f32_16x16x32_bf16 v[156:159], v[52:55], v[44:47], v[156:159]
  s_add_u32 s16, s16, s17
  s_cmp_eq_u32 s16, 65536
  s_cselect_b32 s23, s18, s17
  v_mfma_f32_16x16x32_bf16 v[156:159], v[84:87], v[76:79], v[156:159]
  s_cselect_b32 s16, 0, s16
  v_add_u32 v4, s23, v4
  v_add_u32_e64 v5, s23, v5
  v_mfma_f32_16x16x32_bf16 v[148:151], v[84:87], v[72:75], v[148:151]
  s_add_u32 s19, s19, s20
  s_cmp_eq_u32 s19, 81920
  s_cselect_b32 s23, s21, s20
  v_mfma_f32_16x16x32_bf16 v[148:151], v[52:55], v[40:43], v[148:151]
  s_cselect_b32 s19, 0, s19
  v_add_u32 v6, s23, v6
  v_add_u32_e64 v7, s23, v7
  v_mfma_f32_16x16x32_bf16 v[140:143], v[52:55], v[36:39], v[140:143]
  v_mfma_f32_16x16x32_bf16 v[140:143], v[84:87], v[68:71], v[140:143]
  v_mfma_f32_16x16x32_bf16 v[132:135], v[84:87], v[64:67], v[132:135]
  s_waitcnt lgkmcnt(0)
  v_mfma_f32_16x16x32_bf16 v[132:135], v[52:55], v[32:35], v[132:135]
  s_barrier
  v_mfma_f32_16x16x32_bf16 v[128:131], v[112:115], v[96:99], v[128:131]
  ds_read_b64_tr_b16 v[48:49], v6 offset:0
  ds_read_b64_tr_b16 v[50:51], v6 offset:2048
  v_mfma_f32_16x16x32_bf16 v[128:131], v[208:211], v[192:195], v[128:131]
  ds_read_b128 v[32:35], v4 offset:0
  ds_read_b128 v[36:39], v4 offset:2048
  v_mfma_f32_16x16x32_bf16 v[136:139], v[208:211], v[196:199], v[136:139]
  ds_read_b128 v[40:43], v4 offset:4096
  ds_read_b128 v[44:47], v4 offset:6144
  v_mfma_f32_16x16x32_bf16 v[136:139], v[112:115], v[100:103], v[136:139]
  ds_read_b64_tr_b16 v[52:53], v7 offset:0
  ds_read_b64_tr_b16 v[54:55], v7 offset:2048
  v_mfma_f32_16x16x32_bf16 v[144:147], v[112:115], v[104:107], v[144:147]
  ds_read_b64_tr_b16 v[80:81], v6 offset:4096
  ds_read_b64_tr_b16 v[82:83], v6 offset:6144
  v_mfma_f32_16x16x32_bf16 v[144:147], v[208:211], v[200:203], v[144:147]
  ds_read_b128 v[64:67], v5 offset:0
  ds_read_b128 v[68:71], v5 offset:2048
  v_mfma_f32_16x16x32_bf16 v[152:155], v[208:211], v[204:207], v[152:155]
  ds_read_b128 v[72:75], v5 offset:4096
  ds_read_b128 v[76:79], v5 offset:6144
  v_mfma_f32_16x16x32_bf16 v[152:155], v[112:115], v[108:111], v[152:155]
  ds_read_b64_tr_b16 v[84:85], v7 offset:4096
  ds_read_b64_tr_b16 v[86:87], v7 offset:6144
  v_mfma_f32_16x16x32_bf16 v[156:159], v[116:119], v[108:111], v[156:159]
  s_add_u32 s16, s16, s17
  s_cmp_eq_u32 s16, 65536
  s_cselect_b32 s23, s18, s17
  v_mfma_f32_16x16x32_bf16 v[156:159], v[212:215], v[204:207], v[156:159]
  s_cselect_b32 s16, 0, s16
  v_add_u32 v4, s23, v4
  v_add_u32_e64 v5, s23, v5
  v_mfma_f32_16x16x32_bf16 v[148:151], v[212:215], v[200:203], v[148:151]
  s_add_u32 s19, s19, s20
  s_cmp_eq_u32 s19, 81920
  s_cselect_b32 s23, s21, s20
  v_mfma_f32_16x16x32_bf16 v[148:151], v[116:119], v[104:107], v[148:151]
  s_cselect_b32 s19, 0, s19
  v_add_u32 v6, s23, v6
  v_add_u32_e64 v7, s23, v7
  v_mfma_f32_16x16x32_bf16 v[140:143], v[116:119], v[100:103], v[140:143]
  s_sub_u32 s22, s22, 1
  s_cmp_lg_u32 s22, 0
  v_mfma_f32_16x16x32_bf16 v[140:143], v[212:215], v[196:199], v[140:143]
  v_mfma_f32_16x16x32_bf16 v[132:135], v[212:215], v[192:195], v[132:135]
  s_nop 0
  s_waitcnt lgkmcnt(0)
  v_mfma_f32_16x16x32_bf16 v[132:135], v[116:119], v[96:99], v[132:135]
  s_cbranch_scc1 Lk_20
  s_waitcnt lgkmcnt(0)
  v_cvt_pk_bf16_f32 v252, v152, v153
  v_cvt_pk_bf16_f32 v253, v154, v155
  v_cvt_pk_bf16_f32 v254, v156, v157
  v_cvt_pk_bf16_f32 v255, v158, v159
  buffer_store_dwordx4 v[252:255], v0, s[40:43], s7 offen offset:2048 sc0 sc1
  v_cvt_pk_bf16_f32 v248, v144, v145
  v_cvt_pk_bf16_f32 v249, v146, v147
  v_cvt_pk_bf16_f32 v250, v148, v149
  v_cvt_pk_bf16_f32 v251, v150, v151
  buffer_store_dwordx4 v[248:251], v0, s[40:43], s7 offen offset:0 sc0 sc1
  v_cvt_pk_bf16_f32 v244, v136, v137
  v_cvt_pk_bf16_f32 v245, v138, v139
  v_cvt_pk_bf16_f32 v246, v140, v141
  v_cvt_pk_bf16_f32 v247, v142, v143
  buffer_store_dwordx4 v[244:247], v0, s[40:43], s6 offen offset:2048 sc0 sc1
  v_cvt_pk_bf16_f32 v240, v128, v129
  v_cvt_pk_bf16_f32 v241, v130, v131
  v_cvt_pk_bf16_f32 v242, v132, v133
  v_cvt_pk_bf16_f32 v243, v134, v135
  buffer_store_dwordx4 v[240:243], v0, s[40:43], s6 offen offset:0 sc0 sc1
  s_lshl_b32 s5, s78, Lz1-Lz0+1
  v_mov_b32 v40, 0x3f803f80
  v_dot2_f32_bf16 v32, v240, v40, 0
  v_dot2_f32_bf16 v36, v240, v240, 0
  v_dot2_f32_bf16 v33, v244, v40, 0
  v_dot2_f32_bf16 v37, v244, v244, 0
  v_dot2_f32_bf16 v34, v248, v40, 0
  v_dot2_f32_bf16 v38, v248, v248, 0
  v_dot2_f32_bf16 v35, v252, v40, 0
  v_dot2_f32_bf16 v39, v252, v252, 0
  v_dot2_f32_bf16 v32, v241, v40, v32
  v_dot2_f32_bf16 v36, v241, v241, v36
  v_dot2_f32_bf16 v33, v245, v40, v33
  v_dot2_f32_bf16 v37, v245, v245, v37
  v_dot2_f32_bf16 v34, v249, v40, v34
  v_dot2_f32_bf16 v38, v249, v249, v38
  v_dot2_f32_bf16 v35, v253, v40, v35
  v_dot2_f32_bf16 v39, v253, v253, v39
  v_dot2_f32_bf16 v32, v242, v40, v32
  v_dot2_f32_bf16 v36, v242, v242, v36
  v_dot2_f32_bf16 v33, v246, v40, v33
  v_dot2_f32_bf16 v37, v246, v246, v37
  v_dot2_f32_bf16 v34, v250, v40, v34
  v_dot2_f32_bf16 v38, v250, v250, v38
  v_dot2_f32_bf16 v35, v254, v40, v35
  v_dot2_f32_bf16 v39, v254, v254, v39
  v_dot2_f32_bf16 v32, v243, v40, v32
  v_dot2_f32_bf16 v36, v243, v243, v36
  v_dot2_f32_bf16 v33, v247, v40, v33
  v_dot2_f32_bf16 v37, v247, v247, v37
  v_dot2_f32_bf16 v34, v251, v40, v34
  v_dot2_f32_bf16 v38, v251, v251, v38
  v_dot2_f32_bf16 v35, v255, v40, v35
  v_dot2_f32_bf16 v39, v255, v255, v39
  s_lshl_b32 s6, s76, Lz1-Lz0+9
  s_lshl_b32 s7, s85, 8
  s_add_u32 s6, s6, s7
  s_add_u32 s6, s6, s5
  s_add_u32 s6, s6, s86
  s_lshl_b32 s6, s6, 6
  s_add_u32 s6, s6, s83
  s_add_u32 s6, s6, 31457280
  v_permlane32_swap_b32 v32, v34
  v_permlane32_swap_b32 v33, v35
  v_permlane32_swap_b32 v36, v38
  v_permlane32_swap_b32 v37, v39
  v_add_f32 v32, v32, v34
  v_add_f32 v33, v33, v35
  v_add_f32 v36, v36, v38
  v_add_f32 v37, v37, v39
  v_permlane16_swap_b32 v32, v33
  s_nop 0
  v_permlane16_swap_b32 v36, v37
  v_add_f32 v42, v32, v33
  v_add_f32_e64 v43, v36, v37
  buffer_store_dwordx2 v[42:43], v30, s[40:43], s6 offen sc0 sc1
  ds_write_b128 v0, v[240:243] offset:0
  ds_write_b128 v0, v[244:247] offset:2048
  ds_write_b128 v0, v[248:251] offset:4096
  ds_write_b128 v0, v[252:255] offset:6144
  s_add_u32 s5, s87, 0x4
  s_sub_u32 s4, s78, s77
  s_lshl_b32 s4, s4, 7
  s_add_u32 s5, s5, s4
  s_waitcnt vmcnt(0)
  s_mov_b64 exec, 1
  ds_add_rtn_u32 v2, v28, v27 offset:0
  s_waitcnt lgkmcnt(0)
  v_readfirstlane_b32 s4, v2
  s_and_b32 s4, s4, Lz1-Lz0+3
  s_cmp_lg_u32 s4, 3
  s_cbranch_scc1 Ls_21
  s_mov_b32 exec_lo, 0xffff
  buffer_store_dword v27, v24, s[40:43], s5 offen sc0 sc1
Ls_21:
  s_mov_b64 exec, -1
  s_mov_b32 s16, 0
  s_mov_b32 s17, 16384
  s_mov_b32 s18, 0xffff4000
  s_mov_b32 s19, Lz1-Lz0+0
  s_mov_b32 s20, 28672
  s_mov_b32 s21, 0xffff2000
  s_mul_i32 s4, s85, 8192
  v_add_u32_e64 v4, s4, v11
  v_add_u32 v5, 1024, v4
  s_mul_i32 s4, s86, 6
  s_add_u32 s4, s4, 0
  s_lshr_b32 s5, s4, 2
  s_lshl_b32 s5, s5, 13
  s_and_b32 s4, s4, 3
  v_xor_b32 v2, s4, v26
  v_lshl_add_u32 v6, v2, 5, v25
  v_add_u32 v6, s5, v6
  s_mul_i32 s4, s86, 6
  s_add_u32 s4, s4, 1
  s_lshr_b32 s5, s4, 2
  s_lshl_b32 s5, s5, 13
  s_and_b32 s4, s4, 3
  v_xor_b32_e64 v2, s4, v26
  v_lshl_add_u32 v7, v2, 5, v25
  v_add_u32 v7, s5, v7
  s_mul_i32 s4, s86, 6
  s_add_u32 s4, s4, 2
  s_lshr_b32 s5, s4, 2
  s_lshl_b32 s5, s5, 13
  s_and_b32 s4, s4, 3
  v_xor_b32_e64 v2, s4, v26
  v_lshl_add_u32 v8, v2, 5, v25
  v_add_u32 v8, s5, v8
  s_mul_i32 s4, s86, 6
  s_add_u32 s4, s4, 3
  s_lshr_b32 s5, s4, 2
  s_lshl_b32 s5, s5, 13
  s_and_b32 s4, s4, 3
  v_xor_b32_e64 v2, s4, v26
  v_lshl_add_u32 v9, v2, 5, v25
  v_add_u32 v9, s5, v9
  v_lshrrev_b32 v2, 2, v1
  v_lshlrev_b32 v3, 6, v2
  v_and_b32 v2, 3, v1
  v_lshl_add_u32 v3, v2, 3, v3
  v_bfe_u32 v2, v1, 4, 1
  v_xor_b32_e64 v2, s86, v2
  v_lshl_add_u32 v3, v2, 5, v3
  v_add_u32 v10, 90112, v3
  v_mov_b64 v[128:129], 0
  v_mov_b64 v[130:131], 0
  v_mov_b64 v[132:133], 0
  v_mov_b64 v[134:135], 0
  v_mov_b64 v[136:137], 0
  v_mov_b64 v[138:139], 0
  v_mov_b64 v[140:141], 0
  v_mov_b64 v[142:143], 0
  v_mov_b64 v[144:145], 0
  v_mov_b64 v[146:147], 0
  v_mov_b64 v[148:149], 0
  v_mov_b64 v[150:151], 0
  v_mov_b64 v[152:153], 0
  v_mov_b64 v[154:155], 0
  v_mov_b64 v[156:157], 0
  v_mov_b64 v[158:159], 0
  v_mov_b64 v[160:161], 0
  v_mov_b64 v[162:163], 0
  v_mov_b64 v[164:165], 0
  v_mov_b64 v[166:167], 0
  v_mov_b64 v[168:169], 0
  v_mov_b64 v[170:171], 0
  v_mov_b64 v[172:173], 0
  v_mov_b64 v[174:175], 0
  v_mov_b64 v[176:177], 0
  v_mov_b64 v[178:179], 0
  v_mov_b64 v[180:181], 0
  v_mov_b64 v[182:183], 0
  v_mov_b64 v[184:185], 0
  v_mov_b64 v[186:187], 0
  v_mov_b64 v[188:189], 0
  v_mov_b64 v[190:191], 0
  v_mov_b64 v[192:193], 0
  v_mov_b64 v[194:195], 0
  v_mov_b64 v[196:197], 0
  v_mov_b64 v[198:199], 0
  v_mov_b64 v[200:201], 0
  v_mov_b64 v[202:203], 0
  v_mov_b64 v[204:205], 0
  v_mov_b64 v[206:207], 0
  v_mov_b64 v[208:209], 0
  v_mov_b64 v[210:211], 0
  v_mov_b64 v[212:213], 0
  v_mov_b64 v[214:215], 0
  v_mov_b64 v[216:217], 0
  v_mov_b64 v[218:219], 0
  v_mov_b64 v[220:221], 0
  v_mov_b64 v[222:223], 0
  v_mov_b64 v[224:225], 0
  v_mov_b64 v[226:227], 0
  v_mov_b64 v[228:229], 0
  v_mov_b64 v[230:231], 0
  v_mov_b64 v[232:233], 0
  v_mov_b64 v[234:235], 0
  v_mov_b64 v[236:237], 0
  v_mov_b64 v[238:239], 0
  s_mul_i32 s5, s86, 384
  s_add_u32 s5, s5, 154112
  v_add_u32 v3, s5, v29
  s_mul_i32 s4, s76, 56
  s_mul_i32 s5, s79, 28
  s_add_u32 s4, s4, s5
  s_add_u32 s6, s4, s80
  s_lshl_b32 s6, s6, 14
  s_add_u32 s6, s6, 11599872
  s_add_u32 s7, s6, 4096
  s_lshr_b32 s5, s80, 1
  s_add_u32 s4, s4, s5
  s_lshl_b32 s4, s4, 1
  s_add_u32 s4, s4, s85
  s_lshl_b32 s4, s4, 3
  s_and_b32 s5, s80, 1
  s_add_u32 s4, s4, s5
  s_lshl_b32 s4, s4, 1
  s_add_u32 s4, s4, s86
  s_lshl_b32 s8, s4, 9
  s_add_u32 s8, s8, 11534336
  s_lshl_b32 s4, s79, Lz1-Lz0+3
  s_lshl_b32 s10, 0xff, s4
  s_mov_b32 s22, 8
  s_mov_b64 vcc, -1
  s_waitcnt lgkmcnt(0)
  s_barrier
  s_branch Lo_25
Lo_26:
  s_mov_b64 vcc, 0
  s_waitcnt lgkmcnt(0)
  s_barrier
  ds_read_b128 v[64:67], v4 offset:0
  ds_read_b128 v[80:83], v5 offset:0
  ds_read_b128 v[68:71], v4 offset:2048
  ds_read_b128 v[84:87], v5 offset:2048
  ds_read_b128 v[72:75], v4 offset:4096
  ds_read_b128 v[88:91], v5 offset:4096
  ds_read_b64_tr_b16 v[96:97], v6 offset:0
  ds_read_b64_tr_b16 v[98:99], v6 offset:2048
  ds_read_b64_tr_b16 v[100:101], v6 offset:4096
  ds_read_b64_tr_b16 v[102:103], v6 offset:6144
  ds_read_b128 v[76:79], v4 offset:6144
  ds_read_b128 v[92:95], v5 offset:6144
  ds_read_b64_tr_b16 v[104:105], v7 offset:0
  s_nop 0
  s_waitcnt lgkmcnt(8)
  ds_read_b64_tr_b16 v[106:107], v7 offset:2048
  ds_read_b64_tr_b16 v[108:109], v7 offset:4096
  ds_read_b64_tr_b16 v[110:111], v7 offset:6144
  s_waitcnt lgkmcnt(6)
  s_branch Lk_23
Lo_25:
  ds_read_b128 v[32:35], v4 offset:0
  ds_read_b128 v[48:51], v5 offset:0
  ds_read_b128 v[36:39], v4 offset:2048
  ds_read_b128 v[52:55], v5 offset:2048
  ds_read_b128 v[40:43], v4 offset:4096
  ds_read_b128 v[56:59], v5 offset:4096
  ds_read_b64_tr_b16 v[96:97], v6 offset:0
  ds_read_b64_tr_b16 v[98:99], v6 offset:2048
  ds_read_b64_tr_b16 v[100:101], v6 offset:4096
  ds_read_b64_tr_b16 v[102:103], v6 offset:6144
  ds_read_b128 v[44:47], v4 offset:6144
  ds_read_b128 v[60:63], v5 offset:6144
  ds_read_b64_tr_b16 v[104:105], v7 offset:0
  s_nop 0
  s_waitcnt lgkmcnt(8)
  ds_read_b64_tr_b16 v[106:107], v7 offset:2048
  ds_read_b64_tr_b16 v[108:109], v7 offset:4096
  ds_read_b64_tr_b16 v[110:111], v7 offset:6144
  s_nop 0
  s_waitcnt lgkmcnt(6)
  .p2align 7
Lk_22:
  v_mfma_f32_16x16x32_bf16 v[128:131], v[96:99], v[32:35], v[128:131]
  ds_read_b64_tr_b16 v[112:113], v8 offset:0
  v_mfma_f32_16x16x32_bf16 v[128:131], v[100:103], v[48:51], v[128:131]
  ds_read_b64_tr_b16 v[114:115], v8 offset:2048
  v_mfma_f32_16x16x32_bf16 v[132:135], v[100:103], v[52:55], v[132:135]
  ds_read_b64_tr_b16 v[116:117], v8 offset:4096
  v_mfma_f32_16x16x32_bf16 v[132:135], v[96:99], v[36:39], v[132:135]
  ds_read_b64_tr_b16 v[118:119], v8 offset:6144
  v_mfma_f32_16x16x32_bf16 v[136:139], v[96:99], v[40:43], v[136:139]
  s_add_u32 s16, s16, s17
  s_cmp_eq_u32 s16, 65536
  s_cselect_b32 s23, s18, s17
  s_cselect_b32 s16, Lz1-Lz0+0, s16
  v_mfma_f32_16x16x32_bf16 v[136:139], v[100:103], v[56:59], v[136:139]
  v_add_u32_e64 v4, s23, v4
  v_add_u32 v5, s23, v5
  s_add_u32 s19, s19, s20
  s_cmp_eq_u32 s19, 86016
  s_waitcnt lgkmcnt(8)
  v_mfma_f32_16x16x32_bf16 v[140:143], v[100:103], v[60:63], v[140:143]
  s_cselect_b32 s23, s21, s20
  s_cselect_b32 s19, 0, s19
  v_mfma_f32_16x16x32_bf16 v[140:143], v[96:99], v[44:47], v[140:143]
  s_waitcnt lgkmcnt(4)
  v_mfma_f32_16x16x32_bf16 v[156:159], v[104:107], v[44:47], v[156:159]
  ds_read_b64_tr_b16 v[120:121], v9 offset:0
  v_mfma_f32_16x16x32_bf16 v[156:159], v[108:111], v[60:63], v[156:159]
  ds_read_b64_tr_b16 v[122:123], v9 offset:2048
  v_mfma_f32_16x16x32_bf16 v[152:155], v[108:111], v[56:59], v[152:155]
  ds_read_b64_tr_b16 v[124:125], v9 offset:4096
  v_mfma_f32_16x16x32_bf16 v[152:155], v[104:107], v[40:43], v[152:155]
  ds_read_b64_tr_b16 v[126:127], v9 offset:6144
  v_mfma_f32_16x16x32_bf16 v[148:151], v[104:107], v[36:39], v[148:151]
  v_mfma_f32_16x16x32_bf16 v[148:151], v[108:111], v[52:55], v[148:151]
  v_mfma_f32_16x16x32_bf16 v[144:147], v[108:111], v[48:51], v[144:147]
  ds_read_b64_tr_b16 v[96:97], v6 offset:8192
  v_mfma_f32_16x16x32_bf16 v[144:147], v[104:107], v[32:35], v[144:147]
  ds_read_b64_tr_b16 v[98:99], v6 offset:10240
  s_nop 0
  s_waitcnt lgkmcnt(6)
  v_mfma_f32_16x16x32_bf16 v[160:163], v[112:115], v[32:35], v[160:163]
  ds_read_b64_tr_b16 v[100:101], v6 offset:12288
  v_mfma_f32_16x16x32_bf16 v[160:163], v[116:119], v[48:51], v[160:163]
  ds_read_b64_tr_b16 v[102:103], v6 offset:14336
  v_mfma_f32_16x16x32_bf16 v[164:167], v[116:119], v[52:55], v[164:167]
  v_mfma_f32_16x16x32_bf16 v[164:167], v[112:115], v[36:39], v[164:167]
  v_mfma_f32_16x16x32_bf16 v[168:171], v[112:115], v[40:43], v[168:171]
  ds_read_b64_tr_b16 v[104:105], v7 offset:8192
  v_mfma_f32_16x16x32_bf16 v[168:171], v[116:119], v[56:59], v[168:171]
  ds_read_b64_tr_b16 v[106:107], v7 offset:10240
  v_mfma_f32_16x16x32_bf16 v[172:175], v[116:119], v[60:63], v[172:175]
  ds_read_b64_tr_b16 v[108:109], v7 offset:12288
  v_mfma_f32_16x16x32_bf16 v[172:175], v[112:115], v[44:47], v[172:175]
  ds_read_b64_tr_b16 v[110:111], v7 offset:14336
  s_waitcnt lgkmcnt(8)
  v_mfma_f32_16x16x32_bf16 v[188:191], v[120:123], v[44:47], v[188:191]
  v_add_u32 v6, s23, v6
  v_add_u32_e64 v7, s23, v7
  v_mfma_f32_16x16x32_bf16 v[188:191], v[124:127], v[60:63], v[188:191]
  ds_read_b64_tr_b16 v[112:113], v10 offset:0
  v_mfma_f32_16x16x32_bf16 v[184:187], v[124:127], v[56:59], v[184:187]
  ds_read_b64_tr_b16 v[114:115], v10 offset:1024
  v_mfma_f32_16x16x32_bf16 v[184:187], v[120:123], v[40:43], v[184:187]
  ds_read_b64_tr_b16 v[116:117], v10 offset:2048
  v_mfma_f32_16x16x32_bf16 v[180:183], v[120:123], v[36:39], v[180:183]
  ds_read_b64_tr_b16 v[118:119], v10 offset:3072
  v_mfma_f32_16x16x32_bf16 v[180:183], v[124:127], v[52:55], v[180:183]
  v_add_u32 v8, s23, v8
  v_add_u32 v9, s23, v9
  v_mfma_f32_16x16x32_bf16 v[176:179], v[124:127], v[48:51], v[176:179]
  v_add_u32 v10, s23, v10
  v_mfma_f32_16x16x32_bf16 v[176:179], v[120:123], v[32:35], v[176:179]
  s_waitcnt lgkmcnt(0)
  s_cbranch_vccnz Lo_27
  s_barrier
Lo_27:
  v_mfma_f32_16x16x32_bf16 v[192:195], v[96:99], v[32:35], v[192:195]
  ds_read_b128 v[64:67], v4 offset:0
  v_mfma_f32_16x16x32_bf16 v[192:195], v[100:103], v[48:51], v[192:195]
  ds_read_b128 v[80:83], v5 offset:0
  v_mfma_f32_16x16x32_bf16 v[196:199], v[100:103], v[52:55], v[196:199]
  v_mfma_f32_16x16x32_bf16 v[196:199], v[96:99], v[36:39], v[196:199]
  ds_read_b128 v[68:71], v4 offset:2048
  v_mfma_f32_16x16x32_bf16 v[200:203], v[96:99], v[40:43], v[200:203]
  ds_read_b128 v[84:87], v5 offset:2048
  v_mfma_f32_16x16x32_bf16 v[200:203], v[100:103], v[56:59], v[200:203]
  v_mfma_f32_16x16x32_bf16 v[204:207], v[100:103], v[60:63], v[204:207]
  ds_read_b128 v[72:75], v4 offset:4096
  v_mfma_f32_16x16x32_bf16 v[204:207], v[96:99], v[44:47], v[204:207]
  ds_read_b128 v[88:91], v5 offset:4096
  v_mfma_f32_16x16x32_bf16 v[220:223], v[104:107], v[44:47], v[220:223]
  ds_read_b64_tr_b16 v[96:97], v6 offset:0
  v_mfma_f32_16x16x32_bf16 v[220:223], v[108:111], v[60:63], v[220:223]
  ds_read_b64_tr_b16 v[98:99], v6 offset:2048
  v_mfma_f32_16x16x32_bf16 v[216:219], v[108:111], v[56:59], v[216:219]
  ds_read_b64_tr_b16 v[100:101], v6 offset:4096
  v_mfma_f32_16x16x32_bf16 v[216:219], v[104:107], v[40:43], v[216:219]
  ds_read_b64_tr_b16 v[102:103], v6 offset:6144
  v_mfma_f32_16x16x32_bf16 v[212:215], v[104:107], v[36:39], v[212:215]
  ds_read_b128 v[76:79], v4 offset:6144
  v_mfma_f32_16x16x32_bf16 v[212:215], v[108:111], v[52:55], v[212:215]
  v_mfma_f32_16x16x32_bf16 v[208:211], v[108:111], v[48:51], v[208:211]
  ds_read_b128 v[92:95], v5 offset:6144
  v_mfma_f32_16x16x32_bf16 v[208:211], v[104:107], v[32:35], v[208:211]
  v_mfma_f32_16x16x32_bf16 v[224:227], v[112:115], v[32:35], v[224:227]
  ds_read_b64_tr_b16 v[104:105], v7 offset:0
  v_mfma_f32_16x16x32_bf16 v[224:227], v[116:119], v[48:51], v[224:227]
  v_mfma_f32_16x16x32_bf16 v[228:231], v[116:119], v[52:55], v[228:231]
  ds_read_b64_tr_b16 v[106:107], v7 offset:2048
  v_mfma_f32_16x16x32_bf16 v[228:231], v[112:115], v[36:39], v[228:231]
  v_mfma_f32_16x16x32_bf16 v[232:235], v[112:115], v[40:43], v[232:235]
  ds_read_b64_tr_b16 v[108:109], v7 offset:4096
  v_mfma_f32_16x16x32_bf16 v[232:235], v[116:119], v[56:59], v[232:235]
  v_mfma_f32_16x16x32_bf16 v[236:239], v[116:119], v[60:63], v[236:239]
  ds_read_b64_tr_b16 v[110:111], v7 offset:6144
  s_waitcnt lgkmcnt(6)
  v_mfma_f32_16x16x32_bf16 v[236:239], v[112:115], v[44:47], v[236:239]
  s_cbranch_vccnz Lo_26
Lk_23:
  v_mfma_f32_16x16x32_bf16 v[128:131], v[96:99], v[64:67], v[128:131]
  ds_read_b64_tr_b16 v[112:113], v8 offset:0
  v_mfma_f32_16x16x32_bf16 v[128:131], v[100:103], v[80:83], v[128:131]
  ds_read_b64_tr_b16 v[114:115], v8 offset:2048
  v_mfma_f32_16x16x32_bf16 v[132:135], v[100:103], v[84:87], v[132:135]
  ds_read_b64_tr_b16 v[116:117], v8 offset:4096
  v_mfma_f32_16x16x32_bf16 v[132:135], v[96:99], v[68:71], v[132:135]
  ds_read_b64_tr_b16 v[118:119], v8 offset:6144
  v_mfma_f32_16x16x32_bf16 v[136:139], v[96:99], v[72:75], v[136:139]
  s_add_u32 s16, s16, s17
  s_cmp_eq_u32 s16, 65536
  s_cselect_b32 s23, s18, s17
  s_cselect_b32 s16, Lz1-Lz0+0, s16
  v_mfma_f32_16x16x32_bf16 v[136:139], v[100:103], v[88:91], v[136:139]
  v_add_u32_e64 v4, s23, v4
  v_add_u32 v5, s23, v5
  s_add_u32 s19, s19, s20
  s_cmp_eq_u32 s19, 86016
  s_waitcnt lgkmcnt(8)
  v_mfma_f32_16x16x32_bf16 v[140:143], v[100:103], v[92:95], v[140:143]
  s_cselect_b32 s23, s21, s20
  s_cselect_b32 s19, 0, s19
  v_mfma_f32_16x16x32_bf16 v[140:143], v[96:99], v[76:79], v[140:143]
  s_waitcnt lgkmcnt(4)
  v_mfma_f32_16x16x32_bf16 v[156:159], v[104:107], v[76:79], v[156:159]
  ds_read_b64_tr_b16 v[120:121], v9 offset:0
  v_mfma_f32_16x16x32_bf16 v[156:159], v[108:111], v[92:95], v[156:159]
  ds_read_b64_tr_b16 v[122:123], v9 offset:2048
  v_mfma_f32_16x16x32_bf16 v[152:155], v[108:111], v[88:91], v[152:155]
  ds_read_b64_tr_b16 v[124:125], v9 offset:4096
  v_mfma_f32_16x16x32_bf16 v[152:155], v[104:107], v[72:75], v[152:155]
  ds_read_b64_tr_b16 v[126:127], v9 offset:6144
  v_mfma_f32_16x16x32_bf16 v[148:151], v[104:107], v[68:71], v[148:151]
  s_sub_u32 s22, s22, 1
  s_cmp_lg_u32 s22, 0
  v_mfma_f32_16x16x32_bf16 v[148:151], v[108:111], v[84:87], v[148:151]
  v_mfma_f32_16x16x32_bf16 v[144:147], v[108:111], v[80:83], v[144:147]
  ds_read_b64_tr_b16 v[96:97], v6 offset:8192
  v_mfma_f32_16x16x32_bf16 v[144:147], v[104:107], v[64:67], v[144:147]
  ds_read_b64_tr_b16 v[98:99], v6 offset:10240
  s_nop 0
  s_waitcnt lgkmcnt(6)
  v_mfma_f32_16x16x32_bf16 v[160:163], v[112:115], v[64:67], v[160:163]
  ds_read_b64_tr_b16 v[100:101], v6 offset:12288
  v_mfma_f32_16x16x32_bf16 v[160:163], v[116:119], v[80:83], v[160:163]
  ds_read_b64_tr_b16 v[102:103], v6 offset:14336
  v_mfma_f32_16x16x32_bf16 v[164:167], v[116:119], v[84:87], v[164:167]
  v_mfma_f32_16x16x32_bf16 v[164:167], v[112:115], v[68:71], v[164:167]
  v_mfma_f32_16x16x32_bf16 v[168:171], v[112:115], v[72:75], v[168:171]
  ds_read_b64_tr_b16 v[104:105], v7 offset:8192
  v_mfma_f32_16x16x32_bf16 v[168:171], v[116:119], v[88:91], v[168:171]
  ds_read_b64_tr_b16 v[106:107], v7 offset:10240
  v_mfma_f32_16x16x32_bf16 v[172:175], v[116:119], v[92:95], v[172:175]
  ds_read_b64_tr_b16 v[108:109], v7 offset:12288
  v_mfma_f32_16x16x32_bf16 v[172:175], v[112:115], v[76:79], v[172:175]
  ds_read_b64_tr_b16 v[110:111], v7 offset:14336
  s_waitcnt lgkmcnt(8)
  v_mfma_f32_16x16x32_bf16 v[188:191], v[120:123], v[76:79], v[188:191]
  v_add_u32 v6, s23, v6
  v_add_u32_e64 v7, s23, v7
  v_mfma_f32_16x16x32_bf16 v[188:191], v[124:127], v[92:95], v[188:191]
  ds_read_b64_tr_b16 v[112:113], v10 offset:0
  v_mfma_f32_16x16x32_bf16 v[184:187], v[124:127], v[88:91], v[184:187]
  ds_read_b64_tr_b16 v[114:115], v10 offset:1024
  v_mfma_f32_16x16x32_bf16 v[184:187], v[120:123], v[72:75], v[184:187]
  ds_read_b64_tr_b16 v[116:117], v10 offset:2048
  v_mfma_f32_16x16x32_bf16 v[180:183], v[120:123], v[68:71], v[180:183]
  ds_read_b64_tr_b16 v[118:119], v10 offset:3072
  v_mfma_f32_16x16x32_bf16 v[180:183], v[124:127], v[84:87], v[180:183]
  v_add_u32 v8, s23, v8
  v_add_u32 v9, s23, v9
  v_mfma_f32_16x16x32_bf16 v[176:179], v[124:127], v[80:83], v[176:179]
  v_add_u32 v10, s23, v10
  v_mfma_f32_16x16x32_bf16 v[176:179], v[120:123], v[64:67], v[176:179]
  s_waitcnt lgkmcnt(0)
  s_barrier
  s_cbranch_scc0 Lk_24
  v_mfma_f32_16x16x32_bf16 v[192:195], v[96:99], v[64:67], v[192:195]
  ds_read_b128 v[32:35], v4 offset:0
  v_mfma_f32_16x16x32_bf16 v[192:195], v[100:103], v[80:83], v[192:195]
  ds_read_b128 v[48:51], v5 offset:0
  v_mfma_f32_16x16x32_bf16 v[196:199], v[100:103], v[84:87], v[196:199]
  v_mfma_f32_16x16x32_bf16 v[196:199], v[96:99], v[68:71], v[196:199]
  ds_read_b128 v[36:39], v4 offset:2048
  v_mfma_f32_16x16x32_bf16 v[200:203], v[96:99], v[72:75], v[200:203]
  ds_read_b128 v[52:55], v5 offset:2048
  v_mfma_f32_16x16x32_bf16 v[200:203], v[100:103], v[88:91], v[200:203]
  v_mfma_f32_16x16x32_bf16 v[204:207], v[100:103], v[92:95], v[204:207]
  ds_read_b128 v[40:43], v4 offset:4096
  v_mfma_f32_16x16x32_bf16 v[204:207], v[96:99], v[76:79], v[204:207]
  ds_read_b128 v[56:59], v5 offset:4096
  v_mfma_f32_16x16x32_bf16 v[220:223], v[104:107], v[76:79], v[220:223]
  ds_read_b64_tr_b16 v[96:97], v6 offset:0
  v_mfma_f32_16x16x32_bf16 v[220:223], v[108:111], v[92:95], v[220:223]
  ds_read_b64_tr_b16 v[98:99], v6 offset:2048
  v_mfma_f32_16x16x32_bf16 v[216:219], v[108:111], v[88:91], v[216:219]
  ds_read_b64_tr_b16 v[100:101], v6 offset:4096
  v_mfma_f32_16x16x32_bf16 v[216:219], v[104:107], v[72:75], v[216:219]
  ds_read_b64_tr_b16 v[102:103], v6 offset:6144
  v_mfma_f32_16x16x32_bf16 v[212:215], v[104:107], v[68:71], v[212:215]
  ds_read_b128 v[44:47], v4 offset:6144
  v_mfma_f32_16x16x32_bf16 v[212:215], v[108:111], v[84:87], v[212:215]
  v_mfma_f32_16x16x32_bf16 v[208:211], v[108:111], v[80:83], v[208:211]
  ds_read_b128 v[60:63], v5 offset:6144
  v_mfma_f32_16x16x32_bf16 v[208:211], v[104:107], v[64:67], v[208:211]
  v_mfma_f32_16x16x32_bf16 v[224:227], v[112:115], v[64:67], v[224:227]
  ds_read_b64_tr_b16 v[104:105], v7 offset:0
  v_mfma_f32_16x16x32_bf16 v[224:227], v[116:119], v[80:83], v[224:227]
  v_mfma_f32_16x16x32_bf16 v[228:231], v[116:119], v[84:87], v[228:231]
  ds_read_b64_tr_b16 v[106:107], v7 offset:2048
  v_mfma_f32_16x16x32_bf16 v[228:231], v[112:115], v[68:71], v[228:231]
  v_mfma_f32_16x16x32_bf16 v[232:235], v[112:115], v[72:75], v[232:235]
  ds_read_b64_tr_b16 v[108:109], v7 offset:4096
  v_mfma_f32_16x16x32_bf16 v[232:235], v[116:119], v[88:91], v[232:235]
  v_mfma_f32_16x16x32_bf16 v[236:239], v[116:119], v[92:95], v[236:239]
  ds_read_b64_tr_b16 v[110:111], v7 offset:6144
  s_waitcnt lgkmcnt(6)
  v_mfma_f32_16x16x32_bf16 v[236:239], v[112:115], v[76:79], v[236:239]
  s_branch Lk_22
Lk_24:
  v_mfma_f32_16x16x32_bf16 v[192:195], v[96:99], v[64:67], v[192:195]
  ds_read_b128 v[32:35], v3 offset:0
  s_mul_i32 s4, s85, 320
  v_mfma_f32_16x16x32_bf16 v[192:195], v[100:103], v[80:83], v[192:195]
  ds_read_b128 v[36:39], v3 offset:1024
  s_add_u32 s4, s4, 151552
  v_mfma_f32_16x16x32_bf16 v[196:199], v[100:103], v[84:87], v[196:199]
  ds_read_b128 v[40:43], v3 offset:64
  v_and_b32_e64 v2, 15, v1
  v_mfma_f32_16x16x32_bf16 v[196:199], v[96:99], v[68:71], v[196:199]
  ds_read_b128 v[44:47], v3 offset:1088
  v_lshl_add_u32 v7, v2, 2, s4
  v_mfma_f32_16x16x32_bf16 v[200:203], v[96:99], v[72:75], v[200:203]
  ds_read_b128 v[48:51], v3 offset:128
  v_mov_b32 v4, 0x409d30fc
  v_mfma_f32_16x16x32_bf16 v[200:203], v[100:103], v[88:91], v[200:203]
  ds_read_b128 v[52:55], v3 offset:1152
  v_mov_b32 v5, 0x3eeff558
  v_mfma_f32_16x16x32_bf16 v[204:207], v[100:103], v[92:95], v[204:207]
  ds_read_b128 v[56:59], v3 offset:192
  v_and_b32_e64 v2, 32, v1
  v_mfma_f32_16x16x32_bf16 v[204:207], v[96:99], v[76:79], v[204:207]
  ds_read_b128 v[60:63], v3 offset:1216
  v_mad_u32_u24 v6, v2, 48, v11
  v_mfma_f32_16x16x32_bf16 v[220:223], v[104:107], v[76:79], v[220:223]
  v_mfma_f32_16x16x32_bf16 v[220:223], v[108:111], v[92:95], v[220:223]
  ds_read2_b32 v[96:97], v7 offset0:0 offset1:160
  ds_read2_b32 v[98:99], v7 offset0:16 offset1:176
  v_mfma_f32_16x16x32_bf16 v[216:219], v[108:111], v[88:91], v[216:219]
  ds_read2_b32 v[100:101], v7 offset0:32 offset1:192
  ds_read2_b32 v[102:103], v7 offset0:48 offset1:208
  v_mfma_f32_16x16x32_bf16 v[216:219], v[104:107], v[72:75], v[216:219]
  s_lshl_b32 s5, s86, Lz1-Lz0+6
  s_add_u32 s5, s5, 154880
  v_mfma_f32_16x16x32_bf16 v[212:215], v[104:107], v[68:71], v[212:215]
  v_add_u32_e64 v2, s5, v29
  v_mfma_f32_16x16x32_bf16 v[212:215], v[108:111], v[84:87], v[212:215]
  v_mfma_f32_16x16x32_bf16 v[208:211], v[108:111], v[80:83], v[208:211]
  v_mfma_f32_16x16x32_bf16 v[208:211], v[104:107], v[64:67], v[208:211]
  v_mfma_f32_16x16x32_bf16 v[224:227], v[112:115], v[64:67], v[224:227]
  v_mfma_f32_16x16x32_bf16 v[224:227], v[116:119], v[80:83], v[224:227]
  v_mfma_f32_16x16x32_bf16 v[228:231], v[116:119], v[84:87], v[228:231]
  v_mfma_f32_16x16x32_bf16 v[228:231], v[112:115], v[68:71], v[228:231]
  s_waitcnt lgkmcnt(0)
  v_mul_f32 v96, v5, v96
  v_mul_f32_e64 v98, v5, v98
  v_mfma_f32_16x16x32_bf16 v[232:235], v[112:115], v[72:75], v[232:235]
  v_mul_f32 v100, v5, v100
  v_mul_f32 v102, v5, v102
  v_mfma_f32_16x16x32_bf16 v[232:235], v[116:119], v[88:91], v[232:235]
  v_mfma_f32_16x16x32_bf16 v[236:239], v[116:119], v[92:95], v[236:239]
  v_mfma_f32_16x16x32_bf16 v[236:239], v[112:115], v[76:79], v[236:239]
  ds_read_b128 v[80:83], v2 offset:0
  ds_read_b128 v[84:87], v2 offset:1024
  ds_read_b128 v[64:67], v3 offset:256
  ds_read_b128 v[68:71], v3 offset:1280
  ds_read_b128 v[72:75], v3 offset:320
  ds_read_b128 v[76:79], v3 offset:1344
  v_pk_fma_f32 v[128:129], v[32:33], v[96:97], v[128:129] op_sel:[0,1,0] op_sel_hi:[1,1,1] neg_lo:[0,1,0] neg_hi:[0,1,0]
  v_pk_fma_f32 v[130:131], v[34:35], v[96:97], v[130:131] op_sel:[0,1,0] op_sel_hi:[1,1,1] neg_lo:[0,1,0] neg_hi:[0,1,0]
  v_pk_fma_f32 v[144:145], v[40:41], v[96:97], v[144:145] op_sel:[0,1,0] op_sel_hi:[1,1,1] neg_lo:[0,1,0] neg_hi:[0,1,0]
  v_pk_fma_f32 v[146:147], v[42:43], v[96:97], v[146:147] op_sel:[0,1,0] op_sel_hi:[1,1,1] neg_lo:[0,1,0] neg_hi:[0,1,0]
  v_pk_fma_f32 v[128:129], v[128:129], v[96:97], v[36:37] op_sel:[0,0,0] op_sel_hi:[1,0,1]
  v_pk_fma_f32 v[130:131], v[130:131], v[96:97], v[38:39] op_sel:[0,0,0] op_sel_hi:[1,0,1]
  v_pk_fma_f32 v[144:145], v[144:145], v[96:97], v[44:45] op_sel:[0,0,0] op_sel_hi:[1,0,1]
  v_pk_fma_f32 v[146:147], v[146:147], v[96:97], v[46:47] op_sel:[0,0,0] op_sel_hi:[1,0,1]
  v_pk_fma_f32 v[104:105], v[128:129], v[128:129], v[4:5] op_sel_hi:[1,1,0]
  v_pk_fma_f32 v[106:107], v[130:131], v[130:131], v[4:5] op_sel_hi:[1,1,0]
  v_pk_fma_f32 v[108:109], v[144:145], v[144:145], v[4:5] op_sel_hi:[1,1,0]
  v_pk_fma_f32 v[110:111], v[146:147], v[146:147], v[4:5] op_sel_hi:[1,1,0]
  v_pk_mul_f32 v[104:105], v[104:105], v[128:129] neg_lo:[0,1] neg_hi:[0,1]
  v_pk_mul_f32 v[106:107], v[106:107], v[130:131] neg_lo:[0,1] neg_hi:[0,1]
  v_pk_mul_f32 v[108:109], v[108:109], v[144:145] neg_lo:[0,1] neg_hi:[0,1]
  v_pk_mul_f32 v[110:111], v[110:111], v[146:147] neg_lo:[0,1] neg_hi:[0,1]
  v_exp_f32 v104, v104
  v_exp_f32 v105, v105
  v_exp_f32 v106, v106
  v_exp_f32 v107, v107
  v_exp_f32 v108, v108
  v_exp_f32 v109, v109
  v_exp_f32 v110, v110
  v_exp_f32 v111, v111
  v_pk_fma_f32 v[104:105], v[104:105], v[4:5], v[4:5] op_sel:[0,1,1] op_sel_hi:[1,1,1]
  v_pk_fma_f32 v[106:107], v[106:107], v[4:5], v[4:5] op_sel:[0,1,1] op_sel_hi:[1,1,1]
  v_pk_fma_f32 v[108:109], v[108:109], v[4:5], v[4:5] op_sel:[0,1,1] op_sel_hi:[1,1,1]
  v_pk_fma_f32 v[110:111], v[110:111], v[4:5], v[4:5] op_sel:[0,1,1] op_sel_hi:[1,1,1]
  v_rcp_f32 v104, v104
  v_rcp_f32 v105, v105
  v_rcp_f32 v106, v106
  v_rcp_f32 v107, v107
  v_rcp_f32 v108, v108
  v_rcp_f32 v109, v109
  v_rcp_f32 v110, v110
  v_rcp_f32 v111, v111
  v_pk_mul_f32 v[128:129], v[128:129], v[104:105]
  v_pk_mul_f32 v[130:131], v[130:131], v[106:107]
  v_pk_mul_f32 v[144:145], v[144:145], v[108:109]
  v_pk_mul_f32 v[146:147], v[146:147], v[110:111]
  v_cvt_pk_bf16_f32 v116, v128, v129
  v_cvt_pk_bf16_f32 v117, v130, v131
  v_cvt_pk_bf16_f32 v118, v144, v145
  v_cvt_pk_bf16_f32 v119, v146, v147
  buffer_store_dwordx4 v[116:119], v0, s[40:43], s6 offen offset:0 sc0 sc1
  ds_write_b128 v0, v[116:119] offset:0
  v_pk_fma_f32 v[132:133], v[32:33], v[98:99], v[132:133] op_sel:[0,1,0] op_sel_hi:[1,1,1] neg_lo:[0,1,0] neg_hi:[0,1,0]
  v_pk_fma_f32 v[134:135], v[34:35], v[98:99], v[134:135] op_sel:[0,1,0] op_sel_hi:[1,1,1] neg_lo:[0,1,0] neg_hi:[0,1,0]
  v_pk_fma_f32 v[148:149], v[40:41], v[98:99], v[148:149] op_sel:[0,1,0] op_sel_hi:[1,1,1] neg_lo:[0,1,0] neg_hi:[0,1,0]
  v_pk_fma_f32 v[150:151], v[42:43], v[98:99], v[150:151] op_sel:[0,1,0] op_sel_hi:[1,1,1] neg_lo:[0,1,0] neg_hi:[0,1,0]
  v_pk_fma_f32 v[132:133], v[132:133], v[98:99], v[36:37] op_sel:[0,0,0] op_sel_hi:[1,0,1]
  v_pk_fma_f32 v[134:135], v[134:135], v[98:99], v[38:39] op_sel:[0,0,0] op_sel_hi:[1,0,1]
  v_pk_fma_f32 v[148:149], v[148:149], v[98:99], v[44:45] op_sel:[0,0,0] op_sel_hi:[1,0,1]
  v_pk_fma_f32 v[150:151], v[150:151], v[98:99], v[46:47] op_sel:[0,0,0] op_sel_hi:[1,0,1]
  v_pk_fma_f32 v[104:105], v[132:133], v[132:133], v[4:5] op_sel_hi:[1,1,0]
  v_pk_fma_f32 v[106:107], v[134:135], v[134:135], v[4:5] op_sel_hi:[1,1,0]
  v_pk_fma_f32 v[108:109], v[148:149], v[148:149], v[4:5] op_sel_hi:[1,1,0]
  v_pk_fma_f32 v[110:111], v[150:151], v[150:151], v[4:5] op_sel_hi:[1,1,0]
  v_pk_mul_f32 v[104:105], v[104:105], v[132:133] neg_lo:[0,1] neg_hi:[0,1]
  v_pk_mul_f32 v[106:107], v[106:107], v[134:135] neg_lo:[0,1] neg_hi:[0,1]
  v_pk_mul_f32 v[108:109], v[108:109], v[148:149] neg_lo:[0,1] neg_hi:[0,1]
  v_pk_mul_f32 v[110:111], v[110:111], v[150:151] neg_lo:[0,1] neg_hi:[0,1]
  v_exp_f32 v104, v104
  v_exp_f32 v105, v105
  v_exp_f32 v106, v106
  v_exp_f32 v107, v107
  v_exp_f32 v108, v108
  v_exp_f32 v109, v109
  v_exp_f32 v110, v110
  v_exp_f32 v111, v111
  v_pk_fma_f32 v[104:105], v[104:105], v[4:5], v[4:5] op_sel:[0,1,1] op_sel_hi:[1,1,1]
  v_pk_fma_f32 v[106:107], v[106:107], v[4:5], v[4:5] op_sel:[0,1,1] op_sel_hi:[1,1,1]
  v_pk_fma_f32 v[108:109], v[108:109], v[4:5], v[4:5] op_sel:[0,1,1] op_sel_hi:[1,1,1]
  v_pk_fma_f32 v[110:111], v[110:111], v[4:5], v[4:5] op_sel:[0,1,1] op_sel_hi:[1,1,1]
  v_rcp_f32 v104, v104
  v_rcp_f32 v105, v105
  v_rcp_f32 v106, v106
  v_rcp_f32 v107, v107
  v_rcp_f32 v108, v108
  v_rcp_f32 v109, v109
  v_rcp_f32 v110, v110
  v_rcp_f32 v111, v111
  v_pk_mul_f32 v[132:133], v[132:133], v[104:105]
  v_pk_mul_f32 v[134:135], v[134:135], v[106:107]
  v_pk_mul_f32 v[148:149], v[148:149], v[108:109]
  v_pk_mul_f32 v[150:151], v[150:151], v[110:111]
  v_cvt_pk_bf16_f32 v120, v132, v133
  v_cvt_pk_bf16_f32 v121, v134, v135
  v_cvt_pk_bf16_f32 v122, v148, v149
  v_cvt_pk_bf16_f32 v123, v150, v151
  buffer_store_dwordx4 v[120:123], v0, s[40:43], s6 offen offset:2048 sc0 sc1
  ds_write_b128 v0, v[120:123] offset:2048
  s_add_u32 s6, s6, 0x20000
  v_pk_fma_f32 v[136:137], v[32:33], v[100:101], v[136:137] op_sel:[0,1,0] op_sel_hi:[1,1,1] neg_lo:[0,1,0] neg_hi:[0,1,0]
  v_pk_fma_f32 v[138:139], v[34:35], v[100:101], v[138:139] op_sel:[0,1,0] op_sel_hi:[1,1,1] neg_lo:[0,1,0] neg_hi:[0,1,0]
  v_pk_fma_f32 v[152:153], v[40:41], v[100:101], v[152:153] op_sel:[0,1,0] op_sel_hi:[1,1,1] neg_lo:[0,1,0] neg_hi:[0,1,0]
  v_pk_fma_f32 v[154:155], v[42:43], v[100:101], v[154:155] op_sel:[0,1,0] op_sel_hi:[1,1,1] neg_lo:[0,1,0] neg_hi:[0,1,0]
  v_pk_fma_f32 v[136:137], v[136:137], v[100:101], v[36:37] op_sel:[0,0,0] op_sel_hi:[1,0,1]
  v_pk_fma_f32 v[138:139], v[138:139], v[100:101], v[38:39] op_sel:[0,0,0] op_sel_hi:[1,0,1]
  v_pk_fma_f32 v[152:153], v[152:153], v[100:101], v[44:45] op_sel:[0,0,0] op_sel_hi:[1,0,1]
  v_pk_fma_f32 v[154:155], v[154:155], v[100:101], v[46:47] op_sel:[0,0,0] op_sel_hi:[1,0,1]
  v_pk_fma_f32 v[104:105], v[136:137], v[136:137], v[4:5] op_sel_hi:[1,1,0]
  v_pk_fma_f32 v[106:107], v[138:139], v[138:139], v[4:5] op_sel_hi:[1,1,0]
  v_pk_fma_f32 v[108:109], v[152:153], v[152:153], v[4:5] op_sel_hi:[1,1,0]
  v_pk_fma_f32 v[110:111], v[154:155], v[154:155], v[4:5] op_sel_hi:[1,1,0]
  v_pk_mul_f32 v[104:105], v[104:105], v[136:137] neg_lo:[0,1] neg_hi:[0,1]
  v_pk_mul_f32 v[106:107], v[106:107], v[138:139] neg_lo:[0,1] neg_hi:[0,1]
  v_pk_mul_f32 v[108:109], v[108:109], v[152:153] neg_lo:[0,1] neg_hi:[0,1]
  v_pk_mul_f32 v[110:111], v[110:111], v[154:155] neg_lo:[0,1] neg_hi:[0,1]
  v_exp_f32 v104, v104
  v_exp_f32 v105, v105
  v_exp_f32 v106, v106
  v_exp_f32 v107, v107
  v_exp_f32 v108, v108
  v_exp_f32 v109, v109
  v_exp_f32 v110, v110
  v_exp_f32 v111, v111
  v_pk_fma_f32 v[104:105], v[104:105], v[4:5], v[4:5] op_sel:[0,1,1] op_sel_hi:[1,1,1]
  v_pk_fma_f32 v[106:107], v[106:107], v[4:5], v[4:5] op_sel:[0,1,1] op_sel_hi:[1,1,1]
  v_pk_fma_f32 v[108:109], v[108:109], v[4:5], v[4:5] op_sel:[0,1,1] op_sel_hi:[1,1,1]
  v_pk_fma_f32 v[110:111], v[110:111], v[4:5], v[4:5] op_sel:[0,1,1] op_sel_hi:[1,1,1]
  v_rcp_f32 v104, v104
  v_rcp_f32 v105, v105
  v_rcp_f32 v106, v106
  v_rcp_f32 v107, v107
  v_rcp_f32 v108, v108
  v_rcp_f32 v109, v109
  v_rcp_f32 v110, v110
  v_rcp_f32 v111, v111
  v_pk_mul_f32 v[136:137], v[136:137], v[104:105]
  v_pk_mul_f32 v[138:139], v[138:139], v[106:107]
  v_pk_mul_f32 v[152:153], v[152:153], v[108:109]
  v_pk_mul_f32 v[154:155], v[154:155], v[110:111]
  v_cvt_pk_bf16_f32 v116, v136, v137
  v_cvt_pk_bf16_f32 v117, v138, v139
  v_cvt_pk_bf16_f32 v118, v152, v153
  v_cvt_pk_bf16_f32 v119, v154, v155
  buffer_store_dwordx4 v[116:119], v0, s[40:43], s7 offen offset:0 sc0 sc1
  ds_write_b128 v0, v[116:119] offset:4096
  v_pk_fma_f32 v[140:141], v[32:33], v[102:103], v[140:141] op_sel:[0,1,0] op_sel_hi:[1,1,1] neg_lo:[0,1,0] neg_hi:[0,1,0]
  v_pk_fma_f32 v[142:143], v[34:35], v[102:103], v[142:143] op_sel:[0,1,0] op_sel_hi:[1,1,1] neg_lo:[0,1,0] neg_hi:[0,1,0]
  v_pk_fma_f32 v[156:157], v[40:41], v[102:103], v[156:157] op_sel:[0,1,0] op_sel_hi:[1,1,1] neg_lo:[0,1,0] neg_hi:[0,1,0]
  v_pk_fma_f32 v[158:159], v[42:43], v[102:103], v[158:159] op_sel:[0,1,0] op_sel_hi:[1,1,1] neg_lo:[0,1,0] neg_hi:[0,1,0]
  v_pk_fma_f32 v[140:141], v[140:141], v[102:103], v[36:37] op_sel:[0,0,0] op_sel_hi:[1,0,1]
  v_pk_fma_f32 v[142:143], v[142:143], v[102:103], v[38:39] op_sel:[0,0,0] op_sel_hi:[1,0,1]
  v_pk_fma_f32 v[156:157], v[156:157], v[102:103], v[44:45] op_sel:[0,0,0] op_sel_hi:[1,0,1]
  v_pk_fma_f32 v[158:159], v[158:159], v[102:103], v[46:47] op_sel:[0,0,0] op_sel_hi:[1,0,1]
  v_pk_fma_f32 v[104:105], v[140:141], v[140:141], v[4:5] op_sel_hi:[1,1,0]
  v_pk_fma_f32 v[106:107], v[142:143], v[142:143], v[4:5] op_sel_hi:[1,1,0]
  v_pk_fma_f32 v[108:109], v[156:157], v[156:157], v[4:5] op_sel_hi:[1,1,0]
  v_pk_fma_f32 v[110:111], v[158:159], v[158:159], v[4:5] op_sel_hi:[1,1,0]
  v_pk_mul_f32 v[104:105], v[104:105], v[140:141] neg_lo:[0,1] neg_hi:[0,1]
  v_pk_mul_f32 v[106:107], v[106:107], v[142:143] neg_lo:[0,1] neg_hi:[0,1]
  v_pk_mul_f32 v[108:109], v[108:109], v[156:157] neg_lo:[0,1] neg_hi:[0,1]
  v_pk_mul_f32 v[110:111], v[110:111], v[158:159] neg_lo:[0,1] neg_hi:[0,1]
  v_exp_f32 v104, v104
  v_exp_f32 v105, v105
  v_exp_f32 v106, v106
  v_exp_f32 v107, v107
  v_exp_f32 v108, v108
  v_exp_f32 v109, v109
  v_exp_f32 v110, v110
  v_exp_f32 v111, v111
  v_pk_fma_f32 v[104:105], v[104:105], v[4:5], v[4:5] op_sel:[0,1,1] op_sel_hi:[1,1,1]
  v_pk_fma_f32 v[106:107], v[106:107], v[4:5], v[4:5] op_sel:[0,1,1] op_sel_hi:[1,1,1]
  v_pk_fma_f32 v[108:109], v[108:109], v[4:5], v[4:5] op_sel:[0,1,1] op_sel_hi:[1,1,1]
  v_pk_fma_f32 v[110:111], v[110:111], v[4:5], v[4:5] op_sel:[0,1,1] op_sel_hi:[1,1,1]
  v_rcp_f32 v104, v104
  v_rcp_f32 v105, v105
  v_rcp_f32 v106, v106
  v_rcp_f32 v107, v107
  v_rcp_f32 v108, v108
  v_rcp_f32 v109, v109
  v_rcp_f32 v110, v110
  v_rcp_f32 v111, v111
  v_pk_mul_f32 v[140:141], v[140:141], v[104:105]
  v_pk_mul_f32 v[142:143], v[142:143], v[106:107]
  v_pk_mul_f32 v[156:157], v[156:157], v[108:109]
  v_pk_mul_f32 v[158:159], v[158:159], v[110:111]
  v_cvt_pk_bf16_f32 v120, v140, v141
  v_cvt_pk_bf16_f32 v121, v142, v143
  v_cvt_pk_bf16_f32 v122, v156, v157
  v_cvt_pk_bf16_f32 v123, v158, v159
  buffer_store_dwordx4 v[120:123], v0, s[40:43], s7 offen offset:2048 sc0 sc1
  ds_write_b128 v0, v[120:123] offset:6144
  s_add_u32 s7, s7, 0x20000
  s_nop 0
  s_waitcnt lgkmcnt(0)
  v_pk_fma_f32 v[224:225], v[80:81], v[96:97], v[224:225] op_sel:[0,1,0] op_sel_hi:[1,1,1] neg_lo:[0,1,0] neg_hi:[0,1,0]
  v_pk_fma_f32 v[226:227], v[82:83], v[96:97], v[226:227] op_sel:[0,1,0] op_sel_hi:[1,1,1] neg_lo:[0,1,0] neg_hi:[0,1,0]
  v_pk_fma_f32 v[228:229], v[80:81], v[98:99], v[228:229] op_sel:[0,1,0] op_sel_hi:[1,1,1] neg_lo:[0,1,0] neg_hi:[0,1,0]
  v_pk_fma_f32 v[230:231], v[82:83], v[98:99], v[230:231] op_sel:[0,1,0] op_sel_hi:[1,1,1] neg_lo:[0,1,0] neg_hi:[0,1,0]
  v_pk_fma_f32 v[224:225], v[224:225], v[96:97], v[84:85] op_sel:[0,0,0] op_sel_hi:[1,0,1]
  v_pk_fma_f32 v[226:227], v[226:227], v[96:97], v[86:87] op_sel:[0,0,0] op_sel_hi:[1,0,1]
  v_pk_fma_f32 v[228:229], v[228:229], v[98:99], v[84:85] op_sel:[0,0,0] op_sel_hi:[1,0,1]
  v_pk_fma_f32 v[230:231], v[230:231], v[98:99], v[86:87] op_sel:[0,0,0] op_sel_hi:[1,0,1]
  v_pk_fma_f32 v[104:105], v[224:225], v[224:225], v[4:5] op_sel_hi:[1,1,0]
  v_pk_fma_f32 v[106:107], v[226:227], v[226:227], v[4:5] op_sel_hi:[1,1,0]
  v_pk_fma_f32 v[108:109], v[228:229], v[228:229], v[4:5] op_sel_hi:[1,1,0]
  v_pk_fma_f32 v[110:111], v[230:231], v[230:231], v[4:5] op_sel_hi:[1,1,0]
  v_pk_mul_f32 v[104:105], v[104:105], v[224:225] neg_lo:[0,1] neg_hi:[0,1]
  v_pk_mul_f32 v[106:107], v[106:107], v[226:227] neg_lo:[0,1] neg_hi:[0,1]
  v_pk_mul_f32 v[108:109], v[108:109], v[228:229] neg_lo:[0,1] neg_hi:[0,1]
  v_pk_mul_f32 v[110:111], v[110:111], v[230:231] neg_lo:[0,1] neg_hi:[0,1]
  v_exp_f32 v104, v104
  v_exp_f32 v105, v105
  v_exp_f32 v106, v106
  v_exp_f32 v107, v107
  v_exp_f32 v108, v108
  v_exp_f32 v109, v109
  v_exp_f32 v110, v110
  v_exp_f32 v111, v111
  v_pk_fma_f32 v[104:105], v[104:105], v[4:5], v[4:5] op_sel:[0,1,1] op_sel_hi:[1,1,1]
  v_pk_fma_f32 v[106:107], v[106:107], v[4:5], v[4:5] op_sel:[0,1,1] op_sel_hi:[1,1,1]
  v_pk_fma_f32 v[108:109], v[108:109], v[4:5], v[4:5] op_sel:[0,1,1] op_sel_hi:[1,1,1]
  v_pk_fma_f32 v[110:111], v[110:111], v[4:5], v[4:5] op_sel:[0,1,1] op_sel_hi:[1,1,1]
  v_rcp_f32 v104, v104
  v_rcp_f32 v105, v105
  v_rcp_f32 v106, v106
  v_rcp_f32 v107, v107
  v_rcp_f32 v108, v108
  v_rcp_f32 v109, v109
  v_rcp_f32 v110, v110
  v_rcp_f32 v111, v111
  v_pk_mul_f32 v[224:225], v[224:225], v[104:105]
  v_pk_mul_f32 v[226:227], v[226:227], v[106:107]
  v_pk_mul_f32 v[228:229], v[228:229], v[108:109]
  v_pk_mul_f32 v[230:231], v[230:231], v[110:111]
  v_cvt_pk_bf16_f32 v116, v224, v225
  v_cvt_pk_bf16_f32 v117, v226, v227
  v_cvt_pk_bf16_f32 v118, v228, v229
  v_cvt_pk_bf16_f32 v119, v230, v231
  s_nop 0
  v_permlane32_swap_b32 v116, v118
  v_permlane32_swap_b32_e64 v117, v119
  buffer_store_dwordx4 v[116:119], v6, s[40:43], s8 offen sc0 sc1
  s_add_u32 s8, s8, 4096
  v_pk_fma_f32 v[232:233], v[80:81], v[100:101], v[232:233] op_sel:[0,1,0] op_sel_hi:[1,1,1] neg_lo:[0,1,0] neg_hi:[0,1,0]
  v_pk_fma_f32 v[234:235], v[82:83], v[100:101], v[234:235] op_sel:[0,1,0] op_sel_hi:[1,1,1] neg_lo:[0,1,0] neg_hi:[0,1,0]
  v_pk_fma_f32 v[236:237], v[80:81], v[102:103], v[236:237] op_sel:[0,1,0] op_sel_hi:[1,1,1] neg_lo:[0,1,0] neg_hi:[0,1,0]
  v_pk_fma_f32 v[238:239], v[82:83], v[102:103], v[238:239] op_sel:[0,1,0] op_sel_hi:[1,1,1] neg_lo:[0,1,0] neg_hi:[0,1,0]
  v_pk_fma_f32 v[232:233], v[232:233], v[100:101], v[84:85] op_sel:[0,0,0] op_sel_hi:[1,0,1]
  v_pk_fma_f32 v[234:235], v[234:235], v[100:101], v[86:87] op_sel:[0,0,0] op_sel_hi:[1,0,1]
  v_pk_fma_f32 v[236:237], v[236:237], v[102:103], v[84:85] op_sel:[0,0,0] op_sel_hi:[1,0,1]
  v_pk_fma_f32 v[238:239], v[238:239], v[102:103], v[86:87] op_sel:[0,0,0] op_sel_hi:[1,0,1]
  v_pk_fma_f32 v[104:105], v[232:233], v[232:233], v[4:5] op_sel_hi:[1,1,0]
  v_pk_fma_f32 v[106:107], v[234:235], v[234:235], v[4:5] op_sel_hi:[1,1,0]
  v_pk_fma_f32 v[108:109], v[236:237], v[236:237], v[4:5] op_sel_hi:[1,1,0]
  v_pk_fma_f32 v[110:111], v[238:239], v[238:239], v[4:5] op_sel_hi:[1,1,0]
  v_pk_mul_f32 v[104:105], v[104:105], v[232:233] neg_lo:[0,1] neg_hi:[0,1]
  v_pk_mul_f32 v[106:107], v[106:107], v[234:235] neg_lo:[0,1] neg_hi:[0,1]
  v_pk_mul_f32 v[108:109], v[108:109], v[236:237] neg_lo:[0,1] neg_hi:[0,1]
  v_pk_mul_f32 v[110:111], v[110:111], v[238:239] neg_lo:[0,1] neg_hi:[0,1]
  v_exp_f32 v104, v104
  v_exp_f32 v105, v105
  v_exp_f32 v106, v106
  v_exp_f32 v107, v107
  v_exp_f32 v108, v108
  v_exp_f32 v109, v109
  v_exp_f32 v110, v110
  v_exp_f32 v111, v111
  v_pk_fma_f32 v[104:105], v[104:105], v[4:5], v[4:5] op_sel:[0,1,1] op_sel_hi:[1,1,1]
  v_pk_fma_f32 v[106:107], v[106:107], v[4:5], v[4:5] op_sel:[0,1,1] op_sel_hi:[1,1,1]
  v_pk_fma_f32 v[108:109], v[108:109], v[4:5], v[4:5] op_sel:[0,1,1] op_sel_hi:[1,1,1]
  v_pk_fma_f32 v[110:111], v[110:111], v[4:5], v[4:5] op_sel:[0,1,1] op_sel_hi:[1,1,1]
  v_rcp_f32 v104, v104
  v_rcp_f32 v105, v105
  v_rcp_f32 v106, v106
  v_rcp_f32 v107, v107
  v_rcp_f32 v108, v108
  v_rcp_f32 v109, v109
  v_rcp_f32 v110, v110
  v_rcp_f32 v111, v111
  v_pk_mul_f32 v[232:233], v[232:233], v[104:105]
  v_pk_mul_f32 v[234:235], v[234:235], v[106:107]
  v_pk_mul_f32 v[236:237], v[236:237], v[108:109]
  v_pk_mul_f32 v[238:239], v[238:239], v[110:111]
  v_cvt_pk_bf16_f32 v120, v232, v233
  v_cvt_pk_bf16_f32 v121, v234, v235
  v_cvt_pk_bf16_f32 v122, v236, v237
  v_cvt_pk_bf16_f32 v123, v238, v239
  s_add_u32 s9, s87, Lz1-Lz0+8
  s_waitcnt vmcnt(1)
  s_mov_b64 exec, 1
  ds_add_rtn_u32 v124, v28, v27 offset:0
  s_mov_b64 exec, -1
  v_permlane32_swap_b32 v120, v122
  v_permlane32_swap_b32_e64 v121, v123
  buffer_store_dwordx4 v[120:123], v6, s[40:43], s8 offen sc0 sc1
  v_pk_fma_f32 v[160:161], v[48:49], v[96:97], v[160:161] op_sel:[0,1,0] op_sel_hi:[1,1,1] neg_lo:[0,1,0] neg_hi:[0,1,0]
  v_pk_fma_f32 v[162:163], v[50:51], v[96:97], v[162:163] op_sel:[0,1,0] op_sel_hi:[1,1,1] neg_lo:[0,1,0] neg_hi:[0,1,0]
  v_pk_fma_f32 v[176:177], v[56:57], v[96:97], v[176:177] op_sel:[0,1,0] op_sel_hi:[1,1,1] neg_lo:[0,1,0] neg_hi:[0,1,0]
  v_pk_fma_f32 v[178:179], v[58:59], v[96:97], v[178:179] op_sel:[0,1,0] op_sel_hi:[1,1,1] neg_lo:[0,1,0] neg_hi:[0,1,0]
  v_pk_fma_f32 v[160:161], v[160:161], v[96:97], v[52:53] op_sel:[0,0,0] op_sel_hi:[1,0,1]
  v_pk_fma_f32 v[162:163], v[162:163], v[96:97], v[54:55] op_sel:[0,0,0] op_sel_hi:[1,0,1]
  v_pk_fma_f32 v[176:177], v[176:177], v[96:97], v[60:61] op_sel:[0,0,0] op_sel_hi:[1,0,1]
  v_pk_fma_f32 v[178:179], v[178:179], v[96:97], v[62:63] op_sel:[0,0,0] op_sel_hi:[1,0,1]
  v_pk_fma_f32 v[104:105], v[160:161], v[160:161], v[4:5] op_sel_hi:[1,1,0]
  v_pk_fma_f32 v[106:107], v[162:163], v[162:163], v[4:5] op_sel_hi:[1,1,0]
  v_pk_fma_f32 v[108:109], v[176:177], v[176:177], v[4:5] op_sel_hi:[1,1,0]
  v_pk_fma_f32 v[110:111], v[178:179], v[178:179], v[4:5] op_sel_hi:[1,1,0]
  v_pk_mul_f32 v[104:105], v[104:105], v[160:161] neg_lo:[0,1] neg_hi:[0,1]
  v_pk_mul_f32 v[106:107], v[106:107], v[162:163] neg_lo:[0,1] neg_hi:[0,1]
  v_pk_mul_f32 v[108:109], v[108:109], v[176:177] neg_lo:[0,1] neg_hi:[0,1]
  v_pk_mul_f32 v[110:111], v[110:111], v[178:179] neg_lo:[0,1] neg_hi:[0,1]
  v_exp_f32 v104, v104
  v_exp_f32 v105, v105
  v_exp_f32 v106, v106
  v_exp_f32 v107, v107
  v_exp_f32 v108, v108
  v_exp_f32 v109, v109
  v_exp_f32 v110, v110
  v_exp_f32 v111, v111
  v_pk_fma_f32 v[104:105], v[104:105], v[4:5], v[4:5] op_sel:[0,1,1] op_sel_hi:[1,1,1]
  v_pk_fma_f32 v[106:107], v[106:107], v[4:5], v[4:5] op_sel:[0,1,1] op_sel_hi:[1,1,1]
  v_pk_fma_f32 v[108:109], v[108:109], v[4:5], v[4:5] op_sel:[0,1,1] op_sel_hi:[1,1,1]
  v_pk_fma_f32 v[110:111], v[110:111], v[4:5], v[4:5] op_sel:[0,1,1] op_sel_hi:[1,1,1]
  v_rcp_f32 v104, v104
  v_rcp_f32 v105, v105
  v_rcp_f32 v106, v106
  v_rcp_f32 v107, v107
  v_rcp_f32 v108, v108
  v_rcp_f32 v109, v109
  v_rcp_f32 v110, v110
  v_rcp_f32 v111, v111
  v_pk_mul_f32 v[160:161], v[160:161], v[104:105]
  v_pk_mul_f32 v[162:163], v[162:163], v[106:107]
  v_pk_mul_f32 v[176:177], v[176:177], v[108:109]
  v_pk_mul_f32 v[178:179], v[178:179], v[110:111]
  v_cvt_pk_bf16_f32 v116, v160, v161
  v_cvt_pk_bf16_f32 v117, v162, v163
  v_cvt_pk_bf16_f32 v118, v176, v177
  v_cvt_pk_bf16_f32 v119, v178, v179
  s_waitcnt lgkmcnt(0)
  v_readfirstlane_b32 s4, v124
  s_and_b32 s4, s4, 3
  s_cmp_lg_u32 s4, 3
  s_cbranch_scc1 Ls_28
  s_mov_b32 exec_lo, s10
  s_mov_b32 exec_hi, 0
  buffer_store_dword v27, v24, s[40:43], s9 offen sc0 sc1
Ls_28:
  s_mov_b64 exec, -1
  buffer_store_dwordx4 v[116:119], v0, s[40:43], s6 offen offset:0 sc0 sc1
  ds_write_b128 v0, v[116:119] offset:16384
  v_pk_fma_f32 v[164:165], v[48:49], v[98:99], v[164:165] op_sel:[0,1,0] op_sel_hi:[1,1,1] neg_lo:[0,1,0] neg_hi:[0,1,0]
  v_pk_fma_f32 v[166:167], v[50:51], v[98:99], v[166:167] op_sel:[0,1,0] op_sel_hi:[1,1,1] neg_lo:[0,1,0] neg_hi:[0,1,0]
  v_pk_fma_f32 v[180:181], v[56:57], v[98:99], v[180:181] op_sel:[0,1,0] op_sel_hi:[1,1,1] neg_lo:[0,1,0] neg_hi:[0,1,0]
  v_pk_fma_f32 v[182:183], v[58:59], v[98:99], v[182:183] op_sel:[0,1,0] op_sel_hi:[1,1,1] neg_lo:[0,1,0] neg_hi:[0,1,0]
  v_pk_fma_f32 v[164:165], v[164:165], v[98:99], v[52:53] op_sel:[0,0,0] op_sel_hi:[1,0,1]
  v_pk_fma_f32 v[166:167], v[166:167], v[98:99], v[54:55] op_sel:[0,0,0] op_sel_hi:[1,0,1]
  v_pk_fma_f32 v[180:181], v[180:181], v[98:99], v[60:61] op_sel:[0,0,0] op_sel_hi:[1,0,1]
  v_pk_fma_f32 v[182:183], v[182:183], v[98:99], v[62:63] op_sel:[0,0,0] op_sel_hi:[1,0,1]
  v_pk_fma_f32 v[104:105], v[164:165], v[164:165], v[4:5] op_sel_hi:[1,1,0]
  v_pk_fma_f32 v[106:107], v[166:167], v[166:167], v[4:5] op_sel_hi:[1,1,0]
  v_pk_fma_f32 v[108:109], v[180:181], v[180:181], v[4:5] op_sel_hi:[1,1,0]
  v_pk_fma_f32 v[110:111], v[182:183], v[182:183], v[4:5] op_sel_hi:[1,1,0]
  v_pk_mul_f32 v[104:105], v[104:105], v[164:165] neg_lo:[0,1] neg_hi:[0,1]
  v_pk_mul_f32 v[106:107], v[106:107], v[166:167] neg_lo:[0,1] neg_hi:[0,1]
  v_pk_mul_f32 v[108:109], v[108:109], v[180:181] neg_lo:[0,1] neg_hi:[0,1]
  v_pk_mul_f32 v[110:111], v[110:111], v[182:183] neg_lo:[0,1] neg_hi:[0,1]
  v_exp_f32 v104, v104
  v_exp_f32 v105, v105
  v_exp_f32 v106, v106
  v_exp_f32 v107, v107
  v_exp_f32 v108, v108
  v_exp_f32 v109, v109
  v_exp_f32 v110, v110
  v_exp_f32 v111, v111
  v_pk_fma_f32 v[104:105], v[104:105], v[4:5], v[4:5] op_sel:[0,1,1] op_sel_hi:[1,1,1]
  v_pk_fma_f32 v[106:107], v[106:107], v[4:5], v[4:5] op_sel:[0,1,1] op_sel_hi:[1,1,1]
  v_pk_fma_f32 v[108:109], v[108:109], v[4:5], v[4:5] op_sel:[0,1,1] op_sel_hi:[1,1,1]
  v_pk_fma_f32 v[110:111], v[110:111], v[4:5], v[4:5] op_sel:[0,1,1] op_sel_hi:[1,1,1]
  v_rcp_f32 v104, v104
  v_rcp_f32 v105, v105
  v_rcp_f32 v106, v106
  v_rcp_f32 v107, v107
  v_rcp_f32 v108, v108
  v_rcp_f32 v109, v109
  v_rcp_f32 v110, v110
  v_rcp_f32 v111, v111
  v_pk_mul_f32 v[164:165], v[164:165], v[104:105]
  v_pk_mul_f32 v[166:167], v[166:167], v[106:107]
  v_pk_mul_f32 v[180:181], v[180:181], v[108:109]
  v_pk_mul_f32 v[182:183], v[182:183], v[110:111]
  v_cvt_pk_bf16_f32 v120, v164, v165
  v_cvt_pk_bf16_f32 v121, v166, v167
  v_cvt_pk_bf16_f32 v122, v180, v181
  v_cvt_pk_bf16_f32 v123, v182, v183
  buffer_store_dwordx4 v[120:123], v0, s[40:43], s6 offen offset:2048 sc0 sc1
  ds_write_b128 v0, v[120:123] offset:18432
  s_add_u32 s6, s6, 0x20000
  v_pk_fma_f32 v[168:169], v[48:49], v[100:101], v[168:169] op_sel:[0,1,0] op_sel_hi:[1,1,1] neg_lo:[0,1,0] neg_hi:[0,1,0]
  v_pk_fma_f32 v[170:171], v[50:51], v[100:101], v[170:171] op_sel:[0,1,0] op_sel_hi:[1,1,1] neg_lo:[0,1,0] neg_hi:[0,1,0]
  v_pk_fma_f32 v[184:185], v[56:57], v[100:101], v[184:185] op_sel:[0,1,0] op_sel_hi:[1,1,1] neg_lo:[0,1,0] neg_hi:[0,1,0]
  v_pk_fma_f32 v[186:187], v[58:59], v[100:101], v[186:187] op_sel:[0,1,0] op_sel_hi:[1,1,1] neg_lo:[0,1,0] neg_hi:[0,1,0]
  v_pk_fma_f32 v[168:169], v[168:169], v[100:101], v[52:53] op_sel:[0,0,0] op_sel_hi:[1,0,1]
  v_pk_fma_f32 v[170:171], v[170:171], v[100:101], v[54:55] op_sel:[0,0,0] op_sel_hi:[1,0,1]
  v_pk_fma_f32 v[184:185], v[184:185], v[100:101], v[60:61] op_sel:[0,0,0] op_sel_hi:[1,0,1]
  v_pk_fma_f32 v[186:187], v[186:187], v[100:101], v[62:63] op_sel:[0,0,0] op_sel_hi:[1,0,1]
  v_pk_fma_f32 v[104:105], v[168:169], v[168:169], v[4:5] op_sel_hi:[1,1,0]
  v_pk_fma_f32 v[106:107], v[170:171], v[170:171], v[4:5] op_sel_hi:[1,1,0]
  v_pk_fma_f32 v[108:109], v[184:185], v[184:185], v[4:5] op_sel_hi:[1,1,0]
  v_pk_fma_f32 v[110:111], v[186:187], v[186:187], v[4:5] op_sel_hi:[1,1,0]
  v_pk_mul_f32 v[104:105], v[104:105], v[168:169] neg_lo:[0,1] neg_hi:[0,1]
  v_pk_mul_f32 v[106:107], v[106:107], v[170:171] neg_lo:[0,1] neg_hi:[0,1]
  v_pk_mul_f32 v[108:109], v[108:109], v[184:185] neg_lo:[0,1] neg_hi:[0,1]
  v_pk_mul_f32 v[110:111], v[110:111], v[186:187] neg_lo:[0,1] neg_hi:[0,1]
  v_exp_f32 v104, v104
  v_exp_f32 v105, v105
  v_exp_f32 v106, v106
  v_exp_f32 v107, v107
  v_exp_f32 v108, v108
  v_exp_f32 v109, v109
  v_exp_f32 v110, v110
  v_exp_f32 v111, v111
  v_pk_fma_f32 v[104:105], v[104:105], v[4:5], v[4:5] op_sel:[0,1,1] op_sel_hi:[1,1,1]
  v_pk_fma_f32 v[106:107], v[106:107], v[4:5], v[4:5] op_sel:[0,1,1] op_sel_hi:[1,1,1]
  v_pk_fma_f32 v[108:109], v[108:109], v[4:5], v[4:5] op_sel:[0,1,1] op_sel_hi:[1,1,1]
  v_pk_fma_f32 v[110:111], v[110:111], v[4:5], v[4:5] op_sel:[0,1,1] op_sel_hi:[1,1,1]
  v_rcp_f32 v104, v104
  v_rcp_f32 v105, v105
  v_rcp_f32 v106, v106
  v_rcp_f32 v107, v107
  v_rcp_f32 v108, v108
  v_rcp_f32 v109, v109
  v_rcp_f32 v110, v110
  v_rcp_f32 v111, v111
  v_pk_mul_f32 v[168:169], v[168:169], v[104:105]
  v_pk_mul_f32 v[170:171], v[170:171], v[106:107]
  v_pk_mul_f32 v[184:185], v[184:185], v[108:109]
  v_pk_mul_f32 v[186:187], v[186:187], v[110:111]
  v_cvt_pk_bf16_f32 v116, v168, v169
  v_cvt_pk_bf16_f32 v117, v170, v171
  v_cvt_pk_bf16_f32 v118, v184, v185
  v_cvt_pk_bf16_f32 v119, v186, v187
  buffer_store_dwordx4 v[116:119], v0, s[40:43], s7 offen offset:0 sc0 sc1
  ds_write_b128 v0, v[116:119] offset:20480
  v_pk_fma_f32 v[172:173], v[48:49], v[102:103], v[172:173] op_sel:[0,1,0] op_sel_hi:[1,1,1] neg_lo:[0,1,0] neg_hi:[0,1,0]
  v_pk_fma_f32 v[174:175], v[50:51], v[102:103], v[174:175] op_sel:[0,1,0] op_sel_hi:[1,1,1] neg_lo:[0,1,0] neg_hi:[0,1,0]
  v_pk_fma_f32 v[188:189], v[56:57], v[102:103], v[188:189] op_sel:[0,1,0] op_sel_hi:[1,1,1] neg_lo:[0,1,0] neg_hi:[0,1,0]
  v_pk_fma_f32 v[190:191], v[58:59], v[102:103], v[190:191] op_sel:[0,1,0] op_sel_hi:[1,1,1] neg_lo:[0,1,0] neg_hi:[0,1,0]
  v_pk_fma_f32 v[172:173], v[172:173], v[102:103], v[52:53] op_sel:[0,0,0] op_sel_hi:[1,0,1]
  v_pk_fma_f32 v[174:175], v[174:175], v[102:103], v[54:55] op_sel:[0,0,0] op_sel_hi:[1,0,1]
  v_pk_fma_f32 v[188:189], v[188:189], v[102:103], v[60:61] op_sel:[0,0,0] op_sel_hi:[1,0,1]
  v_pk_fma_f32 v[190:191], v[190:191], v[102:103], v[62:63] op_sel:[0,0,0] op_sel_hi:[1,0,1]
  v_pk_fma_f32 v[104:105], v[172:173], v[172:173], v[4:5] op_sel_hi:[1,1,0]
  v_pk_fma_f32 v[106:107], v[174:175], v[174:175], v[4:5] op_sel_hi:[1,1,0]
  v_pk_fma_f32 v[108:109], v[188:189], v[188:189], v[4:5] op_sel_hi:[1,1,0]
  v_pk_fma_f32 v[110:111], v[190:191], v[190:191], v[4:5] op_sel_hi:[1,1,0]
  v_pk_mul_f32 v[104:105], v[104:105], v[172:173] neg_lo:[0,1] neg_hi:[0,1]
  v_pk_mul_f32 v[106:107], v[106:107], v[174:175] neg_lo:[0,1] neg_hi:[0,1]
  v_pk_mul_f32 v[108:109], v[108:109], v[188:189] neg_lo:[0,1] neg_hi:[0,1]
  v_pk_mul_f32 v[110:111], v[110:111], v[190:191] neg_lo:[0,1] neg_hi:[0,1]
  v_exp_f32 v104, v104
  v_exp_f32 v105, v105
  v_exp_f32 v106, v106
  v_exp_f32 v107, v107
  v_exp_f32 v108, v108
  v_exp_f32 v109, v109
  v_exp_f32 v110, v110
  v_exp_f32 v111, v111
  v_pk_fma_f32 v[104:105], v[104:105], v[4:5], v[4:5] op_sel:[0,1,1] op_sel_hi:[1,1,1]
  v_pk_fma_f32 v[106:107], v[106:107], v[4:5], v[4:5] op_sel:[0,1,1] op_sel_hi:[1,1,1]
  v_pk_fma_f32 v[108:109], v[108:109], v[4:5], v[4:5] op_sel:[0,1,1] op_sel_hi:[1,1,1]
  v_pk_fma_f32 v[110:111], v[110:111], v[4:5], v[4:5] op_sel:[0,1,1] op_sel_hi:[1,1,1]
  v_rcp_f32 v104, v104
  v_rcp_f32 v105, v105
  v_rcp_f32 v106, v106
  v_rcp_f32 v107, v107
  v_rcp_f32 v108, v108
  v_rcp_f32 v109, v109
  v_rcp_f32 v110, v110
  v_rcp_f32 v111, v111
  v_pk_mul_f32 v[172:173], v[172:173], v[104:105]
  v_pk_mul_f32 v[174:175], v[174:175], v[106:107]
  v_pk_mul_f32 v[188:189], v[188:189], v[108:109]
  v_pk_mul_f32 v[190:191], v[190:191], v[110:111]
  v_cvt_pk_bf16_f32 v120, v172, v173
  v_cvt_pk_bf16_f32 v121, v174, v175
  v_cvt_pk_bf16_f32 v122, v188, v189
  v_cvt_pk_bf16_f32 v123, v190, v191
  buffer_store_dwordx4 v[120:123], v0, s[40:43], s7 offen offset:2048 sc0 sc1
  ds_write_b128 v0, v[120:123] offset:22528
  s_add_u32 s7, s7, 0x20000
  v_pk_fma_f32 v[192:193], v[64:65], v[96:97], v[192:193] op_sel:[0,1,0] op_sel_hi:[1,1,1] neg_lo:[0,1,0] neg_hi:[0,1,0]
  v_pk_fma_f32 v[194:195], v[66:67], v[96:97], v[194:195] op_sel:[0,1,0] op_sel_hi:[1,1,1] neg_lo:[0,1,0] neg_hi:[0,1,0]
  v_pk_fma_f32 v[208:209], v[72:73], v[96:97], v[208:209] op_sel:[0,1,0] op_sel_hi:[1,1,1] neg_lo:[0,1,0] neg_hi:[0,1,0]
  v_pk_fma_f32 v[210:211], v[74:75], v[96:97], v[210:211] op_sel:[0,1,0] op_sel_hi:[1,1,1] neg_lo:[0,1,0] neg_hi:[0,1,0]
  v_pk_fma_f32 v[192:193], v[192:193], v[96:97], v[68:69] op_sel:[0,0,0] op_sel_hi:[1,0,1]
  v_pk_fma_f32 v[194:195], v[194:195], v[96:97], v[70:71] op_sel:[0,0,0] op_sel_hi:[1,0,1]
  v_pk_fma_f32 v[208:209], v[208:209], v[96:97], v[76:77] op_sel:[0,0,0] op_sel_hi:[1,0,1]
  v_pk_fma_f32 v[210:211], v[210:211], v[96:97], v[78:79] op_sel:[0,0,0] op_sel_hi:[1,0,1]
  v_pk_fma_f32 v[104:105], v[192:193], v[192:193], v[4:5] op_sel_hi:[1,1,0]
  v_pk_fma_f32 v[106:107], v[194:195], v[194:195], v[4:5] op_sel_hi:[1,1,0]
  v_pk_fma_f32 v[108:109], v[208:209], v[208:209], v[4:5] op_sel_hi:[1,1,0]
  v_pk_fma_f32 v[110:111], v[210:211], v[210:211], v[4:5] op_sel_hi:[1,1,0]
  v_pk_mul_f32 v[104:105], v[104:105], v[192:193] neg_lo:[0,1] neg_hi:[0,1]
  v_pk_mul_f32 v[106:107], v[106:107], v[194:195] neg_lo:[0,1] neg_hi:[0,1]
  v_pk_mul_f32 v[108:109], v[108:109], v[208:209] neg_lo:[0,1] neg_hi:[0,1]
  v_pk_mul_f32 v[110:111], v[110:111], v[210:211] neg_lo:[0,1] neg_hi:[0,1]
  v_exp_f32 v104, v104
  v_exp_f32 v105, v105
  v_exp_f32 v106, v106
  v_exp_f32 v107, v107
  v_exp_f32 v108, v108
  v_exp_f32 v109, v109
  v_exp_f32 v110, v110
  v_exp_f32 v111, v111
  v_pk_fma_f32 v[104:105], v[104:105], v[4:5], v[4:5] op_sel:[0,1,1] op_sel_hi:[1,1,1]
  v_pk_fma_f32 v[106:107], v[106:107], v[4:5], v[4:5] op_sel:[0,1,1] op_sel_hi:[1,1,1]
  v_pk_fma_f32 v[108:109], v[108:109], v[4:5], v[4:5] op_sel:[0,1,1] op_sel_hi:[1,1,1]
  v_pk_fma_f32 v[110:111], v[110:111], v[4:5], v[4:5] op_sel:[0,1,1] op_sel_hi:[1,1,1]
  v_rcp_f32 v104, v104
  v_rcp_f32 v105, v105
  v_rcp_f32 v106, v106
  v_rcp_f32 v107, v107
  v_rcp_f32 v108, v108
  v_rcp_f32 v109, v109
  v_rcp_f32 v110, v110
  v_rcp_f32 v111, v111
  v_pk_mul_f32 v[192:193], v[192:193], v[104:105]
  v_pk_mul_f32 v[194:195], v[194:195], v[106:107]
  v_pk_mul_f32 v[208:209], v[208:209], v[108:109]
  v_pk_mul_f32 v[210:211], v[210:211], v[110:111]
  v_cvt_pk_bf16_f32 v116, v192, v193
  v_cvt_pk_bf16_f32 v117, v194, v195
  v_cvt_pk_bf16_f32 v118, v208, v209
  v_cvt_pk_bf16_f32 v119, v210, v211
  buffer_store_dwordx4 v[116:119], v0, s[40:43], s6 offen offset:0 sc0 sc1
  ds_write_b128 v0, v[116:119] offset:32768
  v_pk_fma_f32 v[196:197], v[64:65], v[98:99], v[196:197] op_sel:[0,1,0] op_sel_hi:[1,1,1] neg_lo:[0,1,0] neg_hi:[0,1,0]
  v_pk_fma_f32 v[198:199], v[66:67], v[98:99], v[198:199] op_sel:[0,1,0] op_sel_hi:[1,1,1] neg_lo:[0,1,0] neg_hi:[0,1,0]
  v_pk_fma_f32 v[212:213], v[72:73], v[98:99], v[212:213] op_sel:[0,1,0] op_sel_hi:[1,1,1] neg_lo:[0,1,0] neg_hi:[0,1,0]
  v_pk_fma_f32 v[214:215], v[74:75], v[98:99], v[214:215] op_sel:[0,1,0] op_sel_hi:[1,1,1] neg_lo:[0,1,0] neg_hi:[0,1,0]
  v_pk_fma_f32 v[196:197], v[196:197], v[98:99], v[68:69] op_sel:[0,0,0] op_sel_hi:[1,0,1]
  v_pk_fma_f32 v[198:199], v[198:199], v[98:99], v[70:71] op_sel:[0,0,0] op_sel_hi:[1,0,1]
  v_pk_fma_f32 v[212:213], v[212:213], v[98:99], v[76:77] op_sel:[0,0,0] op_sel_hi:[1,0,1]
  v_pk_fma_f32 v[214:215], v[214:215], v[98:99], v[78:79] op_sel:[0,0,0] op_sel_hi:[1,0,1]
  v_pk_fma_f32 v[104:105], v[196:197], v[196:197], v[4:5] op_sel_hi:[1,1,0]
  v_pk_fma_f32 v[106:107], v[198:199], v[198:199], v[4:5] op_sel_hi:[1,1,0]
  v_pk_fma_f32 v[108:109], v[212:213], v[212:213], v[4:5] op_sel_hi:[1,1,0]
  v_pk_fma_f32 v[110:111], v[214:215], v[214:215], v[4:5] op_sel_hi:[1,1,0]
  v_pk_mul_f32 v[104:105], v[104:105], v[196:197] neg_lo:[0,1] neg_hi:[0,1]
  v_pk_mul_f32 v[106:107], v[106:107], v[198:199] neg_lo:[0,1] neg_hi:[0,1]
  v_pk_mul_f32 v[108:109], v[108:109], v[212:213] neg_lo:[0,1] neg_hi:[0,1]
  v_pk_mul_f32 v[110:111], v[110:111], v[214:215] neg_lo:[0,1] neg_hi:[0,1]
  v_exp_f32 v104, v104
  v_exp_f32 v105, v105
  v_exp_f32 v106, v106
  v_exp_f32 v107, v107
  v_exp_f32 v108, v108
  v_exp_f32 v109, v109
  v_exp_f32 v110, v110
  v_exp_f32 v111, v111
  v_pk_fma_f32 v[104:105], v[104:105], v[4:5], v[4:5] op_sel:[0,1,1] op_sel_hi:[1,1,1]
  v_pk_fma_f32 v[106:107], v[106:107], v[4:5], v[4:5] op_sel:[0,1,1] op_sel_hi:[1,1,1]
  v_pk_fma_f32 v[108:109], v[108:109], v[4:5], v[4:5] op_sel:[0,1,1] op_sel_hi:[1,1,1]
  v_pk_fma_f32 v[110:111], v[110:111], v[4:5], v[4:5] op_sel:[0,1,1] op_sel_hi:[1,1,1]
  v_rcp_f32 v104, v104
  v_rcp_f32 v105, v105
  v_rcp_f32 v106, v106
  v_rcp_f32 v107, v107
  v_rcp_f32 v108, v108
  v_rcp_f32 v109, v109
  v_rcp_f32 v110, v110
  v_rcp_f32 v111, v111
  v_pk_mul_f32 v[196:197], v[196:197], v[104:105]
  v_pk_mul_f32 v[198:199], v[198:199], v[106:107]
  v_pk_mul_f32 v[212:213], v[212:213], v[108:109]
  v_pk_mul_f32 v[214:215], v[214:215], v[110:111]
  v_cvt_pk_bf16_f32 v120, v196, v197
  v_cvt_pk_bf16_f32 v121, v198, v199
  v_cvt_pk_bf16_f32 v122, v212, v213
  v_cvt_pk_bf16_f32 v123, v214, v215
  buffer_store_dwordx4 v[120:123], v0, s[40:43], s6 offen offset:2048 sc0 sc1
  ds_write_b128 v0, v[120:123] offset:34816
  s_mov_b64 exec, 1
  ds_add_u32 v28, v27 offset:4
  s_mov_b64 exec, -1
  v_pk_fma_f32 v[200:201], v[64:65], v[100:101], v[200:201] op_sel:[0,1,0] op_sel_hi:[1,1,1] neg_lo:[0,1,0] neg_hi:[0,1,0]
  v_pk_fma_f32 v[202:203], v[66:67], v[100:101], v[202:203] op_sel:[0,1,0] op_sel_hi:[1,1,1] neg_lo:[0,1,0] neg_hi:[0,1,0]
  v_pk_fma_f32 v[216:217], v[72:73], v[100:101], v[216:217] op_sel:[0,1,0] op_sel_hi:[1,1,1] neg_lo:[0,1,0] neg_hi:[0,1,0]
  v_pk_fma_f32 v[218:219], v[74:75], v[100:101], v[218:219] op_sel:[0,1,0] op_sel_hi:[1,1,1] neg_lo:[0,1,0] neg_hi:[0,1,0]
  v_pk_fma_f32 v[200:201], v[200:201], v[100:101], v[68:69] op_sel:[0,0,0] op_sel_hi:[1,0,1]
  v_pk_fma_f32 v[202:203], v[202:203], v[100:101], v[70:71] op_sel:[0,0,0] op_sel_hi:[1,0,1]
  v_pk_fma_f32 v[216:217], v[216:217], v[100:101], v[76:77] op_sel:[0,0,0] op_sel_hi:[1,0,1]
  v_pk_fma_f32 v[218:219], v[218:219], v[100:101], v[78:79] op_sel:[0,0,0] op_sel_hi:[1,0,1]
  v_pk_fma_f32 v[104:105], v[200:201], v[200:201], v[4:5] op_sel_hi:[1,1,0]
  v_pk_fma_f32 v[106:107], v[202:203], v[202:203], v[4:5] op_sel_hi:[1,1,0]
  v_pk_fma_f32 v[108:109], v[216:217], v[216:217], v[4:5] op_sel_hi:[1,1,0]
  v_pk_fma_f32 v[110:111], v[218:219], v[218:219], v[4:5] op_sel_hi:[1,1,0]
  v_pk_mul_f32 v[104:105], v[104:105], v[200:201] neg_lo:[0,1] neg_hi:[0,1]
  v_pk_mul_f32 v[106:107], v[106:107], v[202:203] neg_lo:[0,1] neg_hi:[0,1]
  v_pk_mul_f32 v[108:109], v[108:109], v[216:217] neg_lo:[0,1] neg_hi:[0,1]
  v_pk_mul_f32 v[110:111], v[110:111], v[218:219] neg_lo:[0,1] neg_hi:[0,1]
  v_exp_f32 v104, v104
  v_exp_f32 v105, v105
  v_exp_f32 v106, v106
  v_exp_f32 v107, v107
  v_exp_f32 v108, v108
  v_exp_f32 v109, v109
  v_exp_f32 v110, v110
  v_exp_f32 v111, v111
  v_pk_fma_f32 v[104:105], v[104:105], v[4:5], v[4:5] op_sel:[0,1,1] op_sel_hi:[1,1,1]
  v_pk_fma_f32 v[106:107], v[106:107], v[4:5], v[4:5] op_sel:[0,1,1] op_sel_hi:[1,1,1]
  v_pk_fma_f32 v[108:109], v[108:109], v[4:5], v[4:5] op_sel:[0,1,1] op_sel_hi:[1,1,1]
  v_pk_fma_f32 v[110:111], v[110:111], v[4:5], v[4:5] op_sel:[0,1,1] op_sel_hi:[1,1,1]
  v_rcp_f32 v104, v104
  v_rcp_f32 v105, v105
  v_rcp_f32 v106, v106
  v_rcp_f32 v107, v107
  v_rcp_f32 v108, v108
  v_rcp_f32 v109, v109
  v_rcp_f32 v110, v110
  v_rcp_f32 v111, v111
  v_pk_mul_f32 v[200:201], v[200:201], v[104:105]
  v_pk_mul_f32 v[202:203], v[202:203], v[106:107]
  v_pk_mul_f32 v[216:217], v[216:217], v[108:109]
  v_pk_mul_f32 v[218:219], v[218:219], v[110:111]
  v_cvt_pk_bf16_f32 v116, v200, v201
  v_cvt_pk_bf16_f32 v117, v202, v203
  v_cvt_pk_bf16_f32 v118, v216, v217
  v_cvt_pk_bf16_f32 v119, v218, v219
  buffer_store_dwordx4 v[116:119], v0, s[40:43], s7 offen offset:0 sc0 sc1
  ds_write_b128 v0, v[116:119] offset:36864
  s_lshl_b32 s5, s86, Lz1-Lz0+7
  s_add_u32 s5, s5, 156160
  v_add_u32_e64 v3, s5, v29
  ds_read_b128 v[232:235], v3
  ds_read_b128 v[236:239], v3 offset:64
  v_pk_fma_f32 v[204:205], v[64:65], v[102:103], v[204:205] op_sel:[0,1,0] op_sel_hi:[1,1,1] neg_lo:[0,1,0] neg_hi:[0,1,0]
  v_pk_fma_f32 v[206:207], v[66:67], v[102:103], v[206:207] op_sel:[0,1,0] op_sel_hi:[1,1,1] neg_lo:[0,1,0] neg_hi:[0,1,0]
  v_pk_fma_f32 v[220:221], v[72:73], v[102:103], v[220:221] op_sel:[0,1,0] op_sel_hi:[1,1,1] neg_lo:[0,1,0] neg_hi:[0,1,0]
  v_pk_fma_f32 v[222:223], v[74:75], v[102:103], v[222:223] op_sel:[0,1,0] op_sel_hi:[1,1,1] neg_lo:[0,1,0] neg_hi:[0,1,0]
  v_pk_fma_f32 v[204:205], v[204:205], v[102:103], v[68:69] op_sel:[0,0,0] op_sel_hi:[1,0,1]
  v_pk_fma_f32 v[206:207], v[206:207], v[102:103], v[70:71] op_sel:[0,0,0] op_sel_hi:[1,0,1]
  v_pk_fma_f32 v[220:221], v[220:221], v[102:103], v[76:77] op_sel:[0,0,0] op_sel_hi:[1,0,1]
  v_pk_fma_f32 v[222:223], v[222:223], v[102:103], v[78:79] op_sel:[0,0,0] op_sel_hi:[1,0,1]
  v_pk_fma_f32 v[104:105], v[204:205], v[204:205], v[4:5] op_sel_hi:[1,1,0]
  v_pk_fma_f32 v[106:107], v[206:207], v[206:207], v[4:5] op_sel_hi:[1,1,0]
  v_pk_fma_f32 v[108:109], v[220:221], v[220:221], v[4:5] op_sel_hi:[1,1,0]
  v_pk_fma_f32 v[110:111], v[222:223], v[222:223], v[4:5] op_sel_hi:[1,1,0]
  v_pk_mul_f32 v[104:105], v[104:105], v[204:205] neg_lo:[0,1] neg_hi:[0,1]
  v_pk_mul_f32 v[106:107], v[106:107], v[206:207] neg_lo:[0,1] neg_hi:[0,1]
  v_pk_mul_f32 v[108:109], v[108:109], v[220:221] neg_lo:[0,1] neg_hi:[0,1]
  v_pk_mul_f32 v[110:111], v[110:111], v[222:223] neg_lo:[0,1] neg_hi:[0,1]
  v_exp_f32 v104, v104
  v_exp_f32 v105, v105
  v_exp_f32 v106, v106
  v_exp_f32 v107, v107
  v_exp_f32 v108, v108
  v_exp_f32 v109, v109
  v_exp_f32 v110, v110
  v_exp_f32 v111, v111
  v_pk_fma_f32 v[104:105], v[104:105], v[4:5], v[4:5] op_sel:[0,1,1] op_sel_hi:[1,1,1]
  v_pk_fma_f32 v[106:107], v[106:107], v[4:5], v[4:5] op_sel:[0,1,1] op_sel_hi:[1,1,1]
  v_pk_fma_f32 v[108:109], v[108:109], v[4:5], v[4:5] op_sel:[0,1,1] op_sel_hi:[1,1,1]
  v_pk_fma_f32 v[110:111], v[110:111], v[4:5], v[4:5] op_sel:[0,1,1] op_sel_hi:[1,1,1]
  v_rcp_f32 v104, v104
  v_rcp_f32 v105, v105
  v_rcp_f32 v106, v106
  v_rcp_f32 v107, v107
  v_rcp_f32 v108, v108
  v_rcp_f32 v109, v109
  v_rcp_f32 v110, v110
  v_rcp_f32 v111, v111
  v_pk_mul_f32 v[204:205], v[204:205], v[104:105]
  v_pk_mul_f32 v[206:207], v[206:207], v[106:107]
  v_pk_mul_f32 v[220:221], v[220:221], v[108:109]
  v_pk_mul_f32 v[222:223], v[222:223], v[110:111]
  v_cvt_pk_bf16_f32 v120, v204, v205
  v_cvt_pk_bf16_f32 v121, v206, v207
  v_cvt_pk_bf16_f32 v122, v220, v221
  v_cvt_pk_bf16_f32 v123, v222, v223
  buffer_store_dwordx4 v[120:123], v0, s[40:43], s7 offen offset:2048 sc0 sc1
  ds_write_b128 v0, v[120:123] offset:38912
  s_mov_b32 s16, Lz1-Lz0+0
  s_mov_b32 s17, 16384
  s_mov_b32 s18, 0xffff4000
  s_mov_b32 s19, 49152
  s_mov_b32 s20, 16384
  s_mov_b32 s21, 0xffff0000
  s_mul_i32 s4, s85, 8192
  v_add_u32_e64 v4, s4, v11
  v_add_u32 v5, 1024, v4
  s_lshl_b32 s4, s86, 1
  v_xor_b32 v2, s4, v26
  v_lshl_add_u32 v6, v2, 5, v25
  v_add_u32 v6, s19, v6
  s_add_u32 s4, s4, 1
  v_xor_b32_e64 v2, s4, v26
  v_lshl_add_u32 v7, v2, 5, v25
  v_add_u32 v7, s19, v7
  s_mov_b32 s22, 12
  s_waitcnt lgkmcnt(0)
  s_barrier
  ds_read_b64_tr_b16 v[48:49], v6 offset:0
  v_and_b32 v2, 15, v1
  v_lshrrev_b32 v3, 2, v29
  ds_read_b64_tr_b16 v[50:51], v6 offset:2048
  v_sub_u32 v2, v2, v3
  v_mov_b64 v[224:225], 0
  ds_read_b128 v[32:35], v4 offset:0
  v_lshlrev_b32_e64 v2, 4, v2
  v_mov_b32 v226, 0x3f80
  ds_read_b128 v[36:39], v4 offset:2048
  v_cmp_gt_u32 vcc, 64, v2
  v_mov_b32 v227, 0
  ds_read_b128 v[40:43], v4 offset:4096
  v_cndmask_b32 v226, 0, v226, vcc
  v_mov_b64 v[228:229], 0
  ds_read_b128 v[44:47], v4 offset:6144
  v_lshlrev_b64 v[226:227], v2, v[226:227]
  v_mov_b64_e64 v[160:161], 0
  ds_read_b64_tr_b16 v[52:53], v7 offset:0
  v_mov_b64 v[162:163], 0
  v_mov_b64 v[164:165], 0
  ds_read_b64_tr_b16 v[54:55], v7 offset:2048
  v_mov_b64 v[166:167], 0
  v_mov_b64 v[168:169], 0
  ds_read_b64_tr_b16 v[56:57], v6 offset:8192
  v_mov_b64 v[170:171], 0
  v_mov_b64 v[172:173], 0
  ds_read_b64_tr_b16 v[58:59], v6 offset:10240
  v_mov_b64 v[174:175], 0
  v_mov_b64 v[176:177], 0
  ds_read_b64_tr_b16 v[60:61], v7 offset:8192
  v_mov_b64 v[178:179], 0
  v_mov_b64 v[180:181], 0
  ds_read_b64_tr_b16 v[62:63], v7 offset:10240
  v_mov_b64 v[182:183], 0
  v_mov_b64 v[184:185], 0
  ds_read_b64_tr_b16 v[80:81], v6 offset:4096
  v_mov_b64_e64 v[186:187], 0
  v_mov_b64 v[188:189], 0
  s_waitcnt lgkmcnt(4)
  ds_read_b64_tr_b16 v[82:83], v6 offset:6144
  v_mov_b64_e64 v[190:191], 0
  v_mfma_f32_16x16x32_bf16 v[128:131], v[226:229], v[240:243], v[232:235]
  ds_read_b128 v[64:67], v5 offset:0
  s_lshl_b32 s4, s76, 4
  s_add_u32 s4, s4, s78
  ds_read_b128 v[68:71], v5 offset:2048
  v_mfma_f32_16x16x32_bf16 v[132:135], v[224:227], v[240:243], v[236:239]
  s_lshl_b32 s8, s4, Lz1-Lz0+14
  ds_read_b128 v[72:75], v5 offset:4096
  s_xor_b32 s6, s8, 16384
  v_mfma_f32_16x16x32_bf16 v[136:139], v[226:229], v[244:247], v[232:235]
  ds_read_b128 v[76:79], v5 offset:6144
  s_add_u32 s8, s8, 7340032
  s_add_u32 s6, s6, 7340032
  ds_read_b64_tr_b16 v[84:85], v7 offset:4096
  v_mfma_f32_16x16x32_bf16 v[140:143], v[224:227], v[244:247], v[236:239]
  s_add_u32 s7, s6, 4096
  ds_read_b64_tr_b16 v[86:87], v7 offset:6144
  s_add_u32 s9, s8, 4096
  v_mfma_f32_16x16x32_bf16 v[144:147], v[226:229], v[248:251], v[232:235]
  ds_read_b64_tr_b16 v[88:89], v6 offset:12288
  s_lshl_b32 s4, s81, 7
  s_add_u32 s4, s4, s87
  ds_read_b64_tr_b16 v[90:91], v6 offset:14336
  v_mfma_f32_16x16x32_bf16 v[148:151], v[224:227], v[248:251], v[236:239]
  s_add_u32 s4, s4, Lz1-Lz0+12
  ds_read_b64_tr_b16 v[92:93], v7 offset:12288
  s_lshl_b32 s13, s84, Lz1-Lz0+1
  v_mfma_f32_16x16x32_bf16 v[152:155], v[226:229], v[252:255], v[232:235]
  ds_read_b64_tr_b16 v[94:95], v7 offset:14336
  s_xor_b32 s14, s13, 32768
  s_nop 0
  s_add_u32 s13, s13, s4
  v_mfma_f32_16x16x32_bf16 v[156:159], v[224:227], v[252:255], v[236:239]
  s_add_u32 s14, s14, s4
  s_add_u32 s16, s16, s17
  s_cmp_eq_u32 s16, 65536
  s_cselect_b32 s23, s18, s17
  s_cselect_b32 s16, 0, s16
  v_add_u32_e64 v4, s23, v4
  v_add_u32 v5, s23, v5
  s_add_u32 s19, s19, s20
  s_cmp_eq_u32 s19, 81920
  s_cselect_b32 s23, s21, s20
  s_cselect_b32 s19, 0, s19
  v_add_u32 v6, s23, v6
  v_add_u32 v7, s23, v7
  s_waitcnt lgkmcnt(0)
Lk_29:
  s_barrier
  v_mfma_f32_16x16x32_bf16 v[128:131], v[48:51], v[32:35], v[128:131]
  ds_read_b64_tr_b16 v[112:113], v6 offset:0
  v_mfma_f32_16x16x32_bf16 v[128:131], v[80:83], v[64:67], v[128:131]
  ds_read_b64_tr_b16 v[114:115], v6 offset:2048
  v_mfma_f32_16x16x32_bf16 v[136:139], v[80:83], v[68:71], v[136:139]
  ds_read_b128 v[96:99], v4 offset:0
  v_mfma_f32_16x16x32_bf16 v[136:139], v[48:51], v[36:39], v[136:139]
  ds_read_b128 v[100:103], v4 offset:2048
  v_mfma_f32_16x16x32_bf16 v[144:147], v[48:51], v[40:43], v[144:147]
  ds_read_b128 v[104:107], v4 offset:4096
  v_mfma_f32_16x16x32_bf16 v[144:147], v[80:83], v[72:75], v[144:147]
  ds_read_b128 v[108:111], v4 offset:6144
  v_mfma_f32_16x16x32_bf16 v[152:155], v[80:83], v[76:79], v[152:155]
  ds_read_b64_tr_b16 v[116:117], v7 offset:0
  v_mfma_f32_16x16x32_bf16 v[152:155], v[48:51], v[44:47], v[152:155]
  ds_read_b64_tr_b16 v[118:119], v7 offset:2048
  v_mfma_f32_16x16x32_bf16 v[156:159], v[52:55], v[44:47], v[156:159]
  ds_read_b64_tr_b16 v[120:121], v6 offset:8192
  v_mfma_f32_16x16x32_bf16 v[156:159], v[84:87], v[76:79], v[156:159]
  ds_read_b64_tr_b16 v[122:123], v6 offset:10240
  v_mfma_f32_16x16x32_bf16 v[148:151], v[84:87], v[72:75], v[148:151]
  ds_read_b64_tr_b16 v[124:125], v7 offset:8192
  v_mfma_f32_16x16x32_bf16 v[148:151], v[52:55], v[40:43], v[148:151]
  ds_read_b64_tr_b16 v[126:127], v7 offset:10240
  v_mfma_f32_16x16x32_bf16 v[140:143], v[52:55], v[36:39], v[140:143]
  ds_read_b64_tr_b16 v[208:209], v6 offset:4096
  v_mfma_f32_16x16x32_bf16 v[140:143], v[84:87], v[68:71], v[140:143]
  ds_read_b64_tr_b16 v[210:211], v6 offset:6144
  v_mfma_f32_16x16x32_bf16 v[132:135], v[84:87], v[64:67], v[132:135]
  ds_read_b128 v[192:195], v5 offset:0
  v_mfma_f32_16x16x32_bf16 v[132:135], v[52:55], v[32:35], v[132:135]
  ds_read_b128 v[196:199], v5 offset:2048
  v_mfma_f32_16x16x32_bf16 v[160:163], v[56:59], v[32:35], v[160:163]
  ds_read_b128 v[200:203], v5 offset:4096
  v_mfma_f32_16x16x32_bf16 v[160:163], v[88:91], v[64:67], v[160:163]
  ds_read_b128 v[204:207], v5 offset:6144
  v_mfma_f32_16x16x32_bf16 v[168:171], v[88:91], v[68:71], v[168:171]
  ds_read_b64_tr_b16 v[212:213], v7 offset:4096
  v_mfma_f32_16x16x32_bf16 v[168:171], v[56:59], v[36:39], v[168:171]
  ds_read_b64_tr_b16 v[214:215], v7 offset:6144
  v_mfma_f32_16x16x32_bf16 v[176:179], v[56:59], v[40:43], v[176:179]
  ds_read_b64_tr_b16 v[216:217], v6 offset:12288
  v_mfma_f32_16x16x32_bf16 v[176:179], v[88:91], v[72:75], v[176:179]
  ds_read_b64_tr_b16 v[218:219], v6 offset:14336
  v_mfma_f32_16x16x32_bf16 v[184:187], v[88:91], v[76:79], v[184:187]
  ds_read_b64_tr_b16 v[220:221], v7 offset:12288
  v_mfma_f32_16x16x32_bf16 v[184:187], v[56:59], v[44:47], v[184:187]
  ds_read_b64_tr_b16 v[222:223], v7 offset:14336
  v_mfma_f32_16x16x32_bf16 v[188:191], v[60:63], v[44:47], v[188:191]
  s_add_u32 s16, s16, s17
  s_cmp_eq_u32 s16, 65536
  s_cselect_b32 s23, s18, s17
  v_mfma_f32_16x16x32_bf16 v[188:191], v[92:95], v[76:79], v[188:191]
  s_cselect_b32 s16, 0, s16
  v_add_u32 v4, s23, v4
  v_add_u32_e64 v5, s23, v5
  v_mfma_f32_16x16x32_bf16 v[180:183], v[92:95], v[72:75], v[180:183]
  s_add_u32 s19, s19, s20
  s_cmp_eq_u32 s19, 81920
  s_cselect_b32 s23, s21, s20
  v_mfma_f32_16x16x32_bf16 v[180:183], v[60:63], v[40:43], v[180:183]
  s_cselect_b32 s19, 0, s19
  v_add_u32 v6, s23, v6
  v_add_u32_e64 v7, s23, v7
  v_mfma_f32_16x16x32_bf16 v[172:175], v[60:63], v[36:39], v[172:175]
  v_mfma_f32_16x16x32_bf16 v[172:175], v[92:95], v[68:71], v[172:175]
  v_mfma_f32_16x16x32_bf16 v[164:167], v[92:95], v[64:67], v[164:167]
  s_nop 0
  s_waitcnt lgkmcnt(0)
  v_mfma_f32_16x16x32_bf16 v[164:167], v[60:63], v[32:35], v[164:167]
  s_waitcnt vmcnt(0)
  s_barrier
  v_mfma_f32_16x16x32_bf16 v[128:131], v[112:115], v[96:99], v[128:131]
  ds_read_b64_tr_b16 v[48:49], v6 offset:0
  v_mfma_f32_16x16x32_bf16 v[128:131], v[208:211], v[192:195], v[128:131]
  ds_read_b64_tr_b16 v[50:51], v6 offset:2048
  v_mfma_f32_16x16x32_bf16 v[136:139], v[208:211], v[196:199], v[136:139]
  ds_read_b128 v[32:35], v4 offset:0
  v_mfma_f32_16x16x32_bf16 v[136:139], v[112:115], v[100:103], v[136:139]
  ds_read_b128 v[36:39], v4 offset:2048
  v_mfma_f32_16x16x32_bf16 v[144:147], v[112:115], v[104:107], v[144:147]
  ds_read_b128 v[40:43], v4 offset:4096
  v_mfma_f32_16x16x32_bf16 v[144:147], v[208:211], v[200:203], v[144:147]
  ds_read_b128 v[44:47], v4 offset:6144
  v_mfma_f32_16x16x32_bf16 v[152:155], v[208:211], v[204:207], v[152:155]
  ds_read_b64_tr_b16 v[52:53], v7 offset:0
  v_mfma_f32_16x16x32_bf16 v[152:155], v[112:115], v[108:111], v[152:155]
  ds_read_b64_tr_b16 v[54:55], v7 offset:2048
  v_mfma_f32_16x16x32_bf16 v[156:159], v[116:119], v[108:111], v[156:159]
  ds_read_b64_tr_b16 v[56:57], v6 offset:8192
  v_mfma_f32_16x16x32_bf16 v[156:159], v[212:215], v[204:207], v[156:159]
  ds_read_b64_tr_b16 v[58:59], v6 offset:10240
  v_mfma_f32_16x16x32_bf16 v[148:151], v[212:215], v[200:203], v[148:151]
  ds_read_b64_tr_b16 v[60:61], v7 offset:8192
  v_mfma_f32_16x16x32_bf16 v[148:151], v[116:119], v[104:107], v[148:151]
  ds_read_b64_tr_b16 v[62:63], v7 offset:10240
  v_mfma_f32_16x16x32_bf16 v[140:143], v[116:119], v[100:103], v[140:143]
  ds_read_b64_tr_b16 v[80:81], v6 offset:4096
  v_mfma_f32_16x16x32_bf16 v[140:143], v[212:215], v[196:199], v[140:143]
  ds_read_b64_tr_b16 v[82:83], v6 offset:6144
  v_mfma_f32_16x16x32_bf16 v[132:135], v[212:215], v[192:195], v[132:135]
  ds_read_b128 v[64:67], v5 offset:0
  v_mfma_f32_16x16x32_bf16 v[132:135], v[116:119], v[96:99], v[132:135]
  ds_read_b128 v[68:71], v5 offset:2048
  v_mfma_f32_16x16x32_bf16 v[160:163], v[120:123], v[96:99], v[160:163]
  ds_read_b128 v[72:75], v5 offset:4096
  v_mfma_f32_16x16x32_bf16 v[160:163], v[216:219], v[192:195], v[160:163]
  ds_read_b128 v[76:79], v5 offset:6144
  v_mfma_f32_16x16x32_bf16 v[168:171], v[216:219], v[196:199], v[168:171]
  ds_read_b64_tr_b16 v[84:85], v7 offset:4096
  v_mfma_f32_16x16x32_bf16 v[168:171], v[120:123], v[100:103], v[168:171]
  ds_read_b64_tr_b16 v[86:87], v7 offset:6144
  v_mfma_f32_16x16x32_bf16 v[176:179], v[120:123], v[104:107], v[176:179]
  ds_read_b64_tr_b16 v[88:89], v6 offset:12288
  v_mfma_f32_16x16x32_bf16 v[176:179], v[216:219], v[200:203], v[176:179]
  ds_read_b64_tr_b16 v[90:91], v6 offset:14336
  v_mfma_f32_16x16x32_bf16 v[184:187], v[216:219], v[204:207], v[184:187]
  ds_read_b64_tr_b16 v[92:93], v7 offset:12288
  v_mfma_f32_16x16x32_bf16 v[184:187], v[120:123], v[108:111], v[184:187]
  ds_read_b64_tr_b16 v[94:95], v7 offset:14336
  v_mfma_f32_16x16x32_bf16 v[188:191], v[124:127], v[108:111], v[188:191]
  s_add_u32 s16, s16, s17
  s_cmp_eq_u32 s16, 65536
  s_cselect_b32 s23, s18, s17
  v_mfma_f32_16x16x32_bf16 v[188:191], v[220:223], v[204:207], v[188:191]
  s_cselect_b32 s16, 0, s16
  v_add_u32 v4, s23, v4
  v_add_u32_e64 v5, s23, v5
  v_mfma_f32_16x16x32_bf16 v[180:183], v[220:223], v[200:203], v[180:183]
  s_add_u32 s19, s19, s20
  s_cmp_eq_u32 s19, 81920
  s_cselect_b32 s23, s21, s20
  v_mfma_f32_16x16x32_bf16 v[180:183], v[124:127], v[104:107], v[180:183]
  s_cselect_b32 s19, 0, s19
  v_add_u32 v6, s23, v6
  v_add_u32_e64 v7, s23, v7
  v_mfma_f32_16x16x32_bf16 v[172:175], v[124:127], v[100:103], v[172:175]
  s_sub_u32 s22, s22, 1
  s_cmp_lg_u32 s22, 0
  v_mfma_f32_16x16x32_bf16 v[172:175], v[220:223], v[196:199], v[172:175]
  v_mfma_f32_16x16x32_bf16 v[164:167], v[220:223], v[192:195], v[164:167]
  s_nop 0
  s_waitcnt lgkmcnt(0)
  v_mfma_f32_16x16x32_bf16 v[164:167], v[124:127], v[96:99], v[164:167]
  s_cbranch_scc1 Lk_29
  s_barrier
  v_mfma_f32_16x16x32_bf16 v[128:131], v[48:51], v[32:35], v[128:131]
  ds_read_b64_tr_b16 v[112:113], v6 offset:0
  v_mfma_f32_16x16x32_bf16 v[128:131], v[80:83], v[64:67], v[128:131]
  ds_read_b64_tr_b16 v[114:115], v6 offset:2048
  v_mfma_f32_16x16x32_bf16 v[136:139], v[80:83], v[68:71], v[136:139]
  ds_read_b128 v[96:99], v4 offset:0
  v_mfma_f32_16x16x32_bf16 v[136:139], v[48:51], v[36:39], v[136:139]
  ds_read_b128 v[100:103], v4 offset:2048
  v_mfma_f32_16x16x32_bf16 v[144:147], v[48:51], v[40:43], v[144:147]
  ds_read_b128 v[104:107], v4 offset:4096
  v_mfma_f32_16x16x32_bf16 v[144:147], v[80:83], v[72:75], v[144:147]
  ds_read_b128 v[108:111], v4 offset:6144
  v_mfma_f32_16x16x32_bf16 v[152:155], v[80:83], v[76:79], v[152:155]
  ds_read_b64_tr_b16 v[116:117], v7 offset:0
  v_mfma_f32_16x16x32_bf16 v[152:155], v[48:51], v[44:47], v[152:155]
  ds_read_b64_tr_b16 v[118:119], v7 offset:2048
  v_mfma_f32_16x16x32_bf16 v[156:159], v[52:55], v[44:47], v[156:159]
  ds_read_b64_tr_b16 v[120:121], v6 offset:8192
  v_mfma_f32_16x16x32_bf16 v[156:159], v[84:87], v[76:79], v[156:159]
  ds_read_b64_tr_b16 v[122:123], v6 offset:10240
  v_mfma_f32_16x16x32_bf16 v[148:151], v[84:87], v[72:75], v[148:151]
  ds_read_b64_tr_b16 v[124:125], v7 offset:8192
  v_mfma_f32_16x16x32_bf16 v[148:151], v[52:55], v[40:43], v[148:151]
  ds_read_b64_tr_b16 v[126:127], v7 offset:10240
  v_mfma_f32_16x16x32_bf16 v[140:143], v[52:55], v[36:39], v[140:143]
  ds_read_b64_tr_b16 v[208:209], v6 offset:4096
  v_mfma_f32_16x16x32_bf16 v[140:143], v[84:87], v[68:71], v[140:143]
  ds_read_b64_tr_b16 v[210:211], v6 offset:6144
  v_mfma_f32_16x16x32_bf16 v[132:135], v[84:87], v[64:67], v[132:135]
  ds_read_b128 v[192:195], v5 offset:0
  v_mfma_f32_16x16x32_bf16 v[132:135], v[52:55], v[32:35], v[132:135]
  ds_read_b128 v[196:199], v5 offset:2048
  v_mfma_f32_16x16x32_bf16 v[160:163], v[56:59], v[32:35], v[160:163]
  ds_read_b128 v[200:203], v5 offset:4096
  v_mfma_f32_16x16x32_bf16 v[160:163], v[88:91], v[64:67], v[160:163]
  ds_read_b128 v[204:207], v5 offset:6144
  v_mfma_f32_16x16x32_bf16 v[168:171], v[88:91], v[68:71], v[168:171]
  ds_read_b64_tr_b16 v[212:213], v7 offset:4096
  v_mfma_f32_16x16x32_bf16 v[168:171], v[56:59], v[36:39], v[168:171]
  ds_read_b64_tr_b16 v[214:215], v7 offset:6144
  v_mfma_f32_16x16x32_bf16 v[176:179], v[56:59], v[40:43], v[176:179]
  ds_read_b64_tr_b16 v[216:217], v6 offset:12288
  v_mfma_f32_16x16x32_bf16 v[176:179], v[88:91], v[72:75], v[176:179]
  ds_read_b64_tr_b16 v[218:219], v6 offset:14336
  v_mfma_f32_16x16x32_bf16 v[184:187], v[88:91], v[76:79], v[184:187]
  ds_read_b64_tr_b16 v[220:221], v7 offset:12288
  v_mfma_f32_16x16x32_bf16 v[184:187], v[56:59], v[44:47], v[184:187]
  ds_read_b64_tr_b16 v[222:223], v7 offset:14336
  v_mfma_f32_16x16x32_bf16 v[188:191], v[60:63], v[44:47], v[188:191]
  s_add_u32 s16, s16, s17
  s_cmp_eq_u32 s16, 65536
  s_cselect_b32 s23, s18, s17
  v_mfma_f32_16x16x32_bf16 v[188:191], v[92:95], v[76:79], v[188:191]
  s_cselect_b32 s16, 0, s16
  v_add_u32 v4, s23, v4
  v_add_u32_e64 v5, s23, v5
  v_mfma_f32_16x16x32_bf16 v[180:183], v[92:95], v[72:75], v[180:183]
  s_add_u32 s19, s19, s20
  s_cmp_eq_u32 s19, 81920
  s_cselect_b32 s23, s21, s20
  v_mfma_f32_16x16x32_bf16 v[180:183], v[60:63], v[40:43], v[180:183]
  s_cselect_b32 s19, 0, s19
  v_add_u32 v6, s23, v6
  v_add_u32_e64 v7, s23, v7
  v_mfma_f32_16x16x32_bf16 v[172:175], v[60:63], v[36:39], v[172:175]
  v_mfma_f32_16x16x32_bf16 v[172:175], v[92:95], v[68:71], v[172:175]
  v_mfma_f32_16x16x32_bf16 v[164:167], v[92:95], v[64:67], v[164:167]
  s_waitcnt lgkmcnt(0)
  v_mfma_f32_16x16x32_bf16 v[164:167], v[60:63], v[32:35], v[164:167]
  s_barrier
  v_mfma_f32_16x16x32_bf16 v[160:163], v[120:123], v[96:99], v[160:163]
  ds_read_b64_tr_b16 v[48:49], v6 offset:0
  ds_read_b64_tr_b16 v[50:51], v6 offset:2048
  v_mfma_f32_16x16x32_bf16 v[160:163], v[216:219], v[192:195], v[160:163]
  ds_read_b128 v[32:35], v4 offset:0
  ds_read_b128 v[36:39], v4 offset:2048
  v_mfma_f32_16x16x32_bf16 v[164:167], v[220:223], v[192:195], v[164:167]
  ds_read_b128 v[40:43], v4 offset:4096
  ds_read_b128 v[44:47], v4 offset:6144
  v_mfma_f32_16x16x32_bf16 v[164:167], v[124:127], v[96:99], v[164:167]
  ds_read_b64_tr_b16 v[52:53], v7 offset:0
  ds_read_b64_tr_b16 v[54:55], v7 offset:2048
  v_mfma_f32_16x16x32_bf16 v[172:175], v[124:127], v[100:103], v[172:175]
  ds_read_b64_tr_b16 v[80:81], v6 offset:4096
  ds_read_b64_tr_b16 v[82:83], v6 offset:6144
  v_mfma_f32_16x16x32_bf16 v[172:175], v[220:223], v[196:199], v[172:175]
  v_cvt_pk_bf16_f32 v160, v160, v161
  v_cvt_pk_bf16_f32 v161, v162, v163
  v_mfma_f32_16x16x32_bf16 v[168:171], v[216:219], v[196:199], v[168:171]
  v_cvt_pk_bf16_f32 v162, v164, v165
  v_cvt_pk_bf16_f32 v163, v166, v167
  v_mfma_f32_16x16x32_bf16 v[168:171], v[120:123], v[100:103], v[168:171]
  buffer_store_dwordx4 v[160:163], v0, s[40:43], s6 offen offset:0 sc0 sc1
  v_mfma_f32_16x16x32_bf16 v[176:179], v[120:123], v[104:107], v[176:179]
  ds_read_b128 v[64:67], v5 offset:0
  v_mfma_f32_16x16x32_bf16 v[176:179], v[216:219], v[200:203], v[176:179]
  v_cvt_pk_bf16_f32 v166, v172, v173
  v_cvt_pk_bf16_f32 v167, v174, v175
  v_mfma_f32_16x16x32_bf16 v[180:183], v[220:223], v[200:203], v[180:183]
  s_nop 0
  s_nop 0
  v_cvt_pk_bf16_f32 v164, v168, v169
  v_cvt_pk_bf16_f32 v165, v170, v171
  v_mfma_f32_16x16x32_bf16 v[180:183], v[124:127], v[104:107], v[180:183]
  buffer_store_dwordx4 v[164:167], v0, s[40:43], s6 offen offset:2048 sc0 sc1
  ds_read_b128 v[68:71], v5 offset:2048
  v_mfma_f32_16x16x32_bf16 v[188:191], v[124:127], v[108:111], v[188:191]
  ds_read_b128 v[72:75], v5 offset:4096
  v_mfma_f32_16x16x32_bf16 v[188:191], v[220:223], v[204:207], v[188:191]
  v_cvt_pk_bf16_f32 v168, v176, v177
  v_cvt_pk_bf16_f32 v169, v178, v179
  v_mfma_f32_16x16x32_bf16 v[184:187], v[216:219], v[204:207], v[184:187]
  v_cvt_pk_bf16_f32 v170, v180, v181
  v_cvt_pk_bf16_f32 v171, v182, v183
  v_mfma_f32_16x16x32_bf16 v[184:187], v[120:123], v[108:111], v[184:187]
  buffer_store_dwordx4 v[168:171], v0, s[40:43], s7 offen offset:0 sc0 sc1
  ds_read_b128 v[76:79], v5 offset:6144
  v_mfma_f32_16x16x32_bf16 v[128:131], v[112:115], v[96:99], v[128:131]
  ds_read_b64_tr_b16 v[84:85], v7 offset:4096
  v_mfma_f32_16x16x32_bf16 v[128:131], v[208:211], v[192:195], v[128:131]
  v_cvt_pk_bf16_f32 v174, v188, v189
  v_cvt_pk_bf16_f32 v175, v190, v191
  v_mfma_f32_16x16x32_bf16 v[136:139], v[208:211], v[196:199], v[136:139]
  v_cvt_pk_bf16_f32 v172, v184, v185
  v_cvt_pk_bf16_f32 v173, v186, v187
  v_mfma_f32_16x16x32_bf16 v[136:139], v[112:115], v[100:103], v[136:139]
  buffer_store_dwordx4 v[172:175], v0, s[40:43], s7 offen offset:2048 sc0 sc1
  ds_read_b64_tr_b16 v[86:87], v7 offset:6144
  v_mfma_f32_16x16x32_bf16 v[144:147], v[112:115], v[104:107], v[144:147]
  v_subrev_u32 v4, 32768, v4
  v_mfma_f32_16x16x32_bf16 v[144:147], v[208:211], v[200:203], v[144:147]
  v_subrev_u32 v6, 0x10000, v6
  v_mfma_f32_16x16x32_bf16 v[152:155], v[208:211], v[204:207], v[152:155]
  v_subrev_u32 v7, 0x10000, v7
  v_mfma_f32_16x16x32_bf16 v[152:155], v[112:115], v[108:111], v[152:155]
  v_mfma_f32_16x16x32_bf16 v[156:159], v[116:119], v[108:111], v[156:159]
  v_mfma_f32_16x16x32_bf16 v[156:159], v[212:215], v[204:207], v[156:159]
  v_mfma_f32_16x16x32_bf16 v[148:151], v[212:215], v[200:203], v[148:151]
  v_mfma_f32_16x16x32_bf16 v[148:151], v[116:119], v[104:107], v[148:151]
  v_mfma_f32_16x16x32_bf16 v[140:143], v[116:119], v[100:103], v[140:143]
  v_mfma_f32_16x16x32_bf16 v[140:143], v[212:215], v[196:199], v[140:143]
  v_mfma_f32_16x16x32_bf16 v[132:135], v[212:215], v[192:195], v[132:135]
  s_waitcnt lgkmcnt(0)
  v_mfma_f32_16x16x32_bf16 v[132:135], v[116:119], v[96:99], v[132:135]
  s_barrier
  v_mfma_f32_16x16x32_bf16 v[128:131], v[48:51], v[32:35], v[128:131]
  ds_read_b64_tr_b16 v[112:113], v6 offset:0
  v_mfma_f32_16x16x32_bf16 v[128:131], v[80:83], v[64:67], v[128:131]
  ds_read_b64_tr_b16 v[114:115], v6 offset:2048
  v_mfma_f32_16x16x32_bf16 v[136:139], v[80:83], v[68:71], v[136:139]
  ds_read_b64_tr_b16 v[208:209], v6 offset:4096
  v_mfma_f32_16x16x32_bf16 v[136:139], v[48:51], v[36:39], v[136:139]
  ds_read_b64_tr_b16 v[210:211], v6 offset:6144
  v_mfma_f32_16x16x32_bf16 v[144:147], v[48:51], v[40:43], v[144:147]
  ds_read_b128 v[96:99], v4 offset:49152
  v_mfma_f32_16x16x32_bf16 v[144:147], v[80:83], v[72:75], v[144:147]
  ds_read_b128 v[192:195], v4 offset:50176
  v_mfma_f32_16x16x32_bf16 v[152:155], v[80:83], v[76:79], v[152:155]
  ds_read_b128 v[100:103], v4 offset:51200
  v_mfma_f32_16x16x32_bf16 v[152:155], v[48:51], v[44:47], v[152:155]
  ds_read_b128 v[196:199], v4 offset:52224
  v_mfma_f32_16x16x32_bf16 v[156:159], v[52:55], v[44:47], v[156:159]
  ds_read_b128 v[104:107], v4 offset:53248
  v_mfma_f32_16x16x32_bf16 v[156:159], v[84:87], v[76:79], v[156:159]
  ds_read_b128 v[200:203], v4 offset:54272
  v_mfma_f32_16x16x32_bf16 v[148:151], v[84:87], v[72:75], v[148:151]
  ds_read_b128 v[108:111], v4 offset:55296
  v_mfma_f32_16x16x32_bf16 v[148:151], v[52:55], v[40:43], v[148:151]
  ds_read_b128 v[204:207], v4 offset:56320
  v_mfma_f32_16x16x32_bf16 v[140:143], v[52:55], v[36:39], v[140:143]
  ds_read_b64_tr_b16 v[116:117], v7 offset:0
  v_mfma_f32_16x16x32_bf16 v[140:143], v[84:87], v[68:71], v[140:143]
  ds_read_b64_tr_b16 v[118:119], v7 offset:2048
  v_mfma_f32_16x16x32_bf16 v[132:135], v[84:87], v[64:67], v[132:135]
  ds_read_b64_tr_b16 v[212:213], v7 offset:4096
  ds_read_b64_tr_b16 v[214:215], v7 offset:6144
  v_mfma_f32_16x16x32_bf16 v[132:135], v[52:55], v[32:35], v[132:135]
  s_barrier
  s_waitcnt lgkmcnt(10)
  v_mfma_f32_16x16x32_bf16 v[128:131], v[112:115], v[96:99], v[128:131]
  ds_read_b64_tr_b16 v[48:49], v6 offset:16384
  v_mfma_f32_16x16x32_bf16 v[128:131], v[208:211], v[192:195], v[128:131]
  ds_read_b64_tr_b16 v[50:51], v6 offset:18432
  s_nop 0
  s_waitcnt lgkmcnt(10)
  v_mfma_f32_16x16x32_bf16 v[136:139], v[208:211], v[196:199], v[136:139]
  ds_read_b64_tr_b16 v[80:81], v6 offset:20480
  v_mfma_f32_16x16x32_bf16 v[136:139], v[112:115], v[100:103], v[136:139]
  ds_read_b64_tr_b16 v[82:83], v6 offset:22528
  s_nop 0
  s_waitcnt lgkmcnt(10)
  v_mfma_f32_16x16x32_bf16 v[144:147], v[112:115], v[104:107], v[144:147]
  ds_read_b128 v[32:35], v4 offset:0
  v_mfma_f32_16x16x32_bf16 v[144:147], v[208:211], v[200:203], v[144:147]
  ds_read_b128 v[64:67], v4 offset:1024
  s_nop 0
  s_waitcnt lgkmcnt(10)
  v_mfma_f32_16x16x32_bf16 v[152:155], v[208:211], v[204:207], v[152:155]
  ds_read_b128 v[36:39], v4 offset:2048
  v_mfma_f32_16x16x32_bf16 v[152:155], v[112:115], v[108:111], v[152:155]
  ds_read_b128 v[68:71], v4 offset:3072
  s_nop 0
  s_waitcnt lgkmcnt(8)
  v_mfma_f32_16x16x32_bf16 v[156:159], v[116:119], v[108:111], v[156:159]
  ds_read_b128 v[40:43], v4 offset:4096
  buffer_load_dwordx4 v[176:179], v0, s[40:43], s8 offen offset:0 sc0 sc1
  v_mfma_f32_16x16x32_bf16 v[156:159], v[212:215], v[204:207], v[156:159]
  ds_read_b128 v[72:75], v4 offset:5120
  v_mfma_f32_16x16x32_bf16 v[148:151], v[212:215], v[200:203], v[148:151]
  ds_read_b128 v[44:47], v4 offset:6144
  buffer_load_dwordx4 v[180:183], v0, s[40:43], s8 offen offset:2048 sc0 sc1
  v_mfma_f32_16x16x32_bf16 v[148:151], v[116:119], v[104:107], v[148:151]
  ds_read_b128 v[76:79], v4 offset:7168
  v_mfma_f32_16x16x32_bf16 v[140:143], v[116:119], v[100:103], v[140:143]
  ds_read_b64_tr_b16 v[52:53], v7 offset:16384
  buffer_load_dwordx4 v[184:187], v0, s[40:43], s9 offen offset:0 sc0 sc1
  v_mfma_f32_16x16x32_bf16 v[140:143], v[212:215], v[196:199], v[140:143]
  ds_read_b64_tr_b16 v[54:55], v7 offset:18432
  v_mfma_f32_16x16x32_bf16 v[132:135], v[212:215], v[192:195], v[132:135]
  ds_read_b64_tr_b16 v[84:85], v7 offset:20480
  ds_read_b64_tr_b16 v[86:87], v7 offset:22528
  buffer_load_dwordx4 v[188:191], v0, s[40:43], s9 offen offset:2048 sc0 sc1
  v_mfma_f32_16x16x32_bf16 v[132:135], v[116:119], v[96:99], v[132:135]
  s_barrier
  s_waitcnt lgkmcnt(10)
  v_mfma_f32_16x16x32_bf16 v[128:131], v[48:51], v[32:35], v[128:131]
  ds_read_b64_tr_b16 v[112:113], v6 offset:32768
  v_mfma_f32_16x16x32_bf16 v[128:131], v[80:83], v[64:67], v[128:131]
  ds_read_b64_tr_b16 v[114:115], v6 offset:34816
  s_nop 0
  s_waitcnt lgkmcnt(10)
  v_mfma_f32_16x16x32_bf16 v[136:139], v[80:83], v[68:71], v[136:139]
  ds_read_b64_tr_b16 v[208:209], v6 offset:36864
  v_mfma_f32_16x16x32_bf16 v[136:139], v[48:51], v[36:39], v[136:139]
  ds_read_b64_tr_b16 v[210:211], v6 offset:38912
  s_nop 0
  s_waitcnt lgkmcnt(10)
  v_mfma_f32_16x16x32_bf16 v[144:147], v[48:51], v[40:43], v[144:147]
  ds_read_b128 v[96:99], v4 offset:16384
  v_mfma_f32_16x16x32_bf16 v[144:147], v[80:83], v[72:75], v[144:147]
  ds_read_b128 v[192:195], v4 offset:17408
  s_nop 0
  s_waitcnt lgkmcnt(10)
  v_mfma_f32_16x16x32_bf16 v[152:155], v[80:83], v[76:79], v[152:155]
  ds_read_b128 v[100:103], v4 offset:18432
  v_mfma_f32_16x16x32_bf16 v[152:155], v[48:51], v[44:47], v[152:155]
  ds_read_b128 v[196:199], v4 offset:19456
  s_nop 0
  s_waitcnt lgkmcnt(8)
  v_mfma_f32_16x16x32_bf16 v[156:159], v[52:55], v[44:47], v[156:159]
  ds_read_b128 v[104:107], v4 offset:20480
  v_mfma_f32_16x16x32_bf16 v[156:159], v[84:87], v[76:79], v[156:159]
  ds_read_b128 v[200:203], v4 offset:21504
  v_mfma_f32_16x16x32_bf16 v[148:151], v[84:87], v[72:75], v[148:151]
  ds_read_b128 v[108:111], v4 offset:22528
  v_mfma_f32_16x16x32_bf16 v[148:151], v[52:55], v[40:43], v[148:151]
  ds_read_b128 v[204:207], v4 offset:23552
  v_mfma_f32_16x16x32_bf16 v[140:143], v[52:55], v[36:39], v[140:143]
  ds_read_b64_tr_b16 v[116:117], v7 offset:32768
  v_mfma_f32_16x16x32_bf16 v[140:143], v[84:87], v[68:71], v[140:143]
  ds_read_b64_tr_b16 v[118:119], v7 offset:34816
  v_mfma_f32_16x16x32_bf16 v[132:135], v[84:87], v[64:67], v[132:135]
  ds_read_b64_tr_b16 v[212:213], v7 offset:36864
  ds_read_b64_tr_b16 v[214:215], v7 offset:38912
  v_mfma_f32_16x16x32_bf16 v[132:135], v[52:55], v[32:35], v[132:135]
  s_waitcnt lgkmcnt(10)
  v_mfma_f32_16x16x32_bf16 v[128:131], v[112:115], v[96:99], v[128:131]
  v_mfma_f32_16x16x32_bf16 v[128:131], v[208:211], v[192:195], v[128:131]
  s_waitcnt lgkmcnt(8)
  v_mfma_f32_16x16x32_bf16 v[136:139], v[208:211], v[196:199], v[136:139]
  v_mfma_f32_16x16x32_bf16 v[136:139], v[112:115], v[100:103], v[136:139]
  s_waitcnt lgkmcnt(6)
  v_mfma_f32_16x16x32_bf16 v[144:147], v[112:115], v[104:107], v[144:147]
  v_mfma_f32_16x16x32_bf16 v[144:147], v[208:211], v[200:203], v[144:147]
  s_waitcnt lgkmcnt(4)
  v_mfma_f32_16x16x32_bf16 v[152:155], v[208:211], v[204:207], v[152:155]
  s_lshl_b32 s4, s76, Lz1-Lz0+4
  v_mfma_f32_16x16x32_bf16 v[152:155], v[112:115], v[108:111], v[152:155]
  s_add_u32 s4, s4, s78
  s_lshl_b32 s6, s4, 14
  s_waitcnt lgkmcnt(0)
  s_barrier
  v_mfma_f32_16x16x32_bf16 v[156:159], v[116:119], v[108:111], v[156:159]
  s_add_u32 s6, s6, 35651584
  s_add_u32 s7, s6, 4096
  v_mfma_f32_16x16x32_bf16 v[156:159], v[212:215], v[204:207], v[156:159]
  v_and_b32 v2, 15, v1
  v_lshlrev_b32 v3, 12, v2
  v_mfma_f32_16x16x32_bf16 v[148:151], v[212:215], v[200:203], v[148:151]
  v_and_b32_e64 v2, 16, v1
  v_lshl_add_u32 v3, v2, 1, v3
  v_mfma_f32_16x16x32_bf16 v[148:151], v[116:119], v[104:107], v[148:151]
  v_and_b32 v2, 32, v1
  v_lshrrev_b32 v2, 1, v2
  v_mfma_f32_16x16x32_bf16 v[140:143], v[116:119], v[100:103], v[140:143]
  v_add_u32 v3, v2, v3
  s_lshl_b32 s26, s76, 18
  v_mfma_f32_16x16x32_bf16 v[140:143], v[212:215], v[196:199], v[140:143]
  s_lshl_b32 s4, s85, 11
  s_add_u32 s26, s26, s4
  v_mfma_f32_16x16x32_bf16 v[132:135], v[212:215], v[192:195], v[132:135]
  s_lshl_b32 s4, s78, 7
  s_add_u32 s26, s26, s4
  v_mfma_f32_16x16x32_bf16 v[132:135], v[116:119], v[96:99], v[132:135]
  s_lshl_b32 s4, s86, 6
  s_add_u32 s26, s26, s4
  s_mov_b32 s89, 200000
  v_mov_b32_e64 v32, 0
  s_waitcnt vmcnt(0)
  s_mov_b64 exec, 1
  buffer_store_dword v27, off, s[40:43], s14 sc0 sc1
  s_mov_b64 exec, -1
Lx_31:
  v_cmpx_ne_u64 vcc, v[176:177], v[240:241]
  v_cmpx_ne_u64 vcc, v[178:179], v[242:243]
  v_cmpx_ne_u64 vcc, v[180:181], v[244:245]
  v_cmpx_ne_u64 vcc, v[182:183], v[246:247]
  v_cmpx_ne_u64 vcc, v[184:185], v[248:249]
  v_cmpx_ne_u64 vcc, v[186:187], v[250:251]
  v_cmpx_ne_u64 vcc, v[188:189], v[252:253]
  v_cmpx_ne_u64 vcc, v[190:191], v[254:255]
  s_cmp_eq_u64 exec, -1
  s_cbranch_scc0 Lx_30
Lx_32:
  s_nop 1
  v_mfma_f32_16x16x32_bf16 v[128:131], v[226:229], v[176:179], v[128:131]
  v_mfma_f32_16x16x32_bf16 v[132:135], v[224:227], v[176:179], v[132:135]
  v_mfma_f32_16x16x32_bf16 v[136:139], v[226:229], v[180:183], v[136:139]
  v_mfma_f32_16x16x32_bf16 v[140:143], v[224:227], v[180:183], v[140:143]
  v_mfma_f32_16x16x32_bf16 v[144:147], v[226:229], v[184:187], v[144:147]
  v_mfma_f32_16x16x32_bf16 v[148:151], v[224:227], v[184:187], v[148:151]
  v_mfma_f32_16x16x32_bf16 v[152:155], v[226:229], v[188:191], v[152:155]
  v_mfma_f32_16x16x32_bf16 v[156:159], v[224:227], v[188:191], v[156:159]
  s_cmp_lg_u32 s82, 0
  s_cbranch_scc1 L_cfinal
  v_cvt_pk_bf16_f32 v240, v128, v129
  v_cvt_pk_bf16_f32 v241, v130, v131
  v_cvt_pk_bf16_f32 v242, v132, v133
  v_cvt_pk_bf16_f32 v243, v134, v135
  buffer_store_dwordx4 v[240:243], v0, s[40:43], s6 offen offset:0 sc0 sc1
  v_cvt_pk_bf16_f32 v244, v136, v137
  v_cvt_pk_bf16_f32 v245, v138, v139
  v_cvt_pk_bf16_f32 v246, v140, v141
  v_cvt_pk_bf16_f32 v247, v142, v143
  buffer_store_dwordx4 v[244:247], v0, s[40:43], s6 offen offset:2048 sc0 sc1
  v_cvt_pk_bf16_f32 v248, v144, v145
  v_cvt_pk_bf16_f32 v249, v146, v147
  v_cvt_pk_bf16_f32 v250, v148, v149
  v_cvt_pk_bf16_f32 v251, v150, v151
  buffer_store_dwordx4 v[248:251], v0, s[40:43], s7 offen offset:0 sc0 sc1
  v_cvt_pk_bf16_f32 v252, v152, v153
  v_cvt_pk_bf16_f32 v253, v154, v155
  v_cvt_pk_bf16_f32 v254, v156, v157
  v_cvt_pk_bf16_f32 v255, v158, v159
  buffer_store_dwordx4 v[252:255], v0, s[40:43], s7 offen offset:2048 sc0 sc1
  s_lshl_b32 s5, s78, Lz1-Lz0+1
  v_mov_b32 v40, 0x3f803f80
  v_dot2_f32_bf16 v32, v240, v40, 0
  v_dot2_f32_bf16 v36, v240, v240, 0
  v_dot2_f32_bf16 v33, v244, v40, 0
  v_dot2_f32_bf16 v37, v244, v244, 0
  v_dot2_f32_bf16 v34, v248, v40, 0
  v_dot2_f32_bf16 v38, v248, v248, 0
  v_dot2_f32_bf16 v35, v252, v40, 0
  v_dot2_f32_bf16 v39, v252, v252, 0
  v_dot2_f32_bf16 v32, v241, v40, v32
  v_dot2_f32_bf16 v36, v241, v241, v36
  v_dot2_f32_bf16 v33, v245, v40, v33
  v_dot2_f32_bf16 v37, v245, v245, v37
  v_dot2_f32_bf16 v34, v249, v40, v34
  v_dot2_f32_bf16 v38, v249, v249, v38
  v_dot2_f32_bf16 v35, v253, v40, v35
  v_dot2_f32_bf16 v39, v253, v253, v39
  v_dot2_f32_bf16 v32, v242, v40, v32
  v_dot2_f32_bf16 v36, v242, v242, v36
  v_dot2_f32_bf16 v33, v246, v40, v33
  v_dot2_f32_bf16 v37, v246, v246, v37
  v_dot2_f32_bf16 v34, v250, v40, v34
  v_dot2_f32_bf16 v38, v250, v250, v38
  v_dot2_f32_bf16 v35, v254, v40, v35
  v_dot2_f32_bf16 v39, v254, v254, v39
  v_dot2_f32_bf16 v32, v243, v40, v32
  v_dot2_f32_bf16 v36, v243, v243, v36
  v_dot2_f32_bf16 v33, v247, v40, v33
  v_dot2_f32_bf16 v37, v247, v247, v37
  v_dot2_f32_bf16 v34, v251, v40, v34
  v_dot2_f32_bf16 v38, v251, v251, v38
  v_dot2_f32_bf16 v35, v255, v40, v35
  v_dot2_f32_bf16 v39, v255, v255, v39
  s_lshl_b32 s6, s76, Lz1-Lz0+9
  s_lshl_b32 s7, s85, 8
  s_add_u32 s6, s6, s7
  s_add_u32 s6, s6, s5
  s_add_u32 s6, s6, s86
  s_lshl_b32 s6, s6, 6
  s_add_u32 s6, s6, s83
  s_add_u32 s6, s6, 36700160
  v_permlane32_swap_b32 v32, v34
  v_permlane32_swap_b32 v33, v35
  v_permlane32_swap_b32 v36, v38
  v_permlane32_swap_b32 v37, v39
  v_add_f32 v32, v32, v34
  v_add_f32 v33, v33, v35
  v_add_f32 v36, v36, v38
  v_add_f32 v37, v37, v39
  v_permlane16_swap_b32 v32, v33
  s_nop 0
  v_permlane16_swap_b32 v36, v37
  v_add_f32 v42, v32, v33
  v_add_f32_e64 v43, v36, v37
  buffer_store_dwordx2 v[42:43], v30, s[40:43], s6 offen sc0 sc1
  s_add_u32 s5, s87, 0x10
  s_sub_u32 s4, s78, s77
  s_lshl_b32 s4, s4, 7
  s_add_u32 s5, s5, s4
  s_waitcnt vmcnt(0)
  s_mov_b64 exec, 1
  ds_add_rtn_u32 v2, v28, v27 offset:0
  s_waitcnt lgkmcnt(0)
  v_readfirstlane_b32 s4, v2
  s_and_b32 s4, s4, Lz1-Lz0+3
  s_cmp_lg_u32 s4, 3
  s_cbranch_scc1 Ls_33
  s_mov_b32 exec_lo, 0xffff
  buffer_store_dword v27, v24, s[40:43], s5 offen sc0 sc1
Ls_33:
  s_nop 0
  s_mov_b64 exec, -1
  ds_write_b128 v0, v[240:243] offset:0
  ds_write_b128 v0, v[244:247] offset:2048
  ds_write_b128 v0, v[248:251] offset:4096
  ds_write_b128 v0, v[252:255] offset:6144
  s_mov_b32 s82, 1
  s_add_u32 s83, s83, 0
  s_add_u32 s87, s87, 32
  s_branch L_clayer
  s_nop 0
L_cfinal:
  s_nop 1
  v_cvt_pk_bf16_f32 v240, v128, v129
  v_cvt_pk_bf16_f32 v241, v130, v131
  v_cvt_pk_bf16_f32 v242, v132, v133
  v_cvt_pk_bf16_f32 v243, v134, v135
  s_nop 0
  v_permlane16_swap_b32 v240, v242
  v_permlane16_swap_b32_e64 v241, v243
  buffer_store_dwordx4 v[240:243], v3, s[64:67], s26 offen sc0 sc1
  s_add_u32 s26, s26, 0x10000
  v_cvt_pk_bf16_f32 v244, v136, v137
  v_cvt_pk_bf16_f32 v245, v138, v139
  v_cvt_pk_bf16_f32 v246, v140, v141
  v_cvt_pk_bf16_f32 v247, v142, v143
  s_nop 0
  v_permlane16_swap_b32 v244, v246
  v_permlane16_swap_b32_e64 v245, v247
  buffer_store_dwordx4 v[244:247], v3, s[64:67], s26 offen sc0 sc1
  s_add_u32 s26, s26, 0x10000
  v_cvt_pk_bf16_f32 v248, v144, v145
  v_cvt_pk_bf16_f32 v249, v146, v147
  v_cvt_pk_bf16_f32 v250, v148, v149
  v_cvt_pk_bf16_f32 v251, v150, v151
  s_nop 0
  v_permlane16_swap_b32 v248, v250
  v_permlane16_swap_b32_e64 v249, v251
  buffer_store_dwordx4 v[248:251], v3, s[64:67], s26 offen sc0 sc1
  s_add_u32 s26, s26, 0x10000
  v_cvt_pk_bf16_f32 v252, v152, v153
  v_cvt_pk_bf16_f32 v253, v154, v155
  v_cvt_pk_bf16_f32 v254, v156, v157
  v_cvt_pk_bf16_f32 v255, v158, v159
  s_nop 0
  v_permlane16_swap_b32 v252, v254
  v_permlane16_swap_b32_e64 v253, v255
  buffer_store_dwordx4 v[252:255], v3, s[64:67], s26 offen sc0 sc1
  s_endpgm
Lo_6:
  s_mov_b64 vcc, 0
  s_waitcnt lgkmcnt(0)
  s_barrier
  ds_read_b128 v[64:67], v4 offset:0
  ds_read_b128 v[80:83], v5 offset:0
  ds_read_b128 v[68:71], v4 offset:2048
  ds_read_b128 v[84:87], v5 offset:2048
  ds_read_b128 v[72:75], v4 offset:4096
  ds_read_b128 v[88:91], v5 offset:4096
  ds_read_b64_tr_b16 v[96:97], v6 offset:0
  ds_read_b64_tr_b16 v[98:99], v6 offset:2048
  ds_read_b64_tr_b16 v[100:101], v6 offset:4096
  ds_read_b64_tr_b16 v[102:103], v6 offset:6144
  ds_read_b128 v[76:79], v4 offset:6144
  ds_read_b128 v[92:95], v5 offset:6144
  ds_read_b64_tr_b16 v[104:105], v7 offset:0
  s_nop 0
  s_waitcnt lgkmcnt(8)
  ds_read_b64_tr_b16 v[106:107], v7 offset:2048
  ds_read_b64_tr_b16 v[108:109], v7 offset:4096
  ds_read_b64_tr_b16 v[110:111], v7 offset:6144
  s_waitcnt lgkmcnt(6)
  s_branch Lk_3
Lo_8:
  s_waitcnt lgkmcnt(0)
  s_branch Lo_7
Lx_30:
  s_mov_b64 exec, -1
  v_readfirstlane_b32 s5, v32
  s_sub_u32 s89, s89, 1
  s_cbranch_scc1 Lx_32
  buffer_load_dword v32, off, s[40:43], s13 sc0 sc1
  buffer_load_dwordx4 v[176:179], v0, s[40:43], s8 offen offset:0 sc0 sc1
  buffer_load_dwordx4 v[180:183], v0, s[40:43], s8 offen offset:2048 sc0 sc1
  buffer_load_dwordx4 v[184:187], v0, s[40:43], s9 offen offset:0 sc0 sc1
  buffer_load_dwordx4 v[188:191], v0, s[40:43], s9 offen offset:2048 sc0 sc1
  s_waitcnt vmcnt(0)
  s_cmp_lg_u32 s5, 0
  s_cbranch_scc1 Lx_32
  s_branch Lx_31
  s_nop 0
L_w1:
  s_lshl_b32 s11, s85, 12
  s_add_u32 s11, s11, 65536
  s_add_u32 s15, s11, 81920
  s_add_u32 s11, s11, 32768
  v_readfirstlane_b32 s7, v38
  s_mov_b32 s12, 0
  s_mov_b32 m0, s11
  s_waitcnt vmcnt(12)
  s_barrier
  s_branch Ll_47
Lt_54:
  s_cmp_lg_u32 s12, 2
  s_cbranch_scc1 Lt_52
  s_waitcnt vmcnt(8)
  s_barrier
  s_branch Ll_47
Lt_52:
  s_cmp_lg_u32 s12, 4
  s_cbranch_scc1 Ll_47
  s_barrier
Ll_47:
  buffer_load_dwordx4 v4, s[52:55], s7 offen offset:0  lds
  s_mov_b32 s5, s7
  buffer_load_dwordx4 v5, s[52:55], s5 offen offset:1024  lds
  s_add_u32 s12, s12, 1
  v_readlane_b32 s7, v38, s12
  s_add_u32 s11, s11, 8192
  s_nop 0
  s_cmp_eq_u32 s11, s15
  buffer_load_dwordx4 v6, s[52:55], s5 offen offset:2048  lds
  s_cselect_b32 s4, 81920, 0
  s_sub_u32 s11, s11, s4
  s_cmp_lg_u32 s12, 10
  buffer_load_dwordx4 v7, s[52:55], s5 offen offset:3072  lds
  s_mov_b32 m0, s11
  s_cbranch_scc1 Lt_54
Lt_55:
  v_mov_b32 v2, 156416
  v_mov_b32_e64 v3, 1
  s_waitcnt vmcnt(16)
  s_mov_b64 exec, 1
  ds_add_u32 v2, v3 offset:8
  s_mov_b64 exec, -1
  s_barrier
Ll_49:
  buffer_load_dwordx4 v4, s[52:55], s7 offen offset:0  lds
  s_mov_b32 s5, s7
  buffer_load_dwordx4 v5, s[52:55], s5 offen offset:1024  lds
  s_add_u32 s12, s12, 1
  v_readlane_b32 s7, v38, s12
  s_add_u32 s11, s11, 8192
  s_nop 0
  s_cmp_eq_u32 s11, s15
  buffer_load_dwordx4 v6, s[52:55], s5 offen offset:2048  lds
  s_cselect_b32 s4, 81920, 0
  s_sub_u32 s11, s11, s4
  s_cmp_lg_u32 s12, 16
  buffer_load_dwordx4 v7, s[52:55], s5 offen offset:3072  lds
  s_mov_b32 m0, s11
  s_cbranch_scc1 Ll_49
  v_lshrrev_b32 v2, 3, v1
  s_movk_i32 s4, 7168
  v_mad_u32_u24 v32, v2, s4, v10
  v_add_u32 v33, 56320, v32
  v_add_u32 v34, 112640, v32
  v_add_u32 v35, 168960, v32
  v_lshrrev_b32 v2, 2, v1
  s_movk_i32 s4, 7168
  v_mul_u32_u24_e64 v2, s4, v2
  v_bfe_u32 v3, v10, 5, 1
  v_lshl_add_u32 v2, v3, 4, v2
  v_and_b32 v3, 1, v1
  v_lshlrev_b32 v3, 5, v3
  v_add_u32_e64 v8, v2, v3
  v_add_u32 v9, 113664, v8
  s_mul_i32 s5, s77, 448
  s_and_b32 s4, s77, Lz1-Lz0+1
  s_mul_i32 s94, s4, 448
  s_sub_u32 s94, 384, s94
  s_lshl_b32 s4, s4, 6
  s_add_u32 s5, s5, s4
  s_mul_i32 s4, s85, 229376
  s_add_u32 s5, s5, s4
  s_and_b32 s4, s76, 7
  s_add_u32 s6, s4, 1
  v_cmp_lt_u32 vcc, s6, v1
  v_add_u32 v12, s4, v1
  s_nop 0
  v_subbrev_co_u32 v12, vcc, 0, v12, vcc
  v_and_b32 v12, 7, v12
  v_subrev_u32 v2, 9, v1
  v_cmp_le_u32 vcc, s4, v2
  s_nop 1
  v_addc_co_u32 v2, vcc, 8, v2, vcc
  v_cmp_le_u32 vcc, 9, v1
  s_nop 1
  v_cndmask_b32 v12, v12, v2, vcc
  s_add_u32 s4, s4, 8
  s_mov_b32 m0, s6
  s_nop 0
  v_writelane_b32 v12, s4, m0
  s_and_b32 s4, s76, 8
  v_xor_b32 v12, s4, v12
  v_cmp_eq_u32 vcc, s78, v12
  s_nop 0
  v_mov_b32_dpp v2, v12 row_shr:1 row_mask:0xf bank_mask:0xf
  s_ff1_i32_b32 s4, vcc_lo
  v_cmp_ge_u32 vcc, s4, v1
  s_nop 1
  v_cndmask_b32 v12, v12, v2, vcc
  v_writelane_b32 v12, s78, 0
  s_mov_b32 s4, 458752
  v_mul_u32_u24 v12, s4, v12
  v_add_u32 v12, s5, v12
  s_nop 0
  v_readfirstlane_b32 s7, v12
  s_lshl_b32 s11, s85, Lz1-Lz0+12
  s_add_u32 s11, s11, 65536
  s_add_u32 s15, s11, 86016
  s_lshl_b32 s4, s85, Lz1-Lz0+11
  s_sub_u32 s13, 24576, s4
  s_mul_i32 s5, s85, 6144
  s_nop 0
  s_mov_b32 s68, s28
  s_and_b32 s69, s29, 0xffff
  s_mov_b32 s70, 7340032
  s_mov_b32 s71, 0x00020000
  s_lshl_b32 s4, s76, 4
  s_add_u32 s4, s4, s77
  s_mul_i32 s34, s4, 28672
  s_add_u32 s34, s34, s5
  v_lshlrev_b32 v15, 4, v1
  s_lshl_b32 s91, s85, Lz1-Lz0+13
  s_add_u32 s91, s91, 4096
  s_mul_i32 s4, s76, 262144
  s_add_u32 s4, s4, 3145728
  s_add_u32 s4, s4, s91
  v_lshl_add_u32 v14, v39, 14, s4
  s_mov_b32 s12, 4
Lh_56:
  v_readlane_b32 s90, v14, s12
  s_mov_b32 m0, s91
  s_cmp_lt_u32 s12, Lz1-Lz0+7
  s_cbranch_scc1 Lh_57
  s_waitcnt vmcnt(8)
Lh_57:
  s_barrier
  buffer_load_dwordx4 v15, s[40:43], s90 offen offset:0 sc1 lds
  s_add_u32 s91, s91, 16384
  s_and_b32 s91, s91, 0xffff
  buffer_load_dwordx4 v15, s[40:43], s90 offen offset:1024 sc1 lds
  s_add_u32 s12, s12, 1
  s_cmp_lg_u32 s12, 16
  buffer_load_dwordx4 v15, s[40:43], s90 offen offset:2048 sc1 lds
  buffer_load_dwordx4 v15, s[40:43], s90 offen offset:3072 sc1 lds
  s_cbranch_scc1 Lh_56
  s_mov_b32 s12, 0
  s_mov_b32 m0, s11
  s_branch Ll_58
Lt_64:
  s_cmp_lg_u32 s12, 1
  s_cbranch_scc1 Ll_58
  s_waitcnt vmcnt(18)
  s_barrier
Ll_58:
  buffer_load_dwordx4 v32, s[56:59], s7 offen offset:0  lds
  buffer_load_dwordx4 v33, s[56:59], s7 offen offset:1024  lds
  buffer_load_dwordx4 v34, s[56:59], s7 offen offset:2048  lds
  buffer_load_dwordx4 v35, s[56:59], s7 offen offset:3072  lds
  s_add_u32 m0, s11, s13
  s_add_u32 s5, s7, s94
  buffer_load_dwordx4 v8, s[56:59], s5 offen offset:0  lds
  buffer_load_dwordx4 v9, s[56:59], s5 offen offset:1024  lds
  s_cmp_ge_u32 s12, Lz1-Lz0+2
  s_cbranch_scc1 Lm_65
  s_waitcnt vmcnt(20)
  s_cmp_lg_u32 s12, 0
  s_cbranch_scc1 Lm_66
  s_waitcnt vmcnt(14)
Lm_66:
  s_barrier
Lm_65:
  s_add_u32 m0, s11, 8192
  s_add_u32 s5, s7, 128
  buffer_load_dwordx4 v32, s[56:59], s5 offen offset:0  lds
  buffer_load_dwordx4 v33, s[56:59], s5 offen offset:1024  lds
  buffer_load_dwordx4 v34, s[56:59], s5 offen offset:2048  lds
  buffer_load_dwordx4 v35, s[56:59], s5 offen offset:3072  lds
  s_add_u32 m0, s11, 16384
  s_add_u32 s5, s7, 256
  buffer_load_dwordx4 v32, s[56:59], s5 offen offset:0  lds
  s_add_u32 s12, s12, Lz1-Lz0+1
  v_readlane_b32 s7, v12, s12
  s_add_u32 s11, s11, 28672
  buffer_load_dwordx4 v33, s[56:59], s5 offen offset:1024  lds
  s_cmp_eq_u32 s11, s15
  s_cselect_b32 s4, 86016, 0
  s_sub_u32 s11, s11, s4
  buffer_load_dwordx4 v34, s[56:59], s5 offen offset:2048  lds
  s_cmp_lg_u32 s12, Lz1-Lz0+2
  buffer_load_dwordx4 v35, s[56:59], s5 offen offset:3072  lds
  s_mov_b32 m0, s11
  s_cbranch_scc1 Ll_59
  s_barrier
Lt_67:
  s_waitcnt vmcnt(0)
  s_barrier
Ll_68:
Ll_59:
  s_cmp_lt_u32 s12, 3
  s_cbranch_scc1 Lt_64
  s_cmp_lg_u32 s82, 0
  s_cbranch_scc1 L_69
  s_lshl_b32 s5, s78, 7
  s_mul_i32 s4, s79, 3670016
  s_add_u32 s5, s5, s4
  v_subrev_u32 v2, 2, v1
  v_cmp_le_u32 vcc, 28, v1
  s_nop 1
  v_cndmask_b32 v37, v1, v2, vcc
  v_subrev_u32 v3, 3, v37
  v_mov_b32 v36, 4
  v_cmp_le_u32 vcc, 14, v37
  v_subrev_u32 v2, 14, v37
  s_nop 0
  v_cndmask_b32_e64 v3, v3, v2, vcc
  v_cndmask_b32_e64 v36, v36, 12, vcc
  v_cmp_le_u32 vcc, 21, v37
  v_subrev_u32 v2, 21, v37
  s_nop 0
  v_cndmask_b32 v3, v3, v2, vcc
  v_cndmask_b32_e64 v36, v36, 20, vcc
  s_sub_u32 s4, s80, s76
  s_and_b32 s4, s4, 7
  v_cmp_le_u32 vcc, s4, v3
  v_mov_b32 v2, s76
  s_nop 0
  v_addc_co_u32 v3, vcc, v3, v2, vcc
  v_and_b32 v3, 7, v3
  v_add_u32 v36, v36, v3
  v_add_u32 v2, v2, v1
  v_and_b32 v2, 3, v2
  v_subrev_u32 v3, 10, v1
  v_cmp_gt_u32 vcc, 4, v3
  s_nop 1
  v_cndmask_b32 v36, v36, v2, vcc
  s_add_u32 s4, s80, Lz1-Lz0+4
  v_lshl_add_u32 v2, v1, 3, s4
  v_cmp_gt_u32 vcc, 3, v1
  s_nop 1
  v_cndmask_b32 v36, v36, v2, vcc
  v_subrev_u32 v2, 4, v36
  v_and_b32 v3, 7, v2
  v_lshrrev_b32 v2, 3, v2
  v_mad_u32_u24 v2, v3, 7, v2
  v_and_b32 v3, 1, v3
  v_add_u32 v2, v2, v3
  s_mul_i32 s4, s85, 3
  v_add_u32 v2, s4, v2
  s_add_u32 s4, s85, Lz1-Lz0+6
  v_mad_u32_u24 v3, v36, 14, s4
  v_cmp_gt_u32 vcc, 4, v36
  s_nop 1
  v_cndmask_b32_e64 v2, v2, v3, vcc
  v_lshl_add_u32 v36, v2, 16, s5
  s_mul_i32 s4, s79, 7340032
  s_sub_u32 s4, 3670016, s4
  v_add_u32 v2, s4, v36
  v_cmp_le_u32 vcc, 28, v1
  s_nop 1
  v_cndmask_b32 v36, v36, v2, vcc
L_69:
  s_waitcnt vmcnt(14)
  s_barrier
  buffer_load_dwordx4 v32, s[56:59], s7 offen offset:0  lds
  buffer_load_dwordx4 v33, s[56:59], s7 offen offset:1024  lds
  buffer_load_dwordx4 v34, s[56:59], s7 offen offset:2048  lds
  buffer_load_dwordx4 v35, s[56:59], s7 offen offset:3072  lds
Ll_70:
  s_add_u32 m0, s11, s13
  s_add_u32 s5, s7, s94
  buffer_load_dwordx4 v8, s[56:59], s5 offen offset:0  lds
  buffer_load_dwordx4 v9, s[56:59], s5 offen offset:1024  lds
  s_add_u32 m0, s11, 8192
  s_add_u32 s5, s7, 128
  buffer_load_dwordx4 v32, s[56:59], s5 offen offset:0  lds
  buffer_load_dwordx4 v33, s[56:59], s5 offen offset:1024  lds
  buffer_load_dwordx4 v34, s[56:59], s5 offen offset:2048  lds
  buffer_load_dwordx4 v35, s[56:59], s5 offen offset:3072  lds
  s_add_u32 m0, s11, 16384
  s_add_u32 s5, s7, 256
  buffer_load_dwordx4 v32, s[56:59], s5 offen offset:0  lds
  s_add_u32 s12, s12, Lz1-Lz0+1
  v_readlane_b32 s7, v12, s12
  s_add_u32 s11, s11, 28672
  buffer_load_dwordx4 v33, s[56:59], s5 offen offset:1024  lds
  s_cmp_eq_u32 s11, s15
  s_cselect_b32 s4, 86016, 0
  s_sub_u32 s11, s11, s4
  buffer_load_dwordx4 v34, s[56:59], s5 offen offset:2048  lds
  s_cmp_eq_u32 s12, Lz1-Lz0+16
  buffer_load_dwordx4 v35, s[56:59], s5 offen offset:3072  lds
  s_mov_b32 m0, s11
  s_cbranch_scc1 Ll_71
  s_cmp_lg_u32 s82, 0
  s_cbranch_scc1 L_72
  s_buffer_load_dwordx2 s[98:99], s[68:71], s34 offset:60
  s_buffer_load_dwordx2 s[98:99], s[68:71], s34 offset:188
  s_buffer_load_dwordx2 s[98:99], s[68:71], s34 offset:316
  s_buffer_load_dwordx2 s[98:99], s[68:71], s34 offset:444
  s_add_u32 s34, s34, 512
L_72:
  s_waitcnt vmcnt(14)
  s_barrier
  buffer_load_dwordx4 v32, s[56:59], s7 offen offset:0  lds
  buffer_load_dwordx4 v33, s[56:59], s7 offen offset:1024  lds
  buffer_load_dwordx4 v34, s[56:59], s7 offen offset:2048  lds
  buffer_load_dwordx4 v35, s[56:59], s7 offen offset:3072  lds
  s_branch Ll_70
Ll_71:
  s_lshl_b32 s94, s79, 8
  s_sub_u32 s94, 128, s94
  s_lshl_b32 s11, s85, Lz1-Lz0+12
  s_add_u32 s11, s11, 65536
  s_add_u32 s15, s11, 81920
  s_add_u32 s11, s11, 49152
  v_readfirstlane_b32 s7, v36
  s_mov_b32 s12, 0
  s_mov_b32 m0, s11
  s_waitcnt vmcnt(14)
  s_barrier
  s_waitcnt vmcnt(0)
  s_barrier
  s_branch Ll_73
  s_nop 0
Lt_79:
  s_cmp_lg_u32 s12, 2
  s_cbranch_scc1 Ll_73
  s_barrier
Ll_73:
  buffer_load_dwordx4 v4, s[60:63], s7 offen offset:0  lds
  buffer_load_dwordx4 v5, s[60:63], s7 offen offset:1024  lds
  buffer_load_dwordx4 v6, s[60:63], s7 offen offset:2048  lds
  buffer_load_dwordx4 v7, s[60:63], s7 offen offset:3072  lds
  s_add_u32 m0, s11, 8192
  s_add_u32 s5, s7, s94
  buffer_load_dwordx4 v4, s[60:63], s5 offen offset:0  lds
  s_add_u32 s12, s12, 1
  v_readlane_b32 s7, v36, s12
  s_add_u32 s11, s11, 16384
  buffer_load_dwordx4 v5, s[60:63], s5 offen offset:1024  lds
  s_cmp_eq_u32 s11, s15
  s_cselect_b32 s4, 81920, 0
  s_sub_u32 s11, s11, s4
  buffer_load_dwordx4 v6, s[60:63], s5 offen offset:2048  lds
  s_cmp_lg_u32 s12, Lz1-Lz0+5
  buffer_load_dwordx4 v7, s[60:63], s5 offen offset:3072  lds
  s_mov_b32 m0, s11
  s_cbranch_scc1 Lt_79
Lt_80:
  s_cmp_lg_u32 s82, 0
  s_cbranch_scc1 L_81
  v_lshrrev_b32 v2, 3, v1
  s_movk_i32 s4, 6144
  v_mad_u32_u24 v16, v2, s4, v10
  v_add_u32 v17, 48128, v16
  v_add_u32 v18, 96256, v16
  v_add_u32 v19, 144384, v16
  s_lshl_b32 s5, s77, Lz1-Lz0+7
  s_mul_i32 s4, s85, 196608
  s_add_u32 s5, s5, s4
  s_and_b32 s4, s76, 7
  s_add_u32 s6, s4, 1
  v_cmp_lt_u32 vcc, s6, v1
  v_add_u32 v20, s4, v1
  s_nop 0
  v_subbrev_co_u32 v20, vcc, 0, v20, vcc
  v_and_b32 v20, 7, v20
  v_subrev_u32 v2, 9, v1
  v_cmp_le_u32 vcc, s4, v2
  s_nop 1
  v_addc_co_u32 v2, vcc, 8, v2, vcc
  v_cmp_le_u32 vcc, 9, v1
  s_nop 1
  v_cndmask_b32 v20, v20, v2, vcc
  s_add_u32 s4, s4, 8
  s_mov_b32 m0, s6
  s_nop 0
  v_writelane_b32 v20, s4, m0
  s_and_b32 s4, s76, 8
  v_xor_b32 v20, s4, v20
  v_cmp_eq_u32 vcc, s78, v20
  s_nop 0
  v_mov_b32_dpp v2, v20 row_shr:1 row_mask:0xf bank_mask:0xf
  s_ff1_i32_b32 s4, vcc_lo
  v_cmp_ge_u32 vcc, s4, v1
  s_nop 1
  v_cndmask_b32 v20, v20, v2, vcc
  v_writelane_b32 v20, s78, 0
  s_mov_b32 s4, 393216
  v_mul_u32_u24_e64 v20, s4, v20
  v_add_u32 v20, s5, v20
  s_mov_b32 m0, s11
L_81:
  s_waitcnt vmcnt(32)
  s_barrier
Ll_82:
  s_waitcnt vmcnt(24)
  s_barrier
  buffer_load_dwordx4 v4, s[60:63], s7 offen offset:0  lds
  buffer_load_dwordx4 v5, s[60:63], s7 offen offset:1024  lds
  buffer_load_dwordx4 v6, s[60:63], s7 offen offset:2048  lds
  buffer_load_dwordx4 v7, s[60:63], s7 offen offset:3072  lds
Ll_83:
  s_add_u32 m0, s11, 8192
  s_add_u32 s5, s7, s94
  buffer_load_dwordx4 v4, s[60:63], s5 offen offset:0  lds
  s_add_u32 s12, s12, 1
  v_readlane_b32 s7, v36, s12
  s_add_u32 s11, s11, 16384
  buffer_load_dwordx4 v5, s[60:63], s5 offen offset:1024  lds
  s_cmp_eq_u32 s11, s15
  s_cselect_b32 s4, 81920, 0
  s_sub_u32 s11, s11, s4
  buffer_load_dwordx4 v6, s[60:63], s5 offen offset:2048  lds
  s_cmp_eq_u32 s12, Lz1-Lz0+26
  buffer_load_dwordx4 v7, s[60:63], s5 offen offset:3072  lds
  s_mov_b32 m0, s11
  s_cbranch_scc1 Ll_84
  s_waitcnt vmcnt(24)
  s_barrier
  buffer_load_dwordx4 v4, s[60:63], s7 offen offset:0  lds
  buffer_load_dwordx4 v5, s[60:63], s7 offen offset:1024  lds
  buffer_load_dwordx4 v6, s[60:63], s7 offen offset:2048  lds
  buffer_load_dwordx4 v7, s[60:63], s7 offen offset:3072  lds
  s_branch Ll_83
  s_nop 0
Ll_84:
  s_waitcnt vmcnt(24)
  s_barrier
  buffer_load_dwordx4 v4, s[60:63], s7 offen offset:0  lds
Ll_85:
  s_mov_b32 s5, s7
  buffer_load_dwordx4 v5, s[60:63], s5 offen offset:1024  lds
  s_add_u32 s12, s12, 1
  v_readlane_b32 s7, v36, s12
  s_add_u32 s11, s11, 16384
  s_nop 0
  s_cmp_eq_u32 s11, s15
  buffer_load_dwordx4 v6, s[60:63], s5 offen offset:2048  lds
  s_cselect_b32 s4, 81920, 0
  s_sub_u32 s11, s11, s4
  s_cmp_eq_u32 s12, 30
  buffer_load_dwordx4 v7, s[60:63], s5 offen offset:3072  lds
  s_mov_b32 m0, s11
  s_cbranch_scc1 Ll_86
  s_waitcnt vmcnt(12)
  s_barrier
  buffer_load_dwordx4 v4, s[60:63], s7 offen offset:0  lds
  s_branch Ll_85
  s_nop 0
Ll_86:
  v_readfirstlane_b32 s7, v20
  s_lshl_b32 s11, s85, 12
  s_add_u32 s11, s11, 65536
  s_add_u32 s15, s11, 73728
  s_cmp_eq_u32 s82, 0
  s_mov_b32 s82, 1
  s_cbranch_scc1 L_wlayer
  s_waitcnt vmcnt(12)
  s_barrier
  s_waitcnt vmcnt(8)
  s_barrier
  s_waitcnt vmcnt(4)
  s_barrier
  s_waitcnt vmcnt(0)
  s_barrier
  s_barrier
  s_branch L_lend
  s_nop 0
L_x1:
  s_and_b32 s4, s77, 7
  s_lshr_b32 s5, s77, 3
  s_lshl1_add_u32 s4, s4, s5
  s_lshl_b32 s5, s76, 11
  s_add_u32 s4, s4, s5
  s_lshl_b32 s7, s4, 7
  s_movk_i32 s11, 16384
  s_mov_b32 m0, s11
  s_cmp_eq_u32 s82, 0
  s_waitcnt vmcnt(32)
  s_barrier
  s_waitcnt vmcnt(16)
  s_barrier
  s_cbranch_scc1 L_96
  s_waitcnt vmcnt(0)
  s_barrier
  s_barrier
  s_branch L_97
L_96:
  buffer_load_dwordx4 v4, s[72:75], s7 offen offset:0 sc1 lds
  buffer_load_dwordx4 v5, s[72:75], s7 offen offset:1024 sc1 lds
  buffer_load_dwordx4 v6, s[72:75], s7 offen offset:2048 sc1 lds
  buffer_load_dwordx4 v7, s[72:75], s7 offen offset:3072 sc1 lds
  s_add_u32 m0, s11, 4096
  s_nop 0
  s_add_u32 s5, s7, s13
  buffer_load_dwordx4 v4, s[72:75], s5 offen offset:0 sc1 lds
  buffer_load_dwordx4 v5, s[72:75], s5 offen offset:1024 sc1 lds
  buffer_load_dwordx4 v6, s[72:75], s5 offen offset:2048 sc1 lds
  buffer_load_dwordx4 v7, s[72:75], s5 offen offset:3072 sc1 lds
  s_add_u32 m0, s11, 8192
  s_nop 0
  s_add_u32 s3, s7, s95
  buffer_load_dwordx4 v4, s[72:75], s3 offen offset:0 sc1 lds
  buffer_load_dwordx4 v5, s[72:75], s3 offen offset:1024 sc1 lds
  buffer_load_dwordx4 v6, s[72:75], s3 offen offset:2048 sc1 lds
  buffer_load_dwordx4 v7, s[72:75], s3 offen offset:3072 sc1 lds
  s_add_u32 m0, s11, 12288
  s_nop 0
  s_add_u32 s5, s3, s13
  buffer_load_dwordx4 v4, s[72:75], s5 offen offset:0 sc1 lds
  buffer_load_dwordx4 v5, s[72:75], s5 offen offset:1024 sc1 lds
  buffer_load_dwordx4 v6, s[72:75], s5 offen offset:2048 sc1 lds
  buffer_load_dwordx4 v7, s[72:75], s5 offen offset:3072 sc1 lds
  s_waitcnt vmcnt(16)
  s_barrier
  s_waitcnt vmcnt(0)
  s_barrier
L_97:
  s_cmp_lg_u32 s82, 0
  s_cbranch_scc1 L_98
  s_and_b32 s80, s77, 7
  s_lshr_b32 s79, s77, 3
  s_lshl_b32 s78, s80, 1
  s_add_u32 s78, s78, s79
  s_lshl_b32 s5, s76, 4
  s_add_u32 s5, s5, s77
  s_lshl_b32 s84, s5, Lz1-Lz0+11
  s_mov_b32 s83, 3145728
  s_mov_b32 s87, 1835016
  s_lshr_b32 s86, s81, 1
  v_lshlrev_b32 v4, 4, v1
  v_lshlrev_b32 v5, 4, v1
  v_lshlrev_b32 v6, 4, v1
  v_lshlrev_b32 v7, 4, v1
  s_movk_i32 s13, 4096
  s_movk_i32 s95, 8192
  v_and_b32 v2, 31, v1
  v_lshlrev_b32 v8, 7, v2
L_98:
  s_mov_b32 s40, s38
  s_and_b32 s41, s39, 0xffff
  s_mov_b32 s42, 100663296
  s_mov_b32 s43, 0x00020000
  s_mov_b32 s72, s40
  s_mov_b32 s73, s41
  s_mov_b32 s74, s42
  s_mov_b32 s11, 0
  s_mov_b32 s15, 65536
  s_mul_i32 s5, s76, 16
  s_lshl_b32 s5, s5, 14
  s_add_u32 s5, s5, 3145728
  s_mul_i32 s4, s76, 14
  s_lshr_b32 s4, s4, 4
  v_add_u32 v9, s4, v1
  v_subrev_u32 v2, 14, v9
  v_min_u32 v9, v9, v2
  v_cmp_le_u32 vcc, 14, v1
  s_nop 1
  v_cndmask_b32 v9, v9, v1, vcc
  v_lshlrev_b32_e64 v9, 2, v9
  v_mov_b32 v2, 0x87654210
  v_mov_b32 v3, 0xb3fedca9
  v_lshrrev_b64 v[2:3], v9, v[2:3]
  v_and_b32_e64 v9, 15, v2
  v_cmp_eq_u32 vcc, s77, v9
  s_nop 0
  v_mov_b32_dpp v2, v9 row_shr:1 row_mask:0xf bank_mask:0xf
  s_ff1_i32_b32 s4, vcc_lo
  v_cmp_ge_u32 vcc, s4, v1
  s_nop 1
  v_cndmask_b32 v9, v9, v2, vcc
  v_writelane_b32 v9, s77, 0
  v_lshlrev_b32 v11, 7, v9
  v_lshl_add_u32 v9, v9, 14, s5
  s_nop 0
  v_readlane_b32 s7, v9, 1
  s_mov_b32 s11, 16384
  s_mov_b32 s90, 0xfe
  s_lshl_b32 s91, s84, Lz1-Lz0+1
  s_add_u32 s91, s91, s87
  s_barrier
  s_mov_b32 s89, 200000
  s_mov_b32 exec_lo, s90
  s_mov_b32 exec_hi, 0
  buffer_load_dword v12, v11, s[40:43], s91 offen sc0 sc1
Lp_99:
  s_waitcnt vmcnt(0)
  v_cmp_ne_u32 vcc, 0, v12
  s_andn2_b32 s3, exec_lo, vcc_lo
  s_cbranch_scc0 Lp_100
  s_mov_b32 exec_lo, s3
  s_sleep 1
  buffer_load_dword v12, v11, s[40:43], s91 offen sc0 sc1
  s_sub_u32 s89, s89, 1
  s_cbranch_scc0 Lp_99
Lp_100:
  s_mov_b64 exec, -1
  s_mov_b32 s12, 1
  s_mov_b32 m0, s11
Ll_102:
  s_nop 0
  buffer_load_dwordx4 v4, s[40:43], s7 offen offset:0 sc1 lds
  buffer_load_dwordx4 v5, s[40:43], s7 offen offset:1024 sc1 lds
  buffer_load_dwordx4 v6, s[40:43], s7 offen offset:2048 sc1 lds
  buffer_load_dwordx4 v7, s[40:43], s7 offen offset:3072 sc1 lds
  s_add_u32 m0, s11, 4096
  s_nop 0
  s_add_u32 s5, s7, s13
  buffer_load_dwordx4 v4, s[40:43], s5 offen offset:0 sc1 lds
  buffer_load_dwordx4 v5, s[40:43], s5 offen offset:1024 sc1 lds
  buffer_load_dwordx4 v6, s[40:43], s5 offen offset:2048 sc1 lds
  buffer_load_dwordx4 v7, s[40:43], s5 offen offset:3072 sc1 lds
  s_add_u32 m0, s11, 8192
  s_nop 0
  s_add_u32 s3, s7, s95
  buffer_load_dwordx4 v4, s[40:43], s3 offen offset:0 sc1 lds
  buffer_load_dwordx4 v5, s[40:43], s3 offen offset:1024 sc1 lds
  buffer_load_dwordx4 v6, s[40:43], s3 offen offset:2048 sc1 lds
  buffer_load_dwordx4 v7, s[40:43], s3 offen offset:3072 sc1 lds
  s_add_u32 m0, s11, 12288
  s_add_u32 s5, s3, s13
  buffer_load_dwordx4 v4, s[40:43], s5 offen offset:0 sc1 lds
  s_add_u32 s12, s12, 1
  v_readlane_b32 s7, v9, s12
  s_add_u32 s11, s11, 16384
  buffer_load_dwordx4 v5, s[40:43], s5 offen offset:1024 sc1 lds
  s_cmp_eq_u32 s11, s15
  s_cselect_b32 s4, 65536, 0
  s_sub_u32 s11, s11, s4
  buffer_load_dwordx4 v6, s[40:43], s5 offen offset:2048 sc1 lds
  s_cmp_lg_u32 s12, Lz1-Lz0+4
  buffer_load_dwordx4 v7, s[40:43], s5 offen offset:3072 sc1 lds
  s_mov_b32 m0, s11
  s_cbranch_scc1 Ll_102
  s_waitcnt vmcnt(32)
  s_barrier
  buffer_load_dwordx4 v4, s[40:43], s7 offen offset:0 sc1 lds
  buffer_load_dwordx4 v5, s[40:43], s7 offen offset:1024 sc1 lds
  buffer_load_dwordx4 v6, s[40:43], s7 offen offset:2048 sc1 lds
  buffer_load_dwordx4 v7, s[40:43], s7 offen offset:3072 sc1 lds
  s_add_u32 m0, s11, 8192
  s_add_u32 s3, s7, s95
  buffer_load_dwordx4 v4, s[40:43], s3 offen offset:0 sc1 lds
  s_add_u32 s12, s12, 1
  v_readlane_b32 s7, v9, s12
  buffer_load_dwordx4 v5, s[40:43], s3 offen offset:1024 sc1 lds
  s_add_u32 s11, s11, 16384
  s_nop 0
  s_cmp_eq_u32 s11, s15
  buffer_load_dwordx4 v6, s[40:43], s3 offen offset:2048 sc1 lds
  s_cselect_b32 s4, 65536, 0
  s_sub_u32 s11, s11, s4
  buffer_load_dwordx4 v7, s[40:43], s3 offen offset:3072 sc1 lds
  s_mov_b32 m0, s11
  s_waitcnt vmcnt(24)
  s_barrier
  buffer_load_dwordx4 v4, s[40:43], s7 offen offset:0 sc1 lds
  buffer_load_dwordx4 v5, s[40:43], s7 offen offset:1024 sc1 lds
  buffer_load_dwordx4 v6, s[40:43], s7 offen offset:2048 sc1 lds
  buffer_load_dwordx4 v7, s[40:43], s7 offen offset:3072 sc1 lds
Ll_107:
  s_add_u32 m0, s11, 8192
  s_add_u32 s3, s7, s95
  buffer_load_dwordx4 v4, s[40:43], s3 offen offset:0 sc1 lds
  s_add_u32 s12, s12, 1
  v_readlane_b32 s7, v9, s12
  s_add_u32 s11, s11, 16384
  buffer_load_dwordx4 v5, s[40:43], s3 offen offset:1024 sc1 lds
  s_cmp_eq_u32 s11, s15
  s_cselect_b32 s4, 65536, 0
  s_sub_u32 s11, s11, s4
  buffer_load_dwordx4 v6, s[40:43], s3 offen offset:2048 sc1 lds
  s_cmp_eq_u32 s12, Lz1-Lz0+16
  buffer_load_dwordx4 v7, s[40:43], s3 offen offset:3072 sc1 lds
  s_mov_b32 m0, s11
  s_cbranch_scc1 Ll_108
  s_waitcnt vmcnt(16)
  s_barrier
  buffer_load_dwordx4 v4, s[40:43], s7 offen offset:0 sc1 lds
  buffer_load_dwordx4 v5, s[40:43], s7 offen offset:1024 sc1 lds
  buffer_load_dwordx4 v6, s[40:43], s7 offen offset:2048 sc1 lds
  buffer_load_dwordx4 v7, s[40:43], s7 offen offset:3072 sc1 lds
  s_branch Ll_107
  s_nop 0
Ll_108:
  s_waitcnt vmcnt(16)
  s_barrier
  s_waitcnt vmcnt(8)
  s_barrier
  s_waitcnt vmcnt(0)
  s_barrier
  s_barrier
  s_mov_b32 s11, 0
  s_mov_b32 s15, 65536
  s_mul_i32 s5, s76, 16
  s_lshl_b32 s5, s5, 14
  s_add_u32 s5, s5, 7340032
  s_and_b32 s4, s76, 7
  s_add_u32 s6, s4, 1
  v_cmp_lt_u32 vcc, s6, v1
  v_add_u32 v9, s4, v1
  s_nop 0
  v_subbrev_co_u32 v9, vcc, 0, v9, vcc
  v_and_b32 v9, 7, v9
  v_subrev_u32 v2, 9, v1
  v_cmp_le_u32 vcc, s4, v2
  s_nop 1
  v_addc_co_u32 v2, vcc, 8, v2, vcc
  v_cmp_le_u32 vcc, 9, v1
  s_nop 1
  v_cndmask_b32 v9, v9, v2, vcc
  s_add_u32 s4, s4, Lz1-Lz0+8
  s_mov_b32 m0, s6
  s_nop 0
  v_writelane_b32 v9, s4, m0
  s_and_b32 s4, s76, 8
  v_xor_b32 v9, s4, v9
  v_cmp_eq_u32 vcc, s78, v9
  s_nop 0
  v_mov_b32_dpp v2, v9 row_shr:1 row_mask:0xf bank_mask:0xf
  s_ff1_i32_b32 s4, vcc_lo
  v_cmp_ge_u32 vcc, s4, v1
  s_nop 1
  v_cndmask_b32 v9, v9, v2, vcc
  v_writelane_b32 v9, s78, 0
  v_lshlrev_b32_e64 v11, 7, v9
  v_lshl_add_u32 v9, v9, 14, s5
  s_lshl_b32 s6, s76, Lz1-Lz0+14
  v_readlane_b32 s7, v9, 1
  s_mov_b32 s11, 16384
  s_mov_b32 s90, Lz1-Lz0+62
  s_add_u32 s91, s91, 4
  s_barrier
  s_mov_b32 s89, 200000
  s_mov_b32 exec_lo, s90
  s_mov_b32 exec_hi, 0
  buffer_load_dword v12, v11, s[40:43], s91 offen sc0 sc1
Lp_109:
  s_waitcnt vmcnt(0)
  v_cmp_ne_u32 vcc, 0, v12
  s_andn2_b32 s3, exec_lo, vcc_lo
  s_cbranch_scc0 Lp_110
  s_mov_b32 exec_lo, s3
  s_sleep 1
  buffer_load_dword v12, v11, s[40:43], s91 offen sc0 sc1
  s_sub_u32 s89, s89, 1
  s_cbranch_scc0 Lp_109
Lp_110:
  s_mov_b64 exec, -1
  s_mov_b32 s12, 1
  s_mov_b32 m0, s11
Ll_112:
  s_nop 0
  buffer_load_dwordx4 v4, s[72:75], s7 offen offset:0 sc1 lds
  buffer_load_dwordx4 v5, s[72:75], s7 offen offset:1024 sc1 lds
  buffer_load_dwordx4 v6, s[72:75], s7 offen offset:2048 sc1 lds
  buffer_load_dwordx4 v7, s[72:75], s7 offen offset:3072 sc1 lds
  s_add_u32 m0, s11, 4096
  s_nop 0
  s_add_u32 s5, s7, s13
  buffer_load_dwordx4 v4, s[72:75], s5 offen offset:0 sc1 lds
  buffer_load_dwordx4 v5, s[72:75], s5 offen offset:1024 sc1 lds
  buffer_load_dwordx4 v6, s[72:75], s5 offen offset:2048 sc1 lds
  buffer_load_dwordx4 v7, s[72:75], s5 offen offset:3072 sc1 lds
  s_add_u32 m0, s11, 8192
  s_nop 0
  s_add_u32 s3, s7, s95
  buffer_load_dwordx4 v4, s[72:75], s3 offen offset:0 sc1 lds
  buffer_load_dwordx4 v5, s[72:75], s3 offen offset:1024 sc1 lds
  buffer_load_dwordx4 v6, s[72:75], s3 offen offset:2048 sc1 lds
  buffer_load_dwordx4 v7, s[72:75], s3 offen offset:3072 sc1 lds
  s_add_u32 m0, s11, 12288
  s_add_u32 s5, s3, s13
  buffer_load_dwordx4 v4, s[72:75], s5 offen offset:0 sc1 lds
  s_add_u32 s12, s12, 1
  v_readlane_b32 s7, v9, s12
  s_add_u32 s11, s11, 16384
  buffer_load_dwordx4 v5, s[72:75], s5 offen offset:1024 sc1 lds
  s_cmp_eq_u32 s11, s15
  s_cselect_b32 s4, 65536, 0
  s_sub_u32 s11, s11, s4
  buffer_load_dwordx4 v6, s[72:75], s5 offen offset:2048 sc1 lds
  s_cmp_lg_u32 s12, Lz1-Lz0+4
  buffer_load_dwordx4 v7, s[72:75], s5 offen offset:3072 sc1 lds
  s_mov_b32 m0, s11
  s_cbranch_scc1 Ll_112
  s_waitcnt vmcnt(32)
  s_barrier
  buffer_load_dwordx4 v4, s[72:75], s7 offen offset:0 sc1 lds
  buffer_load_dwordx4 v5, s[72:75], s7 offen offset:1024 sc1 lds
  buffer_load_dwordx4 v6, s[72:75], s7 offen offset:2048 sc1 lds
  buffer_load_dwordx4 v7, s[72:75], s7 offen offset:3072 sc1 lds
Ll_117:
  s_add_u32 m0, s11, 4096
  s_nop 0
  s_add_u32 s5, s7, s13
  buffer_load_dwordx4 v4, s[72:75], s5 offen offset:0 sc1 lds
  buffer_load_dwordx4 v5, s[72:75], s5 offen offset:1024 sc1 lds
  buffer_load_dwordx4 v6, s[72:75], s5 offen offset:2048 sc1 lds
  buffer_load_dwordx4 v7, s[72:75], s5 offen offset:3072 sc1 lds
  s_add_u32 m0, s11, 8192
  s_nop 0
  s_add_u32 s3, s7, s95
  buffer_load_dwordx4 v4, s[72:75], s3 offen offset:0 sc1 lds
  buffer_load_dwordx4 v5, s[72:75], s3 offen offset:1024 sc1 lds
  buffer_load_dwordx4 v6, s[72:75], s3 offen offset:2048 sc1 lds
  buffer_load_dwordx4 v7, s[72:75], s3 offen offset:3072 sc1 lds
  s_add_u32 m0, s11, 12288
  s_add_u32 s5, s3, s13
  buffer_load_dwordx4 v4, s[72:75], s5 offen offset:0 sc1 lds
  s_add_u32 s12, s12, 1
  v_readlane_b32 s7, v9, s12
  s_add_u32 s11, s11, 16384
  buffer_load_dwordx4 v5, s[72:75], s5 offen offset:1024 sc1 lds
  s_cmp_eq_u32 s11, s15
  s_cselect_b32 s4, 65536, 0
  s_sub_u32 s11, s11, s4
  buffer_load_dwordx4 v6, s[72:75], s5 offen offset:2048 sc1 lds
  s_cmp_eq_u32 s12, Lz1-Lz0+16
  buffer_load_dwordx4 v7, s[72:75], s5 offen offset:3072 sc1 lds
  s_mov_b32 m0, s11
  s_cbranch_scc1 Ll_118
  s_waitcnt vmcnt(32)
  s_barrier
  buffer_load_dwordx4 v4, s[72:75], s7 offen offset:0 sc1 lds
  buffer_load_dwordx4 v5, s[72:75], s7 offen offset:1024 sc1 lds
  buffer_load_dwordx4 v6, s[72:75], s7 offen offset:2048 sc1 lds
  buffer_load_dwordx4 v7, s[72:75], s7 offen offset:3072 sc1 lds
  s_branch Ll_117
  s_nop 0
Ll_118:
  s_waitcnt vmcnt(32)
  s_barrier
  s_waitcnt vmcnt(16)
  s_barrier
  s_waitcnt vmcnt(0)
  s_barrier
  s_barrier
  s_mov_b32 s11, 0
  s_mov_b32 s15, 65536
  s_mul_i32 s5, s76, 56
  s_mul_i32 s4, s79, 28
  s_add_u32 s5, s5, s4
  s_lshl_b32 s5, s5, 14
  s_add_u32 s5, s5, 11534336
  v_subrev_u32 v2, 2, v1
  v_cmp_le_u32 vcc, 28, v1
  s_nop 1
  v_cndmask_b32 v10, v1, v2, vcc
  v_subrev_u32 v3, 3, v10
  v_mov_b32 v9, 4
  v_cmp_le_u32 vcc, 14, v10
  v_subrev_u32 v2, 14, v10
  s_nop 0
  v_cndmask_b32 v3, v3, v2, vcc
  v_cndmask_b32_e64 v9, v9, 12, vcc
  v_cmp_le_u32 vcc, 21, v10
  v_subrev_u32 v2, 21, v10
  s_nop 0
  v_cndmask_b32 v3, v3, v2, vcc
  v_cndmask_b32_e64 v9, v9, 20, vcc
  s_sub_u32 s4, s80, s76
  s_and_b32 s4, s4, 7
  v_cmp_le_u32 vcc, s4, v3
  v_mov_b32 v2, s76
  s_nop 0
  v_addc_co_u32 v3, vcc, v3, v2, vcc
  v_and_b32 v3, 7, v3
  v_add_u32 v9, v9, v3
  v_add_u32 v2, v2, v1
  v_and_b32 v2, 3, v2
  v_subrev_u32 v3, 10, v1
  v_cmp_gt_u32 vcc, 4, v3
  s_nop 1
  v_cndmask_b32 v9, v9, v2, vcc
  s_add_u32 s4, s80, Lz1-Lz0+4
  v_lshl_add_u32 v2, v1, 3, s4
  v_cmp_gt_u32 vcc, 3, v1
  s_nop 1
  v_cndmask_b32_e64 v9, v9, v2, vcc
  v_lshl_add_u32 v9, v9, 14, s5
  s_mul_i32 s4, s79, 917504
  s_sub_u32 s4, 458752, s4
  v_add_u32_e64 v2, s4, v9
  v_cmp_le_u32 vcc, 28, v1
  s_nop 1
  v_cndmask_b32 v9, v9, v2, vcc
  s_nop 0
  v_readlane_b32 s7, v9, 3
  s_mov_b32 s11, 49152
  s_add_u32 s91, s91, 4
  s_lshl_b32 s4, s79, 3
  s_lshl_b32 s90, 0xff, s4
  s_bitset0_b32 s90, s77
  v_mov_b32 v2, 156420
  s_lshl_b32 s5, s82, 2
  s_add_u32 s5, s5, Lz1-Lz0+1
  s_mov_b32 s89, 200000
  s_mov_b32 s92, 1
  s_mov_b32 exec_lo, s90
  s_mov_b32 exec_hi, Lz1-Lz0+0
  buffer_load_dword v12, v8, s[40:43], s91 offen sc0 sc1
Lp_119:
  s_waitcnt vmcnt(0)
  v_cmp_ne_u32 vcc, 0, v12
  s_andn2_b32 s3, exec_lo, vcc_lo
  s_cbranch_scc0 Lp_121
  s_mov_b32 exec_lo, s3
  s_cmp_eq_u32 s92, 0
  s_cbranch_scc1 Lp_120
  ds_read_b32 v3, v2
  s_waitcnt lgkmcnt(0)
  buffer_load_dword v12, v8, s[40:43], s91 offen sc0 sc1
  v_readfirstlane_b32 s4, v3
  s_cmp_lt_u32 s4, s5
  s_cbranch_scc1 Lp_122
  s_mov_b32 s92, 0
  s_barrier
  s_branch Lp_122
  s_nop 0
Lp_120:
  s_sleep 1
  buffer_load_dword v12, v8, s[40:43], s91 offen sc0 sc1
Lp_122:
  s_sub_u32 s89, s89, 1
  s_cbranch_scc0 Lp_119
Lp_121:
  s_mov_b64 exec, -1
  s_cmp_eq_u32 s92, 0
  s_cbranch_scc1 Lp_123
  s_barrier
Lp_123:
  s_mov_b32 s12, Lz1-Lz0+3
  s_mov_b32 m0, s11
Ll_124:
  s_nop 0
  buffer_load_dwordx4 v4, s[40:43], s7 offen offset:0 sc1 lds
  buffer_load_dwordx4 v5, s[40:43], s7 offen offset:1024 sc1 lds
  buffer_load_dwordx4 v6, s[40:43], s7 offen offset:2048 sc1 lds
  buffer_load_dwordx4 v7, s[40:43], s7 offen offset:3072 sc1 lds
  s_add_u32 m0, s11, 4096
  s_nop 0
  s_add_u32 s5, s7, s13
  buffer_load_dwordx4 v4, s[40:43], s5 offen offset:0 sc1 lds
  buffer_load_dwordx4 v5, s[40:43], s5 offen offset:1024 sc1 lds
  buffer_load_dwordx4 v6, s[40:43], s5 offen offset:2048 sc1 lds
  buffer_load_dwordx4 v7, s[40:43], s5 offen offset:3072 sc1 lds
  s_add_u32 m0, s11, 8192
  s_nop 0
  s_add_u32 s3, s7, s95
  buffer_load_dwordx4 v4, s[40:43], s3 offen offset:0 sc1 lds
  buffer_load_dwordx4 v5, s[40:43], s3 offen offset:1024 sc1 lds
  buffer_load_dwordx4 v6, s[40:43], s3 offen offset:2048 sc1 lds
  buffer_load_dwordx4 v7, s[40:43], s3 offen offset:3072 sc1 lds
  s_add_u32 m0, s11, 12288
  s_add_u32 s5, s3, s13
  buffer_load_dwordx4 v4, s[40:43], s5 offen offset:0 sc1 lds
  s_add_u32 s12, s12, 1
  v_readlane_b32 s7, v9, s12
  s_add_u32 s11, s11, 16384
  buffer_load_dwordx4 v5, s[40:43], s5 offen offset:1024 sc1 lds
  s_cmp_eq_u32 s11, s15
  s_cselect_b32 s4, 65536, 0
  s_sub_u32 s11, s11, s4
  buffer_load_dwordx4 v6, s[40:43], s5 offen offset:2048 sc1 lds
  s_cmp_lg_u32 s12, Lz1-Lz0+4
  buffer_load_dwordx4 v7, s[40:43], s5 offen offset:3072 sc1 lds
  s_mov_b32 m0, s11
  s_cbranch_scc1 Ll_124
  s_waitcnt vmcnt(32)
  s_barrier
  buffer_load_dwordx4 v4, s[40:43], s7 offen offset:0 sc1 lds
  buffer_load_dwordx4 v5, s[40:43], s7 offen offset:1024 sc1 lds
  buffer_load_dwordx4 v6, s[40:43], s7 offen offset:2048 sc1 lds
  buffer_load_dwordx4 v7, s[40:43], s7 offen offset:3072 sc1 lds
Ll_129:
  s_add_u32 m0, s11, 4096
  s_nop 0
  s_add_u32 s5, s7, s13
  buffer_load_dwordx4 v4, s[40:43], s5 offen offset:0 sc1 lds
  buffer_load_dwordx4 v5, s[40:43], s5 offen offset:1024 sc1 lds
  buffer_load_dwordx4 v6, s[40:43], s5 offen offset:2048 sc1 lds
  buffer_load_dwordx4 v7, s[40:43], s5 offen offset:3072 sc1 lds
  s_add_u32 m0, s11, 8192
  s_nop 0
  s_add_u32 s3, s7, s95
  buffer_load_dwordx4 v4, s[40:43], s3 offen offset:0 sc1 lds
  buffer_load_dwordx4 v5, s[40:43], s3 offen offset:1024 sc1 lds
  buffer_load_dwordx4 v6, s[40:43], s3 offen offset:2048 sc1 lds
  buffer_load_dwordx4 v7, s[40:43], s3 offen offset:3072 sc1 lds
  s_add_u32 m0, s11, 12288
  s_add_u32 s5, s3, s13
  buffer_load_dwordx4 v4, s[40:43], s5 offen offset:0 sc1 lds
  s_add_u32 s12, s12, 1
  v_readlane_b32 s7, v9, s12
  s_add_u32 s11, s11, 16384
  buffer_load_dwordx4 v5, s[40:43], s5 offen offset:1024 sc1 lds
  s_cmp_eq_u32 s11, s15
  s_cselect_b32 s4, 65536, 0
  s_sub_u32 s11, s11, s4
  buffer_load_dwordx4 v6, s[40:43], s5 offen offset:2048 sc1 lds
  s_cmp_eq_u32 s12, Lz1-Lz0+30
  buffer_load_dwordx4 v7, s[40:43], s5 offen offset:3072 sc1 lds
  s_mov_b32 m0, s11
  s_cbranch_scc1 Ll_130
  s_waitcnt vmcnt(32)
  s_barrier
  buffer_load_dwordx4 v4, s[40:43], s7 offen offset:0 sc1 lds
  buffer_load_dwordx4 v5, s[40:43], s7 offen offset:1024 sc1 lds
  buffer_load_dwordx4 v6, s[40:43], s7 offen offset:2048 sc1 lds
  buffer_load_dwordx4 v7, s[40:43], s7 offen offset:3072 sc1 lds
  s_branch Ll_129
  s_nop 0
Ll_130:
  s_waitcnt vmcnt(32)
  s_barrier
  s_waitcnt vmcnt(16)
  s_barrier
  s_waitcnt vmcnt(0)
  s_barrier
  s_barrier
  s_cmp_lg_u32 s82, 0
  s_cbranch_scc1 L_lend
  s_mov_b32 s11, 0
  s_mov_b32 s15, 65536
  s_mul_i32 s5, s76, 16
  s_lshl_b32 s5, s5, 14
  s_add_u32 s5, s5, 35651584
  s_and_b32 s4, s76, 7
  s_add_u32 s6, s4, 1
  v_cmp_lt_u32 vcc, s6, v1
  v_add_u32 v9, s4, v1
  s_nop 0
  v_subbrev_co_u32 v9, vcc, 0, v9, vcc
  v_and_b32 v9, 7, v9
  v_subrev_u32 v2, 9, v1
  v_cmp_le_u32 vcc, s4, v2
  s_nop 1
  v_addc_co_u32 v2, vcc, 8, v2, vcc
  v_cmp_le_u32 vcc, 9, v1
  s_nop 1
  v_cndmask_b32 v9, v9, v2, vcc
  s_add_u32 s4, s4, Lz1-Lz0+8
  s_mov_b32 m0, s6
  s_nop 0
  v_writelane_b32 v9, s4, m0
  s_and_b32 s4, s76, 8
  v_xor_b32 v9, s4, v9
  v_cmp_eq_u32 vcc, s78, v9
  s_nop 0
  v_mov_b32_dpp v2, v9 row_shr:1 row_mask:0xf bank_mask:0xf
  s_ff1_i32_b32 s4, vcc_lo
  v_cmp_ge_u32 vcc, s4, v1
  s_nop 1
  v_cndmask_b32 v9, v9, v2, vcc
  v_writelane_b32 v9, s78, 0
  v_lshlrev_b32_e64 v11, 7, v9
  v_lshl_add_u32 v9, v9, 14, s5
  s_lshl_b32 s6, s76, Lz1-Lz0+14
  v_readlane_b32 s7, v9, 1
  s_mov_b32 s11, 16384
  s_add_u32 s91, s91, 8
  s_mov_b32 s90, 0x3e
  s_barrier
  s_mov_b32 s82, 1
  s_add_u32 s83, s83, 0
  s_add_u32 s87, s87, 32
  s_mov_b32 s89, 200000
  s_mov_b32 exec_lo, s90
  s_mov_b32 exec_hi, 0
  buffer_load_dword v12, v11, s[40:43], s91 offen sc0 sc1
Lp_131:
  s_waitcnt vmcnt(0)
  v_cmp_ne_u32 vcc, 0, v12
  s_andn2_b32 s3, exec_lo, vcc_lo
  s_cbranch_scc0 Lp_132
  s_mov_b32 exec_lo, s3
  s_sleep 1
  buffer_load_dword v12, v11, s[40:43], s91 offen sc0 sc1
  s_sub_u32 s89, s89, 1
  s_cbranch_scc0 Lp_131
Lp_132:
  s_mov_b64 exec, -1
  s_branch L_xlayer
  s_nop 0
L_s1:
  v_mov_b32 v11, 1
  v_mov_b32 v2, 156416
  ds_write_b128 v2, v[24:27]
  v_and_b32 v2, 31, v1
  v_lshlrev_b32 v5, 7, v2
  v_lshlrev_b32 v10, 3, v2
  v_lshrrev_b32 v3, 5, v1
  v_mul_u32_u24 v3, 320, v3
  v_add_u32_e64 v10, v3, v10
  v_add_u32 v10, 151552, v10
  v_bfe_u32 v3, v1, 3, 1
  v_and_b32 v2, 7, v1
  v_lshlrev_b32 v12, 9, v3
  v_lshl_add_u32 v12, v2, 4, v12
  v_mul_u32_u24 v3, 320, v3
  v_lshl_add_u32 v13, v2, 3, v3
  v_add_u32 v13, 151808, v13
  v_and_b32 v2, 15, v1
  v_lshlrev_b32 v8, 4, v2
  v_lshlrev_b32 v15, 6, v2
  v_and_b32 v3, 48, v1
  v_add_u32 v15, v15, v3
  v_and_b32 v2, 14, v1
  v_lshlrev_b32 v6, 2, v2
  v_lshlrev_b32 v14, 16, v1
  s_lshl_b32 s4, s77, 12
  s_lshl_b32 s5, s76, 7
  s_add_u32 s4, s4, s5
  v_add_u32 v14, s4, v14
  v_lshrrev_b32 v2, 2, v1
  v_lshlrev_b32 v22, 7, v2
  v_lshlrev_b32 v96, 6, v2
  v_and_b32 v2, 3, v1
  v_lshl_add_u32 v22, v2, 3, v22
  v_lshl_add_u32 v96, v2, 3, v96
  v_add_u32 v22, 65536, v22
  v_add_u32 v96, 90112, v96
  v_bfe_u32 v3, v1, 3, 2
  v_xor_b32_e64 v2, 0, v3
  v_lshl_add_u32 v16, v2, 5, v22
  v_xor_b32_e64 v2, 1, v3
  v_lshl_add_u32 v17, v2, 5, v22
  v_xor_b32_e64 v2, 2, v3
  v_lshl_add_u32 v18, v2, 5, v22
  v_xor_b32_e64 v2, 3, v3
  v_lshl_add_u32 v19, v2, 5, v22
  v_bfe_u32 v3, v1, 4, 1
  v_xor_b32_e64 v2, 0, v3
  v_lshl_add_u32 v20, v2, 5, v96
  v_xor_b32_e64 v2, 1, v3
  v_lshl_add_u32 v21, v2, 5, v96
  v_mov_b32 v22, 0x3f803f80
  s_mul_i32 s4, s76, 11
  s_lshr_b32 s4, s4, 5
  s_mul_i32 s4, s4, 3
  s_and_b32 s14, s76, 1
  s_mov_b32 s15, 32768
  s_mul_i32 s4, s14, 24576
  v_add_u32 v16, s4, v16
  v_add_u32 v17, s4, v17
  v_add_u32 v18, s4, v18
  v_add_u32 v19, s4, v19
  s_mov_b32 s98, 0x00010001
  s_mov_b32 s99, 0x00010001
  v_cndmask_b32_e64 v200, 0, v22, s[98:99]
  v_cndmask_b32_e64 v201, 0, v22, s[98:99]
  v_cndmask_b32_e64 v202, 0, v22, s[98:99]
  v_cndmask_b32_e64 v203, 0, v22, s[98:99]
  s_nop 0
  s_lshl_b64 s[98:99], s[98:99], 1
  v_cndmask_b32_e64 v204, 0, v22, s[98:99]
  v_cndmask_b32_e64 v205, 0, v22, s[98:99]
  v_cndmask_b32_e64 v206, 0, v22, s[98:99]
  v_cndmask_b32_e64 v207, 0, v22, s[98:99]
  s_nop 0
  s_lshl_b64 s[98:99], s[98:99], 1
  v_cndmask_b32_e64 v208, 0, v22, s[98:99]
  v_cndmask_b32_e64 v209, 0, v22, s[98:99]
  v_cndmask_b32_e64 v210, 0, v22, s[98:99]
  v_cndmask_b32_e64 v211, 0, v22, s[98:99]
  s_nop 0
  s_lshl_b64 s[98:99], s[98:99], 1
  v_cndmask_b32_e64 v212, 0, v22, s[98:99]
  v_cndmask_b32_e64 v213, 0, v22, s[98:99]
  v_cndmask_b32_e64 v214, 0, v22, s[98:99]
  v_cndmask_b32_e64 v215, 0, v22, s[98:99]
  s_nop 0
  s_lshl_b64 s[98:99], s[98:99], 1
  v_cndmask_b32_e64 v216, 0, v22, s[98:99]
  v_cndmask_b32_e64 v217, 0, v22, s[98:99]
  v_cndmask_b32_e64 v218, 0, v22, s[98:99]
  v_cndmask_b32_e64 v219, 0, v22, s[98:99]
  s_nop 0
  s_lshl_b64 s[98:99], s[98:99], 1
  v_cndmask_b32_e64 v220, 0, v22, s[98:99]
  v_cndmask_b32_e64 v221, 0, v22, s[98:99]
  v_cndmask_b32_e64 v222, 0, v22, s[98:99]
  v_cndmask_b32_e64 v223, 0, v22, s[98:99]
  s_nop 0
  s_lshl_b64 s[98:99], s[98:99], 1
  v_cndmask_b32_e64 v224, 0, v22, s[98:99]
  v_cndmask_b32_e64 v225, 0, v22, s[98:99]
  v_cndmask_b32_e64 v226, 0, v22, s[98:99]
  v_cndmask_b32_e64 v227, 0, v22, s[98:99]
  s_nop 0
  s_lshl_b64 s[98:99], s[98:99], 1
  v_cndmask_b32_e64 v228, 0, v22, s[98:99]
  v_cndmask_b32_e64 v229, 0, v22, s[98:99]
  v_cndmask_b32_e64 v230, 0, v22, s[98:99]
  v_cndmask_b32_e64 v231, 0, v22, s[98:99]
  s_nop 0
  s_lshl_b64 s[98:99], s[98:99], 1
  v_cndmask_b32_e64 v232, 0, v22, s[98:99]
  v_cndmask_b32_e64 v233, 0, v22, s[98:99]
  v_cndmask_b32_e64 v234, 0, v22, s[98:99]
  v_cndmask_b32_e64 v235, 0, v22, s[98:99]
  s_nop 0
  s_lshl_b64 s[98:99], s[98:99], 1
  v_cndmask_b32_e64 v236, 0, v22, s[98:99]
  v_cndmask_b32_e64 v237, 0, v22, s[98:99]
  v_cndmask_b32_e64 v238, 0, v22, s[98:99]
  v_cndmask_b32_e64 v239, 0, v22, s[98:99]
  s_nop 0
  s_lshl_b64 s[98:99], s[98:99], 1
  v_cndmask_b32_e64 v240, 0, v22, s[98:99]
  v_cndmask_b32_e64 v241, 0, v22, s[98:99]
  v_cndmask_b32_e64 v242, 0, v22, s[98:99]
  v_cndmask_b32_e64 v243, 0, v22, s[98:99]
  s_nop 0
  s_lshl_b64 s[98:99], s[98:99], 1
  v_cndmask_b32_e64 v244, 0, v22, s[98:99]
  v_cndmask_b32_e64 v245, 0, v22, s[98:99]
  v_cndmask_b32_e64 v246, 0, v22, s[98:99]
  v_cndmask_b32_e64 v247, 0, v22, s[98:99]
  s_lshl_b64 s[98:99], s[98:99], 1
  s_mov_b32 s56, s24
  s_and_b32 s57, s25, 0xffff
  s_mov_b32 s58, 7340032
  s_mov_b32 s59, 0x00020000
  s_nop 0
  s_mov_b32 s60, s28
  s_and_b32 s61, s29, 0xffff
  s_mov_b32 s62, 7340032
  s_mov_b32 s63, 0x00020000
  s_mul_i32 s12, s84, Lz1-Lz0+14
  s_add_u32 s12, s12, 20480
  s_mov_b32 s13, s12
  v_lshlrev_b32 v110, 7, v1
  s_mov_b32 s8, 0x00500005
  s_mov_b32 s9, 0x50000500
L_slayer:
  s_barrier
  s_cmp_lg_u32 s82, Lz1-Lz0+0
  s_cbranch_scc1 L_134
  buffer_load_dwordx4 v[128:131], v108, s[44:47], s7 offen offset:0
  buffer_load_dwordx4 v[132:135], v108, s[44:47], s7 offen offset:128
  buffer_load_dwordx4 v[136:139], v108, s[44:47], s7 offen offset:256
  buffer_load_dwordx4 v[140:143], v108, s[44:47], s7 offen offset:384
  buffer_load_dwordx4 v[144:147], v108, s[44:47], s7 offen offset:512
  buffer_load_dwordx4 v[148:151], v108, s[44:47], s7 offen offset:640
  buffer_load_dwordx4 v[152:155], v108, s[44:47], s7 offen offset:768
  buffer_load_dwordx4 v[156:159], v108, s[44:47], s7 offen offset:896
  buffer_load_dwordx4 v[160:163], v108, s[44:47], s7 offen offset:1024
  buffer_load_dwordx4 v[164:167], v108, s[44:47], s7 offen offset:1152
  buffer_load_dwordx4 v[168:171], v108, s[44:47], s7 offen offset:1280
  buffer_load_dwordx4 v[172:175], v108, s[44:47], s7 offen offset:1408
  buffer_load_dwordx4 v[176:179], v108, s[44:47], s7 offen offset:1536
  buffer_load_dwordx4 v[180:183], v108, s[44:47], s7 offen offset:1664
  buffer_load_dwordx4 v[184:187], v108, s[44:47], s7 offen offset:1792
  buffer_load_dwordx4 v[188:191], v108, s[44:47], s7 offen offset:1920
  s_waitcnt vmcnt(16)
  s_lshl_b32 s4, s76, 4
  s_mov_b64 exec, 1
  buffer_atomic_add v11, v24, s[68:71], s4 offen sc1
  s_mov_b64 exec, -1
L_134:
  s_cmp_le_u32 s14, 0
  s_cbranch_scc1 L_136
  s_barrier
L_136:
  s_cmp_le_u32 s14, 1
  s_cbranch_scc1 L_137
  s_barrier
L_137:
  s_cmp_lg_u32 s82, 0
  s_cbranch_scc1 L_138
  ds_read_b64_tr_b16 v[32:33], v16 offset:0
  ds_read_b64_tr_b16 v[34:35], v16 offset:2048
  ds_read_b64_tr_b16 v[36:37], v17 offset:0
  ds_read_b64_tr_b16 v[38:39], v17 offset:2048
  ds_read_b64_tr_b16 v[40:41], v18 offset:0
  ds_read_b64_tr_b16 v[42:43], v18 offset:2048
  ds_read_b64_tr_b16 v[44:45], v19 offset:0
  ds_read_b64_tr_b16 v[46:47], v19 offset:2048
  ds_read_b64_tr_b16 v[48:49], v16 offset:4096
  ds_read_b64_tr_b16 v[50:51], v16 offset:6144
  ds_read_b64_tr_b16 v[52:53], v17 offset:4096
  ds_read_b64_tr_b16 v[54:55], v17 offset:6144
  s_nop 0
  s_waitcnt lgkmcnt(4)
  ds_read_b64_tr_b16 v[56:57], v18 offset:4096
  ds_read_b64_tr_b16 v[58:59], v18 offset:6144
  ds_read_b64_tr_b16 v[60:61], v19 offset:4096
  ds_read_b64_tr_b16 v[62:63], v19 offset:6144
  v_add_u32 v16, 8192, v16
  v_add_u32 v17, 8192, v17
  v_add_u32 v18, 8192, v18
  v_add_u32 v19, 8192, v19
  s_nop 0
  s_waitcnt lgkmcnt(2)
  ds_read_b64_tr_b16 v[64:65], v16 offset:0
  ds_read_b64_tr_b16 v[66:67], v16 offset:2048
  ds_read_b64_tr_b16 v[68:69], v17 offset:0
  ds_read_b64_tr_b16 v[70:71], v17 offset:2048
  ds_read_b64_tr_b16 v[72:73], v18 offset:0
  ds_read_b64_tr_b16 v[74:75], v18 offset:2048
  ds_read_b64_tr_b16 v[76:77], v19 offset:0
  ds_read_b64_tr_b16 v[78:79], v19 offset:2048
  ds_read_b64_tr_b16 v[80:81], v16 offset:4096
  ds_read_b64_tr_b16 v[82:83], v16 offset:6144
  ds_read_b64_tr_b16 v[84:85], v17 offset:4096
  ds_read_b64_tr_b16 v[86:87], v17 offset:6144
  s_nop 0
  s_waitcnt lgkmcnt(4)
  ds_read_b64_tr_b16 v[88:89], v18 offset:4096
  ds_read_b64_tr_b16 v[90:91], v18 offset:6144
  ds_read_b64_tr_b16 v[92:93], v19 offset:4096
  ds_read_b64_tr_b16 v[94:95], v19 offset:6144
  v_add_u32 v16, 8192, v16
  v_add_u32 v17, 8192, v17
  v_add_u32 v18, 8192, v18
  v_add_u32 v19, 8192, v19
  v_mfma_f32_16x16x32_bf16 v[28:31], v[32:35], v[200:203], 0
  v_mfma_f32_16x16x32_bf16 v[28:31], v[36:39], v[204:207], v[28:31]
  v_mfma_f32_16x16x32_bf16 v[28:31], v[40:43], v[208:211], v[28:31]
  v_mfma_f32_16x16x32_bf16 v[28:31], v[44:47], v[212:215], v[28:31]
  v_mfma_f32_16x16x32_bf16 v[28:31], v[48:51], v[200:203], v[28:31]
  v_mfma_f32_16x16x32_bf16 v[28:31], v[52:55], v[204:207], v[28:31]
  v_mfma_f32_16x16x32_bf16 v[28:31], v[56:59], v[208:211], v[28:31]
  v_mfma_f32_16x16x32_bf16 v[28:31], v[60:63], v[212:215], v[28:31]
  s_nop 0
  s_waitcnt lgkmcnt(2)
  ds_read_b64_tr_b16 v[32:33], v16 offset:0
  ds_read_b64_tr_b16 v[34:35], v16 offset:2048
  ds_read_b64_tr_b16 v[36:37], v17 offset:0
  ds_read_b64_tr_b16 v[38:39], v17 offset:2048
  ds_read_b64_tr_b16 v[40:41], v18 offset:0
  ds_read_b64_tr_b16 v[42:43], v18 offset:2048
  ds_read_b64_tr_b16 v[44:45], v19 offset:0
  ds_read_b64_tr_b16 v[46:47], v19 offset:2048
  ds_read_b64_tr_b16 v[48:49], v16 offset:4096
  ds_read_b64_tr_b16 v[50:51], v16 offset:6144
  ds_read_b64_tr_b16 v[52:53], v17 offset:4096
  ds_read_b64_tr_b16 v[54:55], v17 offset:6144
  s_nop 0
  s_waitcnt lgkmcnt(4)
  ds_read_b64_tr_b16 v[56:57], v18 offset:4096
  ds_read_b64_tr_b16 v[58:59], v18 offset:6144
  ds_read_b64_tr_b16 v[60:61], v19 offset:4096
  ds_read_b64_tr_b16 v[62:63], v19 offset:6144
  v_mfma_f32_16x16x32_bf16 v[28:31], v[64:67], v[216:219], v[28:31]
  v_mfma_f32_16x16x32_bf16 v[28:31], v[68:71], v[220:223], v[28:31]
  v_mfma_f32_16x16x32_bf16 v[28:31], v[72:75], v[224:227], v[28:31]
  v_mfma_f32_16x16x32_bf16 v[28:31], v[76:79], v[228:231], v[28:31]
  v_mfma_f32_16x16x32_bf16 v[28:31], v[80:83], v[216:219], v[28:31]
  v_mfma_f32_16x16x32_bf16 v[28:31], v[84:87], v[220:223], v[28:31]
  v_mfma_f32_16x16x32_bf16 v[28:31], v[88:91], v[224:227], v[28:31]
  v_mfma_f32_16x16x32_bf16 v[28:31], v[92:95], v[228:231], v[28:31]
  s_waitcnt lgkmcnt(0)
L_138:
  s_barrier
  s_cmp_lg_u32 s82, 0
  s_cbranch_scc1 L_140
  v_mfma_f32_16x16x32_bf16 v[28:31], v[32:35], v[232:235], v[28:31]
  v_mfma_f32_16x16x32_bf16 v[28:31], v[36:39], v[236:239], v[28:31]
  v_mfma_f32_16x16x32_bf16 v[28:31], v[40:43], v[240:243], v[28:31]
  v_mfma_f32_16x16x32_bf16 v[28:31], v[44:47], v[244:247], v[28:31]
  v_mfma_f32_16x16x32_bf16 v[28:31], v[48:51], v[232:235], v[28:31]
  v_mfma_f32_16x16x32_bf16 v[28:31], v[52:55], v[236:239], v[28:31]
  v_mfma_f32_16x16x32_bf16 v[28:31], v[56:59], v[240:243], v[28:31]
  v_mfma_f32_16x16x32_bf16 v[28:31], v[60:63], v[244:247], v[28:31]
  s_lshl_b32 s5, s77, 14
  s_lshl_b32 s4, s76, 10
  s_add_u32 s5, s5, s4
  s_add_u32 s5, s5, 1114112
  s_nop 3
  buffer_store_dwordx4 v[28:31], v15, s[40:43], s5 offen sc0 sc1
  s_branch L_141
L_140:
  s_lshl_b32 s91, s84, 1
  s_add_u32 s91, s91, s87
  s_add_u32 s91, s91, 0xfffffff0
  s_mov_b32 s16, 0xffff
  s_mov_b32 exec_lo, s16
  s_mov_b32 exec_hi, 0
  buffer_load_dword v7, v5, s[40:43], s91 offen sc0 sc1
  s_mov_b64 exec, -1
L_141:
  s_barrier
  s_cmp_lg_u32 s82, 0
  s_cbranch_scc1 L_142
  s_branch L_143
L_142:
  s_waitcnt vmcnt(0)
  s_mov_b32 s89, 200000
  s_mov_b32 exec_lo, s16
  s_mov_b32 exec_hi, 0
  s_branch Lp_145
Lp_144:
  buffer_load_dword v7, v5, s[40:43], s91 offen sc0 sc1
  s_waitcnt vmcnt(0)
Lp_145:
  v_cmp_ne_u32 vcc, 0, v7
  s_andn2_b32 s3, s16, vcc_lo
  s_cbranch_scc0 Lp_146
  s_sleep 1
  s_sub_u32 s89, s89, 1
  s_cbranch_scc0 Lp_144
Lp_146:
  s_mov_b64 exec, -1
  s_add_u32 s5, s84, s92
  buffer_load_dwordx2 v[96:97], v6, s[40:43], s5 offen offset:0 sc1
  buffer_load_dwordx2 v[98:99], v6, s[40:43], s5 offen offset:512 sc1
  buffer_load_dwordx2 v[100:101], v6, s[40:43], s5 offen offset:1024 sc1
  buffer_load_dwordx2 v[102:103], v6, s[40:43], s5 offen offset:1536 sc1
L_143:
  s_barrier
  s_cmp_gt_u32 s14, 0
  s_cbranch_scc1 L_147
  s_barrier
L_147:
  s_cmp_gt_u32 s14, Lz1-Lz0+1
  s_cbranch_scc1 L_148
  s_barrier
L_148:
  s_cmp_lg_u32 s82, 0
  s_cbranch_scc1 L_149
  s_waitcnt vmcnt(2)
  buffer_load_dword v9, v8, s[68:71], 0 offen sc0 sc1
  s_mov_b32 s72, s26
  s_and_b32 s73, s27, 0xffff
  s_mov_b32 s74, 7168
  s_mov_b32 s75, 0x00020000
  s_mul_i32 s4, s77, 448
  s_and_b32 s5, s77, Lz1-Lz0+1
  s_lshl_b32 s6, s5, 6
  s_add_u32 s6, s6, s4
  s_mul_i32 s5, s5, 384
  s_sub_u32 s5, s4, s5
  v_lshlrev_b32 v2, 1, v1
  v_lshrrev_b32 v3, 1, v2
  v_xor_b32 v3, v3, v2
  v_and_b32 v3, 16, v3
  v_mul_u32_u24 v3, 3, v3
  v_xor_b32_e64 v3, v3, v2
  buffer_load_ushort v104, v2, s[72:75], s6 offen offset:0
  buffer_load_ushort v105, v2, s[72:75], s6 offen offset:128
  buffer_load_ushort v106, v2, s[72:75], s6 offen offset:256
  buffer_load_ushort v107, v3, s[72:75], s5 offen offset:384
  s_nop 0
  s_mov_b32 s64, s30
  s_and_b32 s65, s31, 0xffff
  s_mov_b32 s66, 2048
  s_mov_b32 s67, 0x00020000
  s_lshl_b32 s4, s78, Lz1-Lz0+7
  buffer_load_ushort v108, v2, s[64:67], s4 offen
  v_mov_b32 v32, v22
  v_mov_b32 v33, v22
  v_mov_b32_e64 v34, v22
  v_mov_b32 v35, v22
  s_nop 1
  v_mfma_f32_16x16x32_bf16 v[96:99], v[32:35], v[128:131], 0
  v_mfma_f32_16x16x32_bf16 v[100:103], v[128:131], v[128:131], 0
  v_mfma_f32_16x16x32_bf16 v[96:99], v[32:35], v[132:135], v[96:99]
  v_mfma_f32_16x16x32_bf16 v[100:103], v[132:135], v[132:135], v[100:103]
  v_mfma_f32_16x16x32_bf16 v[96:99], v[32:35], v[136:139], v[96:99]
  v_mfma_f32_16x16x32_bf16 v[100:103], v[136:139], v[136:139], v[100:103]
  v_mfma_f32_16x16x32_bf16 v[96:99], v[32:35], v[140:143], v[96:99]
  v_mfma_f32_16x16x32_bf16 v[100:103], v[140:143], v[140:143], v[100:103]
L_149:
  s_barrier
  s_cmp_lg_u32 s82, Lz1-Lz0+0
  s_cbranch_scc1 L_151
  v_mfma_f32_16x16x32_bf16 v[96:99], v[32:35], v[144:147], v[96:99]
  v_mfma_f32_16x16x32_bf16 v[100:103], v[144:147], v[144:147], v[100:103]
  v_mfma_f32_16x16x32_bf16 v[96:99], v[32:35], v[148:151], v[96:99]
  v_mfma_f32_16x16x32_bf16 v[100:103], v[148:151], v[148:151], v[100:103]
  v_mfma_f32_16x16x32_bf16 v[96:99], v[32:35], v[152:155], v[96:99]
  v_mfma_f32_16x16x32_bf16 v[100:103], v[152:155], v[152:155], v[100:103]
  v_mfma_f32_16x16x32_bf16 v[96:99], v[32:35], v[156:159], v[96:99]
  v_mfma_f32_16x16x32_bf16 v[100:103], v[156:159], v[156:159], v[100:103]
L_151:
  s_barrier
  s_cmp_lg_u32 s82, Lz1-Lz0+0
  s_cbranch_scc1 L_153
  v_mfma_f32_16x16x32_bf16 v[96:99], v[32:35], v[160:163], v[96:99]
  v_mfma_f32_16x16x32_bf16 v[100:103], v[160:163], v[160:163], v[100:103]
  v_mfma_f32_16x16x32_bf16 v[96:99], v[32:35], v[164:167], v[96:99]
  v_mfma_f32_16x16x32_bf16 v[100:103], v[164:167], v[164:167], v[100:103]
  v_mfma_f32_16x16x32_bf16 v[96:99], v[32:35], v[168:171], v[96:99]
  v_mfma_f32_16x16x32_bf16 v[100:103], v[168:171], v[168:171], v[100:103]
  v_mfma_f32_16x16x32_bf16 v[96:99], v[32:35], v[172:175], v[96:99]
  v_mfma_f32_16x16x32_bf16 v[100:103], v[172:175], v[172:175], v[100:103]
  s_waitcnt vmcnt(0)
  s_mov_b32 s89, 200000
  s_branch Lg_156
Lg_155:
  buffer_load_dword v9, v8, s[68:71], 0 offen sc0 sc1
  s_waitcnt vmcnt(0)
Lg_156:
  v_cmp_eq_u32 vcc, 16, v9
  s_andn2_b32 s3, 0xffff, vcc_lo
  s_cbranch_scc0 Lg_157
  s_sleep 2
  s_sub_u32 s89, s89, 1
  s_cbranch_scc0 Lg_155
Lg_157:
  s_mov_b32 s5, 1835008
  s_mov_b64 exec, 0x101
  buffer_store_dword v11, v14, s[40:43], s5 offen sc0 sc1
  s_mov_b64 exec, -1
  s_getpc_b64 s[4:5]
L_pc0:
  s_sub_u32 s4, s4, L_pc0-mega_kernel
  s_nop 0
  s_subb_u32 s5, s5, 0
  s_bfe_u32 s6, s2, 0x20003
  s_mul_i32 s6, s6, 10240
  v_lshl_add_u32 v3, v1, 4, s6
  v_mov_b32_e64 v119, s5
  v_min_u32 v118, L_end-mega_kernel-16, v3
  v_add_co_u32_e64 v116, vcc, s4, v118
  v_add_u32 v3, 0x400, v3
  s_nop 0
  v_addc_co_u32 v117, vcc, 0, v119, vcc
  global_load_dwordx4 v[112:115], v[116:117], off
  v_min_u32 v118, L_end-mega_kernel-16, v3
  v_add_co_u32_e64 v116, vcc, s4, v118
  v_add_u32 v3, 0x400, v3
  s_nop 0
  v_addc_co_u32 v117, vcc, 0, v119, vcc
  global_load_dwordx4 v[112:115], v[116:117], off
  v_min_u32 v118, L_end-mega_kernel-16, v3
  v_add_co_u32_e64 v116, vcc, s4, v118
  v_add_u32 v3, 0x400, v3
  s_nop 0
  v_addc_co_u32 v117, vcc, 0, v119, vcc
  global_load_dwordx4 v[112:115], v[116:117], off
  v_min_u32 v118, L_end-mega_kernel-16, v3
  v_add_co_u32_e64 v116, vcc, s4, v118
  v_add_u32 v3, 0x400, v3
  s_nop 0
  v_addc_co_u32 v117, vcc, 0, v119, vcc
  global_load_dwordx4 v[112:115], v[116:117], off
  v_min_u32 v118, L_end-mega_kernel-16, v3
  v_add_co_u32 v116, vcc, s4, v118
  s_nop 1
  v_addc_co_u32 v117, vcc, 0, v119, vcc
  global_load_dwordx4 v[112:115], v[116:117], off
L_153:
  s_barrier
  s_cmp_lg_u32 s82, 0
  s_cbranch_scc1 L_158
  v_mfma_f32_16x16x32_bf16 v[96:99], v[32:35], v[176:179], v[96:99]
  v_mfma_f32_16x16x32_bf16 v[100:103], v[176:179], v[176:179], v[100:103]
  v_mfma_f32_16x16x32_bf16 v[96:99], v[32:35], v[180:183], v[96:99]
  v_mfma_f32_16x16x32_bf16 v[100:103], v[180:183], v[180:183], v[100:103]
  v_mfma_f32_16x16x32_bf16 v[96:99], v[32:35], v[184:187], v[96:99]
  v_mfma_f32_16x16x32_bf16 v[100:103], v[184:187], v[184:187], v[100:103]
  v_mfma_f32_16x16x32_bf16 v[96:99], v[32:35], v[188:191], v[96:99]
  v_mfma_f32_16x16x32_bf16 v[100:103], v[188:191], v[188:191], v[100:103]
  s_getpc_b64 s[4:5]
L_pc1:
  s_sub_u32 s4, s4, L_pc1-mega_kernel
  s_subb_u32 s5, s5, 0
  s_bfe_u32 s6, s2, 0x20003
  s_mul_i32 s6, s6, 10240
  s_add_u32 s6, s6, 5120
  v_lshl_add_u32 v3, v1, 4, s6
  v_mov_b32_e64 v119, s5
  v_min_u32 v118, L_end-mega_kernel-16, v3
  v_add_co_u32_e64 v116, vcc, s4, v118
  v_add_u32 v3, 0x400, v3
  s_nop 0
  v_addc_co_u32 v117, vcc, 0, v119, vcc
  global_load_dwordx4 v[112:115], v[116:117], off
  v_min_u32 v118, L_end-mega_kernel-16, v3
  v_add_co_u32_e64 v116, vcc, s4, v118
  v_add_u32 v3, 0x400, v3
  s_nop 0
  v_addc_co_u32 v117, vcc, 0, v119, vcc
  global_load_dwordx4 v[112:115], v[116:117], off
  v_min_u32 v118, L_end-mega_kernel-16, v3
  v_add_co_u32_e64 v116, vcc, s4, v118
  v_add_u32 v3, 0x400, v3
  s_nop 0
  v_addc_co_u32 v117, vcc, 0, v119, vcc
  global_load_dwordx4 v[112:115], v[116:117], off
  v_min_u32 v118, L_end-mega_kernel-16, v3
  v_add_co_u32_e64 v116, vcc, s4, v118
  v_add_u32 v3, 0x400, v3
  s_nop 0
  v_addc_co_u32 v117, vcc, 0, v119, vcc
  global_load_dwordx4 v[112:115], v[116:117], off
  v_min_u32 v118, L_end-mega_kernel-16, v3
  v_add_co_u32 v116, vcc, s4, v118
  s_nop 1
  v_addc_co_u32_e64 v117, vcc, 0, v119, vcc
  global_load_dwordx4 v[112:115], v[116:117], off
  s_mov_b32 s98, 0xaaaaaaaa
  s_mov_b32 s99, 0xaaaaaaaa
  v_cndmask_b32_e64 v100, v100, v101, s[98:99]
  v_cndmask_b32_e64 v102, v102, v103, s[98:99]
  s_mov_b32 s98, 0xcccccccc
  s_mov_b32 s99, 0xcccccccc
  v_cndmask_b32_e64 v97, v100, v102, s[98:99]
  v_add_f32_dpp v96, v96, v96 quad_perm:[1,0,3,2] row_mask:0xf bank_mask:0xf
  s_nop 0
  v_add_f32_dpp v97, v97, v97 quad_perm:[1,0,3,2] row_mask:0xf bank_mask:0xf
  s_branch L_159
L_158:
  s_waitcnt vmcnt(0)
  v_add_f32 v96, v96, v100
  v_add_f32 v97, v97, v101
  v_add_f32 v98, v98, v102
  v_add_f32 v99, v99, v103
  v_add_f32 v96, v96, v98
  v_add_f32 v97, v97, v99
  s_nop 0
  v_add_f32_dpp v96, v96, v96 row_ror:8 row_mask:0xf bank_mask:0xf
  v_add_f32_dpp v97, v97, v97 row_ror:8 row_mask:0xf bank_mask:0xf
  v_mov_b32 v98, v96
  v_mov_b32 v99, v97
  s_nop 0
  v_permlane16_swap_b32 v96, v98
  v_permlane16_swap_b32 v97, v99
  v_add_f32 v96, v96, v98
  v_add_f32 v97, v97, v99
  v_mov_b32 v98, v96
  v_mov_b32 v99, v97
  s_nop 0
  v_permlane32_swap_b32 v96, v98
  v_permlane32_swap_b32 v97, v99
  v_add_f32 v96, v96, v98
  v_add_f32 v97, v97, v99
L_159:
  v_mul_f32 v96, 0x3a800000, v96
  v_mul_f32 v97, 0x3a800000, v97
  v_fma_f32 v98, -v96, v96, v97
  v_max_f32_e64 v98, 0, v98
  v_add_f32 v98, 0x3727c5ac, v98
  v_rsq_f32_e64 v98, v98
  v_mov_b32 v99, v96
  s_mov_b64 exec, s[8:9]
  buffer_store_dwordx2 v[98:99], v6, s[40:43], s10 offen sc0 sc1
  s_mov_b64 exec, -1
  s_barrier
  s_cmp_lg_u32 s82, 0
  s_cbranch_scc1 L_160
  v_lshlrev_b32_e64 v6, 3, v1
  s_mov_b64 s[8:9], 0xff
  s_lshl_b32 s91, s84, Lz1-Lz0+1
  s_and_b32 s91, s91, 0x8f000
  s_add_u32 s91, s91, 1835008
  s_mov_b32 exec_lo, 0xffff
  s_mov_b32 exec_hi, Lz1-Lz0+0
  buffer_load_dword v7, v5, s[40:43], s91 offen sc0 sc1
  s_mov_b64 exec, -1
L_160:
  s_barrier
  s_barrier
  s_waitcnt vmcnt(0)
  s_and_b32 s5, s10, 0xfffffc00
  buffer_load_dwordx4 v[120:123], v4, s[40:43], s5 offen sc1
  s_cmp_lg_u32 s82, 0
  s_cbranch_scc1 L_162
  s_mov_b32 s89, 200000
  s_mov_b32 exec_lo, 0xffff
  s_mov_b32 exec_hi, 0
  s_branch Lp_165
Lp_164:
  buffer_load_dword v7, v5, s[40:43], s91 offen sc0 sc1
  s_waitcnt vmcnt(0)
Lp_165:
  v_cmp_ne_u32 vcc, 0, v7
  s_andn2_b32 s3, 0xffff, vcc_lo
  s_cbranch_scc0 Lp_166
  s_sleep 1
  s_sub_u32 s89, s89, 1
  s_cbranch_scc0 Lp_164
Lp_166:
  s_mov_b64 exec, -1
  s_lshl_b32 s5, s77, 14
  s_add_u32 s5, s5, 1114112
  buffer_load_dwordx4 v[192:195], v4, s[40:43], s5 offen offset:0 sc1
  buffer_load_dwordx4 v[196:199], v4, s[40:43], s5 offen offset:1024 sc1
  buffer_load_dwordx4 v[200:203], v4, s[40:43], s5 offen offset:2048 sc1
  buffer_load_dwordx4 v[204:207], v4, s[40:43], s5 offen offset:3072 sc1
  s_add_u32 s5, s5, 4096
  buffer_load_dwordx4 v[208:211], v4, s[40:43], s5 offen offset:0 sc1
  buffer_load_dwordx4 v[212:215], v4, s[40:43], s5 offen offset:1024 sc1
  buffer_load_dwordx4 v[216:219], v4, s[40:43], s5 offen offset:2048 sc1
  buffer_load_dwordx4 v[220:223], v4, s[40:43], s5 offen offset:3072 sc1
L_162:
  s_barrier
  s_cmp_lg_u32 s82, 0
  s_cbranch_scc1 L_167
  s_lshl_b32 s5, s77, 14
  s_add_u32 s5, s5, 1122304
  buffer_load_dwordx4 v[224:227], v4, s[40:43], s5 offen offset:0 sc1
  buffer_load_dwordx4 v[228:231], v4, s[40:43], s5 offen offset:1024 sc1
  buffer_load_dwordx4 v[232:235], v4, s[40:43], s5 offen offset:2048 sc1
  buffer_load_dwordx4 v[236:239], v4, s[40:43], s5 offen offset:3072 sc1
  s_add_u32 s5, s5, 4096
  buffer_load_dwordx4 v[240:243], v4, s[40:43], s5 offen offset:0 sc1
  buffer_load_dwordx4 v[244:247], v4, s[40:43], s5 offen offset:1024 sc1
  buffer_load_dwordx4 v[248:251], v4, s[40:43], s5 offen offset:2048 sc1
  buffer_load_dwordx4 v[252:255], v4, s[40:43], s5 offen offset:3072 sc1
L_167:
  s_barrier
  s_cmp_lg_u32 s82, 0
  s_cbranch_scc1 L_169
  s_waitcnt vmcnt(16)
  s_branch L_170
L_169:
  s_waitcnt vmcnt(0)
L_170:
  s_mov_b32 s89, 200000
  s_branch Lp_172
  s_nop 0
Lp_171:
  s_and_b32 s5, s10, 0xfffffc00
  buffer_load_dwordx4 v[120:123], v4, s[40:43], s5 offen sc1
  s_waitcnt vmcnt(0)
Lp_172:
  v_min_u32 v2, v120, v122
  v_cmp_eq_u32 vcc, 0, v2
  s_cmp_eq_u64 vcc, 0
  s_cbranch_scc1 Lp_173
  s_sleep 1
  s_sub_u32 s89, s89, 1
  s_cbranch_scc0 Lp_171
Lp_173:
  s_and_b32 s5, s10, 0xfffffc00
  s_mov_b32 m0, 151552
  s_nop 0
  buffer_load_dword v6, s[40:43], s5 offen offset:0 sc1 lds
  s_mov_b32 m0, 152188
  s_nop 0
  buffer_load_dword v6, s[40:43], s5 offen offset:4 sc1 lds
  s_mov_b32 m0, 151360
  s_nop 0
  buffer_load_dword v6, s[40:43], s5 offen offset:512 sc1 lds
  s_mov_b32 m0, 151996
  s_nop 0
  buffer_load_dword v6, s[40:43], s5 offen offset:516 sc1 lds
  s_add_u32 s10, s10, 16384
  s_cmp_lg_u32 s82, 0
  s_cbranch_scc1 L_174
  s_waitcnt vmcnt(12)
  v_add_f32 v192, v192, v208
  v_add_f32 v193, v193, v209
  v_add_f32 v194, v194, v210
  v_add_f32 v195, v195, v211
  v_add_f32 v196, v196, v212
  v_add_f32 v197, v197, v213
  v_add_f32 v198, v198, v214
  v_add_f32 v199, v199, v215
  v_add_f32 v200, v200, v216
  v_add_f32 v201, v201, v217
  v_add_f32 v202, v202, v218
  v_add_f32 v203, v203, v219
  v_add_f32 v204, v204, v220
  v_add_f32 v205, v205, v221
  v_add_f32 v206, v206, v222
  v_add_f32 v207, v207, v223
  v_add_f32 v192, v192, v200
  v_add_f32 v193, v193, v201
  v_add_f32 v194, v194, v202
  v_add_f32 v195, v195, v203
  v_add_f32 v196, v196, v204
  v_add_f32 v197, v197, v205
  v_add_f32 v198, v198, v206
  v_add_f32 v199, v199, v207
  v_add_f32 v192, v192, v196
  v_add_f32 v193, v193, v197
  v_add_f32 v194, v194, v198
  v_add_f32_e64 v195, v195, v199
L_174:
  s_cmp_lg_u32 s82, 0
  s_cbranch_scc1 L_176
  buffer_load_dword v109, v110, s[56:59], s12 offen
  s_sub_u32 s12, s12, 8192
L_176:
  s_barrier
  s_cmp_lg_u32 s82, 0
  s_cbranch_scc1 L_178
  s_cmp_lg_u32 s82, 0
  s_cbranch_scc1 L_180
  s_waitcnt vmcnt(1)
  s_branch L_181
L_180:
  s_waitcnt vmcnt(0)
L_181:
  v_add_f32 v224, v224, v240
  v_add_f32 v225, v225, v241
  v_add_f32 v226, v226, v242
  v_add_f32 v227, v227, v243
  v_add_f32 v228, v228, v244
  v_add_f32 v229, v229, v245
  v_add_f32 v230, v230, v246
  v_add_f32 v231, v231, v247
  v_add_f32 v232, v232, v248
  v_add_f32 v233, v233, v249
  v_add_f32 v234, v234, v250
  v_add_f32 v235, v235, v251
  v_add_f32 v236, v236, v252
  v_add_f32 v237, v237, v253
  v_add_f32 v238, v238, v254
  v_add_f32 v239, v239, v255
  v_add_f32 v224, v224, v232
  v_add_f32 v225, v225, v233
  v_add_f32 v226, v226, v234
  v_add_f32 v227, v227, v235
  v_add_f32 v228, v228, v236
  v_add_f32 v229, v229, v237
  v_add_f32 v230, v230, v238
  v_add_f32 v231, v231, v239
  v_add_f32 v224, v224, v228
  v_add_f32 v225, v225, v229
  v_add_f32 v226, v226, v230
  v_add_f32 v227, v227, v231
  v_add_f32 v192, v192, v224
  v_add_f32 v193, v193, v225
  v_add_f32 v194, v194, v226
  v_add_f32 v195, v195, v227
  v_add_u32 v2, 153088, v4
  ds_write_b128 v2, v[192:195]
L_178:
  s_cmp_lg_u32 s82, 0
  s_cbranch_scc1 L_182
  buffer_load_dword v109, v110, s[56:59], s12 offen
  s_sub_u32 s12, s12, 8192
L_182:
  s_barrier
  s_cmp_lg_u32 s82, 0
  s_cbranch_scc1 L_184
  s_waitcnt vmcnt(2)
  s_branch L_185
  s_nop 0
L_184:
  s_waitcnt vmcnt(0)
L_185:
  s_waitcnt lgkmcnt(0)
  s_barrier
  s_cmp_lg_u32 s82, 0
  s_cbranch_scc1 L_186
  v_lshlrev_b32 v2, 2, v1
  v_add_u32 v2, 155136, v2
  v_lshlrev_b32_e64 v104, 16, v104
  v_mul_f32 v104, 0x3eeff558, v104
  ds_write_b32 v2, v104 offset:0
  v_lshlrev_b32_e64 v105, 16, v105
  v_mul_f32 v105, 0x3eeff558, v105
  ds_write_b32 v2, v105 offset:256
  v_lshlrev_b32_e64 v106, 16, v106
  v_mul_f32 v106, 0x3eeff558, v106
  ds_write_b32 v2, v106 offset:512
  v_lshlrev_b32_e64 v107, 16, v107
  v_mul_f32 v107, 0x3eeff558, v107
  ds_write_b32 v2, v107 offset:768
  v_lshlrev_b32_e64 v108, 16, v108
  ds_write_b32 v2, v108 offset:1024
  v_lshrrev_b32 v2, 2, v1
  v_lshlrev_b32 v22, 7, v2
  v_lshlrev_b32 v96, 6, v2
  v_and_b32 v2, 3, v1
  v_lshl_add_u32 v22, v2, 3, v22
  v_lshl_add_u32 v96, v2, 3, v96
  v_add_u32 v22, 65536, v22
  v_add_u32 v96, 90112, v96
  v_bfe_u32 v3, v1, 3, 2
  v_xor_b32_e64 v2, 0, v3
  v_lshl_add_u32 v16, v2, 5, v22
  v_xor_b32_e64 v2, 1, v3
  v_lshl_add_u32 v17, v2, 5, v22
  v_xor_b32_e64 v2, 2, v3
  v_lshl_add_u32 v18, v2, 5, v22
  v_xor_b32_e64 v2, 3, v3
  v_lshl_add_u32 v19, v2, 5, v22
  v_bfe_u32 v3, v1, 4, 1
  v_xor_b32_e64 v2, 0, v3
  v_lshl_add_u32 v20, v2, 5, v96
  v_xor_b32_e64 v2, 1, v3
  v_lshl_add_u32 v21, v2, 5, v96
  v_mov_b32 v22, 0x3f803f80
  s_mov_b32 s98, 0x00010001
  s_mov_b32 s99, 0x00010001
  v_cndmask_b32_e64 v200, 0, v22, s[98:99]
  v_cndmask_b32_e64 v201, 0, v22, s[98:99]
  v_cndmask_b32_e64 v202, 0, v22, s[98:99]
  v_cndmask_b32_e64 v203, 0, v22, s[98:99]
  s_nop 0
  s_lshl_b64 s[98:99], s[98:99], 1
  v_cndmask_b32_e64 v204, 0, v22, s[98:99]
  v_cndmask_b32_e64 v205, 0, v22, s[98:99]
  v_cndmask_b32_e64 v206, 0, v22, s[98:99]
  v_cndmask_b32_e64 v207, 0, v22, s[98:99]
  s_nop 0
  s_lshl_b64 s[98:99], s[98:99], 1
  v_cndmask_b32_e64 v208, 0, v22, s[98:99]
  v_cndmask_b32_e64 v209, 0, v22, s[98:99]
  v_cndmask_b32_e64 v210, 0, v22, s[98:99]
  v_cndmask_b32_e64 v211, 0, v22, s[98:99]
  s_nop 0
  s_lshl_b64 s[98:99], s[98:99], 1
  v_cndmask_b32_e64 v212, 0, v22, s[98:99]
  v_cndmask_b32_e64 v213, 0, v22, s[98:99]
  v_cndmask_b32_e64 v214, 0, v22, s[98:99]
  v_cndmask_b32_e64 v215, 0, v22, s[98:99]
  s_nop 0
  s_lshl_b64 s[98:99], s[98:99], 1
  v_cndmask_b32_e64 v216, 0, v22, s[98:99]
  v_cndmask_b32_e64 v217, 0, v22, s[98:99]
  v_cndmask_b32_e64 v218, 0, v22, s[98:99]
  v_cndmask_b32_e64 v219, 0, v22, s[98:99]
  s_nop 0
  s_lshl_b64 s[98:99], s[98:99], 1
  v_cndmask_b32_e64 v220, 0, v22, s[98:99]
  v_cndmask_b32_e64 v221, 0, v22, s[98:99]
  v_cndmask_b32_e64 v222, 0, v22, s[98:99]
  v_cndmask_b32_e64 v223, 0, v22, s[98:99]
  s_nop 0
  s_lshl_b64 s[98:99], s[98:99], 1
  v_cndmask_b32_e64 v224, 0, v22, s[98:99]
  v_cndmask_b32_e64 v225, 0, v22, s[98:99]
  v_cndmask_b32_e64 v226, 0, v22, s[98:99]
  v_cndmask_b32_e64 v227, 0, v22, s[98:99]
  s_nop 0
  s_lshl_b64 s[98:99], s[98:99], 1
  v_cndmask_b32_e64 v228, 0, v22, s[98:99]
  v_cndmask_b32_e64 v229, 0, v22, s[98:99]
  v_cndmask_b32_e64 v230, 0, v22, s[98:99]
  v_cndmask_b32_e64 v231, 0, v22, s[98:99]
  s_nop 0
  s_lshl_b64 s[98:99], s[98:99], 1
  v_cndmask_b32_e64 v232, 0, v22, s[98:99]
  v_cndmask_b32_e64 v233, 0, v22, s[98:99]
  v_cndmask_b32_e64 v234, 0, v22, s[98:99]
  v_cndmask_b32_e64 v235, 0, v22, s[98:99]
  s_nop 0
  s_lshl_b64 s[98:99], s[98:99], 1
  v_cndmask_b32_e64 v236, 0, v22, s[98:99]
  v_cndmask_b32_e64 v237, 0, v22, s[98:99]
  v_cndmask_b32_e64 v238, 0, v22, s[98:99]
  v_cndmask_b32_e64 v239, 0, v22, s[98:99]
  s_nop 0
  s_lshl_b64 s[98:99], s[98:99], 1
  v_cndmask_b32_e64 v240, 0, v22, s[98:99]
  v_cndmask_b32_e64 v241, 0, v22, s[98:99]
  v_cndmask_b32_e64 v242, 0, v22, s[98:99]
  v_cndmask_b32_e64 v243, 0, v22, s[98:99]
  s_nop 0
  s_lshl_b64 s[98:99], s[98:99], 1
  v_cndmask_b32_e64 v244, 0, v22, s[98:99]
  v_cndmask_b32_e64 v245, 0, v22, s[98:99]
  v_cndmask_b32_e64 v246, 0, v22, s[98:99]
  v_cndmask_b32_e64 v247, 0, v22, s[98:99]
  s_nop 0
  s_lshl_b64 s[98:99], s[98:99], 1
  v_cndmask_b32_e64 v248, 0, v22, s[98:99]
  v_cndmask_b32_e64 v249, 0, v22, s[98:99]
  v_cndmask_b32_e64 v250, 0, v22, s[98:99]
  v_cndmask_b32_e64 v251, 0, v22, s[98:99]
  s_nop 0
  s_lshl_b64 s[98:99], s[98:99], 1
  v_cndmask_b32_e64 v252, 0, v22, s[98:99]
  v_cndmask_b32_e64 v253, 0, v22, s[98:99]
  v_cndmask_b32_e64 v254, 0, v22, s[98:99]
  v_cndmask_b32_e64 v255, 0, v22, s[98:99]
  s_lshl_b64 s[98:99], s[98:99], 1
L_186:
  s_lshl_b32 s91, s84, Lz1-Lz0+1
  s_add_u32 s91, s91, s87
  s_barrier
  s_barrier
  s_mov_b32 exec_lo, 0xf7f7
  s_mov_b32 exec_hi, 0
  buffer_load_dword v7, v5, s[40:43], s91 offen sc0 sc1
  s_mov_b64 exec, -1
  s_barrier
  s_barrier
  s_barrier
  s_waitcnt vmcnt(0)
  s_mov_b32 s89, 200000
  s_mov_b32 exec_lo, 0xf7f7
  s_mov_b32 exec_hi, 0
  s_branch Lp_189
Lp_188:
  buffer_load_dword v7, v5, s[40:43], s91 offen sc0 sc1
  s_waitcnt vmcnt(0)
Lp_189:
  v_cmp_ne_u32 vcc, 0, v7
  s_andn2_b32 s3, 0xf7f7, vcc_lo
  s_cbranch_scc0 Lp_190
  s_sleep 1
  s_sub_u32 s89, s89, Lz1-Lz0+1
  s_cbranch_scc0 Lp_188
Lp_190:
  s_mov_b64 exec, -1
  s_barrier
  s_barrier
  s_mov_b32 exec_lo, 0x808
  s_mov_b32 exec_hi, Lz1-Lz0+0
  buffer_load_dword v7, v5, s[40:43], s91 offen sc0 sc1
  s_mov_b64 exec, -1
  s_barrier
  s_barrier
  s_barrier
  s_barrier
  s_waitcnt vmcnt(0)
  s_mov_b32 s89, 200000
  s_mov_b32 exec_lo, 0x808
  s_mov_b32 exec_hi, 0
  s_branch Lp_192
Lp_191:
  buffer_load_dword v7, v5, s[40:43], s91 offen sc0 sc1
  s_waitcnt vmcnt(0)
Lp_192:
  v_cmp_ne_u32 vcc, 0, v7
  s_andn2_b32 s3, 0x808, vcc_lo
  s_cbranch_scc0 Lp_193
  s_sleep 1
  s_sub_u32 s89, s89, Lz1-Lz0+1
  s_cbranch_scc0 Lp_191
Lp_193:
  s_mov_b64 exec, -1
  s_barrier
  s_barrier
  s_barrier
  s_barrier
  s_barrier
  s_barrier
  s_add_u32 s92, s83, 31457280
  s_add_u32 s91, s91, 4
  s_sub_u32 s16, s78, s76
  s_add_u32 s16, s16, 1
  s_and_b32 s16, s16, 15
  s_barrier
  s_cmp_lg_u32 s82, 0
  s_cbranch_scc1 L_194
  s_cmp_eq_u32 s16, 1
  s_cselect_b32 s4, 0, 28672
  v_add_u32 v112, s4, v16
  v_add_u32 v113, s4, v17
  v_add_u32 v114, s4, v18
  v_add_u32 v115, s4, v19
  v_add_u32 v116, s4, v20
  v_add_u32 v117, s4, v21
  ds_read_b64_tr_b16 v[32:33], v112 offset:0
  ds_read_b64_tr_b16 v[34:35], v112 offset:2048
  ds_read_b64_tr_b16 v[36:37], v113 offset:0
  ds_read_b64_tr_b16 v[38:39], v113 offset:2048
  ds_read_b64_tr_b16 v[40:41], v114 offset:0
  ds_read_b64_tr_b16 v[42:43], v114 offset:2048
  ds_read_b64_tr_b16 v[44:45], v115 offset:0
  ds_read_b64_tr_b16 v[46:47], v115 offset:2048
  ds_read_b64_tr_b16 v[48:49], v112 offset:4096
  ds_read_b64_tr_b16 v[50:51], v112 offset:6144
  ds_read_b64_tr_b16 v[52:53], v113 offset:4096
  ds_read_b64_tr_b16 v[54:55], v113 offset:6144
  s_nop 0
  s_waitcnt lgkmcnt(6)
  ds_read_b64_tr_b16 v[56:57], v114 offset:4096
  ds_read_b64_tr_b16 v[58:59], v114 offset:6144
  ds_read_b64_tr_b16 v[60:61], v115 offset:4096
  ds_read_b64_tr_b16 v[62:63], v115 offset:6144
  s_nop 0
  s_waitcnt lgkmcnt(6)
  ds_read_b64_tr_b16 v[64:65], v112 offset:8192
  ds_read_b64_tr_b16 v[66:67], v112 offset:10240
  ds_read_b64_tr_b16 v[68:69], v113 offset:8192
  ds_read_b64_tr_b16 v[70:71], v113 offset:10240
  ds_read_b64_tr_b16 v[72:73], v114 offset:8192
  ds_read_b64_tr_b16 v[74:75], v114 offset:10240
  ds_read_b64_tr_b16 v[76:77], v115 offset:8192
  ds_read_b64_tr_b16 v[78:79], v115 offset:10240
  s_nop 0
  s_waitcnt lgkmcnt(8)
  v_mfma_f32_16x16x32_bf16 v[28:31], v[32:35], v[200:203], 0
  v_mfma_f32_16x16x32_bf16 v[28:31], v[36:39], v[204:207], v[28:31]
  v_mfma_f32_16x16x32_bf16 v[28:31], v[40:43], v[208:211], v[28:31]
  v_mfma_f32_16x16x32_bf16 v[28:31], v[44:47], v[212:215], v[28:31]
  v_mfma_f32_16x16x32_bf16 v[28:31], v[48:51], v[200:203], v[28:31]
  v_mfma_f32_16x16x32_bf16 v[28:31], v[52:55], v[204:207], v[28:31]
  v_mfma_f32_16x16x32_bf16 v[28:31], v[56:59], v[208:211], v[28:31]
  v_mfma_f32_16x16x32_bf16 v[28:31], v[60:63], v[212:215], v[28:31]
  s_nop 0
  s_waitcnt lgkmcnt(7)
  ds_read_b64_tr_b16 v[80:81], v112 offset:12288
  ds_read_b64_tr_b16 v[82:83], v112 offset:14336
  ds_read_b64_tr_b16 v[84:85], v113 offset:12288
  ds_read_b64_tr_b16 v[86:87], v113 offset:14336
  ds_read_b64_tr_b16 v[88:89], v114 offset:12288
  ds_read_b64_tr_b16 v[90:91], v114 offset:14336
  ds_read_b64_tr_b16 v[92:93], v115 offset:12288
  ds_read_b64_tr_b16 v[94:95], v115 offset:14336
  s_nop 0
  s_waitcnt lgkmcnt(6)
  ds_read_b64_tr_b16 v[128:129], v112 offset:16384
  ds_read_b64_tr_b16 v[130:131], v112 offset:18432
  ds_read_b64_tr_b16 v[132:133], v113 offset:16384
  ds_read_b64_tr_b16 v[134:135], v113 offset:18432
  ds_read_b64_tr_b16 v[136:137], v114 offset:16384
  ds_read_b64_tr_b16 v[138:139], v114 offset:18432
  ds_read_b64_tr_b16 v[140:141], v115 offset:16384
  ds_read_b64_tr_b16 v[142:143], v115 offset:18432
  s_nop 0
  s_waitcnt lgkmcnt(8)
  v_mfma_f32_16x16x32_bf16 v[28:31], v[64:67], v[216:219], v[28:31]
  v_mfma_f32_16x16x32_bf16 v[28:31], v[68:71], v[220:223], v[28:31]
  v_mfma_f32_16x16x32_bf16 v[28:31], v[72:75], v[224:227], v[28:31]
  v_mfma_f32_16x16x32_bf16 v[28:31], v[76:79], v[228:231], v[28:31]
  v_mfma_f32_16x16x32_bf16 v[28:31], v[80:83], v[216:219], v[28:31]
  v_mfma_f32_16x16x32_bf16 v[28:31], v[84:87], v[220:223], v[28:31]
  v_mfma_f32_16x16x32_bf16 v[28:31], v[88:91], v[224:227], v[28:31]
  v_mfma_f32_16x16x32_bf16 v[28:31], v[92:95], v[228:231], v[28:31]
  s_nop 0
  s_waitcnt lgkmcnt(7)
  ds_read_b64_tr_b16 v[144:145], v112 offset:20480
  ds_read_b64_tr_b16 v[146:147], v112 offset:22528
  ds_read_b64_tr_b16 v[148:149], v113 offset:20480
  ds_read_b64_tr_b16 v[150:151], v113 offset:22528
  ds_read_b64_tr_b16 v[152:153], v114 offset:20480
  ds_read_b64_tr_b16 v[154:155], v114 offset:22528
  ds_read_b64_tr_b16 v[156:157], v115 offset:20480
  ds_read_b64_tr_b16 v[158:159], v115 offset:22528
  s_nop 0
  s_waitcnt lgkmcnt(6)
  ds_read_b64_tr_b16 v[160:161], v116 offset:0
  ds_read_b64_tr_b16 v[162:163], v116 offset:1024
  ds_read_b64_tr_b16 v[164:165], v117 offset:0
  ds_read_b64_tr_b16 v[166:167], v117 offset:1024
  ds_read_b64_tr_b16 v[176:177], v116 offset:2048
  ds_read_b64_tr_b16 v[178:179], v116 offset:3072
  ds_read_b64_tr_b16 v[180:181], v117 offset:2048
  ds_read_b64_tr_b16 v[182:183], v117 offset:3072
  s_nop 0
  s_waitcnt lgkmcnt(8)
  v_mfma_f32_16x16x32_bf16 v[28:31], v[128:131], v[232:235], v[28:31]
  v_mfma_f32_16x16x32_bf16 v[28:31], v[132:135], v[236:239], v[28:31]
  v_mfma_f32_16x16x32_bf16 v[28:31], v[136:139], v[240:243], v[28:31]
  v_mfma_f32_16x16x32_bf16 v[28:31], v[140:143], v[244:247], v[28:31]
  v_mfma_f32_16x16x32_bf16 v[28:31], v[144:147], v[232:235], v[28:31]
  v_mfma_f32_16x16x32_bf16 v[28:31], v[148:151], v[236:239], v[28:31]
  v_mfma_f32_16x16x32_bf16 v[28:31], v[152:155], v[240:243], v[28:31]
  v_mfma_f32_16x16x32_bf16 v[28:31], v[156:159], v[244:247], v[28:31]
  s_waitcnt lgkmcnt(7)
  s_waitcnt lgkmcnt(0)
  v_mfma_f32_16x16x32_bf16 v[28:31], v[160:163], v[248:251], v[28:31]
  v_mfma_f32_16x16x32_bf16 v[28:31], v[164:167], v[252:255], v[28:31]
  v_mfma_f32_16x16x32_bf16 v[28:31], v[176:179], v[248:251], v[28:31]
  v_mfma_f32_16x16x32_bf16 v[28:31], v[180:183], v[252:255], v[28:31]
  s_lshl_b32 s5, s77, Lz1-Lz0+14
  s_lshl_b32 s4, s76, 10
  s_add_u32 s5, s5, s4
  s_add_u32 s5, s5, 1376256
  s_nop 3
  buffer_store_dwordx4 v[28:31], v15, s[40:43], s5 offen sc0 sc1
L_194:
  s_barrier
  s_mov_b32 exec_lo, 0xffff
  s_mov_b32 exec_hi, 0
  buffer_load_dword v7, v5, s[40:43], s91 offen sc0 sc1
  s_mov_b64 exec, -1
  s_barrier
  s_waitcnt vmcnt(0)
  s_mov_b32 s89, 200000
  s_mov_b32 exec_lo, 0xffff
  s_mov_b32 exec_hi, 0
  s_branch Lp_197
Lp_196:
  buffer_load_dword v7, v5, s[40:43], s91 offen sc0 sc1
  s_waitcnt vmcnt(0)
Lp_197:
  v_cmp_ne_u32 vcc, 0, v7
  s_andn2_b32 s3, 0xffff, vcc_lo
  s_cbranch_scc0 Lp_198
  s_sleep 1
  s_sub_u32 s89, s89, Lz1-Lz0+1
  s_cbranch_scc0 Lp_196
Lp_198:
  s_mov_b64 exec, -1
  s_cmp_lg_u32 s82, 0
  s_cbranch_scc1 L_199
  s_mov_b32 s5, 1835012
  s_mov_b64 exec, 0x101
  buffer_store_dword v11, v14, s[40:43], s5 offen sc0 sc1
  s_mov_b64 exec, -1
L_199:
  s_add_u32 s5, s84, s92
  buffer_load_dwordx2 v[96:97], v6, s[40:43], s5 offen offset:0 sc1
  buffer_load_dwordx2 v[98:99], v6, s[40:43], s5 offen offset:512 sc1
  buffer_load_dwordx2 v[100:101], v6, s[40:43], s5 offen offset:1024 sc1
  buffer_load_dwordx2 v[102:103], v6, s[40:43], s5 offen offset:1536 sc1
  s_barrier
  s_barrier
  s_barrier
  s_waitcnt vmcnt(0)
  v_add_f32 v96, v96, v100
  v_add_f32 v97, v97, v101
  v_add_f32 v98, v98, v102
  v_add_f32 v99, v99, v103
  v_add_f32_e64 v96, v96, v98
  v_add_f32 v97, v97, v99
  s_nop 0
  v_add_f32_dpp v96, v96, v96 row_ror:8 row_mask:0xf bank_mask:0xf
  v_add_f32_dpp v97, v97, v97 row_ror:8 row_mask:0xf bank_mask:0xf
  v_mov_b32 v98, v96
  v_mov_b32 v99, v97
  s_nop 0
  v_permlane16_swap_b32 v96, v98
  v_permlane16_swap_b32 v97, v99
  v_add_f32 v96, v96, v98
  v_add_f32 v97, v97, v99
  v_mov_b32 v98, v96
  v_mov_b32 v99, v97
  s_nop 0
  v_permlane32_swap_b32 v96, v98
  v_permlane32_swap_b32 v97, v99
  v_add_f32 v96, v96, v98
  v_add_f32 v97, v97, v99
  v_mul_f32 v96, 0x3a800000, v96
  v_mul_f32 v97, 0x3a800000, v97
  v_fma_f32 v98, -v96, v96, v97
  v_max_f32_e64 v98, 0, v98
  v_add_f32 v98, 0x3727c5ac, v98
  v_rsq_f32_e64 v98, v98
  v_mov_b32 v99, v96
  s_mov_b64 exec, s[8:9]
  buffer_store_dwordx2 v[98:99], v6, s[40:43], s10 offen sc0 sc1
  s_mov_b64 exec, -1
  s_barrier
  s_barrier
  s_barrier
  s_barrier
  s_barrier
  s_cmp_lg_u32 s82, 0
  s_cbranch_scc1 L_201
  s_lshl_b32 s91, s84, Lz1-Lz0+1
  s_and_b32 s91, s91, 0x8f000
  s_add_u32 s91, s91, 1835012
  s_mov_b32 exec_lo, 0xffff
  s_mov_b32 exec_hi, 0
  buffer_load_dword v7, v5, s[40:43], s91 offen sc0 sc1
  s_mov_b64 exec, -1
L_201:
  s_and_b32 s5, s10, 0xfffffc00
  buffer_load_dwordx4 v[120:123], v4, s[40:43], s5 offen sc1
  s_barrier
  s_barrier
  s_waitcnt vmcnt(0)
  s_mov_b32 s89, 200000
  s_branch Lp_204
Lp_203:
  s_and_b32 s5, s10, 0xfffffc00
  buffer_load_dwordx4 v[120:123], v4, s[40:43], s5 offen sc1
  s_waitcnt vmcnt(0)
Lp_204:
  v_min_u32 v2, v120, v122
  v_cmp_eq_u32 vcc, 0, v2
  s_cmp_eq_u64 vcc, 0
  s_cbranch_scc1 Lp_205
  s_sleep 1
  s_sub_u32 s89, s89, 1
  s_cbranch_scc0 Lp_203
Lp_205:
  s_and_b32 s5, s10, 0xfffffc00
  s_mov_b32 m0, 151552
  s_nop 0
  buffer_load_dword v6, s[40:43], s5 offen offset:0 sc1 lds
  s_mov_b32 m0, 152188
  s_nop 0
  buffer_load_dword v6, s[40:43], s5 offen offset:4 sc1 lds
  s_mov_b32 m0, 151360
  s_nop 0
  buffer_load_dword v6, s[40:43], s5 offen offset:512 sc1 lds
  s_mov_b32 m0, 151996
  s_nop 0
  buffer_load_dword v6, s[40:43], s5 offen offset:516 sc1 lds
  s_add_u32 s10, s10, 16384
  s_barrier
  s_cmp_lg_u32 s82, Lz1-Lz0+0
  s_cbranch_scc1 L_206
  s_mov_b32 s89, 200000
  s_mov_b32 exec_lo, 0xffff
  s_mov_b32 exec_hi, 0
  s_branch Lp_209
Lp_208:
  buffer_load_dword v7, v5, s[40:43], s91 offen sc0 sc1
  s_waitcnt vmcnt(0)
Lp_209:
  v_cmp_ne_u32 vcc, 0, v7
  s_andn2_b32 s3, 0xffff, vcc_lo
  s_cbranch_scc0 Lp_210
  s_sleep 1
  s_sub_u32 s89, s89, 1
  s_cbranch_scc0 Lp_208
Lp_210:
  s_mov_b64 exec, -1
  s_lshl_b32 s5, s77, 14
  s_add_u32 s5, s5, 1376256
  buffer_load_dwordx4 v[192:195], v4, s[40:43], s5 offen offset:0 sc1
  buffer_load_dwordx4 v[196:199], v4, s[40:43], s5 offen offset:1024 sc1
  buffer_load_dwordx4 v[200:203], v4, s[40:43], s5 offen offset:2048 sc1
  buffer_load_dwordx4 v[204:207], v4, s[40:43], s5 offen offset:3072 sc1
  s_add_u32 s5, s5, 4096
  buffer_load_dwordx4 v[208:211], v4, s[40:43], s5 offen offset:0 sc1
  buffer_load_dwordx4 v[212:215], v4, s[40:43], s5 offen offset:1024 sc1
  buffer_load_dwordx4 v[216:219], v4, s[40:43], s5 offen offset:2048 sc1
  buffer_load_dwordx4 v[220:223], v4, s[40:43], s5 offen offset:3072 sc1
  s_lshl_b32 s5, s77, Lz1-Lz0+14
  s_add_u32 s5, s5, 1384448
  buffer_load_dwordx4 v[224:227], v4, s[40:43], s5 offen offset:0 sc1
  buffer_load_dwordx4 v[228:231], v4, s[40:43], s5 offen offset:1024 sc1
  buffer_load_dwordx4 v[232:235], v4, s[40:43], s5 offen offset:2048 sc1
  buffer_load_dwordx4 v[236:239], v4, s[40:43], s5 offen offset:3072 sc1
  s_add_u32 s5, s5, 4096
  buffer_load_dwordx4 v[240:243], v4, s[40:43], s5 offen offset:0 sc1
  buffer_load_dwordx4 v[244:247], v4, s[40:43], s5 offen offset:1024 sc1
  buffer_load_dwordx4 v[248:251], v4, s[40:43], s5 offen offset:2048 sc1
  buffer_load_dwordx4 v[252:255], v4, s[40:43], s5 offen offset:3072 sc1
L_206:
  s_barrier
  s_cmp_lg_u32 s82, 0
  s_cbranch_scc1 L_211
  s_waitcnt vmcnt(8)
  v_add_f32 v192, v192, v208
  v_add_f32 v193, v193, v209
  v_add_f32 v194, v194, v210
  v_add_f32 v195, v195, v211
  v_add_f32 v196, v196, v212
  v_add_f32 v197, v197, v213
  v_add_f32 v198, v198, v214
  v_add_f32 v199, v199, v215
  v_add_f32 v200, v200, v216
  v_add_f32 v201, v201, v217
  v_add_f32 v202, v202, v218
  v_add_f32 v203, v203, v219
  v_add_f32 v204, v204, v220
  v_add_f32 v205, v205, v221
  v_add_f32 v206, v206, v222
  v_add_f32 v207, v207, v223
  v_add_f32 v192, v192, v200
  v_add_f32 v193, v193, v201
  v_add_f32 v194, v194, v202
  v_add_f32 v195, v195, v203
  v_add_f32 v196, v196, v204
  v_add_f32 v197, v197, v205
  v_add_f32 v198, v198, v206
  v_add_f32 v199, v199, v207
  v_add_f32 v192, v192, v196
  v_add_f32 v193, v193, v197
  v_add_f32 v194, v194, v198
  v_add_f32 v195, v195, v199
L_211:
  s_cmp_lg_u32 s82, 0
  s_cbranch_scc1 L_213
  buffer_load_dword v109, v110, s[60:63], s13 offen
  s_sub_u32 s13, s13, 8192
  buffer_load_dword v109, v110, s[60:63], s13 offen
  s_sub_u32 s13, s13, 8192
L_213:
  s_barrier
  s_cmp_lg_u32 s82, 0
  s_cbranch_scc1 L_215
  s_cmp_lg_u32 s82, 0
  s_cbranch_scc1 L_217
  s_waitcnt vmcnt(2)
  s_branch L_218
L_217:
  s_waitcnt vmcnt(0)
L_218:
  v_add_f32 v224, v224, v240
  v_add_f32 v225, v225, v241
  v_add_f32 v226, v226, v242
  v_add_f32 v227, v227, v243
  v_add_f32 v228, v228, v244
  v_add_f32 v229, v229, v245
  v_add_f32 v230, v230, v246
  v_add_f32 v231, v231, v247
  v_add_f32 v232, v232, v248
  v_add_f32 v233, v233, v249
  v_add_f32 v234, v234, v250
  v_add_f32 v235, v235, v251
  v_add_f32 v236, v236, v252
  v_add_f32 v237, v237, v253
  v_add_f32 v238, v238, v254
  v_add_f32 v239, v239, v255
  v_add_f32 v224, v224, v232
  v_add_f32 v225, v225, v233
  v_add_f32 v226, v226, v234
  v_add_f32 v227, v227, v235
  v_add_f32 v228, v228, v236
  v_add_f32 v229, v229, v237
  v_add_f32 v230, v230, v238
  v_add_f32 v231, v231, v239
  v_add_f32 v224, v224, v228
  v_add_f32 v225, v225, v229
  v_add_f32 v226, v226, v230
  v_add_f32 v227, v227, v231
  v_add_f32 v192, v192, v224
  v_add_f32 v193, v193, v225
  v_add_f32 v194, v194, v226
  v_add_f32 v195, v195, v227
  v_add_u32 v2, 154112, v4
  ds_write_b128 v2, v[192:195]
  s_branch L_216
  s_nop 0
L_215:
  s_waitcnt vmcnt(0)
L_216:
  s_waitcnt lgkmcnt(0)
  s_barrier
  v_lshlrev_b32 v2, 12, v1
  s_lshl_b32 s4, s76, 16
  s_lshl_b32 s5, s77, 7
  s_add_u32 s4, s4, s5
  s_add_u32 s4, s4, s87
  s_add_u32 s5, s4, 24
  s_lshl_b32 s4, s79, 3
  s_lshl_b32 s90, 0xff, s4
  s_lshl_b32 s91, s84, 1
  s_add_u32 s91, s91, s87
  s_add_u32 s91, s91, 24
  s_lshl_b32 s4, s82, 7
  s_add_u32 s4, s4, 1837056
  s_lshl_b32 s5, s84, 1
  s_add_u32 s5, s5, s4
  s_and_b32 s91, s5, 0xffff0fff
  s_barrier
  s_barrier
  s_barrier
  s_mov_b32 exec_lo, 1
  s_mov_b32 exec_hi, Lz1-Lz0+0
  buffer_store_dword v11, v2, s[40:43], s5 offen sc0 sc1
  s_mov_b64 exec, -1
  s_barrier
  s_barrier
  s_barrier
  s_mov_b32 exec_lo, s90
  s_mov_b32 exec_hi, 0
  buffer_load_dword v7, v2, s[40:43], s91 offen sc0 sc1
  s_mov_b64 exec, -1
  s_barrier
  s_waitcnt vmcnt(0)
  s_mov_b32 s89, 200000
  s_mov_b32 exec_lo, s90
  s_mov_b32 exec_hi, 0
  s_branch Lp_220
Lp_219:
  buffer_load_dword v7, v2, s[40:43], s91 offen sc0 sc1
  s_waitcnt vmcnt(0)
Lp_220:
  v_cmp_ne_u32 vcc, 0, v7
  s_andn2_b32 s3, s90, vcc_lo
  s_cbranch_scc0 Lp_221
  s_sleep 1
  s_sub_u32 s89, s89, 1
  s_cbranch_scc0 Lp_219
Lp_221:
  s_mov_b64 exec, -1
  s_xor_b32 s90, s90, 0xffff
  s_barrier
  s_barrier
  s_barrier
  s_barrier
  s_barrier
  s_barrier
  s_barrier
  s_barrier
  s_barrier
  s_barrier
  s_mov_b32 exec_lo, s90
  s_mov_b32 exec_hi, 0
  buffer_load_dword v7, v2, s[40:43], s91 offen sc0 sc1
  s_mov_b64 exec, -1
  s_barrier
  s_barrier
  s_barrier
  s_waitcnt vmcnt(0)
  s_mov_b32 s89, 200000
  s_mov_b32 exec_lo, s90
  s_mov_b32 exec_hi, 0
  s_branch Lp_223
Lp_222:
  buffer_load_dword v7, v2, s[40:43], s91 offen sc0 sc1
  s_waitcnt vmcnt(0)
Lp_223:
  v_cmp_ne_u32 vcc, 0, v7
  s_andn2_b32 s3, s90, vcc_lo
  s_cbranch_scc0 Lp_224
  s_sleep 1
  s_sub_u32 s89, s89, 1
  s_cbranch_scc0 Lp_222
Lp_224:
  s_mov_b64 exec, -1
  s_barrier
  s_barrier
  s_barrier
  s_barrier
  s_barrier
  s_barrier
  s_barrier
  s_barrier
  s_barrier
  s_barrier
  s_barrier
  s_cmp_lg_u32 s82, 0
  s_cbranch_scc1 L_lend
  s_add_u32 s92, s83, 36700160
  s_mov_b32 s82, 1
  s_mov_b32 s14, 0
  s_add_u32 s83, s83, 0
  s_add_u32 s87, s87, 32
  s_branch L_slayer
L_lend:
Lz0:
Lz1:
L_end:
  s_endpgm
.section .rodata,"a"
.p2align 6
.amdhsa_kernel mega_kernel
  .amdhsa_next_free_vgpr 256
  .amdhsa_next_free_sgpr 102
  .amdhsa_accum_offset 256
  .amdhsa_group_segment_fixed_size 0
  .amdhsa_kernarg_size 88
  .amdhsa_user_sgpr_count 2
  .amdhsa_user_sgpr_kernarg_segment_ptr 1
  .amdhsa_system_sgpr_workgroup_id_x 1
  .amdhsa_float_denorm_mode_32 3
  .amdhsa_float_denorm_mode_16_64 3
.end_amdhsa_kernel
.text
```

```asm
; @launch kernel=mega_kernel grid=(256,1,1) block=(512,1,1) lds=156672
.amdgcn_target "amdgcn-amd-amdhsa--gfx950"
.text
.globl mega_kernel
.p2align 8
.type mega_kernel,@function
mega_kernel:
  s_cmp_ge_u32 s2, 256
  s_nop 0
  s_cbranch_scc1 L_end
  s_load_dwordx16 s[16:31], s[0:1], 0
  s_load_dwordx2 s[32:33], s[0:1], 64
  s_load_dwordx4 s[36:39], s[0:1], 72
  v_lshrrev_b32 v2, 6, v0
  v_and_b32 v1, 63, v0
  v_readfirstlane_b32 s81, v2
  s_and_b32 s3, s2, 7
  s_lshr_b32 s4, s2, 3
  s_and_b32 s5, s3, 1
  s_lshl_b32 s5, s5, 3
  s_and_b32 s6, s4, 7
  s_add_u32 s76, s5, s6
  s_lshr_b32 s5, s3, 1
  s_lshl_b32 s5, s5, 2
  s_lshr_b32 s6, s4, 3
  s_add_u32 s77, s5, s6
  s_mov_b32 s82, 0
  s_mov_b32 s88, 0
  s_and_b32 s85, s81, 1
  s_cmp_lt_u32 s81, 4
  s_cbranch_scc1 L_comp
  s_cmp_eq_u32 s81, Lz1-Lz0+5
  s_cbranch_scc1 L_serv
  s_setprio 0
  s_cmp_eq_u32 s81, 4
  s_cbranch_scc1 L_xload
  v_bfe_u32 v2, v1, 1, 2
  v_bfe_u32 v3, v1, 4, 2
  v_xor_b32 v2, v2, v3
  v_lshlrev_b32 v10, 5, v2
  v_and_b32_e64 v2, 1, v1
  v_lshl_add_u32 v10, v2, 4, v10
  v_lshrrev_b32_e64 v2, 5, v1
  v_bfe_u32 v3, v1, 3, 2
  v_lshl_add_u32 v2, v2, 3, v3
  s_mov_b32 s4, 6144
  v_mad_u32_u24 v16, v2, s4, v10
  v_add_u32 v17, 97280, v16
  v_add_u32 v18, 22528, v16
  v_add_u32 v19, 119808, v16
  s_lshl_b32 s5, s77, Lz1-Lz0+7
  s_mul_i32 s4, s85, 196608
  s_add_u32 s5, s5, s4
  s_and_b32 s6, s76, 6
  s_lshr_b32 s4, s76, 3
  s_add_u32 s6, s6, s4
  s_lshl_b32 s6, s6, 1
  v_add_u32 v20, s6, v1
  v_and_b32_e64 v20, 15, v20
  s_mov_b32 s4, 393216
  v_mul_u32_u24 v20, s4, v20
  v_add_u32 v20, s5, v20
  s_nop 0
  v_readfirstlane_b32 s7, v20
  s_lshl_b32 s11, s85, Lz1-Lz0+12
  s_add_u32 s11, s11, 65536
  s_add_u32 s15, s11, 73728
  s_waitcnt lgkmcnt(0)
  s_mov_b32 s48, s18
  s_and_b32 s49, s19, 0xffff
  s_mov_b32 s50, 6291456
  s_mov_b32 s51, 0x00020000
L_wlayer:
  s_mov_b32 s12, 0
  s_mov_b32 m0, s11
  s_cmp_eq_u32 s82, 0
  s_cbranch_scc1 Ll_34
  s_waitcnt vmcnt(12)
  s_barrier
  s_waitcnt vmcnt(8)
  s_barrier
  s_waitcnt vmcnt(4)
  s_barrier
  s_waitcnt vmcnt(0)
  s_barrier
  s_barrier
  s_branch Ll_34
Lt_40:
  s_cmp_lg_u32 s12, 1
  s_cbranch_scc1 Ll_34
  s_cmp_eq_u32 s82, 0
  s_cbranch_scc1 Ll_34
  s_waitcnt vmcnt(0)
  s_barrier
Ll_34:
  buffer_load_dwordx4 v16, s[48:51], s7 offen offset:0  lds
  buffer_load_dwordx4 v17, s[48:51], s7 offen offset:1024  lds
  buffer_load_dwordx4 v18, s[48:51], s7 offen offset:2048  lds
  buffer_load_dwordx4 v19, s[48:51], s7 offen offset:3072  lds
  s_add_u32 m0, s11, 8192
  s_add_u32 s5, s7, 2048
  buffer_load_dwordx4 v16, s[48:51], s5 offen offset:0  lds
  buffer_load_dwordx4 v17, s[48:51], s5 offen offset:1024  lds
  buffer_load_dwordx4 v18, s[48:51], s5 offen offset:2048  lds
  buffer_load_dwordx4 v19, s[48:51], s5 offen offset:3072  lds
  s_add_u32 m0, s11, 16384
  s_add_u32 s5, s7, 4096
  buffer_load_dwordx4 v16, s[48:51], s5 offen offset:0  lds
  s_add_u32 s12, s12, Lz1-Lz0+1
  v_readlane_b32 s7, v20, s12
  s_add_u32 s11, s11, 24576
  buffer_load_dwordx4 v17, s[48:51], s5 offen offset:1024  lds
  s_cmp_eq_u32 s11, s15
  s_cselect_b32 s4, 73728, 0
  s_sub_u32 s11, s11, s4
  buffer_load_dwordx4 v18, s[48:51], s5 offen offset:2048  lds
  s_cmp_lg_u32 s12, Lz1-Lz0+3
  buffer_load_dwordx4 v19, s[48:51], s5 offen offset:3072  lds
  s_mov_b32 m0, s11
  s_cbranch_scc1 Lt_40
Lt_41:
  s_cmp_lg_u32 s82, Lz1-Lz0+0
  s_cbranch_scc1 Ll_42
  s_waitcnt vmcnt(24)
  s_barrier
Ll_42:
  s_mul_i32 s5, s85, 6144
  s_mov_b32 s68, s24
  s_and_b32 s69, s25, 0xffff
  s_mov_b32 s70, 7340032
  s_mov_b32 s71, 0x00020000
  s_lshl_b32 s4, s76, 4
  s_add_u32 s4, s4, s77
  s_mul_i32 s34, s4, 28672
  s_add_u32 s34, s34, s5
  s_mov_b32 s40, s38
  s_and_b32 s41, s39, 0xffff
  s_mov_b32 s42, 100663296
  s_mov_b32 s43, 0x00020000
  s_nop 0
  s_mov_b32 s52, s20
  s_and_b32 s53, s21, 0xffff
  s_mov_b32 s54, 2097152
  s_mov_b32 s55, 0x00020000
  s_nop 0
  s_mov_b32 s56, s24
  s_and_b32 s57, s25, 0xffff
  s_mov_b32 s58, 7340032
  s_mov_b32 s59, 0x00020000
  s_nop 0
  s_mov_b32 s60, s28
  s_and_b32 s61, s29, 0xffff
  s_mov_b32 s62, 7340032
  s_mov_b32 s63, 0x00020000
  s_cmp_lg_u32 s82, 0
  s_cbranch_scc1 L_43
  s_and_b32 s80, s77, 7
  s_lshr_b32 s79, s77, 3
  s_lshl_b32 s78, s80, 1
  s_add_u32 s78, s78, s79
  s_lshl_b32 s5, s76, 4
  s_add_u32 s5, s5, s77
  s_lshl_b32 s84, s5, Lz1-Lz0+11
  s_mov_b32 s83, 3145728
  s_mov_b32 s87, 1835016
  s_lshr_b32 s86, s81, 1
  v_lshrrev_b32 v2, 3, v1
  s_mov_b32 s4, 2048
  v_mad_u32_u24 v4, v2, s4, v10
  v_add_u32 v5, 15360, v4
  v_add_u32 v6, 30720, v4
  v_add_u32 v7, 46080, v4
  s_lshl_b32 s5, s78, Lz1-Lz0+7
  s_mul_i32 s4, s85, 65536
  s_add_u32 s5, s5, s4
  s_mul_i32 s4, s76, 14
  s_lshr_b32 s4, s4, 4
  v_add_u32 v39, s4, v1
  v_subrev_u32 v2, 14, v39
  v_min_u32 v39, v39, v2
  v_cmp_le_u32 vcc, 14, v1
  s_nop 1
  v_cndmask_b32 v39, v39, v1, vcc
  v_lshlrev_b32 v39, 2, v39
  v_mov_b32 v2, 0x87654210
  v_mov_b32 v3, 0xb3fedca9
  v_lshrrev_b64 v[2:3], v39, v[2:3]
  v_and_b32_e64 v39, 15, v2
  v_cmp_eq_u32 vcc, s77, v39
  s_nop 0
  v_mov_b32_dpp v2, v39 row_shr:1 row_mask:0xf bank_mask:0xf
  s_ff1_i32_b32 s4, vcc_lo
  v_cmp_ge_u32 vcc, s4, v1
  s_nop 1
  v_cndmask_b32 v39, v39, v2, vcc
  v_writelane_b32 v39, s77, 0
  v_lshl_add_u32 v38, v39, 17, s5
L_43:
  s_waitcnt vmcnt(12)
  s_barrier
  buffer_load_dwordx4 v16, s[48:51], s7 offen offset:0  lds
  buffer_load_dwordx4 v17, s[48:51], s7 offen offset:1024  lds
  buffer_load_dwordx4 v18, s[48:51], s7 offen offset:2048  lds
  buffer_load_dwordx4 v19, s[48:51], s7 offen offset:3072  lds
Ll_44:
  s_add_u32 m0, s11, 8192
  s_add_u32 s5, s7, 2048
  buffer_load_dwordx4 v16, s[48:51], s5 offen offset:0  lds
  buffer_load_dwordx4 v17, s[48:51], s5 offen offset:1024  lds
  buffer_load_dwordx4 v18, s[48:51], s5 offen offset:2048  lds
  buffer_load_dwordx4 v19, s[48:51], s5 offen offset:3072  lds
  s_add_u32 m0, s11, 16384
  s_add_u32 s5, s7, 4096
  buffer_load_dwordx4 v16, s[48:51], s5 offen offset:0  lds
  s_add_u32 s12, s12, Lz1-Lz0+1
  v_readlane_b32 s7, v20, s12
  s_add_u32 s11, s11, 24576
  buffer_load_dwordx4 v17, s[48:51], s5 offen offset:1024  lds
  s_cmp_eq_u32 s11, s15
  s_cselect_b32 s4, 73728, 0
  s_sub_u32 s11, s11, s4
  buffer_load_dwordx4 v18, s[48:51], s5 offen offset:2048  lds
  s_cmp_eq_u32 s12, Lz1-Lz0+16
  buffer_load_dwordx4 v19, s[48:51], s5 offen offset:3072  lds
  s_mov_b32 m0, s11
  s_cbranch_scc1 Ll_45
  s_cmp_lg_u32 s82, 0
  s_cbranch_scc1 L_46
  s_buffer_load_dwordx2 s[98:99], s[68:71], s34 offset:60
  s_buffer_load_dwordx2 s[98:99], s[68:71], s34 offset:188
  s_buffer_load_dwordx2 s[98:99], s[68:71], s34 offset:316
  s_buffer_load_dwordx2 s[98:99], s[68:71], s34 offset:444
  s_add_u32 s34, s34, 512
L_46:
  s_waitcnt vmcnt(12)
  s_barrier
  buffer_load_dwordx4 v16, s[48:51], s7 offen offset:0  lds
  buffer_load_dwordx4 v17, s[48:51], s7 offen offset:1024  lds
  buffer_load_dwordx4 v18, s[48:51], s7 offen offset:2048  lds
  buffer_load_dwordx4 v19, s[48:51], s7 offen offset:3072  lds
  s_branch Ll_44
Ll_45:
  s_branch L_w1
L_xload:
  s_setprio 0
  v_lshrrev_b32 v2, 4, v1
  v_and_b32 v3, 7, v1
  v_xor_b32 v2, v2, v3
  v_lshrrev_b32 v3, 3, v1
  v_lshlrev_b32 v3, 12, v3
  v_lshl_add_u32 v4, v2, 4, v3
  v_xor_b32_e64 v5, 64, v4
  v_add_u32 v5, 31744, v5
  v_add_u32 v6, 63488, v4
  v_add_u32 v7, 63488, v5
  s_mov_b32 s13, 0x20000
  s_movk_i32 s95, 2048
  s_lshl_b32 s5, s76, 18
  s_and_b32 s6, s76, 6
  s_lshr_b32 s4, s76, 3
  s_add_u32 s6, s6, s4
  s_lshl_b32 s6, s6, 1
  v_add_u32 v9, s6, v1
  v_and_b32 v9, 15, v9
  v_lshl_add_u32 v9, v9, 7, s5
  s_nop 0
  v_readfirstlane_b32 s7, v9
  s_waitcnt lgkmcnt(0)
  s_mov_b32 s72, s16
  s_and_b32 s73, s17, 0xffff
  s_mov_b32 s74, 4194304
  s_mov_b32 s75, 0x00020000
  s_mov_b32 s11, 0
  s_mov_b32 s15, 65536
L_xlayer:
  s_mov_b32 s12, s82
  s_mov_b32 m0, s11
Ll_87:
  s_nop 0
  buffer_load_dwordx4 v4, s[72:75], s7 offen offset:0 sc1 lds
  buffer_load_dwordx4 v5, s[72:75], s7 offen offset:1024 sc1 lds
  buffer_load_dwordx4 v6, s[72:75], s7 offen offset:2048 sc1 lds
  buffer_load_dwordx4 v7, s[72:75], s7 offen offset:3072 sc1 lds
  s_add_u32 m0, s11, 4096
  s_nop 0
  s_add_u32 s5, s7, s13
  buffer_load_dwordx4 v4, s[72:75], s5 offen offset:0 sc1 lds
  buffer_load_dwordx4 v5, s[72:75], s5 offen offset:1024 sc1 lds
  buffer_load_dwordx4 v6, s[72:75], s5 offen offset:2048 sc1 lds
  buffer_load_dwordx4 v7, s[72:75], s5 offen offset:3072 sc1 lds
  s_add_u32 m0, s11, 8192
  s_nop 0
  s_add_u32 s3, s7, s95
  buffer_load_dwordx4 v4, s[72:75], s3 offen offset:0 sc1 lds
  buffer_load_dwordx4 v5, s[72:75], s3 offen offset:1024 sc1 lds
  buffer_load_dwordx4 v6, s[72:75], s3 offen offset:2048 sc1 lds
  buffer_load_dwordx4 v7, s[72:75], s3 offen offset:3072 sc1 lds
  s_add_u32 m0, s11, 12288
  s_add_u32 s5, s3, s13
  buffer_load_dwordx4 v4, s[72:75], s5 offen offset:0 sc1 lds
  s_add_u32 s12, s12, 1
  v_readlane_b32 s7, v9, s12
  s_add_u32 s11, s11, 16384
  buffer_load_dwordx4 v5, s[72:75], s5 offen offset:1024 sc1 lds
  s_cmp_eq_u32 s11, s15
  s_cselect_b32 s4, 65536, 0
  s_sub_u32 s11, s11, s4
  buffer_load_dwordx4 v6, s[72:75], s5 offen offset:2048 sc1 lds
  s_cmp_lg_u32 s12, Lz1-Lz0+2
  buffer_load_dwordx4 v7, s[72:75], s5 offen offset:3072 sc1 lds
  s_mov_b32 m0, s11
  s_cbranch_scc1 Ll_88
  s_cmp_lg_u32 s82, 0
  s_cbranch_scc1 Ll_88
  s_waitcnt vmcnt(16)
  s_barrier
Ll_92:
Ll_88:
  s_cmp_lt_u32 s12, Lz1-Lz0+4
  s_cbranch_scc1 Ll_87
  s_mov_b32 s68, s20
  s_and_b32 s69, s21, 0xffff
  s_mov_b32 s70, 2097152
  s_mov_b32 s71, 0x00020000
  s_lshl_b32 s4, s76, 4
  s_add_u32 s4, s4, s77
  s_mul_i32 s34, s4, 8192
  s_waitcnt vmcnt(32)
  s_barrier
  buffer_load_dwordx4 v4, s[72:75], s7 offen offset:0 sc1 lds
  buffer_load_dwordx4 v5, s[72:75], s7 offen offset:1024 sc1 lds
  buffer_load_dwordx4 v6, s[72:75], s7 offen offset:2048 sc1 lds
  buffer_load_dwordx4 v7, s[72:75], s7 offen offset:3072 sc1 lds
Ll_93:
  s_add_u32 m0, s11, 4096
  s_nop 0
  s_add_u32 s5, s7, s13
  buffer_load_dwordx4 v4, s[72:75], s5 offen offset:0 sc1 lds
  buffer_load_dwordx4 v5, s[72:75], s5 offen offset:1024 sc1 lds
  buffer_load_dwordx4 v6, s[72:75], s5 offen offset:2048 sc1 lds
  buffer_load_dwordx4 v7, s[72:75], s5 offen offset:3072 sc1 lds
  s_add_u32 m0, s11, 8192
  s_nop 0
  s_add_u32 s3, s7, s95
  buffer_load_dwordx4 v4, s[72:75], s3 offen offset:0 sc1 lds
  buffer_load_dwordx4 v5, s[72:75], s3 offen offset:1024 sc1 lds
  buffer_load_dwordx4 v6, s[72:75], s3 offen offset:2048 sc1 lds
  buffer_load_dwordx4 v7, s[72:75], s3 offen offset:3072 sc1 lds
  s_add_u32 m0, s11, 12288
  s_add_u32 s5, s3, s13
  buffer_load_dwordx4 v4, s[72:75], s5 offen offset:0 sc1 lds
  s_add_u32 s12, s12, 1
  v_readlane_b32 s7, v9, s12
  s_add_u32 s11, s11, 16384
  buffer_load_dwordx4 v5, s[72:75], s5 offen offset:1024 sc1 lds
  s_cmp_eq_u32 s11, s15
  s_cselect_b32 s4, 65536, 0
  s_sub_u32 s11, s11, s4
  buffer_load_dwordx4 v6, s[72:75], s5 offen offset:2048 sc1 lds
  s_cmp_eq_u32 s12, Lz1-Lz0+16
  buffer_load_dwordx4 v7, s[72:75], s5 offen offset:3072 sc1 lds
  s_mov_b32 m0, s11
  s_cbranch_scc1 Ll_94
  s_cmp_lg_u32 s82, 0
  s_cbranch_scc1 L_95
  s_buffer_load_dwordx2 s[98:99], s[68:71], s34 offset:60
  s_buffer_load_dwordx2 s[98:99], s[68:71], s34 offset:188
  s_buffer_load_dwordx2 s[98:99], s[68:71], s34 offset:316
  s_buffer_load_dwordx2 s[98:99], s[68:71], s34 offset:444
  s_buffer_load_dwordx2 s[98:99], s[68:71], s34 offset:572
  s_add_u32 s34, s34, 640
L_95:
  s_waitcnt vmcnt(32)
  s_barrier
  buffer_load_dwordx4 v4, s[72:75], s7 offen offset:0 sc1 lds
  buffer_load_dwordx4 v5, s[72:75], s7 offen offset:1024 sc1 lds
  buffer_load_dwordx4 v6, s[72:75], s7 offen offset:2048 sc1 lds
  buffer_load_dwordx4 v7, s[72:75], s7 offen offset:3072 sc1 lds
  s_branch Ll_93
Ll_94:
  s_waitcnt vmcnt(32)
  s_barrier
  s_branch L_x1
L_serv:
  s_setprio 3
  s_and_b32 s80, s77, 7
  s_lshr_b32 s79, s77, 3
  s_lshl_b32 s78, s80, 1
  s_add_u32 s78, s78, s79
  s_lshl_b32 s5, s76, 4
  s_add_u32 s5, s5, s77
  s_lshl_b32 s84, s5, 11
  s_mov_b32 s83, 3145728
  s_mov_b32 s87, 1835016
  s_lshr_b32 s86, s81, 1
  v_lshlrev_b32 v4, 4, v1
  v_mov_b32 v24, 0
  v_mov_b32 v25, 0
  v_mov_b32 v26, 0
  v_mov_b32 v27, 0
  v_and_b32 v2, 14, v1
  v_lshlrev_b32 v3, 11, v2
  v_and_b32_e64 v2, 1, v1
  v_lshl_add_u32 v3, v2, 4, v3
  v_and_b32_e64 v2, 48, v1
  v_lshl_add_u32 v3, v2, 1, v3
  v_bfe_u32 v2, v1, 3, 2
  v_and_b32 v22, 7, v1
  v_lshlrev_b32 v2, 14, v2
  v_lshl_add_u32 v2, v22, 3, v2
  s_lshl_b32 s5, s76, 7
  s_lshl_b32 s4, s80, 4
  s_add_u32 s6, s5, s4
  s_add_u32 s6, s6, s79
  s_lshl_b32 s6, s6, 11
  s_lshr_b32 s10, s84, 5
  s_add_u32 s10, s10, 1638400
  s_waitcnt lgkmcnt(0)
  s_mov_b32 s40, s38
  s_and_b32 s41, s39, 0xffff
  s_mov_b32 s42, 100663296
  s_mov_b32 s43, 0x00020000
  s_nop 0
  s_mov_b32 s44, s16
  s_and_b32 s45, s17, 0xffff
  s_mov_b32 s46, 4194304
  s_mov_b32 s47, 0x00020000
  s_nop 0
  s_mov_b32 s68, s36
  s_and_b32 s69, s37, 0xffff
  s_mov_b32 s70, 256
  s_mov_b32 s71, 0x00020000
  s_lshl_b32 s4, s84, Lz1-Lz0+1
  s_add_u32 s4, s4, 1835008
  buffer_store_dwordx4 v[24:27], v4, s[40:43], s4 offen offset:0 sc0 sc1
  buffer_store_dwordx4 v[24:27], v4, s[40:43], s4 offen offset:1024 sc0 sc1
  s_mov_b64 exec, 0xffff
  buffer_store_dwordx4 v[24:27], v4, s[40:43], s4 offen offset:2048 sc0 sc1
  s_mov_b64 exec, -1
  v_mov_b32 v28, -1
  v_mov_b32 v29, -1
  v_mov_b32 v30, -1
  v_mov_b32 v31, -1
  s_lshl_b32 s4, s84, 1
  s_add_u32 s4, s4, Lz1-Lz0+0
  buffer_store_dwordx4 v[28:31], v4, s[40:43], s4 offen offset:0 sc0 sc1
  buffer_store_dwordx4 v[28:31], v4, s[40:43], s4 offen offset:1024 sc0 sc1
  buffer_store_dwordx4 v[28:31], v4, s[40:43], s4 offen offset:2048 sc0 sc1
  buffer_store_dwordx4 v[28:31], v4, s[40:43], s4 offen offset:3072 sc0 sc1
  buffer_store_dwordx2 v[24:25], v2, s[40:43], s10 offen sc0 sc1
  v_mov_b32 v108, v3
  s_mov_b32 s7, s6
  s_branch L_s1
L_comp:
  s_and_b32 s80, s77, 7
  s_lshr_b32 s79, s77, 3
  s_lshl_b32 s78, s80, 1
  s_add_u32 s78, s78, s79
  s_lshl_b32 s5, s76, 4
  s_add_u32 s5, s5, s77
  s_lshl_b32 s84, s5, 11
  s_mov_b32 s83, 3145728
  s_mov_b32 s87, 1835016
  s_lshr_b32 s86, s81, Lz1-Lz0+1
  s_waitcnt lgkmcnt(0)
  s_mov_b32 s40, s38
  s_and_b32 s41, s39, 0xffff
  s_mov_b32 s42, 100663296
  s_mov_b32 s43, 0x00020000
  s_nop 0
  s_mov_b32 s64, s32
  s_and_b32 s65, s33, 0xffff
  s_mov_b32 s66, 4194304
  s_mov_b32 s67, 0x00020000
  s_setprio 1
  v_lshlrev_b32 v11, 4, v1
  v_lshrrev_b32 v2, 3, v1
  v_and_b32 v3, 7, v1
  v_lshlrev_b32_e64 v3, 3, v3
  v_lshl_add_u32 v30, v2, 11, v3
  s_lshl_b32 s4, s85, 13
  s_lshl_b32 s5, s86, 10
  s_add_u32 s4, s4, s5
  v_add_u32 v0, s4, v11
  v_mov_b32_e64 v27, 1
  v_mov_b32 v28, 156416
  v_and_b32 v29, 48, v1
  s_lshl_b32 s4, s76, 16
  s_lshl_b32 s5, s77, 7
  s_add_u32 s4, s4, s5
  v_lshlrev_b32 v24, 12, v1
  v_and_b32 v2, 16, v1
  v_lshl_add_u32 v24, v2, 7, v24
  v_add_u32 v24, s4, v24
  v_lshrrev_b32 v2, 2, v1
  v_lshlrev_b32 v25, 7, v2
  v_and_b32 v2, 3, v1
  v_lshl_add_u32 v25, v2, 3, v25
  v_add_u32 v25, 65536, v25
  v_bfe_u32 v26, v1, 3, 2
  v_and_b32 v2, 15, v1
  v_lshrrev_b32 v3, 2, v29
  v_sub_u32_e64 v2, v2, v3
  s_mov_b32 s4, 0xf149f2ca
  v_mov_b32 v32, s4
  v_subrev_u32 v3, 0, v2
  v_cmp_gt_u32 vcc, 8, v3
  s_nop 1
  v_cndmask_b32_e64 v12, v32, 0, vcc
  v_cmp_ge_i32 vcc, -9, v3
  s_nop 1
  v_cndmask_b32_e64 v16, v32, 0, vcc
  v_cndmask_b32_e64 v20, 0, -1, vcc
  v_subrev_u32_e64 v3, 1, v2
  v_cmp_gt_u32 vcc, 8, v3
  s_nop 1
  v_cndmask_b32_e64 v13, v32, 0, vcc
  v_cmp_ge_i32 vcc, -9, v3
  s_nop 1
  v_cndmask_b32_e64 v17, v32, 0, vcc
  v_cndmask_b32_e64 v21, 0, -1, vcc
  v_subrev_u32_e64 v3, 2, v2
  v_cmp_gt_u32 vcc, 8, v3
  s_nop 1
  v_cndmask_b32_e64 v14, v32, 0, vcc
  v_cmp_ge_i32 vcc, -9, v3
  s_nop 1
  v_cndmask_b32_e64 v18, v32, 0, vcc
  v_cndmask_b32_e64 v22, 0, -1, vcc
  v_subrev_u32_e64 v3, 3, v2
  v_cmp_gt_u32 vcc, 8, v3
  s_nop 1
  v_cndmask_b32_e64 v15, v32, 0, vcc
  v_cmp_ge_i32 vcc, -9, v3
  s_nop 1
  v_cndmask_b32_e64 v19, v32, 0, vcc
  v_cndmask_b32_e64 v23, 0, -1, vcc
  v_alignbit_b32 v20, v21, v20, 16
  v_alignbit_b32 v21, v23, v22, 16
  s_lshl_b32 s11, s84, Lz1-Lz0+1
  s_lshl_b32 s4, s81, 10
  s_add_u32 s11, s11, s4
  v_bfe_u32 v2, v1, 4, 1
  v_lshrrev_b32_e64 v3, 5, v1
  v_lshl_add_u32 v2, v2, 1, v3
  v_lshl_add_u32 v2, s86, 2, v2
  v_bfe_u32 v3, v1, 1, 3
  v_xor_b32 v2, v2, v3
  v_and_b32 v3, 15, v1
  v_lshl_add_u32 v2, v3, 3, v2
  s_lshl_b32 s4, s85, Lz1-Lz0+13
  v_lshl_add_u32 v255, v2, 4, s4
L_clayer:
  s_mov_b32 s16, Lz1-Lz0+0
  s_mov_b32 s17, 16384
  s_mov_b32 s18, 0xffff4000
  s_mov_b32 s19, Lz1-Lz0+0
  s_mov_b32 s20, 24576
  s_mov_b32 s21, 0xffff4000
  s_mul_i32 s4, s85, 8192
  v_add_u32_e64 v4, s4, v11
  v_add_u32 v5, 1024, v4
  s_cmp_lg_u32 s82, 0
  s_cbranch_scc1 L_1
  v_and_b32 v2, 15, v1
  v_lshrrev_b32 v3, 1, v2
  v_lshrrev_b32 v32, 4, v1
  v_xor_b32 v3, v3, v32
  v_lshlrev_b32_e64 v3, 4, v3
  v_lshl_add_u32 v3, v2, 7, v3
  v_add_u32 v4, s4, v3
  v_xor_b32 v3, 64, v3
  v_add_u32 v5, s4, v3
L_1:
  s_lshl_b32 s4, s86, 1
  v_xor_b32_e64 v2, s4, v26
  v_lshl_add_u32 v6, v2, 5, v25
  s_add_u32 s4, s4, 1
  v_xor_b32 v2, s4, v26
  v_lshl_add_u32 v7, v2, 5, v25
  v_mov_b64 v[128:129], 0
  v_mov_b64 v[130:131], 0
  v_mov_b64 v[132:133], 0
  v_mov_b64 v[134:135], 0
  v_mov_b64 v[136:137], 0
  v_mov_b64 v[138:139], 0
  v_mov_b64 v[140:141], 0
  v_mov_b64 v[142:143], 0
  v_mov_b64 v[144:145], 0
  v_mov_b64 v[146:147], 0
  v_mov_b64 v[148:149], 0
  v_mov_b64 v[150:151], 0
  v_mov_b64 v[152:153], 0
  v_mov_b64 v[154:155], 0
  v_mov_b64 v[156:157], 0
  v_mov_b64 v[158:159], 0
  v_mov_b64 v[160:161], 0
  v_mov_b64 v[162:163], 0
  v_mov_b64 v[164:165], 0
  v_mov_b64 v[166:167], 0
  v_mov_b64 v[168:169], 0
  v_mov_b64 v[170:171], 0
  v_mov_b64 v[172:173], 0
  v_mov_b64 v[174:175], 0
  v_mov_b64 v[176:177], 0
  v_mov_b64 v[178:179], 0
  v_mov_b64 v[180:181], 0
  v_mov_b64 v[182:183], 0
  v_mov_b64 v[184:185], 0
  v_mov_b64 v[186:187], 0
  v_mov_b64 v[188:189], 0
  v_mov_b64 v[190:191], 0
  v_mov_b64 v[192:193], 0
  v_mov_b64 v[194:195], 0
  v_mov_b64 v[196:197], 0
  v_mov_b64 v[198:199], 0
  v_mov_b64 v[200:201], 0
  v_mov_b64 v[202:203], 0
  v_mov_b64 v[204:205], 0
  v_mov_b64 v[206:207], 0
  v_mov_b64 v[208:209], 0
  v_mov_b64 v[210:211], 0
  v_mov_b64 v[212:213], 0
  v_mov_b64 v[214:215], 0
  v_mov_b64 v[216:217], 0
  v_mov_b64 v[218:219], 0
  v_mov_b64 v[220:221], 0
  v_mov_b64 v[222:223], 0
  s_mul_i32 s4, s85, 320
  s_add_u32 s4, s4, 151552
  v_and_b32_e64 v2, 15, v1
  v_lshl_add_u32 v3, v2, 2, s4
  v_add_u32 v10, s4, v29
  s_lshl_b32 s5, s86, 7
  s_add_u32 s5, s5, 153088
  v_add_u32_e64 v8, s5, v29
  v_lshl_add_u32 v2, v2, 2, s5
  s_mov_b32 s10, 0x7f
  s_mov_b32 s12, 0xff00ff00
  s_add_u32 s9, s11, 65536
  v_lshrrev_b32_e64 v9, 1, v11
  v_bfi_b32 v9, s10, v11, v9
  s_mov_b32 s22, Lz1-Lz0+8
  s_cmp_lg_u32 s82, 0
  s_cselect_b64 vcc, -1, 0
  s_waitcnt lgkmcnt(0)
  s_barrier
Lo_5:
  ds_read_b128 v[32:35], v4 offset:0
  ds_read_b128 v[48:51], v5 offset:0
  ds_read_b128 v[36:39], v4 offset:2048
  ds_read_b128 v[52:55], v5 offset:2048
  ds_read_b128 v[40:43], v4 offset:4096
  ds_read_b128 v[56:59], v5 offset:4096
  ds_read_b64_tr_b16 v[96:97], v6 offset:0
  ds_read_b64_tr_b16 v[98:99], v6 offset:2048
  ds_read_b64_tr_b16 v[100:101], v6 offset:4096
  ds_read_b64_tr_b16 v[102:103], v6 offset:6144
  ds_read_b128 v[44:47], v4 offset:6144
  ds_read_b128 v[60:63], v5 offset:6144
  ds_read_b64_tr_b16 v[104:105], v7 offset:0
  s_nop 0
  s_waitcnt lgkmcnt(8)
  ds_read_b64_tr_b16 v[106:107], v7 offset:2048
  ds_read_b64_tr_b16 v[108:109], v7 offset:4096
  ds_read_b64_tr_b16 v[110:111], v7 offset:6144
  s_nop 0
  s_waitcnt lgkmcnt(6)
  .p2align 7
Lk_2:
  v_mfma_f32_16x16x32_bf16 v[128:131], v[96:99], v[32:35], v[128:131]
  ds_read_b64_tr_b16 v[112:113], v6 offset:8192
  v_mfma_f32_16x16x32_bf16 v[128:131], v[100:103], v[48:51], v[128:131]
  ds_read_b64_tr_b16 v[114:115], v6 offset:10240
  v_mfma_f32_16x16x32_bf16 v[136:139], v[100:103], v[52:55], v[136:139]
  ds_read_b64_tr_b16 v[116:117], v6 offset:12288
  v_mfma_f32_16x16x32_bf16 v[136:139], v[96:99], v[36:39], v[136:139]
  ds_read_b64_tr_b16 v[118:119], v6 offset:14336
  v_mfma_f32_16x16x32_bf16 v[144:147], v[96:99], v[40:43], v[144:147]
  s_add_u32 s16, s16, s17
  s_cmp_eq_u32 s16, 65536
  s_cselect_b32 s23, s18, s17
  s_cselect_b32 s16, Lz1-Lz0+0, s16
  v_mfma_f32_16x16x32_bf16 v[144:147], v[100:103], v[56:59], v[144:147]
  v_add_u32_e64 v4, s23, v4
  v_add_u32 v5, s23, v5
  s_add_u32 s19, s19, s20
  s_cmp_eq_u32 s19, 73728
  s_waitcnt lgkmcnt(8)
  v_mfma_f32_16x16x32_bf16 v[152:155], v[100:103], v[60:63], v[152:155]
  s_cselect_b32 s23, s21, s20
  s_cselect_b32 s19, 0, s19
  v_mfma_f32_16x16x32_bf16 v[152:155], v[96:99], v[44:47], v[152:155]
  s_waitcnt lgkmcnt(4)
  v_mfma_f32_16x16x32_bf16 v[156:159], v[104:107], v[44:47], v[156:159]
  ds_read_b64_tr_b16 v[120:121], v7 offset:8192
  v_mfma_f32_16x16x32_bf16 v[156:159], v[108:111], v[60:63], v[156:159]
  ds_read_b64_tr_b16 v[122:123], v7 offset:10240
  v_mfma_f32_16x16x32_bf16 v[148:151], v[108:111], v[56:59], v[148:151]
  ds_read_b64_tr_b16 v[124:125], v7 offset:12288
  v_mfma_f32_16x16x32_bf16 v[148:151], v[104:107], v[40:43], v[148:151]
  ds_read_b64_tr_b16 v[126:127], v7 offset:14336
  v_mfma_f32_16x16x32_bf16 v[140:143], v[104:107], v[36:39], v[140:143]
  ds_read_b64_tr_b16 v[224:225], v6 offset:16384
  v_mfma_f32_16x16x32_bf16 v[140:143], v[108:111], v[52:55], v[140:143]
  ds_read_b64_tr_b16 v[226:227], v6 offset:18432
  v_mfma_f32_16x16x32_bf16 v[132:135], v[108:111], v[48:51], v[132:135]
  ds_read_b64_tr_b16 v[228:229], v6 offset:20480
  v_mfma_f32_16x16x32_bf16 v[132:135], v[104:107], v[32:35], v[132:135]
  ds_read_b64_tr_b16 v[230:231], v6 offset:22528
  s_nop 0
  s_waitcnt lgkmcnt(8)
  v_mfma_f32_16x16x32_bf16 v[160:163], v[112:115], v[32:35], v[160:163]
  ds_read_b64_tr_b16 v[232:233], v7 offset:16384
  v_mfma_f32_16x16x32_bf16 v[160:163], v[116:119], v[48:51], v[160:163]
  ds_read_b64_tr_b16 v[234:235], v7 offset:18432
  v_mfma_f32_16x16x32_bf16 v[168:171], v[116:119], v[52:55], v[168:171]
  ds_read_b64_tr_b16 v[236:237], v7 offset:20480
  v_mfma_f32_16x16x32_bf16 v[168:171], v[112:115], v[36:39], v[168:171]
  ds_read_b64_tr_b16 v[238:239], v7 offset:22528
  v_mfma_f32_16x16x32_bf16 v[176:179], v[112:115], v[40:43], v[176:179]
  v_add_u32_e64 v6, s23, v6
  v_mfma_f32_16x16x32_bf16 v[176:179], v[116:119], v[56:59], v[176:179]
  v_add_u32_e64 v7, s23, v7
  v_mfma_f32_16x16x32_bf16 v[184:187], v[116:119], v[60:63], v[184:187]
  v_mfma_f32_16x16x32_bf16 v[184:187], v[112:115], v[44:47], v[184:187]
  s_cbranch_vccnz Lo_8
  s_waitcnt lgkmcnt(0)
  s_nop 0
  s_barrier
Lo_7:
  v_mfma_f32_16x16x32_bf16 v[188:191], v[120:123], v[44:47], v[188:191]
  ds_read_b128 v[64:67], v4 offset:0
  v_mfma_f32_16x16x32_bf16 v[188:191], v[124:127], v[60:63], v[188:191]
  ds_read_b128 v[80:83], v5 offset:0
  v_mfma_f32_16x16x32_bf16 v[180:183], v[124:127], v[56:59], v[180:183]
  v_mfma_f32_16x16x32_bf16 v[180:183], v[120:123], v[40:43], v[180:183]
  ds_read_b128 v[68:71], v4 offset:2048
  v_mfma_f32_16x16x32_bf16 v[172:175], v[120:123], v[36:39], v[172:175]
  ds_read_b128 v[84:87], v5 offset:2048
  v_mfma_f32_16x16x32_bf16 v[172:175], v[124:127], v[52:55], v[172:175]
  v_mfma_f32_16x16x32_bf16 v[164:167], v[124:127], v[48:51], v[164:167]
  ds_read_b128 v[72:75], v4 offset:4096
  v_mfma_f32_16x16x32_bf16 v[164:167], v[120:123], v[32:35], v[164:167]
  ds_read_b128 v[88:91], v5 offset:4096
  v_mfma_f32_16x16x32_bf16 v[192:195], v[32:35], v[224:227], v[192:195]
  ds_read_b64_tr_b16 v[96:97], v6 offset:0
  v_mfma_f32_16x16x32_bf16 v[192:195], v[48:51], v[228:231], v[192:195]
  ds_read_b64_tr_b16 v[98:99], v6 offset:2048
  v_mfma_f32_16x16x32_bf16 v[200:203], v[52:55], v[228:231], v[200:203]
  ds_read_b64_tr_b16 v[100:101], v6 offset:4096
  v_mfma_f32_16x16x32_bf16 v[200:203], v[36:39], v[224:227], v[200:203]
  ds_read_b64_tr_b16 v[102:103], v6 offset:6144
  v_mfma_f32_16x16x32_bf16 v[208:211], v[40:43], v[224:227], v[208:211]
  ds_read_b128 v[76:79], v4 offset:6144
  v_mfma_f32_16x16x32_bf16 v[208:211], v[56:59], v[228:231], v[208:211]
  v_mfma_f32_16x16x32_bf16 v[216:219], v[60:63], v[228:231], v[216:219]
  ds_read_b128 v[92:95], v5 offset:6144
  v_mfma_f32_16x16x32_bf16 v[216:219], v[44:47], v[224:227], v[216:219]
  v_mfma_f32_16x16x32_bf16 v[220:223], v[44:47], v[232:235], v[220:223]
  ds_read_b64_tr_b16 v[104:105], v7 offset:0
  v_mfma_f32_16x16x32_bf16 v[220:223], v[60:63], v[236:239], v[220:223]
  v_mfma_f32_16x16x32_bf16 v[212:215], v[56:59], v[236:239], v[212:215]
  ds_read_b64_tr_b16 v[106:107], v7 offset:2048
  v_mfma_f32_16x16x32_bf16 v[212:215], v[40:43], v[232:235], v[212:215]
  v_mfma_f32_16x16x32_bf16 v[204:207], v[36:39], v[232:235], v[204:207]
  ds_read_b64_tr_b16 v[108:109], v7 offset:4096
  v_mfma_f32_16x16x32_bf16 v[204:207], v[52:55], v[236:239], v[204:207]
  v_mfma_f32_16x16x32_bf16 v[196:199], v[48:51], v[236:239], v[196:199]
  ds_read_b64_tr_b16 v[110:111], v7 offset:6144
  s_waitcnt lgkmcnt(6)
  v_mfma_f32_16x16x32_bf16 v[196:199], v[32:35], v[232:235], v[196:199]
  s_cbranch_vccnz Lo_6
Lk_3:
  v_mfma_f32_16x16x32_bf16 v[128:131], v[96:99], v[64:67], v[128:131]
  ds_read_b64_tr_b16 v[112:113], v6 offset:8192
  v_mfma_f32_16x16x32_bf16 v[128:131], v[100:103], v[80:83], v[128:131]
  ds_read_b64_tr_b16 v[114:115], v6 offset:10240
  v_mfma_f32_16x16x32_bf16 v[136:139], v[100:103], v[84:87], v[136:139]
  ds_read_b64_tr_b16 v[116:117], v6 offset:12288
  v_mfma_f32_16x16x32_bf16 v[136:139], v[96:99], v[68:71], v[136:139]
  ds_read_b64_tr_b16 v[118:119], v6 offset:14336
  v_mfma_f32_16x16x32_bf16 v[144:147], v[96:99], v[72:75], v[144:147]
  s_add_u32 s16, s16, s17
  s_cmp_eq_u32 s16, 65536
  s_cselect_b32 s23, s18, s17
  s_cselect_b32 s16, Lz1-Lz0+0, s16
  v_mfma_f32_16x16x32_bf16 v[144:147], v[100:103], v[88:91], v[144:147]
  v_add_u32_e64 v4, s23, v4
  v_add_u32 v5, s23, v5
  s_add_u32 s19, s19, s20
  s_cmp_eq_u32 s19, 73728
  s_waitcnt lgkmcnt(8)
  v_mfma_f32_16x16x32_bf16 v[152:155], v[100:103], v[92:95], v[152:155]
  s_cselect_b32 s23, s21, s20
  s_cselect_b32 s19, 0, s19
  v_mfma_f32_16x16x32_bf16 v[152:155], v[96:99], v[76:79], v[152:155]
  s_waitcnt lgkmcnt(4)
  v_mfma_f32_16x16x32_bf16 v[156:159], v[104:107], v[76:79], v[156:159]
  ds_read_b64_tr_b16 v[120:121], v7 offset:8192
  v_mfma_f32_16x16x32_bf16 v[156:159], v[108:111], v[92:95], v[156:159]
  ds_read_b64_tr_b16 v[122:123], v7 offset:10240
  v_mfma_f32_16x16x32_bf16 v[148:151], v[108:111], v[88:91], v[148:151]
  ds_read_b64_tr_b16 v[124:125], v7 offset:12288
  v_mfma_f32_16x16x32_bf16 v[148:151], v[104:107], v[72:75], v[148:151]
  ds_read_b64_tr_b16 v[126:127], v7 offset:14336
  v_mfma_f32_16x16x32_bf16 v[140:143], v[104:107], v[68:71], v[140:143]
  ds_read_b64_tr_b16 v[224:225], v6 offset:16384
  v_mfma_f32_16x16x32_bf16 v[140:143], v[108:111], v[84:87], v[140:143]
  ds_read_b64_tr_b16 v[226:227], v6 offset:18432
  v_mfma_f32_16x16x32_bf16 v[132:135], v[108:111], v[80:83], v[132:135]
  ds_read_b64_tr_b16 v[228:229], v6 offset:20480
  v_mfma_f32_16x16x32_bf16 v[132:135], v[104:107], v[64:67], v[132:135]
  ds_read_b64_tr_b16 v[230:231], v6 offset:22528
  s_nop 0
  s_waitcnt lgkmcnt(8)
  v_mfma_f32_16x16x32_bf16 v[160:163], v[112:115], v[64:67], v[160:163]
  ds_read_b64_tr_b16 v[232:233], v7 offset:16384
  v_mfma_f32_16x16x32_bf16 v[160:163], v[116:119], v[80:83], v[160:163]
  ds_read_b64_tr_b16 v[234:235], v7 offset:18432
  v_mfma_f32_16x16x32_bf16 v[168:171], v[116:119], v[84:87], v[168:171]
  ds_read_b64_tr_b16 v[236:237], v7 offset:20480
  v_mfma_f32_16x16x32_bf16 v[168:171], v[112:115], v[68:71], v[168:171]
  ds_read_b64_tr_b16 v[238:239], v7 offset:22528
  v_mfma_f32_16x16x32_bf16 v[176:179], v[112:115], v[72:75], v[176:179]
  v_add_u32_e64 v6, s23, v6
  v_mfma_f32_16x16x32_bf16 v[176:179], v[116:119], v[88:91], v[176:179]
  v_add_u32_e64 v7, s23, v7
  v_mfma_f32_16x16x32_bf16 v[184:187], v[116:119], v[92:95], v[184:187]
  s_sub_u32 s22, s22, 1
  s_cmp_lg_u32 s22, 0
  v_mfma_f32_16x16x32_bf16 v[184:187], v[112:115], v[76:79], v[184:187]
  s_waitcnt lgkmcnt(0)
  s_barrier
  v_mfma_f32_16x16x32_bf16 v[188:191], v[120:123], v[76:79], v[188:191]
  s_nop 0
  s_cbranch_scc0 Lk_4
  ds_read_b128 v[32:35], v4 offset:0
  v_mfma_f32_16x16x32_bf16 v[188:191], v[124:127], v[92:95], v[188:191]
  ds_read_b128 v[48:51], v5 offset:0
  v_mfma_f32_16x16x32_bf16 v[180:183], v[124:127], v[88:91], v[180:183]
  v_mfma_f32_16x16x32_bf16 v[180:183], v[120:123], v[72:75], v[180:183]
  ds_read_b128 v[36:39], v4 offset:2048
  v_mfma_f32_16x16x32_bf16 v[172:175], v[120:123], v[68:71], v[172:175]
  ds_read_b128 v[52:55], v5 offset:2048
  v_mfma_f32_16x16x32_bf16 v[172:175], v[124:127], v[84:87], v[172:175]
  v_mfma_f32_16x16x32_bf16 v[164:167], v[124:127], v[80:83], v[164:167]
  ds_read_b128 v[40:43], v4 offset:4096
  v_mfma_f32_16x16x32_bf16 v[164:167], v[120:123], v[64:67], v[164:167]
  ds_read_b128 v[56:59], v5 offset:4096
  v_mfma_f32_16x16x32_bf16 v[192:195], v[64:67], v[224:227], v[192:195]
  ds_read_b64_tr_b16 v[96:97], v6 offset:0
  v_mfma_f32_16x16x32_bf16 v[192:195], v[80:83], v[228:231], v[192:195]
  ds_read_b64_tr_b16 v[98:99], v6 offset:2048
  v_mfma_f32_16x16x32_bf16 v[200:203], v[84:87], v[228:231], v[200:203]
  ds_read_b64_tr_b16 v[100:101], v6 offset:4096
  v_mfma_f32_16x16x32_bf16 v[200:203], v[68:71], v[224:227], v[200:203]
  ds_read_b64_tr_b16 v[102:103], v6 offset:6144
  v_mfma_f32_16x16x32_bf16 v[208:211], v[72:75], v[224:227], v[208:211]
  ds_read_b128 v[44:47], v4 offset:6144
  v_mfma_f32_16x16x32_bf16 v[208:211], v[88:91], v[228:231], v[208:211]
  v_mfma_f32_16x16x32_bf16 v[216:219], v[92:95], v[228:231], v[216:219]
  ds_read_b128 v[60:63], v5 offset:6144
  v_mfma_f32_16x16x32_bf16 v[216:219], v[76:79], v[224:227], v[216:219]
  v_mfma_f32_16x16x32_bf16 v[220:223], v[76:79], v[232:235], v[220:223]
  ds_read_b64_tr_b16 v[104:105], v7 offset:0
  v_mfma_f32_16x16x32_bf16 v[220:223], v[92:95], v[236:239], v[220:223]
  v_mfma_f32_16x16x32_bf16 v[212:215], v[88:91], v[236:239], v[212:215]
  ds_read_b64_tr_b16 v[106:107], v7 offset:2048
  v_mfma_f32_16x16x32_bf16 v[212:215], v[72:75], v[232:235], v[212:215]
  v_mfma_f32_16x16x32_bf16 v[204:207], v[68:71], v[232:235], v[204:207]
  ds_read_b64_tr_b16 v[108:109], v7 offset:4096
  v_mfma_f32_16x16x32_bf16 v[204:207], v[84:87], v[236:239], v[204:207]
  v_mfma_f32_16x16x32_bf16 v[196:199], v[80:83], v[236:239], v[196:199]
  ds_read_b64_tr_b16 v[110:111], v7 offset:6144
  s_waitcnt lgkmcnt(6)
  v_mfma_f32_16x16x32_bf16 v[196:199], v[64:67], v[232:235], v[196:199]
  s_branch Lk_2
Lk_4:
  ds_read2_b32 v[4:5], v3 offset0:48 offset1:208
  ds_read_b128 v[106:109], v8 offset:256
  v_mfma_f32_16x16x32_bf16 v[188:191], v[124:127], v[92:95], v[188:191]
  ds_read_b128 v[110:113], v8 offset:320
  ds_read_b128 v[32:35], v10 offset:192
  v_mfma_f32_16x16x32_bf16 v[216:219], v[92:95], v[228:231], v[216:219]
  ds_read_b128 v[36:39], v10 offset:832
  ds_read2_b32 v[114:115], v2 offset0:128 offset1:144
  v_mfma_f32_16x16x32_bf16 v[216:219], v[76:79], v[224:227], v[216:219]
  ds_read_b128 v[98:101], v8 offset:0
  ds_read_b128 v[102:105], v8 offset:64
  v_mfma_f32_16x16x32_bf16 v[220:223], v[76:79], v[232:235], v[220:223]
  ds_read2_b32 v[6:7], v3 offset0:32 offset1:192
  ds_read2_b32 v[96:97], v3 offset0:16 offset1:176
  v_mfma_f32_16x16x32_bf16 v[220:223], v[92:95], v[236:239], v[220:223]
  v_mfma_f32_16x16x32_bf16 v[180:183], v[124:127], v[88:91], v[180:183]
  v_mfma_f32_16x16x32_bf16 v[180:183], v[120:123], v[72:75], v[180:183]
  v_mfma_f32_16x16x32_bf16 v[172:175], v[120:123], v[68:71], v[172:175]
  s_nop 0
  s_waitcnt lgkmcnt(4)
  v_fma_f32 v184, -v106, v5, v184
  v_fma_f32 v185, -v107, v5, v185
  v_fma_f32 v186, -v108, v5, v186
  v_mfma_f32_16x16x32_bf16 v[172:175], v[124:127], v[84:87], v[172:175]
  v_fma_f32 v187, -v109, v5, v187
  v_mul_f32 v184, v184, v4
  v_mul_f32 v185, v185, v4
  v_mfma_f32_16x16x32_bf16 v[164:167], v[124:127], v[80:83], v[164:167]
  v_mul_f32 v186, v186, v4
  v_mul_f32 v187, v187, v4
  v_cvt_pk_bf16_f32 v60, v184, v185
  v_mfma_f32_16x16x32_bf16 v[164:167], v[120:123], v[64:67], v[164:167]
  v_cvt_pk_bf16_f32 v61, v186, v187
  v_fma_f32 v188, -v110, v5, v188
  v_fma_f32 v189, -v111, v5, v189
  v_mfma_f32_16x16x32_bf16 v[192:195], v[64:67], v[224:227], v[192:195]
  ds_read2_b32 v[124:125], v3 offset0:0 offset1:160
  v_fma_f32 v190, -v112, v5, v190
  v_fma_f32 v191, -v113, v5, v191
  v_mul_f32_e64 v188, v188, v4
  v_mfma_f32_16x16x32_bf16 v[192:195], v[80:83], v[228:231], v[192:195]
  v_mov_b32 v120, 0x3f803f80
  v_mul_f32 v189, v189, v4
  v_mul_f32 v190, v190, v4
  v_mul_f32_e64 v191, v191, v4
  v_mfma_f32_16x16x32_bf16 v[196:199], v[80:83], v[236:239], v[196:199]
  v_mov_b32 v121, 0x3f803f80
  v_cvt_pk_bf16_f32 v62, v188, v189
  v_cvt_pk_bf16_f32 v63, v190, v191
  v_mfma_f32_16x16x32_bf16 v[196:199], v[64:67], v[232:235], v[196:199]
  v_mov_b32 v122, 0x3f803f80
  s_mov_b32 exec_lo, s12
  s_mov_b32 exec_hi, s12
  buffer_store_dwordx4 v[60:63], v9, s[40:43], s9 offen sc0 sc1
  s_nop 0
  s_mov_b64 exec, -1
  v_fma_f32 v216, -v36, v114, v216
  v_fma_f32 v217, -v37, v114, v217
  v_fma_f32 v218, -v38, v114, v218
  v_mfma_f32_16x16x32_bf16 v[204:207], v[68:71], v[232:235], v[204:207]
  v_mov_b32 v123, 0x3f803f80
  v_fma_f32 v219, -v39, v114, v219
  v_mul_f32 v216, v216, v32
  v_mul_f32 v217, v217, v33
  v_mfma_f32_16x16x32_bf16 v[204:207], v[84:87], v[236:239], v[204:207]
  v_mul_f32 v218, v218, v34
  v_mul_f32 v219, v219, v35
  v_cvt_pk_bf16_f32 v76, v216, v217
  v_mfma_f32_16x16x32_bf16 v[200:203], v[84:87], v[228:231], v[200:203]
  v_cvt_pk_bf16_f32 v77, v218, v219
  v_fma_f32 v220, -v36, v115, v220
  v_fma_f32 v221, -v37, v115, v221
  v_mfma_f32_16x16x32_bf16 v[200:203], v[68:71], v[224:227], v[200:203]
  v_fma_f32 v222, -v38, v115, v222
  v_fma_f32 v223, -v39, v115, v223
  v_mul_f32_e64 v220, v220, v32
  v_mfma_f32_16x16x32_bf16 v[208:211], v[72:75], v[224:227], v[208:211]
  v_mul_f32 v221, v221, v33
  v_mul_f32 v222, v222, v34
  v_mul_f32_e64 v223, v223, v35
  v_mfma_f32_16x16x32_bf16 v[208:211], v[88:91], v[228:231], v[208:211]
  v_cvt_pk_bf16_f32 v78, v220, v221
  v_cvt_pk_bf16_f32 v79, v222, v223
  v_mfma_f32_16x16x32_bf16 v[212:215], v[88:91], v[236:239], v[212:215]
  s_mov_b32 exec_lo, 0
  buffer_store_dwordx4 v[76:79], v11, s[40:43], s9 offen sc0 sc1
  s_mov_b64 exec, -1
  v_mfma_f32_16x16x32_bf16 v[212:215], v[72:75], v[232:235], v[212:215]
  v_mov_b64_e64 v[86:87], v[78:79]
  s_cmp_lg_u32 s82, 0
  s_cbranch_scc1 L_9
  ds_read_b128 v[240:243], v255 offset:16384
  ds_read_b128 v[244:247], v255 offset:18432
  ds_read_b128 v[248:251], v255 offset:20480
  ds_read_b128 v[252:255], v255 offset:22528
L_9:
  v_mov_b64 v[64:65], 0
  v_mov_b64 v[66:67], 0
  v_mov_b64_e64 v[232:233], 0
  v_mov_b64 v[234:235], 0
  s_waitcnt lgkmcnt(0)
  v_pk_fma_f32 v[128:129], v[98:99], v[124:125], v[128:129] op_sel:[0,1,0] op_sel_hi:[1,1,1] neg_lo:[1,0,0] neg_hi:[1,0,0]
  v_pk_fma_f32 v[130:131], v[100:101], v[124:125], v[130:131] op_sel:[0,1,0] op_sel_hi:[1,1,1] neg_lo:[1,0,0] neg_hi:[1,0,0]
  v_pk_fma_f32 v[132:133], v[102:103], v[124:125], v[132:133] op_sel:[0,1,0] op_sel_hi:[1,1,1] neg_lo:[1,0,0] neg_hi:[1,0,0]
  v_pk_fma_f32 v[134:135], v[104:105], v[124:125], v[134:135] op_sel:[0,1,0] op_sel_hi:[1,1,1] neg_lo:[1,0,0] neg_hi:[1,0,0]
  v_cvt_pk_bf16_f32 v32, v128, v129
  v_cvt_pk_bf16_f32 v33, v130, v131
  v_cvt_pk_bf16_f32 v34, v132, v133
  v_cvt_pk_bf16_f32 v35, v134, v135
  v_pk_fma_f32 v[136:137], v[98:99], v[96:97], v[136:137] op_sel:[0,1,0] op_sel_hi:[1,1,1] neg_lo:[1,0,0] neg_hi:[1,0,0]
  v_pk_fma_f32 v[138:139], v[100:101], v[96:97], v[138:139] op_sel:[0,1,0] op_sel_hi:[1,1,1] neg_lo:[1,0,0] neg_hi:[1,0,0]
  v_pk_fma_f32 v[140:141], v[102:103], v[96:97], v[140:141] op_sel:[0,1,0] op_sel_hi:[1,1,1] neg_lo:[1,0,0] neg_hi:[1,0,0]
  v_pk_fma_f32 v[142:143], v[104:105], v[96:97], v[142:143] op_sel:[0,1,0] op_sel_hi:[1,1,1] neg_lo:[1,0,0] neg_hi:[1,0,0]
  v_cvt_pk_bf16_f32 v36, v136, v137
  v_cvt_pk_bf16_f32 v37, v138, v139
  v_cvt_pk_bf16_f32 v38, v140, v141
  v_cvt_pk_bf16_f32 v39, v142, v143
  v_pk_fma_f32 v[144:145], v[98:99], v[6:7], v[144:145] op_sel:[0,1,0] op_sel_hi:[1,1,1] neg_lo:[1,0,0] neg_hi:[1,0,0]
  v_pk_fma_f32 v[146:147], v[100:101], v[6:7], v[146:147] op_sel:[0,1,0] op_sel_hi:[1,1,1] neg_lo:[1,0,0] neg_hi:[1,0,0]
  v_pk_fma_f32 v[148:149], v[102:103], v[6:7], v[148:149] op_sel:[0,1,0] op_sel_hi:[1,1,1] neg_lo:[1,0,0] neg_hi:[1,0,0]
  v_pk_fma_f32 v[150:151], v[104:105], v[6:7], v[150:151] op_sel:[0,1,0] op_sel_hi:[1,1,1] neg_lo:[1,0,0] neg_hi:[1,0,0]
  v_cvt_pk_bf16_f32 v40, v144, v145
  v_cvt_pk_bf16_f32 v41, v146, v147
  v_cvt_pk_bf16_f32 v42, v148, v149
  v_cvt_pk_bf16_f32 v43, v150, v151
  v_pk_fma_f32 v[152:153], v[98:99], v[4:5], v[152:153] op_sel:[0,1,0] op_sel_hi:[1,1,1] neg_lo:[1,0,0] neg_hi:[1,0,0]
  v_pk_fma_f32 v[154:155], v[100:101], v[4:5], v[154:155] op_sel:[0,1,0] op_sel_hi:[1,1,1] neg_lo:[1,0,0] neg_hi:[1,0,0]
  v_pk_fma_f32 v[156:157], v[102:103], v[4:5], v[156:157] op_sel:[0,1,0] op_sel_hi:[1,1,1] neg_lo:[1,0,0] neg_hi:[1,0,0]
  v_pk_fma_f32 v[158:159], v[104:105], v[4:5], v[158:159] op_sel:[0,1,0] op_sel_hi:[1,1,1] neg_lo:[1,0,0] neg_hi:[1,0,0]
  v_cvt_pk_bf16_f32 v44, v152, v153
  v_cvt_pk_bf16_f32 v45, v154, v155
  v_cvt_pk_bf16_f32 v46, v156, v157
  v_cvt_pk_bf16_f32 v47, v158, v159
  ds_read_b128 v[128:131], v10 offset:0
  ds_read_b128 v[132:135], v10 offset:640
  ds_read_b128 v[136:139], v10 offset:64
  ds_read_b128 v[140:143], v10 offset:704
  ds_read_b128 v[144:147], v10 offset:128
  ds_read_b128 v[148:151], v10 offset:768
  v_pk_fma_f32 v[160:161], v[106:107], v[124:125], v[160:161] op_sel:[0,1,0] op_sel_hi:[1,1,1] neg_lo:[1,0,0] neg_hi:[1,0,0]
  v_pk_fma_f32 v[162:163], v[108:109], v[124:125], v[162:163] op_sel:[0,1,0] op_sel_hi:[1,1,1] neg_lo:[1,0,0] neg_hi:[1,0,0]
  v_pk_fma_f32 v[164:165], v[110:111], v[124:125], v[164:165] op_sel:[0,1,0] op_sel_hi:[1,1,1] neg_lo:[1,0,0] neg_hi:[1,0,0]
  v_pk_fma_f32 v[166:167], v[112:113], v[124:125], v[166:167] op_sel:[0,1,0] op_sel_hi:[1,1,1] neg_lo:[1,0,0] neg_hi:[1,0,0]
  v_pk_mul_f32 v[160:161], v[160:161], v[124:125] op_sel_hi:[1,0]
  v_pk_mul_f32 v[162:163], v[162:163], v[124:125] op_sel_hi:[1,0]
  v_pk_mul_f32 v[164:165], v[164:165], v[124:125] op_sel_hi:[1,0]
  v_pk_mul_f32 v[166:167], v[166:167], v[124:125] op_sel_hi:[1,0]
  v_cvt_pk_bf16_f32 v48, v160, v161
  v_cvt_pk_bf16_f32 v49, v162, v163
  v_cvt_pk_bf16_f32 v50, v164, v165
  v_cvt_pk_bf16_f32 v51, v166, v167
  v_pk_fma_f32 v[168:169], v[106:107], v[96:97], v[168:169] op_sel:[0,1,0] op_sel_hi:[1,1,1] neg_lo:[1,0,0] neg_hi:[1,0,0]
  v_pk_fma_f32 v[170:171], v[108:109], v[96:97], v[170:171] op_sel:[0,1,0] op_sel_hi:[1,1,1] neg_lo:[1,0,0] neg_hi:[1,0,0]
  v_pk_fma_f32 v[172:173], v[110:111], v[96:97], v[172:173] op_sel:[0,1,0] op_sel_hi:[1,1,1] neg_lo:[1,0,0] neg_hi:[1,0,0]
  v_pk_fma_f32 v[174:175], v[112:113], v[96:97], v[174:175] op_sel:[0,1,0] op_sel_hi:[1,1,1] neg_lo:[1,0,0] neg_hi:[1,0,0]
  v_pk_mul_f32 v[168:169], v[168:169], v[96:97] op_sel_hi:[1,0]
  v_pk_mul_f32 v[170:171], v[170:171], v[96:97] op_sel_hi:[1,0]
  v_pk_mul_f32 v[172:173], v[172:173], v[96:97] op_sel_hi:[1,0]
  v_pk_mul_f32 v[174:175], v[174:175], v[96:97] op_sel_hi:[1,0]
  v_cvt_pk_bf16_f32 v52, v168, v169
  v_cvt_pk_bf16_f32 v53, v170, v171
  v_cvt_pk_bf16_f32 v54, v172, v173
  v_cvt_pk_bf16_f32 v55, v174, v175
  v_pk_fma_f32 v[176:177], v[106:107], v[6:7], v[176:177] op_sel:[0,1,0] op_sel_hi:[1,1,1] neg_lo:[1,0,0] neg_hi:[1,0,0]
  v_pk_fma_f32 v[178:179], v[108:109], v[6:7], v[178:179] op_sel:[0,1,0] op_sel_hi:[1,1,1] neg_lo:[1,0,0] neg_hi:[1,0,0]
  v_pk_fma_f32 v[180:181], v[110:111], v[6:7], v[180:181] op_sel:[0,1,0] op_sel_hi:[1,1,1] neg_lo:[1,0,0] neg_hi:[1,0,0]
  v_pk_fma_f32 v[182:183], v[112:113], v[6:7], v[182:183] op_sel:[0,1,0] op_sel_hi:[1,1,1] neg_lo:[1,0,0] neg_hi:[1,0,0]
  v_pk_mul_f32 v[176:177], v[176:177], v[6:7] op_sel_hi:[1,0]
  v_pk_mul_f32 v[178:179], v[178:179], v[6:7] op_sel_hi:[1,0]
  v_pk_mul_f32 v[180:181], v[180:181], v[6:7] op_sel_hi:[1,0]
  v_pk_mul_f32 v[182:183], v[182:183], v[6:7] op_sel_hi:[1,0]
  v_cvt_pk_bf16_f32 v56, v176, v177
  v_cvt_pk_bf16_f32 v57, v178, v179
  v_cvt_pk_bf16_f32 v58, v180, v181
  v_cvt_pk_bf16_f32 v59, v182, v183
  v_mfma_f32_16x16x32_bf16 v[164:167], v[48:51], v[32:35], v[12:15]
  v_mfma_f32_16x16x32_bf16 v[168:171], v[48:51], v[36:39], v[16:19]
  v_mfma_f32_16x16x32_bf16 v[172:175], v[52:55], v[36:39], v[12:15]
  v_mfma_f32_16x16x32_bf16 v[176:179], v[52:55], v[40:43], v[16:19]
  v_mfma_f32_16x16x32_bf16 v[180:183], v[56:59], v[40:43], v[12:15]
  v_mfma_f32_16x16x32_bf16 v[184:187], v[56:59], v[44:47], v[16:19]
  v_mfma_f32_16x16x32_bf16 v[188:191], v[60:63], v[44:47], v[12:15]
  s_nop 0
  s_waitcnt lgkmcnt(0)
  v_pk_fma_f32 v[192:193], v[132:133], v[114:115], v[192:193] op_sel:[0,0,0] op_sel_hi:[1,0,1] neg_lo:[1,0,0] neg_hi:[1,0,0]
  v_pk_fma_f32 v[194:195], v[134:135], v[114:115], v[194:195] op_sel:[0,0,0] op_sel_hi:[1,0,1] neg_lo:[1,0,0] neg_hi:[1,0,0]
  v_pk_fma_f32 v[196:197], v[132:133], v[114:115], v[196:197] op_sel:[0,1,0] op_sel_hi:[1,1,1] neg_lo:[1,0,0] neg_hi:[1,0,0]
  v_pk_fma_f32 v[198:199], v[134:135], v[114:115], v[198:199] op_sel:[0,1,0] op_sel_hi:[1,1,1] neg_lo:[1,0,0] neg_hi:[1,0,0]
  v_pk_mul_f32 v[192:193], v[192:193], v[128:129]
  v_pk_mul_f32 v[194:195], v[194:195], v[130:131]
  v_pk_mul_f32 v[196:197], v[196:197], v[128:129]
  v_pk_mul_f32 v[198:199], v[198:199], v[130:131]
  v_cvt_pk_bf16_f32 v70, v192, v193
  v_cvt_pk_bf16_f32 v71, v194, v195
  v_cvt_pk_bf16_f32 v80, v196, v197
  v_cvt_pk_bf16_f32 v81, v198, v199
  v_pk_fma_f32 v[200:201], v[140:141], v[114:115], v[200:201] op_sel:[0,0,0] op_sel_hi:[1,0,1] neg_lo:[1,0,0] neg_hi:[1,0,0]
  v_pk_fma_f32 v[202:203], v[142:143], v[114:115], v[202:203] op_sel:[0,0,0] op_sel_hi:[1,0,1] neg_lo:[1,0,0] neg_hi:[1,0,0]
  v_pk_fma_f32 v[204:205], v[140:141], v[114:115], v[204:205] op_sel:[0,1,0] op_sel_hi:[1,1,1] neg_lo:[1,0,0] neg_hi:[1,0,0]
  v_pk_fma_f32 v[206:207], v[142:143], v[114:115], v[206:207] op_sel:[0,1,0] op_sel_hi:[1,1,1] neg_lo:[1,0,0] neg_hi:[1,0,0]
  v_pk_mul_f32 v[200:201], v[200:201], v[136:137]
  v_pk_mul_f32 v[202:203], v[202:203], v[138:139]
  v_pk_mul_f32 v[204:205], v[204:205], v[136:137]
  v_pk_mul_f32 v[206:207], v[206:207], v[138:139]
  v_cvt_pk_bf16_f32 v72, v200, v201
  v_cvt_pk_bf16_f32 v73, v202, v203
  v_cvt_pk_bf16_f32 v82, v204, v205
  v_cvt_pk_bf16_f32 v83, v206, v207
  v_pk_fma_f32 v[208:209], v[148:149], v[114:115], v[208:209] op_sel:[0,0,0] op_sel_hi:[1,0,1] neg_lo:[1,0,0] neg_hi:[1,0,0]
  v_pk_fma_f32 v[210:211], v[150:151], v[114:115], v[210:211] op_sel:[0,0,0] op_sel_hi:[1,0,1] neg_lo:[1,0,0] neg_hi:[1,0,0]
  v_pk_fma_f32 v[212:213], v[148:149], v[114:115], v[212:213] op_sel:[0,1,0] op_sel_hi:[1,1,1] neg_lo:[1,0,0] neg_hi:[1,0,0]
  v_pk_fma_f32 v[214:215], v[150:151], v[114:115], v[214:215] op_sel:[0,1,0] op_sel_hi:[1,1,1] neg_lo:[1,0,0] neg_hi:[1,0,0]
  v_pk_mul_f32 v[208:209], v[208:209], v[144:145]
  v_pk_mul_f32 v[210:211], v[210:211], v[146:147]
  v_pk_mul_f32 v[212:213], v[212:213], v[144:145]
  v_pk_mul_f32 v[214:215], v[214:215], v[146:147]
  v_cvt_pk_bf16_f32 v74, v208, v209
  v_cvt_pk_bf16_f32 v75, v210, v211
  v_cvt_pk_bf16_f32 v84, v212, v213
  v_cvt_pk_bf16_f32 v85, v214, v215
  v_max_f32 v172, v172, v168
  v_max_f32 v173, v173, v169
  v_max_f32 v174, v174, v170
  v_max_f32 v175, v175, v171
  v_max_f32 v180, v180, v176
  v_max_f32 v181, v181, v177
  v_max_f32 v182, v182, v178
  v_max_f32 v183, v183, v179
  v_max_f32 v188, v188, v184
  v_max_f32 v189, v189, v185
  v_max_f32 v190, v190, v186
  v_max_f32 v191, v191, v187
  v_max3_f32 v90, v172, v173, v174
  v_max3_f32 v92, v180, v181, v182
  v_max3_f32 v94, v188, v189, v190
  v_max_f32 v90, v90, v175
  v_max_f32 v92, v92, v183
  v_max_f32 v94, v94, v191
  v_mov_b32 v99, v90
  v_mov_b32 v100, v92
  v_mov_b32 v101, v94
  v_permlane32_swap_b32 v90, v99
  v_permlane32_swap_b32 v92, v100
  v_permlane32_swap_b32 v94, v101
  v_max_f32 v90, v90, v99
  v_max_f32 v92, v92, v100
  v_max_f32 v94, v94, v101
  v_mov_b32 v99, v90
  v_mov_b32 v100, v92
  v_mov_b32 v101, v94
  v_permlane16_swap_b32 v90, v99
  v_permlane16_swap_b32 v92, v100
  v_permlane16_swap_b32 v94, v101
  v_max_f32 v90, v90, v99
  v_max_f32 v92, v92, v100
  v_max_f32_e64 v94, v94, v101
  s_mov_b32 s4, 0x3e8293ee
  v_mul_f32 v91, s4, v96
  v_mul_f32 v90, v91, v90
  v_mul_f32 v93, s4, v6
  v_mul_f32 v92, v93, v92
  v_mul_f32 v95, s4, v4
  v_mul_f32 v94, v95, v94
  v_pk_fma_f32 v[172:173], v[172:173], v[90:91], v[90:91] op_sel:[0,1,0] op_sel_hi:[1,1,0] neg_lo:[0,0,1] neg_hi:[0,0,1]
  v_pk_fma_f32 v[174:175], v[174:175], v[90:91], v[90:91] op_sel:[0,1,0] op_sel_hi:[1,1,0] neg_lo:[0,0,1] neg_hi:[0,0,1]
  v_pk_fma_f32 v[180:181], v[180:181], v[92:93], v[92:93] op_sel:[0,1,0] op_sel_hi:[1,1,0] neg_lo:[0,0,1] neg_hi:[0,0,1]
  v_pk_fma_f32 v[182:183], v[182:183], v[92:93], v[92:93] op_sel:[0,1,0] op_sel_hi:[1,1,0] neg_lo:[0,0,1] neg_hi:[0,0,1]
  v_pk_fma_f32 v[188:189], v[188:189], v[94:95], v[94:95] op_sel:[0,1,0] op_sel_hi:[1,1,0] neg_lo:[0,0,1] neg_hi:[0,0,1]
  v_pk_fma_f32 v[190:191], v[190:191], v[94:95], v[94:95] op_sel:[0,1,0] op_sel_hi:[1,1,0] neg_lo:[0,0,1] neg_hi:[0,0,1]
  s_lshl_b32 s6, s84, Lz1-Lz0+3
  s_add_u32 s6, s6, 3145728
  s_add_u32 s7, s6, 4096
  s_mov_b32 exec_lo, s12
  s_mov_b32 exec_hi, s12
  buffer_load_dwordx4 v[64:67], v9, s[40:43], s11 offen sc0 sc1
  s_mov_b32 exec_lo, 0
  s_mov_b32 exec_hi, -1
  buffer_load_dwordx4 v[232:235], v11, s[40:43], s11 offen sc0 sc1
  s_mov_b64 exec, -1
  v_exp_f32 v172, v172
  v_exp_f32 v173, v173
  v_exp_f32 v174, v174
  v_exp_f32_e64 v175, v175
  v_cvt_pk_bf16_f32 v38, v172, v173
  v_cvt_pk_bf16_f32 v39, v174, v175
  v_and_b32 v36, v38, v20
  v_and_b32 v37, v39, v21
  v_xor_b32 v38, v38, v36
  v_xor_b32 v39, v39, v37
  v_exp_f32 v180, v180
  v_exp_f32 v181, v181
  v_exp_f32 v182, v182
  v_exp_f32 v183, v183
  v_cvt_pk_bf16_f32 v42, v180, v181
  v_cvt_pk_bf16_f32 v43, v182, v183
  v_and_b32 v40, v42, v20
  v_and_b32 v41, v43, v21
  v_xor_b32 v42, v42, v40
  v_xor_b32 v43, v43, v41
  v_mfma_f32_16x16x32_bf16 v[132:135], v[120:123], v[36:39], 0
  v_mfma_f32_16x16x32_bf16 v[200:203], v[70:73], v[36:39], 0
  v_mfma_f32_16x16x32_bf16 v[204:207], v[80:83], v[36:39], 0
  v_exp_f32 v188, v188
  v_exp_f32 v189, v189
  v_exp_f32 v190, v190
  v_exp_f32 v191, v191
  v_cvt_pk_bf16_f32 v46, v188, v189
  v_cvt_pk_bf16_f32 v47, v190, v191
  v_and_b32 v44, v46, v20
  v_and_b32 v45, v47, v21
  v_xor_b32 v46, v46, v44
  v_xor_b32 v47, v47, v45
  v_mfma_f32_16x16x32_bf16 v[136:139], v[120:123], v[40:43], 0
  v_mfma_f32_16x16x32_bf16 v[208:211], v[72:75], v[40:43], 0
  v_mfma_f32_16x16x32_bf16 v[212:215], v[82:85], v[40:43], 0
  v_mfma_f32_16x16x32_bf16 v[140:143], v[120:123], v[44:47], 0
  v_mfma_f32_16x16x32_bf16 v[216:219], v[74:77], v[44:47], 0
  v_mfma_f32_16x16x32_bf16 v[220:223], v[84:87], v[44:47], 0
  v_rcp_f32 v132, v132
  s_nop 0
  v_pk_mul_f32 v[200:201], v[200:201], v[132:133] op_sel_hi:[1,0]
  v_pk_mul_f32 v[202:203], v[202:203], v[132:133] op_sel_hi:[1,0]
  v_pk_mul_f32 v[204:205], v[204:205], v[132:133] op_sel_hi:[1,0]
  v_pk_mul_f32 v[206:207], v[206:207], v[132:133] op_sel_hi:[1,0]
  v_cvt_pk_bf16_f32 v52, v200, v201
  v_cvt_pk_bf16_f32 v53, v202, v203
  v_cvt_pk_bf16_f32 v54, v204, v205
  v_cvt_pk_bf16_f32 v55, v206, v207
  buffer_store_dwordx4 v[52:55], v0, s[40:43], s6 offen offset:2048 sc0 sc1
  ds_write_b128 v0, v[52:55] offset:2048
  v_rcp_f32 v136, v136
  s_nop 0
  v_pk_mul_f32 v[208:209], v[208:209], v[136:137] op_sel_hi:[1,0]
  v_pk_mul_f32 v[210:211], v[210:211], v[136:137] op_sel_hi:[1,0]
  v_pk_mul_f32 v[212:213], v[212:213], v[136:137] op_sel_hi:[1,0]
  v_pk_mul_f32 v[214:215], v[214:215], v[136:137] op_sel_hi:[1,0]
  v_cvt_pk_bf16_f32 v56, v208, v209
  v_cvt_pk_bf16_f32 v57, v210, v211
  v_cvt_pk_bf16_f32 v58, v212, v213
  v_cvt_pk_bf16_f32 v59, v214, v215
  buffer_store_dwordx4 v[56:59], v0, s[40:43], s7 offen offset:0 sc0 sc1
  ds_write_b128 v0, v[56:59] offset:4096
  v_rcp_f32 v140, v140
  s_nop 0
  v_pk_mul_f32 v[216:217], v[216:217], v[140:141] op_sel_hi:[1,0]
  v_pk_mul_f32 v[218:219], v[218:219], v[140:141] op_sel_hi:[1,0]
  v_pk_mul_f32 v[220:221], v[220:221], v[140:141] op_sel_hi:[1,0]
  v_pk_mul_f32 v[222:223], v[222:223], v[140:141] op_sel_hi:[1,0]
  v_cvt_pk_bf16_f32 v60, v216, v217
  v_cvt_pk_bf16_f32 v61, v218, v219
  v_cvt_pk_bf16_f32 v62, v220, v221
  v_cvt_pk_bf16_f32 v63, v222, v223
  buffer_store_dwordx4 v[60:63], v0, s[40:43], s7 offen offset:2048 sc0 sc1
  ds_write_b128 v0, v[60:63] offset:6144
  s_cmp_eq_u32 s76, Lz1-Lz0+0
  s_mov_b32 s89, 200000
  s_waitcnt vmcnt(3)
  s_cbranch_scc0 Lh_11
  v_mov_b64 v[64:65], 0
  v_mov_b64 v[66:67], 0
  v_mov_b64 v[232:233], 0
  v_mov_b64 v[234:235], 0
  s_branch Lh_12
  s_nop 0
Lh_10:
  s_mov_b32 exec_lo, s12
  s_mov_b32 exec_hi, s12
  buffer_load_dwordx4 v[64:67], v9, s[40:43], s11 offen sc0 sc1
  s_mov_b32 exec_lo, 0
  s_mov_b32 exec_hi, -1
  buffer_load_dwordx4 v[232:235], v11, s[40:43], s11 offen sc0 sc1
  s_mov_b64 exec, -1
  s_waitcnt vmcnt(0)
Lh_11:
  v_max3_u32 v2, v64, v65, v66
  v_max3_u32 v3, v232, v233, v234
  v_max3_u32 v2, v2, v67, v235
  v_max_u32_e64 v2, v2, v3
  v_cmp_eq_u32 vcc, -1, v2
  s_cbranch_vccz Lh_12
  s_sub_u32 s89, s89, 1
  s_cbranch_scc0 Lh_10
Lh_12:
  v_mfma_f32_16x16x32_bf16 v[160:163], v[64:67], v[32:35], v[16:19]
  v_mov_b64 v[68:69], v[232:233]
  v_mov_b64 v[78:79], v[234:235]
  v_mov_b64 v[236:237], -1
  v_mov_b64 v[238:239], -1
  buffer_store_dwordx4 v[236:239], v11, s[40:43], s11 offen sc0 sc1
  s_cmp_eq_u32 s76, 0
  s_cbranch_scc1 L_14
  s_nop 0
  v_max_f32 v164, v164, v160
  v_max_f32 v165, v165, v161
  v_max_f32 v166, v166, v162
  v_max_f32_e64 v167, v167, v163
L_14:
  v_max3_f32 v88, v164, v165, v166
  v_max_f32 v88, v88, v167
  v_mov_b32 v98, v88
  s_nop 1
  v_permlane32_swap_b32 v88, v98
  v_max_f32 v88, v88, v98
  v_mov_b32 v98, v88
  s_nop 1
  v_permlane16_swap_b32 v88, v98
  v_max_f32_e64 v88, v88, v98
  s_mov_b32 s4, 0x3e8293ee
  v_mul_f32 v89, s4, v124
  v_mul_f32 v88, v89, v88
  v_pk_fma_f32 v[164:165], v[164:165], v[88:89], v[88:89] op_sel:[0,1,0] op_sel_hi:[1,1,0] neg_lo:[0,0,1] neg_hi:[0,0,1]
  v_pk_fma_f32 v[166:167], v[166:167], v[88:89], v[88:89] op_sel:[0,1,0] op_sel_hi:[1,1,0] neg_lo:[0,0,1] neg_hi:[0,0,1]
  v_exp_f32 v164, v164
  v_exp_f32 v165, v165
  v_exp_f32 v166, v166
  v_exp_f32 v167, v167
  v_cvt_pk_bf16_f32 v34, v164, v165
  v_cvt_pk_bf16_f32 v35, v166, v167
  v_and_b32 v32, v34, v20
  v_and_b32 v33, v35, v21
  v_xor_b32_e64 v34, v34, v32
  v_xor_b32 v35, v35, v33
  s_nop 1
  v_mfma_f32_16x16x32_bf16 v[128:131], v[120:123], v[32:35], 0
  v_mfma_f32_16x16x32_bf16 v[192:195], v[68:71], v[32:35], 0
  v_mfma_f32_16x16x32_bf16 v[196:199], v[78:81], v[32:35], 0
  s_nop 5
  v_rcp_f32_e64 v128, v128
  s_nop 0
  v_pk_mul_f32 v[192:193], v[192:193], v[128:129] op_sel_hi:[1,0]
  v_pk_mul_f32 v[194:195], v[194:195], v[128:129] op_sel_hi:[1,0]
  v_pk_mul_f32 v[196:197], v[196:197], v[128:129] op_sel_hi:[1,0]
  v_pk_mul_f32 v[198:199], v[198:199], v[128:129] op_sel_hi:[1,0]
  v_cvt_pk_bf16_f32 v48, v192, v193
  v_cvt_pk_bf16_f32 v49, v194, v195
  v_cvt_pk_bf16_f32 v50, v196, v197
  v_cvt_pk_bf16_f32 v51, v198, v199
  buffer_store_dwordx4 v[48:51], v0, s[40:43], s6 offen offset:0 sc0 sc1
  ds_write_b128 v0, v[48:51] offset:0
  ds_read_b32 v3, v28 offset:8
  s_cmp_lg_u32 s82, 0
  s_cbranch_scc1 L_15
  v_permlane16_swap_b32 v240, v242
  v_permlane16_swap_b32 v241, v243
  v_permlane16_swap_b32 v244, v246
  v_permlane16_swap_b32 v245, v247
  v_permlane16_swap_b32 v248, v250
  v_permlane16_swap_b32 v249, v251
  v_permlane16_swap_b32 v252, v254
  v_permlane16_swap_b32 v253, v255
L_15:
  s_mov_b32 s16, Lz1-Lz0+0
  s_mov_b32 s17, 16384
  s_mov_b32 s18, 0xffff4000
  s_mov_b32 s19, 32768
  s_mov_b32 s20, 8192
  s_mov_b32 s21, 0xfffee000
  s_mul_i32 s4, s85, 8192
  v_add_u32_e64 v4, s4, v11
  v_add_u32 v5, 1024, v4
  s_add_u32 s5, s19, 0
  s_lshl_b32 s4, s86, 1
  v_xor_b32_e64 v2, s4, v26
  v_lshl_add_u32 v6, v2, 5, v25
  v_add_u32 v6, s5, v6
  s_add_u32 s4, s4, 1
  v_xor_b32_e64 v2, s4, v26
  v_lshl_add_u32 v7, v2, 5, v25
  v_add_u32 v7, s5, v7
  s_lshl_b32 s5, s82, 1
  s_add_u32 s5, s5, Lz1-Lz0+2
  s_mov_b32 s89, 1600000
  s_branch Lw_17
Lw_16:
  ds_read_b32 v3, v28 offset:8
Lw_17:
  s_waitcnt lgkmcnt(0)
  v_readfirstlane_b32 s4, v3
  s_cmp_ge_u32 s4, s5
  s_cbranch_scc1 Lw_18
  s_sleep 1
  s_sub_u32 s89, s89, 1
  s_cbranch_scc0 Lw_16
Lw_18:
  ds_read_b64_tr_b16 v[48:49], v6 offset:0
  ds_read_b64_tr_b16 v[50:51], v6 offset:2048
  ds_read_b64_tr_b16 v[52:53], v7 offset:0
  ds_read_b64_tr_b16 v[54:55], v7 offset:2048
  ds_read_b64_tr_b16 v[80:81], v6 offset:4096
  ds_read_b64_tr_b16 v[82:83], v6 offset:6144
  ds_read_b64_tr_b16 v[84:85], v7 offset:4096
  ds_read_b64_tr_b16 v[86:87], v7 offset:6144
  ds_read_b64_tr_b16 v[112:113], v6 offset:8192
  ds_read_b64_tr_b16 v[114:115], v6 offset:10240
  ds_read_b64_tr_b16 v[116:117], v7 offset:8192
  ds_read_b64_tr_b16 v[118:119], v7 offset:10240
  s_nop 0
  s_waitcnt lgkmcnt(8)
  ds_read_b64_tr_b16 v[208:209], v6 offset:12288
  ds_read_b64_tr_b16 v[210:211], v6 offset:14336
  ds_read_b64_tr_b16 v[212:213], v7 offset:12288
  ds_read_b64_tr_b16 v[214:215], v7 offset:14336
  s_nop 0
  s_waitcnt lgkmcnt(8)
  ds_read_b64_tr_b16 v[160:161], v6 offset:16384
  ds_read_b64_tr_b16 v[162:163], v6 offset:18432
  ds_read_b64_tr_b16 v[164:165], v7 offset:16384
  ds_read_b64_tr_b16 v[166:167], v7 offset:18432
  s_nop 0
  s_waitcnt lgkmcnt(8)
  ds_read_b64_tr_b16 v[168:169], v6 offset:20480
  ds_read_b64_tr_b16 v[170:171], v6 offset:22528
  ds_read_b64_tr_b16 v[172:173], v7 offset:20480
  ds_read_b64_tr_b16 v[174:175], v7 offset:22528
  s_waitcnt lgkmcnt(8)
  s_add_u32 s5, s87, 0x0
  s_waitcnt vmcnt(0)
  s_mov_b64 exec, 1
  ds_add_rtn_u32 v2, v28, v27 offset:0
  s_waitcnt lgkmcnt(0)
  v_readfirstlane_b32 s4, v2
  s_and_b32 s4, s4, Lz1-Lz0+3
  s_cmp_lg_u32 s4, 3
  s_cbranch_scc1 Ls_19
  s_mov_b32 exec_lo, 0xffff
  buffer_store_dword v27, v24, s[40:43], s5 offen sc0 sc1
Ls_19:
  s_nop 0
  s_mov_b64 exec, -1
  ds_read_b64_tr_b16 v[176:177], v6 offset:24576
  ds_read_b64_tr_b16 v[178:179], v6 offset:26624
  ds_read_b64_tr_b16 v[180:181], v7 offset:24576
  ds_read_b64_tr_b16 v[182:183], v7 offset:26624
  ds_read_b64_tr_b16 v[184:185], v6 offset:28672
  ds_read_b64_tr_b16 v[186:187], v6 offset:30720
  ds_read_b64_tr_b16 v[188:189], v7 offset:28672
  ds_read_b64_tr_b16 v[190:191], v7 offset:30720
  ds_read_b64_tr_b16 v[224:225], v6 offset:32768
  ds_read_b64_tr_b16 v[226:227], v6 offset:34816
  ds_read_b64_tr_b16 v[228:229], v7 offset:32768
  ds_read_b64_tr_b16 v[230:231], v7 offset:34816
  s_nop 0
  s_waitcnt lgkmcnt(8)
  ds_read_b64_tr_b16 v[232:233], v6 offset:36864
  ds_read_b64_tr_b16 v[234:235], v6 offset:38912
  ds_read_b64_tr_b16 v[236:237], v7 offset:36864
  ds_read_b64_tr_b16 v[238:239], v7 offset:38912
  s_nop 0
  s_waitcnt lgkmcnt(8)
  ds_read_b64_tr_b16 v[56:57], v6 offset:40960
  ds_read_b64_tr_b16 v[58:59], v6 offset:43008
  ds_read_b64_tr_b16 v[60:61], v7 offset:40960
  ds_read_b64_tr_b16 v[62:63], v7 offset:43008
  s_nop 0
  s_waitcnt lgkmcnt(8)
  ds_read_b64_tr_b16 v[88:89], v6 offset:45056
  ds_read_b64_tr_b16 v[90:91], v6 offset:47104
  ds_read_b64_tr_b16 v[92:93], v7 offset:45056
  ds_read_b64_tr_b16 v[94:95], v7 offset:47104
  s_waitcnt lgkmcnt(8)
  s_mov_b32 s19, 0
  v_add_u32 v6, 0xffff8000, v6
  v_add_u32 v7, 0xffff8000, v7
  s_waitcnt lgkmcnt(0)
  s_mov_b64 exec, 1
  ds_add_u32 v28, v27 offset:12
  s_mov_b64 exec, -1
  s_mov_b32 s4, 0xffff0000
  v_lshlrev_b32 v128, 16, v240
  v_and_b32 v129, s4, v240
  v_lshlrev_b32 v130, 16, v241
  v_and_b32 v131, s4, v241
  v_lshlrev_b32 v132, 16, v242
  v_and_b32 v133, s4, v242
  v_lshlrev_b32 v134, 16, v243
  v_and_b32 v135, s4, v243
  v_lshlrev_b32 v136, 16, v244
  v_and_b32 v137, s4, v244
  v_lshlrev_b32 v138, 16, v245
  v_and_b32 v139, s4, v245
  v_lshlrev_b32 v140, 16, v246
  v_and_b32 v141, s4, v246
  v_lshlrev_b32 v142, 16, v247
  v_and_b32 v143, s4, v247
  v_lshlrev_b32 v144, 16, v248
  v_and_b32 v145, s4, v248
  v_lshlrev_b32 v146, 16, v249
  v_and_b32 v147, s4, v249
  v_lshlrev_b32 v148, 16, v250
  v_and_b32 v149, s4, v250
  v_lshlrev_b32 v150, 16, v251
  v_and_b32 v151, s4, v251
  v_lshlrev_b32 v152, 16, v252
  v_and_b32 v153, s4, v252
  v_lshlrev_b32 v154, 16, v253
  v_and_b32 v155, s4, v253
  v_lshlrev_b32 v156, 16, v254
  v_and_b32 v157, s4, v254
  v_lshlrev_b32 v158, 16, v255
  v_and_b32 v159, s4, v255
  s_lshl_b32 s4, s76, 4
  s_add_u32 s4, s4, s78
  s_lshl_b32 s6, s4, 14
  s_add_u32 s6, s6, 7340032
  s_add_u32 s7, s6, 4096
  s_mov_b32 s22, 5
  s_barrier
  ds_read_b128 v[32:35], v4 offset:0
  ds_read_b128 v[36:39], v4 offset:2048
  ds_read_b128 v[40:43], v4 offset:4096
  ds_read_b128 v[44:47], v4 offset:6144
  ds_read_b128 v[64:67], v5 offset:0
  ds_read_b128 v[68:71], v5 offset:2048
  ds_read_b128 v[72:75], v5 offset:4096
  ds_read_b128 v[76:79], v5 offset:6144
  s_add_u32 s16, s16, s17
  s_cmp_eq_u32 s16, 65536
  s_cselect_b32 s23, s18, s17
  s_cselect_b32 s16, 0, s16
  v_add_u32 v4, s23, v4
  v_add_u32 v5, s23, v5
  s_waitcnt lgkmcnt(0)
  v_mfma_f32_16x16x32_bf16 v[128:131], v[48:51], v[32:35], v[128:131]
  v_mfma_f32_16x16x32_bf16 v[128:131], v[80:83], v[64:67], v[128:131]
  v_mfma_f32_16x16x32_bf16 v[136:139], v[80:83], v[68:71], v[136:139]
  v_mfma_f32_16x16x32_bf16 v[136:139], v[48:51], v[36:39], v[136:139]
  v_mfma_f32_16x16x32_bf16 v[144:147], v[48:51], v[40:43], v[144:147]
  v_mfma_f32_16x16x32_bf16 v[144:147], v[80:83], v[72:75], v[144:147]
  v_mfma_f32_16x16x32_bf16 v[152:155], v[80:83], v[76:79], v[152:155]
  v_mfma_f32_16x16x32_bf16 v[152:155], v[48:51], v[44:47], v[152:155]
  v_mfma_f32_16x16x32_bf16 v[156:159], v[52:55], v[44:47], v[156:159]
  v_mfma_f32_16x16x32_bf16 v[156:159], v[84:87], v[76:79], v[156:159]
  v_mfma_f32_16x16x32_bf16 v[148:151], v[84:87], v[72:75], v[148:151]
  v_mfma_f32_16x16x32_bf16 v[148:151], v[52:55], v[40:43], v[148:151]
  v_mfma_f32_16x16x32_bf16 v[140:143], v[52:55], v[36:39], v[140:143]
  v_mfma_f32_16x16x32_bf16 v[140:143], v[84:87], v[68:71], v[140:143]
  v_mfma_f32_16x16x32_bf16 v[132:135], v[84:87], v[64:67], v[132:135]
  v_mfma_f32_16x16x32_bf16 v[132:135], v[52:55], v[32:35], v[132:135]
  s_nop 0
  s_barrier
  ds_read_b128 v[96:99], v4 offset:0
  ds_read_b128 v[192:195], v5 offset:0
  ds_read_b128 v[100:103], v4 offset:2048
  ds_read_b128 v[196:199], v5 offset:2048
  ds_read_b128 v[104:107], v4 offset:4096
  ds_read_b128 v[200:203], v5 offset:4096
  ds_read_b128 v[108:111], v4 offset:6144
  ds_read_b128 v[204:207], v5 offset:6144
  s_add_u32 s16, s16, s17
  s_cmp_eq_u32 s16, 65536
  s_cselect_b32 s23, s18, s17
  s_cselect_b32 s16, 0, s16
  v_add_u32 v4, s23, v4
  v_add_u32 v5, s23, v5
  s_waitcnt lgkmcnt(6)
  v_mfma_f32_16x16x32_bf16 v[128:131], v[112:115], v[96:99], v[128:131]
  v_mfma_f32_16x16x32_bf16 v[128:131], v[208:211], v[192:195], v[128:131]
  s_waitcnt lgkmcnt(4)
  v_mfma_f32_16x16x32_bf16 v[136:139], v[208:211], v[196:199], v[136:139]
  v_mfma_f32_16x16x32_bf16 v[136:139], v[112:115], v[100:103], v[136:139]
  s_waitcnt lgkmcnt(2)
  v_mfma_f32_16x16x32_bf16 v[144:147], v[112:115], v[104:107], v[144:147]
  v_mfma_f32_16x16x32_bf16 v[144:147], v[208:211], v[200:203], v[144:147]
  s_waitcnt lgkmcnt(0)
  v_mfma_f32_16x16x32_bf16 v[152:155], v[208:211], v[204:207], v[152:155]
  s_barrier
  v_mfma_f32_16x16x32_bf16 v[152:155], v[112:115], v[108:111], v[152:155]
  ds_read_b128 v[32:35], v4 offset:0
  ds_read_b128 v[36:39], v4 offset:2048
  v_mfma_f32_16x16x32_bf16 v[156:159], v[116:119], v[108:111], v[156:159]
  ds_read_b128 v[40:43], v4 offset:4096
  ds_read_b128 v[44:47], v4 offset:6144
  v_mfma_f32_16x16x32_bf16 v[156:159], v[212:215], v[204:207], v[156:159]
  ds_read_b128 v[64:67], v5 offset:0
  ds_read_b128 v[68:71], v5 offset:2048
  v_mfma_f32_16x16x32_bf16 v[148:151], v[212:215], v[200:203], v[148:151]
  ds_read_b128 v[72:75], v5 offset:4096
  ds_read_b128 v[76:79], v5 offset:6144
  v_mfma_f32_16x16x32_bf16 v[148:151], v[116:119], v[104:107], v[148:151]
  s_add_u32 s16, s16, s17
  s_cmp_eq_u32 s16, 65536
  s_cselect_b32 s23, s18, s17
  v_mfma_f32_16x16x32_bf16 v[140:143], v[116:119], v[100:103], v[140:143]
  s_cselect_b32 s16, 0, s16
  v_add_u32 v4, s23, v4
  v_add_u32_e64 v5, s23, v5
  v_mfma_f32_16x16x32_bf16 v[140:143], v[212:215], v[196:199], v[140:143]
  v_mfma_f32_16x16x32_bf16 v[132:135], v[212:215], v[192:195], v[132:135]
  s_waitcnt lgkmcnt(0)
  v_mfma_f32_16x16x32_bf16 v[132:135], v[116:119], v[96:99], v[132:135]
  s_barrier
  v_mfma_f32_16x16x32_bf16 v[128:131], v[160:163], v[32:35], v[128:131]
  ds_read_b128 v[96:99], v4 offset:0
  ds_read_b128 v[100:103], v4 offset:2048
  v_mfma_f32_16x16x32_bf16 v[128:131], v[168:171], v[64:67], v[128:131]
  ds_read_b128 v[104:107], v4 offset:4096
  ds_read_b128 v[108:111], v4 offset:6144
  v_mfma_f32_16x16x32_bf16 v[136:139], v[168:171], v[68:71], v[136:139]
  ds_read_b128 v[192:195], v5 offset:0
  ds_read_b128 v[196:199], v5 offset:2048
  v_mfma_f32_16x16x32_bf16 v[136:139], v[160:163], v[36:39], v[136:139]
  ds_read_b128 v[200:203], v5 offset:4096
  ds_read_b128 v[204:207], v5 offset:6144
  v_mfma_f32_16x16x32_bf16 v[144:147], v[160:163], v[40:43], v[144:147]
  s_add_u32 s16, s16, s17
  s_cmp_eq_u32 s16, 65536
  s_cselect_b32 s23, s18, s17
  v_mfma_f32_16x16x32_bf16 v[144:147], v[168:171], v[72:75], v[144:147]
  s_cselect_b32 s16, 0, s16
  v_add_u32 v4, s23, v4
  v_add_u32_e64 v5, s23, v5
  v_mfma_f32_16x16x32_bf16 v[152:155], v[168:171], v[76:79], v[152:155]
  v_mfma_f32_16x16x32_bf16 v[152:155], v[160:163], v[44:47], v[152:155]
  v_mfma_f32_16x16x32_bf16 v[156:159], v[164:167], v[44:47], v[156:159]
  v_mfma_f32_16x16x32_bf16 v[156:159], v[172:175], v[76:79], v[156:159]
  v_mfma_f32_16x16x32_bf16 v[148:151], v[172:175], v[72:75], v[148:151]
  v_mfma_f32_16x16x32_bf16 v[148:151], v[164:167], v[40:43], v[148:151]
  v_mfma_f32_16x16x32_bf16 v[140:143], v[164:167], v[36:39], v[140:143]
  v_mfma_f32_16x16x32_bf16 v[140:143], v[172:175], v[68:71], v[140:143]
  v_mfma_f32_16x16x32_bf16 v[132:135], v[172:175], v[64:67], v[132:135]
  s_waitcnt lgkmcnt(0)
  v_mfma_f32_16x16x32_bf16 v[132:135], v[164:167], v[32:35], v[132:135]
  s_barrier
  v_mfma_f32_16x16x32_bf16 v[128:131], v[176:179], v[96:99], v[128:131]
  ds_read_b128 v[32:35], v4 offset:0
  ds_read_b128 v[36:39], v4 offset:2048
  v_mfma_f32_16x16x32_bf16 v[128:131], v[184:187], v[192:195], v[128:131]
  ds_read_b128 v[40:43], v4 offset:4096
  ds_read_b128 v[44:47], v4 offset:6144
  v_mfma_f32_16x16x32_bf16 v[136:139], v[184:187], v[196:199], v[136:139]
  ds_read_b128 v[64:67], v5 offset:0
  ds_read_b128 v[68:71], v5 offset:2048
  v_mfma_f32_16x16x32_bf16 v[136:139], v[176:179], v[100:103], v[136:139]
  ds_read_b128 v[72:75], v5 offset:4096
  ds_read_b128 v[76:79], v5 offset:6144
  v_mfma_f32_16x16x32_bf16 v[144:147], v[176:179], v[104:107], v[144:147]
  s_add_u32 s16, s16, s17
  s_cmp_eq_u32 s16, 65536
  s_cselect_b32 s23, s18, s17
  v_mfma_f32_16x16x32_bf16 v[144:147], v[184:187], v[200:203], v[144:147]
  s_cselect_b32 s16, 0, s16
  v_add_u32 v4, s23, v4
  v_add_u32_e64 v5, s23, v5
  v_mfma_f32_16x16x32_bf16 v[152:155], v[184:187], v[204:207], v[152:155]
  v_mfma_f32_16x16x32_bf16 v[152:155], v[176:179], v[108:111], v[152:155]
  v_mfma_f32_16x16x32_bf16 v[156:159], v[180:183], v[108:111], v[156:159]
  v_mfma_f32_16x16x32_bf16 v[156:159], v[188:191], v[204:207], v[156:159]
  v_mfma_f32_16x16x32_bf16 v[148:151], v[188:191], v[200:203], v[148:151]
  v_mfma_f32_16x16x32_bf16 v[148:151], v[180:183], v[104:107], v[148:151]
  v_mfma_f32_16x16x32_bf16 v[140:143], v[180:183], v[100:103], v[140:143]
  v_mfma_f32_16x16x32_bf16 v[140:143], v[188:191], v[196:199], v[140:143]
  v_mfma_f32_16x16x32_bf16 v[132:135], v[188:191], v[192:195], v[132:135]
  s_waitcnt lgkmcnt(0)
  v_mfma_f32_16x16x32_bf16 v[132:135], v[180:183], v[96:99], v[132:135]
  s_barrier
  v_mfma_f32_16x16x32_bf16 v[128:131], v[224:227], v[32:35], v[128:131]
  ds_read_b128 v[96:99], v4 offset:0
  ds_read_b128 v[100:103], v4 offset:2048
  v_mfma_f32_16x16x32_bf16 v[128:131], v[232:235], v[64:67], v[128:131]
  ds_read_b128 v[104:107], v4 offset:4096
  ds_read_b128 v[108:111], v4 offset:6144
  v_mfma_f32_16x16x32_bf16 v[136:139], v[232:235], v[68:71], v[136:139]
  ds_read_b128 v[192:195], v5 offset:0
  ds_read_b128 v[196:199], v5 offset:2048
  v_mfma_f32_16x16x32_bf16 v[136:139], v[224:227], v[36:39], v[136:139]
  ds_read_b128 v[200:203], v5 offset:4096
  ds_read_b128 v[204:207], v5 offset:6144
  v_mfma_f32_16x16x32_bf16 v[144:147], v[224:227], v[40:43], v[144:147]
  s_add_u32 s16, s16, s17
  s_cmp_eq_u32 s16, 65536
  s_cselect_b32 s23, s18, s17
  v_mfma_f32_16x16x32_bf16 v[144:147], v[232:235], v[72:75], v[144:147]
  s_cselect_b32 s16, 0, s16
  v_add_u32 v4, s23, v4
  v_add_u32_e64 v5, s23, v5
  v_mfma_f32_16x16x32_bf16 v[152:155], v[232:235], v[76:79], v[152:155]
  v_mfma_f32_16x16x32_bf16 v[152:155], v[224:227], v[44:47], v[152:155]
  v_mfma_f32_16x16x32_bf16 v[156:159], v[228:231], v[44:47], v[156:159]
  v_mfma_f32_16x16x32_bf16 v[156:159], v[236:239], v[76:79], v[156:159]
  v_mfma_f32_16x16x32_bf16 v[148:151], v[236:239], v[72:75], v[148:151]
  v_mfma_f32_16x16x32_bf16 v[148:151], v[228:231], v[40:43], v[148:151]
  v_mfma_f32_16x16x32_bf16 v[140:143], v[228:231], v[36:39], v[140:143]
  v_mfma_f32_16x16x32_bf16 v[140:143], v[236:239], v[68:71], v[140:143]
  v_mfma_f32_16x16x32_bf16 v[132:135], v[236:239], v[64:67], v[132:135]
  s_waitcnt lgkmcnt(0)
  v_mfma_f32_16x16x32_bf16 v[132:135], v[228:231], v[32:35], v[132:135]
  s_barrier
  v_mfma_f32_16x16x32_bf16 v[128:131], v[56:59], v[96:99], v[128:131]
  ds_read_b64_tr_b16 v[48:49], v6 offset:0
  ds_read_b64_tr_b16 v[50:51], v6 offset:2048
  v_mfma_f32_16x16x32_bf16 v[128:131], v[88:91], v[192:195], v[128:131]
  ds_read_b128 v[32:35], v4 offset:0
  ds_read_b128 v[36:39], v4 offset:2048
  v_mfma_f32_16x16x32_bf16 v[136:139], v[88:91], v[196:199], v[136:139]
  ds_read_b128 v[40:43], v4 offset:4096
  ds_read_b128 v[44:47], v4 offset:6144
  v_mfma_f32_16x16x32_bf16 v[136:139], v[56:59], v[100:103], v[136:139]
  ds_read_b64_tr_b16 v[52:53], v7 offset:0
  ds_read_b64_tr_b16 v[54:55], v7 offset:2048
  v_mfma_f32_16x16x32_bf16 v[144:147], v[56:59], v[104:107], v[144:147]
  ds_read_b64_tr_b16 v[80:81], v6 offset:4096
  ds_read_b64_tr_b16 v[82:83], v6 offset:6144
  v_mfma_f32_16x16x32_bf16 v[144:147], v[88:91], v[200:203], v[144:147]
  ds_read_b128 v[64:67], v5 offset:0
  ds_read_b128 v[68:71], v5 offset:2048
  v_mfma_f32_16x16x32_bf16 v[152:155], v[88:91], v[204:207], v[152:155]
  ds_read_b128 v[72:75], v5 offset:4096
  ds_read_b128 v[76:79], v5 offset:6144
  v_mfma_f32_16x16x32_bf16 v[152:155], v[56:59], v[108:111], v[152:155]
  ds_read_b64_tr_b16 v[84:85], v7 offset:4096
  ds_read_b64_tr_b16 v[86:87], v7 offset:6144
  v_mfma_f32_16x16x32_bf16 v[156:159], v[60:63], v[108:111], v[156:159]
  s_add_u32 s16, s16, s17
  s_cmp_eq_u32 s16, 65536
  s_cselect_b32 s23, s18, s17
  v_mfma_f32_16x16x32_bf16 v[156:159], v[92:95], v[204:207], v[156:159]
  s_cselect_b32 s16, 0, s16
  v_add_u32 v4, s23, v4
  v_add_u32_e64 v5, s23, v5
  v_mfma_f32_16x16x32_bf16 v[148:151], v[92:95], v[200:203], v[148:151]
  s_add_u32 s19, s19, s20
  s_cmp_eq_u32 s19, 81920
  s_cselect_b32 s23, s21, s20
  v_mfma_f32_16x16x32_bf16 v[148:151], v[60:63], v[104:107], v[148:151]
  s_cselect_b32 s19, 0, s19
  v_add_u32 v6, s23, v6
  v_add_u32_e64 v7, s23, v7
  v_mfma_f32_16x16x32_bf16 v[140:143], v[60:63], v[100:103], v[140:143]
  v_mfma_f32_16x16x32_bf16 v[140:143], v[92:95], v[196:199], v[140:143]
  v_mfma_f32_16x16x32_bf16 v[132:135], v[92:95], v[192:195], v[132:135]
  s_waitcnt lgkmcnt(0)
  v_mfma_f32_16x16x32_bf16 v[132:135], v[60:63], v[96:99], v[132:135]
Lk_20:
  s_barrier
  v_mfma_f32_16x16x32_bf16 v[128:131], v[48:51], v[32:35], v[128:131]
  ds_read_b64_tr_b16 v[112:113], v6 offset:0
  ds_read_b64_tr_b16 v[114:115], v6 offset:2048
  v_mfma_f32_16x16x32_bf16 v[128:131], v[80:83], v[64:67], v[128:131]
  ds_read_b128 v[96:99], v4 offset:0
  ds_read_b128 v[100:103], v4 offset:2048
  v_mfma_f32_16x16x32_bf16 v[136:139], v[80:83], v[68:71], v[136:139]
  ds_read_b128 v[104:107], v4 offset:4096
  ds_read_b128 v[108:111], v4 offset:6144
  v_mfma_f32_16x16x32_bf16 v[136:139], v[48:51], v[36:39], v[136:139]
  ds_read_b64_tr_b16 v[116:117], v7 offset:0
  ds_read_b64_tr_b16 v[118:119], v7 offset:2048
  v_mfma_f32_16x16x32_bf16 v[144:147], v[48:51], v[40:43], v[144:147]
  ds_read_b64_tr_b16 v[208:209], v6 offset:4096
  ds_read_b64_tr_b16 v[210:211], v6 offset:6144
  v_mfma_f32_16x16x32_bf16 v[144:147], v[80:83], v[72:75], v[144:147]
  ds_read_b128 v[192:195], v5 offset:0
  ds_read_b128 v[196:199], v5 offset:2048
  v_mfma_f32_16x16x32_bf16 v[152:155], v[80:83], v[76:79], v[152:155]
  ds_read_b128 v[200:203], v5 offset:4096
  ds_read_b128 v[204:207], v5 offset:6144
  v_mfma_f32_16x16x32_bf16 v[152:155], v[48:51], v[44:47], v[152:155]
  ds_read_b64_tr_b16 v[212:213], v7 offset:4096
  ds_read_b64_tr_b16 v[214:215], v7 offset:6144
  v_mfma_f32_16x16x32_bf16 v[156:159], v[52:55], v[44:47], v[156:159]
  s_add_u32 s16, s16, s17
  s_cmp_eq_u32 s16, 65536
  s_cselect_b32 s23, s18, s17
  v_mfma_f32_16x16x32_bf16 v[156:159], v[84:87], v[76:79], v[156:159]
  s_cselect_b32 s16, 0, s16
  v_add_u32 v4, s23, v4
  v_add_u32_e64 v5, s23, v5
  v_mfma_f32_16x16x32_bf16 v[148:151], v[84:87], v[72:75], v[148:151]
  s_add_u32 s19, s19, s20
  s_cmp_eq_u32 s19, 81920
  s_cselect_b32 s23, s21, s20
  v_mfma_f32_16x16x32_bf16 v[148:151], v[52:55], v[40:43], v[148:151]
  s_cselect_b32 s19, 0, s19
  v_add_u32 v6, s23, v6
  v_add_u32_e64 v7, s23, v7
  v_mfma_f32_16x16x32_bf16 v[140:143], v[52:55], v[36:39], v[140:143]
  v_mfma_f32_16x16x32_bf16 v[140:143], v[84:87], v[68:71], v[140:143]
  v_mfma_f32_16x16x32_bf16 v[132:135], v[84:87], v[64:67], v[132:135]
  s_waitcnt lgkmcnt(0)
  v_mfma_f32_16x16x32_bf16 v[132:135], v[52:55], v[32:35], v[132:135]
  s_barrier
  v_mfma_f32_16x16x32_bf16 v[128:131], v[112:115], v[96:99], v[128:131]
  ds_read_b64_tr_b16 v[48:49], v6 offset:0
  ds_read_b64_tr_b16 v[50:51], v6 offset:2048
  v_mfma_f32_16x16x32_bf16 v[128:131], v[208:211], v[192:195], v[128:131]
  ds_read_b128 v[32:35], v4 offset:0
  ds_read_b128 v[36:39], v4 offset:2048
  v_mfma_f32_16x16x32_bf16 v[136:139], v[208:211], v[196:199], v[136:139]
  ds_read_b128 v[40:43], v4 offset:4096
  ds_read_b128 v[44:47], v4 offset:6144
  v_mfma_f32_16x16x32_bf16 v[136:139], v[112:115], v[100:103], v[136:139]
  ds_read_b64_tr_b16 v[52:53], v7 offset:0
  ds_read_b64_tr_b16 v[54:55], v7 offset:2048
  v_mfma_f32_16x16x32_bf16 v[144:147], v[112:115], v[104:107], v[144:147]
  ds_read_b64_tr_b16 v[80:81], v6 offset:4096
  ds_read_b64_tr_b16 v[82:83], v6 offset:6144
  v_mfma_f32_16x16x32_bf16 v[144:147], v[208:211], v[200:203], v[144:147]
  ds_read_b128 v[64:67], v5 offset:0
  ds_read_b128 v[68:71], v5 offset:2048
  v_mfma_f32_16x16x32_bf16 v[152:155], v[208:211], v[204:207], v[152:155]
  ds_read_b128 v[72:75], v5 offset:4096
  ds_read_b128 v[76:79], v5 offset:6144
  v_mfma_f32_16x16x32_bf16 v[152:155], v[112:115], v[108:111], v[152:155]
  ds_read_b64_tr_b16 v[84:85], v7 offset:4096
  ds_read_b64_tr_b16 v[86:87], v7 offset:6144
  v_mfma_f32_16x16x32_bf16 v[156:159], v[116:119], v[108:111], v[156:159]
  s_add_u32 s16, s16, s17
  s_cmp_eq_u32 s16, 65536
  s_cselect_b32 s23, s18, s17
  v_mfma_f32_16x16x32_bf16 v[156:159], v[212:215], v[204:207], v[156:159]
  s_cselect_b32 s16, 0, s16
  v_add_u32 v4, s23, v4
  v_add_u32_e64 v5, s23, v5
  v_mfma_f32_16x16x32_bf16 v[148:151], v[212:215], v[200:203], v[148:151]
  s_add_u32 s19, s19, s20
  s_cmp_eq_u32 s19, 81920
  s_cselect_b32 s23, s21, s20
  v_mfma_f32_16x16x32_bf16 v[148:151], v[116:119], v[104:107], v[148:151]
  s_cselect_b32 s19, 0, s19
  v_add_u32 v6, s23, v6
  v_add_u32_e64 v7, s23, v7
  v_mfma_f32_16x16x32_bf16 v[140:143], v[116:119], v[100:103], v[140:143]
  s_sub_u32 s22, s22, 1
  s_cmp_lg_u32 s22, 0
  v_mfma_f32_16x16x32_bf16 v[140:143], v[212:215], v[196:199], v[140:143]
  v_mfma_f32_16x16x32_bf16 v[132:135], v[212:215], v[192:195], v[132:135]
  s_nop 0
  s_waitcnt lgkmcnt(0)
  v_mfma_f32_16x16x32_bf16 v[132:135], v[116:119], v[96:99], v[132:135]
  s_cbranch_scc1 Lk_20
  s_waitcnt lgkmcnt(0)
  v_cvt_pk_bf16_f32 v252, v152, v153
  v_cvt_pk_bf16_f32 v253, v154, v155
  v_cvt_pk_bf16_f32 v254, v156, v157
  v_cvt_pk_bf16_f32 v255, v158, v159
  buffer_store_dwordx4 v[252:255], v0, s[40:43], s7 offen offset:2048 sc0 sc1
  v_cvt_pk_bf16_f32 v248, v144, v145
  v_cvt_pk_bf16_f32 v249, v146, v147
  v_cvt_pk_bf16_f32 v250, v148, v149
  v_cvt_pk_bf16_f32 v251, v150, v151
  buffer_store_dwordx4 v[248:251], v0, s[40:43], s7 offen offset:0 sc0 sc1
  v_cvt_pk_bf16_f32 v244, v136, v137
  v_cvt_pk_bf16_f32 v245, v138, v139
  v_cvt_pk_bf16_f32 v246, v140, v141
  v_cvt_pk_bf16_f32 v247, v142, v143
  buffer_store_dwordx4 v[244:247], v0, s[40:43], s6 offen offset:2048 sc0 sc1
  v_cvt_pk_bf16_f32 v240, v128, v129
  v_cvt_pk_bf16_f32 v241, v130, v131
  v_cvt_pk_bf16_f32 v242, v132, v133
  v_cvt_pk_bf16_f32 v243, v134, v135
  buffer_store_dwordx4 v[240:243], v0, s[40:43], s6 offen offset:0 sc0 sc1
  s_lshl_b32 s5, s78, Lz1-Lz0+1
  v_mov_b32 v40, 0x3f803f80
  v_dot2_f32_bf16 v32, v240, v40, 0
  v_dot2_f32_bf16 v36, v240, v240, 0
  v_dot2_f32_bf16 v33, v244, v40, 0
  v_dot2_f32_bf16 v37, v244, v244, 0
  v_dot2_f32_bf16 v34, v248, v40, 0
  v_dot2_f32_bf16 v38, v248, v248, 0
  v_dot2_f32_bf16 v35, v252, v40, 0
  v_dot2_f32_bf16 v39, v252, v252, 0
  v_dot2_f32_bf16 v32, v241, v40, v32
  v_dot2_f32_bf16 v36, v241, v241, v36
  v_dot2_f32_bf16 v33, v245, v40, v33
  v_dot2_f32_bf16 v37, v245, v245, v37
  v_dot2_f32_bf16 v34, v249, v40, v34
  v_dot2_f32_bf16 v38, v249, v249, v38
  v_dot2_f32_bf16 v35, v253, v40, v35
  v_dot2_f32_bf16 v39, v253, v253, v39
  v_dot2_f32_bf16 v32, v242, v40, v32
  v_dot2_f32_bf16 v36, v242, v242, v36
  v_dot2_f32_bf16 v33, v246, v40, v33
  v_dot2_f32_bf16 v37, v246, v246, v37
  v_dot2_f32_bf16 v34, v250, v40, v34
  v_dot2_f32_bf16 v38, v250, v250, v38
  v_dot2_f32_bf16 v35, v254, v40, v35
  v_dot2_f32_bf16 v39, v254, v254, v39
  v_dot2_f32_bf16 v32, v243, v40, v32
  v_dot2_f32_bf16 v36, v243, v243, v36
  v_dot2_f32_bf16 v33, v247, v40, v33
  v_dot2_f32_bf16 v37, v247, v247, v37
  v_dot2_f32_bf16 v34, v251, v40, v34
  v_dot2_f32_bf16 v38, v251, v251, v38
  v_dot2_f32_bf16 v35, v255, v40, v35
  v_dot2_f32_bf16 v39, v255, v255, v39
  s_lshl_b32 s6, s76, Lz1-Lz0+9
  s_lshl_b32 s7, s85, 8
  s_add_u32 s6, s6, s7
  s_add_u32 s6, s6, s5
  s_add_u32 s6, s6, s86
  s_lshl_b32 s6, s6, 6
  s_add_u32 s6, s6, s83
  s_add_u32 s6, s6, 31457280
  v_permlane32_swap_b32 v32, v34
  v_permlane32_swap_b32 v33, v35
  v_permlane32_swap_b32 v36, v38
  v_permlane32_swap_b32 v37, v39
  v_add_f32 v32, v32, v34
  v_add_f32 v33, v33, v35
  v_add_f32 v36, v36, v38
  v_add_f32 v37, v37, v39
  v_permlane16_swap_b32 v32, v33
  s_nop 0
  v_permlane16_swap_b32 v36, v37
  v_add_f32 v42, v32, v33
  v_add_f32_e64 v43, v36, v37
  buffer_store_dwordx2 v[42:43], v30, s[40:43], s6 offen sc0 sc1
  ds_write_b128 v0, v[240:243] offset:0
  ds_write_b128 v0, v[244:247] offset:2048
  ds_write_b128 v0, v[248:251] offset:4096
  ds_write_b128 v0, v[252:255] offset:6144
  s_add_u32 s5, s87, 0x4
  s_sub_u32 s4, s78, s77
  s_lshl_b32 s4, s4, 7
  s_add_u32 s5, s5, s4
  s_waitcnt vmcnt(0)
  s_mov_b64 exec, 1
  ds_add_rtn_u32 v2, v28, v27 offset:0
  s_waitcnt lgkmcnt(0)
  v_readfirstlane_b32 s4, v2
  s_and_b32 s4, s4, Lz1-Lz0+3
  s_cmp_lg_u32 s4, 3
  s_cbranch_scc1 Ls_21
  s_mov_b32 exec_lo, 0xffff
  buffer_store_dword v27, v24, s[40:43], s5 offen sc0 sc1
Ls_21:
  s_mov_b64 exec, -1
  s_mov_b32 s16, 0
  s_mov_b32 s17, 16384
  s_mov_b32 s18, 0xffff4000
  s_mov_b32 s19, Lz1-Lz0+0
  s_mov_b32 s20, 28672
  s_mov_b32 s21, 0xffff2000
  s_mul_i32 s4, s85, 8192
  v_add_u32_e64 v4, s4, v11
  v_add_u32 v5, 1024, v4
  s_mul_i32 s4, s86, 6
  s_add_u32 s4, s4, 0
  s_lshr_b32 s5, s4, 2
  s_lshl_b32 s5, s5, 13
  s_and_b32 s4, s4, 3
  v_xor_b32 v2, s4, v26
  v_lshl_add_u32 v6, v2, 5, v25
  v_add_u32 v6, s5, v6
  s_mul_i32 s4, s86, 6
  s_add_u32 s4, s4, 1
  s_lshr_b32 s5, s4, 2
  s_lshl_b32 s5, s5, 13
  s_and_b32 s4, s4, 3
  v_xor_b32_e64 v2, s4, v26
  v_lshl_add_u32 v7, v2, 5, v25
  v_add_u32 v7, s5, v7
  s_mul_i32 s4, s86, 6
  s_add_u32 s4, s4, 2
  s_lshr_b32 s5, s4, 2
  s_lshl_b32 s5, s5, 13
  s_and_b32 s4, s4, 3
  v_xor_b32_e64 v2, s4, v26
  v_lshl_add_u32 v8, v2, 5, v25
  v_add_u32 v8, s5, v8
  s_mul_i32 s4, s86, 6
  s_add_u32 s4, s4, 3
  s_lshr_b32 s5, s4, 2
  s_lshl_b32 s5, s5, 13
  s_and_b32 s4, s4, 3
  v_xor_b32_e64 v2, s4, v26
  v_lshl_add_u32 v9, v2, 5, v25
  v_add_u32 v9, s5, v9
  v_lshrrev_b32 v2, 2, v1
  v_lshlrev_b32 v3, 6, v2
  v_and_b32 v2, 3, v1
  v_lshl_add_u32 v3, v2, 3, v3
  v_bfe_u32 v2, v1, 4, 1
  v_xor_b32_e64 v2, s86, v2
  v_lshl_add_u32 v3, v2, 5, v3
  v_add_u32 v10, 90112, v3
  v_mov_b64 v[128:129], 0
  v_mov_b64 v[130:131], 0
  v_mov_b64 v[132:133], 0
  v_mov_b64 v[134:135], 0
  v_mov_b64 v[136:137], 0
  v_mov_b64 v[138:139], 0
  v_mov_b64 v[140:141], 0
  v_mov_b64 v[142:143], 0
  v_mov_b64 v[144:145], 0
  v_mov_b64 v[146:147], 0
  v_mov_b64 v[148:149], 0
  v_mov_b64 v[150:151], 0
  v_mov_b64 v[152:153], 0
  v_mov_b64 v[154:155], 0
  v_mov_b64 v[156:157], 0
  v_mov_b64 v[158:159], 0
  v_mov_b64 v[160:161], 0
  v_mov_b64 v[162:163], 0
  v_mov_b64 v[164:165], 0
  v_mov_b64 v[166:167], 0
  v_mov_b64 v[168:169], 0
  v_mov_b64 v[170:171], 0
  v_mov_b64 v[172:173], 0
  v_mov_b64 v[174:175], 0
  v_mov_b64 v[176:177], 0
  v_mov_b64 v[178:179], 0
  v_mov_b64 v[180:181], 0
  v_mov_b64 v[182:183], 0
  v_mov_b64 v[184:185], 0
  v_mov_b64 v[186:187], 0
  v_mov_b64 v[188:189], 0
  v_mov_b64 v[190:191], 0
  v_mov_b64 v[192:193], 0
  v_mov_b64 v[194:195], 0
  v_mov_b64 v[196:197], 0
  v_mov_b64 v[198:199], 0
  v_mov_b64 v[200:201], 0
  v_mov_b64 v[202:203], 0
  v_mov_b64 v[204:205], 0
  v_mov_b64 v[206:207], 0
  v_mov_b64 v[208:209], 0
  v_mov_b64 v[210:211], 0
  v_mov_b64 v[212:213], 0
  v_mov_b64 v[214:215], 0
  v_mov_b64 v[216:217], 0
  v_mov_b64 v[218:219], 0
  v_mov_b64 v[220:221], 0
  v_mov_b64 v[222:223], 0
  v_mov_b64 v[224:225], 0
  v_mov_b64 v[226:227], 0
  v_mov_b64 v[228:229], 0
  v_mov_b64 v[230:231], 0
  v_mov_b64 v[232:233], 0
  v_mov_b64 v[234:235], 0
  v_mov_b64 v[236:237], 0
  v_mov_b64 v[238:239], 0
  s_mul_i32 s5, s86, 384
  s_add_u32 s5, s5, 154112
  v_add_u32 v3, s5, v29
  s_mul_i32 s4, s76, 56
  s_mul_i32 s5, s79, 28
  s_add_u32 s4, s4, s5
  s_add_u32 s6, s4, s80
  s_lshl_b32 s6, s6, 14
  s_add_u32 s6, s6, 11599872
  s_add_u32 s7, s6, 4096
  s_lshr_b32 s5, s80, 1
  s_add_u32 s4, s4, s5
  s_lshl_b32 s4, s4, 1
  s_add_u32 s4, s4, s85
  s_lshl_b32 s4, s4, 3
  s_and_b32 s5, s80, 1
  s_add_u32 s4, s4, s5
  s_lshl_b32 s4, s4, 1
  s_add_u32 s4, s4, s86
  s_lshl_b32 s8, s4, 9
  s_add_u32 s8, s8, 11534336
  s_lshl_b32 s4, s79, Lz1-Lz0+3
  s_lshl_b32 s10, 0xff, s4
  s_mov_b32 s22, 8
  s_mov_b64 vcc, -1
  s_waitcnt lgkmcnt(0)
  s_barrier
  s_branch Lo_25
Lo_26:
  s_mov_b64 vcc, 0
  s_waitcnt lgkmcnt(0)
  s_barrier
  ds_read_b128 v[64:67], v4 offset:0
  ds_read_b128 v[80:83], v5 offset:0
  ds_read_b128 v[68:71], v4 offset:2048
  ds_read_b128 v[84:87], v5 offset:2048
  ds_read_b128 v[72:75], v4 offset:4096
  ds_read_b128 v[88:91], v5 offset:4096
  ds_read_b64_tr_b16 v[96:97], v6 offset:0
  ds_read_b64_tr_b16 v[98:99], v6 offset:2048
  ds_read_b64_tr_b16 v[100:101], v6 offset:4096
  ds_read_b64_tr_b16 v[102:103], v6 offset:6144
  ds_read_b128 v[76:79], v4 offset:6144
  ds_read_b128 v[92:95], v5 offset:6144
  ds_read_b64_tr_b16 v[104:105], v7 offset:0
  s_nop 0
  s_waitcnt lgkmcnt(8)
  ds_read_b64_tr_b16 v[106:107], v7 offset:2048
  ds_read_b64_tr_b16 v[108:109], v7 offset:4096
  ds_read_b64_tr_b16 v[110:111], v7 offset:6144
  s_waitcnt lgkmcnt(6)
  s_branch Lk_23
Lo_25:
  ds_read_b128 v[32:35], v4 offset:0
  ds_read_b128 v[48:51], v5 offset:0
  ds_read_b128 v[36:39], v4 offset:2048
  ds_read_b128 v[52:55], v5 offset:2048
  ds_read_b128 v[40:43], v4 offset:4096
  ds_read_b128 v[56:59], v5 offset:4096
  ds_read_b64_tr_b16 v[96:97], v6 offset:0
  ds_read_b64_tr_b16 v[98:99], v6 offset:2048
  ds_read_b64_tr_b16 v[100:101], v6 offset:4096
  ds_read_b64_tr_b16 v[102:103], v6 offset:6144
  ds_read_b128 v[44:47], v4 offset:6144
  ds_read_b128 v[60:63], v5 offset:6144
  ds_read_b64_tr_b16 v[104:105], v7 offset:0
  s_nop 0
  s_waitcnt lgkmcnt(8)
  ds_read_b64_tr_b16 v[106:107], v7 offset:2048
  ds_read_b64_tr_b16 v[108:109], v7 offset:4096
  ds_read_b64_tr_b16 v[110:111], v7 offset:6144
  s_nop 0
  s_waitcnt lgkmcnt(6)
  .p2align 7
Lk_22:
  v_mfma_f32_16x16x32_bf16 v[128:131], v[96:99], v[32:35], v[128:131]
  ds_read_b64_tr_b16 v[112:113], v8 offset:0
  v_mfma_f32_16x16x32_bf16 v[128:131], v[100:103], v[48:51], v[128:131]
  ds_read_b64_tr_b16 v[114:115], v8 offset:2048
  v_mfma_f32_16x16x32_bf16 v[132:135], v[100:103], v[52:55], v[132:135]
  ds_read_b64_tr_b16 v[116:117], v8 offset:4096
  v_mfma_f32_16x16x32_bf16 v[132:135], v[96:99], v[36:39], v[132:135]
  ds_read_b64_tr_b16 v[118:119], v8 offset:6144
  v_mfma_f32_16x16x32_bf16 v[136:139], v[96:99], v[40:43], v[136:139]
  s_add_u32 s16, s16, s17
  s_cmp_eq_u32 s16, 65536
  s_cselect_b32 s23, s18, s17
  s_cselect_b32 s16, Lz1-Lz0+0, s16
  v_mfma_f32_16x16x32_bf16 v[136:139], v[100:103], v[56:59], v[136:139]
  v_add_u32_e64 v4, s23, v4
  v_add_u32 v5, s23, v5
  s_add_u32 s19, s19, s20
  s_cmp_eq_u32 s19, 86016
  s_waitcnt lgkmcnt(8)
  v_mfma_f32_16x16x32_bf16 v[140:143], v[100:103], v[60:63], v[140:143]
  s_cselect_b32 s23, s21, s20
  s_cselect_b32 s19, 0, s19
  v_mfma_f32_16x16x32_bf16 v[140:143], v[96:99], v[44:47], v[140:143]
  s_waitcnt lgkmcnt(4)
  v_mfma_f32_16x16x32_bf16 v[156:159], v[104:107], v[44:47], v[156:159]
  ds_read_b64_tr_b16 v[120:121], v9 offset:0
  v_mfma_f32_16x16x32_bf16 v[156:159], v[108:111], v[60:63], v[156:159]
  ds_read_b64_tr_b16 v[122:123], v9 offset:2048
  v_mfma_f32_16x16x32_bf16 v[152:155], v[108:111], v[56:59], v[152:155]
  ds_read_b64_tr_b16 v[124:125], v9 offset:4096
  v_mfma_f32_16x16x32_bf16 v[152:155], v[104:107], v[40:43], v[152:155]
  ds_read_b64_tr_b16 v[126:127], v9 offset:6144
  v_mfma_f32_16x16x32_bf16 v[148:151], v[104:107], v[36:39], v[148:151]
  v_mfma_f32_16x16x32_bf16 v[148:151], v[108:111], v[52:55], v[148:151]
  v_mfma_f32_16x16x32_bf16 v[144:147], v[108:111], v[48:51], v[144:147]
  ds_read_b64_tr_b16 v[96:97], v6 offset:8192
  v_mfma_f32_16x16x32_bf16 v[144:147], v[104:107], v[32:35], v[144:147]
  ds_read_b64_tr_b16 v[98:99], v6 offset:10240
  s_nop 0
  s_waitcnt lgkmcnt(6)
  v_mfma_f32_16x16x32_bf16 v[160:163], v[112:115], v[32:35], v[160:163]
  ds_read_b64_tr_b16 v[100:101], v6 offset:12288
  v_mfma_f32_16x16x32_bf16 v[160:163], v[116:119], v[48:51], v[160:163]
  ds_read_b64_tr_b16 v[102:103], v6 offset:14336
  v_mfma_f32_16x16x32_bf16 v[164:167], v[116:119], v[52:55], v[164:167]
  v_mfma_f32_16x16x32_bf16 v[164:167], v[112:115], v[36:39], v[164:167]
  v_mfma_f32_16x16x32_bf16 v[168:171], v[112:115], v[40:43], v[168:171]
  ds_read_b64_tr_b16 v[104:105], v7 offset:8192
  v_mfma_f32_16x16x32_bf16 v[168:171], v[116:119], v[56:59], v[168:171]
  ds_read_b64_tr_b16 v[106:107], v7 offset:10240
  v_mfma_f32_16x16x32_bf16 v[172:175], v[116:119], v[60:63], v[172:175]
  ds_read_b64_tr_b16 v[108:109], v7 offset:12288
  v_mfma_f32_16x16x32_bf16 v[172:175], v[112:115], v[44:47], v[172:175]
  ds_read_b64_tr_b16 v[110:111], v7 offset:14336
  s_waitcnt lgkmcnt(8)
  v_mfma_f32_16x16x32_bf16 v[188:191], v[120:123], v[44:47], v[188:191]
  v_add_u32 v6, s23, v6
  v_add_u32_e64 v7, s23, v7
  v_mfma_f32_16x16x32_bf16 v[188:191], v[124:127], v[60:63], v[188:191]
  ds_read_b64_tr_b16 v[112:113], v10 offset:0
  v_mfma_f32_16x16x32_bf16 v[184:187], v[124:127], v[56:59], v[184:187]
  ds_read_b64_tr_b16 v[114:115], v10 offset:1024
  v_mfma_f32_16x16x32_bf16 v[184:187], v[120:123], v[40:43], v[184:187]
  ds_read_b64_tr_b16 v[116:117], v10 offset:2048
  v_mfma_f32_16x16x32_bf16 v[180:183], v[120:123], v[36:39], v[180:183]
  ds_read_b64_tr_b16 v[118:119], v10 offset:3072
  v_mfma_f32_16x16x32_bf16 v[180:183], v[124:127], v[52:55], v[180:183]
  v_add_u32 v8, s23, v8
  v_add_u32 v9, s23, v9
  v_mfma_f32_16x16x32_bf16 v[176:179], v[124:127], v[48:51], v[176:179]
  v_add_u32 v10, s23, v10
  v_mfma_f32_16x16x32_bf16 v[176:179], v[120:123], v[32:35], v[176:179]
  s_waitcnt lgkmcnt(0)
  s_cbranch_vccnz Lo_27
  s_barrier
Lo_27:
  v_mfma_f32_16x16x32_bf16 v[192:195], v[96:99], v[32:35], v[192:195]
  ds_read_b128 v[64:67], v4 offset:0
  v_mfma_f32_16x16x32_bf16 v[192:195], v[100:103], v[48:51], v[192:195]
  ds_read_b128 v[80:83], v5 offset:0
  v_mfma_f32_16x16x32_bf16 v[196:199], v[100:103], v[52:55], v[196:199]
  v_mfma_f32_16x16x32_bf16 v[196:199], v[96:99], v[36:39], v[196:199]
  ds_read_b128 v[68:71], v4 offset:2048
  v_mfma_f32_16x16x32_bf16 v[200:203], v[96:99], v[40:43], v[200:203]
  ds_read_b128 v[84:87], v5 offset:2048
  v_mfma_f32_16x16x32_bf16 v[200:203], v[100:103], v[56:59], v[200:203]
  v_mfma_f32_16x16x32_bf16 v[204:207], v[100:103], v[60:63], v[204:207]
  ds_read_b128 v[72:75], v4 offset:4096
  v_mfma_f32_16x16x32_bf16 v[204:207], v[96:99], v[44:47], v[204:207]
  ds_read_b128 v[88:91], v5 offset:4096
  v_mfma_f32_16x16x32_bf16 v[220:223], v[104:107], v[44:47], v[220:223]
  ds_read_b64_tr_b16 v[96:97], v6 offset:0
  v_mfma_f32_16x16x32_bf16 v[220:223], v[108:111], v[60:63], v[220:223]
  ds_read_b64_tr_b16 v[98:99], v6 offset:2048
  v_mfma_f32_16x16x32_bf16 v[216:219], v[108:111], v[56:59], v[216:219]
  ds_read_b64_tr_b16 v[100:101], v6 offset:4096
  v_mfma_f32_16x16x32_bf16 v[216:219], v[104:107], v[40:43], v[216:219]
  ds_read_b64_tr_b16 v[102:103], v6 offset:6144
  v_mfma_f32_16x16x32_bf16 v[212:215], v[104:107], v[36:39], v[212:215]
  ds_read_b128 v[76:79], v4 offset:6144
  v_mfma_f32_16x16x32_bf16 v[212:215], v[108:111], v[52:55], v[212:215]
  v_mfma_f32_16x16x32_bf16 v[208:211], v[108:111], v[48:51], v[208:211]
  ds_read_b128 v[92:95], v5 offset:6144
  v_mfma_f32_16x16x32_bf16 v[208:211], v[104:107], v[32:35], v[208:211]
  v_mfma_f32_16x16x32_bf16 v[224:227], v[112:115], v[32:35], v[224:227]
  ds_read_b64_tr_b16 v[104:105], v7 offset:0
  v_mfma_f32_16x16x32_bf16 v[224:227], v[116:119], v[48:51], v[224:227]
  v_mfma_f32_16x16x32_bf16 v[228:231], v[116:119], v[52:55], v[228:231]
  ds_read_b64_tr_b16 v[106:107], v7 offset:2048
  v_mfma_f32_16x16x32_bf16 v[228:231], v[112:115], v[36:39], v[228:231]
  v_mfma_f32_16x16x32_bf16 v[232:235], v[112:115], v[40:43], v[232:235]
  ds_read_b64_tr_b16 v[108:109], v7 offset:4096
  v_mfma_f32_16x16x32_bf16 v[232:235], v[116:119], v[56:59], v[232:235]
  v_mfma_f32_16x16x32_bf16 v[236:239], v[116:119], v[60:63], v[236:239]
  ds_read_b64_tr_b16 v[110:111], v7 offset:6144
  s_waitcnt lgkmcnt(6)
  v_mfma_f32_16x16x32_bf16 v[236:239], v[112:115], v[44:47], v[236:239]
  s_cbranch_vccnz Lo_26
Lk_23:
  v_mfma_f32_16x16x32_bf16 v[128:131], v[96:99], v[64:67], v[128:131]
  ds_read_b64_tr_b16 v[112:113], v8 offset:0
  v_mfma_f32_16x16x32_bf16 v[128:131], v[100:103], v[80:83], v[128:131]
  ds_read_b64_tr_b16 v[114:115], v8 offset:2048
  v_mfma_f32_16x16x32_bf16 v[132:135], v[100:103], v[84:87], v[132:135]
  ds_read_b64_tr_b16 v[116:117], v8 offset:4096
  v_mfma_f32_16x16x32_bf16 v[132:135], v[96:99], v[68:71], v[132:135]
  ds_read_b64_tr_b16 v[118:119], v8 offset:6144
  v_mfma_f32_16x16x32_bf16 v[136:139], v[96:99], v[72:75], v[136:139]
  s_add_u32 s16, s16, s17
  s_cmp_eq_u32 s16, 65536
  s_cselect_b32 s23, s18, s17
  s_cselect_b32 s16, Lz1-Lz0+0, s16
  v_mfma_f32_16x16x32_bf16 v[136:139], v[100:103], v[88:91], v[136:139]
  v_add_u32_e64 v4, s23, v4
  v_add_u32 v5, s23, v5
  s_add_u32 s19, s19, s20
  s_cmp_eq_u32 s19, 86016
  s_waitcnt lgkmcnt(8)
  v_mfma_f32_16x16x32_bf16 v[140:143], v[100:103], v[92:95], v[140:143]
  s_cselect_b32 s23, s21, s20
  s_cselect_b32 s19, 0, s19
  v_mfma_f32_16x16x32_bf16 v[140:143], v[96:99], v[76:79], v[140:143]
  s_waitcnt lgkmcnt(4)
  v_mfma_f32_16x16x32_bf16 v[156:159], v[104:107], v[76:79], v[156:159]
  ds_read_b64_tr_b16 v[120:121], v9 offset:0
  v_mfma_f32_16x16x32_bf16 v[156:159], v[108:111], v[92:95], v[156:159]
  ds_read_b64_tr_b16 v[122:123], v9 offset:2048
  v_mfma_f32_16x16x32_bf16 v[152:155], v[108:111], v[88:91], v[152:155]
  ds_read_b64_tr_b16 v[124:125], v9 offset:4096
  v_mfma_f32_16x16x32_bf16 v[152:155], v[104:107], v[72:75], v[152:155]
  ds_read_b64_tr_b16 v[126:127], v9 offset:6144
  v_mfma_f32_16x16x32_bf16 v[148:151], v[104:107], v[68:71], v[148:151]
  s_sub_u32 s22, s22, 1
  s_cmp_lg_u32 s22, 0
  v_mfma_f32_16x16x32_bf16 v[148:151], v[108:111], v[84:87], v[148:151]
  v_mfma_f32_16x16x32_bf16 v[144:147], v[108:111], v[80:83], v[144:147]
  ds_read_b64_tr_b16 v[96:97], v6 offset:8192
  v_mfma_f32_16x16x32_bf16 v[144:147], v[104:107], v[64:67], v[144:147]
  ds_read_b64_tr_b16 v[98:99], v6 offset:10240
  s_nop 0
  s_waitcnt lgkmcnt(6)
  v_mfma_f32_16x16x32_bf16 v[160:163], v[112:115], v[64:67], v[160:163]
  ds_read_b64_tr_b16 v[100:101], v6 offset:12288
  v_mfma_f32_16x16x32_bf16 v[160:163], v[116:119], v[80:83], v[160:163]
  ds_read_b64_tr_b16 v[102:103], v6 offset:14336
  v_mfma_f32_16x16x32_bf16 v[164:167], v[116:119], v[84:87], v[164:167]
  v_mfma_f32_16x16x32_bf16 v[164:167], v[112:115], v[68:71], v[164:167]
  v_mfma_f32_16x16x32_bf16 v[168:171], v[112:115], v[72:75], v[168:171]
  ds_read_b64_tr_b16 v[104:105], v7 offset:8192
  v_mfma_f32_16x16x32_bf16 v[168:171], v[116:119], v[88:91], v[168:171]
  ds_read_b64_tr_b16 v[106:107], v7 offset:10240
  v_mfma_f32_16x16x32_bf16 v[172:175], v[116:119], v[92:95], v[172:175]
  ds_read_b64_tr_b16 v[108:109], v7 offset:12288
  v_mfma_f32_16x16x32_bf16 v[172:175], v[112:115], v[76:79], v[172:175]
  ds_read_b64_tr_b16 v[110:111], v7 offset:14336
  s_waitcnt lgkmcnt(8)
  v_mfma_f32_16x16x32_bf16 v[188:191], v[120:123], v[76:79], v[188:191]
  v_add_u32 v6, s23, v6
  v_add_u32_e64 v7, s23, v7
  v_mfma_f32_16x16x32_bf16 v[188:191], v[124:127], v[92:95], v[188:191]
  ds_read_b64_tr_b16 v[112:113], v10 offset:0
  v_mfma_f32_16x16x32_bf16 v[184:187], v[124:127], v[88:91], v[184:187]
  ds_read_b64_tr_b16 v[114:115], v10 offset:1024
  v_mfma_f32_16x16x32_bf16 v[184:187], v[120:123], v[72:75], v[184:187]
  ds_read_b64_tr_b16 v[116:117], v10 offset:2048
  v_mfma_f32_16x16x32_bf16 v[180:183], v[120:123], v[68:71], v[180:183]
  ds_read_b64_tr_b16 v[118:119], v10 offset:3072
  v_mfma_f32_16x16x32_bf16 v[180:183], v[124:127], v[84:87], v[180:183]
  v_add_u32 v8, s23, v8
  v_add_u32 v9, s23, v9
  v_mfma_f32_16x16x32_bf16 v[176:179], v[124:127], v[80:83], v[176:179]
  v_add_u32 v10, s23, v10
  v_mfma_f32_16x16x32_bf16 v[176:179], v[120:123], v[64:67], v[176:179]
  s_waitcnt lgkmcnt(0)
  s_barrier
  s_cbranch_scc0 Lk_24
  v_mfma_f32_16x16x32_bf16 v[192:195], v[96:99], v[64:67], v[192:195]
  ds_read_b128 v[32:35], v4 offset:0
  v_mfma_f32_16x16x32_bf16 v[192:195], v[100:103], v[80:83], v[192:195]
  ds_read_b128 v[48:51], v5 offset:0
  v_mfma_f32_16x16x32_bf16 v[196:199], v[100:103], v[84:87], v[196:199]
  v_mfma_f32_16x16x32_bf16 v[196:199], v[96:99], v[68:71], v[196:199]
  ds_read_b128 v[36:39], v4 offset:2048
  v_mfma_f32_16x16x32_bf16 v[200:203], v[96:99], v[72:75], v[200:203]
  ds_read_b128 v[52:55], v5 offset:2048
  v_mfma_f32_16x16x32_bf16 v[200:203], v[100:103], v[88:91], v[200:203]
  v_mfma_f32_16x16x32_bf16 v[204:207], v[100:103], v[92:95], v[204:207]
  ds_read_b128 v[40:43], v4 offset:4096
  v_mfma_f32_16x16x32_bf16 v[204:207], v[96:99], v[76:79], v[204:207]
  ds_read_b128 v[56:59], v5 offset:4096
  v_mfma_f32_16x16x32_bf16 v[220:223], v[104:107], v[76:79], v[220:223]
  ds_read_b64_tr_b16 v[96:97], v6 offset:0
  v_mfma_f32_16x16x32_bf16 v[220:223], v[108:111], v[92:95], v[220:223]
  ds_read_b64_tr_b16 v[98:99], v6 offset:2048
  v_mfma_f32_16x16x32_bf16 v[216:219], v[108:111], v[88:91], v[216:219]
  ds_read_b64_tr_b16 v[100:101], v6 offset:4096
  v_mfma_f32_16x16x32_bf16 v[216:219], v[104:107], v[72:75], v[216:219]
  ds_read_b64_tr_b16 v[102:103], v6 offset:6144
  v_mfma_f32_16x16x32_bf16 v[212:215], v[104:107], v[68:71], v[212:215]
  ds_read_b128 v[44:47], v4 offset:6144
  v_mfma_f32_16x16x32_bf16 v[212:215], v[108:111], v[84:87], v[212:215]
  v_mfma_f32_16x16x32_bf16 v[208:211], v[108:111], v[80:83], v[208:211]
  ds_read_b128 v[60:63], v5 offset:6144
  v_mfma_f32_16x16x32_bf16 v[208:211], v[104:107], v[64:67], v[208:211]
  v_mfma_f32_16x16x32_bf16 v[224:227], v[112:115], v[64:67], v[224:227]
  ds_read_b64_tr_b16 v[104:105], v7 offset:0
  v_mfma_f32_16x16x32_bf16 v[224:227], v[116:119], v[80:83], v[224:227]
  v_mfma_f32_16x16x32_bf16 v[228:231], v[116:119], v[84:87], v[228:231]
  ds_read_b64_tr_b16 v[106:107], v7 offset:2048
  v_mfma_f32_16x16x32_bf16 v[228:231], v[112:115], v[68:71], v[228:231]
  v_mfma_f32_16x16x32_bf16 v[232:235], v[112:115], v[72:75], v[232:235]
  ds_read_b64_tr_b16 v[108:109], v7 offset:4096
  v_mfma_f32_16x16x32_bf16 v[232:235], v[116:119], v[88:91], v[232:235]
  v_mfma_f32_16x16x32_bf16 v[236:239], v[116:119], v[92:95], v[236:239]
  ds_read_b64_tr_b16 v[110:111], v7 offset:6144
  s_waitcnt lgkmcnt(6)
  v_mfma_f32_16x16x32_bf16 v[236:239], v[112:115], v[76:79], v[236:239]
  s_branch Lk_22
Lk_24:
  v_mfma_f32_16x16x32_bf16 v[192:195], v[96:99], v[64:67], v[192:195]
  ds_read_b128 v[32:35], v3 offset:0
  s_mul_i32 s4, s85, 320
  v_mfma_f32_16x16x32_bf16 v[192:195], v[100:103], v[80:83], v[192:195]
  ds_read_b128 v[36:39], v3 offset:1024
  s_add_u32 s4, s4, 151552
  v_mfma_f32_16x16x32_bf16 v[196:199], v[100:103], v[84:87], v[196:199]
  ds_read_b128 v[40:43], v3 offset:64
  v_and_b32_e64 v2, 15, v1
  v_mfma_f32_16x16x32_bf16 v[196:199], v[96:99], v[68:71], v[196:199]
  ds_read_b128 v[44:47], v3 offset:1088
  v_lshl_add_u32 v7, v2, 2, s4
  v_mfma_f32_16x16x32_bf16 v[200:203], v[96:99], v[72:75], v[200:203]
  ds_read_b128 v[48:51], v3 offset:128
  v_mov_b32 v4, 0x409d30fc
  v_mfma_f32_16x16x32_bf16 v[200:203], v[100:103], v[88:91], v[200:203]
  ds_read_b128 v[52:55], v3 offset:1152
  v_mov_b32 v5, 0x3eeff558
  v_mfma_f32_16x16x32_bf16 v[204:207], v[100:103], v[92:95], v[204:207]
  ds_read_b128 v[56:59], v3 offset:192
  v_and_b32_e64 v2, 32, v1
  v_mfma_f32_16x16x32_bf16 v[204:207], v[96:99], v[76:79], v[204:207]
  ds_read_b128 v[60:63], v3 offset:1216
  v_mad_u32_u24 v6, v2, 48, v11
  v_mfma_f32_16x16x32_bf16 v[220:223], v[104:107], v[76:79], v[220:223]
  v_mfma_f32_16x16x32_bf16 v[220:223], v[108:111], v[92:95], v[220:223]
  ds_read2_b32 v[96:97], v7 offset0:0 offset1:160
  ds_read2_b32 v[98:99], v7 offset0:16 offset1:176
  v_mfma_f32_16x16x32_bf16 v[216:219], v[108:111], v[88:91], v[216:219]
  ds_read2_b32 v[100:101], v7 offset0:32 offset1:192
  ds_read2_b32 v[102:103], v7 offset0:48 offset1:208
  v_mfma_f32_16x16x32_bf16 v[216:219], v[104:107], v[72:75], v[216:219]
  s_lshl_b32 s5, s86, Lz1-Lz0+6
  s_add_u32 s5, s5, 154880
  v_mfma_f32_16x16x32_bf16 v[212:215], v[104:107], v[68:71], v[212:215]
  v_add_u32_e64 v2, s5, v29
  v_mfma_f32_16x16x32_bf16 v[212:215], v[108:111], v[84:87], v[212:215]
  v_mfma_f32_16x16x32_bf16 v[208:211], v[108:111], v[80:83], v[208:211]
  v_mfma_f32_16x16x32_bf16 v[208:211], v[104:107], v[64:67], v[208:211]
  v_mfma_f32_16x16x32_bf16 v[224:227], v[112:115], v[64:67], v[224:227]
  v_mfma_f32_16x16x32_bf16 v[224:227], v[116:119], v[80:83], v[224:227]
  v_mfma_f32_16x16x32_bf16 v[228:231], v[116:119], v[84:87], v[228:231]
  v_mfma_f32_16x16x32_bf16 v[228:231], v[112:115], v[68:71], v[228:231]
  s_waitcnt lgkmcnt(0)
  v_mul_f32 v96, v5, v96
  v_mul_f32_e64 v98, v5, v98
  v_mfma_f32_16x16x32_bf16 v[232:235], v[112:115], v[72:75], v[232:235]
  v_mul_f32 v100, v5, v100
  v_mul_f32 v102, v5, v102
  v_mfma_f32_16x16x32_bf16 v[232:235], v[116:119], v[88:91], v[232:235]
  v_mfma_f32_16x16x32_bf16 v[236:239], v[116:119], v[92:95], v[236:239]
  v_mfma_f32_16x16x32_bf16 v[236:239], v[112:115], v[76:79], v[236:239]
  ds_read_b128 v[80:83], v2 offset:0
  ds_read_b128 v[84:87], v2 offset:1024
  ds_read_b128 v[64:67], v3 offset:256
  ds_read_b128 v[68:71], v3 offset:1280
  ds_read_b128 v[72:75], v3 offset:320
  ds_read_b128 v[76:79], v3 offset:1344
  v_pk_fma_f32 v[128:129], v[32:33], v[96:97], v[128:129] op_sel:[0,1,0] op_sel_hi:[1,1,1] neg_lo:[0,1,0] neg_hi:[0,1,0]
  v_pk_fma_f32 v[130:131], v[34:35], v[96:97], v[130:131] op_sel:[0,1,0] op_sel_hi:[1,1,1] neg_lo:[0,1,0] neg_hi:[0,1,0]
  v_pk_fma_f32 v[144:145], v[40:41], v[96:97], v[144:145] op_sel:[0,1,0] op_sel_hi:[1,1,1] neg_lo:[0,1,0] neg_hi:[0,1,0]
  v_pk_fma_f32 v[146:147], v[42:43], v[96:97], v[146:147] op_sel:[0,1,0] op_sel_hi:[1,1,1] neg_lo:[0,1,0] neg_hi:[0,1,0]
  v_pk_fma_f32 v[128:129], v[128:129], v[96:97], v[36:37] op_sel:[0,0,0] op_sel_hi:[1,0,1]
  v_pk_fma_f32 v[130:131], v[130:131], v[96:97], v[38:39] op_sel:[0,0,0] op_sel_hi:[1,0,1]
  v_pk_fma_f32 v[144:145], v[144:145], v[96:97], v[44:45] op_sel:[0,0,0] op_sel_hi:[1,0,1]
  v_pk_fma_f32 v[146:147], v[146:147], v[96:97], v[46:47] op_sel:[0,0,0] op_sel_hi:[1,0,1]
  v_pk_fma_f32 v[104:105], v[128:129], v[128:129], v[4:5] op_sel_hi:[1,1,0]
  v_pk_fma_f32 v[106:107], v[130:131], v[130:131], v[4:5] op_sel_hi:[1,1,0]
  v_pk_fma_f32 v[108:109], v[144:145], v[144:145], v[4:5] op_sel_hi:[1,1,0]
  v_pk_fma_f32 v[110:111], v[146:147], v[146:147], v[4:5] op_sel_hi:[1,1,0]
  v_pk_mul_f32 v[104:105], v[104:105], v[128:129] neg_lo:[0,1] neg_hi:[0,1]
  v_pk_mul_f32 v[106:107], v[106:107], v[130:131] neg_lo:[0,1] neg_hi:[0,1]
  v_pk_mul_f32 v[108:109], v[108:109], v[144:145] neg_lo:[0,1] neg_hi:[0,1]
  v_pk_mul_f32 v[110:111], v[110:111], v[146:147] neg_lo:[0,1] neg_hi:[0,1]
  v_exp_f32 v104, v104
  v_exp_f32 v105, v105
  v_exp_f32 v106, v106
  v_exp_f32 v107, v107
  v_exp_f32 v108, v108
  v_exp_f32 v109, v109
  v_exp_f32 v110, v110
  v_exp_f32 v111, v111
  v_pk_fma_f32 v[104:105], v[104:105], v[4:5], v[4:5] op_sel:[0,1,1] op_sel_hi:[1,1,1]
  v_pk_fma_f32 v[106:107], v[106:107], v[4:5], v[4:5] op_sel:[0,1,1] op_sel_hi:[1,1,1]
  v_pk_fma_f32 v[108:109], v[108:109], v[4:5], v[4:5] op_sel:[0,1,1] op_sel_hi:[1,1,1]
  v_pk_fma_f32 v[110:111], v[110:111], v[4:5], v[4:5] op_sel:[0,1,1] op_sel_hi:[1,1,1]
  v_rcp_f32 v104, v104
  v_rcp_f32 v105, v105
  v_rcp_f32 v106, v106
  v_rcp_f32 v107, v107
  v_rcp_f32 v108, v108
  v_rcp_f32 v109, v109
  v_rcp_f32 v110, v110
  v_rcp_f32 v111, v111
  v_pk_mul_f32 v[128:129], v[128:129], v[104:105]
  v_pk_mul_f32 v[130:131], v[130:131], v[106:107]
  v_pk_mul_f32 v[144:145], v[144:145], v[108:109]
  v_pk_mul_f32 v[146:147], v[146:147], v[110:111]
  v_cvt_pk_bf16_f32 v116, v128, v129
  v_cvt_pk_bf16_f32 v117, v130, v131
  v_cvt_pk_bf16_f32 v118, v144, v145
  v_cvt_pk_bf16_f32 v119, v146, v147
  buffer_store_dwordx4 v[116:119], v0, s[40:43], s6 offen offset:0 sc0 sc1
  ds_write_b128 v0, v[116:119] offset:0
  v_pk_fma_f32 v[132:133], v[32:33], v[98:99], v[132:133] op_sel:[0,1,0] op_sel_hi:[1,1,1] neg_lo:[0,1,0] neg_hi:[0,1,0]
  v_pk_fma_f32 v[134:135], v[34:35], v[98:99], v[134:135] op_sel:[0,1,0] op_sel_hi:[1,1,1] neg_lo:[0,1,0] neg_hi:[0,1,0]
  v_pk_fma_f32 v[148:149], v[40:41], v[98:99], v[148:149] op_sel:[0,1,0] op_sel_hi:[1,1,1] neg_lo:[0,1,0] neg_hi:[0,1,0]
  v_pk_fma_f32 v[150:151], v[42:43], v[98:99], v[150:151] op_sel:[0,1,0] op_sel_hi:[1,1,1] neg_lo:[0,1,0] neg_hi:[0,1,0]
  v_pk_fma_f32 v[132:133], v[132:133], v[98:99], v[36:37] op_sel:[0,0,0] op_sel_hi:[1,0,1]
  v_pk_fma_f32 v[134:135], v[134:135], v[98:99], v[38:39] op_sel:[0,0,0] op_sel_hi:[1,0,1]
  v_pk_fma_f32 v[148:149], v[148:149], v[98:99], v[44:45] op_sel:[0,0,0] op_sel_hi:[1,0,1]
  v_pk_fma_f32 v[150:151], v[150:151], v[98:99], v[46:47] op_sel:[0,0,0] op_sel_hi:[1,0,1]
  v_pk_fma_f32 v[104:105], v[132:133], v[132:133], v[4:5] op_sel_hi:[1,1,0]
  v_pk_fma_f32 v[106:107], v[134:135], v[134:135], v[4:5] op_sel_hi:[1,1,0]
  v_pk_fma_f32 v[108:109], v[148:149], v[148:149], v[4:5] op_sel_hi:[1,1,0]
  v_pk_fma_f32 v[110:111], v[150:151], v[150:151], v[4:5] op_sel_hi:[1,1,0]
  v_pk_mul_f32 v[104:105], v[104:105], v[132:133] neg_lo:[0,1] neg_hi:[0,1]
  v_pk_mul_f32 v[106:107], v[106:107], v[134:135] neg_lo:[0,1] neg_hi:[0,1]
  v_pk_mul_f32 v[108:109], v[108:109], v[148:149] neg_lo:[0,1] neg_hi:[0,1]
  v_pk_mul_f32 v[110:111], v[110:111], v[150:151] neg_lo:[0,1] neg_hi:[0,1]
  v_exp_f32 v104, v104
  v_exp_f32 v105, v105
  v_exp_f32 v106, v106
  v_exp_f32 v107, v107
  v_exp_f32 v108, v108
  v_exp_f32 v109, v109
  v_exp_f32 v110, v110
  v_exp_f32 v111, v111
  v_pk_fma_f32 v[104:105], v[104:105], v[4:5], v[4:5] op_sel:[0,1,1] op_sel_hi:[1,1,1]
  v_pk_fma_f32 v[106:107], v[106:107], v[4:5], v[4:5] op_sel:[0,1,1] op_sel_hi:[1,1,1]
  v_pk_fma_f32 v[108:109], v[108:109], v[4:5], v[4:5] op_sel:[0,1,1] op_sel_hi:[1,1,1]
  v_pk_fma_f32 v[110:111], v[110:111], v[4:5], v[4:5] op_sel:[0,1,1] op_sel_hi:[1,1,1]
  v_rcp_f32 v104, v104
  v_rcp_f32 v105, v105
  v_rcp_f32 v106, v106
  v_rcp_f32 v107, v107
  v_rcp_f32 v108, v108
  v_rcp_f32 v109, v109
  v_rcp_f32 v110, v110
  v_rcp_f32 v111, v111
  v_pk_mul_f32 v[132:133], v[132:133], v[104:105]
  v_pk_mul_f32 v[134:135], v[134:135], v[106:107]
  v_pk_mul_f32 v[148:149], v[148:149], v[108:109]
  v_pk_mul_f32 v[150:151], v[150:151], v[110:111]
  v_cvt_pk_bf16_f32 v120, v132, v133
  v_cvt_pk_bf16_f32 v121, v134, v135
  v_cvt_pk_bf16_f32 v122, v148, v149
  v_cvt_pk_bf16_f32 v123, v150, v151
  buffer_store_dwordx4 v[120:123], v0, s[40:43], s6 offen offset:2048 sc0 sc1
  ds_write_b128 v0, v[120:123] offset:2048
  s_add_u32 s6, s6, 0x20000
  v_pk_fma_f32 v[136:137], v[32:33], v[100:101], v[136:137] op_sel:[0,1,0] op_sel_hi:[1,1,1] neg_lo:[0,1,0] neg_hi:[0,1,0]
  v_pk_fma_f32 v[138:139], v[34:35], v[100:101], v[138:139] op_sel:[0,1,0] op_sel_hi:[1,1,1] neg_lo:[0,1,0] neg_hi:[0,1,0]
  v_pk_fma_f32 v[152:153], v[40:41], v[100:101], v[152:153] op_sel:[0,1,0] op_sel_hi:[1,1,1] neg_lo:[0,1,0] neg_hi:[0,1,0]
  v_pk_fma_f32 v[154:155], v[42:43], v[100:101], v[154:155] op_sel:[0,1,0] op_sel_hi:[1,1,1] neg_lo:[0,1,0] neg_hi:[0,1,0]
  v_pk_fma_f32 v[136:137], v[136:137], v[100:101], v[36:37] op_sel:[0,0,0] op_sel_hi:[1,0,1]
  v_pk_fma_f32 v[138:139], v[138:139], v[100:101], v[38:39] op_sel:[0,0,0] op_sel_hi:[1,0,1]
  v_pk_fma_f32 v[152:153], v[152:153], v[100:101], v[44:45] op_sel:[0,0,0] op_sel_hi:[1,0,1]
  v_pk_fma_f32 v[154:155], v[154:155], v[100:101], v[46:47] op_sel:[0,0,0] op_sel_hi:[1,0,1]
  v_pk_fma_f32 v[104:105], v[136:137], v[136:137], v[4:5] op_sel_hi:[1,1,0]
  v_pk_fma_f32 v[106:107], v[138:139], v[138:139], v[4:5] op_sel_hi:[1,1,0]
  v_pk_fma_f32 v[108:109], v[152:153], v[152:153], v[4:5] op_sel_hi:[1,1,0]
  v_pk_fma_f32 v[110:111], v[154:155], v[154:155], v[4:5] op_sel_hi:[1,1,0]
  v_pk_mul_f32 v[104:105], v[104:105], v[136:137] neg_lo:[0,1] neg_hi:[0,1]
  v_pk_mul_f32 v[106:107], v[106:107], v[138:139] neg_lo:[0,1] neg_hi:[0,1]
  v_pk_mul_f32 v[108:109], v[108:109], v[152:153] neg_lo:[0,1] neg_hi:[0,1]
  v_pk_mul_f32 v[110:111], v[110:111], v[154:155] neg_lo:[0,1] neg_hi:[0,1]
  v_exp_f32 v104, v104
  v_exp_f32 v105, v105
  v_exp_f32 v106, v106
  v_exp_f32 v107, v107
  v_exp_f32 v108, v108
  v_exp_f32 v109, v109
  v_exp_f32 v110, v110
  v_exp_f32 v111, v111
  v_pk_fma_f32 v[104:105], v[104:105], v[4:5], v[4:5] op_sel:[0,1,1] op_sel_hi:[1,1,1]
  v_pk_fma_f32 v[106:107], v[106:107], v[4:5], v[4:5] op_sel:[0,1,1] op_sel_hi:[1,1,1]
  v_pk_fma_f32 v[108:109], v[108:109], v[4:5], v[4:5] op_sel:[0,1,1] op_sel_hi:[1,1,1]
  v_pk_fma_f32 v[110:111], v[110:111], v[4:5], v[4:5] op_sel:[0,1,1] op_sel_hi:[1,1,1]
  v_rcp_f32 v104, v104
  v_rcp_f32 v105, v105
  v_rcp_f32 v106, v106
  v_rcp_f32 v107, v107
  v_rcp_f32 v108, v108
  v_rcp_f32 v109, v109
  v_rcp_f32 v110, v110
  v_rcp_f32 v111, v111
  v_pk_mul_f32 v[136:137], v[136:137], v[104:105]
  v_pk_mul_f32 v[138:139], v[138:139], v[106:107]
  v_pk_mul_f32 v[152:153], v[152:153], v[108:109]
  v_pk_mul_f32 v[154:155], v[154:155], v[110:111]
  v_cvt_pk_bf16_f32 v116, v136, v137
  v_cvt_pk_bf16_f32 v117, v138, v139
  v_cvt_pk_bf16_f32 v118, v152, v153
  v_cvt_pk_bf16_f32 v119, v154, v155
  buffer_store_dwordx4 v[116:119], v0, s[40:43], s7 offen offset:0 sc0 sc1
  ds_write_b128 v0, v[116:119] offset:4096
  v_pk_fma_f32 v[140:141], v[32:33], v[102:103], v[140:141] op_sel:[0,1,0] op_sel_hi:[1,1,1] neg_lo:[0,1,0] neg_hi:[0,1,0]
  v_pk_fma_f32 v[142:143], v[34:35], v[102:103], v[142:143] op_sel:[0,1,0] op_sel_hi:[1,1,1] neg_lo:[0,1,0] neg_hi:[0,1,0]
  v_pk_fma_f32 v[156:157], v[40:41], v[102:103], v[156:157] op_sel:[0,1,0] op_sel_hi:[1,1,1] neg_lo:[0,1,0] neg_hi:[0,1,0]
  v_pk_fma_f32 v[158:159], v[42:43], v[102:103], v[158:159] op_sel:[0,1,0] op_sel_hi:[1,1,1] neg_lo:[0,1,0] neg_hi:[0,1,0]
  v_pk_fma_f32 v[140:141], v[140:141], v[102:103], v[36:37] op_sel:[0,0,0] op_sel_hi:[1,0,1]
  v_pk_fma_f32 v[142:143], v[142:143], v[102:103], v[38:39] op_sel:[0,0,0] op_sel_hi:[1,0,1]
  v_pk_fma_f32 v[156:157], v[156:157], v[102:103], v[44:45] op_sel:[0,0,0] op_sel_hi:[1,0,1]
  v_pk_fma_f32 v[158:159], v[158:159], v[102:103], v[46:47] op_sel:[0,0,0] op_sel_hi:[1,0,1]
  v_pk_fma_f32 v[104:105], v[140:141], v[140:141], v[4:5] op_sel_hi:[1,1,0]
  v_pk_fma_f32 v[106:107], v[142:143], v[142:143], v[4:5] op_sel_hi:[1,1,0]
  v_pk_fma_f32 v[108:109], v[156:157], v[156:157], v[4:5] op_sel_hi:[1,1,0]
  v_pk_fma_f32 v[110:111], v[158:159], v[158:159], v[4:5] op_sel_hi:[1,1,0]
  v_pk_mul_f32 v[104:105], v[104:105], v[140:141] neg_lo:[0,1] neg_hi:[0,1]
  v_pk_mul_f32 v[106:107], v[106:107], v[142:143] neg_lo:[0,1] neg_hi:[0,1]
  v_pk_mul_f32 v[108:109], v[108:109], v[156:157] neg_lo:[0,1] neg_hi:[0,1]
  v_pk_mul_f32 v[110:111], v[110:111], v[158:159] neg_lo:[0,1] neg_hi:[0,1]
  v_exp_f32 v104, v104
  v_exp_f32 v105, v105
  v_exp_f32 v106, v106
  v_exp_f32 v107, v107
  v_exp_f32 v108, v108
  v_exp_f32 v109, v109
  v_exp_f32 v110, v110
  v_exp_f32 v111, v111
  v_pk_fma_f32 v[104:105], v[104:105], v[4:5], v[4:5] op_sel:[0,1,1] op_sel_hi:[1,1,1]
  v_pk_fma_f32 v[106:107], v[106:107], v[4:5], v[4:5] op_sel:[0,1,1] op_sel_hi:[1,1,1]
  v_pk_fma_f32 v[108:109], v[108:109], v[4:5], v[4:5] op_sel:[0,1,1] op_sel_hi:[1,1,1]
  v_pk_fma_f32 v[110:111], v[110:111], v[4:5], v[4:5] op_sel:[0,1,1] op_sel_hi:[1,1,1]
  v_rcp_f32 v104, v104
  v_rcp_f32 v105, v105
  v_rcp_f32 v106, v106
  v_rcp_f32 v107, v107
  v_rcp_f32 v108, v108
  v_rcp_f32 v109, v109
  v_rcp_f32 v110, v110
  v_rcp_f32 v111, v111
  v_pk_mul_f32 v[140:141], v[140:141], v[104:105]
  v_pk_mul_f32 v[142:143], v[142:143], v[106:107]
  v_pk_mul_f32 v[156:157], v[156:157], v[108:109]
  v_pk_mul_f32 v[158:159], v[158:159], v[110:111]
  v_cvt_pk_bf16_f32 v120, v140, v141
  v_cvt_pk_bf16_f32 v121, v142, v143
  v_cvt_pk_bf16_f32 v122, v156, v157
  v_cvt_pk_bf16_f32 v123, v158, v159
  buffer_store_dwordx4 v[120:123], v0, s[40:43], s7 offen offset:2048 sc0 sc1
  ds_write_b128 v0, v[120:123] offset:6144
  s_add_u32 s7, s7, 0x20000
  s_nop 0
  s_waitcnt lgkmcnt(0)
  v_pk_fma_f32 v[224:225], v[80:81], v[96:97], v[224:225] op_sel:[0,1,0] op_sel_hi:[1,1,1] neg_lo:[0,1,0] neg_hi:[0,1,0]
  v_pk_fma_f32 v[226:227], v[82:83], v[96:97], v[226:227] op_sel:[0,1,0] op_sel_hi:[1,1,1] neg_lo:[0,1,0] neg_hi:[0,1,0]
  v_pk_fma_f32 v[228:229], v[80:81], v[98:99], v[228:229] op_sel:[0,1,0] op_sel_hi:[1,1,1] neg_lo:[0,1,0] neg_hi:[0,1,0]
  v_pk_fma_f32 v[230:231], v[82:83], v[98:99], v[230:231] op_sel:[0,1,0] op_sel_hi:[1,1,1] neg_lo:[0,1,0] neg_hi:[0,1,0]
  v_pk_fma_f32 v[224:225], v[224:225], v[96:97], v[84:85] op_sel:[0,0,0] op_sel_hi:[1,0,1]
  v_pk_fma_f32 v[226:227], v[226:227], v[96:97], v[86:87] op_sel:[0,0,0] op_sel_hi:[1,0,1]
  v_pk_fma_f32 v[228:229], v[228:229], v[98:99], v[84:85] op_sel:[0,0,0] op_sel_hi:[1,0,1]
  v_pk_fma_f32 v[230:231], v[230:231], v[98:99], v[86:87] op_sel:[0,0,0] op_sel_hi:[1,0,1]
  v_pk_fma_f32 v[104:105], v[224:225], v[224:225], v[4:5] op_sel_hi:[1,1,0]
  v_pk_fma_f32 v[106:107], v[226:227], v[226:227], v[4:5] op_sel_hi:[1,1,0]
  v_pk_fma_f32 v[108:109], v[228:229], v[228:229], v[4:5] op_sel_hi:[1,1,0]
  v_pk_fma_f32 v[110:111], v[230:231], v[230:231], v[4:5] op_sel_hi:[1,1,0]
  v_pk_mul_f32 v[104:105], v[104:105], v[224:225] neg_lo:[0,1] neg_hi:[0,1]
  v_pk_mul_f32 v[106:107], v[106:107], v[226:227] neg_lo:[0,1] neg_hi:[0,1]
  v_pk_mul_f32 v[108:109], v[108:109], v[228:229] neg_lo:[0,1] neg_hi:[0,1]
  v_pk_mul_f32 v[110:111], v[110:111], v[230:231] neg_lo:[0,1] neg_hi:[0,1]
  v_exp_f32 v104, v104
  v_exp_f32 v105, v105
  v_exp_f32 v106, v106
  v_exp_f32 v107, v107
  v_exp_f32 v108, v108
  v_exp_f32 v109, v109
  v_exp_f32 v110, v110
  v_exp_f32 v111, v111
  v_pk_fma_f32 v[104:105], v[104:105], v[4:5], v[4:5] op_sel:[0,1,1] op_sel_hi:[1,1,1]
  v_pk_fma_f32 v[106:107], v[106:107], v[4:5], v[4:5] op_sel:[0,1,1] op_sel_hi:[1,1,1]
  v_pk_fma_f32 v[108:109], v[108:109], v[4:5], v[4:5] op_sel:[0,1,1] op_sel_hi:[1,1,1]
  v_pk_fma_f32 v[110:111], v[110:111], v[4:5], v[4:5] op_sel:[0,1,1] op_sel_hi:[1,1,1]
  v_rcp_f32 v104, v104
  v_rcp_f32 v105, v105
  v_rcp_f32 v106, v106
  v_rcp_f32 v107, v107
  v_rcp_f32 v108, v108
  v_rcp_f32 v109, v109
  v_rcp_f32 v110, v110
  v_rcp_f32 v111, v111
  v_pk_mul_f32 v[224:225], v[224:225], v[104:105]
  v_pk_mul_f32 v[226:227], v[226:227], v[106:107]
  v_pk_mul_f32 v[228:229], v[228:229], v[108:109]
  v_pk_mul_f32 v[230:231], v[230:231], v[110:111]
  v_cvt_pk_bf16_f32 v116, v224, v225
  v_cvt_pk_bf16_f32 v117, v226, v227
  v_cvt_pk_bf16_f32 v118, v228, v229
  v_cvt_pk_bf16_f32 v119, v230, v231
  s_nop 0
  v_permlane32_swap_b32 v116, v118
  v_permlane32_swap_b32_e64 v117, v119
  buffer_store_dwordx4 v[116:119], v6, s[40:43], s8 offen sc0 sc1
  s_add_u32 s8, s8, 4096
  v_pk_fma_f32 v[232:233], v[80:81], v[100:101], v[232:233] op_sel:[0,1,0] op_sel_hi:[1,1,1] neg_lo:[0,1,0] neg_hi:[0,1,0]
  v_pk_fma_f32 v[234:235], v[82:83], v[100:101], v[234:235] op_sel:[0,1,0] op_sel_hi:[1,1,1] neg_lo:[0,1,0] neg_hi:[0,1,0]
  v_pk_fma_f32 v[236:237], v[80:81], v[102:103], v[236:237] op_sel:[0,1,0] op_sel_hi:[1,1,1] neg_lo:[0,1,0] neg_hi:[0,1,0]
  v_pk_fma_f32 v[238:239], v[82:83], v[102:103], v[238:239] op_sel:[0,1,0] op_sel_hi:[1,1,1] neg_lo:[0,1,0] neg_hi:[0,1,0]
  v_pk_fma_f32 v[232:233], v[232:233], v[100:101], v[84:85] op_sel:[0,0,0] op_sel_hi:[1,0,1]
  v_pk_fma_f32 v[234:235], v[234:235], v[100:101], v[86:87] op_sel:[0,0,0] op_sel_hi:[1,0,1]
  v_pk_fma_f32 v[236:237], v[236:237], v[102:103], v[84:85] op_sel:[0,0,0] op_sel_hi:[1,0,1]
  v_pk_fma_f32 v[238:239], v[238:239], v[102:103], v[86:87] op_sel:[0,0,0] op_sel_hi:[1,0,1]
  v_pk_fma_f32 v[104:105], v[232:233], v[232:233], v[4:5] op_sel_hi:[1,1,0]
  v_pk_fma_f32 v[106:107], v[234:235], v[234:235], v[4:5] op_sel_hi:[1,1,0]
  v_pk_fma_f32 v[108:109], v[236:237], v[236:237], v[4:5] op_sel_hi:[1,1,0]
  v_pk_fma_f32 v[110:111], v[238:239], v[238:239], v[4:5] op_sel_hi:[1,1,0]
  v_pk_mul_f32 v[104:105], v[104:105], v[232:233] neg_lo:[0,1] neg_hi:[0,1]
  v_pk_mul_f32 v[106:107], v[106:107], v[234:235] neg_lo:[0,1] neg_hi:[0,1]
  v_pk_mul_f32 v[108:109], v[108:109], v[236:237] neg_lo:[0,1] neg_hi:[0,1]
  v_pk_mul_f32 v[110:111], v[110:111], v[238:239] neg_lo:[0,1] neg_hi:[0,1]
  v_exp_f32 v104, v104
  v_exp_f32 v105, v105
  v_exp_f32 v106, v106
  v_exp_f32 v107, v107
  v_exp_f32 v108, v108
  v_exp_f32 v109, v109
  v_exp_f32 v110, v110
  v_exp_f32 v111, v111
  v_pk_fma_f32 v[104:105], v[104:105], v[4:5], v[4:5] op_sel:[0,1,1] op_sel_hi:[1,1,1]
  v_pk_fma_f32 v[106:107], v[106:107], v[4:5], v[4:5] op_sel:[0,1,1] op_sel_hi:[1,1,1]
  v_pk_fma_f32 v[108:109], v[108:109], v[4:5], v[4:5] op_sel:[0,1,1] op_sel_hi:[1,1,1]
  v_pk_fma_f32 v[110:111], v[110:111], v[4:5], v[4:5] op_sel:[0,1,1] op_sel_hi:[1,1,1]
  v_rcp_f32 v104, v104
  v_rcp_f32 v105, v105
  v_rcp_f32 v106, v106
  v_rcp_f32 v107, v107
  v_rcp_f32 v108, v108
  v_rcp_f32 v109, v109
  v_rcp_f32 v110, v110
  v_rcp_f32 v111, v111
  v_pk_mul_f32 v[232:233], v[232:233], v[104:105]
  v_pk_mul_f32 v[234:235], v[234:235], v[106:107]
  v_pk_mul_f32 v[236:237], v[236:237], v[108:109]
  v_pk_mul_f32 v[238:239], v[238:239], v[110:111]
  v_cvt_pk_bf16_f32 v120, v232, v233
  v_cvt_pk_bf16_f32 v121, v234, v235
  v_cvt_pk_bf16_f32 v122, v236, v237
  v_cvt_pk_bf16_f32 v123, v238, v239
  s_add_u32 s9, s87, Lz1-Lz0+8
  s_waitcnt vmcnt(1)
  s_mov_b64 exec, 1
  ds_add_rtn_u32 v124, v28, v27 offset:0
  s_mov_b64 exec, -1
  v_permlane32_swap_b32 v120, v122
  v_permlane32_swap_b32_e64 v121, v123
  buffer_store_dwordx4 v[120:123], v6, s[40:43], s8 offen sc0 sc1
  v_pk_fma_f32 v[160:161], v[48:49], v[96:97], v[160:161] op_sel:[0,1,0] op_sel_hi:[1,1,1] neg_lo:[0,1,0] neg_hi:[0,1,0]
  v_pk_fma_f32 v[162:163], v[50:51], v[96:97], v[162:163] op_sel:[0,1,0] op_sel_hi:[1,1,1] neg_lo:[0,1,0] neg_hi:[0,1,0]
  v_pk_fma_f32 v[176:177], v[56:57], v[96:97], v[176:177] op_sel:[0,1,0] op_sel_hi:[1,1,1] neg_lo:[0,1,0] neg_hi:[0,1,0]
  v_pk_fma_f32 v[178:179], v[58:59], v[96:97], v[178:179] op_sel:[0,1,0] op_sel_hi:[1,1,1] neg_lo:[0,1,0] neg_hi:[0,1,0]
  v_pk_fma_f32 v[160:161], v[160:161], v[96:97], v[52:53] op_sel:[0,0,0] op_sel_hi:[1,0,1]
  v_pk_fma_f32 v[162:163], v[162:163], v[96:97], v[54:55] op_sel:[0,0,0] op_sel_hi:[1,0,1]
  v_pk_fma_f32 v[176:177], v[176:177], v[96:97], v[60:61] op_sel:[0,0,0] op_sel_hi:[1,0,1]
  v_pk_fma_f32 v[178:179], v[178:179], v[96:97], v[62:63] op_sel:[0,0,0] op_sel_hi:[1,0,1]
  v_pk_fma_f32 v[104:105], v[160:161], v[160:161], v[4:5] op_sel_hi:[1,1,0]
  v_pk_fma_f32 v[106:107], v[162:163], v[162:163], v[4:5] op_sel_hi:[1,1,0]
  v_pk_fma_f32 v[108:109], v[176:177], v[176:177], v[4:5] op_sel_hi:[1,1,0]
  v_pk_fma_f32 v[110:111], v[178:179], v[178:179], v[4:5] op_sel_hi:[1,1,0]
  v_pk_mul_f32 v[104:105], v[104:105], v[160:161] neg_lo:[0,1] neg_hi:[0,1]
  v_pk_mul_f32 v[106:107], v[106:107], v[162:163] neg_lo:[0,1] neg_hi:[0,1]
  v_pk_mul_f32 v[108:109], v[108:109], v[176:177] neg_lo:[0,1] neg_hi:[0,1]
  v_pk_mul_f32 v[110:111], v[110:111], v[178:179] neg_lo:[0,1] neg_hi:[0,1]
  v_exp_f32 v104, v104
  v_exp_f32 v105, v105
  v_exp_f32 v106, v106
  v_exp_f32 v107, v107
  v_exp_f32 v108, v108
  v_exp_f32 v109, v109
  v_exp_f32 v110, v110
  v_exp_f32 v111, v111
  v_pk_fma_f32 v[104:105], v[104:105], v[4:5], v[4:5] op_sel:[0,1,1] op_sel_hi:[1,1,1]
  v_pk_fma_f32 v[106:107], v[106:107], v[4:5], v[4:5] op_sel:[0,1,1] op_sel_hi:[1,1,1]
  v_pk_fma_f32 v[108:109], v[108:109], v[4:5], v[4:5] op_sel:[0,1,1] op_sel_hi:[1,1,1]
  v_pk_fma_f32 v[110:111], v[110:111], v[4:5], v[4:5] op_sel:[0,1,1] op_sel_hi:[1,1,1]
  v_rcp_f32 v104, v104
  v_rcp_f32 v105, v105
  v_rcp_f32 v106, v106
  v_rcp_f32 v107, v107
  v_rcp_f32 v108, v108
  v_rcp_f32 v109, v109
  v_rcp_f32 v110, v110
  v_rcp_f32 v111, v111
  v_pk_mul_f32 v[160:161], v[160:161], v[104:105]
  v_pk_mul_f32 v[162:163], v[162:163], v[106:107]
  v_pk_mul_f32 v[176:177], v[176:177], v[108:109]
  v_pk_mul_f32 v[178:179], v[178:179], v[110:111]
  v_cvt_pk_bf16_f32 v116, v160, v161
  v_cvt_pk_bf16_f32 v117, v162, v163
  v_cvt_pk_bf16_f32 v118, v176, v177
  v_cvt_pk_bf16_f32 v119, v178, v179
  s_waitcnt lgkmcnt(0)
  v_readfirstlane_b32 s4, v124
  s_and_b32 s4, s4, 3
  s_cmp_lg_u32 s4, 3
  s_cbranch_scc1 Ls_28
  s_mov_b32 exec_lo, s10
  s_mov_b32 exec_hi, 0
  buffer_store_dword v27, v24, s[40:43], s9 offen sc0 sc1
Ls_28:
  s_mov_b64 exec, -1
  buffer_store_dwordx4 v[116:119], v0, s[40:43], s6 offen offset:0 sc0 sc1
  ds_write_b128 v0, v[116:119] offset:16384
  v_pk_fma_f32 v[164:165], v[48:49], v[98:99], v[164:165] op_sel:[0,1,0] op_sel_hi:[1,1,1] neg_lo:[0,1,0] neg_hi:[0,1,0]
  v_pk_fma_f32 v[166:167], v[50:51], v[98:99], v[166:167] op_sel:[0,1,0] op_sel_hi:[1,1,1] neg_lo:[0,1,0] neg_hi:[0,1,0]
  v_pk_fma_f32 v[180:181], v[56:57], v[98:99], v[180:181] op_sel:[0,1,0] op_sel_hi:[1,1,1] neg_lo:[0,1,0] neg_hi:[0,1,0]
  v_pk_fma_f32 v[182:183], v[58:59], v[98:99], v[182:183] op_sel:[0,1,0] op_sel_hi:[1,1,1] neg_lo:[0,1,0] neg_hi:[0,1,0]
  v_pk_fma_f32 v[164:165], v[164:165], v[98:99], v[52:53] op_sel:[0,0,0] op_sel_hi:[1,0,1]
  v_pk_fma_f32 v[166:167], v[166:167], v[98:99], v[54:55] op_sel:[0,0,0] op_sel_hi:[1,0,1]
  v_pk_fma_f32 v[180:181], v[180:181], v[98:99], v[60:61] op_sel:[0,0,0] op_sel_hi:[1,0,1]
  v_pk_fma_f32 v[182:183], v[182:183], v[98:99], v[62:63] op_sel:[0,0,0] op_sel_hi:[1,0,1]
  v_pk_fma_f32 v[104:105], v[164:165], v[164:165], v[4:5] op_sel_hi:[1,1,0]
  v_pk_fma_f32 v[106:107], v[166:167], v[166:167], v[4:5] op_sel_hi:[1,1,0]
  v_pk_fma_f32 v[108:109], v[180:181], v[180:181], v[4:5] op_sel_hi:[1,1,0]
  v_pk_fma_f32 v[110:111], v[182:183], v[182:183], v[4:5] op_sel_hi:[1,1,0]
  v_pk_mul_f32 v[104:105], v[104:105], v[164:165] neg_lo:[0,1] neg_hi:[0,1]
  v_pk_mul_f32 v[106:107], v[106:107], v[166:167] neg_lo:[0,1] neg_hi:[0,1]
  v_pk_mul_f32 v[108:109], v[108:109], v[180:181] neg_lo:[0,1] neg_hi:[0,1]
  v_pk_mul_f32 v[110:111], v[110:111], v[182:183] neg_lo:[0,1] neg_hi:[0,1]
  v_exp_f32 v104, v104
  v_exp_f32 v105, v105
  v_exp_f32 v106, v106
  v_exp_f32 v107, v107
  v_exp_f32 v108, v108
  v_exp_f32 v109, v109
  v_exp_f32 v110, v110
  v_exp_f32 v111, v111
  v_pk_fma_f32 v[104:105], v[104:105], v[4:5], v[4:5] op_sel:[0,1,1] op_sel_hi:[1,1,1]
  v_pk_fma_f32 v[106:107], v[106:107], v[4:5], v[4:5] op_sel:[0,1,1] op_sel_hi:[1,1,1]
  v_pk_fma_f32 v[108:109], v[108:109], v[4:5], v[4:5] op_sel:[0,1,1] op_sel_hi:[1,1,1]
  v_pk_fma_f32 v[110:111], v[110:111], v[4:5], v[4:5] op_sel:[0,1,1] op_sel_hi:[1,1,1]
  v_rcp_f32 v104, v104
  v_rcp_f32 v105, v105
  v_rcp_f32 v106, v106
  v_rcp_f32 v107, v107
  v_rcp_f32 v108, v108
  v_rcp_f32 v109, v109
  v_rcp_f32 v110, v110
  v_rcp_f32 v111, v111
  v_pk_mul_f32 v[164:165], v[164:165], v[104:105]
  v_pk_mul_f32 v[166:167], v[166:167], v[106:107]
  v_pk_mul_f32 v[180:181], v[180:181], v[108:109]
  v_pk_mul_f32 v[182:183], v[182:183], v[110:111]
  v_cvt_pk_bf16_f32 v120, v164, v165
  v_cvt_pk_bf16_f32 v121, v166, v167
  v_cvt_pk_bf16_f32 v122, v180, v181
  v_cvt_pk_bf16_f32 v123, v182, v183
  buffer_store_dwordx4 v[120:123], v0, s[40:43], s6 offen offset:2048 sc0 sc1
  ds_write_b128 v0, v[120:123] offset:18432
  s_add_u32 s6, s6, 0x20000
  v_pk_fma_f32 v[168:169], v[48:49], v[100:101], v[168:169] op_sel:[0,1,0] op_sel_hi:[1,1,1] neg_lo:[0,1,0] neg_hi:[0,1,0]
  v_pk_fma_f32 v[170:171], v[50:51], v[100:101], v[170:171] op_sel:[0,1,0] op_sel_hi:[1,1,1] neg_lo:[0,1,0] neg_hi:[0,1,0]
  v_pk_fma_f32 v[184:185], v[56:57], v[100:101], v[184:185] op_sel:[0,1,0] op_sel_hi:[1,1,1] neg_lo:[0,1,0] neg_hi:[0,1,0]
  v_pk_fma_f32 v[186:187], v[58:59], v[100:101], v[186:187] op_sel:[0,1,0] op_sel_hi:[1,1,1] neg_lo:[0,1,0] neg_hi:[0,1,0]
  v_pk_fma_f32 v[168:169], v[168:169], v[100:101], v[52:53] op_sel:[0,0,0] op_sel_hi:[1,0,1]
  v_pk_fma_f32 v[170:171], v[170:171], v[100:101], v[54:55] op_sel:[0,0,0] op_sel_hi:[1,0,1]
  v_pk_fma_f32 v[184:185], v[184:185], v[100:101], v[60:61] op_sel:[0,0,0] op_sel_hi:[1,0,1]
  v_pk_fma_f32 v[186:187], v[186:187], v[100:101], v[62:63] op_sel:[0,0,0] op_sel_hi:[1,0,1]
  v_pk_fma_f32 v[104:105], v[168:169], v[168:169], v[4:5] op_sel_hi:[1,1,0]
  v_pk_fma_f32 v[106:107], v[170:171], v[170:171], v[4:5] op_sel_hi:[1,1,0]
  v_pk_fma_f32 v[108:109], v[184:185], v[184:185], v[4:5] op_sel_hi:[1,1,0]
  v_pk_fma_f32 v[110:111], v[186:187], v[186:187], v[4:5] op_sel_hi:[1,1,0]
  v_pk_mul_f32 v[104:105], v[104:105], v[168:169] neg_lo:[0,1] neg_hi:[0,1]
  v_pk_mul_f32 v[106:107], v[106:107], v[170:171] neg_lo:[0,1] neg_hi:[0,1]
  v_pk_mul_f32 v[108:109], v[108:109], v[184:185] neg_lo:[0,1] neg_hi:[0,1]
  v_pk_mul_f32 v[110:111], v[110:111], v[186:187] neg_lo:[0,1] neg_hi:[0,1]
  v_exp_f32 v104, v104
  v_exp_f32 v105, v105
  v_exp_f32 v106, v106
  v_exp_f32 v107, v107
  v_exp_f32 v108, v108
  v_exp_f32 v109, v109
  v_exp_f32 v110, v110
  v_exp_f32 v111, v111
  v_pk_fma_f32 v[104:105], v[104:105], v[4:5], v[4:5] op_sel:[0,1,1] op_sel_hi:[1,1,1]
  v_pk_fma_f32 v[106:107], v[106:107], v[4:5], v[4:5] op_sel:[0,1,1] op_sel_hi:[1,1,1]
  v_pk_fma_f32 v[108:109], v[108:109], v[4:5], v[4:5] op_sel:[0,1,1] op_sel_hi:[1,1,1]
  v_pk_fma_f32 v[110:111], v[110:111], v[4:5], v[4:5] op_sel:[0,1,1] op_sel_hi:[1,1,1]
  v_rcp_f32 v104, v104
  v_rcp_f32 v105, v105
  v_rcp_f32 v106, v106
  v_rcp_f32 v107, v107
  v_rcp_f32 v108, v108
  v_rcp_f32 v109, v109
  v_rcp_f32 v110, v110
  v_rcp_f32 v111, v111
  v_pk_mul_f32 v[168:169], v[168:169], v[104:105]
  v_pk_mul_f32 v[170:171], v[170:171], v[106:107]
  v_pk_mul_f32 v[184:185], v[184:185], v[108:109]
  v_pk_mul_f32 v[186:187], v[186:187], v[110:111]
  v_cvt_pk_bf16_f32 v116, v168, v169
  v_cvt_pk_bf16_f32 v117, v170, v171
  v_cvt_pk_bf16_f32 v118, v184, v185
  v_cvt_pk_bf16_f32 v119, v186, v187
  buffer_store_dwordx4 v[116:119], v0, s[40:43], s7 offen offset:0 sc0 sc1
  ds_write_b128 v0, v[116:119] offset:20480
  v_pk_fma_f32 v[172:173], v[48:49], v[102:103], v[172:173] op_sel:[0,1,0] op_sel_hi:[1,1,1] neg_lo:[0,1,0] neg_hi:[0,1,0]
  v_pk_fma_f32 v[174:175], v[50:51], v[102:103], v[174:175] op_sel:[0,1,0] op_sel_hi:[1,1,1] neg_lo:[0,1,0] neg_hi:[0,1,0]
  v_pk_fma_f32 v[188:189], v[56:57], v[102:103], v[188:189] op_sel:[0,1,0] op_sel_hi:[1,1,1] neg_lo:[0,1,0] neg_hi:[0,1,0]
  v_pk_fma_f32 v[190:191], v[58:59], v[102:103], v[190:191] op_sel:[0,1,0] op_sel_hi:[1,1,1] neg_lo:[0,1,0] neg_hi:[0,1,0]
  v_pk_fma_f32 v[172:173], v[172:173], v[102:103], v[52:53] op_sel:[0,0,0] op_sel_hi:[1,0,1]
  v_pk_fma_f32 v[174:175], v[174:175], v[102:103], v[54:55] op_sel:[0,0,0] op_sel_hi:[1,0,1]
  v_pk_fma_f32 v[188:189], v[188:189], v[102:103], v[60:61] op_sel:[0,0,0] op_sel_hi:[1,0,1]
  v_pk_fma_f32 v[190:191], v[190:191], v[102:103], v[62:63] op_sel:[0,0,0] op_sel_hi:[1,0,1]
  v_pk_fma_f32 v[104:105], v[172:173], v[172:173], v[4:5] op_sel_hi:[1,1,0]
  v_pk_fma_f32 v[106:107], v[174:175], v[174:175], v[4:5] op_sel_hi:[1,1,0]
  v_pk_fma_f32 v[108:109], v[188:189], v[188:189], v[4:5] op_sel_hi:[1,1,0]
  v_pk_fma_f32 v[110:111], v[190:191], v[190:191], v[4:5] op_sel_hi:[1,1,0]
  v_pk_mul_f32 v[104:105], v[104:105], v[172:173] neg_lo:[0,1] neg_hi:[0,1]
  v_pk_mul_f32 v[106:107], v[106:107], v[174:175] neg_lo:[0,1] neg_hi:[0,1]
  v_pk_mul_f32 v[108:109], v[108:109], v[188:189] neg_lo:[0,1] neg_hi:[0,1]
  v_pk_mul_f32 v[110:111], v[110:111], v[190:191] neg_lo:[0,1] neg_hi:[0,1]
  v_exp_f32 v104, v104
  v_exp_f32 v105, v105
  v_exp_f32 v106, v106
  v_exp_f32 v107, v107
  v_exp_f32 v108, v108
  v_exp_f32 v109, v109
  v_exp_f32 v110, v110
  v_exp_f32 v111, v111
  v_pk_fma_f32 v[104:105], v[104:105], v[4:5], v[4:5] op_sel:[0,1,1] op_sel_hi:[1,1,1]
  v_pk_fma_f32 v[106:107], v[106:107], v[4:5], v[4:5] op_sel:[0,1,1] op_sel_hi:[1,1,1]
  v_pk_fma_f32 v[108:109], v[108:109], v[4:5], v[4:5] op_sel:[0,1,1] op_sel_hi:[1,1,1]
  v_pk_fma_f32 v[110:111], v[110:111], v[4:5], v[4:5] op_sel:[0,1,1] op_sel_hi:[1,1,1]
  v_rcp_f32 v104, v104
  v_rcp_f32 v105, v105
  v_rcp_f32 v106, v106
  v_rcp_f32 v107, v107
  v_rcp_f32 v108, v108
  v_rcp_f32 v109, v109
  v_rcp_f32 v110, v110
  v_rcp_f32 v111, v111
  v_pk_mul_f32 v[172:173], v[172:173], v[104:105]
  v_pk_mul_f32 v[174:175], v[174:175], v[106:107]
  v_pk_mul_f32 v[188:189], v[188:189], v[108:109]
  v_pk_mul_f32 v[190:191], v[190:191], v[110:111]
  v_cvt_pk_bf16_f32 v120, v172, v173
  v_cvt_pk_bf16_f32 v121, v174, v175
  v_cvt_pk_bf16_f32 v122, v188, v189
  v_cvt_pk_bf16_f32 v123, v190, v191
  buffer_store_dwordx4 v[120:123], v0, s[40:43], s7 offen offset:2048 sc0 sc1
  ds_write_b128 v0, v[120:123] offset:22528
  s_add_u32 s7, s7, 0x20000
  v_pk_fma_f32 v[192:193], v[64:65], v[96:97], v[192:193] op_sel:[0,1,0] op_sel_hi:[1,1,1] neg_lo:[0,1,0] neg_hi:[0,1,0]
  v_pk_fma_f32 v[194:195], v[66:67], v[96:97], v[194:195] op_sel:[0,1,0] op_sel_hi:[1,1,1] neg_lo:[0,1,0] neg_hi:[0,1,0]
  v_pk_fma_f32 v[208:209], v[72:73], v[96:97], v[208:209] op_sel:[0,1,0] op_sel_hi:[1,1,1] neg_lo:[0,1,0] neg_hi:[0,1,0]
  v_pk_fma_f32 v[210:211], v[74:75], v[96:97], v[210:211] op_sel:[0,1,0] op_sel_hi:[1,1,1] neg_lo:[0,1,0] neg_hi:[0,1,0]
  v_pk_fma_f32 v[192:193], v[192:193], v[96:97], v[68:69] op_sel:[0,0,0] op_sel_hi:[1,0,1]
  v_pk_fma_f32 v[194:195], v[194:195], v[96:97], v[70:71] op_sel:[0,0,0] op_sel_hi:[1,0,1]
  v_pk_fma_f32 v[208:209], v[208:209], v[96:97], v[76:77] op_sel:[0,0,0] op_sel_hi:[1,0,1]
  v_pk_fma_f32 v[210:211], v[210:211], v[96:97], v[78:79] op_sel:[0,0,0] op_sel_hi:[1,0,1]
  v_pk_fma_f32 v[104:105], v[192:193], v[192:193], v[4:5] op_sel_hi:[1,1,0]
  v_pk_fma_f32 v[106:107], v[194:195], v[194:195], v[4:5] op_sel_hi:[1,1,0]
  v_pk_fma_f32 v[108:109], v[208:209], v[208:209], v[4:5] op_sel_hi:[1,1,0]
  v_pk_fma_f32 v[110:111], v[210:211], v[210:211], v[4:5] op_sel_hi:[1,1,0]
  v_pk_mul_f32 v[104:105], v[104:105], v[192:193] neg_lo:[0,1] neg_hi:[0,1]
  v_pk_mul_f32 v[106:107], v[106:107], v[194:195] neg_lo:[0,1] neg_hi:[0,1]
  v_pk_mul_f32 v[108:109], v[108:109], v[208:209] neg_lo:[0,1] neg_hi:[0,1]
  v_pk_mul_f32 v[110:111], v[110:111], v[210:211] neg_lo:[0,1] neg_hi:[0,1]
  v_exp_f32 v104, v104
  v_exp_f32 v105, v105
  v_exp_f32 v106, v106
  v_exp_f32 v107, v107
  v_exp_f32 v108, v108
  v_exp_f32 v109, v109
  v_exp_f32 v110, v110
  v_exp_f32 v111, v111
  v_pk_fma_f32 v[104:105], v[104:105], v[4:5], v[4:5] op_sel:[0,1,1] op_sel_hi:[1,1,1]
  v_pk_fma_f32 v[106:107], v[106:107], v[4:5], v[4:5] op_sel:[0,1,1] op_sel_hi:[1,1,1]
  v_pk_fma_f32 v[108:109], v[108:109], v[4:5], v[4:5] op_sel:[0,1,1] op_sel_hi:[1,1,1]
  v_pk_fma_f32 v[110:111], v[110:111], v[4:5], v[4:5] op_sel:[0,1,1] op_sel_hi:[1,1,1]
  v_rcp_f32 v104, v104
  v_rcp_f32 v105, v105
  v_rcp_f32 v106, v106
  v_rcp_f32 v107, v107
  v_rcp_f32 v108, v108
  v_rcp_f32 v109, v109
  v_rcp_f32 v110, v110
  v_rcp_f32 v111, v111
  v_pk_mul_f32 v[192:193], v[192:193], v[104:105]
  v_pk_mul_f32 v[194:195], v[194:195], v[106:107]
  v_pk_mul_f32 v[208:209], v[208:209], v[108:109]
  v_pk_mul_f32 v[210:211], v[210:211], v[110:111]
  v_cvt_pk_bf16_f32 v116, v192, v193
  v_cvt_pk_bf16_f32 v117, v194, v195
  v_cvt_pk_bf16_f32 v118, v208, v209
  v_cvt_pk_bf16_f32 v119, v210, v211
  buffer_store_dwordx4 v[116:119], v0, s[40:43], s6 offen offset:0 sc0 sc1
  ds_write_b128 v0, v[116:119] offset:32768
  v_pk_fma_f32 v[196:197], v[64:65], v[98:99], v[196:197] op_sel:[0,1,0] op_sel_hi:[1,1,1] neg_lo:[0,1,0] neg_hi:[0,1,0]
  v_pk_fma_f32 v[198:199], v[66:67], v[98:99], v[198:199] op_sel:[0,1,0] op_sel_hi:[1,1,1] neg_lo:[0,1,0] neg_hi:[0,1,0]
  v_pk_fma_f32 v[212:213], v[72:73], v[98:99], v[212:213] op_sel:[0,1,0] op_sel_hi:[1,1,1] neg_lo:[0,1,0] neg_hi:[0,1,0]
  v_pk_fma_f32 v[214:215], v[74:75], v[98:99], v[214:215] op_sel:[0,1,0] op_sel_hi:[1,1,1] neg_lo:[0,1,0] neg_hi:[0,1,0]
  v_pk_fma_f32 v[196:197], v[196:197], v[98:99], v[68:69] op_sel:[0,0,0] op_sel_hi:[1,0,1]
  v_pk_fma_f32 v[198:199], v[198:199], v[98:99], v[70:71] op_sel:[0,0,0] op_sel_hi:[1,0,1]
  v_pk_fma_f32 v[212:213], v[212:213], v[98:99], v[76:77] op_sel:[0,0,0] op_sel_hi:[1,0,1]
  v_pk_fma_f32 v[214:215], v[214:215], v[98:99], v[78:79] op_sel:[0,0,0] op_sel_hi:[1,0,1]
  v_pk_fma_f32 v[104:105], v[196:197], v[196:197], v[4:5] op_sel_hi:[1,1,0]
  v_pk_fma_f32 v[106:107], v[198:199], v[198:199], v[4:5] op_sel_hi:[1,1,0]
  v_pk_fma_f32 v[108:109], v[212:213], v[212:213], v[4:5] op_sel_hi:[1,1,0]
  v_pk_fma_f32 v[110:111], v[214:215], v[214:215], v[4:5] op_sel_hi:[1,1,0]
  v_pk_mul_f32 v[104:105], v[104:105], v[196:197] neg_lo:[0,1] neg_hi:[0,1]
  v_pk_mul_f32 v[106:107], v[106:107], v[198:199] neg_lo:[0,1] neg_hi:[0,1]
  v_pk_mul_f32 v[108:109], v[108:109], v[212:213] neg_lo:[0,1] neg_hi:[0,1]
  v_pk_mul_f32 v[110:111], v[110:111], v[214:215] neg_lo:[0,1] neg_hi:[0,1]
  v_exp_f32 v104, v104
  v_exp_f32 v105, v105
  v_exp_f32 v106, v106
  v_exp_f32 v107, v107
  v_exp_f32 v108, v108
  v_exp_f32 v109, v109
  v_exp_f32 v110, v110
  v_exp_f32 v111, v111
  v_pk_fma_f32 v[104:105], v[104:105], v[4:5], v[4:5] op_sel:[0,1,1] op_sel_hi:[1,1,1]
  v_pk_fma_f32 v[106:107], v[106:107], v[4:5], v[4:5] op_sel:[0,1,1] op_sel_hi:[1,1,1]
  v_pk_fma_f32 v[108:109], v[108:109], v[4:5], v[4:5] op_sel:[0,1,1] op_sel_hi:[1,1,1]
  v_pk_fma_f32 v[110:111], v[110:111], v[4:5], v[4:5] op_sel:[0,1,1] op_sel_hi:[1,1,1]
  v_rcp_f32 v104, v104
  v_rcp_f32 v105, v105
  v_rcp_f32 v106, v106
  v_rcp_f32 v107, v107
  v_rcp_f32 v108, v108
  v_rcp_f32 v109, v109
  v_rcp_f32 v110, v110
  v_rcp_f32 v111, v111
  v_pk_mul_f32 v[196:197], v[196:197], v[104:105]
  v_pk_mul_f32 v[198:199], v[198:199], v[106:107]
  v_pk_mul_f32 v[212:213], v[212:213], v[108:109]
  v_pk_mul_f32 v[214:215], v[214:215], v[110:111]
  v_cvt_pk_bf16_f32 v120, v196, v197
  v_cvt_pk_bf16_f32 v121, v198, v199
  v_cvt_pk_bf16_f32 v122, v212, v213
  v_cvt_pk_bf16_f32 v123, v214, v215
  buffer_store_dwordx4 v[120:123], v0, s[40:43], s6 offen offset:2048 sc0 sc1
  ds_write_b128 v0, v[120:123] offset:34816
  s_mov_b64 exec, 1
  ds_add_u32 v28, v27 offset:4
  s_mov_b64 exec, -1
  v_pk_fma_f32 v[200:201], v[64:65], v[100:101], v[200:201] op_sel:[0,1,0] op_sel_hi:[1,1,1] neg_lo:[0,1,0] neg_hi:[0,1,0]
  v_pk_fma_f32 v[202:203], v[66:67], v[100:101], v[202:203] op_sel:[0,1,0] op_sel_hi:[1,1,1] neg_lo:[0,1,0] neg_hi:[0,1,0]
  v_pk_fma_f32 v[216:217], v[72:73], v[100:101], v[216:217] op_sel:[0,1,0] op_sel_hi:[1,1,1] neg_lo:[0,1,0] neg_hi:[0,1,0]
  v_pk_fma_f32 v[218:219], v[74:75], v[100:101], v[218:219] op_sel:[0,1,0] op_sel_hi:[1,1,1] neg_lo:[0,1,0] neg_hi:[0,1,0]
  v_pk_fma_f32 v[200:201], v[200:201], v[100:101], v[68:69] op_sel:[0,0,0] op_sel_hi:[1,0,1]
  v_pk_fma_f32 v[202:203], v[202:203], v[100:101], v[70:71] op_sel:[0,0,0] op_sel_hi:[1,0,1]
  v_pk_fma_f32 v[216:217], v[216:217], v[100:101], v[76:77] op_sel:[0,0,0] op_sel_hi:[1,0,1]
  v_pk_fma_f32 v[218:219], v[218:219], v[100:101], v[78:79] op_sel:[0,0,0] op_sel_hi:[1,0,1]
  v_pk_fma_f32 v[104:105], v[200:201], v[200:201], v[4:5] op_sel_hi:[1,1,0]
  v_pk_fma_f32 v[106:107], v[202:203], v[202:203], v[4:5] op_sel_hi:[1,1,0]
  v_pk_fma_f32 v[108:109], v[216:217], v[216:217], v[4:5] op_sel_hi:[1,1,0]
  v_pk_fma_f32 v[110:111], v[218:219], v[218:219], v[4:5] op_sel_hi:[1,1,0]
  v_pk_mul_f32 v[104:105], v[104:105], v[200:201] neg_lo:[0,1] neg_hi:[0,1]
  v_pk_mul_f32 v[106:107], v[106:107], v[202:203] neg_lo:[0,1] neg_hi:[0,1]
  v_pk_mul_f32 v[108:109], v[108:109], v[216:217] neg_lo:[0,1] neg_hi:[0,1]
  v_pk_mul_f32 v[110:111], v[110:111], v[218:219] neg_lo:[0,1] neg_hi:[0,1]
  v_exp_f32 v104, v104
  v_exp_f32 v105, v105
  v_exp_f32 v106, v106
  v_exp_f32 v107, v107
  v_exp_f32 v108, v108
  v_exp_f32 v109, v109
  v_exp_f32 v110, v110
  v_exp_f32 v111, v111
  v_pk_fma_f32 v[104:105], v[104:105], v[4:5], v[4:5] op_sel:[0,1,1] op_sel_hi:[1,1,1]
  v_pk_fma_f32 v[106:107], v[106:107], v[4:5], v[4:5] op_sel:[0,1,1] op_sel_hi:[1,1,1]
  v_pk_fma_f32 v[108:109], v[108:109], v[4:5], v[4:5] op_sel:[0,1,1] op_sel_hi:[1,1,1]
  v_pk_fma_f32 v[110:111], v[110:111], v[4:5], v[4:5] op_sel:[0,1,1] op_sel_hi:[1,1,1]
  v_rcp_f32 v104, v104
  v_rcp_f32 v105, v105
  v_rcp_f32 v106, v106
  v_rcp_f32 v107, v107
  v_rcp_f32 v108, v108
  v_rcp_f32 v109, v109
  v_rcp_f32 v110, v110
  v_rcp_f32 v111, v111
  v_pk_mul_f32 v[200:201], v[200:201], v[104:105]
  v_pk_mul_f32 v[202:203], v[202:203], v[106:107]
  v_pk_mul_f32 v[216:217], v[216:217], v[108:109]
  v_pk_mul_f32 v[218:219], v[218:219], v[110:111]
  v_cvt_pk_bf16_f32 v116, v200, v201
  v_cvt_pk_bf16_f32 v117, v202, v203
  v_cvt_pk_bf16_f32 v118, v216, v217
  v_cvt_pk_bf16_f32 v119, v218, v219
  buffer_store_dwordx4 v[116:119], v0, s[40:43], s7 offen offset:0 sc0 sc1
  ds_write_b128 v0, v[116:119] offset:36864
  s_lshl_b32 s5, s86, Lz1-Lz0+7
  s_add_u32 s5, s5, 156160
  v_add_u32_e64 v3, s5, v29
  ds_read_b128 v[232:235], v3
  ds_read_b128 v[236:239], v3 offset:64
  v_pk_fma_f32 v[204:205], v[64:65], v[102:103], v[204:205] op_sel:[0,1,0] op_sel_hi:[1,1,1] neg_lo:[0,1,0] neg_hi:[0,1,0]
  v_pk_fma_f32 v[206:207], v[66:67], v[102:103], v[206:207] op_sel:[0,1,0] op_sel_hi:[1,1,1] neg_lo:[0,1,0] neg_hi:[0,1,0]
  v_pk_fma_f32 v[220:221], v[72:73], v[102:103], v[220:221] op_sel:[0,1,0] op_sel_hi:[1,1,1] neg_lo:[0,1,0] neg_hi:[0,1,0]
  v_pk_fma_f32 v[222:223], v[74:75], v[102:103], v[222:223] op_sel:[0,1,0] op_sel_hi:[1,1,1] neg_lo:[0,1,0] neg_hi:[0,1,0]
  v_pk_fma_f32 v[204:205], v[204:205], v[102:103], v[68:69] op_sel:[0,0,0] op_sel_hi:[1,0,1]
  v_pk_fma_f32 v[206:207], v[206:207], v[102:103], v[70:71] op_sel:[0,0,0] op_sel_hi:[1,0,1]
  v_pk_fma_f32 v[220:221], v[220:221], v[102:103], v[76:77] op_sel:[0,0,0] op_sel_hi:[1,0,1]
  v_pk_fma_f32 v[222:223], v[222:223], v[102:103], v[78:79] op_sel:[0,0,0] op_sel_hi:[1,0,1]
  v_pk_fma_f32 v[104:105], v[204:205], v[204:205], v[4:5] op_sel_hi:[1,1,0]
  v_pk_fma_f32 v[106:107], v[206:207], v[206:207], v[4:5] op_sel_hi:[1,1,0]
  v_pk_fma_f32 v[108:109], v[220:221], v[220:221], v[4:5] op_sel_hi:[1,1,0]
  v_pk_fma_f32 v[110:111], v[222:223], v[222:223], v[4:5] op_sel_hi:[1,1,0]
  v_pk_mul_f32 v[104:105], v[104:105], v[204:205] neg_lo:[0,1] neg_hi:[0,1]
  v_pk_mul_f32 v[106:107], v[106:107], v[206:207] neg_lo:[0,1] neg_hi:[0,1]
  v_pk_mul_f32 v[108:109], v[108:109], v[220:221] neg_lo:[0,1] neg_hi:[0,1]
  v_pk_mul_f32 v[110:111], v[110:111], v[222:223] neg_lo:[0,1] neg_hi:[0,1]
  v_exp_f32 v104, v104
  v_exp_f32 v105, v105
  v_exp_f32 v106, v106
  v_exp_f32 v107, v107
  v_exp_f32 v108, v108
  v_exp_f32 v109, v109
  v_exp_f32 v110, v110
  v_exp_f32 v111, v111
  v_pk_fma_f32 v[104:105], v[104:105], v[4:5], v[4:5] op_sel:[0,1,1] op_sel_hi:[1,1,1]
  v_pk_fma_f32 v[106:107], v[106:107], v[4:5], v[4:5] op_sel:[0,1,1] op_sel_hi:[1,1,1]
  v_pk_fma_f32 v[108:109], v[108:109], v[4:5], v[4:5] op_sel:[0,1,1] op_sel_hi:[1,1,1]
  v_pk_fma_f32 v[110:111], v[110:111], v[4:5], v[4:5] op_sel:[0,1,1] op_sel_hi:[1,1,1]
  v_rcp_f32 v104, v104
  v_rcp_f32 v105, v105
  v_rcp_f32 v106, v106
  v_rcp_f32 v107, v107
  v_rcp_f32 v108, v108
  v_rcp_f32 v109, v109
  v_rcp_f32 v110, v110
  v_rcp_f32 v111, v111
  v_pk_mul_f32 v[204:205], v[204:205], v[104:105]
  v_pk_mul_f32 v[206:207], v[206:207], v[106:107]
  v_pk_mul_f32 v[220:221], v[220:221], v[108:109]
  v_pk_mul_f32 v[222:223], v[222:223], v[110:111]
  v_cvt_pk_bf16_f32 v120, v204, v205
  v_cvt_pk_bf16_f32 v121, v206, v207
  v_cvt_pk_bf16_f32 v122, v220, v221
  v_cvt_pk_bf16_f32 v123, v222, v223
  buffer_store_dwordx4 v[120:123], v0, s[40:43], s7 offen offset:2048 sc0 sc1
  ds_write_b128 v0, v[120:123] offset:38912
  s_mov_b32 s16, Lz1-Lz0+0
  s_mov_b32 s17, 16384
  s_mov_b32 s18, 0xffff4000
  s_mov_b32 s19, 49152
  s_mov_b32 s20, 16384
  s_mov_b32 s21, 0xffff0000
  s_mul_i32 s4, s85, 8192
  v_add_u32_e64 v4, s4, v11
  v_add_u32 v5, 1024, v4
  s_lshl_b32 s4, s86, 1
  v_xor_b32 v2, s4, v26
  v_lshl_add_u32 v6, v2, 5, v25
  v_add_u32 v6, s19, v6
  s_add_u32 s4, s4, 1
  v_xor_b32_e64 v2, s4, v26
  v_lshl_add_u32 v7, v2, 5, v25
  v_add_u32 v7, s19, v7
  s_mov_b32 s22, 12
  s_waitcnt lgkmcnt(0)
  s_barrier
  ds_read_b64_tr_b16 v[48:49], v6 offset:0
  v_and_b32 v2, 15, v1
  v_lshrrev_b32 v3, 2, v29
  ds_read_b64_tr_b16 v[50:51], v6 offset:2048
  v_sub_u32 v2, v2, v3
  v_mov_b64 v[224:225], 0
  ds_read_b128 v[32:35], v4 offset:0
  v_lshlrev_b32_e64 v2, 4, v2
  v_mov_b32 v226, 0x3f80
  ds_read_b128 v[36:39], v4 offset:2048
  v_cmp_gt_u32 vcc, 64, v2
  v_mov_b32 v227, 0
  ds_read_b128 v[40:43], v4 offset:4096
  v_cndmask_b32 v226, 0, v226, vcc
  v_mov_b64 v[228:229], 0
  ds_read_b128 v[44:47], v4 offset:6144
  v_lshlrev_b64 v[226:227], v2, v[226:227]
  v_mov_b64_e64 v[160:161], 0
  ds_read_b64_tr_b16 v[52:53], v7 offset:0
  v_mov_b64 v[162:163], 0
  v_mov_b64 v[164:165], 0
  ds_read_b64_tr_b16 v[54:55], v7 offset:2048
  v_mov_b64 v[166:167], 0
  v_mov_b64 v[168:169], 0
  ds_read_b64_tr_b16 v[56:57], v6 offset:8192
  v_mov_b64 v[170:171], 0
  v_mov_b64 v[172:173], 0
  ds_read_b64_tr_b16 v[58:59], v6 offset:10240
  v_mov_b64 v[174:175], 0
  v_mov_b64 v[176:177], 0
  ds_read_b64_tr_b16 v[60:61], v7 offset:8192
  v_mov_b64 v[178:179], 0
  v_mov_b64 v[180:181], 0
  ds_read_b64_tr_b16 v[62:63], v7 offset:10240
  v_mov_b64 v[182:183], 0
  v_mov_b64 v[184:185], 0
  ds_read_b64_tr_b16 v[80:81], v6 offset:4096
  v_mov_b64_e64 v[186:187], 0
  v_mov_b64 v[188:189], 0
  s_waitcnt lgkmcnt(4)
  ds_read_b64_tr_b16 v[82:83], v6 offset:6144
  v_mov_b64_e64 v[190:191], 0
  v_mfma_f32_16x16x32_bf16 v[128:131], v[226:229], v[240:243], v[232:235]
  ds_read_b128 v[64:67], v5 offset:0
  s_lshl_b32 s4, s76, 4
  s_add_u32 s4, s4, s78
  ds_read_b128 v[68:71], v5 offset:2048
  v_mfma_f32_16x16x32_bf16 v[132:135], v[224:227], v[240:243], v[236:239]
  s_lshl_b32 s8, s4, Lz1-Lz0+14
  ds_read_b128 v[72:75], v5 offset:4096
  s_xor_b32 s6, s8, 16384
  v_mfma_f32_16x16x32_bf16 v[136:139], v[226:229], v[244:247], v[232:235]
  ds_read_b128 v[76:79], v5 offset:6144
  s_add_u32 s8, s8, 7340032
  s_add_u32 s6, s6, 7340032
  ds_read_b64_tr_b16 v[84:85], v7 offset:4096
  v_mfma_f32_16x16x32_bf16 v[140:143], v[224:227], v[244:247], v[236:239]
  s_add_u32 s7, s6, 4096
  ds_read_b64_tr_b16 v[86:87], v7 offset:6144
  s_add_u32 s9, s8, 4096
  v_mfma_f32_16x16x32_bf16 v[144:147], v[226:229], v[248:251], v[232:235]
  ds_read_b64_tr_b16 v[88:89], v6 offset:12288
  s_lshl_b32 s4, s81, 7
  s_add_u32 s4, s4, s87
  ds_read_b64_tr_b16 v[90:91], v6 offset:14336
  v_mfma_f32_16x16x32_bf16 v[148:151], v[224:227], v[248:251], v[236:239]
  s_add_u32 s4, s4, Lz1-Lz0+12
  ds_read_b64_tr_b16 v[92:93], v7 offset:12288
  s_lshl_b32 s13, s84, Lz1-Lz0+1
  v_mfma_f32_16x16x32_bf16 v[152:155], v[226:229], v[252:255], v[232:235]
  ds_read_b64_tr_b16 v[94:95], v7 offset:14336
  s_xor_b32 s14, s13, 32768
  s_nop 0
  s_add_u32 s13, s13, s4
  v_mfma_f32_16x16x32_bf16 v[156:159], v[224:227], v[252:255], v[236:239]
  s_add_u32 s14, s14, s4
  s_add_u32 s16, s16, s17
  s_cmp_eq_u32 s16, 65536
  s_cselect_b32 s23, s18, s17
  s_cselect_b32 s16, 0, s16
  v_add_u32_e64 v4, s23, v4
  v_add_u32 v5, s23, v5
  s_add_u32 s19, s19, s20
  s_cmp_eq_u32 s19, 81920
  s_cselect_b32 s23, s21, s20
  s_cselect_b32 s19, 0, s19
  v_add_u32 v6, s23, v6
  v_add_u32 v7, s23, v7
  s_waitcnt lgkmcnt(0)
Lk_29:
  s_barrier
  v_mfma_f32_16x16x32_bf16 v[128:131], v[48:51], v[32:35], v[128:131]
  ds_read_b64_tr_b16 v[112:113], v6 offset:0
  v_mfma_f32_16x16x32_bf16 v[128:131], v[80:83], v[64:67], v[128:131]
  ds_read_b64_tr_b16 v[114:115], v6 offset:2048
  v_mfma_f32_16x16x32_bf16 v[136:139], v[80:83], v[68:71], v[136:139]
  ds_read_b128 v[96:99], v4 offset:0
  v_mfma_f32_16x16x32_bf16 v[136:139], v[48:51], v[36:39], v[136:139]
  ds_read_b128 v[100:103], v4 offset:2048
  v_mfma_f32_16x16x32_bf16 v[144:147], v[48:51], v[40:43], v[144:147]
  ds_read_b128 v[104:107], v4 offset:4096
  v_mfma_f32_16x16x32_bf16 v[144:147], v[80:83], v[72:75], v[144:147]
  ds_read_b128 v[108:111], v4 offset:6144
  v_mfma_f32_16x16x32_bf16 v[152:155], v[80:83], v[76:79], v[152:155]
  ds_read_b64_tr_b16 v[116:117], v7 offset:0
  v_mfma_f32_16x16x32_bf16 v[152:155], v[48:51], v[44:47], v[152:155]
  ds_read_b64_tr_b16 v[118:119], v7 offset:2048
  v_mfma_f32_16x16x32_bf16 v[156:159], v[52:55], v[44:47], v[156:159]
  ds_read_b64_tr_b16 v[120:121], v6 offset:8192
  v_mfma_f32_16x16x32_bf16 v[156:159], v[84:87], v[76:79], v[156:159]
  ds_read_b64_tr_b16 v[122:123], v6 offset:10240
  v_mfma_f32_16x16x32_bf16 v[148:151], v[84:87], v[72:75], v[148:151]
  ds_read_b64_tr_b16 v[124:125], v7 offset:8192
  v_mfma_f32_16x16x32_bf16 v[148:151], v[52:55], v[40:43], v[148:151]
  ds_read_b64_tr_b16 v[126:127], v7 offset:10240
  v_mfma_f32_16x16x32_bf16 v[140:143], v[52:55], v[36:39], v[140:143]
  ds_read_b64_tr_b16 v[208:209], v6 offset:4096
  v_mfma_f32_16x16x32_bf16 v[140:143], v[84:87], v[68:71], v[140:143]
  ds_read_b64_tr_b16 v[210:211], v6 offset:6144
  v_mfma_f32_16x16x32_bf16 v[132:135], v[84:87], v[64:67], v[132:135]
  ds_read_b128 v[192:195], v5 offset:0
  v_mfma_f32_16x16x32_bf16 v[132:135], v[52:55], v[32:35], v[132:135]
  ds_read_b128 v[196:199], v5 offset:2048
  v_mfma_f32_16x16x32_bf16 v[160:163], v[56:59], v[32:35], v[160:163]
  ds_read_b128 v[200:203], v5 offset:4096
  v_mfma_f32_16x16x32_bf16 v[160:163], v[88:91], v[64:67], v[160:163]
  ds_read_b128 v[204:207], v5 offset:6144
  v_mfma_f32_16x16x32_bf16 v[168:171], v[88:91], v[68:71], v[168:171]
  ds_read_b64_tr_b16 v[212:213], v7 offset:4096
  v_mfma_f32_16x16x32_bf16 v[168:171], v[56:59], v[36:39], v[168:171]
  ds_read_b64_tr_b16 v[214:215], v7 offset:6144
  v_mfma_f32_16x16x32_bf16 v[176:179], v[56:59], v[40:43], v[176:179]
  ds_read_b64_tr_b16 v[216:217], v6 offset:12288
  v_mfma_f32_16x16x32_bf16 v[176:179], v[88:91], v[72:75], v[176:179]
  ds_read_b64_tr_b16 v[218:219], v6 offset:14336
  v_mfma_f32_16x16x32_bf16 v[184:187], v[88:91], v[76:79], v[184:187]
  ds_read_b64_tr_b16 v[220:221], v7 offset:12288
  v_mfma_f32_16x16x32_bf16 v[184:187], v[56:59], v[44:47], v[184:187]
  ds_read_b64_tr_b16 v[222:223], v7 offset:14336
  v_mfma_f32_16x16x32_bf16 v[188:191], v[60:63], v[44:47], v[188:191]
  s_add_u32 s16, s16, s17
  s_cmp_eq_u32 s16, 65536
  s_cselect_b32 s23, s18, s17
  v_mfma_f32_16x16x32_bf16 v[188:191], v[92:95], v[76:79], v[188:191]
  s_cselect_b32 s16, 0, s16
  v_add_u32 v4, s23, v4
  v_add_u32_e64 v5, s23, v5
  v_mfma_f32_16x16x32_bf16 v[180:183], v[92:95], v[72:75], v[180:183]
  s_add_u32 s19, s19, s20
  s_cmp_eq_u32 s19, 81920
  s_cselect_b32 s23, s21, s20
  v_mfma_f32_16x16x32_bf16 v[180:183], v[60:63], v[40:43], v[180:183]
  s_cselect_b32 s19, 0, s19
  v_add_u32 v6, s23, v6
  v_add_u32_e64 v7, s23, v7
  v_mfma_f32_16x16x32_bf16 v[172:175], v[60:63], v[36:39], v[172:175]
  v_mfma_f32_16x16x32_bf16 v[172:175], v[92:95], v[68:71], v[172:175]
  v_mfma_f32_16x16x32_bf16 v[164:167], v[92:95], v[64:67], v[164:167]
  s_nop 0
  s_waitcnt lgkmcnt(0)
  v_mfma_f32_16x16x32_bf16 v[164:167], v[60:63], v[32:35], v[164:167]
  s_waitcnt vmcnt(0)
  s_barrier
  v_mfma_f32_16x16x32_bf16 v[128:131], v[112:115], v[96:99], v[128:131]
  ds_read_b64_tr_b16 v[48:49], v6 offset:0
  v_mfma_f32_16x16x32_bf16 v[128:131], v[208:211], v[192:195], v[128:131]
  ds_read_b64_tr_b16 v[50:51], v6 offset:2048
  v_mfma_f32_16x16x32_bf16 v[136:139], v[208:211], v[196:199], v[136:139]
  ds_read_b128 v[32:35], v4 offset:0
  v_mfma_f32_16x16x32_bf16 v[136:139], v[112:115], v[100:103], v[136:139]
  ds_read_b128 v[36:39], v4 offset:2048
  v_mfma_f32_16x16x32_bf16 v[144:147], v[112:115], v[104:107], v[144:147]
  ds_read_b128 v[40:43], v4 offset:4096
  v_mfma_f32_16x16x32_bf16 v[144:147], v[208:211], v[200:203], v[144:147]
  ds_read_b128 v[44:47], v4 offset:6144
  v_mfma_f32_16x16x32_bf16 v[152:155], v[208:211], v[204:207], v[152:155]
  ds_read_b64_tr_b16 v[52:53], v7 offset:0
  v_mfma_f32_16x16x32_bf16 v[152:155], v[112:115], v[108:111], v[152:155]
  ds_read_b64_tr_b16 v[54:55], v7 offset:2048
  v_mfma_f32_16x16x32_bf16 v[156:159], v[116:119], v[108:111], v[156:159]
  ds_read_b64_tr_b16 v[56:57], v6 offset:8192
  v_mfma_f32_16x16x32_bf16 v[156:159], v[212:215], v[204:207], v[156:159]
  ds_read_b64_tr_b16 v[58:59], v6 offset:10240
  v_mfma_f32_16x16x32_bf16 v[148:151], v[212:215], v[200:203], v[148:151]
  ds_read_b64_tr_b16 v[60:61], v7 offset:8192
  v_mfma_f32_16x16x32_bf16 v[148:151], v[116:119], v[104:107], v[148:151]
  ds_read_b64_tr_b16 v[62:63], v7 offset:10240
  v_mfma_f32_16x16x32_bf16 v[140:143], v[116:119], v[100:103], v[140:143]
  ds_read_b64_tr_b16 v[80:81], v6 offset:4096
  v_mfma_f32_16x16x32_bf16 v[140:143], v[212:215], v[196:199], v[140:143]
  ds_read_b64_tr_b16 v[82:83], v6 offset:6144
  v_mfma_f32_16x16x32_bf16 v[132:135], v[212:215], v[192:195], v[132:135]
  ds_read_b128 v[64:67], v5 offset:0
  v_mfma_f32_16x16x32_bf16 v[132:135], v[116:119], v[96:99], v[132:135]
  ds_read_b128 v[68:71], v5 offset:2048
  v_mfma_f32_16x16x32_bf16 v[160:163], v[120:123], v[96:99], v[160:163]
  ds_read_b128 v[72:75], v5 offset:4096
  v_mfma_f32_16x16x32_bf16 v[160:163], v[216:219], v[192:195], v[160:163]
  ds_read_b128 v[76:79], v5 offset:6144
  v_mfma_f32_16x16x32_bf16 v[168:171], v[216:219], v[196:199], v[168:171]
  ds_read_b64_tr_b16 v[84:85], v7 offset:4096
  v_mfma_f32_16x16x32_bf16 v[168:171], v[120:123], v[100:103], v[168:171]
  ds_read_b64_tr_b16 v[86:87], v7 offset:6144
  v_mfma_f32_16x16x32_bf16 v[176:179], v[120:123], v[104:107], v[176:179]
  ds_read_b64_tr_b16 v[88:89], v6 offset:12288
  v_mfma_f32_16x16x32_bf16 v[176:179], v[216:219], v[200:203], v[176:179]
  ds_read_b64_tr_b16 v[90:91], v6 offset:14336
  v_mfma_f32_16x16x32_bf16 v[184:187], v[216:219], v[204:207], v[184:187]
  ds_read_b64_tr_b16 v[92:93], v7 offset:12288
  v_mfma_f32_16x16x32_bf16 v[184:187], v[120:123], v[108:111], v[184:187]
  ds_read_b64_tr_b16 v[94:95], v7 offset:14336
  v_mfma_f32_16x16x32_bf16 v[188:191], v[124:127], v[108:111], v[188:191]
  s_add_u32 s16, s16, s17
  s_cmp_eq_u32 s16, 65536
  s_cselect_b32 s23, s18, s17
  v_mfma_f32_16x16x32_bf16 v[188:191], v[220:223], v[204:207], v[188:191]
  s_cselect_b32 s16, 0, s16
  v_add_u32 v4, s23, v4
  v_add_u32_e64 v5, s23, v5
  v_mfma_f32_16x16x32_bf16 v[180:183], v[220:223], v[200:203], v[180:183]
  s_add_u32 s19, s19, s20
  s_cmp_eq_u32 s19, 81920
  s_cselect_b32 s23, s21, s20
  v_mfma_f32_16x16x32_bf16 v[180:183], v[124:127], v[104:107], v[180:183]
  s_cselect_b32 s19, 0, s19
  v_add_u32 v6, s23, v6
  v_add_u32_e64 v7, s23, v7
  v_mfma_f32_16x16x32_bf16 v[172:175], v[124:127], v[100:103], v[172:175]
  s_sub_u32 s22, s22, 1
  s_cmp_lg_u32 s22, 0
  v_mfma_f32_16x16x32_bf16 v[172:175], v[220:223], v[196:199], v[172:175]
  v_mfma_f32_16x16x32_bf16 v[164:167], v[220:223], v[192:195], v[164:167]
  s_nop 0
  s_waitcnt lgkmcnt(0)
  v_mfma_f32_16x16x32_bf16 v[164:167], v[124:127], v[96:99], v[164:167]
  s_cbranch_scc1 Lk_29
  s_barrier
  v_mfma_f32_16x16x32_bf16 v[128:131], v[48:51], v[32:35], v[128:131]
  ds_read_b64_tr_b16 v[112:113], v6 offset:0
  v_mfma_f32_16x16x32_bf16 v[128:131], v[80:83], v[64:67], v[128:131]
  ds_read_b64_tr_b16 v[114:115], v6 offset:2048
  v_mfma_f32_16x16x32_bf16 v[136:139], v[80:83], v[68:71], v[136:139]
  ds_read_b128 v[96:99], v4 offset:0
  v_mfma_f32_16x16x32_bf16 v[136:139], v[48:51], v[36:39], v[136:139]
  ds_read_b128 v[100:103], v4 offset:2048
  v_mfma_f32_16x16x32_bf16 v[144:147], v[48:51], v[40:43], v[144:147]
  ds_read_b128 v[104:107], v4 offset:4096
  v_mfma_f32_16x16x32_bf16 v[144:147], v[80:83], v[72:75], v[144:147]
  ds_read_b128 v[108:111], v4 offset:6144
  v_mfma_f32_16x16x32_bf16 v[152:155], v[80:83], v[76:79], v[152:155]
  ds_read_b64_tr_b16 v[116:117], v7 offset:0
  v_mfma_f32_16x16x32_bf16 v[152:155], v[48:51], v[44:47], v[152:155]
  ds_read_b64_tr_b16 v[118:119], v7 offset:2048
  v_mfma_f32_16x16x32_bf16 v[156:159], v[52:55], v[44:47], v[156:159]
  ds_read_b64_tr_b16 v[120:121], v6 offset:8192
  v_mfma_f32_16x16x32_bf16 v[156:159], v[84:87], v[76:79], v[156:159]
  ds_read_b64_tr_b16 v[122:123], v6 offset:10240
  v_mfma_f32_16x16x32_bf16 v[148:151], v[84:87], v[72:75], v[148:151]
  ds_read_b64_tr_b16 v[124:125], v7 offset:8192
  v_mfma_f32_16x16x32_bf16 v[148:151], v[52:55], v[40:43], v[148:151]
  ds_read_b64_tr_b16 v[126:127], v7 offset:10240
  v_mfma_f32_16x16x32_bf16 v[140:143], v[52:55], v[36:39], v[140:143]
  ds_read_b64_tr_b16 v[208:209], v6 offset:4096
  v_mfma_f32_16x16x32_bf16 v[140:143], v[84:87], v[68:71], v[140:143]
  ds_read_b64_tr_b16 v[210:211], v6 offset:6144
  v_mfma_f32_16x16x32_bf16 v[132:135], v[84:87], v[64:67], v[132:135]
  ds_read_b128 v[192:195], v5 offset:0
  v_mfma_f32_16x16x32_bf16 v[132:135], v[52:55], v[32:35], v[132:135]
  ds_read_b128 v[196:199], v5 offset:2048
  v_mfma_f32_16x16x32_bf16 v[160:163], v[56:59], v[32:35], v[160:163]
  ds_read_b128 v[200:203], v5 offset:4096
  v_mfma_f32_16x16x32_bf16 v[160:163], v[88:91], v[64:67], v[160:163]
  ds_read_b128 v[204:207], v5 offset:6144
  v_mfma_f32_16x16x32_bf16 v[168:171], v[88:91], v[68:71], v[168:171]
  ds_read_b64_tr_b16 v[212:213], v7 offset:4096
  v_mfma_f32_16x16x32_bf16 v[168:171], v[56:59], v[36:39], v[168:171]
  ds_read_b64_tr_b16 v[214:215], v7 offset:6144
  v_mfma_f32_16x16x32_bf16 v[176:179], v[56:59], v[40:43], v[176:179]
  ds_read_b64_tr_b16 v[216:217], v6 offset:12288
  v_mfma_f32_16x16x32_bf16 v[176:179], v[88:91], v[72:75], v[176:179]
  ds_read_b64_tr_b16 v[218:219], v6 offset:14336
  v_mfma_f32_16x16x32_bf16 v[184:187], v[88:91], v[76:79], v[184:187]
  ds_read_b64_tr_b16 v[220:221], v7 offset:12288
  v_mfma_f32_16x16x32_bf16 v[184:187], v[56:59], v[44:47], v[184:187]
  ds_read_b64_tr_b16 v[222:223], v7 offset:14336
  v_mfma_f32_16x16x32_bf16 v[188:191], v[60:63], v[44:47], v[188:191]
  s_add_u32 s16, s16, s17
  s_cmp_eq_u32 s16, 65536
  s_cselect_b32 s23, s18, s17
  v_mfma_f32_16x16x32_bf16 v[188:191], v[92:95], v[76:79], v[188:191]
  s_cselect_b32 s16, 0, s16
  v_add_u32 v4, s23, v4
  v_add_u32_e64 v5, s23, v5
  v_mfma_f32_16x16x32_bf16 v[180:183], v[92:95], v[72:75], v[180:183]
  s_add_u32 s19, s19, s20
  s_cmp_eq_u32 s19, 81920
  s_cselect_b32 s23, s21, s20
  v_mfma_f32_16x16x32_bf16 v[180:183], v[60:63], v[40:43], v[180:183]
  s_cselect_b32 s19, 0, s19
  v_add_u32 v6, s23, v6
  v_add_u32_e64 v7, s23, v7
  v_mfma_f32_16x16x32_bf16 v[172:175], v[60:63], v[36:39], v[172:175]
  v_mfma_f32_16x16x32_bf16 v[172:175], v[92:95], v[68:71], v[172:175]
  v_mfma_f32_16x16x32_bf16 v[164:167], v[92:95], v[64:67], v[164:167]
  s_waitcnt lgkmcnt(0)
  v_mfma_f32_16x16x32_bf16 v[164:167], v[60:63], v[32:35], v[164:167]
  s_barrier
  v_mfma_f32_16x16x32_bf16 v[160:163], v[120:123], v[96:99], v[160:163]
  ds_read_b64_tr_b16 v[48:49], v6 offset:0
  ds_read_b64_tr_b16 v[50:51], v6 offset:2048
  v_mfma_f32_16x16x32_bf16 v[160:163], v[216:219], v[192:195], v[160:163]
  ds_read_b128 v[32:35], v4 offset:0
  ds_read_b128 v[36:39], v4 offset:2048
  v_mfma_f32_16x16x32_bf16 v[164:167], v[220:223], v[192:195], v[164:167]
  ds_read_b128 v[40:43], v4 offset:4096
  ds_read_b128 v[44:47], v4 offset:6144
  v_mfma_f32_16x16x32_bf16 v[164:167], v[124:127], v[96:99], v[164:167]
  ds_read_b64_tr_b16 v[52:53], v7 offset:0
  ds_read_b64_tr_b16 v[54:55], v7 offset:2048
  v_mfma_f32_16x16x32_bf16 v[172:175], v[124:127], v[100:103], v[172:175]
  ds_read_b64_tr_b16 v[80:81], v6 offset:4096
  ds_read_b64_tr_b16 v[82:83], v6 offset:6144
  v_mfma_f32_16x16x32_bf16 v[172:175], v[220:223], v[196:199], v[172:175]
  v_cvt_pk_bf16_f32 v160, v160, v161
  v_cvt_pk_bf16_f32 v161, v162, v163
  v_mfma_f32_16x16x32_bf16 v[168:171], v[216:219], v[196:199], v[168:171]
  v_cvt_pk_bf16_f32 v162, v164, v165
  v_cvt_pk_bf16_f32 v163, v166, v167
  v_mfma_f32_16x16x32_bf16 v[168:171], v[120:123], v[100:103], v[168:171]
  buffer_store_dwordx4 v[160:163], v0, s[40:43], s6 offen offset:0 sc0 sc1
  v_mfma_f32_16x16x32_bf16 v[176:179], v[120:123], v[104:107], v[176:179]
  ds_read_b128 v[64:67], v5 offset:0
  v_mfma_f32_16x16x32_bf16 v[176:179], v[216:219], v[200:203], v[176:179]
  v_cvt_pk_bf16_f32 v166, v172, v173
  v_cvt_pk_bf16_f32 v167, v174, v175
  v_mfma_f32_16x16x32_bf16 v[180:183], v[220:223], v[200:203], v[180:183]
  s_nop 0
  s_nop 0
  v_cvt_pk_bf16_f32 v164, v168, v169
  v_cvt_pk_bf16_f32 v165, v170, v171
  v_mfma_f32_16x16x32_bf16 v[180:183], v[124:127], v[104:107], v[180:183]
  buffer_store_dwordx4 v[164:167], v0, s[40:43], s6 offen offset:2048 sc0 sc1
  ds_read_b128 v[68:71], v5 offset:2048
  v_mfma_f32_16x16x32_bf16 v[188:191], v[124:127], v[108:111], v[188:191]
  ds_read_b128 v[72:75], v5 offset:4096
  v_mfma_f32_16x16x32_bf16 v[188:191], v[220:223], v[204:207], v[188:191]
  v_cvt_pk_bf16_f32 v168, v176, v177
  v_cvt_pk_bf16_f32 v169, v178, v179
  v_mfma_f32_16x16x32_bf16 v[184:187], v[216:219], v[204:207], v[184:187]
  v_cvt_pk_bf16_f32 v170, v180, v181
  v_cvt_pk_bf16_f32 v171, v182, v183
  v_mfma_f32_16x16x32_bf16 v[184:187], v[120:123], v[108:111], v[184:187]
  buffer_store_dwordx4 v[168:171], v0, s[40:43], s7 offen offset:0 sc0 sc1
  ds_read_b128 v[76:79], v5 offset:6144
  v_mfma_f32_16x16x32_bf16 v[128:131], v[112:115], v[96:99], v[128:131]
  ds_read_b64_tr_b16 v[84:85], v7 offset:4096
  v_mfma_f32_16x16x32_bf16 v[128:131], v[208:211], v[192:195], v[128:131]
  v_cvt_pk_bf16_f32 v174, v188, v189
  v_cvt_pk_bf16_f32 v175, v190, v191
  v_mfma_f32_16x16x32_bf16 v[136:139], v[208:211], v[196:199], v[136:139]
  v_cvt_pk_bf16_f32 v172, v184, v185
  v_cvt_pk_bf16_f32 v173, v186, v187
  v_mfma_f32_16x16x32_bf16 v[136:139], v[112:115], v[100:103], v[136:139]
  buffer_store_dwordx4 v[172:175], v0, s[40:43], s7 offen offset:2048 sc0 sc1
  ds_read_b64_tr_b16 v[86:87], v7 offset:6144
  v_mfma_f32_16x16x32_bf16 v[144:147], v[112:115], v[104:107], v[144:147]
  v_subrev_u32 v4, 32768, v4
  v_mfma_f32_16x16x32_bf16 v[144:147], v[208:211], v[200:203], v[144:147]
  v_subrev_u32 v6, 0x10000, v6
  v_mfma_f32_16x16x32_bf16 v[152:155], v[208:211], v[204:207], v[152:155]
  v_subrev_u32 v7, 0x10000, v7
  v_mfma_f32_16x16x32_bf16 v[152:155], v[112:115], v[108:111], v[152:155]
  v_mfma_f32_16x16x32_bf16 v[156:159], v[116:119], v[108:111], v[156:159]
  v_mfma_f32_16x16x32_bf16 v[156:159], v[212:215], v[204:207], v[156:159]
  v_mfma_f32_16x16x32_bf16 v[148:151], v[212:215], v[200:203], v[148:151]
  v_mfma_f32_16x16x32_bf16 v[148:151], v[116:119], v[104:107], v[148:151]
  v_mfma_f32_16x16x32_bf16 v[140:143], v[116:119], v[100:103], v[140:143]
  v_mfma_f32_16x16x32_bf16 v[140:143], v[212:215], v[196:199], v[140:143]
  v_mfma_f32_16x16x32_bf16 v[132:135], v[212:215], v[192:195], v[132:135]
  s_waitcnt lgkmcnt(0)
  v_mfma_f32_16x16x32_bf16 v[132:135], v[116:119], v[96:99], v[132:135]
  s_barrier
  v_mfma_f32_16x16x32_bf16 v[128:131], v[48:51], v[32:35], v[128:131]
  ds_read_b64_tr_b16 v[112:113], v6 offset:0
  v_mfma_f32_16x16x32_bf16 v[128:131], v[80:83], v[64:67], v[128:131]
  ds_read_b64_tr_b16 v[114:115], v6 offset:2048
  v_mfma_f32_16x16x32_bf16 v[136:139], v[80:83], v[68:71], v[136:139]
  ds_read_b64_tr_b16 v[208:209], v6 offset:4096
  v_mfma_f32_16x16x32_bf16 v[136:139], v[48:51], v[36:39], v[136:139]
  ds_read_b64_tr_b16 v[210:211], v6 offset:6144
  v_mfma_f32_16x16x32_bf16 v[144:147], v[48:51], v[40:43], v[144:147]
  ds_read_b128 v[96:99], v4 offset:49152
  v_mfma_f32_16x16x32_bf16 v[144:147], v[80:83], v[72:75], v[144:147]
  ds_read_b128 v[192:195], v4 offset:50176
  v_mfma_f32_16x16x32_bf16 v[152:155], v[80:83], v[76:79], v[152:155]
  ds_read_b128 v[100:103], v4 offset:51200
  v_mfma_f32_16x16x32_bf16 v[152:155], v[48:51], v[44:47], v[152:155]
  ds_read_b128 v[196:199], v4 offset:52224
  v_mfma_f32_16x16x32_bf16 v[156:159], v[52:55], v[44:47], v[156:159]
  ds_read_b128 v[104:107], v4 offset:53248
  v_mfma_f32_16x16x32_bf16 v[156:159], v[84:87], v[76:79], v[156:159]
  ds_read_b128 v[200:203], v4 offset:54272
  v_mfma_f32_16x16x32_bf16 v[148:151], v[84:87], v[72:75], v[148:151]
  ds_read_b128 v[108:111], v4 offset:55296
  v_mfma_f32_16x16x32_bf16 v[148:151], v[52:55], v[40:43], v[148:151]
  ds_read_b128 v[204:207], v4 offset:56320
  v_mfma_f32_16x16x32_bf16 v[140:143], v[52:55], v[36:39], v[140:143]
  ds_read_b64_tr_b16 v[116:117], v7 offset:0
  v_mfma_f32_16x16x32_bf16 v[140:143], v[84:87], v[68:71], v[140:143]
  ds_read_b64_tr_b16 v[118:119], v7 offset:2048
  v_mfma_f32_16x16x32_bf16 v[132:135], v[84:87], v[64:67], v[132:135]
  ds_read_b64_tr_b16 v[212:213], v7 offset:4096
  ds_read_b64_tr_b16 v[214:215], v7 offset:6144
  v_mfma_f32_16x16x32_bf16 v[132:135], v[52:55], v[32:35], v[132:135]
  s_barrier
  s_waitcnt lgkmcnt(10)
  v_mfma_f32_16x16x32_bf16 v[128:131], v[112:115], v[96:99], v[128:131]
  ds_read_b64_tr_b16 v[48:49], v6 offset:16384
  v_mfma_f32_16x16x32_bf16 v[128:131], v[208:211], v[192:195], v[128:131]
  ds_read_b64_tr_b16 v[50:51], v6 offset:18432
  s_nop 0
  s_waitcnt lgkmcnt(10)
  v_mfma_f32_16x16x32_bf16 v[136:139], v[208:211], v[196:199], v[136:139]
  ds_read_b64_tr_b16 v[80:81], v6 offset:20480
  v_mfma_f32_16x16x32_bf16 v[136:139], v[112:115], v[100:103], v[136:139]
  ds_read_b64_tr_b16 v[82:83], v6 offset:22528
  s_nop 0
  s_waitcnt lgkmcnt(10)
  v_mfma_f32_16x16x32_bf16 v[144:147], v[112:115], v[104:107], v[144:147]
  ds_read_b128 v[32:35], v4 offset:0
  v_mfma_f32_16x16x32_bf16 v[144:147], v[208:211], v[200:203], v[144:147]
  ds_read_b128 v[64:67], v4 offset:1024
  s_nop 0
  s_waitcnt lgkmcnt(10)
  v_mfma_f32_16x16x32_bf16 v[152:155], v[208:211], v[204:207], v[152:155]
  ds_read_b128 v[36:39], v4 offset:2048
  v_mfma_f32_16x16x32_bf16 v[152:155], v[112:115], v[108:111], v[152:155]
  ds_read_b128 v[68:71], v4 offset:3072
  s_nop 0
  s_waitcnt lgkmcnt(8)
  v_mfma_f32_16x16x32_bf16 v[156:159], v[116:119], v[108:111], v[156:159]
  ds_read_b128 v[40:43], v4 offset:4096
  buffer_load_dwordx4 v[176:179], v0, s[40:43], s8 offen offset:0 sc0 sc1
  v_mfma_f32_16x16x32_bf16 v[156:159], v[212:215], v[204:207], v[156:159]
  ds_read_b128 v[72:75], v4 offset:5120
  v_mfma_f32_16x16x32_bf16 v[148:151], v[212:215], v[200:203], v[148:151]
  ds_read_b128 v[44:47], v4 offset:6144
  buffer_load_dwordx4 v[180:183], v0, s[40:43], s8 offen offset:2048 sc0 sc1
  v_mfma_f32_16x16x32_bf16 v[148:151], v[116:119], v[104:107], v[148:151]
  ds_read_b128 v[76:79], v4 offset:7168
  v_mfma_f32_16x16x32_bf16 v[140:143], v[116:119], v[100:103], v[140:143]
  ds_read_b64_tr_b16 v[52:53], v7 offset:16384
  buffer_load_dwordx4 v[184:187], v0, s[40:43], s9 offen offset:0 sc0 sc1
  v_mfma_f32_16x16x32_bf16 v[140:143], v[212:215], v[196:199], v[140:143]
  ds_read_b64_tr_b16 v[54:55], v7 offset:18432
  v_mfma_f32_16x16x32_bf16 v[132:135], v[212:215], v[192:195], v[132:135]
  ds_read_b64_tr_b16 v[84:85], v7 offset:20480
  ds_read_b64_tr_b16 v[86:87], v7 offset:22528
  buffer_load_dwordx4 v[188:191], v0, s[40:43], s9 offen offset:2048 sc0 sc1
  v_mfma_f32_16x16x32_bf16 v[132:135], v[116:119], v[96:99], v[132:135]
  s_barrier
  s_waitcnt lgkmcnt(10)
  v_mfma_f32_16x16x32_bf16 v[128:131], v[48:51], v[32:35], v[128:131]
  ds_read_b64_tr_b16 v[112:113], v6 offset:32768
  v_mfma_f32_16x16x32_bf16 v[128:131], v[80:83], v[64:67], v[128:131]
  ds_read_b64_tr_b16 v[114:115], v6 offset:34816
  s_nop 0
  s_waitcnt lgkmcnt(10)
  v_mfma_f32_16x16x32_bf16 v[136:139], v[80:83], v[68:71], v[136:139]
  ds_read_b64_tr_b16 v[208:209], v6 offset:36864
  v_mfma_f32_16x16x32_bf16 v[136:139], v[48:51], v[36:39], v[136:139]
  ds_read_b64_tr_b16 v[210:211], v6 offset:38912
  s_nop 0
  s_waitcnt lgkmcnt(10)
  v_mfma_f32_16x16x32_bf16 v[144:147], v[48:51], v[40:43], v[144:147]
  ds_read_b128 v[96:99], v4 offset:16384
  v_mfma_f32_16x16x32_bf16 v[144:147], v[80:83], v[72:75], v[144:147]
  ds_read_b128 v[192:195], v4 offset:17408
  s_nop 0
  s_waitcnt lgkmcnt(10)
  v_mfma_f32_16x16x32_bf16 v[152:155], v[80:83], v[76:79], v[152:155]
  ds_read_b128 v[100:103], v4 offset:18432
  v_mfma_f32_16x16x32_bf16 v[152:155], v[48:51], v[44:47], v[152:155]
  ds_read_b128 v[196:199], v4 offset:19456
  s_nop 0
  s_waitcnt lgkmcnt(8)
  v_mfma_f32_16x16x32_bf16 v[156:159], v[52:55], v[44:47], v[156:159]
  ds_read_b128 v[104:107], v4 offset:20480
  v_mfma_f32_16x16x32_bf16 v[156:159], v[84:87], v[76:79], v[156:159]
  ds_read_b128 v[200:203], v4 offset:21504
  v_mfma_f32_16x16x32_bf16 v[148:151], v[84:87], v[72:75], v[148:151]
  ds_read_b128 v[108:111], v4 offset:22528
  v_mfma_f32_16x16x32_bf16 v[148:151], v[52:55], v[40:43], v[148:151]
  ds_read_b128 v[204:207], v4 offset:23552
  v_mfma_f32_16x16x32_bf16 v[140:143], v[52:55], v[36:39], v[140:143]
  ds_read_b64_tr_b16 v[116:117], v7 offset:32768
  v_mfma_f32_16x16x32_bf16 v[140:143], v[84:87], v[68:71], v[140:143]
  ds_read_b64_tr_b16 v[118:119], v7 offset:34816
  v_mfma_f32_16x16x32_bf16 v[132:135], v[84:87], v[64:67], v[132:135]
  ds_read_b64_tr_b16 v[212:213], v7 offset:36864
  ds_read_b64_tr_b16 v[214:215], v7 offset:38912
  v_mfma_f32_16x16x32_bf16 v[132:135], v[52:55], v[32:35], v[132:135]
  s_waitcnt lgkmcnt(10)
  v_mfma_f32_16x16x32_bf16 v[128:131], v[112:115], v[96:99], v[128:131]
  v_mfma_f32_16x16x32_bf16 v[128:131], v[208:211], v[192:195], v[128:131]
  s_waitcnt lgkmcnt(8)
  v_mfma_f32_16x16x32_bf16 v[136:139], v[208:211], v[196:199], v[136:139]
  v_mfma_f32_16x16x32_bf16 v[136:139], v[112:115], v[100:103], v[136:139]
  s_waitcnt lgkmcnt(6)
  v_mfma_f32_16x16x32_bf16 v[144:147], v[112:115], v[104:107], v[144:147]
  v_mfma_f32_16x16x32_bf16 v[144:147], v[208:211], v[200:203], v[144:147]
  s_waitcnt lgkmcnt(4)
  v_mfma_f32_16x16x32_bf16 v[152:155], v[208:211], v[204:207], v[152:155]
  s_lshl_b32 s4, s76, Lz1-Lz0+4
  v_mfma_f32_16x16x32_bf16 v[152:155], v[112:115], v[108:111], v[152:155]
  s_add_u32 s4, s4, s78
  s_lshl_b32 s6, s4, 14
  s_waitcnt lgkmcnt(0)
  s_barrier
  v_mfma_f32_16x16x32_bf16 v[156:159], v[116:119], v[108:111], v[156:159]
  s_add_u32 s6, s6, 35651584
  s_add_u32 s7, s6, 4096
  v_mfma_f32_16x16x32_bf16 v[156:159], v[212:215], v[204:207], v[156:159]
  v_and_b32 v2, 15, v1
  v_lshlrev_b32 v3, 12, v2
  v_mfma_f32_16x16x32_bf16 v[148:151], v[212:215], v[200:203], v[148:151]
  v_and_b32_e64 v2, 16, v1
  v_lshl_add_u32 v3, v2, 1, v3
  v_mfma_f32_16x16x32_bf16 v[148:151], v[116:119], v[104:107], v[148:151]
  v_and_b32 v2, 32, v1
  v_lshrrev_b32 v2, 1, v2
  v_mfma_f32_16x16x32_bf16 v[140:143], v[116:119], v[100:103], v[140:143]
  v_add_u32 v3, v2, v3
  s_lshl_b32 s26, s76, 18
  v_mfma_f32_16x16x32_bf16 v[140:143], v[212:215], v[196:199], v[140:143]
  s_lshl_b32 s4, s85, 11
  s_add_u32 s26, s26, s4
  v_mfma_f32_16x16x32_bf16 v[132:135], v[212:215], v[192:195], v[132:135]
  s_lshl_b32 s4, s78, 7
  s_add_u32 s26, s26, s4
  v_mfma_f32_16x16x32_bf16 v[132:135], v[116:119], v[96:99], v[132:135]
  s_lshl_b32 s4, s86, 6
  s_add_u32 s26, s26, s4
  s_mov_b32 s89, 200000
  v_mov_b32_e64 v32, 0
  s_waitcnt vmcnt(0)
  s_mov_b64 exec, 1
  buffer_store_dword v27, off, s[40:43], s14 sc0 sc1
  s_mov_b64 exec, -1
Lx_31:
  v_cmpx_ne_u64 vcc, v[176:177], v[240:241]
  v_cmpx_ne_u64 vcc, v[178:179], v[242:243]
  v_cmpx_ne_u64 vcc, v[180:181], v[244:245]
  v_cmpx_ne_u64 vcc, v[182:183], v[246:247]
  v_cmpx_ne_u64 vcc, v[184:185], v[248:249]
  v_cmpx_ne_u64 vcc, v[186:187], v[250:251]
  v_cmpx_ne_u64 vcc, v[188:189], v[252:253]
  v_cmpx_ne_u64 vcc, v[190:191], v[254:255]
  s_cmp_eq_u64 exec, -1
  s_cbranch_scc0 Lx_30
Lx_32:
  s_nop 1
  v_mfma_f32_16x16x32_bf16 v[128:131], v[226:229], v[176:179], v[128:131]
  v_mfma_f32_16x16x32_bf16 v[132:135], v[224:227], v[176:179], v[132:135]
  v_mfma_f32_16x16x32_bf16 v[136:139], v[226:229], v[180:183], v[136:139]
  v_mfma_f32_16x16x32_bf16 v[140:143], v[224:227], v[180:183], v[140:143]
  v_mfma_f32_16x16x32_bf16 v[144:147], v[226:229], v[184:187], v[144:147]
  v_mfma_f32_16x16x32_bf16 v[148:151], v[224:227], v[184:187], v[148:151]
  v_mfma_f32_16x16x32_bf16 v[152:155], v[226:229], v[188:191], v[152:155]
  v_mfma_f32_16x16x32_bf16 v[156:159], v[224:227], v[188:191], v[156:159]
  s_cmp_lg_u32 s82, 0
  s_cbranch_scc1 L_cfinal
  v_cvt_pk_bf16_f32 v240, v128, v129
  v_cvt_pk_bf16_f32 v241, v130, v131
  v_cvt_pk_bf16_f32 v242, v132, v133
  v_cvt_pk_bf16_f32 v243, v134, v135
  buffer_store_dwordx4 v[240:243], v0, s[40:43], s6 offen offset:0 sc0 sc1
  v_cvt_pk_bf16_f32 v244, v136, v137
  v_cvt_pk_bf16_f32 v245, v138, v139
  v_cvt_pk_bf16_f32 v246, v140, v141
  v_cvt_pk_bf16_f32 v247, v142, v143
  buffer_store_dwordx4 v[244:247], v0, s[40:43], s6 offen offset:2048 sc0 sc1
  v_cvt_pk_bf16_f32 v248, v144, v145
  v_cvt_pk_bf16_f32 v249, v146, v147
  v_cvt_pk_bf16_f32 v250, v148, v149
  v_cvt_pk_bf16_f32 v251, v150, v151
  buffer_store_dwordx4 v[248:251], v0, s[40:43], s7 offen offset:0 sc0 sc1
  v_cvt_pk_bf16_f32 v252, v152, v153
  v_cvt_pk_bf16_f32 v253, v154, v155
  v_cvt_pk_bf16_f32 v254, v156, v157
  v_cvt_pk_bf16_f32 v255, v158, v159
  buffer_store_dwordx4 v[252:255], v0, s[40:43], s7 offen offset:2048 sc0 sc1
  s_lshl_b32 s5, s78, Lz1-Lz0+1
  v_mov_b32 v40, 0x3f803f80
  v_dot2_f32_bf16 v32, v240, v40, 0
  v_dot2_f32_bf16 v36, v240, v240, 0
  v_dot2_f32_bf16 v33, v244, v40, 0
  v_dot2_f32_bf16 v37, v244, v244, 0
  v_dot2_f32_bf16 v34, v248, v40, 0
  v_dot2_f32_bf16 v38, v248, v248, 0
  v_dot2_f32_bf16 v35, v252, v40, 0
  v_dot2_f32_bf16 v39, v252, v252, 0
  v_dot2_f32_bf16 v32, v241, v40, v32
  v_dot2_f32_bf16 v36, v241, v241, v36
  v_dot2_f32_bf16 v33, v245, v40, v33
  v_dot2_f32_bf16 v37, v245, v245, v37
  v_dot2_f32_bf16 v34, v249, v40, v34
  v_dot2_f32_bf16 v38, v249, v249, v38
  v_dot2_f32_bf16 v35, v253, v40, v35
  v_dot2_f32_bf16 v39, v253, v253, v39
  v_dot2_f32_bf16 v32, v242, v40, v32
  v_dot2_f32_bf16 v36, v242, v242, v36
  v_dot2_f32_bf16 v33, v246, v40, v33
  v_dot2_f32_bf16 v37, v246, v246, v37
  v_dot2_f32_bf16 v34, v250, v40, v34
  v_dot2_f32_bf16 v38, v250, v250, v38
  v_dot2_f32_bf16 v35, v254, v40, v35
  v_dot2_f32_bf16 v39, v254, v254, v39
  v_dot2_f32_bf16 v32, v243, v40, v32
  v_dot2_f32_bf16 v36, v243, v243, v36
  v_dot2_f32_bf16 v33, v247, v40, v33
  v_dot2_f32_bf16 v37, v247, v247, v37
  v_dot2_f32_bf16 v34, v251, v40, v34
  v_dot2_f32_bf16 v38, v251, v251, v38
  v_dot2_f32_bf16 v35, v255, v40, v35
  v_dot2_f32_bf16 v39, v255, v255, v39
  s_lshl_b32 s6, s76, Lz1-Lz0+9
  s_lshl_b32 s7, s85, 8
  s_add_u32 s6, s6, s7
  s_add_u32 s6, s6, s5
  s_add_u32 s6, s6, s86
  s_lshl_b32 s6, s6, 6
  s_add_u32 s6, s6, s83
  s_add_u32 s6, s6, 36700160
  v_permlane32_swap_b32 v32, v34
  v_permlane32_swap_b32 v33, v35
  v_permlane32_swap_b32 v36, v38
  v_permlane32_swap_b32 v37, v39
  v_add_f32 v32, v32, v34
  v_add_f32 v33, v33, v35
  v_add_f32 v36, v36, v38
  v_add_f32 v37, v37, v39
  v_permlane16_swap_b32 v32, v33
  s_nop 0
  v_permlane16_swap_b32 v36, v37
  v_add_f32 v42, v32, v33
  v_add_f32_e64 v43, v36, v37
  buffer_store_dwordx2 v[42:43], v30, s[40:43], s6 offen sc0 sc1
  s_add_u32 s5, s87, 0x10
  s_sub_u32 s4, s78, s77
  s_lshl_b32 s4, s4, 7
  s_add_u32 s5, s5, s4
  s_waitcnt vmcnt(0)
  s_mov_b64 exec, 1
  ds_add_rtn_u32 v2, v28, v27 offset:0
  s_waitcnt lgkmcnt(0)
  v_readfirstlane_b32 s4, v2
  s_and_b32 s4, s4, Lz1-Lz0+3
  s_cmp_lg_u32 s4, 3
  s_cbranch_scc1 Ls_33
  s_mov_b32 exec_lo, 0xffff
  buffer_store_dword v27, v24, s[40:43], s5 offen sc0 sc1
Ls_33:
  s_nop 0
  s_mov_b64 exec, -1
  ds_write_b128 v0, v[240:243] offset:0
  ds_write_b128 v0, v[244:247] offset:2048
  ds_write_b128 v0, v[248:251] offset:4096
  ds_write_b128 v0, v[252:255] offset:6144
  s_mov_b32 s82, 1
  s_add_u32 s83, s83, 0
  s_add_u32 s87, s87, 32
  s_branch L_clayer
  s_nop 0
L_cfinal:
  s_nop 1
  v_cvt_pk_bf16_f32 v240, v128, v129
  v_cvt_pk_bf16_f32 v241, v130, v131
  v_cvt_pk_bf16_f32 v242, v132, v133
  v_cvt_pk_bf16_f32 v243, v134, v135
  s_nop 0
  v_permlane16_swap_b32 v240, v242
  v_permlane16_swap_b32_e64 v241, v243
  buffer_store_dwordx4 v[240:243], v3, s[64:67], s26 offen sc0 sc1
  s_add_u32 s26, s26, 0x10000
  v_cvt_pk_bf16_f32 v244, v136, v137
  v_cvt_pk_bf16_f32 v245, v138, v139
  v_cvt_pk_bf16_f32 v246, v140, v141
  v_cvt_pk_bf16_f32 v247, v142, v143
  s_nop 0
  v_permlane16_swap_b32 v244, v246
  v_permlane16_swap_b32_e64 v245, v247
  buffer_store_dwordx4 v[244:247], v3, s[64:67], s26 offen sc0 sc1
  s_add_u32 s26, s26, 0x10000
  v_cvt_pk_bf16_f32 v248, v144, v145
  v_cvt_pk_bf16_f32 v249, v146, v147
  v_cvt_pk_bf16_f32 v250, v148, v149
  v_cvt_pk_bf16_f32 v251, v150, v151
  s_nop 0
  v_permlane16_swap_b32 v248, v250
  v_permlane16_swap_b32_e64 v249, v251
  buffer_store_dwordx4 v[248:251], v3, s[64:67], s26 offen sc0 sc1
  s_add_u32 s26, s26, 0x10000
  v_cvt_pk_bf16_f32 v252, v152, v153
  v_cvt_pk_bf16_f32 v253, v154, v155
  v_cvt_pk_bf16_f32 v254, v156, v157
  v_cvt_pk_bf16_f32 v255, v158, v159
  s_nop 0
  v_permlane16_swap_b32 v252, v254
  v_permlane16_swap_b32_e64 v253, v255
  buffer_store_dwordx4 v[252:255], v3, s[64:67], s26 offen sc0 sc1
  s_endpgm
Lo_6:
  s_mov_b64 vcc, 0
  s_waitcnt lgkmcnt(0)
  s_barrier
  ds_read_b128 v[64:67], v4 offset:0
  ds_read_b128 v[80:83], v5 offset:0
  ds_read_b128 v[68:71], v4 offset:2048
  ds_read_b128 v[84:87], v5 offset:2048
  ds_read_b128 v[72:75], v4 offset:4096
  ds_read_b128 v[88:91], v5 offset:4096
  ds_read_b64_tr_b16 v[96:97], v6 offset:0
  ds_read_b64_tr_b16 v[98:99], v6 offset:2048
  ds_read_b64_tr_b16 v[100:101], v6 offset:4096
  ds_read_b64_tr_b16 v[102:103], v6 offset:6144
  ds_read_b128 v[76:79], v4 offset:6144
  ds_read_b128 v[92:95], v5 offset:6144
  ds_read_b64_tr_b16 v[104:105], v7 offset:0
  s_nop 0
  s_waitcnt lgkmcnt(8)
  ds_read_b64_tr_b16 v[106:107], v7 offset:2048
  ds_read_b64_tr_b16 v[108:109], v7 offset:4096
  ds_read_b64_tr_b16 v[110:111], v7 offset:6144
  s_waitcnt lgkmcnt(6)
  s_branch Lk_3
Lo_8:
  s_waitcnt lgkmcnt(0)
  s_branch Lo_7
Lx_30:
  s_mov_b64 exec, -1
  v_readfirstlane_b32 s5, v32
  s_sub_u32 s89, s89, 1
  s_cbranch_scc1 Lx_32
  buffer_load_dword v32, off, s[40:43], s13 sc0 sc1
  buffer_load_dwordx4 v[176:179], v0, s[40:43], s8 offen offset:0 sc0 sc1
  buffer_load_dwordx4 v[180:183], v0, s[40:43], s8 offen offset:2048 sc0 sc1
  buffer_load_dwordx4 v[184:187], v0, s[40:43], s9 offen offset:0 sc0 sc1
  buffer_load_dwordx4 v[188:191], v0, s[40:43], s9 offen offset:2048 sc0 sc1
  s_waitcnt vmcnt(0)
  s_cmp_lg_u32 s5, 0
  s_cbranch_scc1 Lx_32
  s_branch Lx_31
  s_nop 0
L_w1:
  s_lshl_b32 s11, s85, 12
  s_add_u32 s11, s11, 65536
  s_add_u32 s15, s11, 81920
  s_add_u32 s11, s11, 32768
  v_readfirstlane_b32 s7, v38
  s_mov_b32 s12, 0
  s_mov_b32 m0, s11
  s_waitcnt vmcnt(12)
  s_barrier
  s_branch Ll_47
Lt_54:
  s_cmp_lg_u32 s12, 2
  s_cbranch_scc1 Lt_52
  s_waitcnt vmcnt(8)
  s_barrier
  s_branch Ll_47
Lt_52:
  s_cmp_lg_u32 s12, 4
  s_cbranch_scc1 Ll_47
  s_barrier
Ll_47:
  buffer_load_dwordx4 v4, s[52:55], s7 offen offset:0  lds
  s_mov_b32 s5, s7
  buffer_load_dwordx4 v5, s[52:55], s5 offen offset:1024  lds
  s_add_u32 s12, s12, 1
  v_readlane_b32 s7, v38, s12
  s_add_u32 s11, s11, 8192
  s_nop 0
  s_cmp_eq_u32 s11, s15
  buffer_load_dwordx4 v6, s[52:55], s5 offen offset:2048  lds
  s_cselect_b32 s4, 81920, 0
  s_sub_u32 s11, s11, s4
  s_cmp_lg_u32 s12, 10
  buffer_load_dwordx4 v7, s[52:55], s5 offen offset:3072  lds
  s_mov_b32 m0, s11
  s_cbranch_scc1 Lt_54
Lt_55:
  v_mov_b32 v2, 156416
  v_mov_b32_e64 v3, 1
  s_waitcnt vmcnt(16)
  s_mov_b64 exec, 1
  ds_add_u32 v2, v3 offset:8
  s_mov_b64 exec, -1
  s_barrier
Ll_49:
  buffer_load_dwordx4 v4, s[52:55], s7 offen offset:0  lds
  s_mov_b32 s5, s7
  buffer_load_dwordx4 v5, s[52:55], s5 offen offset:1024  lds
  s_add_u32 s12, s12, 1
  v_readlane_b32 s7, v38, s12
  s_add_u32 s11, s11, 8192
  s_nop 0
  s_cmp_eq_u32 s11, s15
  buffer_load_dwordx4 v6, s[52:55], s5 offen offset:2048  lds
  s_cselect_b32 s4, 81920, 0
  s_sub_u32 s11, s11, s4
  s_cmp_lg_u32 s12, 16
  buffer_load_dwordx4 v7, s[52:55], s5 offen offset:3072  lds
  s_mov_b32 m0, s11
  s_cbranch_scc1 Ll_49
  v_lshrrev_b32 v2, 3, v1
  s_movk_i32 s4, 7168
  v_mad_u32_u24 v32, v2, s4, v10
  v_add_u32 v33, 56320, v32
  v_add_u32 v34, 112640, v32
  v_add_u32 v35, 168960, v32
  v_lshrrev_b32 v2, 2, v1
  s_movk_i32 s4, 7168
  v_mul_u32_u24_e64 v2, s4, v2
  v_bfe_u32 v3, v10, 5, 1
  v_lshl_add_u32 v2, v3, 4, v2
  v_and_b32 v3, 1, v1
  v_lshlrev_b32 v3, 5, v3
  v_add_u32_e64 v8, v2, v3
  v_add_u32 v9, 113664, v8
  s_mul_i32 s5, s77, 448
  s_and_b32 s4, s77, Lz1-Lz0+1
  s_mul_i32 s94, s4, 448
  s_sub_u32 s94, 384, s94
  s_lshl_b32 s4, s4, 6
  s_add_u32 s5, s5, s4
  s_mul_i32 s4, s85, 229376
  s_add_u32 s5, s5, s4
  s_and_b32 s4, s76, 7
  s_add_u32 s6, s4, 1
  v_cmp_lt_u32 vcc, s6, v1
  v_add_u32 v12, s4, v1
  s_nop 0
  v_subbrev_co_u32 v12, vcc, 0, v12, vcc
  v_and_b32 v12, 7, v12
  v_subrev_u32 v2, 9, v1
  v_cmp_le_u32 vcc, s4, v2
  s_nop 1
  v_addc_co_u32 v2, vcc, 8, v2, vcc
  v_cmp_le_u32 vcc, 9, v1
  s_nop 1
  v_cndmask_b32 v12, v12, v2, vcc
  s_add_u32 s4, s4, 8
  s_mov_b32 m0, s6
  s_nop 0
  v_writelane_b32 v12, s4, m0
  s_and_b32 s4, s76, 8
  v_xor_b32 v12, s4, v12
  v_cmp_eq_u32 vcc, s78, v12
  s_nop 0
  v_mov_b32_dpp v2, v12 row_shr:1 row_mask:0xf bank_mask:0xf
  s_ff1_i32_b32 s4, vcc_lo
  v_cmp_ge_u32 vcc, s4, v1
  s_nop 1
  v_cndmask_b32 v12, v12, v2, vcc
  v_writelane_b32 v12, s78, 0
  s_mov_b32 s4, 458752
  v_mul_u32_u24 v12, s4, v12
  v_add_u32 v12, s5, v12
  s_nop 0
  v_readfirstlane_b32 s7, v12
  s_lshl_b32 s11, s85, Lz1-Lz0+12
  s_add_u32 s11, s11, 65536
  s_add_u32 s15, s11, 86016
  s_lshl_b32 s4, s85, Lz1-Lz0+11
  s_sub_u32 s13, 24576, s4
  s_mul_i32 s5, s85, 6144
  s_nop 0
  s_mov_b32 s68, s28
  s_and_b32 s69, s29, 0xffff
  s_mov_b32 s70, 7340032
  s_mov_b32 s71, 0x00020000
  s_lshl_b32 s4, s76, 4
  s_add_u32 s4, s4, s77
  s_mul_i32 s34, s4, 28672
  s_add_u32 s34, s34, s5
  v_lshlrev_b32 v15, 4, v1
  s_lshl_b32 s91, s85, Lz1-Lz0+13
  s_add_u32 s91, s91, 4096
  s_mul_i32 s4, s76, 262144
  s_add_u32 s4, s4, 3145728
  s_add_u32 s4, s4, s91
  v_lshl_add_u32 v14, v39, 14, s4
  s_mov_b32 s12, 4
Lh_56:
  v_readlane_b32 s90, v14, s12
  s_mov_b32 m0, s91
  s_cmp_lt_u32 s12, Lz1-Lz0+7
  s_cbranch_scc1 Lh_57
  s_waitcnt vmcnt(8)
Lh_57:
  s_barrier
  buffer_load_dwordx4 v15, s[40:43], s90 offen offset:0 sc1 lds
  s_add_u32 s91, s91, 16384
  s_and_b32 s91, s91, 0xffff
  buffer_load_dwordx4 v15, s[40:43], s90 offen offset:1024 sc1 lds
  s_add_u32 s12, s12, 1
  s_cmp_lg_u32 s12, 16
  buffer_load_dwordx4 v15, s[40:43], s90 offen offset:2048 sc1 lds
  buffer_load_dwordx4 v15, s[40:43], s90 offen offset:3072 sc1 lds
  s_cbranch_scc1 Lh_56
  s_mov_b32 s12, 0
  s_mov_b32 m0, s11
  s_branch Ll_58
Lt_64:
  s_cmp_lg_u32 s12, 1
  s_cbranch_scc1 Ll_58
  s_waitcnt vmcnt(18)
  s_barrier
Ll_58:
  buffer_load_dwordx4 v32, s[56:59], s7 offen offset:0  lds
  buffer_load_dwordx4 v33, s[56:59], s7 offen offset:1024  lds
  buffer_load_dwordx4 v34, s[56:59], s7 offen offset:2048  lds
  buffer_load_dwordx4 v35, s[56:59], s7 offen offset:3072  lds
  s_add_u32 m0, s11, s13
  s_add_u32 s5, s7, s94
  buffer_load_dwordx4 v8, s[56:59], s5 offen offset:0  lds
  buffer_load_dwordx4 v9, s[56:59], s5 offen offset:1024  lds
  s_cmp_ge_u32 s12, Lz1-Lz0+2
  s_cbranch_scc1 Lm_65
  s_waitcnt vmcnt(20)
  s_cmp_lg_u32 s12, 0
  s_cbranch_scc1 Lm_66
  s_waitcnt vmcnt(14)
Lm_66:
  s_barrier
Lm_65:
  s_add_u32 m0, s11, 8192
  s_add_u32 s5, s7, 128
  buffer_load_dwordx4 v32, s[56:59], s5 offen offset:0  lds
  buffer_load_dwordx4 v33, s[56:59], s5 offen offset:1024  lds
  buffer_load_dwordx4 v34, s[56:59], s5 offen offset:2048  lds
  buffer_load_dwordx4 v35, s[56:59], s5 offen offset:3072  lds
  s_add_u32 m0, s11, 16384
  s_add_u32 s5, s7, 256
  buffer_load_dwordx4 v32, s[56:59], s5 offen offset:0  lds
  s_add_u32 s12, s12, Lz1-Lz0+1
  v_readlane_b32 s7, v12, s12
  s_add_u32 s11, s11, 28672
  buffer_load_dwordx4 v33, s[56:59], s5 offen offset:1024  lds
  s_cmp_eq_u32 s11, s15
  s_cselect_b32 s4, 86016, 0
  s_sub_u32 s11, s11, s4
  buffer_load_dwordx4 v34, s[56:59], s5 offen offset:2048  lds
  s_cmp_lg_u32 s12, Lz1-Lz0+2
  buffer_load_dwordx4 v35, s[56:59], s5 offen offset:3072  lds
  s_mov_b32 m0, s11
  s_cbranch_scc1 Ll_59
  s_barrier
Lt_67:
  s_waitcnt vmcnt(0)
  s_barrier
Ll_68:
Ll_59:
  s_cmp_lt_u32 s12, 3
  s_cbranch_scc1 Lt_64
  s_cmp_lg_u32 s82, 0
  s_cbranch_scc1 L_69
  s_lshl_b32 s5, s78, 7
  s_mul_i32 s4, s79, 3670016
  s_add_u32 s5, s5, s4
  v_subrev_u32 v2, 2, v1
  v_cmp_le_u32 vcc, 28, v1
  s_nop 1
  v_cndmask_b32 v37, v1, v2, vcc
  v_subrev_u32 v3, 3, v37
  v_mov_b32 v36, 4
  v_cmp_le_u32 vcc, 14, v37
  v_subrev_u32 v2, 14, v37
  s_nop 0
  v_cndmask_b32_e64 v3, v3, v2, vcc
  v_cndmask_b32_e64 v36, v36, 12, vcc
  v_cmp_le_u32 vcc, 21, v37
  v_subrev_u32 v2, 21, v37
  s_nop 0
  v_cndmask_b32 v3, v3, v2, vcc
  v_cndmask_b32_e64 v36, v36, 20, vcc
  s_sub_u32 s4, s80, s76
  s_and_b32 s4, s4, 7
  v_cmp_le_u32 vcc, s4, v3
  v_mov_b32 v2, s76
  s_nop 0
  v_addc_co_u32 v3, vcc, v3, v2, vcc
  v_and_b32 v3, 7, v3
  v_add_u32 v36, v36, v3
  v_add_u32 v2, v2, v1
  v_and_b32 v2, 3, v2
  v_subrev_u32 v3, 10, v1
  v_cmp_gt_u32 vcc, 4, v3
  s_nop 1
  v_cndmask_b32 v36, v36, v2, vcc
  s_add_u32 s4, s80, Lz1-Lz0+4
  v_lshl_add_u32 v2, v1, 3, s4
  v_cmp_gt_u32 vcc, 3, v1
  s_nop 1
  v_cndmask_b32 v36, v36, v2, vcc
  v_subrev_u32 v2, 4, v36
  v_and_b32 v3, 7, v2
  v_lshrrev_b32 v2, 3, v2
  v_mad_u32_u24 v2, v3, 7, v2
  v_and_b32 v3, 1, v3
  v_add_u32 v2, v2, v3
  s_mul_i32 s4, s85, 3
  v_add_u32 v2, s4, v2
  s_add_u32 s4, s85, Lz1-Lz0+6
  v_mad_u32_u24 v3, v36, 14, s4
  v_cmp_gt_u32 vcc, 4, v36
  s_nop 1
  v_cndmask_b32_e64 v2, v2, v3, vcc
  v_lshl_add_u32 v36, v2, 16, s5
  s_mul_i32 s4, s79, 7340032
  s_sub_u32 s4, 3670016, s4
  v_add_u32 v2, s4, v36
  v_cmp_le_u32 vcc, 28, v1
  s_nop 1
  v_cndmask_b32 v36, v36, v2, vcc
L_69:
  s_waitcnt vmcnt(14)
  s_barrier
  buffer_load_dwordx4 v32, s[56:59], s7 offen offset:0  lds
  buffer_load_dwordx4 v33, s[56:59], s7 offen offset:1024  lds
  buffer_load_dwordx4 v34, s[56:59], s7 offen offset:2048  lds
  buffer_load_dwordx4 v35, s[56:59], s7 offen offset:3072  lds
Ll_70:
  s_add_u32 m0, s11, s13
  s_add_u32 s5, s7, s94
  buffer_load_dwordx4 v8, s[56:59], s5 offen offset:0  lds
  buffer_load_dwordx4 v9, s[56:59], s5 offen offset:1024  lds
  s_add_u32 m0, s11, 8192
  s_add_u32 s5, s7, 128
  buffer_load_dwordx4 v32, s[56:59], s5 offen offset:0  lds
  buffer_load_dwordx4 v33, s[56:59], s5 offen offset:1024  lds
  buffer_load_dwordx4 v34, s[56:59], s5 offen offset:2048  lds
  buffer_load_dwordx4 v35, s[56:59], s5 offen offset:3072  lds
  s_add_u32 m0, s11, 16384
  s_add_u32 s5, s7, 256
  buffer_load_dwordx4 v32, s[56:59], s5 offen offset:0  lds
  s_add_u32 s12, s12, Lz1-Lz0+1
  v_readlane_b32 s7, v12, s12
  s_add_u32 s11, s11, 28672
  buffer_load_dwordx4 v33, s[56:59], s5 offen offset:1024  lds
  s_cmp_eq_u32 s11, s15
  s_cselect_b32 s4, 86016, 0
  s_sub_u32 s11, s11, s4
  buffer_load_dwordx4 v34, s[56:59], s5 offen offset:2048  lds
  s_cmp_eq_u32 s12, Lz1-Lz0+16
  buffer_load_dwordx4 v35, s[56:59], s5 offen offset:3072  lds
  s_mov_b32 m0, s11
  s_cbranch_scc1 Ll_71
  s_cmp_lg_u32 s82, 0
  s_cbranch_scc1 L_72
  s_buffer_load_dwordx2 s[98:99], s[68:71], s34 offset:60
  s_buffer_load_dwordx2 s[98:99], s[68:71], s34 offset:188
  s_buffer_load_dwordx2 s[98:99], s[68:71], s34 offset:316
  s_buffer_load_dwordx2 s[98:99], s[68:71], s34 offset:444
  s_add_u32 s34, s34, 512
L_72:
  s_waitcnt vmcnt(14)
  s_barrier
  buffer_load_dwordx4 v32, s[56:59], s7 offen offset:0  lds
  buffer_load_dwordx4 v33, s[56:59], s7 offen offset:1024  lds
  buffer_load_dwordx4 v34, s[56:59], s7 offen offset:2048  lds
  buffer_load_dwordx4 v35, s[56:59], s7 offen offset:3072  lds
  s_branch Ll_70
Ll_71:
  s_lshl_b32 s94, s79, 8
  s_sub_u32 s94, 128, s94
  s_lshl_b32 s11, s85, Lz1-Lz0+12
  s_add_u32 s11, s11, 65536
  s_add_u32 s15, s11, 81920
  s_add_u32 s11, s11, 49152
  v_readfirstlane_b32 s7, v36
  s_mov_b32 s12, 0
  s_mov_b32 m0, s11
  s_waitcnt vmcnt(14)
  s_barrier
  s_waitcnt vmcnt(0)
  s_barrier
  s_branch Ll_73
  s_nop 0
Lt_79:
  s_cmp_lg_u32 s12, 2
  s_cbranch_scc1 Ll_73
  s_barrier
Ll_73:
  buffer_load_dwordx4 v4, s[60:63], s7 offen offset:0  lds
  buffer_load_dwordx4 v5, s[60:63], s7 offen offset:1024  lds
  buffer_load_dwordx4 v6, s[60:63], s7 offen offset:2048  lds
  buffer_load_dwordx4 v7, s[60:63], s7 offen offset:3072  lds
  s_add_u32 m0, s11, 8192
  s_add_u32 s5, s7, s94
  buffer_load_dwordx4 v4, s[60:63], s5 offen offset:0  lds
  s_add_u32 s12, s12, 1
  v_readlane_b32 s7, v36, s12
  s_add_u32 s11, s11, 16384
  buffer_load_dwordx4 v5, s[60:63], s5 offen offset:1024  lds
  s_cmp_eq_u32 s11, s15
  s_cselect_b32 s4, 81920, 0
  s_sub_u32 s11, s11, s4
  buffer_load_dwordx4 v6, s[60:63], s5 offen offset:2048  lds
  s_cmp_lg_u32 s12, Lz1-Lz0+5
  buffer_load_dwordx4 v7, s[60:63], s5 offen offset:3072  lds
  s_mov_b32 m0, s11
  s_cbranch_scc1 Lt_79
Lt_80:
  s_cmp_lg_u32 s82, 0
  s_cbranch_scc1 L_81
  v_lshrrev_b32 v2, 3, v1
  s_movk_i32 s4, 6144
  v_mad_u32_u24 v16, v2, s4, v10
  v_add_u32 v17, 48128, v16
  v_add_u32 v18, 96256, v16
  v_add_u32 v19, 144384, v16
  s_lshl_b32 s5, s77, Lz1-Lz0+7
  s_mul_i32 s4, s85, 196608
  s_add_u32 s5, s5, s4
  s_and_b32 s4, s76, 7
  s_add_u32 s6, s4, 1
  v_cmp_lt_u32 vcc, s6, v1
  v_add_u32 v20, s4, v1
  s_nop 0
  v_subbrev_co_u32 v20, vcc, 0, v20, vcc
  v_and_b32 v20, 7, v20
  v_subrev_u32 v2, 9, v1
  v_cmp_le_u32 vcc, s4, v2
  s_nop 1
  v_addc_co_u32 v2, vcc, 8, v2, vcc
  v_cmp_le_u32 vcc, 9, v1
  s_nop 1
  v_cndmask_b32 v20, v20, v2, vcc
  s_add_u32 s4, s4, 8
  s_mov_b32 m0, s6
  s_nop 0
  v_writelane_b32 v20, s4, m0
  s_and_b32 s4, s76, 8
  v_xor_b32 v20, s4, v20
  v_cmp_eq_u32 vcc, s78, v20
  s_nop 0
  v_mov_b32_dpp v2, v20 row_shr:1 row_mask:0xf bank_mask:0xf
  s_ff1_i32_b32 s4, vcc_lo
  v_cmp_ge_u32 vcc, s4, v1
  s_nop 1
  v_cndmask_b32 v20, v20, v2, vcc
  v_writelane_b32 v20, s78, 0
  s_mov_b32 s4, 393216
  v_mul_u32_u24_e64 v20, s4, v20
  v_add_u32 v20, s5, v20
  s_mov_b32 m0, s11
L_81:
  s_waitcnt vmcnt(32)
  s_barrier
Ll_82:
  s_waitcnt vmcnt(24)
  s_barrier
  buffer_load_dwordx4 v4, s[60:63], s7 offen offset:0  lds
  buffer_load_dwordx4 v5, s[60:63], s7 offen offset:1024  lds
  buffer_load_dwordx4 v6, s[60:63], s7 offen offset:2048  lds
  buffer_load_dwordx4 v7, s[60:63], s7 offen offset:3072  lds
Ll_83:
  s_add_u32 m0, s11, 8192
  s_add_u32 s5, s7, s94
  buffer_load_dwordx4 v4, s[60:63], s5 offen offset:0  lds
  s_add_u32 s12, s12, 1
  v_readlane_b32 s7, v36, s12
  s_add_u32 s11, s11, 16384
  buffer_load_dwordx4 v5, s[60:63], s5 offen offset:1024  lds
  s_cmp_eq_u32 s11, s15
  s_cselect_b32 s4, 81920, 0
  s_sub_u32 s11, s11, s4
  buffer_load_dwordx4 v6, s[60:63], s5 offen offset:2048  lds
  s_cmp_eq_u32 s12, Lz1-Lz0+26
  buffer_load_dwordx4 v7, s[60:63], s5 offen offset:3072  lds
  s_mov_b32 m0, s11
  s_cbranch_scc1 Ll_84
  s_waitcnt vmcnt(24)
  s_barrier
  buffer_load_dwordx4 v4, s[60:63], s7 offen offset:0  lds
  buffer_load_dwordx4 v5, s[60:63], s7 offen offset:1024  lds
  buffer_load_dwordx4 v6, s[60:63], s7 offen offset:2048  lds
  buffer_load_dwordx4 v7, s[60:63], s7 offen offset:3072  lds
  s_branch Ll_83
  s_nop 0
Ll_84:
  s_waitcnt vmcnt(24)
  s_barrier
  buffer_load_dwordx4 v4, s[60:63], s7 offen offset:0  lds
Ll_85:
  s_mov_b32 s5, s7
  buffer_load_dwordx4 v5, s[60:63], s5 offen offset:1024  lds
  s_add_u32 s12, s12, 1
  v_readlane_b32 s7, v36, s12
  s_add_u32 s11, s11, 16384
  s_nop 0
  s_cmp_eq_u32 s11, s15
  buffer_load_dwordx4 v6, s[60:63], s5 offen offset:2048  lds
  s_cselect_b32 s4, 81920, 0
  s_sub_u32 s11, s11, s4
  s_cmp_eq_u32 s12, 30
  buffer_load_dwordx4 v7, s[60:63], s5 offen offset:3072  lds
  s_mov_b32 m0, s11
  s_cbranch_scc1 Ll_86
  s_waitcnt vmcnt(12)
  s_barrier
  buffer_load_dwordx4 v4, s[60:63], s7 offen offset:0  lds
  s_branch Ll_85
  s_nop 0
Ll_86:
  v_readfirstlane_b32 s7, v20
  s_lshl_b32 s11, s85, 12
  s_add_u32 s11, s11, 65536
  s_add_u32 s15, s11, 73728
  s_cmp_eq_u32 s82, 0
  s_mov_b32 s82, 1
  s_cbranch_scc1 L_wlayer
  s_waitcnt vmcnt(12)
  s_barrier
  s_waitcnt vmcnt(8)
  s_barrier
  s_waitcnt vmcnt(4)
  s_barrier
  s_waitcnt vmcnt(0)
  s_barrier
  s_barrier
  s_branch L_lend
  s_nop 0
L_x1:
  s_and_b32 s4, s77, 7
  s_lshr_b32 s5, s77, 3
  s_lshl1_add_u32 s4, s4, s5
  s_lshl_b32 s5, s76, 11
  s_add_u32 s4, s4, s5
  s_lshl_b32 s7, s4, 7
  s_movk_i32 s11, 16384
  s_mov_b32 m0, s11
  s_cmp_eq_u32 s82, 0
  s_waitcnt vmcnt(16)
  s_barrier
  s_cbranch_scc1 L_96
  s_waitcnt vmcnt(0)
  s_barrier
  s_barrier
  s_branch L_97
L_96:
  buffer_load_dwordx4 v4, s[72:75], s7 offen offset:0 sc1 lds
  buffer_load_dwordx4 v5, s[72:75], s7 offen offset:1024 sc1 lds
  buffer_load_dwordx4 v6, s[72:75], s7 offen offset:2048 sc1 lds
  buffer_load_dwordx4 v7, s[72:75], s7 offen offset:3072 sc1 lds
  s_add_u32 m0, s11, 4096
  s_nop 0
  s_add_u32 s5, s7, s13
  buffer_load_dwordx4 v4, s[72:75], s5 offen offset:0 sc1 lds
  buffer_load_dwordx4 v5, s[72:75], s5 offen offset:1024 sc1 lds
  buffer_load_dwordx4 v6, s[72:75], s5 offen offset:2048 sc1 lds
  buffer_load_dwordx4 v7, s[72:75], s5 offen offset:3072 sc1 lds
  s_add_u32 m0, s11, 8192
  s_nop 0
  s_add_u32 s3, s7, s95
  buffer_load_dwordx4 v4, s[72:75], s3 offen offset:0 sc1 lds
  buffer_load_dwordx4 v5, s[72:75], s3 offen offset:1024 sc1 lds
  buffer_load_dwordx4 v6, s[72:75], s3 offen offset:2048 sc1 lds
  buffer_load_dwordx4 v7, s[72:75], s3 offen offset:3072 sc1 lds
  s_add_u32 m0, s11, 12288
  s_nop 0
  s_add_u32 s5, s3, s13
  buffer_load_dwordx4 v4, s[72:75], s5 offen offset:0 sc1 lds
  buffer_load_dwordx4 v5, s[72:75], s5 offen offset:1024 sc1 lds
  buffer_load_dwordx4 v6, s[72:75], s5 offen offset:2048 sc1 lds
  buffer_load_dwordx4 v7, s[72:75], s5 offen offset:3072 sc1 lds
  s_waitcnt vmcnt(16)
  s_barrier
  s_waitcnt vmcnt(0)
  s_barrier
L_97:
  s_cmp_lg_u32 s82, 0
  s_cbranch_scc1 L_98
  s_and_b32 s80, s77, 7
  s_lshr_b32 s79, s77, 3
  s_lshl_b32 s78, s80, 1
  s_add_u32 s78, s78, s79
  s_lshl_b32 s5, s76, 4
  s_add_u32 s5, s5, s77
  s_lshl_b32 s84, s5, Lz1-Lz0+11
  s_mov_b32 s83, 3145728
  s_mov_b32 s87, 1835016
  s_lshr_b32 s86, s81, 1
  v_lshlrev_b32 v4, 4, v1
  v_lshlrev_b32 v5, 4, v1
  v_lshlrev_b32 v6, 4, v1
  v_lshlrev_b32 v7, 4, v1
  s_movk_i32 s13, 4096
  s_movk_i32 s95, 8192
  v_and_b32 v2, 31, v1
  v_lshlrev_b32 v8, 7, v2
L_98:
  s_mov_b32 s40, s38
  s_and_b32 s41, s39, 0xffff
  s_mov_b32 s42, 100663296
  s_mov_b32 s43, 0x00020000
  s_mov_b32 s72, s40
  s_mov_b32 s73, s41
  s_mov_b32 s74, s42
  s_mov_b32 s11, 0
  s_mov_b32 s15, 65536
  s_mul_i32 s5, s76, 16
  s_lshl_b32 s5, s5, 14
  s_add_u32 s5, s5, 3145728
  s_mul_i32 s4, s76, 14
  s_lshr_b32 s4, s4, 4
  v_add_u32 v9, s4, v1
  v_subrev_u32 v2, 14, v9
  v_min_u32 v9, v9, v2
  v_cmp_le_u32 vcc, 14, v1
  s_nop 1
  v_cndmask_b32 v9, v9, v1, vcc
  v_lshlrev_b32_e64 v9, 2, v9
  v_mov_b32 v2, 0x87654210
  v_mov_b32 v3, 0xb3fedca9
  v_lshrrev_b64 v[2:3], v9, v[2:3]
  v_and_b32_e64 v9, 15, v2
  v_cmp_eq_u32 vcc, s77, v9
  s_nop 0
  v_mov_b32_dpp v2, v9 row_shr:1 row_mask:0xf bank_mask:0xf
  s_ff1_i32_b32 s4, vcc_lo
  v_cmp_ge_u32 vcc, s4, v1
  s_nop 1
  v_cndmask_b32 v9, v9, v2, vcc
  v_writelane_b32 v9, s77, 0
  v_lshlrev_b32 v11, 7, v9
  v_lshl_add_u32 v9, v9, 14, s5
  s_nop 0
  v_readlane_b32 s7, v9, 1
  s_mov_b32 s11, 16384
  s_mov_b32 s90, 0xfe
  s_lshl_b32 s91, s84, Lz1-Lz0+1
  s_add_u32 s91, s91, s87
  s_barrier
  s_mov_b32 s89, 200000
  s_mov_b32 exec_lo, s90
  s_mov_b32 exec_hi, 0
  buffer_load_dword v12, v11, s[40:43], s91 offen sc0 sc1
Lp_99:
  s_waitcnt vmcnt(0)
  v_cmp_ne_u32 vcc, 0, v12
  s_andn2_b32 s3, exec_lo, vcc_lo
  s_cbranch_scc0 Lp_100
  s_mov_b32 exec_lo, s3
  s_sleep 1
  buffer_load_dword v12, v11, s[40:43], s91 offen sc0 sc1
  s_sub_u32 s89, s89, 1
  s_cbranch_scc0 Lp_99
Lp_100:
  s_mov_b64 exec, -1
  s_mov_b32 s12, 1
  s_mov_b32 m0, s11
Ll_102:
  s_nop 0
  buffer_load_dwordx4 v4, s[40:43], s7 offen offset:0 sc1 lds
  buffer_load_dwordx4 v5, s[40:43], s7 offen offset:1024 sc1 lds
  buffer_load_dwordx4 v6, s[40:43], s7 offen offset:2048 sc1 lds
  buffer_load_dwordx4 v7, s[40:43], s7 offen offset:3072 sc1 lds
  s_add_u32 m0, s11, 4096
  s_nop 0
  s_add_u32 s5, s7, s13
  buffer_load_dwordx4 v4, s[40:43], s5 offen offset:0 sc1 lds
  buffer_load_dwordx4 v5, s[40:43], s5 offen offset:1024 sc1 lds
  buffer_load_dwordx4 v6, s[40:43], s5 offen offset:2048 sc1 lds
  buffer_load_dwordx4 v7, s[40:43], s5 offen offset:3072 sc1 lds
  s_add_u32 m0, s11, 8192
  s_nop 0
  s_add_u32 s3, s7, s95
  buffer_load_dwordx4 v4, s[40:43], s3 offen offset:0 sc1 lds
  buffer_load_dwordx4 v5, s[40:43], s3 offen offset:1024 sc1 lds
  buffer_load_dwordx4 v6, s[40:43], s3 offen offset:2048 sc1 lds
  buffer_load_dwordx4 v7, s[40:43], s3 offen offset:3072 sc1 lds
  s_add_u32 m0, s11, 12288
  s_add_u32 s5, s3, s13
  buffer_load_dwordx4 v4, s[40:43], s5 offen offset:0 sc1 lds
  s_add_u32 s12, s12, 1
  v_readlane_b32 s7, v9, s12
  s_add_u32 s11, s11, 16384
  buffer_load_dwordx4 v5, s[40:43], s5 offen offset:1024 sc1 lds
  s_cmp_eq_u32 s11, s15
  s_cselect_b32 s4, 65536, 0
  s_sub_u32 s11, s11, s4
  buffer_load_dwordx4 v6, s[40:43], s5 offen offset:2048 sc1 lds
  s_cmp_lg_u32 s12, Lz1-Lz0+4
  buffer_load_dwordx4 v7, s[40:43], s5 offen offset:3072 sc1 lds
  s_mov_b32 m0, s11
  s_cbranch_scc1 Ll_102
  s_waitcnt vmcnt(32)
  s_barrier
  buffer_load_dwordx4 v4, s[40:43], s7 offen offset:0 sc1 lds
  buffer_load_dwordx4 v5, s[40:43], s7 offen offset:1024 sc1 lds
  buffer_load_dwordx4 v6, s[40:43], s7 offen offset:2048 sc1 lds
  buffer_load_dwordx4 v7, s[40:43], s7 offen offset:3072 sc1 lds
  s_add_u32 m0, s11, 8192
  s_add_u32 s3, s7, s95
  buffer_load_dwordx4 v4, s[40:43], s3 offen offset:0 sc1 lds
  s_add_u32 s12, s12, 1
  v_readlane_b32 s7, v9, s12
  buffer_load_dwordx4 v5, s[40:43], s3 offen offset:1024 sc1 lds
  s_add_u32 s11, s11, 16384
  s_nop 0
  s_cmp_eq_u32 s11, s15
  buffer_load_dwordx4 v6, s[40:43], s3 offen offset:2048 sc1 lds
  s_cselect_b32 s4, 65536, 0
  s_sub_u32 s11, s11, s4
  buffer_load_dwordx4 v7, s[40:43], s3 offen offset:3072 sc1 lds
  s_mov_b32 m0, s11
  s_waitcnt vmcnt(24)
  s_barrier
  buffer_load_dwordx4 v4, s[40:43], s7 offen offset:0 sc1 lds
  buffer_load_dwordx4 v5, s[40:43], s7 offen offset:1024 sc1 lds
  buffer_load_dwordx4 v6, s[40:43], s7 offen offset:2048 sc1 lds
  buffer_load_dwordx4 v7, s[40:43], s7 offen offset:3072 sc1 lds
Ll_107:
  s_add_u32 m0, s11, 8192
  s_add_u32 s3, s7, s95
  buffer_load_dwordx4 v4, s[40:43], s3 offen offset:0 sc1 lds
  s_add_u32 s12, s12, 1
  v_readlane_b32 s7, v9, s12
  s_add_u32 s11, s11, 16384
  buffer_load_dwordx4 v5, s[40:43], s3 offen offset:1024 sc1 lds
  s_cmp_eq_u32 s11, s15
  s_cselect_b32 s4, 65536, 0
  s_sub_u32 s11, s11, s4
  buffer_load_dwordx4 v6, s[40:43], s3 offen offset:2048 sc1 lds
  s_cmp_eq_u32 s12, Lz1-Lz0+16
  buffer_load_dwordx4 v7, s[40:43], s3 offen offset:3072 sc1 lds
  s_mov_b32 m0, s11
  s_cbranch_scc1 Ll_108
  s_waitcnt vmcnt(16)
  s_barrier
  buffer_load_dwordx4 v4, s[40:43], s7 offen offset:0 sc1 lds
  buffer_load_dwordx4 v5, s[40:43], s7 offen offset:1024 sc1 lds
  buffer_load_dwordx4 v6, s[40:43], s7 offen offset:2048 sc1 lds
  buffer_load_dwordx4 v7, s[40:43], s7 offen offset:3072 sc1 lds
  s_branch Ll_107
  s_nop 0
Ll_108:
  s_waitcnt vmcnt(16)
  s_barrier
  s_waitcnt vmcnt(8)
  s_barrier
  s_waitcnt vmcnt(0)
  s_barrier
  s_barrier
  s_mov_b32 s11, 0
  s_mov_b32 s15, 65536
  s_mul_i32 s5, s76, 16
  s_lshl_b32 s5, s5, 14
  s_add_u32 s5, s5, 7340032
  s_and_b32 s4, s76, 7
  s_add_u32 s6, s4, 1
  v_cmp_lt_u32 vcc, s6, v1
  v_add_u32 v9, s4, v1
  s_nop 0
  v_subbrev_co_u32 v9, vcc, 0, v9, vcc
  v_and_b32 v9, 7, v9
  v_subrev_u32 v2, 9, v1
  v_cmp_le_u32 vcc, s4, v2
  s_nop 1
  v_addc_co_u32 v2, vcc, 8, v2, vcc
  v_cmp_le_u32 vcc, 9, v1
  s_nop 1
  v_cndmask_b32 v9, v9, v2, vcc
  s_add_u32 s4, s4, Lz1-Lz0+8
  s_mov_b32 m0, s6
  s_nop 0
  v_writelane_b32 v9, s4, m0
  s_and_b32 s4, s76, 8
  v_xor_b32 v9, s4, v9
  v_cmp_eq_u32 vcc, s78, v9
  s_nop 0
  v_mov_b32_dpp v2, v9 row_shr:1 row_mask:0xf bank_mask:0xf
  s_ff1_i32_b32 s4, vcc_lo
  v_cmp_ge_u32 vcc, s4, v1
  s_nop 1
  v_cndmask_b32 v9, v9, v2, vcc
  v_writelane_b32 v9, s78, 0
  v_lshlrev_b32_e64 v11, 7, v9
  v_lshl_add_u32 v9, v9, 14, s5
  s_lshl_b32 s6, s76, Lz1-Lz0+14
  v_readlane_b32 s7, v9, 1
  s_mov_b32 s11, 16384
  s_mov_b32 s90, Lz1-Lz0+62
  s_add_u32 s91, s91, 4
  s_barrier
  s_mov_b32 s89, 200000
  s_mov_b32 exec_lo, s90
  s_mov_b32 exec_hi, 0
  buffer_load_dword v12, v11, s[40:43], s91 offen sc0 sc1
Lp_109:
  s_waitcnt vmcnt(0)
  v_cmp_ne_u32 vcc, 0, v12
  s_andn2_b32 s3, exec_lo, vcc_lo
  s_cbranch_scc0 Lp_110
  s_mov_b32 exec_lo, s3
  s_sleep 1
  buffer_load_dword v12, v11, s[40:43], s91 offen sc0 sc1
  s_sub_u32 s89, s89, 1
  s_cbranch_scc0 Lp_109
Lp_110:
  s_mov_b64 exec, -1
  s_mov_b32 s12, 1
  s_mov_b32 m0, s11
Ll_112:
  s_nop 0
  buffer_load_dwordx4 v4, s[72:75], s7 offen offset:0 sc1 lds
  buffer_load_dwordx4 v5, s[72:75], s7 offen offset:1024 sc1 lds
  buffer_load_dwordx4 v6, s[72:75], s7 offen offset:2048 sc1 lds
  buffer_load_dwordx4 v7, s[72:75], s7 offen offset:3072 sc1 lds
  s_add_u32 m0, s11, 4096
  s_nop 0
  s_add_u32 s5, s7, s13
  buffer_load_dwordx4 v4, s[72:75], s5 offen offset:0 sc1 lds
  buffer_load_dwordx4 v5, s[72:75], s5 offen offset:1024 sc1 lds
  buffer_load_dwordx4 v6, s[72:75], s5 offen offset:2048 sc1 lds
  buffer_load_dwordx4 v7, s[72:75], s5 offen offset:3072 sc1 lds
  s_add_u32 m0, s11, 8192
  s_nop 0
  s_add_u32 s3, s7, s95
  buffer_load_dwordx4 v4, s[72:75], s3 offen offset:0 sc1 lds
  buffer_load_dwordx4 v5, s[72:75], s3 offen offset:1024 sc1 lds
  buffer_load_dwordx4 v6, s[72:75], s3 offen offset:2048 sc1 lds
  buffer_load_dwordx4 v7, s[72:75], s3 offen offset:3072 sc1 lds
  s_add_u32 m0, s11, 12288
  s_add_u32 s5, s3, s13
  buffer_load_dwordx4 v4, s[72:75], s5 offen offset:0 sc1 lds
  s_add_u32 s12, s12, 1
  v_readlane_b32 s7, v9, s12
  s_add_u32 s11, s11, 16384
  buffer_load_dwordx4 v5, s[72:75], s5 offen offset:1024 sc1 lds
  s_cmp_eq_u32 s11, s15
  s_cselect_b32 s4, 65536, 0
  s_sub_u32 s11, s11, s4
  buffer_load_dwordx4 v6, s[72:75], s5 offen offset:2048 sc1 lds
  s_cmp_lg_u32 s12, Lz1-Lz0+4
  buffer_load_dwordx4 v7, s[72:75], s5 offen offset:3072 sc1 lds
  s_mov_b32 m0, s11
  s_cbranch_scc1 Ll_112
  s_waitcnt vmcnt(32)
  s_barrier
  buffer_load_dwordx4 v4, s[72:75], s7 offen offset:0 sc1 lds
  buffer_load_dwordx4 v5, s[72:75], s7 offen offset:1024 sc1 lds
  buffer_load_dwordx4 v6, s[72:75], s7 offen offset:2048 sc1 lds
  buffer_load_dwordx4 v7, s[72:75], s7 offen offset:3072 sc1 lds
Ll_117:
  s_add_u32 m0, s11, 4096
  s_nop 0
  s_add_u32 s5, s7, s13
  buffer_load_dwordx4 v4, s[72:75], s5 offen offset:0 sc1 lds
  buffer_load_dwordx4 v5, s[72:75], s5 offen offset:1024 sc1 lds
  buffer_load_dwordx4 v6, s[72:75], s5 offen offset:2048 sc1 lds
  buffer_load_dwordx4 v7, s[72:75], s5 offen offset:3072 sc1 lds
  s_add_u32 m0, s11, 8192
  s_nop 0
  s_add_u32 s3, s7, s95
  buffer_load_dwordx4 v4, s[72:75], s3 offen offset:0 sc1 lds
  buffer_load_dwordx4 v5, s[72:75], s3 offen offset:1024 sc1 lds
  buffer_load_dwordx4 v6, s[72:75], s3 offen offset:2048 sc1 lds
  buffer_load_dwordx4 v7, s[72:75], s3 offen offset:3072 sc1 lds
  s_add_u32 m0, s11, 12288
  s_add_u32 s5, s3, s13
  buffer_load_dwordx4 v4, s[72:75], s5 offen offset:0 sc1 lds
  s_add_u32 s12, s12, 1
  v_readlane_b32 s7, v9, s12
  s_add_u32 s11, s11, 16384
  buffer_load_dwordx4 v5, s[72:75], s5 offen offset:1024 sc1 lds
  s_cmp_eq_u32 s11, s15
  s_cselect_b32 s4, 65536, 0
  s_sub_u32 s11, s11, s4
  buffer_load_dwordx4 v6, s[72:75], s5 offen offset:2048 sc1 lds
  s_cmp_eq_u32 s12, Lz1-Lz0+16
  buffer_load_dwordx4 v7, s[72:75], s5 offen offset:3072 sc1 lds
  s_mov_b32 m0, s11
  s_cbranch_scc1 Ll_118
  s_waitcnt vmcnt(32)
  s_barrier
  buffer_load_dwordx4 v4, s[72:75], s7 offen offset:0 sc1 lds
  buffer_load_dwordx4 v5, s[72:75], s7 offen offset:1024 sc1 lds
  buffer_load_dwordx4 v6, s[72:75], s7 offen offset:2048 sc1 lds
  buffer_load_dwordx4 v7, s[72:75], s7 offen offset:3072 sc1 lds
  s_branch Ll_117
  s_nop 0
Ll_118:
  s_waitcnt vmcnt(32)
  s_barrier
  s_waitcnt vmcnt(16)
  s_barrier
  s_waitcnt vmcnt(0)
  s_barrier
  s_barrier
  s_mov_b32 s11, 0
  s_mov_b32 s15, 65536
  s_mul_i32 s5, s76, 56
  s_mul_i32 s4, s79, 28
  s_add_u32 s5, s5, s4
  s_lshl_b32 s5, s5, 14
  s_add_u32 s5, s5, 11534336
  v_subrev_u32 v2, 2, v1
  v_cmp_le_u32 vcc, 28, v1
  s_nop 1
  v_cndmask_b32 v10, v1, v2, vcc
  v_subrev_u32 v3, 3, v10
  v_mov_b32 v9, 4
  v_cmp_le_u32 vcc, 14, v10
  v_subrev_u32 v2, 14, v10
  s_nop 0
  v_cndmask_b32 v3, v3, v2, vcc
  v_cndmask_b32_e64 v9, v9, 12, vcc
  v_cmp_le_u32 vcc, 21, v10
  v_subrev_u32 v2, 21, v10
  s_nop 0
  v_cndmask_b32 v3, v3, v2, vcc
  v_cndmask_b32_e64 v9, v9, 20, vcc
  s_sub_u32 s4, s80, s76
  s_and_b32 s4, s4, 7
  v_cmp_le_u32 vcc, s4, v3
  v_mov_b32 v2, s76
  s_nop 0
  v_addc_co_u32 v3, vcc, v3, v2, vcc
  v_and_b32 v3, 7, v3
  v_add_u32 v9, v9, v3
  v_add_u32 v2, v2, v1
  v_and_b32 v2, 3, v2
  v_subrev_u32 v3, 10, v1
  v_cmp_gt_u32 vcc, 4, v3
  s_nop 1
  v_cndmask_b32 v9, v9, v2, vcc
  s_add_u32 s4, s80, Lz1-Lz0+4
  v_lshl_add_u32 v2, v1, 3, s4
  v_cmp_gt_u32 vcc, 3, v1
  s_nop 1
  v_cndmask_b32_e64 v9, v9, v2, vcc
  v_lshl_add_u32 v9, v9, 14, s5
  s_mul_i32 s4, s79, 917504
  s_sub_u32 s4, 458752, s4
  v_add_u32_e64 v2, s4, v9
  v_cmp_le_u32 vcc, 28, v1
  s_nop 1
  v_cndmask_b32 v9, v9, v2, vcc
  s_nop 0
  v_readlane_b32 s7, v9, 3
  s_mov_b32 s11, 49152
  s_add_u32 s91, s91, 4
  s_lshl_b32 s4, s79, 3
  s_lshl_b32 s90, 0xff, s4
  s_bitset0_b32 s90, s77
  v_mov_b32 v2, 156420
  s_lshl_b32 s5, s82, 2
  s_add_u32 s5, s5, Lz1-Lz0+1
  s_mov_b32 s89, 200000
  s_mov_b32 s92, 1
  s_mov_b32 exec_lo, s90
  s_mov_b32 exec_hi, Lz1-Lz0+0
  buffer_load_dword v12, v8, s[40:43], s91 offen sc0 sc1
Lp_119:
  s_waitcnt vmcnt(0)
  v_cmp_ne_u32 vcc, 0, v12
  s_andn2_b32 s3, exec_lo, vcc_lo
  s_cbranch_scc0 Lp_121
  s_mov_b32 exec_lo, s3
  s_cmp_eq_u32 s92, 0
  s_cbranch_scc1 Lp_120
  ds_read_b32 v3, v2
  s_waitcnt lgkmcnt(0)
  buffer_load_dword v12, v8, s[40:43], s91 offen sc0 sc1
  v_readfirstlane_b32 s4, v3
  s_cmp_lt_u32 s4, s5
  s_cbranch_scc1 Lp_122
  s_mov_b32 s92, 0
  s_barrier
  s_branch Lp_122
  s_nop 0
Lp_120:
  s_sleep 1
  buffer_load_dword v12, v8, s[40:43], s91 offen sc0 sc1
Lp_122:
  s_sub_u32 s89, s89, 1
  s_cbranch_scc0 Lp_119
Lp_121:
  s_mov_b64 exec, -1
  s_cmp_eq_u32 s92, 0
  s_cbranch_scc1 Lp_123
  s_barrier
Lp_123:
  s_mov_b32 s12, Lz1-Lz0+3
  s_mov_b32 m0, s11
Ll_124:
  s_nop 0
  buffer_load_dwordx4 v4, s[40:43], s7 offen offset:0 sc1 lds
  buffer_load_dwordx4 v5, s[40:43], s7 offen offset:1024 sc1 lds
  buffer_load_dwordx4 v6, s[40:43], s7 offen offset:2048 sc1 lds
  buffer_load_dwordx4 v7, s[40:43], s7 offen offset:3072 sc1 lds
  s_add_u32 m0, s11, 4096
  s_nop 0
  s_add_u32 s5, s7, s13
  buffer_load_dwordx4 v4, s[40:43], s5 offen offset:0 sc1 lds
  buffer_load_dwordx4 v5, s[40:43], s5 offen offset:1024 sc1 lds
  buffer_load_dwordx4 v6, s[40:43], s5 offen offset:2048 sc1 lds
  buffer_load_dwordx4 v7, s[40:43], s5 offen offset:3072 sc1 lds
  s_add_u32 m0, s11, 8192
  s_nop 0
  s_add_u32 s3, s7, s95
  buffer_load_dwordx4 v4, s[40:43], s3 offen offset:0 sc1 lds
  buffer_load_dwordx4 v5, s[40:43], s3 offen offset:1024 sc1 lds
  buffer_load_dwordx4 v6, s[40:43], s3 offen offset:2048 sc1 lds
  buffer_load_dwordx4 v7, s[40:43], s3 offen offset:3072 sc1 lds
  s_add_u32 m0, s11, 12288
  s_add_u32 s5, s3, s13
  buffer_load_dwordx4 v4, s[40:43], s5 offen offset:0 sc1 lds
  s_add_u32 s12, s12, 1
  v_readlane_b32 s7, v9, s12
  s_add_u32 s11, s11, 16384
  buffer_load_dwordx4 v5, s[40:43], s5 offen offset:1024 sc1 lds
  s_cmp_eq_u32 s11, s15
  s_cselect_b32 s4, 65536, 0
  s_sub_u32 s11, s11, s4
  buffer_load_dwordx4 v6, s[40:43], s5 offen offset:2048 sc1 lds
  s_cmp_lg_u32 s12, Lz1-Lz0+4
  buffer_load_dwordx4 v7, s[40:43], s5 offen offset:3072 sc1 lds
  s_mov_b32 m0, s11
  s_cbranch_scc1 Ll_124
  s_waitcnt vmcnt(32)
  s_barrier
  buffer_load_dwordx4 v4, s[40:43], s7 offen offset:0 sc1 lds
  buffer_load_dwordx4 v5, s[40:43], s7 offen offset:1024 sc1 lds
  buffer_load_dwordx4 v6, s[40:43], s7 offen offset:2048 sc1 lds
  buffer_load_dwordx4 v7, s[40:43], s7 offen offset:3072 sc1 lds
Ll_129:
  s_add_u32 m0, s11, 4096
  s_nop 0
  s_add_u32 s5, s7, s13
  buffer_load_dwordx4 v4, s[40:43], s5 offen offset:0 sc1 lds
  buffer_load_dwordx4 v5, s[40:43], s5 offen offset:1024 sc1 lds
  buffer_load_dwordx4 v6, s[40:43], s5 offen offset:2048 sc1 lds
  buffer_load_dwordx4 v7, s[40:43], s5 offen offset:3072 sc1 lds
  s_add_u32 m0, s11, 8192
  s_nop 0
  s_add_u32 s3, s7, s95
  buffer_load_dwordx4 v4, s[40:43], s3 offen offset:0 sc1 lds
  buffer_load_dwordx4 v5, s[40:43], s3 offen offset:1024 sc1 lds
  buffer_load_dwordx4 v6, s[40:43], s3 offen offset:2048 sc1 lds
  buffer_load_dwordx4 v7, s[40:43], s3 offen offset:3072 sc1 lds
  s_add_u32 m0, s11, 12288
  s_add_u32 s5, s3, s13
  buffer_load_dwordx4 v4, s[40:43], s5 offen offset:0 sc1 lds
  s_add_u32 s12, s12, 1
  v_readlane_b32 s7, v9, s12
  s_add_u32 s11, s11, 16384
  buffer_load_dwordx4 v5, s[40:43], s5 offen offset:1024 sc1 lds
  s_cmp_eq_u32 s11, s15
  s_cselect_b32 s4, 65536, 0
  s_sub_u32 s11, s11, s4
  buffer_load_dwordx4 v6, s[40:43], s5 offen offset:2048 sc1 lds
  s_cmp_eq_u32 s12, Lz1-Lz0+30
  buffer_load_dwordx4 v7, s[40:43], s5 offen offset:3072 sc1 lds
  s_mov_b32 m0, s11
  s_cbranch_scc1 Ll_130
  s_waitcnt vmcnt(32)
  s_barrier
  buffer_load_dwordx4 v4, s[40:43], s7 offen offset:0 sc1 lds
  buffer_load_dwordx4 v5, s[40:43], s7 offen offset:1024 sc1 lds
  buffer_load_dwordx4 v6, s[40:43], s7 offen offset:2048 sc1 lds
  buffer_load_dwordx4 v7, s[40:43], s7 offen offset:3072 sc1 lds
  s_branch Ll_129
  s_nop 0
Ll_130:
  s_waitcnt vmcnt(32)
  s_barrier
  s_waitcnt vmcnt(16)
  s_barrier
  s_waitcnt vmcnt(0)
  s_barrier
  s_barrier
  s_cmp_lg_u32 s82, 0
  s_cbranch_scc1 L_lend
  s_mov_b32 s11, 0
  s_mov_b32 s15, 65536
  s_mul_i32 s5, s76, 16
  s_lshl_b32 s5, s5, 14
  s_add_u32 s5, s5, 35651584
  s_and_b32 s4, s76, 7
  s_add_u32 s6, s4, 1
  v_cmp_lt_u32 vcc, s6, v1
  v_add_u32 v9, s4, v1
  s_nop 0
  v_subbrev_co_u32 v9, vcc, 0, v9, vcc
  v_and_b32 v9, 7, v9
  v_subrev_u32 v2, 9, v1
  v_cmp_le_u32 vcc, s4, v2
  s_nop 1
  v_addc_co_u32 v2, vcc, 8, v2, vcc
  v_cmp_le_u32 vcc, 9, v1
  s_nop 1
  v_cndmask_b32 v9, v9, v2, vcc
  s_add_u32 s4, s4, Lz1-Lz0+8
  s_mov_b32 m0, s6
  s_nop 0
  v_writelane_b32 v9, s4, m0
  s_and_b32 s4, s76, 8
  v_xor_b32 v9, s4, v9
  v_cmp_eq_u32 vcc, s78, v9
  s_nop 0
  v_mov_b32_dpp v2, v9 row_shr:1 row_mask:0xf bank_mask:0xf
  s_ff1_i32_b32 s4, vcc_lo
  v_cmp_ge_u32 vcc, s4, v1
  s_nop 1
  v_cndmask_b32 v9, v9, v2, vcc
  v_writelane_b32 v9, s78, 0
  v_lshlrev_b32_e64 v11, 7, v9
  v_lshl_add_u32 v9, v9, 14, s5
  s_lshl_b32 s6, s76, Lz1-Lz0+14
  v_readlane_b32 s7, v9, 1
  s_mov_b32 s11, 16384
  s_add_u32 s91, s91, 8
  s_mov_b32 s90, 0x3e
  s_barrier
  s_mov_b32 s82, 1
  s_add_u32 s83, s83, 0
  s_add_u32 s87, s87, 32
  s_mov_b32 s89, 200000
  s_mov_b32 exec_lo, s90
  s_mov_b32 exec_hi, 0
  buffer_load_dword v12, v11, s[40:43], s91 offen sc0 sc1
Lp_131:
  s_waitcnt vmcnt(0)
  v_cmp_ne_u32 vcc, 0, v12
  s_andn2_b32 s3, exec_lo, vcc_lo
  s_cbranch_scc0 Lp_132
  s_mov_b32 exec_lo, s3
  s_sleep 1
  buffer_load_dword v12, v11, s[40:43], s91 offen sc0 sc1
  s_sub_u32 s89, s89, 1
  s_cbranch_scc0 Lp_131
Lp_132:
  s_mov_b64 exec, -1
  s_branch L_xlayer
  s_nop 0
L_s1:
  v_mov_b32 v11, 1
  v_mov_b32 v2, 156416
  ds_write_b128 v2, v[24:27]
  v_and_b32 v2, 31, v1
  v_lshlrev_b32 v5, 7, v2
  v_lshlrev_b32 v10, 3, v2
  v_lshrrev_b32 v3, 5, v1
  v_mul_u32_u24 v3, 320, v3
  v_add_u32_e64 v10, v3, v10
  v_add_u32 v10, 151552, v10
  v_bfe_u32 v3, v1, 3, 1
  v_and_b32 v2, 7, v1
  v_lshlrev_b32 v12, 9, v3
  v_lshl_add_u32 v12, v2, 4, v12
  v_mul_u32_u24 v3, 320, v3
  v_lshl_add_u32 v13, v2, 3, v3
  v_add_u32 v13, 151808, v13
  v_and_b32 v2, 15, v1
  v_lshlrev_b32 v8, 4, v2
  v_lshlrev_b32 v15, 6, v2
  v_and_b32 v3, 48, v1
  v_add_u32 v15, v15, v3
  v_and_b32 v2, 14, v1
  v_lshlrev_b32 v6, 2, v2
  v_lshlrev_b32 v14, 16, v1
  s_lshl_b32 s4, s77, 12
  s_lshl_b32 s5, s76, 7
  s_add_u32 s4, s4, s5
  v_add_u32 v14, s4, v14
  v_lshrrev_b32 v2, 2, v1
  v_lshlrev_b32 v22, 7, v2
  v_lshlrev_b32 v96, 6, v2
  v_and_b32 v2, 3, v1
  v_lshl_add_u32 v22, v2, 3, v22
  v_lshl_add_u32 v96, v2, 3, v96
  v_add_u32 v22, 65536, v22
  v_add_u32 v96, 90112, v96
  v_bfe_u32 v3, v1, 3, 2
  v_xor_b32_e64 v2, 0, v3
  v_lshl_add_u32 v16, v2, 5, v22
  v_xor_b32_e64 v2, 1, v3
  v_lshl_add_u32 v17, v2, 5, v22
  v_xor_b32_e64 v2, 2, v3
  v_lshl_add_u32 v18, v2, 5, v22
  v_xor_b32_e64 v2, 3, v3
  v_lshl_add_u32 v19, v2, 5, v22
  v_bfe_u32 v3, v1, 4, 1
  v_xor_b32_e64 v2, 0, v3
  v_lshl_add_u32 v20, v2, 5, v96
  v_xor_b32_e64 v2, 1, v3
  v_lshl_add_u32 v21, v2, 5, v96
  v_mov_b32 v22, 0x3f803f80
  s_mul_i32 s4, s76, 11
  s_lshr_b32 s4, s4, 5
  s_mul_i32 s4, s4, 3
  s_and_b32 s14, s76, 1
  s_mov_b32 s15, 32768
  s_mul_i32 s4, s14, 24576
  v_add_u32 v16, s4, v16
  v_add_u32 v17, s4, v17
  v_add_u32 v18, s4, v18
  v_add_u32 v19, s4, v19
  s_mov_b32 s98, 0x00010001
  s_mov_b32 s99, 0x00010001
  v_cndmask_b32_e64 v200, 0, v22, s[98:99]
  v_cndmask_b32_e64 v201, 0, v22, s[98:99]
  v_cndmask_b32_e64 v202, 0, v22, s[98:99]
  v_cndmask_b32_e64 v203, 0, v22, s[98:99]
  s_nop 0
  s_lshl_b64 s[98:99], s[98:99], 1
  v_cndmask_b32_e64 v204, 0, v22, s[98:99]
  v_cndmask_b32_e64 v205, 0, v22, s[98:99]
  v_cndmask_b32_e64 v206, 0, v22, s[98:99]
  v_cndmask_b32_e64 v207, 0, v22, s[98:99]
  s_nop 0
  s_lshl_b64 s[98:99], s[98:99], 1
  v_cndmask_b32_e64 v208, 0, v22, s[98:99]
  v_cndmask_b32_e64 v209, 0, v22, s[98:99]
  v_cndmask_b32_e64 v210, 0, v22, s[98:99]
  v_cndmask_b32_e64 v211, 0, v22, s[98:99]
  s_nop 0
  s_lshl_b64 s[98:99], s[98:99], 1
  v_cndmask_b32_e64 v212, 0, v22, s[98:99]
  v_cndmask_b32_e64 v213, 0, v22, s[98:99]
  v_cndmask_b32_e64 v214, 0, v22, s[98:99]
  v_cndmask_b32_e64 v215, 0, v22, s[98:99]
  s_nop 0
  s_lshl_b64 s[98:99], s[98:99], 1
  v_cndmask_b32_e64 v216, 0, v22, s[98:99]
  v_cndmask_b32_e64 v217, 0, v22, s[98:99]
  v_cndmask_b32_e64 v218, 0, v22, s[98:99]
  v_cndmask_b32_e64 v219, 0, v22, s[98:99]
  s_nop 0
  s_lshl_b64 s[98:99], s[98:99], 1
  v_cndmask_b32_e64 v220, 0, v22, s[98:99]
  v_cndmask_b32_e64 v221, 0, v22, s[98:99]
  v_cndmask_b32_e64 v222, 0, v22, s[98:99]
  v_cndmask_b32_e64 v223, 0, v22, s[98:99]
  s_nop 0
  s_lshl_b64 s[98:99], s[98:99], 1
  v_cndmask_b32_e64 v224, 0, v22, s[98:99]
  v_cndmask_b32_e64 v225, 0, v22, s[98:99]
  v_cndmask_b32_e64 v226, 0, v22, s[98:99]
  v_cndmask_b32_e64 v227, 0, v22, s[98:99]
  s_nop 0
  s_lshl_b64 s[98:99], s[98:99], 1
  v_cndmask_b32_e64 v228, 0, v22, s[98:99]
  v_cndmask_b32_e64 v229, 0, v22, s[98:99]
  v_cndmask_b32_e64 v230, 0, v22, s[98:99]
  v_cndmask_b32_e64 v231, 0, v22, s[98:99]
  s_nop 0
  s_lshl_b64 s[98:99], s[98:99], 1
  v_cndmask_b32_e64 v232, 0, v22, s[98:99]
  v_cndmask_b32_e64 v233, 0, v22, s[98:99]
  v_cndmask_b32_e64 v234, 0, v22, s[98:99]
  v_cndmask_b32_e64 v235, 0, v22, s[98:99]
  s_nop 0
  s_lshl_b64 s[98:99], s[98:99], 1
  v_cndmask_b32_e64 v236, 0, v22, s[98:99]
  v_cndmask_b32_e64 v237, 0, v22, s[98:99]
  v_cndmask_b32_e64 v238, 0, v22, s[98:99]
  v_cndmask_b32_e64 v239, 0, v22, s[98:99]
  s_nop 0
  s_lshl_b64 s[98:99], s[98:99], 1
  v_cndmask_b32_e64 v240, 0, v22, s[98:99]
  v_cndmask_b32_e64 v241, 0, v22, s[98:99]
  v_cndmask_b32_e64 v242, 0, v22, s[98:99]
  v_cndmask_b32_e64 v243, 0, v22, s[98:99]
  s_nop 0
  s_lshl_b64 s[98:99], s[98:99], 1
  v_cndmask_b32_e64 v244, 0, v22, s[98:99]
  v_cndmask_b32_e64 v245, 0, v22, s[98:99]
  v_cndmask_b32_e64 v246, 0, v22, s[98:99]
  v_cndmask_b32_e64 v247, 0, v22, s[98:99]
  s_lshl_b64 s[98:99], s[98:99], 1
  s_mov_b32 s56, s24
  s_and_b32 s57, s25, 0xffff
  s_mov_b32 s58, 7340032
  s_mov_b32 s59, 0x00020000
  s_nop 0
  s_mov_b32 s60, s28
  s_and_b32 s61, s29, 0xffff
  s_mov_b32 s62, 7340032
  s_mov_b32 s63, 0x00020000
  s_mul_i32 s12, s84, Lz1-Lz0+14
  s_add_u32 s12, s12, 20480
  s_mov_b32 s13, s12
  v_lshlrev_b32 v110, 7, v1
  s_mov_b32 s8, 0x00500005
  s_mov_b32 s9, 0x50000500
L_slayer:
  s_barrier
  s_cmp_lg_u32 s82, Lz1-Lz0+0
  s_cbranch_scc1 L_134
  buffer_load_dwordx4 v[128:131], v108, s[44:47], s7 offen offset:0
  buffer_load_dwordx4 v[132:135], v108, s[44:47], s7 offen offset:128
  buffer_load_dwordx4 v[136:139], v108, s[44:47], s7 offen offset:256
  buffer_load_dwordx4 v[140:143], v108, s[44:47], s7 offen offset:384
  buffer_load_dwordx4 v[144:147], v108, s[44:47], s7 offen offset:512
  buffer_load_dwordx4 v[148:151], v108, s[44:47], s7 offen offset:640
  buffer_load_dwordx4 v[152:155], v108, s[44:47], s7 offen offset:768
  buffer_load_dwordx4 v[156:159], v108, s[44:47], s7 offen offset:896
  buffer_load_dwordx4 v[160:163], v108, s[44:47], s7 offen offset:1024
  buffer_load_dwordx4 v[164:167], v108, s[44:47], s7 offen offset:1152
  buffer_load_dwordx4 v[168:171], v108, s[44:47], s7 offen offset:1280
  buffer_load_dwordx4 v[172:175], v108, s[44:47], s7 offen offset:1408
  buffer_load_dwordx4 v[176:179], v108, s[44:47], s7 offen offset:1536
  buffer_load_dwordx4 v[180:183], v108, s[44:47], s7 offen offset:1664
  buffer_load_dwordx4 v[184:187], v108, s[44:47], s7 offen offset:1792
  buffer_load_dwordx4 v[188:191], v108, s[44:47], s7 offen offset:1920
  s_waitcnt vmcnt(16)
  s_lshl_b32 s4, s76, 4
  s_mov_b64 exec, 1
  buffer_atomic_add v11, v24, s[68:71], s4 offen sc1
  s_mov_b64 exec, -1
L_134:
  s_cmp_le_u32 s14, 0
  s_cbranch_scc1 L_136
  s_barrier
L_136:
  s_cmp_le_u32 s14, 1
  s_cbranch_scc1 L_137
  s_barrier
L_137:
  s_cmp_lg_u32 s82, 0
  s_cbranch_scc1 L_138
  ds_read_b64_tr_b16 v[32:33], v16 offset:0
  ds_read_b64_tr_b16 v[34:35], v16 offset:2048
  ds_read_b64_tr_b16 v[36:37], v17 offset:0
  ds_read_b64_tr_b16 v[38:39], v17 offset:2048
  ds_read_b64_tr_b16 v[40:41], v18 offset:0
  ds_read_b64_tr_b16 v[42:43], v18 offset:2048
  ds_read_b64_tr_b16 v[44:45], v19 offset:0
  ds_read_b64_tr_b16 v[46:47], v19 offset:2048
  ds_read_b64_tr_b16 v[48:49], v16 offset:4096
  ds_read_b64_tr_b16 v[50:51], v16 offset:6144
  ds_read_b64_tr_b16 v[52:53], v17 offset:4096
  ds_read_b64_tr_b16 v[54:55], v17 offset:6144
  s_nop 0
  s_waitcnt lgkmcnt(4)
  ds_read_b64_tr_b16 v[56:57], v18 offset:4096
  ds_read_b64_tr_b16 v[58:59], v18 offset:6144
  ds_read_b64_tr_b16 v[60:61], v19 offset:4096
  ds_read_b64_tr_b16 v[62:63], v19 offset:6144
  v_add_u32 v16, 8192, v16
  v_add_u32 v17, 8192, v17
  v_add_u32 v18, 8192, v18
  v_add_u32 v19, 8192, v19
  s_nop 0
  s_waitcnt lgkmcnt(2)
  ds_read_b64_tr_b16 v[64:65], v16 offset:0
  ds_read_b64_tr_b16 v[66:67], v16 offset:2048
  ds_read_b64_tr_b16 v[68:69], v17 offset:0
  ds_read_b64_tr_b16 v[70:71], v17 offset:2048
  ds_read_b64_tr_b16 v[72:73], v18 offset:0
  ds_read_b64_tr_b16 v[74:75], v18 offset:2048
  ds_read_b64_tr_b16 v[76:77], v19 offset:0
  ds_read_b64_tr_b16 v[78:79], v19 offset:2048
  ds_read_b64_tr_b16 v[80:81], v16 offset:4096
  ds_read_b64_tr_b16 v[82:83], v16 offset:6144
  ds_read_b64_tr_b16 v[84:85], v17 offset:4096
  ds_read_b64_tr_b16 v[86:87], v17 offset:6144
  s_nop 0
  s_waitcnt lgkmcnt(4)
  ds_read_b64_tr_b16 v[88:89], v18 offset:4096
  ds_read_b64_tr_b16 v[90:91], v18 offset:6144
  ds_read_b64_tr_b16 v[92:93], v19 offset:4096
  ds_read_b64_tr_b16 v[94:95], v19 offset:6144
  v_add_u32 v16, 8192, v16
  v_add_u32 v17, 8192, v17
  v_add_u32 v18, 8192, v18
  v_add_u32 v19, 8192, v19
  v_mfma_f32_16x16x32_bf16 v[28:31], v[32:35], v[200:203], 0
  v_mfma_f32_16x16x32_bf16 v[28:31], v[36:39], v[204:207], v[28:31]
  v_mfma_f32_16x16x32_bf16 v[28:31], v[40:43], v[208:211], v[28:31]
  v_mfma_f32_16x16x32_bf16 v[28:31], v[44:47], v[212:215], v[28:31]
  v_mfma_f32_16x16x32_bf16 v[28:31], v[48:51], v[200:203], v[28:31]
  v_mfma_f32_16x16x32_bf16 v[28:31], v[52:55], v[204:207], v[28:31]
  v_mfma_f32_16x16x32_bf16 v[28:31], v[56:59], v[208:211], v[28:31]
  v_mfma_f32_16x16x32_bf16 v[28:31], v[60:63], v[212:215], v[28:31]
  s_nop 0
  s_waitcnt lgkmcnt(2)
  ds_read_b64_tr_b16 v[32:33], v16 offset:0
  ds_read_b64_tr_b16 v[34:35], v16 offset:2048
  ds_read_b64_tr_b16 v[36:37], v17 offset:0
  ds_read_b64_tr_b16 v[38:39], v17 offset:2048
  ds_read_b64_tr_b16 v[40:41], v18 offset:0
  ds_read_b64_tr_b16 v[42:43], v18 offset:2048
  ds_read_b64_tr_b16 v[44:45], v19 offset:0
  ds_read_b64_tr_b16 v[46:47], v19 offset:2048
  ds_read_b64_tr_b16 v[48:49], v16 offset:4096
  ds_read_b64_tr_b16 v[50:51], v16 offset:6144
  ds_read_b64_tr_b16 v[52:53], v17 offset:4096
  ds_read_b64_tr_b16 v[54:55], v17 offset:6144
  s_nop 0
  s_waitcnt lgkmcnt(4)
  ds_read_b64_tr_b16 v[56:57], v18 offset:4096
  ds_read_b64_tr_b16 v[58:59], v18 offset:6144
  ds_read_b64_tr_b16 v[60:61], v19 offset:4096
  ds_read_b64_tr_b16 v[62:63], v19 offset:6144
  v_mfma_f32_16x16x32_bf16 v[28:31], v[64:67], v[216:219], v[28:31]
  v_mfma_f32_16x16x32_bf16 v[28:31], v[68:71], v[220:223], v[28:31]
  v_mfma_f32_16x16x32_bf16 v[28:31], v[72:75], v[224:227], v[28:31]
  v_mfma_f32_16x16x32_bf16 v[28:31], v[76:79], v[228:231], v[28:31]
  v_mfma_f32_16x16x32_bf16 v[28:31], v[80:83], v[216:219], v[28:31]
  v_mfma_f32_16x16x32_bf16 v[28:31], v[84:87], v[220:223], v[28:31]
  v_mfma_f32_16x16x32_bf16 v[28:31], v[88:91], v[224:227], v[28:31]
  v_mfma_f32_16x16x32_bf16 v[28:31], v[92:95], v[228:231], v[28:31]
  s_waitcnt lgkmcnt(0)
L_138:
  s_barrier
  s_cmp_lg_u32 s82, 0
  s_cbranch_scc1 L_140
  v_mfma_f32_16x16x32_bf16 v[28:31], v[32:35], v[232:235], v[28:31]
  v_mfma_f32_16x16x32_bf16 v[28:31], v[36:39], v[236:239], v[28:31]
  v_mfma_f32_16x16x32_bf16 v[28:31], v[40:43], v[240:243], v[28:31]
  v_mfma_f32_16x16x32_bf16 v[28:31], v[44:47], v[244:247], v[28:31]
  v_mfma_f32_16x16x32_bf16 v[28:31], v[48:51], v[232:235], v[28:31]
  v_mfma_f32_16x16x32_bf16 v[28:31], v[52:55], v[236:239], v[28:31]
  v_mfma_f32_16x16x32_bf16 v[28:31], v[56:59], v[240:243], v[28:31]
  v_mfma_f32_16x16x32_bf16 v[28:31], v[60:63], v[244:247], v[28:31]
  s_lshl_b32 s5, s77, 14
  s_lshl_b32 s4, s76, 10
  s_add_u32 s5, s5, s4
  s_add_u32 s5, s5, 1114112
  s_nop 3
  buffer_store_dwordx4 v[28:31], v15, s[40:43], s5 offen sc0 sc1
  s_branch L_141
L_140:
  s_lshl_b32 s91, s84, 1
  s_add_u32 s91, s91, s87
  s_add_u32 s91, s91, 0xfffffff0
  s_mov_b32 s16, 0xffff
  s_mov_b32 exec_lo, s16
  s_mov_b32 exec_hi, 0
  buffer_load_dword v7, v5, s[40:43], s91 offen sc0 sc1
  s_mov_b64 exec, -1
L_141:
  s_barrier
  s_cmp_lg_u32 s82, 0
  s_cbranch_scc1 L_142
  s_branch L_143
L_142:
  s_waitcnt vmcnt(0)
  s_mov_b32 s89, 200000
  s_mov_b32 exec_lo, s16
  s_mov_b32 exec_hi, 0
  s_branch Lp_145
Lp_144:
  buffer_load_dword v7, v5, s[40:43], s91 offen sc0 sc1
  s_waitcnt vmcnt(0)
Lp_145:
  v_cmp_ne_u32 vcc, 0, v7
  s_andn2_b32 s3, s16, vcc_lo
  s_cbranch_scc0 Lp_146
  s_sleep 1
  s_sub_u32 s89, s89, 1
  s_cbranch_scc0 Lp_144
Lp_146:
  s_mov_b64 exec, -1
  s_add_u32 s5, s84, s92
  buffer_load_dwordx2 v[96:97], v6, s[40:43], s5 offen offset:0 sc1
  buffer_load_dwordx2 v[98:99], v6, s[40:43], s5 offen offset:512 sc1
  buffer_load_dwordx2 v[100:101], v6, s[40:43], s5 offen offset:1024 sc1
  buffer_load_dwordx2 v[102:103], v6, s[40:43], s5 offen offset:1536 sc1
L_143:
  s_barrier
  s_cmp_gt_u32 s14, 0
  s_cbranch_scc1 L_147
  s_barrier
L_147:
  s_cmp_gt_u32 s14, Lz1-Lz0+1
  s_cbranch_scc1 L_148
  s_barrier
L_148:
  s_cmp_lg_u32 s82, 0
  s_cbranch_scc1 L_149
  s_waitcnt vmcnt(2)
  buffer_load_dword v9, v8, s[68:71], 0 offen sc0 sc1
  s_mov_b32 s72, s26
  s_and_b32 s73, s27, 0xffff
  s_mov_b32 s74, 7168
  s_mov_b32 s75, 0x00020000
  s_mul_i32 s4, s77, 448
  s_and_b32 s5, s77, Lz1-Lz0+1
  s_lshl_b32 s6, s5, 6
  s_add_u32 s6, s6, s4
  s_mul_i32 s5, s5, 384
  s_sub_u32 s5, s4, s5
  v_lshlrev_b32 v2, 1, v1
  v_lshrrev_b32 v3, 1, v2
  v_xor_b32 v3, v3, v2
  v_and_b32 v3, 16, v3
  v_mul_u32_u24 v3, 3, v3
  v_xor_b32_e64 v3, v3, v2
  buffer_load_ushort v104, v2, s[72:75], s6 offen offset:0
  buffer_load_ushort v105, v2, s[72:75], s6 offen offset:128
  buffer_load_ushort v106, v2, s[72:75], s6 offen offset:256
  buffer_load_ushort v107, v3, s[72:75], s5 offen offset:384
  s_nop 0
  s_mov_b32 s64, s30
  s_and_b32 s65, s31, 0xffff
  s_mov_b32 s66, 2048
  s_mov_b32 s67, 0x00020000
  s_lshl_b32 s4, s78, Lz1-Lz0+7
  buffer_load_ushort v108, v2, s[64:67], s4 offen
  v_mov_b32 v32, v22
  v_mov_b32 v33, v22
  v_mov_b32 v34, v22
  v_mov_b32 v35, v22
  v_mov_b32 v96, 0
  v_mov_b32 v97, 0
  v_mov_b32 v98, 0
  v_mov_b32 v99, 0
  v_and_b32_e64 v2, 1, v1
  v_mul_u32_u24 v2, 0xaaaa, v2
  v_add_u32 v2, 0x4444, v2
  v_lshl_or_b32 v36, v2, 16, v2
  v_mfma_f32_16x16x32_bf16 v[100:103], v[128:131], v[128:131], 0
  s_nop 0
  s_nop 0
  v_smfmac_f32_16x16x64_bf16 v[96:99], v[32:35], v[128:135], v36
  v_mfma_f32_16x16x32_bf16 v[100:103], v[132:135], v[132:135], v[100:103]
  v_mfma_f32_16x16x32_bf16 v[100:103], v[136:139], v[136:139], v[100:103]
  v_smfmac_f32_16x16x64_bf16 v[96:99], v[32:35], v[136:143], v36
  v_mfma_f32_16x16x32_bf16 v[100:103], v[140:143], v[140:143], v[100:103]
L_149:
  s_barrier
  s_cmp_lg_u32 s82, Lz1-Lz0+0
  s_cbranch_scc1 L_151
  v_mfma_f32_16x16x32_bf16 v[100:103], v[144:147], v[144:147], v[100:103]
  v_smfmac_f32_16x16x64_bf16 v[96:99], v[32:35], v[144:151], v36
  v_mfma_f32_16x16x32_bf16 v[100:103], v[148:151], v[148:151], v[100:103]
  v_mfma_f32_16x16x32_bf16 v[100:103], v[152:155], v[152:155], v[100:103]
  v_smfmac_f32_16x16x64_bf16 v[96:99], v[32:35], v[152:159], v36
  v_mfma_f32_16x16x32_bf16 v[100:103], v[156:159], v[156:159], v[100:103]
L_151:
  s_barrier
  s_cmp_lg_u32 s82, Lz1-Lz0+0
  s_cbranch_scc1 L_153
  v_mfma_f32_16x16x32_bf16 v[100:103], v[160:163], v[160:163], v[100:103]
  v_smfmac_f32_16x16x64_bf16 v[96:99], v[32:35], v[160:167], v36
  v_mfma_f32_16x16x32_bf16 v[100:103], v[164:167], v[164:167], v[100:103]
  v_mfma_f32_16x16x32_bf16 v[100:103], v[168:171], v[168:171], v[100:103]
  v_smfmac_f32_16x16x64_bf16 v[96:99], v[32:35], v[168:175], v36
  v_mfma_f32_16x16x32_bf16 v[100:103], v[172:175], v[172:175], v[100:103]
  s_waitcnt vmcnt(0)
  s_mov_b32 s89, 200000
  s_branch Lg_156
Lg_155:
  buffer_load_dword v9, v8, s[68:71], 0 offen sc0 sc1
  s_waitcnt vmcnt(0)
Lg_156:
  v_cmp_eq_u32 vcc, 16, v9
  s_andn2_b32 s3, 0xffff, vcc_lo
  s_cbranch_scc0 Lg_157
  s_sleep 2
  s_sub_u32 s89, s89, 1
  s_cbranch_scc0 Lg_155
Lg_157:
  s_mov_b32 s5, 1835008
  s_mov_b64 exec, 0x101
  buffer_store_dword v11, v14, s[40:43], s5 offen sc0 sc1
  s_mov_b64 exec, -1
  s_getpc_b64 s[4:5]
L_pc0:
  s_sub_u32 s4, s4, L_pc0-mega_kernel
  s_nop 0
  s_subb_u32 s5, s5, 0
  s_bfe_u32 s6, s2, 0x20003
  s_mul_i32 s6, s6, 10240
  v_lshl_add_u32 v3, v1, 4, s6
  v_mov_b32_e64 v119, s5
  v_min_u32 v118, L_end-mega_kernel-16, v3
  v_add_co_u32_e64 v116, vcc, s4, v118
  v_add_u32 v3, 0x400, v3
  s_nop 0
  v_addc_co_u32 v117, vcc, 0, v119, vcc
  global_load_dwordx4 v[112:115], v[116:117], off
  v_min_u32 v118, L_end-mega_kernel-16, v3
  v_add_co_u32_e64 v116, vcc, s4, v118
  v_add_u32 v3, 0x400, v3
  s_nop 0
  v_addc_co_u32 v117, vcc, 0, v119, vcc
  global_load_dwordx4 v[112:115], v[116:117], off
  v_min_u32 v118, L_end-mega_kernel-16, v3
  v_add_co_u32_e64 v116, vcc, s4, v118
  v_add_u32 v3, 0x400, v3
  s_nop 0
  v_addc_co_u32 v117, vcc, 0, v119, vcc
  global_load_dwordx4 v[112:115], v[116:117], off
  v_min_u32 v118, L_end-mega_kernel-16, v3
  v_add_co_u32_e64 v116, vcc, s4, v118
  v_add_u32 v3, 0x400, v3
  s_nop 0
  v_addc_co_u32 v117, vcc, 0, v119, vcc
  global_load_dwordx4 v[112:115], v[116:117], off
  v_min_u32 v118, L_end-mega_kernel-16, v3
  v_add_co_u32 v116, vcc, s4, v118
  s_nop 1
  v_addc_co_u32 v117, vcc, 0, v119, vcc
  global_load_dwordx4 v[112:115], v[116:117], off
L_153:
  s_barrier
  s_cmp_lg_u32 s82, 0
  s_cbranch_scc1 L_158
  v_mfma_f32_16x16x32_bf16 v[100:103], v[176:179], v[176:179], v[100:103]
  v_smfmac_f32_16x16x64_bf16 v[96:99], v[32:35], v[176:183], v36
  v_mfma_f32_16x16x32_bf16 v[100:103], v[180:183], v[180:183], v[100:103]
  v_mfma_f32_16x16x32_bf16 v[100:103], v[184:187], v[184:187], v[100:103]
  v_smfmac_f32_16x16x64_bf16 v[96:99], v[32:35], v[184:191], v36
  v_mfma_f32_16x16x32_bf16 v[100:103], v[188:191], v[188:191], v[100:103]
  s_getpc_b64 s[4:5]
L_pc1:
  s_sub_u32 s4, s4, L_pc1-mega_kernel
  s_subb_u32 s5, s5, 0
  s_bfe_u32 s6, s2, 0x20003
  s_mul_i32 s6, s6, 10240
  s_add_u32 s6, s6, 5120
  v_lshl_add_u32 v3, v1, 4, s6
  v_mov_b32_e64 v119, s5
  v_min_u32 v118, L_end-mega_kernel-16, v3
  v_add_co_u32_e64 v116, vcc, s4, v118
  v_add_u32 v3, 0x400, v3
  s_nop 0
  v_addc_co_u32 v117, vcc, 0, v119, vcc
  global_load_dwordx4 v[112:115], v[116:117], off
  v_min_u32 v118, L_end-mega_kernel-16, v3
  v_add_co_u32_e64 v116, vcc, s4, v118
  v_add_u32 v3, 0x400, v3
  s_nop 0
  v_addc_co_u32 v117, vcc, 0, v119, vcc
  global_load_dwordx4 v[112:115], v[116:117], off
  v_min_u32 v118, L_end-mega_kernel-16, v3
  v_add_co_u32_e64 v116, vcc, s4, v118
  v_add_u32 v3, 0x400, v3
  s_nop 0
  v_addc_co_u32 v117, vcc, 0, v119, vcc
  global_load_dwordx4 v[112:115], v[116:117], off
  v_min_u32 v118, L_end-mega_kernel-16, v3
  v_add_co_u32_e64 v116, vcc, s4, v118
  v_add_u32 v3, 0x400, v3
  s_nop 0
  v_addc_co_u32 v117, vcc, 0, v119, vcc
  global_load_dwordx4 v[112:115], v[116:117], off
  v_min_u32 v118, L_end-mega_kernel-16, v3
  v_add_co_u32 v116, vcc, s4, v118
  s_nop 1
  v_addc_co_u32_e64 v117, vcc, 0, v119, vcc
  global_load_dwordx4 v[112:115], v[116:117], off
  s_nop 7
  s_nop 7
  v_add_f32_e64 v96, v96, v97
  s_mov_b32 s98, 0xaaaaaaaa
  s_mov_b32 s99, 0xaaaaaaaa
  v_cndmask_b32_e64 v100, v100, v101, s[98:99]
  v_cndmask_b32_e64 v102, v102, v103, s[98:99]
  s_mov_b32 s98, 0xcccccccc
  s_mov_b32 s99, 0xcccccccc
  v_cndmask_b32_e64 v97, v100, v102, s[98:99]
  v_add_f32_dpp v96, v96, v96 quad_perm:[1,0,3,2] row_mask:0xf bank_mask:0xf
  s_nop 0
  v_add_f32_dpp v97, v97, v97 quad_perm:[1,0,3,2] row_mask:0xf bank_mask:0xf
  s_branch L_159
L_158:
  s_waitcnt vmcnt(0)
  v_add_f32 v96, v96, v100
  v_add_f32 v97, v97, v101
  v_add_f32 v98, v98, v102
  v_add_f32 v99, v99, v103
  v_add_f32 v96, v96, v98
  v_add_f32 v97, v97, v99
  s_nop 0
  v_add_f32_dpp v96, v96, v96 row_ror:8 row_mask:0xf bank_mask:0xf
  v_add_f32_dpp v97, v97, v97 row_ror:8 row_mask:0xf bank_mask:0xf
  v_mov_b32 v98, v96
  v_mov_b32 v99, v97
  s_nop 0
  v_permlane16_swap_b32 v96, v98
  v_permlane16_swap_b32 v97, v99
  v_add_f32 v96, v96, v98
  v_add_f32 v97, v97, v99
  v_mov_b32 v98, v96
  v_mov_b32 v99, v97
  s_nop 0
  v_permlane32_swap_b32 v96, v98
  v_permlane32_swap_b32 v97, v99
  v_add_f32 v96, v96, v98
  v_add_f32 v97, v97, v99
L_159:
  v_mul_f32 v96, 0x3a800000, v96
  v_mul_f32 v97, 0x3a800000, v97
  v_fma_f32 v98, -v96, v96, v97
  v_max_f32_e64 v98, 0, v98
  v_add_f32 v98, 0x3727c5ac, v98
  v_rsq_f32_e64 v98, v98
  v_mov_b32 v99, v96
  s_mov_b64 exec, s[8:9]
  buffer_store_dwordx2 v[98:99], v6, s[40:43], s10 offen sc0 sc1
  s_mov_b64 exec, -1
  s_barrier
  s_cmp_lg_u32 s82, 0
  s_cbranch_scc1 L_160
  v_lshlrev_b32_e64 v6, 3, v1
  s_mov_b64 s[8:9], 0xff
  s_lshl_b32 s91, s84, Lz1-Lz0+1
  s_and_b32 s91, s91, 0x8f000
  s_add_u32 s91, s91, 1835008
  s_mov_b32 exec_lo, 0xffff
  s_mov_b32 exec_hi, Lz1-Lz0+0
  buffer_load_dword v7, v5, s[40:43], s91 offen sc0 sc1
  s_mov_b64 exec, -1
L_160:
  s_barrier
  s_barrier
  s_waitcnt vmcnt(0)
  s_and_b32 s5, s10, 0xfffffc00
  buffer_load_dwordx4 v[120:123], v4, s[40:43], s5 offen sc1
  s_cmp_lg_u32 s82, 0
  s_cbranch_scc1 L_162
  s_mov_b32 s89, 200000
  s_mov_b32 exec_lo, 0xffff
  s_mov_b32 exec_hi, 0
  s_branch Lp_165
Lp_164:
  buffer_load_dword v7, v5, s[40:43], s91 offen sc0 sc1
  s_waitcnt vmcnt(0)
Lp_165:
  v_cmp_ne_u32 vcc, 0, v7
  s_andn2_b32 s3, 0xffff, vcc_lo
  s_cbranch_scc0 Lp_166
  s_sleep 1
  s_sub_u32 s89, s89, 1
  s_cbranch_scc0 Lp_164
Lp_166:
  s_mov_b64 exec, -1
  s_lshl_b32 s5, s77, 14
  s_add_u32 s5, s5, 1114112
  buffer_load_dwordx4 v[192:195], v4, s[40:43], s5 offen offset:0 sc1
  buffer_load_dwordx4 v[196:199], v4, s[40:43], s5 offen offset:1024 sc1
  buffer_load_dwordx4 v[200:203], v4, s[40:43], s5 offen offset:2048 sc1
  buffer_load_dwordx4 v[204:207], v4, s[40:43], s5 offen offset:3072 sc1
  s_add_u32 s5, s5, 4096
  buffer_load_dwordx4 v[208:211], v4, s[40:43], s5 offen offset:0 sc1
  buffer_load_dwordx4 v[212:215], v4, s[40:43], s5 offen offset:1024 sc1
  buffer_load_dwordx4 v[216:219], v4, s[40:43], s5 offen offset:2048 sc1
  buffer_load_dwordx4 v[220:223], v4, s[40:43], s5 offen offset:3072 sc1
L_162:
  s_barrier
  s_cmp_lg_u32 s82, 0
  s_cbranch_scc1 L_167
  s_lshl_b32 s5, s77, 14
  s_add_u32 s5, s5, 1122304
  buffer_load_dwordx4 v[224:227], v4, s[40:43], s5 offen offset:0 sc1
  buffer_load_dwordx4 v[228:231], v4, s[40:43], s5 offen offset:1024 sc1
  buffer_load_dwordx4 v[232:235], v4, s[40:43], s5 offen offset:2048 sc1
  buffer_load_dwordx4 v[236:239], v4, s[40:43], s5 offen offset:3072 sc1
  s_add_u32 s5, s5, 4096
  buffer_load_dwordx4 v[240:243], v4, s[40:43], s5 offen offset:0 sc1
  buffer_load_dwordx4 v[244:247], v4, s[40:43], s5 offen offset:1024 sc1
  buffer_load_dwordx4 v[248:251], v4, s[40:43], s5 offen offset:2048 sc1
  buffer_load_dwordx4 v[252:255], v4, s[40:43], s5 offen offset:3072 sc1
L_167:
  s_barrier
  s_cmp_lg_u32 s82, 0
  s_cbranch_scc1 L_169
  s_waitcnt vmcnt(16)
  s_branch L_170
L_169:
  s_waitcnt vmcnt(0)
L_170:
  s_mov_b32 s89, 200000
  s_branch Lp_172
  s_nop 0
Lp_171:
  s_and_b32 s5, s10, 0xfffffc00
  buffer_load_dwordx4 v[120:123], v4, s[40:43], s5 offen sc1
  s_waitcnt vmcnt(0)
Lp_172:
  v_min_u32 v2, v120, v122
  v_cmp_eq_u32 vcc, 0, v2
  s_cmp_eq_u64 vcc, 0
  s_cbranch_scc1 Lp_173
  s_sleep 1
  s_sub_u32 s89, s89, 1
  s_cbranch_scc0 Lp_171
Lp_173:
  s_and_b32 s5, s10, 0xfffffc00
  s_mov_b32 m0, 151552
  s_nop 0
  buffer_load_dword v6, s[40:43], s5 offen offset:0 sc1 lds
  s_mov_b32 m0, 152188
  s_nop 0
  buffer_load_dword v6, s[40:43], s5 offen offset:4 sc1 lds
  s_mov_b32 m0, 151360
  s_nop 0
  buffer_load_dword v6, s[40:43], s5 offen offset:512 sc1 lds
  s_mov_b32 m0, 151996
  s_nop 0
  buffer_load_dword v6, s[40:43], s5 offen offset:516 sc1 lds
  s_add_u32 s10, s10, 16384
  s_cmp_lg_u32 s82, 0
  s_cbranch_scc1 L_174
  s_waitcnt vmcnt(12)
  v_add_f32 v192, v192, v208
  v_add_f32 v193, v193, v209
  v_add_f32 v194, v194, v210
  v_add_f32 v195, v195, v211
  v_add_f32 v196, v196, v212
  v_add_f32 v197, v197, v213
  v_add_f32 v198, v198, v214
  v_add_f32 v199, v199, v215
  v_add_f32 v200, v200, v216
  v_add_f32 v201, v201, v217
  v_add_f32 v202, v202, v218
  v_add_f32 v203, v203, v219
  v_add_f32 v204, v204, v220
  v_add_f32 v205, v205, v221
  v_add_f32 v206, v206, v222
  v_add_f32 v207, v207, v223
  v_add_f32 v192, v192, v200
  v_add_f32 v193, v193, v201
  v_add_f32 v194, v194, v202
  v_add_f32 v195, v195, v203
  v_add_f32 v196, v196, v204
  v_add_f32 v197, v197, v205
  v_add_f32 v198, v198, v206
  v_add_f32 v199, v199, v207
  v_add_f32 v192, v192, v196
  v_add_f32 v193, v193, v197
  v_add_f32 v194, v194, v198
  v_add_f32_e64 v195, v195, v199
L_174:
  s_cmp_lg_u32 s82, 0
  s_cbranch_scc1 L_176
  buffer_load_dword v109, v110, s[56:59], s12 offen
  s_sub_u32 s12, s12, 8192
L_176:
  s_barrier
  s_cmp_lg_u32 s82, 0
  s_cbranch_scc1 L_178
  s_cmp_lg_u32 s82, 0
  s_cbranch_scc1 L_180
  s_waitcnt vmcnt(1)
  s_branch L_181
L_180:
  s_waitcnt vmcnt(0)
L_181:
  v_add_f32 v224, v224, v240
  v_add_f32 v225, v225, v241
  v_add_f32 v226, v226, v242
  v_add_f32 v227, v227, v243
  v_add_f32 v228, v228, v244
  v_add_f32 v229, v229, v245
  v_add_f32 v230, v230, v246
  v_add_f32 v231, v231, v247
  v_add_f32 v232, v232, v248
  v_add_f32 v233, v233, v249
  v_add_f32 v234, v234, v250
  v_add_f32 v235, v235, v251
  v_add_f32 v236, v236, v252
  v_add_f32 v237, v237, v253
  v_add_f32 v238, v238, v254
  v_add_f32 v239, v239, v255
  v_add_f32 v224, v224, v232
  v_add_f32 v225, v225, v233
  v_add_f32 v226, v226, v234
  v_add_f32 v227, v227, v235
  v_add_f32 v228, v228, v236
  v_add_f32 v229, v229, v237
  v_add_f32 v230, v230, v238
  v_add_f32 v231, v231, v239
  v_add_f32 v224, v224, v228
  v_add_f32 v225, v225, v229
  v_add_f32 v226, v226, v230
  v_add_f32 v227, v227, v231
  v_add_f32 v192, v192, v224
  v_add_f32 v193, v193, v225
  v_add_f32 v194, v194, v226
  v_add_f32 v195, v195, v227
  v_add_u32 v2, 153088, v4
  ds_write_b128 v2, v[192:195]
L_178:
  s_cmp_lg_u32 s82, 0
  s_cbranch_scc1 L_182
  buffer_load_dword v109, v110, s[56:59], s12 offen
  s_sub_u32 s12, s12, 8192
L_182:
  s_barrier
  s_cmp_lg_u32 s82, 0
  s_cbranch_scc1 L_184
  s_waitcnt vmcnt(2)
  s_branch L_185
  s_nop 0
L_184:
  s_waitcnt vmcnt(0)
L_185:
  s_waitcnt lgkmcnt(0)
  s_barrier
  s_cmp_lg_u32 s82, 0
  s_cbranch_scc1 L_186
  v_lshlrev_b32 v2, 2, v1
  v_add_u32 v2, 155136, v2
  v_lshlrev_b32_e64 v104, 16, v104
  v_mul_f32 v104, 0x3eeff558, v104
  ds_write_b32 v2, v104 offset:0
  v_lshlrev_b32_e64 v105, 16, v105
  v_mul_f32 v105, 0x3eeff558, v105
  ds_write_b32 v2, v105 offset:256
  v_lshlrev_b32_e64 v106, 16, v106
  v_mul_f32 v106, 0x3eeff558, v106
  ds_write_b32 v2, v106 offset:512
  v_lshlrev_b32_e64 v107, 16, v107
  v_mul_f32 v107, 0x3eeff558, v107
  ds_write_b32 v2, v107 offset:768
  v_lshlrev_b32_e64 v108, 16, v108
  ds_write_b32 v2, v108 offset:1024
  v_lshrrev_b32 v2, 2, v1
  v_lshlrev_b32 v22, 7, v2
  v_lshlrev_b32 v96, 6, v2
  v_and_b32 v2, 3, v1
  v_lshl_add_u32 v22, v2, 3, v22
  v_lshl_add_u32 v96, v2, 3, v96
  v_add_u32 v22, 65536, v22
  v_add_u32 v96, 90112, v96
  v_bfe_u32 v3, v1, 3, 2
  v_xor_b32_e64 v2, 0, v3
  v_lshl_add_u32 v16, v2, 5, v22
  v_xor_b32_e64 v2, 1, v3
  v_lshl_add_u32 v17, v2, 5, v22
  v_xor_b32_e64 v2, 2, v3
  v_lshl_add_u32 v18, v2, 5, v22
  v_xor_b32_e64 v2, 3, v3
  v_lshl_add_u32 v19, v2, 5, v22
  v_bfe_u32 v3, v1, 4, 1
  v_xor_b32_e64 v2, 0, v3
  v_lshl_add_u32 v20, v2, 5, v96
  v_xor_b32_e64 v2, 1, v3
  v_lshl_add_u32 v21, v2, 5, v96
  v_mov_b32 v22, 0x3f803f80
  s_mov_b32 s98, 0x00010001
  s_mov_b32 s99, 0x00010001
  v_cndmask_b32_e64 v200, 0, v22, s[98:99]
  v_cndmask_b32_e64 v201, 0, v22, s[98:99]
  v_cndmask_b32_e64 v202, 0, v22, s[98:99]
  v_cndmask_b32_e64 v203, 0, v22, s[98:99]
  s_nop 0
  s_lshl_b64 s[98:99], s[98:99], 1
  v_cndmask_b32_e64 v204, 0, v22, s[98:99]
  v_cndmask_b32_e64 v205, 0, v22, s[98:99]
  v_cndmask_b32_e64 v206, 0, v22, s[98:99]
  v_cndmask_b32_e64 v207, 0, v22, s[98:99]
  s_nop 0
  s_lshl_b64 s[98:99], s[98:99], 1
  v_cndmask_b32_e64 v208, 0, v22, s[98:99]
  v_cndmask_b32_e64 v209, 0, v22, s[98:99]
  v_cndmask_b32_e64 v210, 0, v22, s[98:99]
  v_cndmask_b32_e64 v211, 0, v22, s[98:99]
  s_nop 0
  s_lshl_b64 s[98:99], s[98:99], 1
  v_cndmask_b32_e64 v212, 0, v22, s[98:99]
  v_cndmask_b32_e64 v213, 0, v22, s[98:99]
  v_cndmask_b32_e64 v214, 0, v22, s[98:99]
  v_cndmask_b32_e64 v215, 0, v22, s[98:99]
  s_nop 0
  s_lshl_b64 s[98:99], s[98:99], 1
  v_cndmask_b32_e64 v216, 0, v22, s[98:99]
  v_cndmask_b32_e64 v217, 0, v22, s[98:99]
  v_cndmask_b32_e64 v218, 0, v22, s[98:99]
  v_cndmask_b32_e64 v219, 0, v22, s[98:99]
  s_nop 0
  s_lshl_b64 s[98:99], s[98:99], 1
  v_cndmask_b32_e64 v220, 0, v22, s[98:99]
  v_cndmask_b32_e64 v221, 0, v22, s[98:99]
  v_cndmask_b32_e64 v222, 0, v22, s[98:99]
  v_cndmask_b32_e64 v223, 0, v22, s[98:99]
  s_nop 0
  s_lshl_b64 s[98:99], s[98:99], 1
  v_cndmask_b32_e64 v224, 0, v22, s[98:99]
  v_cndmask_b32_e64 v225, 0, v22, s[98:99]
  v_cndmask_b32_e64 v226, 0, v22, s[98:99]
  v_cndmask_b32_e64 v227, 0, v22, s[98:99]
  s_nop 0
  s_lshl_b64 s[98:99], s[98:99], 1
  v_cndmask_b32_e64 v228, 0, v22, s[98:99]
  v_cndmask_b32_e64 v229, 0, v22, s[98:99]
  v_cndmask_b32_e64 v230, 0, v22, s[98:99]
  v_cndmask_b32_e64 v231, 0, v22, s[98:99]
  s_nop 0
  s_lshl_b64 s[98:99], s[98:99], 1
  v_cndmask_b32_e64 v232, 0, v22, s[98:99]
  v_cndmask_b32_e64 v233, 0, v22, s[98:99]
  v_cndmask_b32_e64 v234, 0, v22, s[98:99]
  v_cndmask_b32_e64 v235, 0, v22, s[98:99]
  s_nop 0
  s_lshl_b64 s[98:99], s[98:99], 1
  v_cndmask_b32_e64 v236, 0, v22, s[98:99]
  v_cndmask_b32_e64 v237, 0, v22, s[98:99]
  v_cndmask_b32_e64 v238, 0, v22, s[98:99]
  v_cndmask_b32_e64 v239, 0, v22, s[98:99]
  s_nop 0
  s_lshl_b64 s[98:99], s[98:99], 1
  v_cndmask_b32_e64 v240, 0, v22, s[98:99]
  v_cndmask_b32_e64 v241, 0, v22, s[98:99]
  v_cndmask_b32_e64 v242, 0, v22, s[98:99]
  v_cndmask_b32_e64 v243, 0, v22, s[98:99]
  s_nop 0
  s_lshl_b64 s[98:99], s[98:99], 1
  v_cndmask_b32_e64 v244, 0, v22, s[98:99]
  v_cndmask_b32_e64 v245, 0, v22, s[98:99]
  v_cndmask_b32_e64 v246, 0, v22, s[98:99]
  v_cndmask_b32_e64 v247, 0, v22, s[98:99]
  s_nop 0
  s_lshl_b64 s[98:99], s[98:99], 1
  v_cndmask_b32_e64 v248, 0, v22, s[98:99]
  v_cndmask_b32_e64 v249, 0, v22, s[98:99]
  v_cndmask_b32_e64 v250, 0, v22, s[98:99]
  v_cndmask_b32_e64 v251, 0, v22, s[98:99]
  s_nop 0
  s_lshl_b64 s[98:99], s[98:99], 1
  v_cndmask_b32_e64 v252, 0, v22, s[98:99]
  v_cndmask_b32_e64 v253, 0, v22, s[98:99]
  v_cndmask_b32_e64 v254, 0, v22, s[98:99]
  v_cndmask_b32_e64 v255, 0, v22, s[98:99]
  s_lshl_b64 s[98:99], s[98:99], 1
L_186:
  s_lshl_b32 s91, s84, Lz1-Lz0+1
  s_add_u32 s91, s91, s87
  s_barrier
  s_barrier
  s_mov_b32 exec_lo, 0xf7f7
  s_mov_b32 exec_hi, 0
  buffer_load_dword v7, v5, s[40:43], s91 offen sc0 sc1
  s_mov_b64 exec, -1
  s_barrier
  s_barrier
  s_barrier
  s_waitcnt vmcnt(0)
  s_mov_b32 s89, 200000
  s_mov_b32 exec_lo, 0xf7f7
  s_mov_b32 exec_hi, 0
  s_branch Lp_189
Lp_188:
  buffer_load_dword v7, v5, s[40:43], s91 offen sc0 sc1
  s_waitcnt vmcnt(0)
Lp_189:
  v_cmp_ne_u32 vcc, 0, v7
  s_andn2_b32 s3, 0xf7f7, vcc_lo
  s_cbranch_scc0 Lp_190
  s_sleep 1
  s_sub_u32 s89, s89, Lz1-Lz0+1
  s_cbranch_scc0 Lp_188
Lp_190:
  s_mov_b64 exec, -1
  s_barrier
  s_barrier
  s_mov_b32 exec_lo, 0x808
  s_mov_b32 exec_hi, Lz1-Lz0+0
  buffer_load_dword v7, v5, s[40:43], s91 offen sc0 sc1
  s_mov_b64 exec, -1
  s_barrier
  s_barrier
  s_barrier
  s_barrier
  s_waitcnt vmcnt(0)
  s_mov_b32 s89, 200000
  s_mov_b32 exec_lo, 0x808
  s_mov_b32 exec_hi, 0
  s_branch Lp_192
Lp_191:
  buffer_load_dword v7, v5, s[40:43], s91 offen sc0 sc1
  s_waitcnt vmcnt(0)
Lp_192:
  v_cmp_ne_u32 vcc, 0, v7
  s_andn2_b32 s3, 0x808, vcc_lo
  s_cbranch_scc0 Lp_193
  s_sleep 1
  s_sub_u32 s89, s89, Lz1-Lz0+1
  s_cbranch_scc0 Lp_191
Lp_193:
  s_mov_b64 exec, -1
  s_barrier
  s_barrier
  s_barrier
  s_barrier
  s_barrier
  s_barrier
  s_add_u32 s92, s83, 31457280
  s_add_u32 s91, s91, 4
  s_sub_u32 s16, s78, s76
  s_add_u32 s16, s16, 1
  s_and_b32 s16, s16, 15
  s_barrier
  s_cmp_lg_u32 s82, 0
  s_cbranch_scc1 L_194
  s_cmp_eq_u32 s16, 1
  s_cselect_b32 s4, 0, 28672
  v_add_u32 v112, s4, v16
  v_add_u32 v113, s4, v17
  v_add_u32 v114, s4, v18
  v_add_u32 v115, s4, v19
  v_add_u32 v116, s4, v20
  v_add_u32 v117, s4, v21
  ds_read_b64_tr_b16 v[32:33], v112 offset:0
  ds_read_b64_tr_b16 v[34:35], v112 offset:2048
  ds_read_b64_tr_b16 v[36:37], v113 offset:0
  ds_read_b64_tr_b16 v[38:39], v113 offset:2048
  ds_read_b64_tr_b16 v[40:41], v114 offset:0
  ds_read_b64_tr_b16 v[42:43], v114 offset:2048
  ds_read_b64_tr_b16 v[44:45], v115 offset:0
  ds_read_b64_tr_b16 v[46:47], v115 offset:2048
  ds_read_b64_tr_b16 v[48:49], v112 offset:4096
  ds_read_b64_tr_b16 v[50:51], v112 offset:6144
  ds_read_b64_tr_b16 v[52:53], v113 offset:4096
  ds_read_b64_tr_b16 v[54:55], v113 offset:6144
  s_nop 0
  s_waitcnt lgkmcnt(6)
  ds_read_b64_tr_b16 v[56:57], v114 offset:4096
  ds_read_b64_tr_b16 v[58:59], v114 offset:6144
  ds_read_b64_tr_b16 v[60:61], v115 offset:4096
  ds_read_b64_tr_b16 v[62:63], v115 offset:6144
  s_nop 0
  s_waitcnt lgkmcnt(6)
  ds_read_b64_tr_b16 v[64:65], v112 offset:8192
  ds_read_b64_tr_b16 v[66:67], v112 offset:10240
  ds_read_b64_tr_b16 v[68:69], v113 offset:8192
  ds_read_b64_tr_b16 v[70:71], v113 offset:10240
  ds_read_b64_tr_b16 v[72:73], v114 offset:8192
  ds_read_b64_tr_b16 v[74:75], v114 offset:10240
  ds_read_b64_tr_b16 v[76:77], v115 offset:8192
  ds_read_b64_tr_b16 v[78:79], v115 offset:10240
  s_nop 0
  s_waitcnt lgkmcnt(8)
  v_mfma_f32_16x16x32_bf16 v[28:31], v[32:35], v[200:203], 0
  v_mfma_f32_16x16x32_bf16 v[28:31], v[36:39], v[204:207], v[28:31]
  v_mfma_f32_16x16x32_bf16 v[28:31], v[40:43], v[208:211], v[28:31]
  v_mfma_f32_16x16x32_bf16 v[28:31], v[44:47], v[212:215], v[28:31]
  v_mfma_f32_16x16x32_bf16 v[28:31], v[48:51], v[200:203], v[28:31]
  v_mfma_f32_16x16x32_bf16 v[28:31], v[52:55], v[204:207], v[28:31]
  v_mfma_f32_16x16x32_bf16 v[28:31], v[56:59], v[208:211], v[28:31]
  v_mfma_f32_16x16x32_bf16 v[28:31], v[60:63], v[212:215], v[28:31]
  s_nop 0
  s_waitcnt lgkmcnt(7)
  ds_read_b64_tr_b16 v[80:81], v112 offset:12288
  ds_read_b64_tr_b16 v[82:83], v112 offset:14336
  ds_read_b64_tr_b16 v[84:85], v113 offset:12288
  ds_read_b64_tr_b16 v[86:87], v113 offset:14336
  ds_read_b64_tr_b16 v[88:89], v114 offset:12288
  ds_read_b64_tr_b16 v[90:91], v114 offset:14336
  ds_read_b64_tr_b16 v[92:93], v115 offset:12288
  ds_read_b64_tr_b16 v[94:95], v115 offset:14336
  s_nop 0
  s_waitcnt lgkmcnt(6)
  ds_read_b64_tr_b16 v[128:129], v112 offset:16384
  ds_read_b64_tr_b16 v[130:131], v112 offset:18432
  ds_read_b64_tr_b16 v[132:133], v113 offset:16384
  ds_read_b64_tr_b16 v[134:135], v113 offset:18432
  ds_read_b64_tr_b16 v[136:137], v114 offset:16384
  ds_read_b64_tr_b16 v[138:139], v114 offset:18432
  ds_read_b64_tr_b16 v[140:141], v115 offset:16384
  ds_read_b64_tr_b16 v[142:143], v115 offset:18432
  s_nop 0
  s_waitcnt lgkmcnt(8)
  v_mfma_f32_16x16x32_bf16 v[28:31], v[64:67], v[216:219], v[28:31]
  v_mfma_f32_16x16x32_bf16 v[28:31], v[68:71], v[220:223], v[28:31]
  v_mfma_f32_16x16x32_bf16 v[28:31], v[72:75], v[224:227], v[28:31]
  v_mfma_f32_16x16x32_bf16 v[28:31], v[76:79], v[228:231], v[28:31]
  v_mfma_f32_16x16x32_bf16 v[28:31], v[80:83], v[216:219], v[28:31]
  v_mfma_f32_16x16x32_bf16 v[28:31], v[84:87], v[220:223], v[28:31]
  v_mfma_f32_16x16x32_bf16 v[28:31], v[88:91], v[224:227], v[28:31]
  v_mfma_f32_16x16x32_bf16 v[28:31], v[92:95], v[228:231], v[28:31]
  s_nop 0
  s_waitcnt lgkmcnt(7)
  ds_read_b64_tr_b16 v[144:145], v112 offset:20480
  ds_read_b64_tr_b16 v[146:147], v112 offset:22528
  ds_read_b64_tr_b16 v[148:149], v113 offset:20480
  ds_read_b64_tr_b16 v[150:151], v113 offset:22528
  ds_read_b64_tr_b16 v[152:153], v114 offset:20480
  ds_read_b64_tr_b16 v[154:155], v114 offset:22528
  ds_read_b64_tr_b16 v[156:157], v115 offset:20480
  ds_read_b64_tr_b16 v[158:159], v115 offset:22528
  s_nop 0
  s_waitcnt lgkmcnt(6)
  ds_read_b64_tr_b16 v[160:161], v116 offset:0
  ds_read_b64_tr_b16 v[162:163], v116 offset:1024
  ds_read_b64_tr_b16 v[164:165], v117 offset:0
  ds_read_b64_tr_b16 v[166:167], v117 offset:1024
  ds_read_b64_tr_b16 v[176:177], v116 offset:2048
  ds_read_b64_tr_b16 v[178:179], v116 offset:3072
  ds_read_b64_tr_b16 v[180:181], v117 offset:2048
  ds_read_b64_tr_b16 v[182:183], v117 offset:3072
  s_nop 0
  s_waitcnt lgkmcnt(8)
  v_mfma_f32_16x16x32_bf16 v[28:31], v[128:131], v[232:235], v[28:31]
  v_mfma_f32_16x16x32_bf16 v[28:31], v[132:135], v[236:239], v[28:31]
  v_mfma_f32_16x16x32_bf16 v[28:31], v[136:139], v[240:243], v[28:31]
  v_mfma_f32_16x16x32_bf16 v[28:31], v[140:143], v[244:247], v[28:31]
  v_mfma_f32_16x16x32_bf16 v[28:31], v[144:147], v[232:235], v[28:31]
  v_mfma_f32_16x16x32_bf16 v[28:31], v[148:151], v[236:239], v[28:31]
  v_mfma_f32_16x16x32_bf16 v[28:31], v[152:155], v[240:243], v[28:31]
  v_mfma_f32_16x16x32_bf16 v[28:31], v[156:159], v[244:247], v[28:31]
  s_waitcnt lgkmcnt(7)
  s_waitcnt lgkmcnt(0)
  v_mfma_f32_16x16x32_bf16 v[28:31], v[160:163], v[248:251], v[28:31]
  v_mfma_f32_16x16x32_bf16 v[28:31], v[164:167], v[252:255], v[28:31]
  v_mfma_f32_16x16x32_bf16 v[28:31], v[176:179], v[248:251], v[28:31]
  v_mfma_f32_16x16x32_bf16 v[28:31], v[180:183], v[252:255], v[28:31]
  s_lshl_b32 s5, s77, Lz1-Lz0+14
  s_lshl_b32 s4, s76, 10
  s_add_u32 s5, s5, s4
  s_add_u32 s5, s5, 1376256
  s_nop 3
  buffer_store_dwordx4 v[28:31], v15, s[40:43], s5 offen sc0 sc1
L_194:
  s_barrier
  s_mov_b32 exec_lo, 0xffff
  s_mov_b32 exec_hi, 0
  buffer_load_dword v7, v5, s[40:43], s91 offen sc0 sc1
  s_mov_b64 exec, -1
  s_barrier
  s_waitcnt vmcnt(0)
  s_mov_b32 s89, 200000
  s_mov_b32 exec_lo, 0xffff
  s_mov_b32 exec_hi, 0
  s_branch Lp_197
Lp_196:
  buffer_load_dword v7, v5, s[40:43], s91 offen sc0 sc1
  s_waitcnt vmcnt(0)
Lp_197:
  v_cmp_ne_u32 vcc, 0, v7
  s_andn2_b32 s3, 0xffff, vcc_lo
  s_cbranch_scc0 Lp_198
  s_sleep 1
  s_sub_u32 s89, s89, Lz1-Lz0+1
  s_cbranch_scc0 Lp_196
Lp_198:
  s_mov_b64 exec, -1
  s_cmp_lg_u32 s82, 0
  s_cbranch_scc1 L_199
  s_mov_b32 s5, 1835012
  s_mov_b64 exec, 0x101
  buffer_store_dword v11, v14, s[40:43], s5 offen sc0 sc1
  s_mov_b64 exec, -1
L_199:
  s_add_u32 s5, s84, s92
  buffer_load_dwordx2 v[96:97], v6, s[40:43], s5 offen offset:0 sc1
  buffer_load_dwordx2 v[98:99], v6, s[40:43], s5 offen offset:512 sc1
  buffer_load_dwordx2 v[100:101], v6, s[40:43], s5 offen offset:1024 sc1
  buffer_load_dwordx2 v[102:103], v6, s[40:43], s5 offen offset:1536 sc1
  s_barrier
  s_barrier
  s_barrier
  s_waitcnt vmcnt(0)
  v_add_f32 v96, v96, v100
  v_add_f32 v97, v97, v101
  v_add_f32 v98, v98, v102
  v_add_f32 v99, v99, v103
  v_add_f32_e64 v96, v96, v98
  v_add_f32 v97, v97, v99
  s_nop 0
  v_add_f32_dpp v96, v96, v96 row_ror:8 row_mask:0xf bank_mask:0xf
  v_add_f32_dpp v97, v97, v97 row_ror:8 row_mask:0xf bank_mask:0xf
  v_mov_b32 v98, v96
  v_mov_b32 v99, v97
  s_nop 0
  v_permlane16_swap_b32 v96, v98
  v_permlane16_swap_b32 v97, v99
  v_add_f32 v96, v96, v98
  v_add_f32 v97, v97, v99
  v_mov_b32 v98, v96
  v_mov_b32 v99, v97
  s_nop 0
  v_permlane32_swap_b32 v96, v98
  v_permlane32_swap_b32 v97, v99
  v_add_f32 v96, v96, v98
  v_add_f32 v97, v97, v99
  v_mul_f32 v96, 0x3a800000, v96
  v_mul_f32 v97, 0x3a800000, v97
  v_fma_f32 v98, -v96, v96, v97
  v_max_f32_e64 v98, 0, v98
  v_add_f32 v98, 0x3727c5ac, v98
  v_rsq_f32_e64 v98, v98
  v_mov_b32 v99, v96
  s_mov_b64 exec, s[8:9]
  buffer_store_dwordx2 v[98:99], v6, s[40:43], s10 offen sc0 sc1
  s_mov_b64 exec, -1
  s_barrier
  s_barrier
  s_barrier
  s_barrier
  s_barrier
  s_cmp_lg_u32 s82, 0
  s_cbranch_scc1 L_201
  s_lshl_b32 s91, s84, Lz1-Lz0+1
  s_and_b32 s91, s91, 0x8f000
  s_add_u32 s91, s91, 1835012
  s_mov_b32 exec_lo, 0xffff
  s_mov_b32 exec_hi, 0
  buffer_load_dword v7, v5, s[40:43], s91 offen sc0 sc1
  s_mov_b64 exec, -1
L_201:
  s_and_b32 s5, s10, 0xfffffc00
  buffer_load_dwordx4 v[120:123], v4, s[40:43], s5 offen sc1
  s_barrier
  s_barrier
  s_waitcnt vmcnt(0)
  s_mov_b32 s89, 200000
  s_branch Lp_204
Lp_203:
  s_and_b32 s5, s10, 0xfffffc00
  buffer_load_dwordx4 v[120:123], v4, s[40:43], s5 offen sc1
  s_waitcnt vmcnt(0)
Lp_204:
  v_min_u32 v2, v120, v122
  v_cmp_eq_u32 vcc, 0, v2
  s_cmp_eq_u64 vcc, 0
  s_cbranch_scc1 Lp_205
  s_sleep 1
  s_sub_u32 s89, s89, 1
  s_cbranch_scc0 Lp_203
Lp_205:
  s_and_b32 s5, s10, 0xfffffc00
  s_mov_b32 m0, 151552
  s_nop 0
  buffer_load_dword v6, s[40:43], s5 offen offset:0 sc1 lds
  s_mov_b32 m0, 152188
  s_nop 0
  buffer_load_dword v6, s[40:43], s5 offen offset:4 sc1 lds
  s_mov_b32 m0, 151360
  s_nop 0
  buffer_load_dword v6, s[40:43], s5 offen offset:512 sc1 lds
  s_mov_b32 m0, 151996
  s_nop 0
  buffer_load_dword v6, s[40:43], s5 offen offset:516 sc1 lds
  s_add_u32 s10, s10, 16384
  s_barrier
  s_cmp_lg_u32 s82, Lz1-Lz0+0
  s_cbranch_scc1 L_206
  s_mov_b32 s89, 200000
  s_mov_b32 exec_lo, 0xffff
  s_mov_b32 exec_hi, 0
  s_branch Lp_209
Lp_208:
  buffer_load_dword v7, v5, s[40:43], s91 offen sc0 sc1
  s_waitcnt vmcnt(0)
Lp_209:
  v_cmp_ne_u32 vcc, 0, v7
  s_andn2_b32 s3, 0xffff, vcc_lo
  s_cbranch_scc0 Lp_210
  s_sleep 1
  s_sub_u32 s89, s89, 1
  s_cbranch_scc0 Lp_208
Lp_210:
  s_mov_b64 exec, -1
  s_lshl_b32 s5, s77, 14
  s_add_u32 s5, s5, 1376256
  buffer_load_dwordx4 v[192:195], v4, s[40:43], s5 offen offset:0 sc1
  buffer_load_dwordx4 v[196:199], v4, s[40:43], s5 offen offset:1024 sc1
  buffer_load_dwordx4 v[200:203], v4, s[40:43], s5 offen offset:2048 sc1
  buffer_load_dwordx4 v[204:207], v4, s[40:43], s5 offen offset:3072 sc1
  s_add_u32 s5, s5, 4096
  buffer_load_dwordx4 v[208:211], v4, s[40:43], s5 offen offset:0 sc1
  buffer_load_dwordx4 v[212:215], v4, s[40:43], s5 offen offset:1024 sc1
  buffer_load_dwordx4 v[216:219], v4, s[40:43], s5 offen offset:2048 sc1
  buffer_load_dwordx4 v[220:223], v4, s[40:43], s5 offen offset:3072 sc1
  s_lshl_b32 s5, s77, Lz1-Lz0+14
  s_add_u32 s5, s5, 1384448
  buffer_load_dwordx4 v[224:227], v4, s[40:43], s5 offen offset:0 sc1
  buffer_load_dwordx4 v[228:231], v4, s[40:43], s5 offen offset:1024 sc1
  buffer_load_dwordx4 v[232:235], v4, s[40:43], s5 offen offset:2048 sc1
  buffer_load_dwordx4 v[236:239], v4, s[40:43], s5 offen offset:3072 sc1
  s_add_u32 s5, s5, 4096
  buffer_load_dwordx4 v[240:243], v4, s[40:43], s5 offen offset:0 sc1
  buffer_load_dwordx4 v[244:247], v4, s[40:43], s5 offen offset:1024 sc1
  buffer_load_dwordx4 v[248:251], v4, s[40:43], s5 offen offset:2048 sc1
  buffer_load_dwordx4 v[252:255], v4, s[40:43], s5 offen offset:3072 sc1
L_206:
  s_barrier
  s_cmp_lg_u32 s82, 0
  s_cbranch_scc1 L_211
  s_waitcnt vmcnt(8)
  v_add_f32 v192, v192, v208
  v_add_f32 v193, v193, v209
  v_add_f32 v194, v194, v210
  v_add_f32 v195, v195, v211
  v_add_f32 v196, v196, v212
  v_add_f32 v197, v197, v213
  v_add_f32 v198, v198, v214
  v_add_f32 v199, v199, v215
  v_add_f32 v200, v200, v216
  v_add_f32 v201, v201, v217
  v_add_f32 v202, v202, v218
  v_add_f32 v203, v203, v219
  v_add_f32 v204, v204, v220
  v_add_f32 v205, v205, v221
  v_add_f32 v206, v206, v222
  v_add_f32 v207, v207, v223
  v_add_f32 v192, v192, v200
  v_add_f32 v193, v193, v201
  v_add_f32 v194, v194, v202
  v_add_f32 v195, v195, v203
  v_add_f32 v196, v196, v204
  v_add_f32 v197, v197, v205
  v_add_f32 v198, v198, v206
  v_add_f32 v199, v199, v207
  v_add_f32 v192, v192, v196
  v_add_f32 v193, v193, v197
  v_add_f32 v194, v194, v198
  v_add_f32 v195, v195, v199
L_211:
  s_cmp_lg_u32 s82, 0
  s_cbranch_scc1 L_213
  buffer_load_dword v109, v110, s[60:63], s13 offen
  s_sub_u32 s13, s13, 8192
  buffer_load_dword v109, v110, s[60:63], s13 offen
  s_sub_u32 s13, s13, 8192
L_213:
  s_barrier
  s_cmp_lg_u32 s82, 0
  s_cbranch_scc1 L_215
  s_cmp_lg_u32 s82, 0
  s_cbranch_scc1 L_217
  s_waitcnt vmcnt(2)
  s_branch L_218
L_217:
  s_waitcnt vmcnt(0)
L_218:
  v_add_f32 v224, v224, v240
  v_add_f32 v225, v225, v241
  v_add_f32 v226, v226, v242
  v_add_f32 v227, v227, v243
  v_add_f32 v228, v228, v244
  v_add_f32 v229, v229, v245
  v_add_f32 v230, v230, v246
  v_add_f32 v231, v231, v247
  v_add_f32 v232, v232, v248
  v_add_f32 v233, v233, v249
  v_add_f32 v234, v234, v250
  v_add_f32 v235, v235, v251
  v_add_f32 v236, v236, v252
  v_add_f32 v237, v237, v253
  v_add_f32 v238, v238, v254
  v_add_f32 v239, v239, v255
  v_add_f32 v224, v224, v232
  v_add_f32 v225, v225, v233
  v_add_f32 v226, v226, v234
  v_add_f32 v227, v227, v235
  v_add_f32 v228, v228, v236
  v_add_f32 v229, v229, v237
  v_add_f32 v230, v230, v238
  v_add_f32 v231, v231, v239
  v_add_f32 v224, v224, v228
  v_add_f32 v225, v225, v229
  v_add_f32 v226, v226, v230
  v_add_f32 v227, v227, v231
  v_add_f32 v192, v192, v224
  v_add_f32 v193, v193, v225
  v_add_f32 v194, v194, v226
  v_add_f32 v195, v195, v227
  v_add_u32 v2, 154112, v4
  ds_write_b128 v2, v[192:195]
  s_branch L_216
  s_nop 0
L_215:
  s_waitcnt vmcnt(0)
L_216:
  s_waitcnt lgkmcnt(0)
  s_barrier
  v_lshlrev_b32 v2, 12, v1
  s_lshl_b32 s4, s76, 16
  s_lshl_b32 s5, s77, 7
  s_add_u32 s4, s4, s5
  s_add_u32 s4, s4, s87
  s_add_u32 s5, s4, 24
  s_lshl_b32 s4, s79, 3
  s_lshl_b32 s90, 0xff, s4
  s_lshl_b32 s91, s84, 1
  s_add_u32 s91, s91, s87
  s_add_u32 s91, s91, 24
  s_lshl_b32 s4, s82, 7
  s_add_u32 s4, s4, 1837056
  s_lshl_b32 s5, s84, 1
  s_add_u32 s5, s5, s4
  s_and_b32 s91, s5, 0xffff0fff
  s_barrier
  s_barrier
  s_barrier
  s_mov_b32 exec_lo, 1
  s_mov_b32 exec_hi, Lz1-Lz0+0
  buffer_store_dword v11, v2, s[40:43], s5 offen sc0 sc1
  s_mov_b64 exec, -1
  s_barrier
  s_barrier
  s_barrier
  s_mov_b32 exec_lo, s90
  s_mov_b32 exec_hi, 0
  buffer_load_dword v7, v2, s[40:43], s91 offen sc0 sc1
  s_mov_b64 exec, -1
  s_barrier
  s_waitcnt vmcnt(0)
  s_mov_b32 s89, 200000
  s_mov_b32 exec_lo, s90
  s_mov_b32 exec_hi, 0
  s_branch Lp_220
Lp_219:
  buffer_load_dword v7, v2, s[40:43], s91 offen sc0 sc1
  s_waitcnt vmcnt(0)
Lp_220:
  v_cmp_ne_u32 vcc, 0, v7
  s_andn2_b32 s3, s90, vcc_lo
  s_cbranch_scc0 Lp_221
  s_sleep 1
  s_sub_u32 s89, s89, 1
  s_cbranch_scc0 Lp_219
Lp_221:
  s_mov_b64 exec, -1
  s_xor_b32 s90, s90, 0xffff
  s_barrier
  s_barrier
  s_barrier
  s_barrier
  s_barrier
  s_barrier
  s_barrier
  s_barrier
  s_barrier
  s_barrier
  s_mov_b32 exec_lo, s90
  s_mov_b32 exec_hi, 0
  buffer_load_dword v7, v2, s[40:43], s91 offen sc0 sc1
  s_mov_b64 exec, -1
  s_barrier
  s_barrier
  s_barrier
  s_waitcnt vmcnt(0)
  s_mov_b32 s89, 200000
  s_mov_b32 exec_lo, s90
  s_mov_b32 exec_hi, 0
  s_branch Lp_223
Lp_222:
  buffer_load_dword v7, v2, s[40:43], s91 offen sc0 sc1
  s_waitcnt vmcnt(0)
Lp_223:
  v_cmp_ne_u32 vcc, 0, v7
  s_andn2_b32 s3, s90, vcc_lo
  s_cbranch_scc0 Lp_224
  s_sleep 1
  s_sub_u32 s89, s89, 1
  s_cbranch_scc0 Lp_222
Lp_224:
  s_mov_b64 exec, -1
  s_barrier
  s_barrier
  s_barrier
  s_barrier
  s_barrier
  s_barrier
  s_barrier
  s_barrier
  s_barrier
  s_barrier
  s_barrier
  s_cmp_lg_u32 s82, 0
  s_cbranch_scc1 L_lend
  s_add_u32 s92, s83, 36700160
  s_mov_b32 s82, 1
  s_mov_b32 s14, 0
  s_add_u32 s83, s83, 0
  s_add_u32 s87, s87, 32
  s_branch L_slayer
L_lend:
Lz0:
Lz1:
L_end:
  s_endpgm
.section .rodata,"a"
.p2align 6
.amdhsa_kernel mega_kernel
  .amdhsa_next_free_vgpr 256
  .amdhsa_next_free_sgpr 102
  .amdhsa_accum_offset 256
  .amdhsa_group_segment_fixed_size 0
  .amdhsa_kernarg_size 88
  .amdhsa_user_sgpr_count 2
  .amdhsa_user_sgpr_kernarg_segment_ptr 1
  .amdhsa_system_sgpr_workgroup_id_x 1
  .amdhsa_float_denorm_mode_32 3
  .amdhsa_float_denorm_mode_16_64 3
.end_amdhsa_kernel
.text
```

```asm
; @launch kernel=mega_kernel grid=(256,1,1) block=(512,1,1) lds=156672
.amdgcn_target "amdgcn-amd-amdhsa--gfx950"
.text
.globl mega_kernel
.p2align 8
.type mega_kernel,@function
mega_kernel:
  s_cmp_ge_u32 s2, 256
  s_nop 0
  s_cbranch_scc1 L_end
  s_load_dwordx16 s[16:31], s[0:1], 0
  s_load_dwordx2 s[32:33], s[0:1], 64
  s_load_dwordx4 s[36:39], s[0:1], 72
  v_lshrrev_b32 v2, 6, v0
  v_and_b32 v1, 63, v0
  v_readfirstlane_b32 s81, v2
  s_and_b32 s3, s2, 7
  s_lshr_b32 s4, s2, 3
  s_and_b32 s5, s3, 1
  s_lshl_b32 s5, s5, 3
  s_and_b32 s6, s4, 7
  s_add_u32 s76, s5, s6
  s_lshr_b32 s5, s3, 1
  s_lshl_b32 s5, s5, 2
  s_lshr_b32 s6, s4, 3
  s_add_u32 s77, s5, s6
  s_mov_b32 s82, 0
  s_mov_b32 s88, 0
  s_and_b32 s85, s81, 1
  s_cmp_lt_u32 s81, 4
  s_cbranch_scc1 L_comp
  s_cmp_eq_u32 s81, Lz1-Lz0+5
  s_cbranch_scc1 L_serv
  s_setprio 0
  s_cmp_eq_u32 s81, 4
  s_cbranch_scc1 L_xload
  v_bfe_u32 v2, v1, 1, 2
  v_bfe_u32 v3, v1, 4, 2
  v_xor_b32 v2, v2, v3
  v_lshlrev_b32 v10, 5, v2
  v_and_b32_e64 v2, 1, v1
  v_lshl_add_u32 v10, v2, 4, v10
  v_lshrrev_b32_e64 v2, 5, v1
  v_bfe_u32 v3, v1, 3, 2
  v_lshl_add_u32 v2, v2, 3, v3
  s_mov_b32 s4, 6144
  v_mad_u32_u24 v16, v2, s4, v10
  v_add_u32 v17, 97280, v16
  v_add_u32 v18, 22528, v16
  v_add_u32 v19, 119808, v16
  s_lshl_b32 s5, s77, Lz1-Lz0+7
  s_mul_i32 s4, s85, 196608
  s_add_u32 s5, s5, s4
  s_and_b32 s6, s76, 6
  s_lshr_b32 s4, s76, 3
  s_add_u32 s6, s6, s4
  s_lshl_b32 s6, s6, 1
  v_add_u32 v20, s6, v1
  v_and_b32_e64 v20, 15, v20
  s_mov_b32 s4, 393216
  v_mul_u32_u24 v20, s4, v20
  v_add_u32 v20, s5, v20
  s_nop 0
  v_readfirstlane_b32 s7, v20
  s_lshl_b32 s11, s85, Lz1-Lz0+12
  s_add_u32 s11, s11, 65536
  s_add_u32 s15, s11, 73728
  s_waitcnt lgkmcnt(0)
  s_mov_b32 s48, s18
  s_and_b32 s49, s19, 0xffff
  s_mov_b32 s50, 6291456
  s_mov_b32 s51, 0x00020000
L_wlayer:
  s_mov_b32 s12, 0
  s_mov_b32 m0, s11
  s_cmp_eq_u32 s82, 0
  s_cbranch_scc1 Ll_34
  s_waitcnt vmcnt(12)
  s_barrier
  s_waitcnt vmcnt(8)
  s_barrier
  s_waitcnt vmcnt(4)
  s_barrier
  s_waitcnt vmcnt(0)
  s_barrier
  s_barrier
  s_branch Ll_34
Lt_40:
  s_cmp_lg_u32 s12, 1
  s_cbranch_scc1 Ll_34
  s_cmp_eq_u32 s82, 0
  s_cbranch_scc1 Ll_34
  s_waitcnt vmcnt(0)
  s_barrier
Ll_34:
  buffer_load_dwordx4 v16, s[48:51], s7 offen offset:0  lds
  buffer_load_dwordx4 v17, s[48:51], s7 offen offset:1024  lds
  buffer_load_dwordx4 v18, s[48:51], s7 offen offset:2048  lds
  buffer_load_dwordx4 v19, s[48:51], s7 offen offset:3072  lds
  s_add_u32 m0, s11, 8192
  s_add_u32 s5, s7, 2048
  buffer_load_dwordx4 v16, s[48:51], s5 offen offset:0  lds
  buffer_load_dwordx4 v17, s[48:51], s5 offen offset:1024  lds
  buffer_load_dwordx4 v18, s[48:51], s5 offen offset:2048  lds
  buffer_load_dwordx4 v19, s[48:51], s5 offen offset:3072  lds
  s_add_u32 m0, s11, 16384
  s_add_u32 s5, s7, 4096
  buffer_load_dwordx4 v16, s[48:51], s5 offen offset:0  lds
  s_add_u32 s12, s12, Lz1-Lz0+1
  v_readlane_b32 s7, v20, s12
  s_add_u32 s11, s11, 24576
  buffer_load_dwordx4 v17, s[48:51], s5 offen offset:1024  lds
  s_cmp_eq_u32 s11, s15
  s_cselect_b32 s4, 73728, 0
  s_sub_u32 s11, s11, s4
  buffer_load_dwordx4 v18, s[48:51], s5 offen offset:2048  lds
  s_cmp_lg_u32 s12, Lz1-Lz0+3
  buffer_load_dwordx4 v19, s[48:51], s5 offen offset:3072  lds
  s_mov_b32 m0, s11
  s_cbranch_scc1 Lt_40
Lt_41:
  s_cmp_lg_u32 s82, Lz1-Lz0+0
  s_cbranch_scc1 Ll_42
  s_waitcnt vmcnt(24)
  s_barrier
Ll_42:
  s_mul_i32 s5, s85, 6144
  s_mov_b32 s68, s24
  s_and_b32 s69, s25, 0xffff
  s_mov_b32 s70, 7340032
  s_mov_b32 s71, 0x00020000
  s_lshl_b32 s4, s76, 4
  s_add_u32 s4, s4, s77
  s_mul_i32 s34, s4, 28672
  s_add_u32 s34, s34, s5
  s_mov_b32 s40, s38
  s_and_b32 s41, s39, 0xffff
  s_mov_b32 s42, 100663296
  s_mov_b32 s43, 0x00020000
  s_nop 0
  s_mov_b32 s52, s20
  s_and_b32 s53, s21, 0xffff
  s_mov_b32 s54, 2097152
  s_mov_b32 s55, 0x00020000
  s_nop 0
  s_mov_b32 s56, s24
  s_and_b32 s57, s25, 0xffff
  s_mov_b32 s58, 7340032
  s_mov_b32 s59, 0x00020000
  s_nop 0
  s_mov_b32 s60, s28
  s_and_b32 s61, s29, 0xffff
  s_mov_b32 s62, 7340032
  s_mov_b32 s63, 0x00020000
  s_cmp_lg_u32 s82, 0
  s_cbranch_scc1 L_43
  s_and_b32 s80, s77, 7
  s_lshr_b32 s79, s77, 3
  s_lshl_b32 s78, s80, 1
  s_add_u32 s78, s78, s79
  s_lshl_b32 s5, s76, 4
  s_add_u32 s5, s5, s77
  s_lshl_b32 s84, s5, Lz1-Lz0+11
  s_mov_b32 s83, 3145728
  s_mov_b32 s87, 1835016
  s_lshr_b32 s86, s81, 1
  v_lshrrev_b32 v2, 3, v1
  s_mov_b32 s4, 2048
  v_mad_u32_u24 v4, v2, s4, v10
  v_add_u32 v5, 15360, v4
  v_add_u32 v6, 30720, v4
  v_add_u32 v7, 46080, v4
  s_lshl_b32 s5, s78, Lz1-Lz0+7
  s_mul_i32 s4, s85, 65536
  s_add_u32 s5, s5, s4
  s_mul_i32 s4, s76, 14
  s_lshr_b32 s4, s4, 4
  v_add_u32 v39, s4, v1
  v_subrev_u32 v2, 14, v39
  v_min_u32 v39, v39, v2
  v_cmp_le_u32 vcc, 14, v1
  s_nop 1
  v_cndmask_b32 v39, v39, v1, vcc
  v_lshlrev_b32 v39, 2, v39
  v_mov_b32 v2, 0x87654210
  v_mov_b32 v3, 0xb3fedca9
  v_lshrrev_b64 v[2:3], v39, v[2:3]
  v_and_b32_e64 v39, 15, v2
  v_cmp_eq_u32 vcc, s77, v39
  s_nop 0
  v_mov_b32_dpp v2, v39 row_shr:1 row_mask:0xf bank_mask:0xf
  s_ff1_i32_b32 s4, vcc_lo
  v_cmp_ge_u32 vcc, s4, v1
  s_nop 1
  v_cndmask_b32 v39, v39, v2, vcc
  v_writelane_b32 v39, s77, 0
  v_lshl_add_u32 v38, v39, 17, s5
L_43:
  s_waitcnt vmcnt(12)
  s_barrier
  buffer_load_dwordx4 v16, s[48:51], s7 offen offset:0  lds
  buffer_load_dwordx4 v17, s[48:51], s7 offen offset:1024  lds
  buffer_load_dwordx4 v18, s[48:51], s7 offen offset:2048  lds
  buffer_load_dwordx4 v19, s[48:51], s7 offen offset:3072  lds
Ll_44:
  s_add_u32 m0, s11, 8192
  s_add_u32 s5, s7, 2048
  buffer_load_dwordx4 v16, s[48:51], s5 offen offset:0  lds
  buffer_load_dwordx4 v17, s[48:51], s5 offen offset:1024  lds
  buffer_load_dwordx4 v18, s[48:51], s5 offen offset:2048  lds
  buffer_load_dwordx4 v19, s[48:51], s5 offen offset:3072  lds
  s_add_u32 m0, s11, 16384
  s_add_u32 s5, s7, 4096
  buffer_load_dwordx4 v16, s[48:51], s5 offen offset:0  lds
  s_add_u32 s12, s12, Lz1-Lz0+1
  v_readlane_b32 s7, v20, s12
  s_add_u32 s11, s11, 24576
  buffer_load_dwordx4 v17, s[48:51], s5 offen offset:1024  lds
  s_cmp_eq_u32 s11, s15
  s_cselect_b32 s4, 73728, 0
  s_sub_u32 s11, s11, s4
  buffer_load_dwordx4 v18, s[48:51], s5 offen offset:2048  lds
  s_cmp_eq_u32 s12, Lz1-Lz0+16
  buffer_load_dwordx4 v19, s[48:51], s5 offen offset:3072  lds
  s_mov_b32 m0, s11
  s_cbranch_scc1 Ll_45
  s_cmp_lg_u32 s82, 0
  s_cbranch_scc1 L_46
  s_buffer_load_dwordx2 s[98:99], s[68:71], s34 offset:60
  s_buffer_load_dwordx2 s[98:99], s[68:71], s34 offset:188
  s_buffer_load_dwordx2 s[98:99], s[68:71], s34 offset:316
  s_buffer_load_dwordx2 s[98:99], s[68:71], s34 offset:444
  s_add_u32 s34, s34, 512
L_46:
  s_waitcnt vmcnt(12)
  s_barrier
  buffer_load_dwordx4 v16, s[48:51], s7 offen offset:0  lds
  buffer_load_dwordx4 v17, s[48:51], s7 offen offset:1024  lds
  buffer_load_dwordx4 v18, s[48:51], s7 offen offset:2048  lds
  buffer_load_dwordx4 v19, s[48:51], s7 offen offset:3072  lds
  s_branch Ll_44
Ll_45:
  s_branch L_w1
L_xload:
  s_setprio 0
  v_lshrrev_b32 v2, 4, v1
  v_and_b32 v3, 7, v1
  v_xor_b32 v2, v2, v3
  v_lshrrev_b32 v3, 3, v1
  v_lshlrev_b32 v3, 12, v3
  v_lshl_add_u32 v4, v2, 4, v3
  v_xor_b32_e64 v5, 64, v4
  v_add_u32 v5, 31744, v5
  v_add_u32 v6, 63488, v4
  v_add_u32 v7, 63488, v5
  s_mov_b32 s13, 0x20000
  s_movk_i32 s95, 2048
  s_lshl_b32 s5, s76, 18
  s_and_b32 s6, s76, 6
  s_lshr_b32 s4, s76, 3
  s_add_u32 s6, s6, s4
  s_lshl_b32 s6, s6, 1
  v_add_u32 v9, s6, v1
  v_and_b32 v9, 15, v9
  v_lshl_add_u32 v9, v9, 7, s5
  s_nop 0
  v_readfirstlane_b32 s7, v9
  s_waitcnt lgkmcnt(0)
  s_mov_b32 s72, s16
  s_and_b32 s73, s17, 0xffff
  s_mov_b32 s74, 4194304
  s_mov_b32 s75, 0x00020000
  s_mov_b32 s11, 0
  s_mov_b32 s15, 65536
L_xlayer:
  s_mov_b32 s12, s82
  s_mov_b32 m0, s11
Ll_87:
  s_nop 0
  buffer_load_dwordx4 v4, s[72:75], s7 offen offset:0 sc1 lds
  buffer_load_dwordx4 v5, s[72:75], s7 offen offset:1024 sc1 lds
  buffer_load_dwordx4 v6, s[72:75], s7 offen offset:2048 sc1 lds
  buffer_load_dwordx4 v7, s[72:75], s7 offen offset:3072 sc1 lds
  s_add_u32 m0, s11, 4096
  s_nop 0
  s_add_u32 s5, s7, s13
  buffer_load_dwordx4 v4, s[72:75], s5 offen offset:0 sc1 lds
  buffer_load_dwordx4 v5, s[72:75], s5 offen offset:1024 sc1 lds
  buffer_load_dwordx4 v6, s[72:75], s5 offen offset:2048 sc1 lds
  buffer_load_dwordx4 v7, s[72:75], s5 offen offset:3072 sc1 lds
  s_add_u32 m0, s11, 8192
  s_nop 0
  s_add_u32 s3, s7, s95
  buffer_load_dwordx4 v4, s[72:75], s3 offen offset:0 sc1 lds
  buffer_load_dwordx4 v5, s[72:75], s3 offen offset:1024 sc1 lds
  buffer_load_dwordx4 v6, s[72:75], s3 offen offset:2048 sc1 lds
  buffer_load_dwordx4 v7, s[72:75], s3 offen offset:3072 sc1 lds
  s_add_u32 m0, s11, 12288
  s_add_u32 s5, s3, s13
  buffer_load_dwordx4 v4, s[72:75], s5 offen offset:0 sc1 lds
  s_add_u32 s12, s12, 1
  v_readlane_b32 s7, v9, s12
  s_add_u32 s11, s11, 16384
  buffer_load_dwordx4 v5, s[72:75], s5 offen offset:1024 sc1 lds
  s_cmp_eq_u32 s11, s15
  s_cselect_b32 s4, 65536, 0
  s_sub_u32 s11, s11, s4
  buffer_load_dwordx4 v6, s[72:75], s5 offen offset:2048 sc1 lds
  s_cmp_lg_u32 s12, Lz1-Lz0+2
  buffer_load_dwordx4 v7, s[72:75], s5 offen offset:3072 sc1 lds
  s_mov_b32 m0, s11
  s_cbranch_scc1 Ll_88
  s_cmp_lg_u32 s82, 0
  s_cbranch_scc1 Ll_88
  s_waitcnt vmcnt(16)
  s_barrier
Ll_92:
Ll_88:
  s_cmp_lt_u32 s12, Lz1-Lz0+4
  s_cbranch_scc1 Ll_87
  s_mov_b32 s68, s20
  s_and_b32 s69, s21, 0xffff
  s_mov_b32 s70, 2097152
  s_mov_b32 s71, 0x00020000
  s_lshl_b32 s4, s76, 4
  s_add_u32 s4, s4, s77
  s_mul_i32 s34, s4, 8192
  s_waitcnt vmcnt(32)
  s_barrier
  buffer_load_dwordx4 v4, s[72:75], s7 offen offset:0 sc1 lds
  buffer_load_dwordx4 v5, s[72:75], s7 offen offset:1024 sc1 lds
  buffer_load_dwordx4 v6, s[72:75], s7 offen offset:2048 sc1 lds
  buffer_load_dwordx4 v7, s[72:75], s7 offen offset:3072 sc1 lds
Ll_93:
  s_add_u32 m0, s11, 4096
  s_nop 0
  s_add_u32 s5, s7, s13
  buffer_load_dwordx4 v4, s[72:75], s5 offen offset:0 sc1 lds
  buffer_load_dwordx4 v5, s[72:75], s5 offen offset:1024 sc1 lds
  buffer_load_dwordx4 v6, s[72:75], s5 offen offset:2048 sc1 lds
  buffer_load_dwordx4 v7, s[72:75], s5 offen offset:3072 sc1 lds
  s_add_u32 m0, s11, 8192
  s_nop 0
  s_add_u32 s3, s7, s95
  buffer_load_dwordx4 v4, s[72:75], s3 offen offset:0 sc1 lds
  buffer_load_dwordx4 v5, s[72:75], s3 offen offset:1024 sc1 lds
  buffer_load_dwordx4 v6, s[72:75], s3 offen offset:2048 sc1 lds
  buffer_load_dwordx4 v7, s[72:75], s3 offen offset:3072 sc1 lds
  s_add_u32 m0, s11, 12288
  s_add_u32 s5, s3, s13
  buffer_load_dwordx4 v4, s[72:75], s5 offen offset:0 sc1 lds
  s_add_u32 s12, s12, 1
  v_readlane_b32 s7, v9, s12
  s_add_u32 s11, s11, 16384
  buffer_load_dwordx4 v5, s[72:75], s5 offen offset:1024 sc1 lds
  s_cmp_eq_u32 s11, s15
  s_cselect_b32 s4, 65536, 0
  s_sub_u32 s11, s11, s4
  buffer_load_dwordx4 v6, s[72:75], s5 offen offset:2048 sc1 lds
  s_cmp_eq_u32 s12, Lz1-Lz0+16
  buffer_load_dwordx4 v7, s[72:75], s5 offen offset:3072 sc1 lds
  s_mov_b32 m0, s11
  s_cbranch_scc1 Ll_94
  s_cmp_lg_u32 s82, 0
  s_cbranch_scc1 L_95
  s_buffer_load_dwordx2 s[98:99], s[68:71], s34 offset:60
  s_buffer_load_dwordx2 s[98:99], s[68:71], s34 offset:188
  s_buffer_load_dwordx2 s[98:99], s[68:71], s34 offset:316
  s_buffer_load_dwordx2 s[98:99], s[68:71], s34 offset:444
  s_buffer_load_dwordx2 s[98:99], s[68:71], s34 offset:572
  s_add_u32 s34, s34, 640
L_95:
  s_waitcnt vmcnt(32)
  s_barrier
  buffer_load_dwordx4 v4, s[72:75], s7 offen offset:0 sc1 lds
  buffer_load_dwordx4 v5, s[72:75], s7 offen offset:1024 sc1 lds
  buffer_load_dwordx4 v6, s[72:75], s7 offen offset:2048 sc1 lds
  buffer_load_dwordx4 v7, s[72:75], s7 offen offset:3072 sc1 lds
  s_branch Ll_93
Ll_94:
  s_waitcnt vmcnt(32)
  s_barrier
  s_branch L_x1
L_serv:
  s_setprio 3
  s_and_b32 s80, s77, 7
  s_lshr_b32 s79, s77, 3
  s_lshl_b32 s78, s80, 1
  s_add_u32 s78, s78, s79
  s_lshl_b32 s5, s76, 4
  s_add_u32 s5, s5, s77
  s_lshl_b32 s84, s5, 11
  s_mov_b32 s83, 3145728
  s_mov_b32 s87, 1835016
  s_lshr_b32 s86, s81, 1
  v_lshlrev_b32 v4, 4, v1
  v_mov_b32 v24, 0
  v_mov_b32 v25, 0
  v_mov_b32 v26, 0
  v_mov_b32 v27, 0
  v_and_b32 v2, 14, v1
  v_lshlrev_b32 v3, 11, v2
  v_and_b32_e64 v2, 1, v1
  v_lshl_add_u32 v3, v2, 4, v3
  v_and_b32_e64 v2, 48, v1
  v_lshl_add_u32 v3, v2, 1, v3
  v_bfe_u32 v2, v1, 3, 2
  v_and_b32 v22, 7, v1
  v_lshlrev_b32 v2, 14, v2
  v_lshl_add_u32 v2, v22, 3, v2
  s_lshl_b32 s5, s76, 7
  s_lshl_b32 s4, s80, 4
  s_add_u32 s6, s5, s4
  s_add_u32 s6, s6, s79
  s_lshl_b32 s6, s6, 11
  s_lshr_b32 s10, s84, 5
  s_add_u32 s10, s10, 1638400
  s_waitcnt lgkmcnt(0)
  s_mov_b32 s40, s38
  s_and_b32 s41, s39, 0xffff
  s_mov_b32 s42, 100663296
  s_mov_b32 s43, 0x00020000
  s_nop 0
  s_mov_b32 s44, s16
  s_and_b32 s45, s17, 0xffff
  s_mov_b32 s46, 4194304
  s_mov_b32 s47, 0x00020000
  s_nop 0
  s_mov_b32 s68, s36
  s_and_b32 s69, s37, 0xffff
  s_mov_b32 s70, 256
  s_mov_b32 s71, 0x00020000
  s_lshl_b32 s4, s84, Lz1-Lz0+1
  s_add_u32 s4, s4, 1835008
  buffer_store_dwordx4 v[24:27], v4, s[40:43], s4 offen offset:0 sc0 sc1
  buffer_store_dwordx4 v[24:27], v4, s[40:43], s4 offen offset:1024 sc0 sc1
  s_mov_b64 exec, 0xffff
  buffer_store_dwordx4 v[24:27], v4, s[40:43], s4 offen offset:2048 sc0 sc1
  s_mov_b64 exec, -1
  v_mov_b32 v28, -1
  v_mov_b32 v29, -1
  v_mov_b32 v30, -1
  v_mov_b32 v31, -1
  s_lshl_b32 s4, s84, 1
  s_add_u32 s4, s4, Lz1-Lz0+0
  buffer_store_dwordx4 v[28:31], v4, s[40:43], s4 offen offset:0 sc0 sc1
  buffer_store_dwordx4 v[28:31], v4, s[40:43], s4 offen offset:1024 sc0 sc1
  buffer_store_dwordx4 v[28:31], v4, s[40:43], s4 offen offset:2048 sc0 sc1
  buffer_store_dwordx4 v[28:31], v4, s[40:43], s4 offen offset:3072 sc0 sc1
  buffer_store_dwordx2 v[24:25], v2, s[40:43], s10 offen sc0 sc1
  v_mov_b32 v108, v3
  s_mov_b32 s7, s6
  s_branch L_s1
L_comp:
  s_and_b32 s80, s77, 7
  s_lshr_b32 s79, s77, 3
  s_lshl_b32 s78, s80, 1
  s_add_u32 s78, s78, s79
  s_lshl_b32 s5, s76, 4
  s_add_u32 s5, s5, s77
  s_lshl_b32 s84, s5, 11
  s_mov_b32 s83, 3145728
  s_mov_b32 s87, 1835016
  s_lshr_b32 s86, s81, Lz1-Lz0+1
  s_waitcnt lgkmcnt(0)
  s_mov_b32 s40, s38
  s_and_b32 s41, s39, 0xffff
  s_mov_b32 s42, 100663296
  s_mov_b32 s43, 0x00020000
  s_nop 0
  s_mov_b32 s64, s32
  s_and_b32 s65, s33, 0xffff
  s_mov_b32 s66, 4194304
  s_mov_b32 s67, 0x00020000
  s_bfe_u32 s4, s2, 0x30003
  s_lshl2_add_u32 s4, s4, s81
  s_cmp_lt_u32 s4, 20
  s_cbranch_scc0 L_tlo
  s_lshl_b32 s4, s4, 21
  s_buffer_load_dword s99, s[40:43], s4 offset:4032
  s_branch L_tle
L_tlo:
  s_lshl_b32 s4, s85, 21
  s_buffer_load_dword s99, s[64:67], s4 offset:4032
L_tle:
  s_setprio 1
  v_lshlrev_b32 v11, 4, v1
  v_lshrrev_b32 v2, 3, v1
  v_and_b32 v3, 7, v1
  v_lshlrev_b32_e64 v3, 3, v3
  v_lshl_add_u32 v30, v2, 11, v3
  s_lshl_b32 s4, s85, 13
  s_lshl_b32 s5, s86, 10
  s_add_u32 s4, s4, s5
  v_add_u32 v0, s4, v11
  v_mov_b32_e64 v27, 1
  v_mov_b32 v28, 156416
  v_and_b32 v29, 48, v1
  s_lshl_b32 s4, s76, 16
  s_lshl_b32 s5, s77, 7
  s_add_u32 s4, s4, s5
  v_lshlrev_b32 v24, 12, v1
  v_and_b32 v2, 16, v1
  v_lshl_add_u32 v24, v2, 7, v24
  v_add_u32 v24, s4, v24
  v_lshrrev_b32 v2, 2, v1
  v_lshlrev_b32 v25, 7, v2
  v_and_b32 v2, 3, v1
  v_lshl_add_u32 v25, v2, 3, v25
  v_add_u32 v25, 65536, v25
  v_bfe_u32 v26, v1, 3, 2
  v_and_b32 v2, 15, v1
  v_lshrrev_b32 v3, 2, v29
  v_sub_u32_e64 v2, v2, v3
  s_mov_b32 s4, 0xf149f2ca
  v_mov_b32 v32, s4
  v_subrev_u32 v3, 0, v2
  v_cmp_gt_u32 vcc, 8, v3
  s_nop 1
  v_cndmask_b32_e64 v12, v32, 0, vcc
  v_cmp_ge_i32 vcc, -9, v3
  s_nop 1
  v_cndmask_b32_e64 v16, v32, 0, vcc
  v_cndmask_b32_e64 v20, 0, -1, vcc
  v_subrev_u32_e64 v3, 1, v2
  v_cmp_gt_u32 vcc, 8, v3
  s_nop 1
  v_cndmask_b32_e64 v13, v32, 0, vcc
  v_cmp_ge_i32 vcc, -9, v3
  s_nop 1
  v_cndmask_b32_e64 v17, v32, 0, vcc
  v_cndmask_b32_e64 v21, 0, -1, vcc
  v_subrev_u32_e64 v3, 2, v2
  v_cmp_gt_u32 vcc, 8, v3
  s_nop 1
  v_cndmask_b32_e64 v14, v32, 0, vcc
  v_cmp_ge_i32 vcc, -9, v3
  s_nop 1
  v_cndmask_b32_e64 v18, v32, 0, vcc
  v_cndmask_b32_e64 v22, 0, -1, vcc
  v_subrev_u32_e64 v3, 3, v2
  v_cmp_gt_u32 vcc, 8, v3
  s_nop 1
  v_cndmask_b32_e64 v15, v32, 0, vcc
  v_cmp_ge_i32 vcc, -9, v3
  s_nop 1
  v_cndmask_b32_e64 v19, v32, 0, vcc
  v_cndmask_b32_e64 v23, 0, -1, vcc
  v_alignbit_b32 v20, v21, v20, 16
  v_alignbit_b32 v21, v23, v22, 16
  s_lshl_b32 s11, s84, Lz1-Lz0+1
  s_lshl_b32 s4, s81, 10
  s_add_u32 s11, s11, s4
  v_bfe_u32 v2, v1, 4, 1
  v_lshrrev_b32_e64 v3, 5, v1
  v_lshl_add_u32 v2, v2, 1, v3
  v_lshl_add_u32 v2, s86, 2, v2
  v_bfe_u32 v3, v1, 1, 3
  v_xor_b32 v2, v2, v3
  v_and_b32 v3, 15, v1
  v_lshl_add_u32 v2, v3, 3, v2
  s_lshl_b32 s4, s85, Lz1-Lz0+13
  v_lshl_add_u32 v255, v2, 4, s4
L_clayer:
  s_mov_b32 s16, Lz1-Lz0+0
  s_mov_b32 s17, 16384
  s_mov_b32 s18, 0xffff4000
  s_mov_b32 s19, Lz1-Lz0+0
  s_mov_b32 s20, 24576
  s_mov_b32 s21, 0xffff4000
  s_mul_i32 s4, s85, 8192
  v_add_u32_e64 v4, s4, v11
  v_add_u32 v5, 1024, v4
  s_cmp_lg_u32 s82, 0
  s_cbranch_scc1 L_1
  v_and_b32 v2, 15, v1
  v_lshrrev_b32 v3, 1, v2
  v_lshrrev_b32 v32, 4, v1
  v_xor_b32 v3, v3, v32
  v_lshlrev_b32_e64 v3, 4, v3
  v_lshl_add_u32 v3, v2, 7, v3
  v_add_u32 v4, s4, v3
  v_xor_b32 v3, 64, v3
  v_add_u32 v5, s4, v3
L_1:
  s_lshl_b32 s4, s86, 1
  v_xor_b32_e64 v2, s4, v26
  v_lshl_add_u32 v6, v2, 5, v25
  s_add_u32 s4, s4, 1
  v_xor_b32 v2, s4, v26
  v_lshl_add_u32 v7, v2, 5, v25
  v_mov_b64 v[128:129], 0
  v_mov_b64 v[130:131], 0
  v_mov_b64 v[132:133], 0
  v_mov_b64 v[134:135], 0
  v_mov_b64 v[136:137], 0
  v_mov_b64 v[138:139], 0
  v_mov_b64 v[140:141], 0
  v_mov_b64 v[142:143], 0
  v_mov_b64 v[144:145], 0
  v_mov_b64 v[146:147], 0
  v_mov_b64 v[148:149], 0
  v_mov_b64 v[150:151], 0
  v_mov_b64 v[152:153], 0
  v_mov_b64 v[154:155], 0
  v_mov_b64 v[156:157], 0
  v_mov_b64 v[158:159], 0
  v_mov_b64 v[160:161], 0
  v_mov_b64 v[162:163], 0
  v_mov_b64 v[164:165], 0
  v_mov_b64 v[166:167], 0
  v_mov_b64 v[168:169], 0
  v_mov_b64 v[170:171], 0
  v_mov_b64 v[172:173], 0
  v_mov_b64 v[174:175], 0
  v_mov_b64 v[176:177], 0
  v_mov_b64 v[178:179], 0
  v_mov_b64 v[180:181], 0
  v_mov_b64 v[182:183], 0
  v_mov_b64 v[184:185], 0
  v_mov_b64 v[186:187], 0
  v_mov_b64 v[188:189], 0
  v_mov_b64 v[190:191], 0
  v_mov_b64 v[192:193], 0
  v_mov_b64 v[194:195], 0
  v_mov_b64 v[196:197], 0
  v_mov_b64 v[198:199], 0
  v_mov_b64 v[200:201], 0
  v_mov_b64 v[202:203], 0
  v_mov_b64 v[204:205], 0
  v_mov_b64 v[206:207], 0
  v_mov_b64 v[208:209], 0
  v_mov_b64 v[210:211], 0
  v_mov_b64 v[212:213], 0
  v_mov_b64 v[214:215], 0
  v_mov_b64 v[216:217], 0
  v_mov_b64 v[218:219], 0
  v_mov_b64 v[220:221], 0
  v_mov_b64 v[222:223], 0
  s_mul_i32 s4, s85, 320
  s_add_u32 s4, s4, 151552
  v_and_b32_e64 v2, 15, v1
  v_lshl_add_u32 v3, v2, 2, s4
  v_add_u32 v10, s4, v29
  s_lshl_b32 s5, s86, 7
  s_add_u32 s5, s5, 153088
  v_add_u32_e64 v8, s5, v29
  v_lshl_add_u32 v2, v2, 2, s5
  s_mov_b32 s10, 0x7f
  s_mov_b32 s12, 0xff00ff00
  s_add_u32 s9, s11, 65536
  v_lshrrev_b32_e64 v9, 1, v11
  v_bfi_b32 v9, s10, v11, v9
  s_mov_b32 s22, Lz1-Lz0+8
  s_cmp_lg_u32 s82, 0
  s_cselect_b64 vcc, -1, 0
  s_waitcnt lgkmcnt(0)
  s_barrier
Lo_5:
  ds_read_b128 v[32:35], v4 offset:0
  ds_read_b128 v[48:51], v5 offset:0
  ds_read_b128 v[36:39], v4 offset:2048
  ds_read_b128 v[52:55], v5 offset:2048
  ds_read_b128 v[40:43], v4 offset:4096
  ds_read_b128 v[56:59], v5 offset:4096
  ds_read_b64_tr_b16 v[96:97], v6 offset:0
  ds_read_b64_tr_b16 v[98:99], v6 offset:2048
  ds_read_b64_tr_b16 v[100:101], v6 offset:4096
  ds_read_b64_tr_b16 v[102:103], v6 offset:6144
  ds_read_b128 v[44:47], v4 offset:6144
  ds_read_b128 v[60:63], v5 offset:6144
  ds_read_b64_tr_b16 v[104:105], v7 offset:0
  s_nop 0
  s_waitcnt lgkmcnt(8)
  ds_read_b64_tr_b16 v[106:107], v7 offset:2048
  ds_read_b64_tr_b16 v[108:109], v7 offset:4096
  ds_read_b64_tr_b16 v[110:111], v7 offset:6144
  s_nop 0
  s_waitcnt lgkmcnt(6)
  .p2align 7
Lk_2:
  v_mfma_f32_16x16x32_bf16 v[128:131], v[96:99], v[32:35], v[128:131]
  ds_read_b64_tr_b16 v[112:113], v6 offset:8192
  v_mfma_f32_16x16x32_bf16 v[128:131], v[100:103], v[48:51], v[128:131]
  ds_read_b64_tr_b16 v[114:115], v6 offset:10240
  v_mfma_f32_16x16x32_bf16 v[136:139], v[100:103], v[52:55], v[136:139]
  ds_read_b64_tr_b16 v[116:117], v6 offset:12288
  v_mfma_f32_16x16x32_bf16 v[136:139], v[96:99], v[36:39], v[136:139]
  ds_read_b64_tr_b16 v[118:119], v6 offset:14336
  v_mfma_f32_16x16x32_bf16 v[144:147], v[96:99], v[40:43], v[144:147]
  s_add_u32 s16, s16, s17
  s_cmp_eq_u32 s16, 65536
  s_cselect_b32 s23, s18, s17
  s_cselect_b32 s16, Lz1-Lz0+0, s16
  v_mfma_f32_16x16x32_bf16 v[144:147], v[100:103], v[56:59], v[144:147]
  v_add_u32_e64 v4, s23, v4
  v_add_u32 v5, s23, v5
  s_add_u32 s19, s19, s20
  s_cmp_eq_u32 s19, 73728
  s_waitcnt lgkmcnt(8)
  v_mfma_f32_16x16x32_bf16 v[152:155], v[100:103], v[60:63], v[152:155]
  s_cselect_b32 s23, s21, s20
  s_cselect_b32 s19, 0, s19
  v_mfma_f32_16x16x32_bf16 v[152:155], v[96:99], v[44:47], v[152:155]
  s_waitcnt lgkmcnt(4)
  v_mfma_f32_16x16x32_bf16 v[156:159], v[104:107], v[44:47], v[156:159]
  ds_read_b64_tr_b16 v[120:121], v7 offset:8192
  v_mfma_f32_16x16x32_bf16 v[156:159], v[108:111], v[60:63], v[156:159]
  ds_read_b64_tr_b16 v[122:123], v7 offset:10240
  v_mfma_f32_16x16x32_bf16 v[148:151], v[108:111], v[56:59], v[148:151]
  ds_read_b64_tr_b16 v[124:125], v7 offset:12288
  v_mfma_f32_16x16x32_bf16 v[148:151], v[104:107], v[40:43], v[148:151]
  ds_read_b64_tr_b16 v[126:127], v7 offset:14336
  v_mfma_f32_16x16x32_bf16 v[140:143], v[104:107], v[36:39], v[140:143]
  ds_read_b64_tr_b16 v[224:225], v6 offset:16384
  v_mfma_f32_16x16x32_bf16 v[140:143], v[108:111], v[52:55], v[140:143]
  ds_read_b64_tr_b16 v[226:227], v6 offset:18432
  v_mfma_f32_16x16x32_bf16 v[132:135], v[108:111], v[48:51], v[132:135]
  ds_read_b64_tr_b16 v[228:229], v6 offset:20480
  v_mfma_f32_16x16x32_bf16 v[132:135], v[104:107], v[32:35], v[132:135]
  ds_read_b64_tr_b16 v[230:231], v6 offset:22528
  s_nop 0
  s_waitcnt lgkmcnt(8)
  v_mfma_f32_16x16x32_bf16 v[160:163], v[112:115], v[32:35], v[160:163]
  ds_read_b64_tr_b16 v[232:233], v7 offset:16384
  v_mfma_f32_16x16x32_bf16 v[160:163], v[116:119], v[48:51], v[160:163]
  ds_read_b64_tr_b16 v[234:235], v7 offset:18432
  v_mfma_f32_16x16x32_bf16 v[168:171], v[116:119], v[52:55], v[168:171]
  ds_read_b64_tr_b16 v[236:237], v7 offset:20480
  v_mfma_f32_16x16x32_bf16 v[168:171], v[112:115], v[36:39], v[168:171]
  ds_read_b64_tr_b16 v[238:239], v7 offset:22528
  v_mfma_f32_16x16x32_bf16 v[176:179], v[112:115], v[40:43], v[176:179]
  v_add_u32_e64 v6, s23, v6
  v_mfma_f32_16x16x32_bf16 v[176:179], v[116:119], v[56:59], v[176:179]
  v_add_u32_e64 v7, s23, v7
  v_mfma_f32_16x16x32_bf16 v[184:187], v[116:119], v[60:63], v[184:187]
  v_mfma_f32_16x16x32_bf16 v[184:187], v[112:115], v[44:47], v[184:187]
  s_cbranch_vccnz Lo_8
  s_waitcnt lgkmcnt(0)
  s_nop 0
  s_barrier
Lo_7:
  v_mfma_f32_16x16x32_bf16 v[188:191], v[120:123], v[44:47], v[188:191]
  ds_read_b128 v[64:67], v4 offset:0
  v_mfma_f32_16x16x32_bf16 v[188:191], v[124:127], v[60:63], v[188:191]
  ds_read_b128 v[80:83], v5 offset:0
  v_mfma_f32_16x16x32_bf16 v[180:183], v[124:127], v[56:59], v[180:183]
  v_mfma_f32_16x16x32_bf16 v[180:183], v[120:123], v[40:43], v[180:183]
  ds_read_b128 v[68:71], v4 offset:2048
  v_mfma_f32_16x16x32_bf16 v[172:175], v[120:123], v[36:39], v[172:175]
  ds_read_b128 v[84:87], v5 offset:2048
  v_mfma_f32_16x16x32_bf16 v[172:175], v[124:127], v[52:55], v[172:175]
  v_mfma_f32_16x16x32_bf16 v[164:167], v[124:127], v[48:51], v[164:167]
  ds_read_b128 v[72:75], v4 offset:4096
  v_mfma_f32_16x16x32_bf16 v[164:167], v[120:123], v[32:35], v[164:167]
  ds_read_b128 v[88:91], v5 offset:4096
  v_mfma_f32_16x16x32_bf16 v[192:195], v[32:35], v[224:227], v[192:195]
  ds_read_b64_tr_b16 v[96:97], v6 offset:0
  v_mfma_f32_16x16x32_bf16 v[192:195], v[48:51], v[228:231], v[192:195]
  ds_read_b64_tr_b16 v[98:99], v6 offset:2048
  v_mfma_f32_16x16x32_bf16 v[200:203], v[52:55], v[228:231], v[200:203]
  ds_read_b64_tr_b16 v[100:101], v6 offset:4096
  v_mfma_f32_16x16x32_bf16 v[200:203], v[36:39], v[224:227], v[200:203]
  ds_read_b64_tr_b16 v[102:103], v6 offset:6144
  v_mfma_f32_16x16x32_bf16 v[208:211], v[40:43], v[224:227], v[208:211]
  ds_read_b128 v[76:79], v4 offset:6144
  v_mfma_f32_16x16x32_bf16 v[208:211], v[56:59], v[228:231], v[208:211]
  v_mfma_f32_16x16x32_bf16 v[216:219], v[60:63], v[228:231], v[216:219]
  ds_read_b128 v[92:95], v5 offset:6144
  v_mfma_f32_16x16x32_bf16 v[216:219], v[44:47], v[224:227], v[216:219]
  v_mfma_f32_16x16x32_bf16 v[220:223], v[44:47], v[232:235], v[220:223]
  ds_read_b64_tr_b16 v[104:105], v7 offset:0
  v_mfma_f32_16x16x32_bf16 v[220:223], v[60:63], v[236:239], v[220:223]
  v_mfma_f32_16x16x32_bf16 v[212:215], v[56:59], v[236:239], v[212:215]
  ds_read_b64_tr_b16 v[106:107], v7 offset:2048
  v_mfma_f32_16x16x32_bf16 v[212:215], v[40:43], v[232:235], v[212:215]
  v_mfma_f32_16x16x32_bf16 v[204:207], v[36:39], v[232:235], v[204:207]
  ds_read_b64_tr_b16 v[108:109], v7 offset:4096
  v_mfma_f32_16x16x32_bf16 v[204:207], v[52:55], v[236:239], v[204:207]
  v_mfma_f32_16x16x32_bf16 v[196:199], v[48:51], v[236:239], v[196:199]
  ds_read_b64_tr_b16 v[110:111], v7 offset:6144
  s_waitcnt lgkmcnt(6)
  v_mfma_f32_16x16x32_bf16 v[196:199], v[32:35], v[232:235], v[196:199]
  s_cbranch_vccnz Lo_6
Lk_3:
  v_mfma_f32_16x16x32_bf16 v[128:131], v[96:99], v[64:67], v[128:131]
  ds_read_b64_tr_b16 v[112:113], v6 offset:8192
  v_mfma_f32_16x16x32_bf16 v[128:131], v[100:103], v[80:83], v[128:131]
  ds_read_b64_tr_b16 v[114:115], v6 offset:10240
  v_mfma_f32_16x16x32_bf16 v[136:139], v[100:103], v[84:87], v[136:139]
  ds_read_b64_tr_b16 v[116:117], v6 offset:12288
  v_mfma_f32_16x16x32_bf16 v[136:139], v[96:99], v[68:71], v[136:139]
  ds_read_b64_tr_b16 v[118:119], v6 offset:14336
  v_mfma_f32_16x16x32_bf16 v[144:147], v[96:99], v[72:75], v[144:147]
  s_add_u32 s16, s16, s17
  s_cmp_eq_u32 s16, 65536
  s_cselect_b32 s23, s18, s17
  s_cselect_b32 s16, Lz1-Lz0+0, s16
  v_mfma_f32_16x16x32_bf16 v[144:147], v[100:103], v[88:91], v[144:147]
  v_add_u32_e64 v4, s23, v4
  v_add_u32 v5, s23, v5
  s_add_u32 s19, s19, s20
  s_cmp_eq_u32 s19, 73728
  s_waitcnt lgkmcnt(8)
  v_mfma_f32_16x16x32_bf16 v[152:155], v[100:103], v[92:95], v[152:155]
  s_cselect_b32 s23, s21, s20
  s_cselect_b32 s19, 0, s19
  v_mfma_f32_16x16x32_bf16 v[152:155], v[96:99], v[76:79], v[152:155]
  s_waitcnt lgkmcnt(4)
  v_mfma_f32_16x16x32_bf16 v[156:159], v[104:107], v[76:79], v[156:159]
  ds_read_b64_tr_b16 v[120:121], v7 offset:8192
  v_mfma_f32_16x16x32_bf16 v[156:159], v[108:111], v[92:95], v[156:159]
  ds_read_b64_tr_b16 v[122:123], v7 offset:10240
  v_mfma_f32_16x16x32_bf16 v[148:151], v[108:111], v[88:91], v[148:151]
  ds_read_b64_tr_b16 v[124:125], v7 offset:12288
  v_mfma_f32_16x16x32_bf16 v[148:151], v[104:107], v[72:75], v[148:151]
  ds_read_b64_tr_b16 v[126:127], v7 offset:14336
  v_mfma_f32_16x16x32_bf16 v[140:143], v[104:107], v[68:71], v[140:143]
  ds_read_b64_tr_b16 v[224:225], v6 offset:16384
  v_mfma_f32_16x16x32_bf16 v[140:143], v[108:111], v[84:87], v[140:143]
  ds_read_b64_tr_b16 v[226:227], v6 offset:18432
  v_mfma_f32_16x16x32_bf16 v[132:135], v[108:111], v[80:83], v[132:135]
  ds_read_b64_tr_b16 v[228:229], v6 offset:20480
  v_mfma_f32_16x16x32_bf16 v[132:135], v[104:107], v[64:67], v[132:135]
  ds_read_b64_tr_b16 v[230:231], v6 offset:22528
  s_nop 0
  s_waitcnt lgkmcnt(8)
  v_mfma_f32_16x16x32_bf16 v[160:163], v[112:115], v[64:67], v[160:163]
  ds_read_b64_tr_b16 v[232:233], v7 offset:16384
  v_mfma_f32_16x16x32_bf16 v[160:163], v[116:119], v[80:83], v[160:163]
  ds_read_b64_tr_b16 v[234:235], v7 offset:18432
  v_mfma_f32_16x16x32_bf16 v[168:171], v[116:119], v[84:87], v[168:171]
  ds_read_b64_tr_b16 v[236:237], v7 offset:20480
  v_mfma_f32_16x16x32_bf16 v[168:171], v[112:115], v[68:71], v[168:171]
  ds_read_b64_tr_b16 v[238:239], v7 offset:22528
  v_mfma_f32_16x16x32_bf16 v[176:179], v[112:115], v[72:75], v[176:179]
  v_add_u32_e64 v6, s23, v6
  v_mfma_f32_16x16x32_bf16 v[176:179], v[116:119], v[88:91], v[176:179]
  v_add_u32_e64 v7, s23, v7
  v_mfma_f32_16x16x32_bf16 v[184:187], v[116:119], v[92:95], v[184:187]
  s_sub_u32 s22, s22, 1
  s_cmp_lg_u32 s22, 0
  v_mfma_f32_16x16x32_bf16 v[184:187], v[112:115], v[76:79], v[184:187]
  s_waitcnt lgkmcnt(0)
  s_barrier
  v_mfma_f32_16x16x32_bf16 v[188:191], v[120:123], v[76:79], v[188:191]
  s_nop 0
  s_cbranch_scc0 Lk_4
  ds_read_b128 v[32:35], v4 offset:0
  v_mfma_f32_16x16x32_bf16 v[188:191], v[124:127], v[92:95], v[188:191]
  ds_read_b128 v[48:51], v5 offset:0
  v_mfma_f32_16x16x32_bf16 v[180:183], v[124:127], v[88:91], v[180:183]
  v_mfma_f32_16x16x32_bf16 v[180:183], v[120:123], v[72:75], v[180:183]
  ds_read_b128 v[36:39], v4 offset:2048
  v_mfma_f32_16x16x32_bf16 v[172:175], v[120:123], v[68:71], v[172:175]
  ds_read_b128 v[52:55], v5 offset:2048
  v_mfma_f32_16x16x32_bf16 v[172:175], v[124:127], v[84:87], v[172:175]
  v_mfma_f32_16x16x32_bf16 v[164:167], v[124:127], v[80:83], v[164:167]
  ds_read_b128 v[40:43], v4 offset:4096
  v_mfma_f32_16x16x32_bf16 v[164:167], v[120:123], v[64:67], v[164:167]
  ds_read_b128 v[56:59], v5 offset:4096
  v_mfma_f32_16x16x32_bf16 v[192:195], v[64:67], v[224:227], v[192:195]
  ds_read_b64_tr_b16 v[96:97], v6 offset:0
  v_mfma_f32_16x16x32_bf16 v[192:195], v[80:83], v[228:231], v[192:195]
  ds_read_b64_tr_b16 v[98:99], v6 offset:2048
  v_mfma_f32_16x16x32_bf16 v[200:203], v[84:87], v[228:231], v[200:203]
  ds_read_b64_tr_b16 v[100:101], v6 offset:4096
  v_mfma_f32_16x16x32_bf16 v[200:203], v[68:71], v[224:227], v[200:203]
  ds_read_b64_tr_b16 v[102:103], v6 offset:6144
  v_mfma_f32_16x16x32_bf16 v[208:211], v[72:75], v[224:227], v[208:211]
  ds_read_b128 v[44:47], v4 offset:6144
  v_mfma_f32_16x16x32_bf16 v[208:211], v[88:91], v[228:231], v[208:211]
  v_mfma_f32_16x16x32_bf16 v[216:219], v[92:95], v[228:231], v[216:219]
  ds_read_b128 v[60:63], v5 offset:6144
  v_mfma_f32_16x16x32_bf16 v[216:219], v[76:79], v[224:227], v[216:219]
  v_mfma_f32_16x16x32_bf16 v[220:223], v[76:79], v[232:235], v[220:223]
  ds_read_b64_tr_b16 v[104:105], v7 offset:0
  v_mfma_f32_16x16x32_bf16 v[220:223], v[92:95], v[236:239], v[220:223]
  v_mfma_f32_16x16x32_bf16 v[212:215], v[88:91], v[236:239], v[212:215]
  ds_read_b64_tr_b16 v[106:107], v7 offset:2048
  v_mfma_f32_16x16x32_bf16 v[212:215], v[72:75], v[232:235], v[212:215]
  v_mfma_f32_16x16x32_bf16 v[204:207], v[68:71], v[232:235], v[204:207]
  ds_read_b64_tr_b16 v[108:109], v7 offset:4096
  v_mfma_f32_16x16x32_bf16 v[204:207], v[84:87], v[236:239], v[204:207]
  v_mfma_f32_16x16x32_bf16 v[196:199], v[80:83], v[236:239], v[196:199]
  ds_read_b64_tr_b16 v[110:111], v7 offset:6144
  s_waitcnt lgkmcnt(6)
  v_mfma_f32_16x16x32_bf16 v[196:199], v[64:67], v[232:235], v[196:199]
  s_branch Lk_2
Lk_4:
  ds_read2_b32 v[4:5], v3 offset0:48 offset1:208
  ds_read_b128 v[106:109], v8 offset:256
  v_mfma_f32_16x16x32_bf16 v[188:191], v[124:127], v[92:95], v[188:191]
  ds_read_b128 v[110:113], v8 offset:320
  ds_read_b128 v[32:35], v10 offset:192
  v_mfma_f32_16x16x32_bf16 v[216:219], v[92:95], v[228:231], v[216:219]
  ds_read_b128 v[36:39], v10 offset:832
  ds_read2_b32 v[114:115], v2 offset0:128 offset1:144
  v_mfma_f32_16x16x32_bf16 v[216:219], v[76:79], v[224:227], v[216:219]
  ds_read_b128 v[98:101], v8 offset:0
  ds_read_b128 v[102:105], v8 offset:64
  v_mfma_f32_16x16x32_bf16 v[220:223], v[76:79], v[232:235], v[220:223]
  ds_read2_b32 v[6:7], v3 offset0:32 offset1:192
  ds_read2_b32 v[96:97], v3 offset0:16 offset1:176
  v_mfma_f32_16x16x32_bf16 v[220:223], v[92:95], v[236:239], v[220:223]
  v_mfma_f32_16x16x32_bf16 v[180:183], v[124:127], v[88:91], v[180:183]
  v_mfma_f32_16x16x32_bf16 v[180:183], v[120:123], v[72:75], v[180:183]
  v_mfma_f32_16x16x32_bf16 v[172:175], v[120:123], v[68:71], v[172:175]
  s_nop 0
  s_waitcnt lgkmcnt(4)
  v_fma_f32 v184, -v106, v5, v184
  v_fma_f32 v185, -v107, v5, v185
  v_fma_f32 v186, -v108, v5, v186
  v_mfma_f32_16x16x32_bf16 v[172:175], v[124:127], v[84:87], v[172:175]
  v_fma_f32 v187, -v109, v5, v187
  v_mul_f32 v184, v184, v4
  v_mul_f32 v185, v185, v4
  v_mfma_f32_16x16x32_bf16 v[164:167], v[124:127], v[80:83], v[164:167]
  v_mul_f32 v186, v186, v4
  v_mul_f32 v187, v187, v4
  v_cvt_pk_bf16_f32 v60, v184, v185
  v_mfma_f32_16x16x32_bf16 v[164:167], v[120:123], v[64:67], v[164:167]
  v_cvt_pk_bf16_f32 v61, v186, v187
  v_fma_f32 v188, -v110, v5, v188
  v_fma_f32 v189, -v111, v5, v189
  v_mfma_f32_16x16x32_bf16 v[192:195], v[64:67], v[224:227], v[192:195]
  ds_read2_b32 v[124:125], v3 offset0:0 offset1:160
  v_fma_f32 v190, -v112, v5, v190
  v_fma_f32 v191, -v113, v5, v191
  v_mul_f32_e64 v188, v188, v4
  v_mfma_f32_16x16x32_bf16 v[192:195], v[80:83], v[228:231], v[192:195]
  v_mov_b32 v120, 0x3f803f80
  v_mul_f32 v189, v189, v4
  v_mul_f32 v190, v190, v4
  v_mul_f32_e64 v191, v191, v4
  v_mfma_f32_16x16x32_bf16 v[196:199], v[80:83], v[236:239], v[196:199]
  v_mov_b32 v121, 0x3f803f80
  v_cvt_pk_bf16_f32 v62, v188, v189
  v_cvt_pk_bf16_f32 v63, v190, v191
  v_mfma_f32_16x16x32_bf16 v[196:199], v[64:67], v[232:235], v[196:199]
  v_mov_b32 v122, 0x3f803f80
  s_mov_b32 exec_lo, s12
  s_mov_b32 exec_hi, s12
  buffer_store_dwordx4 v[60:63], v9, s[40:43], s9 offen sc0 sc1
  s_nop 0
  s_mov_b64 exec, -1
  v_fma_f32 v216, -v36, v114, v216
  v_fma_f32 v217, -v37, v114, v217
  v_fma_f32 v218, -v38, v114, v218
  v_mfma_f32_16x16x32_bf16 v[204:207], v[68:71], v[232:235], v[204:207]
  v_mov_b32 v123, 0x3f803f80
  v_fma_f32 v219, -v39, v114, v219
  v_mul_f32 v216, v216, v32
  v_mul_f32 v217, v217, v33
  v_mfma_f32_16x16x32_bf16 v[204:207], v[84:87], v[236:239], v[204:207]
  v_mul_f32 v218, v218, v34
  v_mul_f32 v219, v219, v35
  v_cvt_pk_bf16_f32 v76, v216, v217
  v_mfma_f32_16x16x32_bf16 v[200:203], v[84:87], v[228:231], v[200:203]
  v_cvt_pk_bf16_f32 v77, v218, v219
  v_fma_f32 v220, -v36, v115, v220
  v_fma_f32 v221, -v37, v115, v221
  v_mfma_f32_16x16x32_bf16 v[200:203], v[68:71], v[224:227], v[200:203]
  v_fma_f32 v222, -v38, v115, v222
  v_fma_f32 v223, -v39, v115, v223
  v_mul_f32_e64 v220, v220, v32
  v_mfma_f32_16x16x32_bf16 v[208:211], v[72:75], v[224:227], v[208:211]
  v_mul_f32 v221, v221, v33
  v_mul_f32 v222, v222, v34
  v_mul_f32_e64 v223, v223, v35
  v_mfma_f32_16x16x32_bf16 v[208:211], v[88:91], v[228:231], v[208:211]
  v_cvt_pk_bf16_f32 v78, v220, v221
  v_cvt_pk_bf16_f32 v79, v222, v223
  v_mfma_f32_16x16x32_bf16 v[212:215], v[88:91], v[236:239], v[212:215]
  s_mov_b32 exec_lo, 0
  buffer_store_dwordx4 v[76:79], v11, s[40:43], s9 offen sc0 sc1
  s_mov_b64 exec, -1
  v_mfma_f32_16x16x32_bf16 v[212:215], v[72:75], v[232:235], v[212:215]
  v_mov_b64_e64 v[86:87], v[78:79]
  s_cmp_lg_u32 s82, 0
  s_cbranch_scc1 L_9
  ds_read_b128 v[240:243], v255 offset:16384
  ds_read_b128 v[244:247], v255 offset:18432
  ds_read_b128 v[248:251], v255 offset:20480
  ds_read_b128 v[252:255], v255 offset:22528
L_9:
  v_mov_b64 v[64:65], 0
  v_mov_b64 v[66:67], 0
  v_mov_b64_e64 v[232:233], 0
  v_mov_b64 v[234:235], 0
  s_waitcnt lgkmcnt(0)
  v_pk_fma_f32 v[128:129], v[98:99], v[124:125], v[128:129] op_sel:[0,1,0] op_sel_hi:[1,1,1] neg_lo:[1,0,0] neg_hi:[1,0,0]
  v_pk_fma_f32 v[130:131], v[100:101], v[124:125], v[130:131] op_sel:[0,1,0] op_sel_hi:[1,1,1] neg_lo:[1,0,0] neg_hi:[1,0,0]
  v_pk_fma_f32 v[132:133], v[102:103], v[124:125], v[132:133] op_sel:[0,1,0] op_sel_hi:[1,1,1] neg_lo:[1,0,0] neg_hi:[1,0,0]
  v_pk_fma_f32 v[134:135], v[104:105], v[124:125], v[134:135] op_sel:[0,1,0] op_sel_hi:[1,1,1] neg_lo:[1,0,0] neg_hi:[1,0,0]
  v_cvt_pk_bf16_f32 v32, v128, v129
  v_cvt_pk_bf16_f32 v33, v130, v131
  v_cvt_pk_bf16_f32 v34, v132, v133
  v_cvt_pk_bf16_f32 v35, v134, v135
  v_pk_fma_f32 v[136:137], v[98:99], v[96:97], v[136:137] op_sel:[0,1,0] op_sel_hi:[1,1,1] neg_lo:[1,0,0] neg_hi:[1,0,0]
  v_pk_fma_f32 v[138:139], v[100:101], v[96:97], v[138:139] op_sel:[0,1,0] op_sel_hi:[1,1,1] neg_lo:[1,0,0] neg_hi:[1,0,0]
  v_pk_fma_f32 v[140:141], v[102:103], v[96:97], v[140:141] op_sel:[0,1,0] op_sel_hi:[1,1,1] neg_lo:[1,0,0] neg_hi:[1,0,0]
  v_pk_fma_f32 v[142:143], v[104:105], v[96:97], v[142:143] op_sel:[0,1,0] op_sel_hi:[1,1,1] neg_lo:[1,0,0] neg_hi:[1,0,0]
  v_cvt_pk_bf16_f32 v36, v136, v137
  v_cvt_pk_bf16_f32 v37, v138, v139
  v_cvt_pk_bf16_f32 v38, v140, v141
  v_cvt_pk_bf16_f32 v39, v142, v143
  v_pk_fma_f32 v[144:145], v[98:99], v[6:7], v[144:145] op_sel:[0,1,0] op_sel_hi:[1,1,1] neg_lo:[1,0,0] neg_hi:[1,0,0]
  v_pk_fma_f32 v[146:147], v[100:101], v[6:7], v[146:147] op_sel:[0,1,0] op_sel_hi:[1,1,1] neg_lo:[1,0,0] neg_hi:[1,0,0]
  v_pk_fma_f32 v[148:149], v[102:103], v[6:7], v[148:149] op_sel:[0,1,0] op_sel_hi:[1,1,1] neg_lo:[1,0,0] neg_hi:[1,0,0]
  v_pk_fma_f32 v[150:151], v[104:105], v[6:7], v[150:151] op_sel:[0,1,0] op_sel_hi:[1,1,1] neg_lo:[1,0,0] neg_hi:[1,0,0]
  v_cvt_pk_bf16_f32 v40, v144, v145
  v_cvt_pk_bf16_f32 v41, v146, v147
  v_cvt_pk_bf16_f32 v42, v148, v149
  v_cvt_pk_bf16_f32 v43, v150, v151
  v_pk_fma_f32 v[152:153], v[98:99], v[4:5], v[152:153] op_sel:[0,1,0] op_sel_hi:[1,1,1] neg_lo:[1,0,0] neg_hi:[1,0,0]
  v_pk_fma_f32 v[154:155], v[100:101], v[4:5], v[154:155] op_sel:[0,1,0] op_sel_hi:[1,1,1] neg_lo:[1,0,0] neg_hi:[1,0,0]
  v_pk_fma_f32 v[156:157], v[102:103], v[4:5], v[156:157] op_sel:[0,1,0] op_sel_hi:[1,1,1] neg_lo:[1,0,0] neg_hi:[1,0,0]
  v_pk_fma_f32 v[158:159], v[104:105], v[4:5], v[158:159] op_sel:[0,1,0] op_sel_hi:[1,1,1] neg_lo:[1,0,0] neg_hi:[1,0,0]
  v_cvt_pk_bf16_f32 v44, v152, v153
  v_cvt_pk_bf16_f32 v45, v154, v155
  v_cvt_pk_bf16_f32 v46, v156, v157
  v_cvt_pk_bf16_f32 v47, v158, v159
  ds_read_b128 v[128:131], v10 offset:0
  ds_read_b128 v[132:135], v10 offset:640
  ds_read_b128 v[136:139], v10 offset:64
  ds_read_b128 v[140:143], v10 offset:704
  ds_read_b128 v[144:147], v10 offset:128
  ds_read_b128 v[148:151], v10 offset:768
  v_pk_fma_f32 v[160:161], v[106:107], v[124:125], v[160:161] op_sel:[0,1,0] op_sel_hi:[1,1,1] neg_lo:[1,0,0] neg_hi:[1,0,0]
  v_pk_fma_f32 v[162:163], v[108:109], v[124:125], v[162:163] op_sel:[0,1,0] op_sel_hi:[1,1,1] neg_lo:[1,0,0] neg_hi:[1,0,0]
  v_pk_fma_f32 v[164:165], v[110:111], v[124:125], v[164:165] op_sel:[0,1,0] op_sel_hi:[1,1,1] neg_lo:[1,0,0] neg_hi:[1,0,0]
  v_pk_fma_f32 v[166:167], v[112:113], v[124:125], v[166:167] op_sel:[0,1,0] op_sel_hi:[1,1,1] neg_lo:[1,0,0] neg_hi:[1,0,0]
  v_pk_mul_f32 v[160:161], v[160:161], v[124:125] op_sel_hi:[1,0]
  v_pk_mul_f32 v[162:163], v[162:163], v[124:125] op_sel_hi:[1,0]
  v_pk_mul_f32 v[164:165], v[164:165], v[124:125] op_sel_hi:[1,0]
  v_pk_mul_f32 v[166:167], v[166:167], v[124:125] op_sel_hi:[1,0]
  v_cvt_pk_bf16_f32 v48, v160, v161
  v_cvt_pk_bf16_f32 v49, v162, v163
  v_cvt_pk_bf16_f32 v50, v164, v165
  v_cvt_pk_bf16_f32 v51, v166, v167
  v_pk_fma_f32 v[168:169], v[106:107], v[96:97], v[168:169] op_sel:[0,1,0] op_sel_hi:[1,1,1] neg_lo:[1,0,0] neg_hi:[1,0,0]
  v_pk_fma_f32 v[170:171], v[108:109], v[96:97], v[170:171] op_sel:[0,1,0] op_sel_hi:[1,1,1] neg_lo:[1,0,0] neg_hi:[1,0,0]
  v_pk_fma_f32 v[172:173], v[110:111], v[96:97], v[172:173] op_sel:[0,1,0] op_sel_hi:[1,1,1] neg_lo:[1,0,0] neg_hi:[1,0,0]
  v_pk_fma_f32 v[174:175], v[112:113], v[96:97], v[174:175] op_sel:[0,1,0] op_sel_hi:[1,1,1] neg_lo:[1,0,0] neg_hi:[1,0,0]
  v_pk_mul_f32 v[168:169], v[168:169], v[96:97] op_sel_hi:[1,0]
  v_pk_mul_f32 v[170:171], v[170:171], v[96:97] op_sel_hi:[1,0]
  v_pk_mul_f32 v[172:173], v[172:173], v[96:97] op_sel_hi:[1,0]
  v_pk_mul_f32 v[174:175], v[174:175], v[96:97] op_sel_hi:[1,0]
  v_cvt_pk_bf16_f32 v52, v168, v169
  v_cvt_pk_bf16_f32 v53, v170, v171
  v_cvt_pk_bf16_f32 v54, v172, v173
  v_cvt_pk_bf16_f32 v55, v174, v175
  v_pk_fma_f32 v[176:177], v[106:107], v[6:7], v[176:177] op_sel:[0,1,0] op_sel_hi:[1,1,1] neg_lo:[1,0,0] neg_hi:[1,0,0]
  v_pk_fma_f32 v[178:179], v[108:109], v[6:7], v[178:179] op_sel:[0,1,0] op_sel_hi:[1,1,1] neg_lo:[1,0,0] neg_hi:[1,0,0]
  v_pk_fma_f32 v[180:181], v[110:111], v[6:7], v[180:181] op_sel:[0,1,0] op_sel_hi:[1,1,1] neg_lo:[1,0,0] neg_hi:[1,0,0]
  v_pk_fma_f32 v[182:183], v[112:113], v[6:7], v[182:183] op_sel:[0,1,0] op_sel_hi:[1,1,1] neg_lo:[1,0,0] neg_hi:[1,0,0]
  v_pk_mul_f32 v[176:177], v[176:177], v[6:7] op_sel_hi:[1,0]
  v_pk_mul_f32 v[178:179], v[178:179], v[6:7] op_sel_hi:[1,0]
  v_pk_mul_f32 v[180:181], v[180:181], v[6:7] op_sel_hi:[1,0]
  v_pk_mul_f32 v[182:183], v[182:183], v[6:7] op_sel_hi:[1,0]
  v_cvt_pk_bf16_f32 v56, v176, v177
  v_cvt_pk_bf16_f32 v57, v178, v179
  v_cvt_pk_bf16_f32 v58, v180, v181
  v_cvt_pk_bf16_f32 v59, v182, v183
  v_mfma_f32_16x16x32_bf16 v[164:167], v[48:51], v[32:35], v[12:15]
  v_mfma_f32_16x16x32_bf16 v[168:171], v[48:51], v[36:39], v[16:19]
  v_mfma_f32_16x16x32_bf16 v[172:175], v[52:55], v[36:39], v[12:15]
  v_mfma_f32_16x16x32_bf16 v[176:179], v[52:55], v[40:43], v[16:19]
  v_mfma_f32_16x16x32_bf16 v[180:183], v[56:59], v[40:43], v[12:15]
  v_mfma_f32_16x16x32_bf16 v[184:187], v[56:59], v[44:47], v[16:19]
  v_mfma_f32_16x16x32_bf16 v[188:191], v[60:63], v[44:47], v[12:15]
  s_nop 0
  s_waitcnt lgkmcnt(0)
  v_pk_fma_f32 v[192:193], v[132:133], v[114:115], v[192:193] op_sel:[0,0,0] op_sel_hi:[1,0,1] neg_lo:[1,0,0] neg_hi:[1,0,0]
  v_pk_fma_f32 v[194:195], v[134:135], v[114:115], v[194:195] op_sel:[0,0,0] op_sel_hi:[1,0,1] neg_lo:[1,0,0] neg_hi:[1,0,0]
  v_pk_fma_f32 v[196:197], v[132:133], v[114:115], v[196:197] op_sel:[0,1,0] op_sel_hi:[1,1,1] neg_lo:[1,0,0] neg_hi:[1,0,0]
  v_pk_fma_f32 v[198:199], v[134:135], v[114:115], v[198:199] op_sel:[0,1,0] op_sel_hi:[1,1,1] neg_lo:[1,0,0] neg_hi:[1,0,0]
  v_pk_mul_f32 v[192:193], v[192:193], v[128:129]
  v_pk_mul_f32 v[194:195], v[194:195], v[130:131]
  v_pk_mul_f32 v[196:197], v[196:197], v[128:129]
  v_pk_mul_f32 v[198:199], v[198:199], v[130:131]
  v_cvt_pk_bf16_f32 v70, v192, v193
  v_cvt_pk_bf16_f32 v71, v194, v195
  v_cvt_pk_bf16_f32 v80, v196, v197
  v_cvt_pk_bf16_f32 v81, v198, v199
  v_pk_fma_f32 v[200:201], v[140:141], v[114:115], v[200:201] op_sel:[0,0,0] op_sel_hi:[1,0,1] neg_lo:[1,0,0] neg_hi:[1,0,0]
  v_pk_fma_f32 v[202:203], v[142:143], v[114:115], v[202:203] op_sel:[0,0,0] op_sel_hi:[1,0,1] neg_lo:[1,0,0] neg_hi:[1,0,0]
  v_pk_fma_f32 v[204:205], v[140:141], v[114:115], v[204:205] op_sel:[0,1,0] op_sel_hi:[1,1,1] neg_lo:[1,0,0] neg_hi:[1,0,0]
  v_pk_fma_f32 v[206:207], v[142:143], v[114:115], v[206:207] op_sel:[0,1,0] op_sel_hi:[1,1,1] neg_lo:[1,0,0] neg_hi:[1,0,0]
  v_pk_mul_f32 v[200:201], v[200:201], v[136:137]
  v_pk_mul_f32 v[202:203], v[202:203], v[138:139]
  v_pk_mul_f32 v[204:205], v[204:205], v[136:137]
  v_pk_mul_f32 v[206:207], v[206:207], v[138:139]
  v_cvt_pk_bf16_f32 v72, v200, v201
  v_cvt_pk_bf16_f32 v73, v202, v203
  v_cvt_pk_bf16_f32 v82, v204, v205
  v_cvt_pk_bf16_f32 v83, v206, v207
  v_pk_fma_f32 v[208:209], v[148:149], v[114:115], v[208:209] op_sel:[0,0,0] op_sel_hi:[1,0,1] neg_lo:[1,0,0] neg_hi:[1,0,0]
  v_pk_fma_f32 v[210:211], v[150:151], v[114:115], v[210:211] op_sel:[0,0,0] op_sel_hi:[1,0,1] neg_lo:[1,0,0] neg_hi:[1,0,0]
  v_pk_fma_f32 v[212:213], v[148:149], v[114:115], v[212:213] op_sel:[0,1,0] op_sel_hi:[1,1,1] neg_lo:[1,0,0] neg_hi:[1,0,0]
  v_pk_fma_f32 v[214:215], v[150:151], v[114:115], v[214:215] op_sel:[0,1,0] op_sel_hi:[1,1,1] neg_lo:[1,0,0] neg_hi:[1,0,0]
  v_pk_mul_f32 v[208:209], v[208:209], v[144:145]
  v_pk_mul_f32 v[210:211], v[210:211], v[146:147]
  v_pk_mul_f32 v[212:213], v[212:213], v[144:145]
  v_pk_mul_f32 v[214:215], v[214:215], v[146:147]
  v_cvt_pk_bf16_f32 v74, v208, v209
  v_cvt_pk_bf16_f32 v75, v210, v211
  v_cvt_pk_bf16_f32 v84, v212, v213
  v_cvt_pk_bf16_f32 v85, v214, v215
  v_max_f32 v172, v172, v168
  v_max_f32 v173, v173, v169
  v_max_f32 v174, v174, v170
  v_max_f32 v175, v175, v171
  v_max_f32 v180, v180, v176
  v_max_f32 v181, v181, v177
  v_max_f32 v182, v182, v178
  v_max_f32 v183, v183, v179
  v_max_f32 v188, v188, v184
  v_max_f32 v189, v189, v185
  v_max_f32 v190, v190, v186
  v_max_f32 v191, v191, v187
  v_max3_f32 v90, v172, v173, v174
  v_max3_f32 v92, v180, v181, v182
  v_max3_f32 v94, v188, v189, v190
  v_max_f32 v90, v90, v175
  v_max_f32 v92, v92, v183
  v_max_f32 v94, v94, v191
  v_mov_b32 v99, v90
  v_mov_b32 v100, v92
  v_mov_b32 v101, v94
  v_permlane32_swap_b32 v90, v99
  v_permlane32_swap_b32 v92, v100
  v_permlane32_swap_b32 v94, v101
  v_max_f32 v90, v90, v99
  v_max_f32 v92, v92, v100
  v_max_f32 v94, v94, v101
  v_mov_b32 v99, v90
  v_mov_b32 v100, v92
  v_mov_b32 v101, v94
  v_permlane16_swap_b32 v90, v99
  v_permlane16_swap_b32 v92, v100
  v_permlane16_swap_b32 v94, v101
  v_max_f32 v90, v90, v99
  v_max_f32 v92, v92, v100
  v_max_f32_e64 v94, v94, v101
  s_mov_b32 s4, 0x3e8293ee
  v_mul_f32 v91, s4, v96
  v_mul_f32 v90, v91, v90
  v_mul_f32 v93, s4, v6
  v_mul_f32 v92, v93, v92
  v_mul_f32 v95, s4, v4
  v_mul_f32 v94, v95, v94
  v_pk_fma_f32 v[172:173], v[172:173], v[90:91], v[90:91] op_sel:[0,1,0] op_sel_hi:[1,1,0] neg_lo:[0,0,1] neg_hi:[0,0,1]
  v_pk_fma_f32 v[174:175], v[174:175], v[90:91], v[90:91] op_sel:[0,1,0] op_sel_hi:[1,1,0] neg_lo:[0,0,1] neg_hi:[0,0,1]
  v_pk_fma_f32 v[180:181], v[180:181], v[92:93], v[92:93] op_sel:[0,1,0] op_sel_hi:[1,1,0] neg_lo:[0,0,1] neg_hi:[0,0,1]
  v_pk_fma_f32 v[182:183], v[182:183], v[92:93], v[92:93] op_sel:[0,1,0] op_sel_hi:[1,1,0] neg_lo:[0,0,1] neg_hi:[0,0,1]
  v_pk_fma_f32 v[188:189], v[188:189], v[94:95], v[94:95] op_sel:[0,1,0] op_sel_hi:[1,1,0] neg_lo:[0,0,1] neg_hi:[0,0,1]
  v_pk_fma_f32 v[190:191], v[190:191], v[94:95], v[94:95] op_sel:[0,1,0] op_sel_hi:[1,1,0] neg_lo:[0,0,1] neg_hi:[0,0,1]
  s_lshl_b32 s6, s84, Lz1-Lz0+3
  s_add_u32 s6, s6, 3145728
  s_add_u32 s7, s6, 4096
  s_mov_b32 exec_lo, s12
  s_mov_b32 exec_hi, s12
  buffer_load_dwordx4 v[64:67], v9, s[40:43], s11 offen sc0 sc1
  s_mov_b32 exec_lo, 0
  s_mov_b32 exec_hi, -1
  buffer_load_dwordx4 v[232:235], v11, s[40:43], s11 offen sc0 sc1
  s_mov_b64 exec, -1
  v_exp_f32 v172, v172
  v_exp_f32 v173, v173
  v_exp_f32 v174, v174
  v_exp_f32_e64 v175, v175
  v_cvt_pk_bf16_f32 v38, v172, v173
  v_cvt_pk_bf16_f32 v39, v174, v175
  v_and_b32 v36, v38, v20
  v_and_b32 v37, v39, v21
  v_xor_b32 v38, v38, v36
  v_xor_b32 v39, v39, v37
  v_exp_f32 v180, v180
  v_exp_f32 v181, v181
  v_exp_f32 v182, v182
  v_exp_f32 v183, v183
  v_cvt_pk_bf16_f32 v42, v180, v181
  v_cvt_pk_bf16_f32 v43, v182, v183
  v_and_b32 v40, v42, v20
  v_and_b32 v41, v43, v21
  v_xor_b32 v42, v42, v40
  v_xor_b32 v43, v43, v41
  v_mfma_f32_16x16x32_bf16 v[132:135], v[120:123], v[36:39], 0
  v_mfma_f32_16x16x32_bf16 v[200:203], v[70:73], v[36:39], 0
  v_mfma_f32_16x16x32_bf16 v[204:207], v[80:83], v[36:39], 0
  v_exp_f32 v188, v188
  v_exp_f32 v189, v189
  v_exp_f32 v190, v190
  v_exp_f32 v191, v191
  v_cvt_pk_bf16_f32 v46, v188, v189
  v_cvt_pk_bf16_f32 v47, v190, v191
  v_and_b32 v44, v46, v20
  v_and_b32 v45, v47, v21
  v_xor_b32 v46, v46, v44
  v_xor_b32 v47, v47, v45
  v_mfma_f32_16x16x32_bf16 v[136:139], v[120:123], v[40:43], 0
  v_mfma_f32_16x16x32_bf16 v[208:211], v[72:75], v[40:43], 0
  v_mfma_f32_16x16x32_bf16 v[212:215], v[82:85], v[40:43], 0
  v_mfma_f32_16x16x32_bf16 v[140:143], v[120:123], v[44:47], 0
  v_mfma_f32_16x16x32_bf16 v[216:219], v[74:77], v[44:47], 0
  v_mfma_f32_16x16x32_bf16 v[220:223], v[84:87], v[44:47], 0
  v_rcp_f32 v132, v132
  s_nop 0
  v_pk_mul_f32 v[200:201], v[200:201], v[132:133] op_sel_hi:[1,0]
  v_pk_mul_f32 v[202:203], v[202:203], v[132:133] op_sel_hi:[1,0]
  v_pk_mul_f32 v[204:205], v[204:205], v[132:133] op_sel_hi:[1,0]
  v_pk_mul_f32 v[206:207], v[206:207], v[132:133] op_sel_hi:[1,0]
  v_cvt_pk_bf16_f32 v52, v200, v201
  v_cvt_pk_bf16_f32 v53, v202, v203
  v_cvt_pk_bf16_f32 v54, v204, v205
  v_cvt_pk_bf16_f32 v55, v206, v207
  buffer_store_dwordx4 v[52:55], v0, s[40:43], s6 offen offset:2048 sc0 sc1
  ds_write_b128 v0, v[52:55] offset:2048
  v_rcp_f32 v136, v136
  s_nop 0
  v_pk_mul_f32 v[208:209], v[208:209], v[136:137] op_sel_hi:[1,0]
  v_pk_mul_f32 v[210:211], v[210:211], v[136:137] op_sel_hi:[1,0]
  v_pk_mul_f32 v[212:213], v[212:213], v[136:137] op_sel_hi:[1,0]
  v_pk_mul_f32 v[214:215], v[214:215], v[136:137] op_sel_hi:[1,0]
  v_cvt_pk_bf16_f32 v56, v208, v209
  v_cvt_pk_bf16_f32 v57, v210, v211
  v_cvt_pk_bf16_f32 v58, v212, v213
  v_cvt_pk_bf16_f32 v59, v214, v215
  buffer_store_dwordx4 v[56:59], v0, s[40:43], s7 offen offset:0 sc0 sc1
  ds_write_b128 v0, v[56:59] offset:4096
  v_rcp_f32 v140, v140
  s_nop 0
  v_pk_mul_f32 v[216:217], v[216:217], v[140:141] op_sel_hi:[1,0]
  v_pk_mul_f32 v[218:219], v[218:219], v[140:141] op_sel_hi:[1,0]
  v_pk_mul_f32 v[220:221], v[220:221], v[140:141] op_sel_hi:[1,0]
  v_pk_mul_f32 v[222:223], v[222:223], v[140:141] op_sel_hi:[1,0]
  v_cvt_pk_bf16_f32 v60, v216, v217
  v_cvt_pk_bf16_f32 v61, v218, v219
  v_cvt_pk_bf16_f32 v62, v220, v221
  v_cvt_pk_bf16_f32 v63, v222, v223
  buffer_store_dwordx4 v[60:63], v0, s[40:43], s7 offen offset:2048 sc0 sc1
  ds_write_b128 v0, v[60:63] offset:6144
  s_cmp_eq_u32 s76, Lz1-Lz0+0
  s_mov_b32 s89, 200000
  s_waitcnt vmcnt(3)
  s_cbranch_scc0 Lh_11
  v_mov_b64 v[64:65], 0
  v_mov_b64 v[66:67], 0
  v_mov_b64 v[232:233], 0
  v_mov_b64 v[234:235], 0
  s_branch Lh_12
  s_nop 0
Lh_10:
  s_mov_b32 exec_lo, s12
  s_mov_b32 exec_hi, s12
  buffer_load_dwordx4 v[64:67], v9, s[40:43], s11 offen sc0 sc1
  s_mov_b32 exec_lo, 0
  s_mov_b32 exec_hi, -1
  buffer_load_dwordx4 v[232:235], v11, s[40:43], s11 offen sc0 sc1
  s_mov_b64 exec, -1
  s_waitcnt vmcnt(0)
Lh_11:
  v_max3_u32 v2, v64, v65, v66
  v_max3_u32 v3, v232, v233, v234
  v_max3_u32 v2, v2, v67, v235
  v_max_u32_e64 v2, v2, v3
  v_cmp_eq_u32 vcc, -1, v2
  s_cbranch_vccz Lh_12
  s_sub_u32 s89, s89, 1
  s_cbranch_scc0 Lh_10
Lh_12:
  v_mfma_f32_16x16x32_bf16 v[160:163], v[64:67], v[32:35], v[16:19]
  v_mov_b64 v[68:69], v[232:233]
  v_mov_b64 v[78:79], v[234:235]
  v_mov_b64 v[236:237], -1
  v_mov_b64 v[238:239], -1
  buffer_store_dwordx4 v[236:239], v11, s[40:43], s11 offen sc0 sc1
  s_cmp_eq_u32 s76, 0
  s_cbranch_scc1 L_14
  s_nop 0
  v_max_f32 v164, v164, v160
  v_max_f32 v165, v165, v161
  v_max_f32 v166, v166, v162
  v_max_f32_e64 v167, v167, v163
L_14:
  v_max3_f32 v88, v164, v165, v166
  v_max_f32 v88, v88, v167
  v_mov_b32 v98, v88
  s_nop 1
  v_permlane32_swap_b32 v88, v98
  v_max_f32 v88, v88, v98
  v_mov_b32 v98, v88
  s_nop 1
  v_permlane16_swap_b32 v88, v98
  v_max_f32_e64 v88, v88, v98
  s_mov_b32 s4, 0x3e8293ee
  v_mul_f32 v89, s4, v124
  v_mul_f32 v88, v89, v88
  v_pk_fma_f32 v[164:165], v[164:165], v[88:89], v[88:89] op_sel:[0,1,0] op_sel_hi:[1,1,0] neg_lo:[0,0,1] neg_hi:[0,0,1]
  v_pk_fma_f32 v[166:167], v[166:167], v[88:89], v[88:89] op_sel:[0,1,0] op_sel_hi:[1,1,0] neg_lo:[0,0,1] neg_hi:[0,0,1]
  v_exp_f32 v164, v164
  v_exp_f32 v165, v165
  v_exp_f32 v166, v166
  v_exp_f32 v167, v167
  v_cvt_pk_bf16_f32 v34, v164, v165
  v_cvt_pk_bf16_f32 v35, v166, v167
  v_and_b32 v32, v34, v20
  v_and_b32 v33, v35, v21
  v_xor_b32_e64 v34, v34, v32
  v_xor_b32 v35, v35, v33
  s_nop 1
  v_mfma_f32_16x16x32_bf16 v[128:131], v[120:123], v[32:35], 0
  v_mfma_f32_16x16x32_bf16 v[192:195], v[68:71], v[32:35], 0
  v_mfma_f32_16x16x32_bf16 v[196:199], v[78:81], v[32:35], 0
  s_nop 5
  v_rcp_f32_e64 v128, v128
  s_nop 0
  v_pk_mul_f32 v[192:193], v[192:193], v[128:129] op_sel_hi:[1,0]
  v_pk_mul_f32 v[194:195], v[194:195], v[128:129] op_sel_hi:[1,0]
  v_pk_mul_f32 v[196:197], v[196:197], v[128:129] op_sel_hi:[1,0]
  v_pk_mul_f32 v[198:199], v[198:199], v[128:129] op_sel_hi:[1,0]
  v_cvt_pk_bf16_f32 v48, v192, v193
  v_cvt_pk_bf16_f32 v49, v194, v195
  v_cvt_pk_bf16_f32 v50, v196, v197
  v_cvt_pk_bf16_f32 v51, v198, v199
  buffer_store_dwordx4 v[48:51], v0, s[40:43], s6 offen offset:0 sc0 sc1
  ds_write_b128 v0, v[48:51] offset:0
  ds_read_b32 v3, v28 offset:8
  s_cmp_lg_u32 s82, 0
  s_cbranch_scc1 L_15
  v_permlane16_swap_b32 v240, v242
  v_permlane16_swap_b32 v241, v243
  v_permlane16_swap_b32 v244, v246
  v_permlane16_swap_b32 v245, v247
  v_permlane16_swap_b32 v248, v250
  v_permlane16_swap_b32 v249, v251
  v_permlane16_swap_b32 v252, v254
  v_permlane16_swap_b32 v253, v255
L_15:
  s_mov_b32 s16, Lz1-Lz0+0
  s_mov_b32 s17, 16384
  s_mov_b32 s18, 0xffff4000
  s_mov_b32 s19, 32768
  s_mov_b32 s20, 8192
  s_mov_b32 s21, 0xfffee000
  s_mul_i32 s4, s85, 8192
  v_add_u32_e64 v4, s4, v11
  v_add_u32 v5, 1024, v4
  s_add_u32 s5, s19, 0
  s_lshl_b32 s4, s86, 1
  v_xor_b32_e64 v2, s4, v26
  v_lshl_add_u32 v6, v2, 5, v25
  v_add_u32 v6, s5, v6
  s_add_u32 s4, s4, 1
  v_xor_b32_e64 v2, s4, v26
  v_lshl_add_u32 v7, v2, 5, v25
  v_add_u32 v7, s5, v7
  s_lshl_b32 s5, s82, 1
  s_add_u32 s5, s5, Lz1-Lz0+2
  s_mov_b32 s89, 1600000
  s_branch Lw_17
Lw_16:
  ds_read_b32 v3, v28 offset:8
Lw_17:
  s_waitcnt lgkmcnt(0)
  v_readfirstlane_b32 s4, v3
  s_cmp_ge_u32 s4, s5
  s_cbranch_scc1 Lw_18
  s_sleep 1
  s_sub_u32 s89, s89, 1
  s_cbranch_scc0 Lw_16
Lw_18:
  ds_read_b64_tr_b16 v[48:49], v6 offset:0
  ds_read_b64_tr_b16 v[50:51], v6 offset:2048
  ds_read_b64_tr_b16 v[52:53], v7 offset:0
  ds_read_b64_tr_b16 v[54:55], v7 offset:2048
  ds_read_b64_tr_b16 v[80:81], v6 offset:4096
  ds_read_b64_tr_b16 v[82:83], v6 offset:6144
  ds_read_b64_tr_b16 v[84:85], v7 offset:4096
  ds_read_b64_tr_b16 v[86:87], v7 offset:6144
  ds_read_b64_tr_b16 v[112:113], v6 offset:8192
  ds_read_b64_tr_b16 v[114:115], v6 offset:10240
  ds_read_b64_tr_b16 v[116:117], v7 offset:8192
  ds_read_b64_tr_b16 v[118:119], v7 offset:10240
  s_nop 0
  s_waitcnt lgkmcnt(8)
  ds_read_b64_tr_b16 v[208:209], v6 offset:12288
  ds_read_b64_tr_b16 v[210:211], v6 offset:14336
  ds_read_b64_tr_b16 v[212:213], v7 offset:12288
  ds_read_b64_tr_b16 v[214:215], v7 offset:14336
  s_nop 0
  s_waitcnt lgkmcnt(8)
  ds_read_b64_tr_b16 v[160:161], v6 offset:16384
  ds_read_b64_tr_b16 v[162:163], v6 offset:18432
  ds_read_b64_tr_b16 v[164:165], v7 offset:16384
  ds_read_b64_tr_b16 v[166:167], v7 offset:18432
  s_nop 0
  s_waitcnt lgkmcnt(8)
  ds_read_b64_tr_b16 v[168:169], v6 offset:20480
  ds_read_b64_tr_b16 v[170:171], v6 offset:22528
  ds_read_b64_tr_b16 v[172:173], v7 offset:20480
  ds_read_b64_tr_b16 v[174:175], v7 offset:22528
  s_waitcnt lgkmcnt(8)
  s_add_u32 s5, s87, 0x0
  s_waitcnt vmcnt(0)
  s_mov_b64 exec, 1
  ds_add_rtn_u32 v2, v28, v27 offset:0
  s_waitcnt lgkmcnt(0)
  v_readfirstlane_b32 s4, v2
  s_and_b32 s4, s4, Lz1-Lz0+3
  s_cmp_lg_u32 s4, 3
  s_cbranch_scc1 Ls_19
  s_mov_b32 exec_lo, 0xffff
  buffer_store_dword v27, v24, s[40:43], s5 offen sc0 sc1
Ls_19:
  s_nop 0
  s_mov_b64 exec, -1
  ds_read_b64_tr_b16 v[176:177], v6 offset:24576
  ds_read_b64_tr_b16 v[178:179], v6 offset:26624
  ds_read_b64_tr_b16 v[180:181], v7 offset:24576
  ds_read_b64_tr_b16 v[182:183], v7 offset:26624
  ds_read_b64_tr_b16 v[184:185], v6 offset:28672
  ds_read_b64_tr_b16 v[186:187], v6 offset:30720
  ds_read_b64_tr_b16 v[188:189], v7 offset:28672
  ds_read_b64_tr_b16 v[190:191], v7 offset:30720
  ds_read_b64_tr_b16 v[224:225], v6 offset:32768
  ds_read_b64_tr_b16 v[226:227], v6 offset:34816
  ds_read_b64_tr_b16 v[228:229], v7 offset:32768
  ds_read_b64_tr_b16 v[230:231], v7 offset:34816
  s_nop 0
  s_waitcnt lgkmcnt(8)
  ds_read_b64_tr_b16 v[232:233], v6 offset:36864
  ds_read_b64_tr_b16 v[234:235], v6 offset:38912
  ds_read_b64_tr_b16 v[236:237], v7 offset:36864
  ds_read_b64_tr_b16 v[238:239], v7 offset:38912
  s_nop 0
  s_waitcnt lgkmcnt(8)
  ds_read_b64_tr_b16 v[56:57], v6 offset:40960
  ds_read_b64_tr_b16 v[58:59], v6 offset:43008
  ds_read_b64_tr_b16 v[60:61], v7 offset:40960
  ds_read_b64_tr_b16 v[62:63], v7 offset:43008
  s_nop 0
  s_waitcnt lgkmcnt(8)
  ds_read_b64_tr_b16 v[88:89], v6 offset:45056
  ds_read_b64_tr_b16 v[90:91], v6 offset:47104
  ds_read_b64_tr_b16 v[92:93], v7 offset:45056
  ds_read_b64_tr_b16 v[94:95], v7 offset:47104
  s_waitcnt lgkmcnt(8)
  s_mov_b32 s19, 0
  v_add_u32 v6, 0xffff8000, v6
  v_add_u32 v7, 0xffff8000, v7
  s_waitcnt lgkmcnt(0)
  s_mov_b64 exec, 1
  ds_add_u32 v28, v27 offset:12
  s_mov_b64 exec, -1
  s_mov_b32 s4, 0xffff0000
  v_lshlrev_b32 v128, 16, v240
  v_and_b32 v129, s4, v240
  v_lshlrev_b32 v130, 16, v241
  v_and_b32 v131, s4, v241
  v_lshlrev_b32 v132, 16, v242
  v_and_b32 v133, s4, v242
  v_lshlrev_b32 v134, 16, v243
  v_and_b32 v135, s4, v243
  v_lshlrev_b32 v136, 16, v244
  v_and_b32 v137, s4, v244
  v_lshlrev_b32 v138, 16, v245
  v_and_b32 v139, s4, v245
  v_lshlrev_b32 v140, 16, v246
  v_and_b32 v141, s4, v246
  v_lshlrev_b32 v142, 16, v247
  v_and_b32 v143, s4, v247
  v_lshlrev_b32 v144, 16, v248
  v_and_b32 v145, s4, v248
  v_lshlrev_b32 v146, 16, v249
  v_and_b32 v147, s4, v249
  v_lshlrev_b32 v148, 16, v250
  v_and_b32 v149, s4, v250
  v_lshlrev_b32 v150, 16, v251
  v_and_b32 v151, s4, v251
  v_lshlrev_b32 v152, 16, v252
  v_and_b32 v153, s4, v252
  v_lshlrev_b32 v154, 16, v253
  v_and_b32 v155, s4, v253
  v_lshlrev_b32 v156, 16, v254
  v_and_b32 v157, s4, v254
  v_lshlrev_b32 v158, 16, v255
  v_and_b32 v159, s4, v255
  s_lshl_b32 s4, s76, 4
  s_add_u32 s4, s4, s78
  s_lshl_b32 s6, s4, 14
  s_add_u32 s6, s6, 7340032
  s_add_u32 s7, s6, 4096
  s_mov_b32 s22, 5
  s_barrier
  ds_read_b128 v[32:35], v4 offset:0
  ds_read_b128 v[36:39], v4 offset:2048
  ds_read_b128 v[40:43], v4 offset:4096
  ds_read_b128 v[44:47], v4 offset:6144
  ds_read_b128 v[64:67], v5 offset:0
  ds_read_b128 v[68:71], v5 offset:2048
  ds_read_b128 v[72:75], v5 offset:4096
  ds_read_b128 v[76:79], v5 offset:6144
  s_add_u32 s16, s16, s17
  s_cmp_eq_u32 s16, 65536
  s_cselect_b32 s23, s18, s17
  s_cselect_b32 s16, 0, s16
  v_add_u32 v4, s23, v4
  v_add_u32 v5, s23, v5
  s_waitcnt lgkmcnt(0)
  v_mfma_f32_16x16x32_bf16 v[128:131], v[48:51], v[32:35], v[128:131]
  v_mfma_f32_16x16x32_bf16 v[128:131], v[80:83], v[64:67], v[128:131]
  v_mfma_f32_16x16x32_bf16 v[136:139], v[80:83], v[68:71], v[136:139]
  v_mfma_f32_16x16x32_bf16 v[136:139], v[48:51], v[36:39], v[136:139]
  v_mfma_f32_16x16x32_bf16 v[144:147], v[48:51], v[40:43], v[144:147]
  v_mfma_f32_16x16x32_bf16 v[144:147], v[80:83], v[72:75], v[144:147]
  v_mfma_f32_16x16x32_bf16 v[152:155], v[80:83], v[76:79], v[152:155]
  v_mfma_f32_16x16x32_bf16 v[152:155], v[48:51], v[44:47], v[152:155]
  v_mfma_f32_16x16x32_bf16 v[156:159], v[52:55], v[44:47], v[156:159]
  v_mfma_f32_16x16x32_bf16 v[156:159], v[84:87], v[76:79], v[156:159]
  v_mfma_f32_16x16x32_bf16 v[148:151], v[84:87], v[72:75], v[148:151]
  v_mfma_f32_16x16x32_bf16 v[148:151], v[52:55], v[40:43], v[148:151]
  v_mfma_f32_16x16x32_bf16 v[140:143], v[52:55], v[36:39], v[140:143]
  v_mfma_f32_16x16x32_bf16 v[140:143], v[84:87], v[68:71], v[140:143]
  v_mfma_f32_16x16x32_bf16 v[132:135], v[84:87], v[64:67], v[132:135]
  v_mfma_f32_16x16x32_bf16 v[132:135], v[52:55], v[32:35], v[132:135]
  s_nop 0
  s_barrier
  ds_read_b128 v[96:99], v4 offset:0
  ds_read_b128 v[192:195], v5 offset:0
  ds_read_b128 v[100:103], v4 offset:2048
  ds_read_b128 v[196:199], v5 offset:2048
  ds_read_b128 v[104:107], v4 offset:4096
  ds_read_b128 v[200:203], v5 offset:4096
  ds_read_b128 v[108:111], v4 offset:6144
  ds_read_b128 v[204:207], v5 offset:6144
  s_add_u32 s16, s16, s17
  s_cmp_eq_u32 s16, 65536
  s_cselect_b32 s23, s18, s17
  s_cselect_b32 s16, 0, s16
  v_add_u32 v4, s23, v4
  v_add_u32 v5, s23, v5
  s_waitcnt lgkmcnt(6)
  v_mfma_f32_16x16x32_bf16 v[128:131], v[112:115], v[96:99], v[128:131]
  v_mfma_f32_16x16x32_bf16 v[128:131], v[208:211], v[192:195], v[128:131]
  s_waitcnt lgkmcnt(4)
  v_mfma_f32_16x16x32_bf16 v[136:139], v[208:211], v[196:199], v[136:139]
  v_mfma_f32_16x16x32_bf16 v[136:139], v[112:115], v[100:103], v[136:139]
  s_waitcnt lgkmcnt(2)
  v_mfma_f32_16x16x32_bf16 v[144:147], v[112:115], v[104:107], v[144:147]
  v_mfma_f32_16x16x32_bf16 v[144:147], v[208:211], v[200:203], v[144:147]
  s_waitcnt lgkmcnt(0)
  v_mfma_f32_16x16x32_bf16 v[152:155], v[208:211], v[204:207], v[152:155]
  s_barrier
  v_mfma_f32_16x16x32_bf16 v[152:155], v[112:115], v[108:111], v[152:155]
  ds_read_b128 v[32:35], v4 offset:0
  ds_read_b128 v[36:39], v4 offset:2048
  v_mfma_f32_16x16x32_bf16 v[156:159], v[116:119], v[108:111], v[156:159]
  ds_read_b128 v[40:43], v4 offset:4096
  ds_read_b128 v[44:47], v4 offset:6144
  v_mfma_f32_16x16x32_bf16 v[156:159], v[212:215], v[204:207], v[156:159]
  ds_read_b128 v[64:67], v5 offset:0
  ds_read_b128 v[68:71], v5 offset:2048
  v_mfma_f32_16x16x32_bf16 v[148:151], v[212:215], v[200:203], v[148:151]
  ds_read_b128 v[72:75], v5 offset:4096
  ds_read_b128 v[76:79], v5 offset:6144
  v_mfma_f32_16x16x32_bf16 v[148:151], v[116:119], v[104:107], v[148:151]
  s_add_u32 s16, s16, s17
  s_cmp_eq_u32 s16, 65536
  s_cselect_b32 s23, s18, s17
  v_mfma_f32_16x16x32_bf16 v[140:143], v[116:119], v[100:103], v[140:143]
  s_cselect_b32 s16, 0, s16
  v_add_u32 v4, s23, v4
  v_add_u32_e64 v5, s23, v5
  v_mfma_f32_16x16x32_bf16 v[140:143], v[212:215], v[196:199], v[140:143]
  v_mfma_f32_16x16x32_bf16 v[132:135], v[212:215], v[192:195], v[132:135]
  s_waitcnt lgkmcnt(0)
  v_mfma_f32_16x16x32_bf16 v[132:135], v[116:119], v[96:99], v[132:135]
  s_barrier
  v_mfma_f32_16x16x32_bf16 v[128:131], v[160:163], v[32:35], v[128:131]
  ds_read_b128 v[96:99], v4 offset:0
  ds_read_b128 v[100:103], v4 offset:2048
  v_mfma_f32_16x16x32_bf16 v[128:131], v[168:171], v[64:67], v[128:131]
  ds_read_b128 v[104:107], v4 offset:4096
  ds_read_b128 v[108:111], v4 offset:6144
  v_mfma_f32_16x16x32_bf16 v[136:139], v[168:171], v[68:71], v[136:139]
  ds_read_b128 v[192:195], v5 offset:0
  ds_read_b128 v[196:199], v5 offset:2048
  v_mfma_f32_16x16x32_bf16 v[136:139], v[160:163], v[36:39], v[136:139]
  ds_read_b128 v[200:203], v5 offset:4096
  ds_read_b128 v[204:207], v5 offset:6144
  v_mfma_f32_16x16x32_bf16 v[144:147], v[160:163], v[40:43], v[144:147]
  s_add_u32 s16, s16, s17
  s_cmp_eq_u32 s16, 65536
  s_cselect_b32 s23, s18, s17
  v_mfma_f32_16x16x32_bf16 v[144:147], v[168:171], v[72:75], v[144:147]
  s_cselect_b32 s16, 0, s16
  v_add_u32 v4, s23, v4
  v_add_u32_e64 v5, s23, v5
  v_mfma_f32_16x16x32_bf16 v[152:155], v[168:171], v[76:79], v[152:155]
  v_mfma_f32_16x16x32_bf16 v[152:155], v[160:163], v[44:47], v[152:155]
  v_mfma_f32_16x16x32_bf16 v[156:159], v[164:167], v[44:47], v[156:159]
  v_mfma_f32_16x16x32_bf16 v[156:159], v[172:175], v[76:79], v[156:159]
  v_mfma_f32_16x16x32_bf16 v[148:151], v[172:175], v[72:75], v[148:151]
  v_mfma_f32_16x16x32_bf16 v[148:151], v[164:167], v[40:43], v[148:151]
  v_mfma_f32_16x16x32_bf16 v[140:143], v[164:167], v[36:39], v[140:143]
  v_mfma_f32_16x16x32_bf16 v[140:143], v[172:175], v[68:71], v[140:143]
  v_mfma_f32_16x16x32_bf16 v[132:135], v[172:175], v[64:67], v[132:135]
  s_waitcnt lgkmcnt(0)
  v_mfma_f32_16x16x32_bf16 v[132:135], v[164:167], v[32:35], v[132:135]
  s_barrier
  v_mfma_f32_16x16x32_bf16 v[128:131], v[176:179], v[96:99], v[128:131]
  ds_read_b128 v[32:35], v4 offset:0
  ds_read_b128 v[36:39], v4 offset:2048
  v_mfma_f32_16x16x32_bf16 v[128:131], v[184:187], v[192:195], v[128:131]
  ds_read_b128 v[40:43], v4 offset:4096
  ds_read_b128 v[44:47], v4 offset:6144
  v_mfma_f32_16x16x32_bf16 v[136:139], v[184:187], v[196:199], v[136:139]
  ds_read_b128 v[64:67], v5 offset:0
  ds_read_b128 v[68:71], v5 offset:2048
  v_mfma_f32_16x16x32_bf16 v[136:139], v[176:179], v[100:103], v[136:139]
  ds_read_b128 v[72:75], v5 offset:4096
  ds_read_b128 v[76:79], v5 offset:6144
  v_mfma_f32_16x16x32_bf16 v[144:147], v[176:179], v[104:107], v[144:147]
  s_add_u32 s16, s16, s17
  s_cmp_eq_u32 s16, 65536
  s_cselect_b32 s23, s18, s17
  v_mfma_f32_16x16x32_bf16 v[144:147], v[184:187], v[200:203], v[144:147]
  s_cselect_b32 s16, 0, s16
  v_add_u32 v4, s23, v4
  v_add_u32_e64 v5, s23, v5
  v_mfma_f32_16x16x32_bf16 v[152:155], v[184:187], v[204:207], v[152:155]
  v_mfma_f32_16x16x32_bf16 v[152:155], v[176:179], v[108:111], v[152:155]
  v_mfma_f32_16x16x32_bf16 v[156:159], v[180:183], v[108:111], v[156:159]
  v_mfma_f32_16x16x32_bf16 v[156:159], v[188:191], v[204:207], v[156:159]
  v_mfma_f32_16x16x32_bf16 v[148:151], v[188:191], v[200:203], v[148:151]
  v_mfma_f32_16x16x32_bf16 v[148:151], v[180:183], v[104:107], v[148:151]
  v_mfma_f32_16x16x32_bf16 v[140:143], v[180:183], v[100:103], v[140:143]
  v_mfma_f32_16x16x32_bf16 v[140:143], v[188:191], v[196:199], v[140:143]
  v_mfma_f32_16x16x32_bf16 v[132:135], v[188:191], v[192:195], v[132:135]
  s_waitcnt lgkmcnt(0)
  v_mfma_f32_16x16x32_bf16 v[132:135], v[180:183], v[96:99], v[132:135]
  s_barrier
  v_mfma_f32_16x16x32_bf16 v[128:131], v[224:227], v[32:35], v[128:131]
  ds_read_b128 v[96:99], v4 offset:0
  ds_read_b128 v[100:103], v4 offset:2048
  v_mfma_f32_16x16x32_bf16 v[128:131], v[232:235], v[64:67], v[128:131]
  ds_read_b128 v[104:107], v4 offset:4096
  ds_read_b128 v[108:111], v4 offset:6144
  v_mfma_f32_16x16x32_bf16 v[136:139], v[232:235], v[68:71], v[136:139]
  ds_read_b128 v[192:195], v5 offset:0
  ds_read_b128 v[196:199], v5 offset:2048
  v_mfma_f32_16x16x32_bf16 v[136:139], v[224:227], v[36:39], v[136:139]
  ds_read_b128 v[200:203], v5 offset:4096
  ds_read_b128 v[204:207], v5 offset:6144
  v_mfma_f32_16x16x32_bf16 v[144:147], v[224:227], v[40:43], v[144:147]
  s_add_u32 s16, s16, s17
  s_cmp_eq_u32 s16, 65536
  s_cselect_b32 s23, s18, s17
  v_mfma_f32_16x16x32_bf16 v[144:147], v[232:235], v[72:75], v[144:147]
  s_cselect_b32 s16, 0, s16
  v_add_u32 v4, s23, v4
  v_add_u32_e64 v5, s23, v5
  v_mfma_f32_16x16x32_bf16 v[152:155], v[232:235], v[76:79], v[152:155]
  v_mfma_f32_16x16x32_bf16 v[152:155], v[224:227], v[44:47], v[152:155]
  v_mfma_f32_16x16x32_bf16 v[156:159], v[228:231], v[44:47], v[156:159]
  v_mfma_f32_16x16x32_bf16 v[156:159], v[236:239], v[76:79], v[156:159]
  v_mfma_f32_16x16x32_bf16 v[148:151], v[236:239], v[72:75], v[148:151]
  v_mfma_f32_16x16x32_bf16 v[148:151], v[228:231], v[40:43], v[148:151]
  v_mfma_f32_16x16x32_bf16 v[140:143], v[228:231], v[36:39], v[140:143]
  v_mfma_f32_16x16x32_bf16 v[140:143], v[236:239], v[68:71], v[140:143]
  v_mfma_f32_16x16x32_bf16 v[132:135], v[236:239], v[64:67], v[132:135]
  s_waitcnt lgkmcnt(0)
  v_mfma_f32_16x16x32_bf16 v[132:135], v[228:231], v[32:35], v[132:135]
  s_barrier
  v_mfma_f32_16x16x32_bf16 v[128:131], v[56:59], v[96:99], v[128:131]
  ds_read_b64_tr_b16 v[48:49], v6 offset:0
  ds_read_b64_tr_b16 v[50:51], v6 offset:2048
  v_mfma_f32_16x16x32_bf16 v[128:131], v[88:91], v[192:195], v[128:131]
  ds_read_b128 v[32:35], v4 offset:0
  ds_read_b128 v[36:39], v4 offset:2048
  v_mfma_f32_16x16x32_bf16 v[136:139], v[88:91], v[196:199], v[136:139]
  ds_read_b128 v[40:43], v4 offset:4096
  ds_read_b128 v[44:47], v4 offset:6144
  v_mfma_f32_16x16x32_bf16 v[136:139], v[56:59], v[100:103], v[136:139]
  ds_read_b64_tr_b16 v[52:53], v7 offset:0
  ds_read_b64_tr_b16 v[54:55], v7 offset:2048
  v_mfma_f32_16x16x32_bf16 v[144:147], v[56:59], v[104:107], v[144:147]
  ds_read_b64_tr_b16 v[80:81], v6 offset:4096
  ds_read_b64_tr_b16 v[82:83], v6 offset:6144
  v_mfma_f32_16x16x32_bf16 v[144:147], v[88:91], v[200:203], v[144:147]
  ds_read_b128 v[64:67], v5 offset:0
  ds_read_b128 v[68:71], v5 offset:2048
  v_mfma_f32_16x16x32_bf16 v[152:155], v[88:91], v[204:207], v[152:155]
  ds_read_b128 v[72:75], v5 offset:4096
  ds_read_b128 v[76:79], v5 offset:6144
  v_mfma_f32_16x16x32_bf16 v[152:155], v[56:59], v[108:111], v[152:155]
  ds_read_b64_tr_b16 v[84:85], v7 offset:4096
  ds_read_b64_tr_b16 v[86:87], v7 offset:6144
  v_mfma_f32_16x16x32_bf16 v[156:159], v[60:63], v[108:111], v[156:159]
  s_add_u32 s16, s16, s17
  s_cmp_eq_u32 s16, 65536
  s_cselect_b32 s23, s18, s17
  v_mfma_f32_16x16x32_bf16 v[156:159], v[92:95], v[204:207], v[156:159]
  s_cselect_b32 s16, 0, s16
  v_add_u32 v4, s23, v4
  v_add_u32_e64 v5, s23, v5
  v_mfma_f32_16x16x32_bf16 v[148:151], v[92:95], v[200:203], v[148:151]
  s_add_u32 s19, s19, s20
  s_cmp_eq_u32 s19, 81920
  s_cselect_b32 s23, s21, s20
  v_mfma_f32_16x16x32_bf16 v[148:151], v[60:63], v[104:107], v[148:151]
  s_cselect_b32 s19, 0, s19
  v_add_u32 v6, s23, v6
  v_add_u32_e64 v7, s23, v7
  v_mfma_f32_16x16x32_bf16 v[140:143], v[60:63], v[100:103], v[140:143]
  v_mfma_f32_16x16x32_bf16 v[140:143], v[92:95], v[196:199], v[140:143]
  v_mfma_f32_16x16x32_bf16 v[132:135], v[92:95], v[192:195], v[132:135]
  s_waitcnt lgkmcnt(0)
  v_mfma_f32_16x16x32_bf16 v[132:135], v[60:63], v[96:99], v[132:135]
Lk_20:
  s_barrier
  v_mfma_f32_16x16x32_bf16 v[128:131], v[48:51], v[32:35], v[128:131]
  ds_read_b64_tr_b16 v[112:113], v6 offset:0
  ds_read_b64_tr_b16 v[114:115], v6 offset:2048
  v_mfma_f32_16x16x32_bf16 v[128:131], v[80:83], v[64:67], v[128:131]
  ds_read_b128 v[96:99], v4 offset:0
  ds_read_b128 v[100:103], v4 offset:2048
  v_mfma_f32_16x16x32_bf16 v[136:139], v[80:83], v[68:71], v[136:139]
  ds_read_b128 v[104:107], v4 offset:4096
  ds_read_b128 v[108:111], v4 offset:6144
  v_mfma_f32_16x16x32_bf16 v[136:139], v[48:51], v[36:39], v[136:139]
  ds_read_b64_tr_b16 v[116:117], v7 offset:0
  ds_read_b64_tr_b16 v[118:119], v7 offset:2048
  v_mfma_f32_16x16x32_bf16 v[144:147], v[48:51], v[40:43], v[144:147]
  ds_read_b64_tr_b16 v[208:209], v6 offset:4096
  ds_read_b64_tr_b16 v[210:211], v6 offset:6144
  v_mfma_f32_16x16x32_bf16 v[144:147], v[80:83], v[72:75], v[144:147]
  ds_read_b128 v[192:195], v5 offset:0
  ds_read_b128 v[196:199], v5 offset:2048
  v_mfma_f32_16x16x32_bf16 v[152:155], v[80:83], v[76:79], v[152:155]
  ds_read_b128 v[200:203], v5 offset:4096
  ds_read_b128 v[204:207], v5 offset:6144
  v_mfma_f32_16x16x32_bf16 v[152:155], v[48:51], v[44:47], v[152:155]
  ds_read_b64_tr_b16 v[212:213], v7 offset:4096
  ds_read_b64_tr_b16 v[214:215], v7 offset:6144
  v_mfma_f32_16x16x32_bf16 v[156:159], v[52:55], v[44:47], v[156:159]
  s_add_u32 s16, s16, s17
  s_cmp_eq_u32 s16, 65536
  s_cselect_b32 s23, s18, s17
  v_mfma_f32_16x16x32_bf16 v[156:159], v[84:87], v[76:79], v[156:159]
  s_cselect_b32 s16, 0, s16
  v_add_u32 v4, s23, v4
  v_add_u32_e64 v5, s23, v5
  v_mfma_f32_16x16x32_bf16 v[148:151], v[84:87], v[72:75], v[148:151]
  s_add_u32 s19, s19, s20
  s_cmp_eq_u32 s19, 81920
  s_cselect_b32 s23, s21, s20
  v_mfma_f32_16x16x32_bf16 v[148:151], v[52:55], v[40:43], v[148:151]
  s_cselect_b32 s19, 0, s19
  v_add_u32 v6, s23, v6
  v_add_u32_e64 v7, s23, v7
  v_mfma_f32_16x16x32_bf16 v[140:143], v[52:55], v[36:39], v[140:143]
  v_mfma_f32_16x16x32_bf16 v[140:143], v[84:87], v[68:71], v[140:143]
  v_mfma_f32_16x16x32_bf16 v[132:135], v[84:87], v[64:67], v[132:135]
  s_waitcnt lgkmcnt(0)
  v_mfma_f32_16x16x32_bf16 v[132:135], v[52:55], v[32:35], v[132:135]
  s_barrier
  v_mfma_f32_16x16x32_bf16 v[128:131], v[112:115], v[96:99], v[128:131]
  ds_read_b64_tr_b16 v[48:49], v6 offset:0
  ds_read_b64_tr_b16 v[50:51], v6 offset:2048
  v_mfma_f32_16x16x32_bf16 v[128:131], v[208:211], v[192:195], v[128:131]
  ds_read_b128 v[32:35], v4 offset:0
  ds_read_b128 v[36:39], v4 offset:2048
  v_mfma_f32_16x16x32_bf16 v[136:139], v[208:211], v[196:199], v[136:139]
  ds_read_b128 v[40:43], v4 offset:4096
  ds_read_b128 v[44:47], v4 offset:6144
  v_mfma_f32_16x16x32_bf16 v[136:139], v[112:115], v[100:103], v[136:139]
  ds_read_b64_tr_b16 v[52:53], v7 offset:0
  ds_read_b64_tr_b16 v[54:55], v7 offset:2048
  v_mfma_f32_16x16x32_bf16 v[144:147], v[112:115], v[104:107], v[144:147]
  ds_read_b64_tr_b16 v[80:81], v6 offset:4096
  ds_read_b64_tr_b16 v[82:83], v6 offset:6144
  v_mfma_f32_16x16x32_bf16 v[144:147], v[208:211], v[200:203], v[144:147]
  ds_read_b128 v[64:67], v5 offset:0
  ds_read_b128 v[68:71], v5 offset:2048
  v_mfma_f32_16x16x32_bf16 v[152:155], v[208:211], v[204:207], v[152:155]
  ds_read_b128 v[72:75], v5 offset:4096
  ds_read_b128 v[76:79], v5 offset:6144
  v_mfma_f32_16x16x32_bf16 v[152:155], v[112:115], v[108:111], v[152:155]
  ds_read_b64_tr_b16 v[84:85], v7 offset:4096
  ds_read_b64_tr_b16 v[86:87], v7 offset:6144
  v_mfma_f32_16x16x32_bf16 v[156:159], v[116:119], v[108:111], v[156:159]
  s_add_u32 s16, s16, s17
  s_cmp_eq_u32 s16, 65536
  s_cselect_b32 s23, s18, s17
  v_mfma_f32_16x16x32_bf16 v[156:159], v[212:215], v[204:207], v[156:159]
  s_cselect_b32 s16, 0, s16
  v_add_u32 v4, s23, v4
  v_add_u32_e64 v5, s23, v5
  v_mfma_f32_16x16x32_bf16 v[148:151], v[212:215], v[200:203], v[148:151]
  s_add_u32 s19, s19, s20
  s_cmp_eq_u32 s19, 81920
  s_cselect_b32 s23, s21, s20
  v_mfma_f32_16x16x32_bf16 v[148:151], v[116:119], v[104:107], v[148:151]
  s_cselect_b32 s19, 0, s19
  v_add_u32 v6, s23, v6
  v_add_u32_e64 v7, s23, v7
  v_mfma_f32_16x16x32_bf16 v[140:143], v[116:119], v[100:103], v[140:143]
  s_sub_u32 s22, s22, 1
  s_cmp_lg_u32 s22, 0
  v_mfma_f32_16x16x32_bf16 v[140:143], v[212:215], v[196:199], v[140:143]
  v_mfma_f32_16x16x32_bf16 v[132:135], v[212:215], v[192:195], v[132:135]
  s_nop 0
  s_waitcnt lgkmcnt(0)
  v_mfma_f32_16x16x32_bf16 v[132:135], v[116:119], v[96:99], v[132:135]
  s_cbranch_scc1 Lk_20
  s_waitcnt lgkmcnt(0)
  v_cvt_pk_bf16_f32 v252, v152, v153
  v_cvt_pk_bf16_f32 v253, v154, v155
  v_cvt_pk_bf16_f32 v254, v156, v157
  v_cvt_pk_bf16_f32 v255, v158, v159
  buffer_store_dwordx4 v[252:255], v0, s[40:43], s7 offen offset:2048 sc0 sc1
  v_cvt_pk_bf16_f32 v248, v144, v145
  v_cvt_pk_bf16_f32 v249, v146, v147
  v_cvt_pk_bf16_f32 v250, v148, v149
  v_cvt_pk_bf16_f32 v251, v150, v151
  buffer_store_dwordx4 v[248:251], v0, s[40:43], s7 offen offset:0 sc0 sc1
  v_cvt_pk_bf16_f32 v244, v136, v137
  v_cvt_pk_bf16_f32 v245, v138, v139
  v_cvt_pk_bf16_f32 v246, v140, v141
  v_cvt_pk_bf16_f32 v247, v142, v143
  buffer_store_dwordx4 v[244:247], v0, s[40:43], s6 offen offset:2048 sc0 sc1
  v_cvt_pk_bf16_f32 v240, v128, v129
  v_cvt_pk_bf16_f32 v241, v130, v131
  v_cvt_pk_bf16_f32 v242, v132, v133
  v_cvt_pk_bf16_f32 v243, v134, v135
  buffer_store_dwordx4 v[240:243], v0, s[40:43], s6 offen offset:0 sc0 sc1
  s_lshl_b32 s5, s78, Lz1-Lz0+1
  v_mov_b32 v40, 0x3f803f80
  v_dot2_f32_bf16 v32, v240, v40, 0
  v_dot2_f32_bf16 v36, v240, v240, 0
  v_dot2_f32_bf16 v33, v244, v40, 0
  v_dot2_f32_bf16 v37, v244, v244, 0
  v_dot2_f32_bf16 v34, v248, v40, 0
  v_dot2_f32_bf16 v38, v248, v248, 0
  v_dot2_f32_bf16 v35, v252, v40, 0
  v_dot2_f32_bf16 v39, v252, v252, 0
  v_dot2_f32_bf16 v32, v241, v40, v32
  v_dot2_f32_bf16 v36, v241, v241, v36
  v_dot2_f32_bf16 v33, v245, v40, v33
  v_dot2_f32_bf16 v37, v245, v245, v37
  v_dot2_f32_bf16 v34, v249, v40, v34
  v_dot2_f32_bf16 v38, v249, v249, v38
  v_dot2_f32_bf16 v35, v253, v40, v35
  v_dot2_f32_bf16 v39, v253, v253, v39
  v_dot2_f32_bf16 v32, v242, v40, v32
  v_dot2_f32_bf16 v36, v242, v242, v36
  v_dot2_f32_bf16 v33, v246, v40, v33
  v_dot2_f32_bf16 v37, v246, v246, v37
  v_dot2_f32_bf16 v34, v250, v40, v34
  v_dot2_f32_bf16 v38, v250, v250, v38
  v_dot2_f32_bf16 v35, v254, v40, v35
  v_dot2_f32_bf16 v39, v254, v254, v39
  v_dot2_f32_bf16 v32, v243, v40, v32
  v_dot2_f32_bf16 v36, v243, v243, v36
  v_dot2_f32_bf16 v33, v247, v40, v33
  v_dot2_f32_bf16 v37, v247, v247, v37
  v_dot2_f32_bf16 v34, v251, v40, v34
  v_dot2_f32_bf16 v38, v251, v251, v38
  v_dot2_f32_bf16 v35, v255, v40, v35
  v_dot2_f32_bf16 v39, v255, v255, v39
  s_lshl_b32 s6, s76, Lz1-Lz0+9
  s_lshl_b32 s7, s85, 8
  s_add_u32 s6, s6, s7
  s_add_u32 s6, s6, s5
  s_add_u32 s6, s6, s86
  s_lshl_b32 s6, s6, 6
  s_add_u32 s6, s6, s83
  s_add_u32 s6, s6, 31457280
  v_permlane32_swap_b32 v32, v34
  v_permlane32_swap_b32 v33, v35
  v_permlane32_swap_b32 v36, v38
  v_permlane32_swap_b32 v37, v39
  v_add_f32 v32, v32, v34
  v_add_f32 v33, v33, v35
  v_add_f32 v36, v36, v38
  v_add_f32 v37, v37, v39
  v_permlane16_swap_b32 v32, v33
  s_nop 0
  v_permlane16_swap_b32 v36, v37
  v_add_f32 v42, v32, v33
  v_add_f32_e64 v43, v36, v37
  buffer_store_dwordx2 v[42:43], v30, s[40:43], s6 offen sc0 sc1
  ds_write_b128 v0, v[240:243] offset:0
  ds_write_b128 v0, v[244:247] offset:2048
  ds_write_b128 v0, v[248:251] offset:4096
  ds_write_b128 v0, v[252:255] offset:6144
  s_add_u32 s5, s87, 0x4
  s_sub_u32 s4, s78, s77
  s_lshl_b32 s4, s4, 7
  s_add_u32 s5, s5, s4
  s_waitcnt vmcnt(0)
  s_mov_b64 exec, 1
  ds_add_rtn_u32 v2, v28, v27 offset:0
  s_waitcnt lgkmcnt(0)
  v_readfirstlane_b32 s4, v2
  s_and_b32 s4, s4, Lz1-Lz0+3
  s_cmp_lg_u32 s4, 3
  s_cbranch_scc1 Ls_21
  s_mov_b32 exec_lo, 0xffff
  buffer_store_dword v27, v24, s[40:43], s5 offen sc0 sc1
Ls_21:
  s_mov_b64 exec, -1
  s_mov_b32 s16, 0
  s_mov_b32 s17, 16384
  s_mov_b32 s18, 0xffff4000
  s_mov_b32 s19, Lz1-Lz0+0
  s_mov_b32 s20, 28672
  s_mov_b32 s21, 0xffff2000
  s_mul_i32 s4, s85, 8192
  v_add_u32_e64 v4, s4, v11
  v_add_u32 v5, 1024, v4
  s_mul_i32 s4, s86, 6
  s_add_u32 s4, s4, 0
  s_lshr_b32 s5, s4, 2
  s_lshl_b32 s5, s5, 13
  s_and_b32 s4, s4, 3
  v_xor_b32 v2, s4, v26
  v_lshl_add_u32 v6, v2, 5, v25
  v_add_u32 v6, s5, v6
  s_mul_i32 s4, s86, 6
  s_add_u32 s4, s4, 1
  s_lshr_b32 s5, s4, 2
  s_lshl_b32 s5, s5, 13
  s_and_b32 s4, s4, 3
  v_xor_b32_e64 v2, s4, v26
  v_lshl_add_u32 v7, v2, 5, v25
  v_add_u32 v7, s5, v7
  s_mul_i32 s4, s86, 6
  s_add_u32 s4, s4, 2
  s_lshr_b32 s5, s4, 2
  s_lshl_b32 s5, s5, 13
  s_and_b32 s4, s4, 3
  v_xor_b32_e64 v2, s4, v26
  v_lshl_add_u32 v8, v2, 5, v25
  v_add_u32 v8, s5, v8
  s_mul_i32 s4, s86, 6
  s_add_u32 s4, s4, 3
  s_lshr_b32 s5, s4, 2
  s_lshl_b32 s5, s5, 13
  s_and_b32 s4, s4, 3
  v_xor_b32_e64 v2, s4, v26
  v_lshl_add_u32 v9, v2, 5, v25
  v_add_u32 v9, s5, v9
  v_lshrrev_b32 v2, 2, v1
  v_lshlrev_b32 v3, 6, v2
  v_and_b32 v2, 3, v1
  v_lshl_add_u32 v3, v2, 3, v3
  v_bfe_u32 v2, v1, 4, 1
  v_xor_b32_e64 v2, s86, v2
  v_lshl_add_u32 v3, v2, 5, v3
  v_add_u32 v10, 90112, v3
  v_mov_b64 v[128:129], 0
  v_mov_b64 v[130:131], 0
  v_mov_b64 v[132:133], 0
  v_mov_b64 v[134:135], 0
  v_mov_b64 v[136:137], 0
  v_mov_b64 v[138:139], 0
  v_mov_b64 v[140:141], 0
  v_mov_b64 v[142:143], 0
  v_mov_b64 v[144:145], 0
  v_mov_b64 v[146:147], 0
  v_mov_b64 v[148:149], 0
  v_mov_b64 v[150:151], 0
  v_mov_b64 v[152:153], 0
  v_mov_b64 v[154:155], 0
  v_mov_b64 v[156:157], 0
  v_mov_b64 v[158:159], 0
  v_mov_b64 v[160:161], 0
  v_mov_b64 v[162:163], 0
  v_mov_b64 v[164:165], 0
  v_mov_b64 v[166:167], 0
  v_mov_b64 v[168:169], 0
  v_mov_b64 v[170:171], 0
  v_mov_b64 v[172:173], 0
  v_mov_b64 v[174:175], 0
  v_mov_b64 v[176:177], 0
  v_mov_b64 v[178:179], 0
  v_mov_b64 v[180:181], 0
  v_mov_b64 v[182:183], 0
  v_mov_b64 v[184:185], 0
  v_mov_b64 v[186:187], 0
  v_mov_b64 v[188:189], 0
  v_mov_b64 v[190:191], 0
  v_mov_b64 v[192:193], 0
  v_mov_b64 v[194:195], 0
  v_mov_b64 v[196:197], 0
  v_mov_b64 v[198:199], 0
  v_mov_b64 v[200:201], 0
  v_mov_b64 v[202:203], 0
  v_mov_b64 v[204:205], 0
  v_mov_b64 v[206:207], 0
  v_mov_b64 v[208:209], 0
  v_mov_b64 v[210:211], 0
  v_mov_b64 v[212:213], 0
  v_mov_b64 v[214:215], 0
  v_mov_b64 v[216:217], 0
  v_mov_b64 v[218:219], 0
  v_mov_b64 v[220:221], 0
  v_mov_b64 v[222:223], 0
  v_mov_b64 v[224:225], 0
  v_mov_b64 v[226:227], 0
  v_mov_b64 v[228:229], 0
  v_mov_b64 v[230:231], 0
  v_mov_b64 v[232:233], 0
  v_mov_b64 v[234:235], 0
  v_mov_b64 v[236:237], 0
  v_mov_b64 v[238:239], 0
  s_mul_i32 s5, s86, 384
  s_add_u32 s5, s5, 154112
  v_add_u32 v3, s5, v29
  s_mul_i32 s4, s76, 56
  s_mul_i32 s5, s79, 28
  s_add_u32 s4, s4, s5
  s_add_u32 s6, s4, s80
  s_lshl_b32 s6, s6, 14
  s_add_u32 s6, s6, 11599872
  s_add_u32 s7, s6, 4096
  s_lshr_b32 s5, s80, 1
  s_add_u32 s4, s4, s5
  s_lshl_b32 s4, s4, 1
  s_add_u32 s4, s4, s85
  s_lshl_b32 s4, s4, 3
  s_and_b32 s5, s80, 1
  s_add_u32 s4, s4, s5
  s_lshl_b32 s4, s4, 1
  s_add_u32 s4, s4, s86
  s_lshl_b32 s8, s4, 9
  s_add_u32 s8, s8, 11534336
  s_lshl_b32 s4, s79, Lz1-Lz0+3
  s_lshl_b32 s10, 0xff, s4
  s_mov_b32 s22, 8
  s_mov_b64 vcc, -1
  s_waitcnt lgkmcnt(0)
  s_barrier
  s_branch Lo_25
Lo_26:
  s_mov_b64 vcc, 0
  s_waitcnt lgkmcnt(0)
  s_barrier
  ds_read_b128 v[64:67], v4 offset:0
  ds_read_b128 v[80:83], v5 offset:0
  ds_read_b128 v[68:71], v4 offset:2048
  ds_read_b128 v[84:87], v5 offset:2048
  ds_read_b128 v[72:75], v4 offset:4096
  ds_read_b128 v[88:91], v5 offset:4096
  ds_read_b64_tr_b16 v[96:97], v6 offset:0
  ds_read_b64_tr_b16 v[98:99], v6 offset:2048
  ds_read_b64_tr_b16 v[100:101], v6 offset:4096
  ds_read_b64_tr_b16 v[102:103], v6 offset:6144
  ds_read_b128 v[76:79], v4 offset:6144
  ds_read_b128 v[92:95], v5 offset:6144
  ds_read_b64_tr_b16 v[104:105], v7 offset:0
  s_nop 0
  s_waitcnt lgkmcnt(8)
  ds_read_b64_tr_b16 v[106:107], v7 offset:2048
  ds_read_b64_tr_b16 v[108:109], v7 offset:4096
  ds_read_b64_tr_b16 v[110:111], v7 offset:6144
  s_waitcnt lgkmcnt(6)
  s_branch Lk_23
Lo_25:
  ds_read_b128 v[32:35], v4 offset:0
  ds_read_b128 v[48:51], v5 offset:0
  ds_read_b128 v[36:39], v4 offset:2048
  ds_read_b128 v[52:55], v5 offset:2048
  ds_read_b128 v[40:43], v4 offset:4096
  ds_read_b128 v[56:59], v5 offset:4096
  ds_read_b64_tr_b16 v[96:97], v6 offset:0
  ds_read_b64_tr_b16 v[98:99], v6 offset:2048
  ds_read_b64_tr_b16 v[100:101], v6 offset:4096
  ds_read_b64_tr_b16 v[102:103], v6 offset:6144
  ds_read_b128 v[44:47], v4 offset:6144
  ds_read_b128 v[60:63], v5 offset:6144
  ds_read_b64_tr_b16 v[104:105], v7 offset:0
  s_nop 0
  s_waitcnt lgkmcnt(8)
  ds_read_b64_tr_b16 v[106:107], v7 offset:2048
  ds_read_b64_tr_b16 v[108:109], v7 offset:4096
  ds_read_b64_tr_b16 v[110:111], v7 offset:6144
  s_nop 0
  s_waitcnt lgkmcnt(6)
  .p2align 7
Lk_22:
  v_mfma_f32_16x16x32_bf16 v[128:131], v[96:99], v[32:35], v[128:131]
  ds_read_b64_tr_b16 v[112:113], v8 offset:0
  v_mfma_f32_16x16x32_bf16 v[128:131], v[100:103], v[48:51], v[128:131]
  ds_read_b64_tr_b16 v[114:115], v8 offset:2048
  v_mfma_f32_16x16x32_bf16 v[132:135], v[100:103], v[52:55], v[132:135]
  ds_read_b64_tr_b16 v[116:117], v8 offset:4096
  v_mfma_f32_16x16x32_bf16 v[132:135], v[96:99], v[36:39], v[132:135]
  ds_read_b64_tr_b16 v[118:119], v8 offset:6144
  v_mfma_f32_16x16x32_bf16 v[136:139], v[96:99], v[40:43], v[136:139]
  s_add_u32 s16, s16, s17
  s_cmp_eq_u32 s16, 65536
  s_cselect_b32 s23, s18, s17
  s_cselect_b32 s16, Lz1-Lz0+0, s16
  v_mfma_f32_16x16x32_bf16 v[136:139], v[100:103], v[56:59], v[136:139]
  v_add_u32_e64 v4, s23, v4
  v_add_u32 v5, s23, v5
  s_add_u32 s19, s19, s20
  s_cmp_eq_u32 s19, 86016
  s_waitcnt lgkmcnt(8)
  v_mfma_f32_16x16x32_bf16 v[140:143], v[100:103], v[60:63], v[140:143]
  s_cselect_b32 s23, s21, s20
  s_cselect_b32 s19, 0, s19
  v_mfma_f32_16x16x32_bf16 v[140:143], v[96:99], v[44:47], v[140:143]
  s_waitcnt lgkmcnt(4)
  v_mfma_f32_16x16x32_bf16 v[156:159], v[104:107], v[44:47], v[156:159]
  ds_read_b64_tr_b16 v[120:121], v9 offset:0
  v_mfma_f32_16x16x32_bf16 v[156:159], v[108:111], v[60:63], v[156:159]
  ds_read_b64_tr_b16 v[122:123], v9 offset:2048
  v_mfma_f32_16x16x32_bf16 v[152:155], v[108:111], v[56:59], v[152:155]
  ds_read_b64_tr_b16 v[124:125], v9 offset:4096
  v_mfma_f32_16x16x32_bf16 v[152:155], v[104:107], v[40:43], v[152:155]
  ds_read_b64_tr_b16 v[126:127], v9 offset:6144
  v_mfma_f32_16x16x32_bf16 v[148:151], v[104:107], v[36:39], v[148:151]
  v_mfma_f32_16x16x32_bf16 v[148:151], v[108:111], v[52:55], v[148:151]
  v_mfma_f32_16x16x32_bf16 v[144:147], v[108:111], v[48:51], v[144:147]
  ds_read_b64_tr_b16 v[96:97], v6 offset:8192
  v_mfma_f32_16x16x32_bf16 v[144:147], v[104:107], v[32:35], v[144:147]
  ds_read_b64_tr_b16 v[98:99], v6 offset:10240
  s_nop 0
  s_waitcnt lgkmcnt(6)
  v_mfma_f32_16x16x32_bf16 v[160:163], v[112:115], v[32:35], v[160:163]
  ds_read_b64_tr_b16 v[100:101], v6 offset:12288
  v_mfma_f32_16x16x32_bf16 v[160:163], v[116:119], v[48:51], v[160:163]
  ds_read_b64_tr_b16 v[102:103], v6 offset:14336
  v_mfma_f32_16x16x32_bf16 v[164:167], v[116:119], v[52:55], v[164:167]
  v_mfma_f32_16x16x32_bf16 v[164:167], v[112:115], v[36:39], v[164:167]
  v_mfma_f32_16x16x32_bf16 v[168:171], v[112:115], v[40:43], v[168:171]
  ds_read_b64_tr_b16 v[104:105], v7 offset:8192
  v_mfma_f32_16x16x32_bf16 v[168:171], v[116:119], v[56:59], v[168:171]
  ds_read_b64_tr_b16 v[106:107], v7 offset:10240
  v_mfma_f32_16x16x32_bf16 v[172:175], v[116:119], v[60:63], v[172:175]
  ds_read_b64_tr_b16 v[108:109], v7 offset:12288
  v_mfma_f32_16x16x32_bf16 v[172:175], v[112:115], v[44:47], v[172:175]
  ds_read_b64_tr_b16 v[110:111], v7 offset:14336
  s_waitcnt lgkmcnt(8)
  v_mfma_f32_16x16x32_bf16 v[188:191], v[120:123], v[44:47], v[188:191]
  v_add_u32 v6, s23, v6
  v_add_u32_e64 v7, s23, v7
  v_mfma_f32_16x16x32_bf16 v[188:191], v[124:127], v[60:63], v[188:191]
  ds_read_b64_tr_b16 v[112:113], v10 offset:0
  v_mfma_f32_16x16x32_bf16 v[184:187], v[124:127], v[56:59], v[184:187]
  ds_read_b64_tr_b16 v[114:115], v10 offset:1024
  v_mfma_f32_16x16x32_bf16 v[184:187], v[120:123], v[40:43], v[184:187]
  ds_read_b64_tr_b16 v[116:117], v10 offset:2048
  v_mfma_f32_16x16x32_bf16 v[180:183], v[120:123], v[36:39], v[180:183]
  ds_read_b64_tr_b16 v[118:119], v10 offset:3072
  v_mfma_f32_16x16x32_bf16 v[180:183], v[124:127], v[52:55], v[180:183]
  v_add_u32 v8, s23, v8
  v_add_u32 v9, s23, v9
  v_mfma_f32_16x16x32_bf16 v[176:179], v[124:127], v[48:51], v[176:179]
  v_add_u32 v10, s23, v10
  v_mfma_f32_16x16x32_bf16 v[176:179], v[120:123], v[32:35], v[176:179]
  s_waitcnt lgkmcnt(0)
  s_cbranch_vccnz Lo_27
  s_barrier
Lo_27:
  v_mfma_f32_16x16x32_bf16 v[192:195], v[96:99], v[32:35], v[192:195]
  ds_read_b128 v[64:67], v4 offset:0
  v_mfma_f32_16x16x32_bf16 v[192:195], v[100:103], v[48:51], v[192:195]
  ds_read_b128 v[80:83], v5 offset:0
  v_mfma_f32_16x16x32_bf16 v[196:199], v[100:103], v[52:55], v[196:199]
  v_mfma_f32_16x16x32_bf16 v[196:199], v[96:99], v[36:39], v[196:199]
  ds_read_b128 v[68:71], v4 offset:2048
  v_mfma_f32_16x16x32_bf16 v[200:203], v[96:99], v[40:43], v[200:203]
  ds_read_b128 v[84:87], v5 offset:2048
  v_mfma_f32_16x16x32_bf16 v[200:203], v[100:103], v[56:59], v[200:203]
  v_mfma_f32_16x16x32_bf16 v[204:207], v[100:103], v[60:63], v[204:207]
  ds_read_b128 v[72:75], v4 offset:4096
  v_mfma_f32_16x16x32_bf16 v[204:207], v[96:99], v[44:47], v[204:207]
  ds_read_b128 v[88:91], v5 offset:4096
  v_mfma_f32_16x16x32_bf16 v[220:223], v[104:107], v[44:47], v[220:223]
  ds_read_b64_tr_b16 v[96:97], v6 offset:0
  v_mfma_f32_16x16x32_bf16 v[220:223], v[108:111], v[60:63], v[220:223]
  ds_read_b64_tr_b16 v[98:99], v6 offset:2048
  v_mfma_f32_16x16x32_bf16 v[216:219], v[108:111], v[56:59], v[216:219]
  ds_read_b64_tr_b16 v[100:101], v6 offset:4096
  v_mfma_f32_16x16x32_bf16 v[216:219], v[104:107], v[40:43], v[216:219]
  ds_read_b64_tr_b16 v[102:103], v6 offset:6144
  v_mfma_f32_16x16x32_bf16 v[212:215], v[104:107], v[36:39], v[212:215]
  ds_read_b128 v[76:79], v4 offset:6144
  v_mfma_f32_16x16x32_bf16 v[212:215], v[108:111], v[52:55], v[212:215]
  v_mfma_f32_16x16x32_bf16 v[208:211], v[108:111], v[48:51], v[208:211]
  ds_read_b128 v[92:95], v5 offset:6144
  v_mfma_f32_16x16x32_bf16 v[208:211], v[104:107], v[32:35], v[208:211]
  v_mfma_f32_16x16x32_bf16 v[224:227], v[112:115], v[32:35], v[224:227]
  ds_read_b64_tr_b16 v[104:105], v7 offset:0
  v_mfma_f32_16x16x32_bf16 v[224:227], v[116:119], v[48:51], v[224:227]
  v_mfma_f32_16x16x32_bf16 v[228:231], v[116:119], v[52:55], v[228:231]
  ds_read_b64_tr_b16 v[106:107], v7 offset:2048
  v_mfma_f32_16x16x32_bf16 v[228:231], v[112:115], v[36:39], v[228:231]
  v_mfma_f32_16x16x32_bf16 v[232:235], v[112:115], v[40:43], v[232:235]
  ds_read_b64_tr_b16 v[108:109], v7 offset:4096
  v_mfma_f32_16x16x32_bf16 v[232:235], v[116:119], v[56:59], v[232:235]
  v_mfma_f32_16x16x32_bf16 v[236:239], v[116:119], v[60:63], v[236:239]
  ds_read_b64_tr_b16 v[110:111], v7 offset:6144
  s_waitcnt lgkmcnt(6)
  v_mfma_f32_16x16x32_bf16 v[236:239], v[112:115], v[44:47], v[236:239]
  s_cbranch_vccnz Lo_26
Lk_23:
  v_mfma_f32_16x16x32_bf16 v[128:131], v[96:99], v[64:67], v[128:131]
  ds_read_b64_tr_b16 v[112:113], v8 offset:0
  v_mfma_f32_16x16x32_bf16 v[128:131], v[100:103], v[80:83], v[128:131]
  ds_read_b64_tr_b16 v[114:115], v8 offset:2048
  v_mfma_f32_16x16x32_bf16 v[132:135], v[100:103], v[84:87], v[132:135]
  ds_read_b64_tr_b16 v[116:117], v8 offset:4096
  v_mfma_f32_16x16x32_bf16 v[132:135], v[96:99], v[68:71], v[132:135]
  ds_read_b64_tr_b16 v[118:119], v8 offset:6144
  v_mfma_f32_16x16x32_bf16 v[136:139], v[96:99], v[72:75], v[136:139]
  s_add_u32 s16, s16, s17
  s_cmp_eq_u32 s16, 65536
  s_cselect_b32 s23, s18, s17
  s_cselect_b32 s16, Lz1-Lz0+0, s16
  v_mfma_f32_16x16x32_bf16 v[136:139], v[100:103], v[88:91], v[136:139]
  v_add_u32_e64 v4, s23, v4
  v_add_u32 v5, s23, v5
  s_add_u32 s19, s19, s20
  s_cmp_eq_u32 s19, 86016
  s_waitcnt lgkmcnt(8)
  v_mfma_f32_16x16x32_bf16 v[140:143], v[100:103], v[92:95], v[140:143]
  s_cselect_b32 s23, s21, s20
  s_cselect_b32 s19, 0, s19
  v_mfma_f32_16x16x32_bf16 v[140:143], v[96:99], v[76:79], v[140:143]
  s_waitcnt lgkmcnt(4)
  v_mfma_f32_16x16x32_bf16 v[156:159], v[104:107], v[76:79], v[156:159]
  ds_read_b64_tr_b16 v[120:121], v9 offset:0
  v_mfma_f32_16x16x32_bf16 v[156:159], v[108:111], v[92:95], v[156:159]
  ds_read_b64_tr_b16 v[122:123], v9 offset:2048
  v_mfma_f32_16x16x32_bf16 v[152:155], v[108:111], v[88:91], v[152:155]
  ds_read_b64_tr_b16 v[124:125], v9 offset:4096
  v_mfma_f32_16x16x32_bf16 v[152:155], v[104:107], v[72:75], v[152:155]
  ds_read_b64_tr_b16 v[126:127], v9 offset:6144
  v_mfma_f32_16x16x32_bf16 v[148:151], v[104:107], v[68:71], v[148:151]
  s_sub_u32 s22, s22, 1
  s_cmp_lg_u32 s22, 0
  v_mfma_f32_16x16x32_bf16 v[148:151], v[108:111], v[84:87], v[148:151]
  v_mfma_f32_16x16x32_bf16 v[144:147], v[108:111], v[80:83], v[144:147]
  ds_read_b64_tr_b16 v[96:97], v6 offset:8192
  v_mfma_f32_16x16x32_bf16 v[144:147], v[104:107], v[64:67], v[144:147]
  ds_read_b64_tr_b16 v[98:99], v6 offset:10240
  s_nop 0
  s_waitcnt lgkmcnt(6)
  v_mfma_f32_16x16x32_bf16 v[160:163], v[112:115], v[64:67], v[160:163]
  ds_read_b64_tr_b16 v[100:101], v6 offset:12288
  v_mfma_f32_16x16x32_bf16 v[160:163], v[116:119], v[80:83], v[160:163]
  ds_read_b64_tr_b16 v[102:103], v6 offset:14336
  v_mfma_f32_16x16x32_bf16 v[164:167], v[116:119], v[84:87], v[164:167]
  v_mfma_f32_16x16x32_bf16 v[164:167], v[112:115], v[68:71], v[164:167]
  v_mfma_f32_16x16x32_bf16 v[168:171], v[112:115], v[72:75], v[168:171]
  ds_read_b64_tr_b16 v[104:105], v7 offset:8192
  v_mfma_f32_16x16x32_bf16 v[168:171], v[116:119], v[88:91], v[168:171]
  ds_read_b64_tr_b16 v[106:107], v7 offset:10240
  v_mfma_f32_16x16x32_bf16 v[172:175], v[116:119], v[92:95], v[172:175]
  ds_read_b64_tr_b16 v[108:109], v7 offset:12288
  v_mfma_f32_16x16x32_bf16 v[172:175], v[112:115], v[76:79], v[172:175]
  ds_read_b64_tr_b16 v[110:111], v7 offset:14336
  s_waitcnt lgkmcnt(8)
  v_mfma_f32_16x16x32_bf16 v[188:191], v[120:123], v[76:79], v[188:191]
  v_add_u32 v6, s23, v6
  v_add_u32_e64 v7, s23, v7
  v_mfma_f32_16x16x32_bf16 v[188:191], v[124:127], v[92:95], v[188:191]
  ds_read_b64_tr_b16 v[112:113], v10 offset:0
  v_mfma_f32_16x16x32_bf16 v[184:187], v[124:127], v[88:91], v[184:187]
  ds_read_b64_tr_b16 v[114:115], v10 offset:1024
  v_mfma_f32_16x16x32_bf16 v[184:187], v[120:123], v[72:75], v[184:187]
  ds_read_b64_tr_b16 v[116:117], v10 offset:2048
  v_mfma_f32_16x16x32_bf16 v[180:183], v[120:123], v[68:71], v[180:183]
  ds_read_b64_tr_b16 v[118:119], v10 offset:3072
  v_mfma_f32_16x16x32_bf16 v[180:183], v[124:127], v[84:87], v[180:183]
  v_add_u32 v8, s23, v8
  v_add_u32 v9, s23, v9
  v_mfma_f32_16x16x32_bf16 v[176:179], v[124:127], v[80:83], v[176:179]
  v_add_u32 v10, s23, v10
  v_mfma_f32_16x16x32_bf16 v[176:179], v[120:123], v[64:67], v[176:179]
  s_waitcnt lgkmcnt(0)
  s_barrier
  s_cbranch_scc0 Lk_24
  v_mfma_f32_16x16x32_bf16 v[192:195], v[96:99], v[64:67], v[192:195]
  ds_read_b128 v[32:35], v4 offset:0
  v_mfma_f32_16x16x32_bf16 v[192:195], v[100:103], v[80:83], v[192:195]
  ds_read_b128 v[48:51], v5 offset:0
  v_mfma_f32_16x16x32_bf16 v[196:199], v[100:103], v[84:87], v[196:199]
  v_mfma_f32_16x16x32_bf16 v[196:199], v[96:99], v[68:71], v[196:199]
  ds_read_b128 v[36:39], v4 offset:2048
  v_mfma_f32_16x16x32_bf16 v[200:203], v[96:99], v[72:75], v[200:203]
  ds_read_b128 v[52:55], v5 offset:2048
  v_mfma_f32_16x16x32_bf16 v[200:203], v[100:103], v[88:91], v[200:203]
  v_mfma_f32_16x16x32_bf16 v[204:207], v[100:103], v[92:95], v[204:207]
  ds_read_b128 v[40:43], v4 offset:4096
  v_mfma_f32_16x16x32_bf16 v[204:207], v[96:99], v[76:79], v[204:207]
  ds_read_b128 v[56:59], v5 offset:4096
  v_mfma_f32_16x16x32_bf16 v[220:223], v[104:107], v[76:79], v[220:223]
  ds_read_b64_tr_b16 v[96:97], v6 offset:0
  v_mfma_f32_16x16x32_bf16 v[220:223], v[108:111], v[92:95], v[220:223]
  ds_read_b64_tr_b16 v[98:99], v6 offset:2048
  v_mfma_f32_16x16x32_bf16 v[216:219], v[108:111], v[88:91], v[216:219]
  ds_read_b64_tr_b16 v[100:101], v6 offset:4096
  v_mfma_f32_16x16x32_bf16 v[216:219], v[104:107], v[72:75], v[216:219]
  ds_read_b64_tr_b16 v[102:103], v6 offset:6144
  v_mfma_f32_16x16x32_bf16 v[212:215], v[104:107], v[68:71], v[212:215]
  ds_read_b128 v[44:47], v4 offset:6144
  v_mfma_f32_16x16x32_bf16 v[212:215], v[108:111], v[84:87], v[212:215]
  v_mfma_f32_16x16x32_bf16 v[208:211], v[108:111], v[80:83], v[208:211]
  ds_read_b128 v[60:63], v5 offset:6144
  v_mfma_f32_16x16x32_bf16 v[208:211], v[104:107], v[64:67], v[208:211]
  v_mfma_f32_16x16x32_bf16 v[224:227], v[112:115], v[64:67], v[224:227]
  ds_read_b64_tr_b16 v[104:105], v7 offset:0
  v_mfma_f32_16x16x32_bf16 v[224:227], v[116:119], v[80:83], v[224:227]
  v_mfma_f32_16x16x32_bf16 v[228:231], v[116:119], v[84:87], v[228:231]
  ds_read_b64_tr_b16 v[106:107], v7 offset:2048
  v_mfma_f32_16x16x32_bf16 v[228:231], v[112:115], v[68:71], v[228:231]
  v_mfma_f32_16x16x32_bf16 v[232:235], v[112:115], v[72:75], v[232:235]
  ds_read_b64_tr_b16 v[108:109], v7 offset:4096
  v_mfma_f32_16x16x32_bf16 v[232:235], v[116:119], v[88:91], v[232:235]
  v_mfma_f32_16x16x32_bf16 v[236:239], v[116:119], v[92:95], v[236:239]
  ds_read_b64_tr_b16 v[110:111], v7 offset:6144
  s_waitcnt lgkmcnt(6)
  v_mfma_f32_16x16x32_bf16 v[236:239], v[112:115], v[76:79], v[236:239]
  s_branch Lk_22
Lk_24:
  v_mfma_f32_16x16x32_bf16 v[192:195], v[96:99], v[64:67], v[192:195]
  ds_read_b128 v[32:35], v3 offset:0
  s_mul_i32 s4, s85, 320
  v_mfma_f32_16x16x32_bf16 v[192:195], v[100:103], v[80:83], v[192:195]
  ds_read_b128 v[36:39], v3 offset:1024
  s_add_u32 s4, s4, 151552
  v_mfma_f32_16x16x32_bf16 v[196:199], v[100:103], v[84:87], v[196:199]
  ds_read_b128 v[40:43], v3 offset:64
  v_and_b32_e64 v2, 15, v1
  v_mfma_f32_16x16x32_bf16 v[196:199], v[96:99], v[68:71], v[196:199]
  ds_read_b128 v[44:47], v3 offset:1088
  v_lshl_add_u32 v7, v2, 2, s4
  v_mfma_f32_16x16x32_bf16 v[200:203], v[96:99], v[72:75], v[200:203]
  ds_read_b128 v[48:51], v3 offset:128
  v_mov_b32 v4, 0x409d30fc
  v_mfma_f32_16x16x32_bf16 v[200:203], v[100:103], v[88:91], v[200:203]
  ds_read_b128 v[52:55], v3 offset:1152
  v_mov_b32 v5, 0x3eeff558
  v_mfma_f32_16x16x32_bf16 v[204:207], v[100:103], v[92:95], v[204:207]
  ds_read_b128 v[56:59], v3 offset:192
  v_and_b32_e64 v2, 32, v1
  v_mfma_f32_16x16x32_bf16 v[204:207], v[96:99], v[76:79], v[204:207]
  ds_read_b128 v[60:63], v3 offset:1216
  v_mad_u32_u24 v6, v2, 48, v11
  v_mfma_f32_16x16x32_bf16 v[220:223], v[104:107], v[76:79], v[220:223]
  v_mfma_f32_16x16x32_bf16 v[220:223], v[108:111], v[92:95], v[220:223]
  ds_read2_b32 v[96:97], v7 offset0:0 offset1:160
  ds_read2_b32 v[98:99], v7 offset0:16 offset1:176
  v_mfma_f32_16x16x32_bf16 v[216:219], v[108:111], v[88:91], v[216:219]
  ds_read2_b32 v[100:101], v7 offset0:32 offset1:192
  ds_read2_b32 v[102:103], v7 offset0:48 offset1:208
  v_mfma_f32_16x16x32_bf16 v[216:219], v[104:107], v[72:75], v[216:219]
  s_lshl_b32 s5, s86, Lz1-Lz0+6
  s_add_u32 s5, s5, 154880
  v_mfma_f32_16x16x32_bf16 v[212:215], v[104:107], v[68:71], v[212:215]
  v_add_u32_e64 v2, s5, v29
  v_mfma_f32_16x16x32_bf16 v[212:215], v[108:111], v[84:87], v[212:215]
  v_mfma_f32_16x16x32_bf16 v[208:211], v[108:111], v[80:83], v[208:211]
  v_mfma_f32_16x16x32_bf16 v[208:211], v[104:107], v[64:67], v[208:211]
  v_mfma_f32_16x16x32_bf16 v[224:227], v[112:115], v[64:67], v[224:227]
  v_mfma_f32_16x16x32_bf16 v[224:227], v[116:119], v[80:83], v[224:227]
  v_mfma_f32_16x16x32_bf16 v[228:231], v[116:119], v[84:87], v[228:231]
  v_mfma_f32_16x16x32_bf16 v[228:231], v[112:115], v[68:71], v[228:231]
  s_waitcnt lgkmcnt(0)
  v_mul_f32 v96, v5, v96
  v_mul_f32_e64 v98, v5, v98
  v_mfma_f32_16x16x32_bf16 v[232:235], v[112:115], v[72:75], v[232:235]
  v_mul_f32 v100, v5, v100
  v_mul_f32 v102, v5, v102
  v_mfma_f32_16x16x32_bf16 v[232:235], v[116:119], v[88:91], v[232:235]
  v_mfma_f32_16x16x32_bf16 v[236:239], v[116:119], v[92:95], v[236:239]
  v_mfma_f32_16x16x32_bf16 v[236:239], v[112:115], v[76:79], v[236:239]
  ds_read_b128 v[80:83], v2 offset:0
  ds_read_b128 v[84:87], v2 offset:1024
  ds_read_b128 v[64:67], v3 offset:256
  ds_read_b128 v[68:71], v3 offset:1280
  ds_read_b128 v[72:75], v3 offset:320
  ds_read_b128 v[76:79], v3 offset:1344
  v_pk_fma_f32 v[128:129], v[32:33], v[96:97], v[128:129] op_sel:[0,1,0] op_sel_hi:[1,1,1] neg_lo:[0,1,0] neg_hi:[0,1,0]
  v_pk_fma_f32 v[130:131], v[34:35], v[96:97], v[130:131] op_sel:[0,1,0] op_sel_hi:[1,1,1] neg_lo:[0,1,0] neg_hi:[0,1,0]
  v_pk_fma_f32 v[144:145], v[40:41], v[96:97], v[144:145] op_sel:[0,1,0] op_sel_hi:[1,1,1] neg_lo:[0,1,0] neg_hi:[0,1,0]
  v_pk_fma_f32 v[146:147], v[42:43], v[96:97], v[146:147] op_sel:[0,1,0] op_sel_hi:[1,1,1] neg_lo:[0,1,0] neg_hi:[0,1,0]
  v_pk_fma_f32 v[128:129], v[128:129], v[96:97], v[36:37] op_sel:[0,0,0] op_sel_hi:[1,0,1]
  v_pk_fma_f32 v[130:131], v[130:131], v[96:97], v[38:39] op_sel:[0,0,0] op_sel_hi:[1,0,1]
  v_pk_fma_f32 v[144:145], v[144:145], v[96:97], v[44:45] op_sel:[0,0,0] op_sel_hi:[1,0,1]
  v_pk_fma_f32 v[146:147], v[146:147], v[96:97], v[46:47] op_sel:[0,0,0] op_sel_hi:[1,0,1]
  v_pk_fma_f32 v[104:105], v[128:129], v[128:129], v[4:5] op_sel_hi:[1,1,0]
  v_pk_fma_f32 v[106:107], v[130:131], v[130:131], v[4:5] op_sel_hi:[1,1,0]
  v_pk_fma_f32 v[108:109], v[144:145], v[144:145], v[4:5] op_sel_hi:[1,1,0]
  v_pk_fma_f32 v[110:111], v[146:147], v[146:147], v[4:5] op_sel_hi:[1,1,0]
  v_pk_mul_f32 v[104:105], v[104:105], v[128:129] neg_lo:[0,1] neg_hi:[0,1]
  v_pk_mul_f32 v[106:107], v[106:107], v[130:131] neg_lo:[0,1] neg_hi:[0,1]
  v_pk_mul_f32 v[108:109], v[108:109], v[144:145] neg_lo:[0,1] neg_hi:[0,1]
  v_pk_mul_f32 v[110:111], v[110:111], v[146:147] neg_lo:[0,1] neg_hi:[0,1]
  v_exp_f32 v104, v104
  v_exp_f32 v105, v105
  v_exp_f32 v106, v106
  v_exp_f32 v107, v107
  v_exp_f32 v108, v108
  v_exp_f32 v109, v109
  v_exp_f32 v110, v110
  v_exp_f32 v111, v111
  v_pk_fma_f32 v[104:105], v[104:105], v[4:5], v[4:5] op_sel:[0,1,1] op_sel_hi:[1,1,1]
  v_pk_fma_f32 v[106:107], v[106:107], v[4:5], v[4:5] op_sel:[0,1,1] op_sel_hi:[1,1,1]
  v_pk_fma_f32 v[108:109], v[108:109], v[4:5], v[4:5] op_sel:[0,1,1] op_sel_hi:[1,1,1]
  v_pk_fma_f32 v[110:111], v[110:111], v[4:5], v[4:5] op_sel:[0,1,1] op_sel_hi:[1,1,1]
  v_rcp_f32 v104, v104
  v_rcp_f32 v105, v105
  v_rcp_f32 v106, v106
  v_rcp_f32 v107, v107
  v_rcp_f32 v108, v108
  v_rcp_f32 v109, v109
  v_rcp_f32 v110, v110
  v_rcp_f32 v111, v111
  v_pk_mul_f32 v[128:129], v[128:129], v[104:105]
  v_pk_mul_f32 v[130:131], v[130:131], v[106:107]
  v_pk_mul_f32 v[144:145], v[144:145], v[108:109]
  v_pk_mul_f32 v[146:147], v[146:147], v[110:111]
  v_cvt_pk_bf16_f32 v116, v128, v129
  v_cvt_pk_bf16_f32 v117, v130, v131
  v_cvt_pk_bf16_f32 v118, v144, v145
  v_cvt_pk_bf16_f32 v119, v146, v147
  buffer_store_dwordx4 v[116:119], v0, s[40:43], s6 offen offset:0 sc0 sc1
  ds_write_b128 v0, v[116:119] offset:0
  v_pk_fma_f32 v[132:133], v[32:33], v[98:99], v[132:133] op_sel:[0,1,0] op_sel_hi:[1,1,1] neg_lo:[0,1,0] neg_hi:[0,1,0]
  v_pk_fma_f32 v[134:135], v[34:35], v[98:99], v[134:135] op_sel:[0,1,0] op_sel_hi:[1,1,1] neg_lo:[0,1,0] neg_hi:[0,1,0]
  v_pk_fma_f32 v[148:149], v[40:41], v[98:99], v[148:149] op_sel:[0,1,0] op_sel_hi:[1,1,1] neg_lo:[0,1,0] neg_hi:[0,1,0]
  v_pk_fma_f32 v[150:151], v[42:43], v[98:99], v[150:151] op_sel:[0,1,0] op_sel_hi:[1,1,1] neg_lo:[0,1,0] neg_hi:[0,1,0]
  v_pk_fma_f32 v[132:133], v[132:133], v[98:99], v[36:37] op_sel:[0,0,0] op_sel_hi:[1,0,1]
  v_pk_fma_f32 v[134:135], v[134:135], v[98:99], v[38:39] op_sel:[0,0,0] op_sel_hi:[1,0,1]
  v_pk_fma_f32 v[148:149], v[148:149], v[98:99], v[44:45] op_sel:[0,0,0] op_sel_hi:[1,0,1]
  v_pk_fma_f32 v[150:151], v[150:151], v[98:99], v[46:47] op_sel:[0,0,0] op_sel_hi:[1,0,1]
  v_pk_fma_f32 v[104:105], v[132:133], v[132:133], v[4:5] op_sel_hi:[1,1,0]
  v_pk_fma_f32 v[106:107], v[134:135], v[134:135], v[4:5] op_sel_hi:[1,1,0]
  v_pk_fma_f32 v[108:109], v[148:149], v[148:149], v[4:5] op_sel_hi:[1,1,0]
  v_pk_fma_f32 v[110:111], v[150:151], v[150:151], v[4:5] op_sel_hi:[1,1,0]
  v_pk_mul_f32 v[104:105], v[104:105], v[132:133] neg_lo:[0,1] neg_hi:[0,1]
  v_pk_mul_f32 v[106:107], v[106:107], v[134:135] neg_lo:[0,1] neg_hi:[0,1]
  v_pk_mul_f32 v[108:109], v[108:109], v[148:149] neg_lo:[0,1] neg_hi:[0,1]
  v_pk_mul_f32 v[110:111], v[110:111], v[150:151] neg_lo:[0,1] neg_hi:[0,1]
  v_exp_f32 v104, v104
  v_exp_f32 v105, v105
  v_exp_f32 v106, v106
  v_exp_f32 v107, v107
  v_exp_f32 v108, v108
  v_exp_f32 v109, v109
  v_exp_f32 v110, v110
  v_exp_f32 v111, v111
  v_pk_fma_f32 v[104:105], v[104:105], v[4:5], v[4:5] op_sel:[0,1,1] op_sel_hi:[1,1,1]
  v_pk_fma_f32 v[106:107], v[106:107], v[4:5], v[4:5] op_sel:[0,1,1] op_sel_hi:[1,1,1]
  v_pk_fma_f32 v[108:109], v[108:109], v[4:5], v[4:5] op_sel:[0,1,1] op_sel_hi:[1,1,1]
  v_pk_fma_f32 v[110:111], v[110:111], v[4:5], v[4:5] op_sel:[0,1,1] op_sel_hi:[1,1,1]
  v_rcp_f32 v104, v104
  v_rcp_f32 v105, v105
  v_rcp_f32 v106, v106
  v_rcp_f32 v107, v107
  v_rcp_f32 v108, v108
  v_rcp_f32 v109, v109
  v_rcp_f32 v110, v110
  v_rcp_f32 v111, v111
  v_pk_mul_f32 v[132:133], v[132:133], v[104:105]
  v_pk_mul_f32 v[134:135], v[134:135], v[106:107]
  v_pk_mul_f32 v[148:149], v[148:149], v[108:109]
  v_pk_mul_f32 v[150:151], v[150:151], v[110:111]
  v_cvt_pk_bf16_f32 v120, v132, v133
  v_cvt_pk_bf16_f32 v121, v134, v135
  v_cvt_pk_bf16_f32 v122, v148, v149
  v_cvt_pk_bf16_f32 v123, v150, v151
  buffer_store_dwordx4 v[120:123], v0, s[40:43], s6 offen offset:2048 sc0 sc1
  ds_write_b128 v0, v[120:123] offset:2048
  s_add_u32 s6, s6, 0x20000
  v_pk_fma_f32 v[136:137], v[32:33], v[100:101], v[136:137] op_sel:[0,1,0] op_sel_hi:[1,1,1] neg_lo:[0,1,0] neg_hi:[0,1,0]
  v_pk_fma_f32 v[138:139], v[34:35], v[100:101], v[138:139] op_sel:[0,1,0] op_sel_hi:[1,1,1] neg_lo:[0,1,0] neg_hi:[0,1,0]
  v_pk_fma_f32 v[152:153], v[40:41], v[100:101], v[152:153] op_sel:[0,1,0] op_sel_hi:[1,1,1] neg_lo:[0,1,0] neg_hi:[0,1,0]
  v_pk_fma_f32 v[154:155], v[42:43], v[100:101], v[154:155] op_sel:[0,1,0] op_sel_hi:[1,1,1] neg_lo:[0,1,0] neg_hi:[0,1,0]
  v_pk_fma_f32 v[136:137], v[136:137], v[100:101], v[36:37] op_sel:[0,0,0] op_sel_hi:[1,0,1]
  v_pk_fma_f32 v[138:139], v[138:139], v[100:101], v[38:39] op_sel:[0,0,0] op_sel_hi:[1,0,1]
  v_pk_fma_f32 v[152:153], v[152:153], v[100:101], v[44:45] op_sel:[0,0,0] op_sel_hi:[1,0,1]
  v_pk_fma_f32 v[154:155], v[154:155], v[100:101], v[46:47] op_sel:[0,0,0] op_sel_hi:[1,0,1]
  v_pk_fma_f32 v[104:105], v[136:137], v[136:137], v[4:5] op_sel_hi:[1,1,0]
  v_pk_fma_f32 v[106:107], v[138:139], v[138:139], v[4:5] op_sel_hi:[1,1,0]
  v_pk_fma_f32 v[108:109], v[152:153], v[152:153], v[4:5] op_sel_hi:[1,1,0]
  v_pk_fma_f32 v[110:111], v[154:155], v[154:155], v[4:5] op_sel_hi:[1,1,0]
  v_pk_mul_f32 v[104:105], v[104:105], v[136:137] neg_lo:[0,1] neg_hi:[0,1]
  v_pk_mul_f32 v[106:107], v[106:107], v[138:139] neg_lo:[0,1] neg_hi:[0,1]
  v_pk_mul_f32 v[108:109], v[108:109], v[152:153] neg_lo:[0,1] neg_hi:[0,1]
  v_pk_mul_f32 v[110:111], v[110:111], v[154:155] neg_lo:[0,1] neg_hi:[0,1]
  v_exp_f32 v104, v104
  v_exp_f32 v105, v105
  v_exp_f32 v106, v106
  v_exp_f32 v107, v107
  v_exp_f32 v108, v108
  v_exp_f32 v109, v109
  v_exp_f32 v110, v110
  v_exp_f32 v111, v111
  v_pk_fma_f32 v[104:105], v[104:105], v[4:5], v[4:5] op_sel:[0,1,1] op_sel_hi:[1,1,1]
  v_pk_fma_f32 v[106:107], v[106:107], v[4:5], v[4:5] op_sel:[0,1,1] op_sel_hi:[1,1,1]
  v_pk_fma_f32 v[108:109], v[108:109], v[4:5], v[4:5] op_sel:[0,1,1] op_sel_hi:[1,1,1]
  v_pk_fma_f32 v[110:111], v[110:111], v[4:5], v[4:5] op_sel:[0,1,1] op_sel_hi:[1,1,1]
  v_rcp_f32 v104, v104
  v_rcp_f32 v105, v105
  v_rcp_f32 v106, v106
  v_rcp_f32 v107, v107
  v_rcp_f32 v108, v108
  v_rcp_f32 v109, v109
  v_rcp_f32 v110, v110
  v_rcp_f32 v111, v111
  v_pk_mul_f32 v[136:137], v[136:137], v[104:105]
  v_pk_mul_f32 v[138:139], v[138:139], v[106:107]
  v_pk_mul_f32 v[152:153], v[152:153], v[108:109]
  v_pk_mul_f32 v[154:155], v[154:155], v[110:111]
  v_cvt_pk_bf16_f32 v116, v136, v137
  v_cvt_pk_bf16_f32 v117, v138, v139
  v_cvt_pk_bf16_f32 v118, v152, v153
  v_cvt_pk_bf16_f32 v119, v154, v155
  buffer_store_dwordx4 v[116:119], v0, s[40:43], s7 offen offset:0 sc0 sc1
  ds_write_b128 v0, v[116:119] offset:4096
  v_pk_fma_f32 v[140:141], v[32:33], v[102:103], v[140:141] op_sel:[0,1,0] op_sel_hi:[1,1,1] neg_lo:[0,1,0] neg_hi:[0,1,0]
  v_pk_fma_f32 v[142:143], v[34:35], v[102:103], v[142:143] op_sel:[0,1,0] op_sel_hi:[1,1,1] neg_lo:[0,1,0] neg_hi:[0,1,0]
  v_pk_fma_f32 v[156:157], v[40:41], v[102:103], v[156:157] op_sel:[0,1,0] op_sel_hi:[1,1,1] neg_lo:[0,1,0] neg_hi:[0,1,0]
  v_pk_fma_f32 v[158:159], v[42:43], v[102:103], v[158:159] op_sel:[0,1,0] op_sel_hi:[1,1,1] neg_lo:[0,1,0] neg_hi:[0,1,0]
  v_pk_fma_f32 v[140:141], v[140:141], v[102:103], v[36:37] op_sel:[0,0,0] op_sel_hi:[1,0,1]
  v_pk_fma_f32 v[142:143], v[142:143], v[102:103], v[38:39] op_sel:[0,0,0] op_sel_hi:[1,0,1]
  v_pk_fma_f32 v[156:157], v[156:157], v[102:103], v[44:45] op_sel:[0,0,0] op_sel_hi:[1,0,1]
  v_pk_fma_f32 v[158:159], v[158:159], v[102:103], v[46:47] op_sel:[0,0,0] op_sel_hi:[1,0,1]
  v_pk_fma_f32 v[104:105], v[140:141], v[140:141], v[4:5] op_sel_hi:[1,1,0]
  v_pk_fma_f32 v[106:107], v[142:143], v[142:143], v[4:5] op_sel_hi:[1,1,0]
  v_pk_fma_f32 v[108:109], v[156:157], v[156:157], v[4:5] op_sel_hi:[1,1,0]
  v_pk_fma_f32 v[110:111], v[158:159], v[158:159], v[4:5] op_sel_hi:[1,1,0]
  v_pk_mul_f32 v[104:105], v[104:105], v[140:141] neg_lo:[0,1] neg_hi:[0,1]
  v_pk_mul_f32 v[106:107], v[106:107], v[142:143] neg_lo:[0,1] neg_hi:[0,1]
  v_pk_mul_f32 v[108:109], v[108:109], v[156:157] neg_lo:[0,1] neg_hi:[0,1]
  v_pk_mul_f32 v[110:111], v[110:111], v[158:159] neg_lo:[0,1] neg_hi:[0,1]
  v_exp_f32 v104, v104
  v_exp_f32 v105, v105
  v_exp_f32 v106, v106
  v_exp_f32 v107, v107
  v_exp_f32 v108, v108
  v_exp_f32 v109, v109
  v_exp_f32 v110, v110
  v_exp_f32 v111, v111
  v_pk_fma_f32 v[104:105], v[104:105], v[4:5], v[4:5] op_sel:[0,1,1] op_sel_hi:[1,1,1]
  v_pk_fma_f32 v[106:107], v[106:107], v[4:5], v[4:5] op_sel:[0,1,1] op_sel_hi:[1,1,1]
  v_pk_fma_f32 v[108:109], v[108:109], v[4:5], v[4:5] op_sel:[0,1,1] op_sel_hi:[1,1,1]
  v_pk_fma_f32 v[110:111], v[110:111], v[4:5], v[4:5] op_sel:[0,1,1] op_sel_hi:[1,1,1]
  v_rcp_f32 v104, v104
  v_rcp_f32 v105, v105
  v_rcp_f32 v106, v106
  v_rcp_f32 v107, v107
  v_rcp_f32 v108, v108
  v_rcp_f32 v109, v109
  v_rcp_f32 v110, v110
  v_rcp_f32 v111, v111
  v_pk_mul_f32 v[140:141], v[140:141], v[104:105]
  v_pk_mul_f32 v[142:143], v[142:143], v[106:107]
  v_pk_mul_f32 v[156:157], v[156:157], v[108:109]
  v_pk_mul_f32 v[158:159], v[158:159], v[110:111]
  v_cvt_pk_bf16_f32 v120, v140, v141
  v_cvt_pk_bf16_f32 v121, v142, v143
  v_cvt_pk_bf16_f32 v122, v156, v157
  v_cvt_pk_bf16_f32 v123, v158, v159
  buffer_store_dwordx4 v[120:123], v0, s[40:43], s7 offen offset:2048 sc0 sc1
  ds_write_b128 v0, v[120:123] offset:6144
  s_add_u32 s7, s7, 0x20000
  s_nop 0
  s_waitcnt lgkmcnt(0)
  v_pk_fma_f32 v[224:225], v[80:81], v[96:97], v[224:225] op_sel:[0,1,0] op_sel_hi:[1,1,1] neg_lo:[0,1,0] neg_hi:[0,1,0]
  v_pk_fma_f32 v[226:227], v[82:83], v[96:97], v[226:227] op_sel:[0,1,0] op_sel_hi:[1,1,1] neg_lo:[0,1,0] neg_hi:[0,1,0]
  v_pk_fma_f32 v[228:229], v[80:81], v[98:99], v[228:229] op_sel:[0,1,0] op_sel_hi:[1,1,1] neg_lo:[0,1,0] neg_hi:[0,1,0]
  v_pk_fma_f32 v[230:231], v[82:83], v[98:99], v[230:231] op_sel:[0,1,0] op_sel_hi:[1,1,1] neg_lo:[0,1,0] neg_hi:[0,1,0]
  v_pk_fma_f32 v[224:225], v[224:225], v[96:97], v[84:85] op_sel:[0,0,0] op_sel_hi:[1,0,1]
  v_pk_fma_f32 v[226:227], v[226:227], v[96:97], v[86:87] op_sel:[0,0,0] op_sel_hi:[1,0,1]
  v_pk_fma_f32 v[228:229], v[228:229], v[98:99], v[84:85] op_sel:[0,0,0] op_sel_hi:[1,0,1]
  v_pk_fma_f32 v[230:231], v[230:231], v[98:99], v[86:87] op_sel:[0,0,0] op_sel_hi:[1,0,1]
  v_pk_fma_f32 v[104:105], v[224:225], v[224:225], v[4:5] op_sel_hi:[1,1,0]
  v_pk_fma_f32 v[106:107], v[226:227], v[226:227], v[4:5] op_sel_hi:[1,1,0]
  v_pk_fma_f32 v[108:109], v[228:229], v[228:229], v[4:5] op_sel_hi:[1,1,0]
  v_pk_fma_f32 v[110:111], v[230:231], v[230:231], v[4:5] op_sel_hi:[1,1,0]
  v_pk_mul_f32 v[104:105], v[104:105], v[224:225] neg_lo:[0,1] neg_hi:[0,1]
  v_pk_mul_f32 v[106:107], v[106:107], v[226:227] neg_lo:[0,1] neg_hi:[0,1]
  v_pk_mul_f32 v[108:109], v[108:109], v[228:229] neg_lo:[0,1] neg_hi:[0,1]
  v_pk_mul_f32 v[110:111], v[110:111], v[230:231] neg_lo:[0,1] neg_hi:[0,1]
  v_exp_f32 v104, v104
  v_exp_f32 v105, v105
  v_exp_f32 v106, v106
  v_exp_f32 v107, v107
  v_exp_f32 v108, v108
  v_exp_f32 v109, v109
  v_exp_f32 v110, v110
  v_exp_f32 v111, v111
  v_pk_fma_f32 v[104:105], v[104:105], v[4:5], v[4:5] op_sel:[0,1,1] op_sel_hi:[1,1,1]
  v_pk_fma_f32 v[106:107], v[106:107], v[4:5], v[4:5] op_sel:[0,1,1] op_sel_hi:[1,1,1]
  v_pk_fma_f32 v[108:109], v[108:109], v[4:5], v[4:5] op_sel:[0,1,1] op_sel_hi:[1,1,1]
  v_pk_fma_f32 v[110:111], v[110:111], v[4:5], v[4:5] op_sel:[0,1,1] op_sel_hi:[1,1,1]
  v_rcp_f32 v104, v104
  v_rcp_f32 v105, v105
  v_rcp_f32 v106, v106
  v_rcp_f32 v107, v107
  v_rcp_f32 v108, v108
  v_rcp_f32 v109, v109
  v_rcp_f32 v110, v110
  v_rcp_f32 v111, v111
  v_pk_mul_f32 v[224:225], v[224:225], v[104:105]
  v_pk_mul_f32 v[226:227], v[226:227], v[106:107]
  v_pk_mul_f32 v[228:229], v[228:229], v[108:109]
  v_pk_mul_f32 v[230:231], v[230:231], v[110:111]
  v_cvt_pk_bf16_f32 v116, v224, v225
  v_cvt_pk_bf16_f32 v117, v226, v227
  v_cvt_pk_bf16_f32 v118, v228, v229
  v_cvt_pk_bf16_f32 v119, v230, v231
  s_nop 0
  v_permlane32_swap_b32 v116, v118
  v_permlane32_swap_b32_e64 v117, v119
  buffer_store_dwordx4 v[116:119], v6, s[40:43], s8 offen sc0 sc1
  s_add_u32 s8, s8, 4096
  v_pk_fma_f32 v[232:233], v[80:81], v[100:101], v[232:233] op_sel:[0,1,0] op_sel_hi:[1,1,1] neg_lo:[0,1,0] neg_hi:[0,1,0]
  v_pk_fma_f32 v[234:235], v[82:83], v[100:101], v[234:235] op_sel:[0,1,0] op_sel_hi:[1,1,1] neg_lo:[0,1,0] neg_hi:[0,1,0]
  v_pk_fma_f32 v[236:237], v[80:81], v[102:103], v[236:237] op_sel:[0,1,0] op_sel_hi:[1,1,1] neg_lo:[0,1,0] neg_hi:[0,1,0]
  v_pk_fma_f32 v[238:239], v[82:83], v[102:103], v[238:239] op_sel:[0,1,0] op_sel_hi:[1,1,1] neg_lo:[0,1,0] neg_hi:[0,1,0]
  v_pk_fma_f32 v[232:233], v[232:233], v[100:101], v[84:85] op_sel:[0,0,0] op_sel_hi:[1,0,1]
  v_pk_fma_f32 v[234:235], v[234:235], v[100:101], v[86:87] op_sel:[0,0,0] op_sel_hi:[1,0,1]
  v_pk_fma_f32 v[236:237], v[236:237], v[102:103], v[84:85] op_sel:[0,0,0] op_sel_hi:[1,0,1]
  v_pk_fma_f32 v[238:239], v[238:239], v[102:103], v[86:87] op_sel:[0,0,0] op_sel_hi:[1,0,1]
  v_pk_fma_f32 v[104:105], v[232:233], v[232:233], v[4:5] op_sel_hi:[1,1,0]
  v_pk_fma_f32 v[106:107], v[234:235], v[234:235], v[4:5] op_sel_hi:[1,1,0]
  v_pk_fma_f32 v[108:109], v[236:237], v[236:237], v[4:5] op_sel_hi:[1,1,0]
  v_pk_fma_f32 v[110:111], v[238:239], v[238:239], v[4:5] op_sel_hi:[1,1,0]
  v_pk_mul_f32 v[104:105], v[104:105], v[232:233] neg_lo:[0,1] neg_hi:[0,1]
  v_pk_mul_f32 v[106:107], v[106:107], v[234:235] neg_lo:[0,1] neg_hi:[0,1]
  v_pk_mul_f32 v[108:109], v[108:109], v[236:237] neg_lo:[0,1] neg_hi:[0,1]
  v_pk_mul_f32 v[110:111], v[110:111], v[238:239] neg_lo:[0,1] neg_hi:[0,1]
  v_exp_f32 v104, v104
  v_exp_f32 v105, v105
  v_exp_f32 v106, v106
  v_exp_f32 v107, v107
  v_exp_f32 v108, v108
  v_exp_f32 v109, v109
  v_exp_f32 v110, v110
  v_exp_f32 v111, v111
  v_pk_fma_f32 v[104:105], v[104:105], v[4:5], v[4:5] op_sel:[0,1,1] op_sel_hi:[1,1,1]
  v_pk_fma_f32 v[106:107], v[106:107], v[4:5], v[4:5] op_sel:[0,1,1] op_sel_hi:[1,1,1]
  v_pk_fma_f32 v[108:109], v[108:109], v[4:5], v[4:5] op_sel:[0,1,1] op_sel_hi:[1,1,1]
  v_pk_fma_f32 v[110:111], v[110:111], v[4:5], v[4:5] op_sel:[0,1,1] op_sel_hi:[1,1,1]
  v_rcp_f32 v104, v104
  v_rcp_f32 v105, v105
  v_rcp_f32 v106, v106
  v_rcp_f32 v107, v107
  v_rcp_f32 v108, v108
  v_rcp_f32 v109, v109
  v_rcp_f32 v110, v110
  v_rcp_f32 v111, v111
  v_pk_mul_f32 v[232:233], v[232:233], v[104:105]
  v_pk_mul_f32 v[234:235], v[234:235], v[106:107]
  v_pk_mul_f32 v[236:237], v[236:237], v[108:109]
  v_pk_mul_f32 v[238:239], v[238:239], v[110:111]
  v_cvt_pk_bf16_f32 v120, v232, v233
  v_cvt_pk_bf16_f32 v121, v234, v235
  v_cvt_pk_bf16_f32 v122, v236, v237
  v_cvt_pk_bf16_f32 v123, v238, v239
  s_add_u32 s9, s87, Lz1-Lz0+8
  s_waitcnt vmcnt(1)
  s_mov_b64 exec, 1
  ds_add_rtn_u32 v124, v28, v27 offset:0
  s_mov_b64 exec, -1
  v_permlane32_swap_b32 v120, v122
  v_permlane32_swap_b32_e64 v121, v123
  buffer_store_dwordx4 v[120:123], v6, s[40:43], s8 offen sc0 sc1
  v_pk_fma_f32 v[160:161], v[48:49], v[96:97], v[160:161] op_sel:[0,1,0] op_sel_hi:[1,1,1] neg_lo:[0,1,0] neg_hi:[0,1,0]
  v_pk_fma_f32 v[162:163], v[50:51], v[96:97], v[162:163] op_sel:[0,1,0] op_sel_hi:[1,1,1] neg_lo:[0,1,0] neg_hi:[0,1,0]
  v_pk_fma_f32 v[176:177], v[56:57], v[96:97], v[176:177] op_sel:[0,1,0] op_sel_hi:[1,1,1] neg_lo:[0,1,0] neg_hi:[0,1,0]
  v_pk_fma_f32 v[178:179], v[58:59], v[96:97], v[178:179] op_sel:[0,1,0] op_sel_hi:[1,1,1] neg_lo:[0,1,0] neg_hi:[0,1,0]
  v_pk_fma_f32 v[160:161], v[160:161], v[96:97], v[52:53] op_sel:[0,0,0] op_sel_hi:[1,0,1]
  v_pk_fma_f32 v[162:163], v[162:163], v[96:97], v[54:55] op_sel:[0,0,0] op_sel_hi:[1,0,1]
  v_pk_fma_f32 v[176:177], v[176:177], v[96:97], v[60:61] op_sel:[0,0,0] op_sel_hi:[1,0,1]
  v_pk_fma_f32 v[178:179], v[178:179], v[96:97], v[62:63] op_sel:[0,0,0] op_sel_hi:[1,0,1]
  v_pk_fma_f32 v[104:105], v[160:161], v[160:161], v[4:5] op_sel_hi:[1,1,0]
  v_pk_fma_f32 v[106:107], v[162:163], v[162:163], v[4:5] op_sel_hi:[1,1,0]
  v_pk_fma_f32 v[108:109], v[176:177], v[176:177], v[4:5] op_sel_hi:[1,1,0]
  v_pk_fma_f32 v[110:111], v[178:179], v[178:179], v[4:5] op_sel_hi:[1,1,0]
  v_pk_mul_f32 v[104:105], v[104:105], v[160:161] neg_lo:[0,1] neg_hi:[0,1]
  v_pk_mul_f32 v[106:107], v[106:107], v[162:163] neg_lo:[0,1] neg_hi:[0,1]
  v_pk_mul_f32 v[108:109], v[108:109], v[176:177] neg_lo:[0,1] neg_hi:[0,1]
  v_pk_mul_f32 v[110:111], v[110:111], v[178:179] neg_lo:[0,1] neg_hi:[0,1]
  v_exp_f32 v104, v104
  v_exp_f32 v105, v105
  v_exp_f32 v106, v106
  v_exp_f32 v107, v107
  v_exp_f32 v108, v108
  v_exp_f32 v109, v109
  v_exp_f32 v110, v110
  v_exp_f32 v111, v111
  v_pk_fma_f32 v[104:105], v[104:105], v[4:5], v[4:5] op_sel:[0,1,1] op_sel_hi:[1,1,1]
  v_pk_fma_f32 v[106:107], v[106:107], v[4:5], v[4:5] op_sel:[0,1,1] op_sel_hi:[1,1,1]
  v_pk_fma_f32 v[108:109], v[108:109], v[4:5], v[4:5] op_sel:[0,1,1] op_sel_hi:[1,1,1]
  v_pk_fma_f32 v[110:111], v[110:111], v[4:5], v[4:5] op_sel:[0,1,1] op_sel_hi:[1,1,1]
  v_rcp_f32 v104, v104
  v_rcp_f32 v105, v105
  v_rcp_f32 v106, v106
  v_rcp_f32 v107, v107
  v_rcp_f32 v108, v108
  v_rcp_f32 v109, v109
  v_rcp_f32 v110, v110
  v_rcp_f32 v111, v111
  v_pk_mul_f32 v[160:161], v[160:161], v[104:105]
  v_pk_mul_f32 v[162:163], v[162:163], v[106:107]
  v_pk_mul_f32 v[176:177], v[176:177], v[108:109]
  v_pk_mul_f32 v[178:179], v[178:179], v[110:111]
  v_cvt_pk_bf16_f32 v116, v160, v161
  v_cvt_pk_bf16_f32 v117, v162, v163
  v_cvt_pk_bf16_f32 v118, v176, v177
  v_cvt_pk_bf16_f32 v119, v178, v179
  s_waitcnt lgkmcnt(0)
  v_readfirstlane_b32 s4, v124
  s_and_b32 s4, s4, 3
  s_cmp_lg_u32 s4, 3
  s_cbranch_scc1 Ls_28
  s_mov_b32 exec_lo, s10
  s_mov_b32 exec_hi, 0
  buffer_store_dword v27, v24, s[40:43], s9 offen sc0 sc1
Ls_28:
  s_mov_b64 exec, -1
  buffer_store_dwordx4 v[116:119], v0, s[40:43], s6 offen offset:0 sc0 sc1
  ds_write_b128 v0, v[116:119] offset:16384
  v_pk_fma_f32 v[164:165], v[48:49], v[98:99], v[164:165] op_sel:[0,1,0] op_sel_hi:[1,1,1] neg_lo:[0,1,0] neg_hi:[0,1,0]
  v_pk_fma_f32 v[166:167], v[50:51], v[98:99], v[166:167] op_sel:[0,1,0] op_sel_hi:[1,1,1] neg_lo:[0,1,0] neg_hi:[0,1,0]
  v_pk_fma_f32 v[180:181], v[56:57], v[98:99], v[180:181] op_sel:[0,1,0] op_sel_hi:[1,1,1] neg_lo:[0,1,0] neg_hi:[0,1,0]
  v_pk_fma_f32 v[182:183], v[58:59], v[98:99], v[182:183] op_sel:[0,1,0] op_sel_hi:[1,1,1] neg_lo:[0,1,0] neg_hi:[0,1,0]
  v_pk_fma_f32 v[164:165], v[164:165], v[98:99], v[52:53] op_sel:[0,0,0] op_sel_hi:[1,0,1]
  v_pk_fma_f32 v[166:167], v[166:167], v[98:99], v[54:55] op_sel:[0,0,0] op_sel_hi:[1,0,1]
  v_pk_fma_f32 v[180:181], v[180:181], v[98:99], v[60:61] op_sel:[0,0,0] op_sel_hi:[1,0,1]
  v_pk_fma_f32 v[182:183], v[182:183], v[98:99], v[62:63] op_sel:[0,0,0] op_sel_hi:[1,0,1]
  v_pk_fma_f32 v[104:105], v[164:165], v[164:165], v[4:5] op_sel_hi:[1,1,0]
  v_pk_fma_f32 v[106:107], v[166:167], v[166:167], v[4:5] op_sel_hi:[1,1,0]
  v_pk_fma_f32 v[108:109], v[180:181], v[180:181], v[4:5] op_sel_hi:[1,1,0]
  v_pk_fma_f32 v[110:111], v[182:183], v[182:183], v[4:5] op_sel_hi:[1,1,0]
  v_pk_mul_f32 v[104:105], v[104:105], v[164:165] neg_lo:[0,1] neg_hi:[0,1]
  v_pk_mul_f32 v[106:107], v[106:107], v[166:167] neg_lo:[0,1] neg_hi:[0,1]
  v_pk_mul_f32 v[108:109], v[108:109], v[180:181] neg_lo:[0,1] neg_hi:[0,1]
  v_pk_mul_f32 v[110:111], v[110:111], v[182:183] neg_lo:[0,1] neg_hi:[0,1]
  v_exp_f32 v104, v104
  v_exp_f32 v105, v105
  v_exp_f32 v106, v106
  v_exp_f32 v107, v107
  v_exp_f32 v108, v108
  v_exp_f32 v109, v109
  v_exp_f32 v110, v110
  v_exp_f32 v111, v111
  v_pk_fma_f32 v[104:105], v[104:105], v[4:5], v[4:5] op_sel:[0,1,1] op_sel_hi:[1,1,1]
  v_pk_fma_f32 v[106:107], v[106:107], v[4:5], v[4:5] op_sel:[0,1,1] op_sel_hi:[1,1,1]
  v_pk_fma_f32 v[108:109], v[108:109], v[4:5], v[4:5] op_sel:[0,1,1] op_sel_hi:[1,1,1]
  v_pk_fma_f32 v[110:111], v[110:111], v[4:5], v[4:5] op_sel:[0,1,1] op_sel_hi:[1,1,1]
  v_rcp_f32 v104, v104
  v_rcp_f32 v105, v105
  v_rcp_f32 v106, v106
  v_rcp_f32 v107, v107
  v_rcp_f32 v108, v108
  v_rcp_f32 v109, v109
  v_rcp_f32 v110, v110
  v_rcp_f32 v111, v111
  v_pk_mul_f32 v[164:165], v[164:165], v[104:105]
  v_pk_mul_f32 v[166:167], v[166:167], v[106:107]
  v_pk_mul_f32 v[180:181], v[180:181], v[108:109]
  v_pk_mul_f32 v[182:183], v[182:183], v[110:111]
  v_cvt_pk_bf16_f32 v120, v164, v165
  v_cvt_pk_bf16_f32 v121, v166, v167
  v_cvt_pk_bf16_f32 v122, v180, v181
  v_cvt_pk_bf16_f32 v123, v182, v183
  buffer_store_dwordx4 v[120:123], v0, s[40:43], s6 offen offset:2048 sc0 sc1
  ds_write_b128 v0, v[120:123] offset:18432
  s_add_u32 s6, s6, 0x20000
  v_pk_fma_f32 v[168:169], v[48:49], v[100:101], v[168:169] op_sel:[0,1,0] op_sel_hi:[1,1,1] neg_lo:[0,1,0] neg_hi:[0,1,0]
  v_pk_fma_f32 v[170:171], v[50:51], v[100:101], v[170:171] op_sel:[0,1,0] op_sel_hi:[1,1,1] neg_lo:[0,1,0] neg_hi:[0,1,0]
  v_pk_fma_f32 v[184:185], v[56:57], v[100:101], v[184:185] op_sel:[0,1,0] op_sel_hi:[1,1,1] neg_lo:[0,1,0] neg_hi:[0,1,0]
  v_pk_fma_f32 v[186:187], v[58:59], v[100:101], v[186:187] op_sel:[0,1,0] op_sel_hi:[1,1,1] neg_lo:[0,1,0] neg_hi:[0,1,0]
  v_pk_fma_f32 v[168:169], v[168:169], v[100:101], v[52:53] op_sel:[0,0,0] op_sel_hi:[1,0,1]
  v_pk_fma_f32 v[170:171], v[170:171], v[100:101], v[54:55] op_sel:[0,0,0] op_sel_hi:[1,0,1]
  v_pk_fma_f32 v[184:185], v[184:185], v[100:101], v[60:61] op_sel:[0,0,0] op_sel_hi:[1,0,1]
  v_pk_fma_f32 v[186:187], v[186:187], v[100:101], v[62:63] op_sel:[0,0,0] op_sel_hi:[1,0,1]
  v_pk_fma_f32 v[104:105], v[168:169], v[168:169], v[4:5] op_sel_hi:[1,1,0]
  v_pk_fma_f32 v[106:107], v[170:171], v[170:171], v[4:5] op_sel_hi:[1,1,0]
  v_pk_fma_f32 v[108:109], v[184:185], v[184:185], v[4:5] op_sel_hi:[1,1,0]
  v_pk_fma_f32 v[110:111], v[186:187], v[186:187], v[4:5] op_sel_hi:[1,1,0]
  v_pk_mul_f32 v[104:105], v[104:105], v[168:169] neg_lo:[0,1] neg_hi:[0,1]
  v_pk_mul_f32 v[106:107], v[106:107], v[170:171] neg_lo:[0,1] neg_hi:[0,1]
  v_pk_mul_f32 v[108:109], v[108:109], v[184:185] neg_lo:[0,1] neg_hi:[0,1]
  v_pk_mul_f32 v[110:111], v[110:111], v[186:187] neg_lo:[0,1] neg_hi:[0,1]
  v_exp_f32 v104, v104
  v_exp_f32 v105, v105
  v_exp_f32 v106, v106
  v_exp_f32 v107, v107
  v_exp_f32 v108, v108
  v_exp_f32 v109, v109
  v_exp_f32 v110, v110
  v_exp_f32 v111, v111
  v_pk_fma_f32 v[104:105], v[104:105], v[4:5], v[4:5] op_sel:[0,1,1] op_sel_hi:[1,1,1]
  v_pk_fma_f32 v[106:107], v[106:107], v[4:5], v[4:5] op_sel:[0,1,1] op_sel_hi:[1,1,1]
  v_pk_fma_f32 v[108:109], v[108:109], v[4:5], v[4:5] op_sel:[0,1,1] op_sel_hi:[1,1,1]
  v_pk_fma_f32 v[110:111], v[110:111], v[4:5], v[4:5] op_sel:[0,1,1] op_sel_hi:[1,1,1]
  v_rcp_f32 v104, v104
  v_rcp_f32 v105, v105
  v_rcp_f32 v106, v106
  v_rcp_f32 v107, v107
  v_rcp_f32 v108, v108
  v_rcp_f32 v109, v109
  v_rcp_f32 v110, v110
  v_rcp_f32 v111, v111
  v_pk_mul_f32 v[168:169], v[168:169], v[104:105]
  v_pk_mul_f32 v[170:171], v[170:171], v[106:107]
  v_pk_mul_f32 v[184:185], v[184:185], v[108:109]
  v_pk_mul_f32 v[186:187], v[186:187], v[110:111]
  v_cvt_pk_bf16_f32 v116, v168, v169
  v_cvt_pk_bf16_f32 v117, v170, v171
  v_cvt_pk_bf16_f32 v118, v184, v185
  v_cvt_pk_bf16_f32 v119, v186, v187
  buffer_store_dwordx4 v[116:119], v0, s[40:43], s7 offen offset:0 sc0 sc1
  ds_write_b128 v0, v[116:119] offset:20480
  v_pk_fma_f32 v[172:173], v[48:49], v[102:103], v[172:173] op_sel:[0,1,0] op_sel_hi:[1,1,1] neg_lo:[0,1,0] neg_hi:[0,1,0]
  v_pk_fma_f32 v[174:175], v[50:51], v[102:103], v[174:175] op_sel:[0,1,0] op_sel_hi:[1,1,1] neg_lo:[0,1,0] neg_hi:[0,1,0]
  v_pk_fma_f32 v[188:189], v[56:57], v[102:103], v[188:189] op_sel:[0,1,0] op_sel_hi:[1,1,1] neg_lo:[0,1,0] neg_hi:[0,1,0]
  v_pk_fma_f32 v[190:191], v[58:59], v[102:103], v[190:191] op_sel:[0,1,0] op_sel_hi:[1,1,1] neg_lo:[0,1,0] neg_hi:[0,1,0]
  v_pk_fma_f32 v[172:173], v[172:173], v[102:103], v[52:53] op_sel:[0,0,0] op_sel_hi:[1,0,1]
  v_pk_fma_f32 v[174:175], v[174:175], v[102:103], v[54:55] op_sel:[0,0,0] op_sel_hi:[1,0,1]
  v_pk_fma_f32 v[188:189], v[188:189], v[102:103], v[60:61] op_sel:[0,0,0] op_sel_hi:[1,0,1]
  v_pk_fma_f32 v[190:191], v[190:191], v[102:103], v[62:63] op_sel:[0,0,0] op_sel_hi:[1,0,1]
  v_pk_fma_f32 v[104:105], v[172:173], v[172:173], v[4:5] op_sel_hi:[1,1,0]
  v_pk_fma_f32 v[106:107], v[174:175], v[174:175], v[4:5] op_sel_hi:[1,1,0]
  v_pk_fma_f32 v[108:109], v[188:189], v[188:189], v[4:5] op_sel_hi:[1,1,0]
  v_pk_fma_f32 v[110:111], v[190:191], v[190:191], v[4:5] op_sel_hi:[1,1,0]
  v_pk_mul_f32 v[104:105], v[104:105], v[172:173] neg_lo:[0,1] neg_hi:[0,1]
  v_pk_mul_f32 v[106:107], v[106:107], v[174:175] neg_lo:[0,1] neg_hi:[0,1]
  v_pk_mul_f32 v[108:109], v[108:109], v[188:189] neg_lo:[0,1] neg_hi:[0,1]
  v_pk_mul_f32 v[110:111], v[110:111], v[190:191] neg_lo:[0,1] neg_hi:[0,1]
  v_exp_f32 v104, v104
  v_exp_f32 v105, v105
  v_exp_f32 v106, v106
  v_exp_f32 v107, v107
  v_exp_f32 v108, v108
  v_exp_f32 v109, v109
  v_exp_f32 v110, v110
  v_exp_f32 v111, v111
  v_pk_fma_f32 v[104:105], v[104:105], v[4:5], v[4:5] op_sel:[0,1,1] op_sel_hi:[1,1,1]
  v_pk_fma_f32 v[106:107], v[106:107], v[4:5], v[4:5] op_sel:[0,1,1] op_sel_hi:[1,1,1]
  v_pk_fma_f32 v[108:109], v[108:109], v[4:5], v[4:5] op_sel:[0,1,1] op_sel_hi:[1,1,1]
  v_pk_fma_f32 v[110:111], v[110:111], v[4:5], v[4:5] op_sel:[0,1,1] op_sel_hi:[1,1,1]
  v_rcp_f32 v104, v104
  v_rcp_f32 v105, v105
  v_rcp_f32 v106, v106
  v_rcp_f32 v107, v107
  v_rcp_f32 v108, v108
  v_rcp_f32 v109, v109
  v_rcp_f32 v110, v110
  v_rcp_f32 v111, v111
  v_pk_mul_f32 v[172:173], v[172:173], v[104:105]
  v_pk_mul_f32 v[174:175], v[174:175], v[106:107]
  v_pk_mul_f32 v[188:189], v[188:189], v[108:109]
  v_pk_mul_f32 v[190:191], v[190:191], v[110:111]
  v_cvt_pk_bf16_f32 v120, v172, v173
  v_cvt_pk_bf16_f32 v121, v174, v175
  v_cvt_pk_bf16_f32 v122, v188, v189
  v_cvt_pk_bf16_f32 v123, v190, v191
  buffer_store_dwordx4 v[120:123], v0, s[40:43], s7 offen offset:2048 sc0 sc1
  ds_write_b128 v0, v[120:123] offset:22528
  s_add_u32 s7, s7, 0x20000
  v_pk_fma_f32 v[192:193], v[64:65], v[96:97], v[192:193] op_sel:[0,1,0] op_sel_hi:[1,1,1] neg_lo:[0,1,0] neg_hi:[0,1,0]
  v_pk_fma_f32 v[194:195], v[66:67], v[96:97], v[194:195] op_sel:[0,1,0] op_sel_hi:[1,1,1] neg_lo:[0,1,0] neg_hi:[0,1,0]
  v_pk_fma_f32 v[208:209], v[72:73], v[96:97], v[208:209] op_sel:[0,1,0] op_sel_hi:[1,1,1] neg_lo:[0,1,0] neg_hi:[0,1,0]
  v_pk_fma_f32 v[210:211], v[74:75], v[96:97], v[210:211] op_sel:[0,1,0] op_sel_hi:[1,1,1] neg_lo:[0,1,0] neg_hi:[0,1,0]
  v_pk_fma_f32 v[192:193], v[192:193], v[96:97], v[68:69] op_sel:[0,0,0] op_sel_hi:[1,0,1]
  v_pk_fma_f32 v[194:195], v[194:195], v[96:97], v[70:71] op_sel:[0,0,0] op_sel_hi:[1,0,1]
  v_pk_fma_f32 v[208:209], v[208:209], v[96:97], v[76:77] op_sel:[0,0,0] op_sel_hi:[1,0,1]
  v_pk_fma_f32 v[210:211], v[210:211], v[96:97], v[78:79] op_sel:[0,0,0] op_sel_hi:[1,0,1]
  v_pk_fma_f32 v[104:105], v[192:193], v[192:193], v[4:5] op_sel_hi:[1,1,0]
  v_pk_fma_f32 v[106:107], v[194:195], v[194:195], v[4:5] op_sel_hi:[1,1,0]
  v_pk_fma_f32 v[108:109], v[208:209], v[208:209], v[4:5] op_sel_hi:[1,1,0]
  v_pk_fma_f32 v[110:111], v[210:211], v[210:211], v[4:5] op_sel_hi:[1,1,0]
  v_pk_mul_f32 v[104:105], v[104:105], v[192:193] neg_lo:[0,1] neg_hi:[0,1]
  v_pk_mul_f32 v[106:107], v[106:107], v[194:195] neg_lo:[0,1] neg_hi:[0,1]
  v_pk_mul_f32 v[108:109], v[108:109], v[208:209] neg_lo:[0,1] neg_hi:[0,1]
  v_pk_mul_f32 v[110:111], v[110:111], v[210:211] neg_lo:[0,1] neg_hi:[0,1]
  v_exp_f32 v104, v104
  v_exp_f32 v105, v105
  v_exp_f32 v106, v106
  v_exp_f32 v107, v107
  v_exp_f32 v108, v108
  v_exp_f32 v109, v109
  v_exp_f32 v110, v110
  v_exp_f32 v111, v111
  v_pk_fma_f32 v[104:105], v[104:105], v[4:5], v[4:5] op_sel:[0,1,1] op_sel_hi:[1,1,1]
  v_pk_fma_f32 v[106:107], v[106:107], v[4:5], v[4:5] op_sel:[0,1,1] op_sel_hi:[1,1,1]
  v_pk_fma_f32 v[108:109], v[108:109], v[4:5], v[4:5] op_sel:[0,1,1] op_sel_hi:[1,1,1]
  v_pk_fma_f32 v[110:111], v[110:111], v[4:5], v[4:5] op_sel:[0,1,1] op_sel_hi:[1,1,1]
  v_rcp_f32 v104, v104
  v_rcp_f32 v105, v105
  v_rcp_f32 v106, v106
  v_rcp_f32 v107, v107
  v_rcp_f32 v108, v108
  v_rcp_f32 v109, v109
  v_rcp_f32 v110, v110
  v_rcp_f32 v111, v111
  v_pk_mul_f32 v[192:193], v[192:193], v[104:105]
  v_pk_mul_f32 v[194:195], v[194:195], v[106:107]
  v_pk_mul_f32 v[208:209], v[208:209], v[108:109]
  v_pk_mul_f32 v[210:211], v[210:211], v[110:111]
  v_cvt_pk_bf16_f32 v116, v192, v193
  v_cvt_pk_bf16_f32 v117, v194, v195
  v_cvt_pk_bf16_f32 v118, v208, v209
  v_cvt_pk_bf16_f32 v119, v210, v211
  buffer_store_dwordx4 v[116:119], v0, s[40:43], s6 offen offset:0 sc0 sc1
  ds_write_b128 v0, v[116:119] offset:32768
  v_pk_fma_f32 v[196:197], v[64:65], v[98:99], v[196:197] op_sel:[0,1,0] op_sel_hi:[1,1,1] neg_lo:[0,1,0] neg_hi:[0,1,0]
  v_pk_fma_f32 v[198:199], v[66:67], v[98:99], v[198:199] op_sel:[0,1,0] op_sel_hi:[1,1,1] neg_lo:[0,1,0] neg_hi:[0,1,0]
  v_pk_fma_f32 v[212:213], v[72:73], v[98:99], v[212:213] op_sel:[0,1,0] op_sel_hi:[1,1,1] neg_lo:[0,1,0] neg_hi:[0,1,0]
  v_pk_fma_f32 v[214:215], v[74:75], v[98:99], v[214:215] op_sel:[0,1,0] op_sel_hi:[1,1,1] neg_lo:[0,1,0] neg_hi:[0,1,0]
  v_pk_fma_f32 v[196:197], v[196:197], v[98:99], v[68:69] op_sel:[0,0,0] op_sel_hi:[1,0,1]
  v_pk_fma_f32 v[198:199], v[198:199], v[98:99], v[70:71] op_sel:[0,0,0] op_sel_hi:[1,0,1]
  v_pk_fma_f32 v[212:213], v[212:213], v[98:99], v[76:77] op_sel:[0,0,0] op_sel_hi:[1,0,1]
  v_pk_fma_f32 v[214:215], v[214:215], v[98:99], v[78:79] op_sel:[0,0,0] op_sel_hi:[1,0,1]
  v_pk_fma_f32 v[104:105], v[196:197], v[196:197], v[4:5] op_sel_hi:[1,1,0]
  v_pk_fma_f32 v[106:107], v[198:199], v[198:199], v[4:5] op_sel_hi:[1,1,0]
  v_pk_fma_f32 v[108:109], v[212:213], v[212:213], v[4:5] op_sel_hi:[1,1,0]
  v_pk_fma_f32 v[110:111], v[214:215], v[214:215], v[4:5] op_sel_hi:[1,1,0]
  v_pk_mul_f32 v[104:105], v[104:105], v[196:197] neg_lo:[0,1] neg_hi:[0,1]
  v_pk_mul_f32 v[106:107], v[106:107], v[198:199] neg_lo:[0,1] neg_hi:[0,1]
  v_pk_mul_f32 v[108:109], v[108:109], v[212:213] neg_lo:[0,1] neg_hi:[0,1]
  v_pk_mul_f32 v[110:111], v[110:111], v[214:215] neg_lo:[0,1] neg_hi:[0,1]
  v_exp_f32 v104, v104
  v_exp_f32 v105, v105
  v_exp_f32 v106, v106
  v_exp_f32 v107, v107
  v_exp_f32 v108, v108
  v_exp_f32 v109, v109
  v_exp_f32 v110, v110
  v_exp_f32 v111, v111
  v_pk_fma_f32 v[104:105], v[104:105], v[4:5], v[4:5] op_sel:[0,1,1] op_sel_hi:[1,1,1]
  v_pk_fma_f32 v[106:107], v[106:107], v[4:5], v[4:5] op_sel:[0,1,1] op_sel_hi:[1,1,1]
  v_pk_fma_f32 v[108:109], v[108:109], v[4:5], v[4:5] op_sel:[0,1,1] op_sel_hi:[1,1,1]
  v_pk_fma_f32 v[110:111], v[110:111], v[4:5], v[4:5] op_sel:[0,1,1] op_sel_hi:[1,1,1]
  v_rcp_f32 v104, v104
  v_rcp_f32 v105, v105
  v_rcp_f32 v106, v106
  v_rcp_f32 v107, v107
  v_rcp_f32 v108, v108
  v_rcp_f32 v109, v109
  v_rcp_f32 v110, v110
  v_rcp_f32 v111, v111
  v_pk_mul_f32 v[196:197], v[196:197], v[104:105]
  v_pk_mul_f32 v[198:199], v[198:199], v[106:107]
  v_pk_mul_f32 v[212:213], v[212:213], v[108:109]
  v_pk_mul_f32 v[214:215], v[214:215], v[110:111]
  v_cvt_pk_bf16_f32 v120, v196, v197
  v_cvt_pk_bf16_f32 v121, v198, v199
  v_cvt_pk_bf16_f32 v122, v212, v213
  v_cvt_pk_bf16_f32 v123, v214, v215
  buffer_store_dwordx4 v[120:123], v0, s[40:43], s6 offen offset:2048 sc0 sc1
  ds_write_b128 v0, v[120:123] offset:34816
  s_mov_b64 exec, 1
  ds_add_u32 v28, v27 offset:4
  s_mov_b64 exec, -1
  v_pk_fma_f32 v[200:201], v[64:65], v[100:101], v[200:201] op_sel:[0,1,0] op_sel_hi:[1,1,1] neg_lo:[0,1,0] neg_hi:[0,1,0]
  v_pk_fma_f32 v[202:203], v[66:67], v[100:101], v[202:203] op_sel:[0,1,0] op_sel_hi:[1,1,1] neg_lo:[0,1,0] neg_hi:[0,1,0]
  v_pk_fma_f32 v[216:217], v[72:73], v[100:101], v[216:217] op_sel:[0,1,0] op_sel_hi:[1,1,1] neg_lo:[0,1,0] neg_hi:[0,1,0]
  v_pk_fma_f32 v[218:219], v[74:75], v[100:101], v[218:219] op_sel:[0,1,0] op_sel_hi:[1,1,1] neg_lo:[0,1,0] neg_hi:[0,1,0]
  v_pk_fma_f32 v[200:201], v[200:201], v[100:101], v[68:69] op_sel:[0,0,0] op_sel_hi:[1,0,1]
  v_pk_fma_f32 v[202:203], v[202:203], v[100:101], v[70:71] op_sel:[0,0,0] op_sel_hi:[1,0,1]
  v_pk_fma_f32 v[216:217], v[216:217], v[100:101], v[76:77] op_sel:[0,0,0] op_sel_hi:[1,0,1]
  v_pk_fma_f32 v[218:219], v[218:219], v[100:101], v[78:79] op_sel:[0,0,0] op_sel_hi:[1,0,1]
  v_pk_fma_f32 v[104:105], v[200:201], v[200:201], v[4:5] op_sel_hi:[1,1,0]
  v_pk_fma_f32 v[106:107], v[202:203], v[202:203], v[4:5] op_sel_hi:[1,1,0]
  v_pk_fma_f32 v[108:109], v[216:217], v[216:217], v[4:5] op_sel_hi:[1,1,0]
  v_pk_fma_f32 v[110:111], v[218:219], v[218:219], v[4:5] op_sel_hi:[1,1,0]
  v_pk_mul_f32 v[104:105], v[104:105], v[200:201] neg_lo:[0,1] neg_hi:[0,1]
  v_pk_mul_f32 v[106:107], v[106:107], v[202:203] neg_lo:[0,1] neg_hi:[0,1]
  v_pk_mul_f32 v[108:109], v[108:109], v[216:217] neg_lo:[0,1] neg_hi:[0,1]
  v_pk_mul_f32 v[110:111], v[110:111], v[218:219] neg_lo:[0,1] neg_hi:[0,1]
  v_exp_f32 v104, v104
  v_exp_f32 v105, v105
  v_exp_f32 v106, v106
  v_exp_f32 v107, v107
  v_exp_f32 v108, v108
  v_exp_f32 v109, v109
  v_exp_f32 v110, v110
  v_exp_f32 v111, v111
  v_pk_fma_f32 v[104:105], v[104:105], v[4:5], v[4:5] op_sel:[0,1,1] op_sel_hi:[1,1,1]
  v_pk_fma_f32 v[106:107], v[106:107], v[4:5], v[4:5] op_sel:[0,1,1] op_sel_hi:[1,1,1]
  v_pk_fma_f32 v[108:109], v[108:109], v[4:5], v[4:5] op_sel:[0,1,1] op_sel_hi:[1,1,1]
  v_pk_fma_f32 v[110:111], v[110:111], v[4:5], v[4:5] op_sel:[0,1,1] op_sel_hi:[1,1,1]
  v_rcp_f32 v104, v104
  v_rcp_f32 v105, v105
  v_rcp_f32 v106, v106
  v_rcp_f32 v107, v107
  v_rcp_f32 v108, v108
  v_rcp_f32 v109, v109
  v_rcp_f32 v110, v110
  v_rcp_f32 v111, v111
  v_pk_mul_f32 v[200:201], v[200:201], v[104:105]
  v_pk_mul_f32 v[202:203], v[202:203], v[106:107]
  v_pk_mul_f32 v[216:217], v[216:217], v[108:109]
  v_pk_mul_f32 v[218:219], v[218:219], v[110:111]
  v_cvt_pk_bf16_f32 v116, v200, v201
  v_cvt_pk_bf16_f32 v117, v202, v203
  v_cvt_pk_bf16_f32 v118, v216, v217
  v_cvt_pk_bf16_f32 v119, v218, v219
  buffer_store_dwordx4 v[116:119], v0, s[40:43], s7 offen offset:0 sc0 sc1
  ds_write_b128 v0, v[116:119] offset:36864
  s_lshl_b32 s5, s86, Lz1-Lz0+7
  s_add_u32 s5, s5, 156160
  v_add_u32_e64 v3, s5, v29
  ds_read_b128 v[232:235], v3
  ds_read_b128 v[236:239], v3 offset:64
  v_pk_fma_f32 v[204:205], v[64:65], v[102:103], v[204:205] op_sel:[0,1,0] op_sel_hi:[1,1,1] neg_lo:[0,1,0] neg_hi:[0,1,0]
  v_pk_fma_f32 v[206:207], v[66:67], v[102:103], v[206:207] op_sel:[0,1,0] op_sel_hi:[1,1,1] neg_lo:[0,1,0] neg_hi:[0,1,0]
  v_pk_fma_f32 v[220:221], v[72:73], v[102:103], v[220:221] op_sel:[0,1,0] op_sel_hi:[1,1,1] neg_lo:[0,1,0] neg_hi:[0,1,0]
  v_pk_fma_f32 v[222:223], v[74:75], v[102:103], v[222:223] op_sel:[0,1,0] op_sel_hi:[1,1,1] neg_lo:[0,1,0] neg_hi:[0,1,0]
  v_pk_fma_f32 v[204:205], v[204:205], v[102:103], v[68:69] op_sel:[0,0,0] op_sel_hi:[1,0,1]
  v_pk_fma_f32 v[206:207], v[206:207], v[102:103], v[70:71] op_sel:[0,0,0] op_sel_hi:[1,0,1]
  v_pk_fma_f32 v[220:221], v[220:221], v[102:103], v[76:77] op_sel:[0,0,0] op_sel_hi:[1,0,1]
  v_pk_fma_f32 v[222:223], v[222:223], v[102:103], v[78:79] op_sel:[0,0,0] op_sel_hi:[1,0,1]
  v_pk_fma_f32 v[104:105], v[204:205], v[204:205], v[4:5] op_sel_hi:[1,1,0]
  v_pk_fma_f32 v[106:107], v[206:207], v[206:207], v[4:5] op_sel_hi:[1,1,0]
  v_pk_fma_f32 v[108:109], v[220:221], v[220:221], v[4:5] op_sel_hi:[1,1,0]
  v_pk_fma_f32 v[110:111], v[222:223], v[222:223], v[4:5] op_sel_hi:[1,1,0]
  v_pk_mul_f32 v[104:105], v[104:105], v[204:205] neg_lo:[0,1] neg_hi:[0,1]
  v_pk_mul_f32 v[106:107], v[106:107], v[206:207] neg_lo:[0,1] neg_hi:[0,1]
  v_pk_mul_f32 v[108:109], v[108:109], v[220:221] neg_lo:[0,1] neg_hi:[0,1]
  v_pk_mul_f32 v[110:111], v[110:111], v[222:223] neg_lo:[0,1] neg_hi:[0,1]
  v_exp_f32 v104, v104
  v_exp_f32 v105, v105
  v_exp_f32 v106, v106
  v_exp_f32 v107, v107
  v_exp_f32 v108, v108
  v_exp_f32 v109, v109
  v_exp_f32 v110, v110
  v_exp_f32 v111, v111
  v_pk_fma_f32 v[104:105], v[104:105], v[4:5], v[4:5] op_sel:[0,1,1] op_sel_hi:[1,1,1]
  v_pk_fma_f32 v[106:107], v[106:107], v[4:5], v[4:5] op_sel:[0,1,1] op_sel_hi:[1,1,1]
  v_pk_fma_f32 v[108:109], v[108:109], v[4:5], v[4:5] op_sel:[0,1,1] op_sel_hi:[1,1,1]
  v_pk_fma_f32 v[110:111], v[110:111], v[4:5], v[4:5] op_sel:[0,1,1] op_sel_hi:[1,1,1]
  v_rcp_f32 v104, v104
  v_rcp_f32 v105, v105
  v_rcp_f32 v106, v106
  v_rcp_f32 v107, v107
  v_rcp_f32 v108, v108
  v_rcp_f32 v109, v109
  v_rcp_f32 v110, v110
  v_rcp_f32 v111, v111
  v_pk_mul_f32 v[204:205], v[204:205], v[104:105]
  v_pk_mul_f32 v[206:207], v[206:207], v[106:107]
  v_pk_mul_f32 v[220:221], v[220:221], v[108:109]
  v_pk_mul_f32 v[222:223], v[222:223], v[110:111]
  v_cvt_pk_bf16_f32 v120, v204, v205
  v_cvt_pk_bf16_f32 v121, v206, v207
  v_cvt_pk_bf16_f32 v122, v220, v221
  v_cvt_pk_bf16_f32 v123, v222, v223
  buffer_store_dwordx4 v[120:123], v0, s[40:43], s7 offen offset:2048 sc0 sc1
  ds_write_b128 v0, v[120:123] offset:38912
  s_mov_b32 s16, Lz1-Lz0+0
  s_mov_b32 s17, 16384
  s_mov_b32 s18, 0xffff4000
  s_mov_b32 s19, 49152
  s_mov_b32 s20, 16384
  s_mov_b32 s21, 0xffff0000
  s_mul_i32 s4, s85, 8192
  v_add_u32_e64 v4, s4, v11
  v_add_u32 v5, 1024, v4
  s_lshl_b32 s4, s86, 1
  v_xor_b32 v2, s4, v26
  v_lshl_add_u32 v6, v2, 5, v25
  v_add_u32 v6, s19, v6
  s_add_u32 s4, s4, 1
  v_xor_b32_e64 v2, s4, v26
  v_lshl_add_u32 v7, v2, 5, v25
  v_add_u32 v7, s19, v7
  s_mov_b32 s22, 12
  s_waitcnt lgkmcnt(0)
  s_barrier
  ds_read_b64_tr_b16 v[48:49], v6 offset:0
  v_and_b32 v2, 15, v1
  v_lshrrev_b32 v3, 2, v29
  ds_read_b64_tr_b16 v[50:51], v6 offset:2048
  v_sub_u32 v2, v2, v3
  v_mov_b64 v[224:225], 0
  ds_read_b128 v[32:35], v4 offset:0
  v_lshlrev_b32_e64 v2, 4, v2
  v_mov_b32 v226, 0x3f80
  ds_read_b128 v[36:39], v4 offset:2048
  v_cmp_gt_u32 vcc, 64, v2
  v_mov_b32 v227, 0
  ds_read_b128 v[40:43], v4 offset:4096
  v_cndmask_b32 v226, 0, v226, vcc
  v_mov_b64 v[228:229], 0
  ds_read_b128 v[44:47], v4 offset:6144
  v_lshlrev_b64 v[226:227], v2, v[226:227]
  v_mov_b64_e64 v[160:161], 0
  ds_read_b64_tr_b16 v[52:53], v7 offset:0
  v_mov_b64 v[162:163], 0
  v_mov_b64 v[164:165], 0
  ds_read_b64_tr_b16 v[54:55], v7 offset:2048
  v_mov_b64 v[166:167], 0
  v_mov_b64 v[168:169], 0
  ds_read_b64_tr_b16 v[56:57], v6 offset:8192
  v_mov_b64 v[170:171], 0
  v_mov_b64 v[172:173], 0
  ds_read_b64_tr_b16 v[58:59], v6 offset:10240
  v_mov_b64 v[174:175], 0
  v_mov_b64 v[176:177], 0
  ds_read_b64_tr_b16 v[60:61], v7 offset:8192
  v_mov_b64 v[178:179], 0
  v_mov_b64 v[180:181], 0
  ds_read_b64_tr_b16 v[62:63], v7 offset:10240
  v_mov_b64 v[182:183], 0
  v_mov_b64 v[184:185], 0
  ds_read_b64_tr_b16 v[80:81], v6 offset:4096
  v_mov_b64_e64 v[186:187], 0
  v_mov_b64 v[188:189], 0
  s_waitcnt lgkmcnt(4)
  ds_read_b64_tr_b16 v[82:83], v6 offset:6144
  v_mov_b64_e64 v[190:191], 0
  v_mfma_f32_16x16x32_bf16 v[128:131], v[226:229], v[240:243], v[232:235]
  ds_read_b128 v[64:67], v5 offset:0
  s_lshl_b32 s4, s76, 4
  s_add_u32 s4, s4, s78
  ds_read_b128 v[68:71], v5 offset:2048
  v_mfma_f32_16x16x32_bf16 v[132:135], v[224:227], v[240:243], v[236:239]
  s_lshl_b32 s8, s4, Lz1-Lz0+14
  ds_read_b128 v[72:75], v5 offset:4096
  s_xor_b32 s6, s8, 16384
  v_mfma_f32_16x16x32_bf16 v[136:139], v[226:229], v[244:247], v[232:235]
  ds_read_b128 v[76:79], v5 offset:6144
  s_add_u32 s8, s8, 7340032
  s_add_u32 s6, s6, 7340032
  ds_read_b64_tr_b16 v[84:85], v7 offset:4096
  v_mfma_f32_16x16x32_bf16 v[140:143], v[224:227], v[244:247], v[236:239]
  s_add_u32 s7, s6, 4096
  ds_read_b64_tr_b16 v[86:87], v7 offset:6144
  s_add_u32 s9, s8, 4096
  v_mfma_f32_16x16x32_bf16 v[144:147], v[226:229], v[248:251], v[232:235]
  ds_read_b64_tr_b16 v[88:89], v6 offset:12288
  s_lshl_b32 s4, s81, 7
  s_add_u32 s4, s4, s87
  ds_read_b64_tr_b16 v[90:91], v6 offset:14336
  v_mfma_f32_16x16x32_bf16 v[148:151], v[224:227], v[248:251], v[236:239]
  s_add_u32 s4, s4, Lz1-Lz0+12
  ds_read_b64_tr_b16 v[92:93], v7 offset:12288
  s_lshl_b32 s13, s84, Lz1-Lz0+1
  v_mfma_f32_16x16x32_bf16 v[152:155], v[226:229], v[252:255], v[232:235]
  ds_read_b64_tr_b16 v[94:95], v7 offset:14336
  s_xor_b32 s14, s13, 32768
  s_nop 0
  s_add_u32 s13, s13, s4
  v_mfma_f32_16x16x32_bf16 v[156:159], v[224:227], v[252:255], v[236:239]
  s_add_u32 s14, s14, s4
  s_add_u32 s16, s16, s17
  s_cmp_eq_u32 s16, 65536
  s_cselect_b32 s23, s18, s17
  s_cselect_b32 s16, 0, s16
  v_add_u32_e64 v4, s23, v4
  v_add_u32 v5, s23, v5
  s_add_u32 s19, s19, s20
  s_cmp_eq_u32 s19, 81920
  s_cselect_b32 s23, s21, s20
  s_cselect_b32 s19, 0, s19
  v_add_u32 v6, s23, v6
  v_add_u32 v7, s23, v7
  s_waitcnt lgkmcnt(0)
Lk_29:
  s_barrier
  v_mfma_f32_16x16x32_bf16 v[128:131], v[48:51], v[32:35], v[128:131]
  ds_read_b64_tr_b16 v[112:113], v6 offset:0
  v_mfma_f32_16x16x32_bf16 v[128:131], v[80:83], v[64:67], v[128:131]
  ds_read_b64_tr_b16 v[114:115], v6 offset:2048
  v_mfma_f32_16x16x32_bf16 v[136:139], v[80:83], v[68:71], v[136:139]
  ds_read_b128 v[96:99], v4 offset:0
  v_mfma_f32_16x16x32_bf16 v[136:139], v[48:51], v[36:39], v[136:139]
  ds_read_b128 v[100:103], v4 offset:2048
  v_mfma_f32_16x16x32_bf16 v[144:147], v[48:51], v[40:43], v[144:147]
  ds_read_b128 v[104:107], v4 offset:4096
  v_mfma_f32_16x16x32_bf16 v[144:147], v[80:83], v[72:75], v[144:147]
  ds_read_b128 v[108:111], v4 offset:6144
  v_mfma_f32_16x16x32_bf16 v[152:155], v[80:83], v[76:79], v[152:155]
  ds_read_b64_tr_b16 v[116:117], v7 offset:0
  v_mfma_f32_16x16x32_bf16 v[152:155], v[48:51], v[44:47], v[152:155]
  ds_read_b64_tr_b16 v[118:119], v7 offset:2048
  v_mfma_f32_16x16x32_bf16 v[156:159], v[52:55], v[44:47], v[156:159]
  ds_read_b64_tr_b16 v[120:121], v6 offset:8192
  v_mfma_f32_16x16x32_bf16 v[156:159], v[84:87], v[76:79], v[156:159]
  ds_read_b64_tr_b16 v[122:123], v6 offset:10240
  v_mfma_f32_16x16x32_bf16 v[148:151], v[84:87], v[72:75], v[148:151]
  ds_read_b64_tr_b16 v[124:125], v7 offset:8192
  v_mfma_f32_16x16x32_bf16 v[148:151], v[52:55], v[40:43], v[148:151]
  ds_read_b64_tr_b16 v[126:127], v7 offset:10240
  v_mfma_f32_16x16x32_bf16 v[140:143], v[52:55], v[36:39], v[140:143]
  ds_read_b64_tr_b16 v[208:209], v6 offset:4096
  v_mfma_f32_16x16x32_bf16 v[140:143], v[84:87], v[68:71], v[140:143]
  ds_read_b64_tr_b16 v[210:211], v6 offset:6144
  v_mfma_f32_16x16x32_bf16 v[132:135], v[84:87], v[64:67], v[132:135]
  ds_read_b128 v[192:195], v5 offset:0
  v_mfma_f32_16x16x32_bf16 v[132:135], v[52:55], v[32:35], v[132:135]
  ds_read_b128 v[196:199], v5 offset:2048
  v_mfma_f32_16x16x32_bf16 v[160:163], v[56:59], v[32:35], v[160:163]
  ds_read_b128 v[200:203], v5 offset:4096
  v_mfma_f32_16x16x32_bf16 v[160:163], v[88:91], v[64:67], v[160:163]
  ds_read_b128 v[204:207], v5 offset:6144
  v_mfma_f32_16x16x32_bf16 v[168:171], v[88:91], v[68:71], v[168:171]
  ds_read_b64_tr_b16 v[212:213], v7 offset:4096
  v_mfma_f32_16x16x32_bf16 v[168:171], v[56:59], v[36:39], v[168:171]
  ds_read_b64_tr_b16 v[214:215], v7 offset:6144
  v_mfma_f32_16x16x32_bf16 v[176:179], v[56:59], v[40:43], v[176:179]
  ds_read_b64_tr_b16 v[216:217], v6 offset:12288
  v_mfma_f32_16x16x32_bf16 v[176:179], v[88:91], v[72:75], v[176:179]
  ds_read_b64_tr_b16 v[218:219], v6 offset:14336
  v_mfma_f32_16x16x32_bf16 v[184:187], v[88:91], v[76:79], v[184:187]
  ds_read_b64_tr_b16 v[220:221], v7 offset:12288
  v_mfma_f32_16x16x32_bf16 v[184:187], v[56:59], v[44:47], v[184:187]
  ds_read_b64_tr_b16 v[222:223], v7 offset:14336
  v_mfma_f32_16x16x32_bf16 v[188:191], v[60:63], v[44:47], v[188:191]
  s_add_u32 s16, s16, s17
  s_cmp_eq_u32 s16, 65536
  s_cselect_b32 s23, s18, s17
  v_mfma_f32_16x16x32_bf16 v[188:191], v[92:95], v[76:79], v[188:191]
  s_cselect_b32 s16, 0, s16
  v_add_u32 v4, s23, v4
  v_add_u32_e64 v5, s23, v5
  v_mfma_f32_16x16x32_bf16 v[180:183], v[92:95], v[72:75], v[180:183]
  s_add_u32 s19, s19, s20
  s_cmp_eq_u32 s19, 81920
  s_cselect_b32 s23, s21, s20
  v_mfma_f32_16x16x32_bf16 v[180:183], v[60:63], v[40:43], v[180:183]
  s_cselect_b32 s19, 0, s19
  v_add_u32 v6, s23, v6
  v_add_u32_e64 v7, s23, v7
  v_mfma_f32_16x16x32_bf16 v[172:175], v[60:63], v[36:39], v[172:175]
  v_mfma_f32_16x16x32_bf16 v[172:175], v[92:95], v[68:71], v[172:175]
  v_mfma_f32_16x16x32_bf16 v[164:167], v[92:95], v[64:67], v[164:167]
  s_nop 0
  s_waitcnt lgkmcnt(0)
  v_mfma_f32_16x16x32_bf16 v[164:167], v[60:63], v[32:35], v[164:167]
  s_waitcnt vmcnt(0)
  s_barrier
  v_mfma_f32_16x16x32_bf16 v[128:131], v[112:115], v[96:99], v[128:131]
  ds_read_b64_tr_b16 v[48:49], v6 offset:0
  v_mfma_f32_16x16x32_bf16 v[128:131], v[208:211], v[192:195], v[128:131]
  ds_read_b64_tr_b16 v[50:51], v6 offset:2048
  v_mfma_f32_16x16x32_bf16 v[136:139], v[208:211], v[196:199], v[136:139]
  ds_read_b128 v[32:35], v4 offset:0
  v_mfma_f32_16x16x32_bf16 v[136:139], v[112:115], v[100:103], v[136:139]
  ds_read_b128 v[36:39], v4 offset:2048
  v_mfma_f32_16x16x32_bf16 v[144:147], v[112:115], v[104:107], v[144:147]
  ds_read_b128 v[40:43], v4 offset:4096
  v_mfma_f32_16x16x32_bf16 v[144:147], v[208:211], v[200:203], v[144:147]
  ds_read_b128 v[44:47], v4 offset:6144
  v_mfma_f32_16x16x32_bf16 v[152:155], v[208:211], v[204:207], v[152:155]
  ds_read_b64_tr_b16 v[52:53], v7 offset:0
  v_mfma_f32_16x16x32_bf16 v[152:155], v[112:115], v[108:111], v[152:155]
  ds_read_b64_tr_b16 v[54:55], v7 offset:2048
  v_mfma_f32_16x16x32_bf16 v[156:159], v[116:119], v[108:111], v[156:159]
  ds_read_b64_tr_b16 v[56:57], v6 offset:8192
  v_mfma_f32_16x16x32_bf16 v[156:159], v[212:215], v[204:207], v[156:159]
  ds_read_b64_tr_b16 v[58:59], v6 offset:10240
  v_mfma_f32_16x16x32_bf16 v[148:151], v[212:215], v[200:203], v[148:151]
  ds_read_b64_tr_b16 v[60:61], v7 offset:8192
  v_mfma_f32_16x16x32_bf16 v[148:151], v[116:119], v[104:107], v[148:151]
  ds_read_b64_tr_b16 v[62:63], v7 offset:10240
  v_mfma_f32_16x16x32_bf16 v[140:143], v[116:119], v[100:103], v[140:143]
  ds_read_b64_tr_b16 v[80:81], v6 offset:4096
  v_mfma_f32_16x16x32_bf16 v[140:143], v[212:215], v[196:199], v[140:143]
  ds_read_b64_tr_b16 v[82:83], v6 offset:6144
  v_mfma_f32_16x16x32_bf16 v[132:135], v[212:215], v[192:195], v[132:135]
  ds_read_b128 v[64:67], v5 offset:0
  v_mfma_f32_16x16x32_bf16 v[132:135], v[116:119], v[96:99], v[132:135]
  ds_read_b128 v[68:71], v5 offset:2048
  v_mfma_f32_16x16x32_bf16 v[160:163], v[120:123], v[96:99], v[160:163]
  ds_read_b128 v[72:75], v5 offset:4096
  v_mfma_f32_16x16x32_bf16 v[160:163], v[216:219], v[192:195], v[160:163]
  ds_read_b128 v[76:79], v5 offset:6144
  v_mfma_f32_16x16x32_bf16 v[168:171], v[216:219], v[196:199], v[168:171]
  ds_read_b64_tr_b16 v[84:85], v7 offset:4096
  v_mfma_f32_16x16x32_bf16 v[168:171], v[120:123], v[100:103], v[168:171]
  ds_read_b64_tr_b16 v[86:87], v7 offset:6144
  v_mfma_f32_16x16x32_bf16 v[176:179], v[120:123], v[104:107], v[176:179]
  ds_read_b64_tr_b16 v[88:89], v6 offset:12288
  v_mfma_f32_16x16x32_bf16 v[176:179], v[216:219], v[200:203], v[176:179]
  ds_read_b64_tr_b16 v[90:91], v6 offset:14336
  v_mfma_f32_16x16x32_bf16 v[184:187], v[216:219], v[204:207], v[184:187]
  ds_read_b64_tr_b16 v[92:93], v7 offset:12288
  v_mfma_f32_16x16x32_bf16 v[184:187], v[120:123], v[108:111], v[184:187]
  ds_read_b64_tr_b16 v[94:95], v7 offset:14336
  v_mfma_f32_16x16x32_bf16 v[188:191], v[124:127], v[108:111], v[188:191]
  s_add_u32 s16, s16, s17
  s_cmp_eq_u32 s16, 65536
  s_cselect_b32 s23, s18, s17
  v_mfma_f32_16x16x32_bf16 v[188:191], v[220:223], v[204:207], v[188:191]
  s_cselect_b32 s16, 0, s16
  v_add_u32 v4, s23, v4
  v_add_u32_e64 v5, s23, v5
  v_mfma_f32_16x16x32_bf16 v[180:183], v[220:223], v[200:203], v[180:183]
  s_add_u32 s19, s19, s20
  s_cmp_eq_u32 s19, 81920
  s_cselect_b32 s23, s21, s20
  v_mfma_f32_16x16x32_bf16 v[180:183], v[124:127], v[104:107], v[180:183]
  s_cselect_b32 s19, 0, s19
  v_add_u32 v6, s23, v6
  v_add_u32_e64 v7, s23, v7
  v_mfma_f32_16x16x32_bf16 v[172:175], v[124:127], v[100:103], v[172:175]
  s_sub_u32 s22, s22, 1
  s_cmp_lg_u32 s22, 0
  v_mfma_f32_16x16x32_bf16 v[172:175], v[220:223], v[196:199], v[172:175]
  v_mfma_f32_16x16x32_bf16 v[164:167], v[220:223], v[192:195], v[164:167]
  s_nop 0
  s_waitcnt lgkmcnt(0)
  v_mfma_f32_16x16x32_bf16 v[164:167], v[124:127], v[96:99], v[164:167]
  s_cbranch_scc1 Lk_29
  s_barrier
  v_mfma_f32_16x16x32_bf16 v[128:131], v[48:51], v[32:35], v[128:131]
  ds_read_b64_tr_b16 v[112:113], v6 offset:0
  v_mfma_f32_16x16x32_bf16 v[128:131], v[80:83], v[64:67], v[128:131]
  ds_read_b64_tr_b16 v[114:115], v6 offset:2048
  v_mfma_f32_16x16x32_bf16 v[136:139], v[80:83], v[68:71], v[136:139]
  ds_read_b128 v[96:99], v4 offset:0
  v_mfma_f32_16x16x32_bf16 v[136:139], v[48:51], v[36:39], v[136:139]
  ds_read_b128 v[100:103], v4 offset:2048
  v_mfma_f32_16x16x32_bf16 v[144:147], v[48:51], v[40:43], v[144:147]
  ds_read_b128 v[104:107], v4 offset:4096
  v_mfma_f32_16x16x32_bf16 v[144:147], v[80:83], v[72:75], v[144:147]
  ds_read_b128 v[108:111], v4 offset:6144
  v_mfma_f32_16x16x32_bf16 v[152:155], v[80:83], v[76:79], v[152:155]
  ds_read_b64_tr_b16 v[116:117], v7 offset:0
  v_mfma_f32_16x16x32_bf16 v[152:155], v[48:51], v[44:47], v[152:155]
  ds_read_b64_tr_b16 v[118:119], v7 offset:2048
  v_mfma_f32_16x16x32_bf16 v[156:159], v[52:55], v[44:47], v[156:159]
  ds_read_b64_tr_b16 v[120:121], v6 offset:8192
  v_mfma_f32_16x16x32_bf16 v[156:159], v[84:87], v[76:79], v[156:159]
  ds_read_b64_tr_b16 v[122:123], v6 offset:10240
  v_mfma_f32_16x16x32_bf16 v[148:151], v[84:87], v[72:75], v[148:151]
  ds_read_b64_tr_b16 v[124:125], v7 offset:8192
  v_mfma_f32_16x16x32_bf16 v[148:151], v[52:55], v[40:43], v[148:151]
  ds_read_b64_tr_b16 v[126:127], v7 offset:10240
  v_mfma_f32_16x16x32_bf16 v[140:143], v[52:55], v[36:39], v[140:143]
  ds_read_b64_tr_b16 v[208:209], v6 offset:4096
  v_mfma_f32_16x16x32_bf16 v[140:143], v[84:87], v[68:71], v[140:143]
  ds_read_b64_tr_b16 v[210:211], v6 offset:6144
  v_mfma_f32_16x16x32_bf16 v[132:135], v[84:87], v[64:67], v[132:135]
  ds_read_b128 v[192:195], v5 offset:0
  v_mfma_f32_16x16x32_bf16 v[132:135], v[52:55], v[32:35], v[132:135]
  ds_read_b128 v[196:199], v5 offset:2048
  v_mfma_f32_16x16x32_bf16 v[160:163], v[56:59], v[32:35], v[160:163]
  ds_read_b128 v[200:203], v5 offset:4096
  v_mfma_f32_16x16x32_bf16 v[160:163], v[88:91], v[64:67], v[160:163]
  ds_read_b128 v[204:207], v5 offset:6144
  v_mfma_f32_16x16x32_bf16 v[168:171], v[88:91], v[68:71], v[168:171]
  ds_read_b64_tr_b16 v[212:213], v7 offset:4096
  v_mfma_f32_16x16x32_bf16 v[168:171], v[56:59], v[36:39], v[168:171]
  ds_read_b64_tr_b16 v[214:215], v7 offset:6144
  v_mfma_f32_16x16x32_bf16 v[176:179], v[56:59], v[40:43], v[176:179]
  ds_read_b64_tr_b16 v[216:217], v6 offset:12288
  v_mfma_f32_16x16x32_bf16 v[176:179], v[88:91], v[72:75], v[176:179]
  ds_read_b64_tr_b16 v[218:219], v6 offset:14336
  v_mfma_f32_16x16x32_bf16 v[184:187], v[88:91], v[76:79], v[184:187]
  ds_read_b64_tr_b16 v[220:221], v7 offset:12288
  v_mfma_f32_16x16x32_bf16 v[184:187], v[56:59], v[44:47], v[184:187]
  ds_read_b64_tr_b16 v[222:223], v7 offset:14336
  v_mfma_f32_16x16x32_bf16 v[188:191], v[60:63], v[44:47], v[188:191]
  s_add_u32 s16, s16, s17
  s_cmp_eq_u32 s16, 65536
  s_cselect_b32 s23, s18, s17
  v_mfma_f32_16x16x32_bf16 v[188:191], v[92:95], v[76:79], v[188:191]
  s_cselect_b32 s16, 0, s16
  v_add_u32 v4, s23, v4
  v_add_u32_e64 v5, s23, v5
  v_mfma_f32_16x16x32_bf16 v[180:183], v[92:95], v[72:75], v[180:183]
  s_add_u32 s19, s19, s20
  s_cmp_eq_u32 s19, 81920
  s_cselect_b32 s23, s21, s20
  v_mfma_f32_16x16x32_bf16 v[180:183], v[60:63], v[40:43], v[180:183]
  s_cselect_b32 s19, 0, s19
  v_add_u32 v6, s23, v6
  v_add_u32_e64 v7, s23, v7
  v_mfma_f32_16x16x32_bf16 v[172:175], v[60:63], v[36:39], v[172:175]
  v_mfma_f32_16x16x32_bf16 v[172:175], v[92:95], v[68:71], v[172:175]
  v_mfma_f32_16x16x32_bf16 v[164:167], v[92:95], v[64:67], v[164:167]
  s_waitcnt lgkmcnt(0)
  v_mfma_f32_16x16x32_bf16 v[164:167], v[60:63], v[32:35], v[164:167]
  s_barrier
  v_mfma_f32_16x16x32_bf16 v[160:163], v[120:123], v[96:99], v[160:163]
  ds_read_b64_tr_b16 v[48:49], v6 offset:0
  ds_read_b64_tr_b16 v[50:51], v6 offset:2048
  v_mfma_f32_16x16x32_bf16 v[160:163], v[216:219], v[192:195], v[160:163]
  ds_read_b128 v[32:35], v4 offset:0
  ds_read_b128 v[36:39], v4 offset:2048
  v_mfma_f32_16x16x32_bf16 v[164:167], v[220:223], v[192:195], v[164:167]
  ds_read_b128 v[40:43], v4 offset:4096
  ds_read_b128 v[44:47], v4 offset:6144
  v_mfma_f32_16x16x32_bf16 v[164:167], v[124:127], v[96:99], v[164:167]
  ds_read_b64_tr_b16 v[52:53], v7 offset:0
  ds_read_b64_tr_b16 v[54:55], v7 offset:2048
  v_mfma_f32_16x16x32_bf16 v[172:175], v[124:127], v[100:103], v[172:175]
  ds_read_b64_tr_b16 v[80:81], v6 offset:4096
  ds_read_b64_tr_b16 v[82:83], v6 offset:6144
  v_mfma_f32_16x16x32_bf16 v[172:175], v[220:223], v[196:199], v[172:175]
  v_cvt_pk_bf16_f32 v160, v160, v161
  v_cvt_pk_bf16_f32 v161, v162, v163
  v_mfma_f32_16x16x32_bf16 v[168:171], v[216:219], v[196:199], v[168:171]
  v_cvt_pk_bf16_f32 v162, v164, v165
  v_cvt_pk_bf16_f32 v163, v166, v167
  v_mfma_f32_16x16x32_bf16 v[168:171], v[120:123], v[100:103], v[168:171]
  buffer_store_dwordx4 v[160:163], v0, s[40:43], s6 offen offset:0 sc0 sc1
  v_mfma_f32_16x16x32_bf16 v[176:179], v[120:123], v[104:107], v[176:179]
  ds_read_b128 v[64:67], v5 offset:0
  v_mfma_f32_16x16x32_bf16 v[176:179], v[216:219], v[200:203], v[176:179]
  v_cvt_pk_bf16_f32 v166, v172, v173
  v_cvt_pk_bf16_f32 v167, v174, v175
  v_mfma_f32_16x16x32_bf16 v[180:183], v[220:223], v[200:203], v[180:183]
  s_nop 0
  s_nop 0
  v_cvt_pk_bf16_f32 v164, v168, v169
  v_cvt_pk_bf16_f32 v165, v170, v171
  v_mfma_f32_16x16x32_bf16 v[180:183], v[124:127], v[104:107], v[180:183]
  buffer_store_dwordx4 v[164:167], v0, s[40:43], s6 offen offset:2048 sc0 sc1
  ds_read_b128 v[68:71], v5 offset:2048
  v_mfma_f32_16x16x32_bf16 v[188:191], v[124:127], v[108:111], v[188:191]
  ds_read_b128 v[72:75], v5 offset:4096
  v_mfma_f32_16x16x32_bf16 v[188:191], v[220:223], v[204:207], v[188:191]
  v_cvt_pk_bf16_f32 v168, v176, v177
  v_cvt_pk_bf16_f32 v169, v178, v179
  v_mfma_f32_16x16x32_bf16 v[184:187], v[216:219], v[204:207], v[184:187]
  v_cvt_pk_bf16_f32 v170, v180, v181
  v_cvt_pk_bf16_f32 v171, v182, v183
  v_mfma_f32_16x16x32_bf16 v[184:187], v[120:123], v[108:111], v[184:187]
  buffer_store_dwordx4 v[168:171], v0, s[40:43], s7 offen offset:0 sc0 sc1
  ds_read_b128 v[76:79], v5 offset:6144
  v_mfma_f32_16x16x32_bf16 v[128:131], v[112:115], v[96:99], v[128:131]
  ds_read_b64_tr_b16 v[84:85], v7 offset:4096
  v_mfma_f32_16x16x32_bf16 v[128:131], v[208:211], v[192:195], v[128:131]
  v_cvt_pk_bf16_f32 v174, v188, v189
  v_cvt_pk_bf16_f32 v175, v190, v191
  v_mfma_f32_16x16x32_bf16 v[136:139], v[208:211], v[196:199], v[136:139]
  v_cvt_pk_bf16_f32 v172, v184, v185
  v_cvt_pk_bf16_f32 v173, v186, v187
  v_mfma_f32_16x16x32_bf16 v[136:139], v[112:115], v[100:103], v[136:139]
  buffer_store_dwordx4 v[172:175], v0, s[40:43], s7 offen offset:2048 sc0 sc1
  ds_read_b64_tr_b16 v[86:87], v7 offset:6144
  v_mfma_f32_16x16x32_bf16 v[144:147], v[112:115], v[104:107], v[144:147]
  v_subrev_u32 v4, 32768, v4
  v_mfma_f32_16x16x32_bf16 v[144:147], v[208:211], v[200:203], v[144:147]
  v_subrev_u32 v6, 0x10000, v6
  v_mfma_f32_16x16x32_bf16 v[152:155], v[208:211], v[204:207], v[152:155]
  v_subrev_u32 v7, 0x10000, v7
  v_mfma_f32_16x16x32_bf16 v[152:155], v[112:115], v[108:111], v[152:155]
  v_mfma_f32_16x16x32_bf16 v[156:159], v[116:119], v[108:111], v[156:159]
  v_mfma_f32_16x16x32_bf16 v[156:159], v[212:215], v[204:207], v[156:159]
  v_mfma_f32_16x16x32_bf16 v[148:151], v[212:215], v[200:203], v[148:151]
  v_mfma_f32_16x16x32_bf16 v[148:151], v[116:119], v[104:107], v[148:151]
  v_mfma_f32_16x16x32_bf16 v[140:143], v[116:119], v[100:103], v[140:143]
  v_mfma_f32_16x16x32_bf16 v[140:143], v[212:215], v[196:199], v[140:143]
  v_mfma_f32_16x16x32_bf16 v[132:135], v[212:215], v[192:195], v[132:135]
  s_waitcnt lgkmcnt(0)
  v_mfma_f32_16x16x32_bf16 v[132:135], v[116:119], v[96:99], v[132:135]
  s_barrier
  v_mfma_f32_16x16x32_bf16 v[128:131], v[48:51], v[32:35], v[128:131]
  ds_read_b64_tr_b16 v[112:113], v6 offset:0
  v_mfma_f32_16x16x32_bf16 v[128:131], v[80:83], v[64:67], v[128:131]
  ds_read_b64_tr_b16 v[114:115], v6 offset:2048
  v_mfma_f32_16x16x32_bf16 v[136:139], v[80:83], v[68:71], v[136:139]
  ds_read_b64_tr_b16 v[208:209], v6 offset:4096
  v_mfma_f32_16x16x32_bf16 v[136:139], v[48:51], v[36:39], v[136:139]
  ds_read_b64_tr_b16 v[210:211], v6 offset:6144
  v_mfma_f32_16x16x32_bf16 v[144:147], v[48:51], v[40:43], v[144:147]
  ds_read_b128 v[96:99], v4 offset:49152
  v_mfma_f32_16x16x32_bf16 v[144:147], v[80:83], v[72:75], v[144:147]
  ds_read_b128 v[192:195], v4 offset:50176
  v_mfma_f32_16x16x32_bf16 v[152:155], v[80:83], v[76:79], v[152:155]
  ds_read_b128 v[100:103], v4 offset:51200
  v_mfma_f32_16x16x32_bf16 v[152:155], v[48:51], v[44:47], v[152:155]
  ds_read_b128 v[196:199], v4 offset:52224
  v_mfma_f32_16x16x32_bf16 v[156:159], v[52:55], v[44:47], v[156:159]
  ds_read_b128 v[104:107], v4 offset:53248
  v_mfma_f32_16x16x32_bf16 v[156:159], v[84:87], v[76:79], v[156:159]
  ds_read_b128 v[200:203], v4 offset:54272
  v_mfma_f32_16x16x32_bf16 v[148:151], v[84:87], v[72:75], v[148:151]
  ds_read_b128 v[108:111], v4 offset:55296
  v_mfma_f32_16x16x32_bf16 v[148:151], v[52:55], v[40:43], v[148:151]
  ds_read_b128 v[204:207], v4 offset:56320
  v_mfma_f32_16x16x32_bf16 v[140:143], v[52:55], v[36:39], v[140:143]
  ds_read_b64_tr_b16 v[116:117], v7 offset:0
  v_mfma_f32_16x16x32_bf16 v[140:143], v[84:87], v[68:71], v[140:143]
  ds_read_b64_tr_b16 v[118:119], v7 offset:2048
  v_mfma_f32_16x16x32_bf16 v[132:135], v[84:87], v[64:67], v[132:135]
  ds_read_b64_tr_b16 v[212:213], v7 offset:4096
  ds_read_b64_tr_b16 v[214:215], v7 offset:6144
  v_mfma_f32_16x16x32_bf16 v[132:135], v[52:55], v[32:35], v[132:135]
  s_barrier
  s_waitcnt lgkmcnt(10)
  v_mfma_f32_16x16x32_bf16 v[128:131], v[112:115], v[96:99], v[128:131]
  ds_read_b64_tr_b16 v[48:49], v6 offset:16384
  v_mfma_f32_16x16x32_bf16 v[128:131], v[208:211], v[192:195], v[128:131]
  ds_read_b64_tr_b16 v[50:51], v6 offset:18432
  s_nop 0
  s_waitcnt lgkmcnt(10)
  v_mfma_f32_16x16x32_bf16 v[136:139], v[208:211], v[196:199], v[136:139]
  ds_read_b64_tr_b16 v[80:81], v6 offset:20480
  v_mfma_f32_16x16x32_bf16 v[136:139], v[112:115], v[100:103], v[136:139]
  ds_read_b64_tr_b16 v[82:83], v6 offset:22528
  s_nop 0
  s_waitcnt lgkmcnt(10)
  v_mfma_f32_16x16x32_bf16 v[144:147], v[112:115], v[104:107], v[144:147]
  ds_read_b128 v[32:35], v4 offset:0
  v_mfma_f32_16x16x32_bf16 v[144:147], v[208:211], v[200:203], v[144:147]
  ds_read_b128 v[64:67], v4 offset:1024
  s_nop 0
  s_waitcnt lgkmcnt(10)
  v_mfma_f32_16x16x32_bf16 v[152:155], v[208:211], v[204:207], v[152:155]
  ds_read_b128 v[36:39], v4 offset:2048
  v_mfma_f32_16x16x32_bf16 v[152:155], v[112:115], v[108:111], v[152:155]
  ds_read_b128 v[68:71], v4 offset:3072
  s_nop 0
  s_waitcnt lgkmcnt(8)
  v_mfma_f32_16x16x32_bf16 v[156:159], v[116:119], v[108:111], v[156:159]
  ds_read_b128 v[40:43], v4 offset:4096
  buffer_load_dwordx4 v[176:179], v0, s[40:43], s8 offen offset:0 sc0 sc1
  v_mfma_f32_16x16x32_bf16 v[156:159], v[212:215], v[204:207], v[156:159]
  ds_read_b128 v[72:75], v4 offset:5120
  v_mfma_f32_16x16x32_bf16 v[148:151], v[212:215], v[200:203], v[148:151]
  ds_read_b128 v[44:47], v4 offset:6144
  buffer_load_dwordx4 v[180:183], v0, s[40:43], s8 offen offset:2048 sc0 sc1
  v_mfma_f32_16x16x32_bf16 v[148:151], v[116:119], v[104:107], v[148:151]
  ds_read_b128 v[76:79], v4 offset:7168
  v_mfma_f32_16x16x32_bf16 v[140:143], v[116:119], v[100:103], v[140:143]
  ds_read_b64_tr_b16 v[52:53], v7 offset:16384
  buffer_load_dwordx4 v[184:187], v0, s[40:43], s9 offen offset:0 sc0 sc1
  v_mfma_f32_16x16x32_bf16 v[140:143], v[212:215], v[196:199], v[140:143]
  ds_read_b64_tr_b16 v[54:55], v7 offset:18432
  v_mfma_f32_16x16x32_bf16 v[132:135], v[212:215], v[192:195], v[132:135]
  ds_read_b64_tr_b16 v[84:85], v7 offset:20480
  ds_read_b64_tr_b16 v[86:87], v7 offset:22528
  buffer_load_dwordx4 v[188:191], v0, s[40:43], s9 offen offset:2048 sc0 sc1
  v_mfma_f32_16x16x32_bf16 v[132:135], v[116:119], v[96:99], v[132:135]
  s_barrier
  s_waitcnt lgkmcnt(10)
  v_mfma_f32_16x16x32_bf16 v[128:131], v[48:51], v[32:35], v[128:131]
  ds_read_b64_tr_b16 v[112:113], v6 offset:32768
  v_mfma_f32_16x16x32_bf16 v[128:131], v[80:83], v[64:67], v[128:131]
  ds_read_b64_tr_b16 v[114:115], v6 offset:34816
  s_nop 0
  s_waitcnt lgkmcnt(10)
  v_mfma_f32_16x16x32_bf16 v[136:139], v[80:83], v[68:71], v[136:139]
  ds_read_b64_tr_b16 v[208:209], v6 offset:36864
  v_mfma_f32_16x16x32_bf16 v[136:139], v[48:51], v[36:39], v[136:139]
  ds_read_b64_tr_b16 v[210:211], v6 offset:38912
  s_nop 0
  s_waitcnt lgkmcnt(10)
  v_mfma_f32_16x16x32_bf16 v[144:147], v[48:51], v[40:43], v[144:147]
  ds_read_b128 v[96:99], v4 offset:16384
  v_mfma_f32_16x16x32_bf16 v[144:147], v[80:83], v[72:75], v[144:147]
  ds_read_b128 v[192:195], v4 offset:17408
  s_nop 0
  s_waitcnt lgkmcnt(10)
  v_mfma_f32_16x16x32_bf16 v[152:155], v[80:83], v[76:79], v[152:155]
  ds_read_b128 v[100:103], v4 offset:18432
  v_mfma_f32_16x16x32_bf16 v[152:155], v[48:51], v[44:47], v[152:155]
  ds_read_b128 v[196:199], v4 offset:19456
  s_nop 0
  s_waitcnt lgkmcnt(8)
  v_mfma_f32_16x16x32_bf16 v[156:159], v[52:55], v[44:47], v[156:159]
  ds_read_b128 v[104:107], v4 offset:20480
  v_mfma_f32_16x16x32_bf16 v[156:159], v[84:87], v[76:79], v[156:159]
  ds_read_b128 v[200:203], v4 offset:21504
  v_mfma_f32_16x16x32_bf16 v[148:151], v[84:87], v[72:75], v[148:151]
  ds_read_b128 v[108:111], v4 offset:22528
  v_mfma_f32_16x16x32_bf16 v[148:151], v[52:55], v[40:43], v[148:151]
  ds_read_b128 v[204:207], v4 offset:23552
  v_mfma_f32_16x16x32_bf16 v[140:143], v[52:55], v[36:39], v[140:143]
  ds_read_b64_tr_b16 v[116:117], v7 offset:32768
  v_mfma_f32_16x16x32_bf16 v[140:143], v[84:87], v[68:71], v[140:143]
  ds_read_b64_tr_b16 v[118:119], v7 offset:34816
  v_mfma_f32_16x16x32_bf16 v[132:135], v[84:87], v[64:67], v[132:135]
  ds_read_b64_tr_b16 v[212:213], v7 offset:36864
  ds_read_b64_tr_b16 v[214:215], v7 offset:38912
  v_mfma_f32_16x16x32_bf16 v[132:135], v[52:55], v[32:35], v[132:135]
  s_waitcnt lgkmcnt(10)
  v_mfma_f32_16x16x32_bf16 v[128:131], v[112:115], v[96:99], v[128:131]
  v_mfma_f32_16x16x32_bf16 v[128:131], v[208:211], v[192:195], v[128:131]
  s_waitcnt lgkmcnt(8)
  v_mfma_f32_16x16x32_bf16 v[136:139], v[208:211], v[196:199], v[136:139]
  v_mfma_f32_16x16x32_bf16 v[136:139], v[112:115], v[100:103], v[136:139]
  s_waitcnt lgkmcnt(6)
  v_mfma_f32_16x16x32_bf16 v[144:147], v[112:115], v[104:107], v[144:147]
  v_mfma_f32_16x16x32_bf16 v[144:147], v[208:211], v[200:203], v[144:147]
  s_waitcnt lgkmcnt(4)
  v_mfma_f32_16x16x32_bf16 v[152:155], v[208:211], v[204:207], v[152:155]
  s_lshl_b32 s4, s76, Lz1-Lz0+4
  v_mfma_f32_16x16x32_bf16 v[152:155], v[112:115], v[108:111], v[152:155]
  s_add_u32 s4, s4, s78
  s_lshl_b32 s6, s4, 14
  s_waitcnt lgkmcnt(0)
  s_barrier
  v_mfma_f32_16x16x32_bf16 v[156:159], v[116:119], v[108:111], v[156:159]
  s_add_u32 s6, s6, 35651584
  s_add_u32 s7, s6, 4096
  v_mfma_f32_16x16x32_bf16 v[156:159], v[212:215], v[204:207], v[156:159]
  v_and_b32 v2, 15, v1
  v_lshlrev_b32 v3, 12, v2
  v_mfma_f32_16x16x32_bf16 v[148:151], v[212:215], v[200:203], v[148:151]
  v_and_b32_e64 v2, 16, v1
  v_lshl_add_u32 v3, v2, 1, v3
  v_mfma_f32_16x16x32_bf16 v[148:151], v[116:119], v[104:107], v[148:151]
  v_and_b32 v2, 32, v1
  v_lshrrev_b32 v2, 1, v2
  v_mfma_f32_16x16x32_bf16 v[140:143], v[116:119], v[100:103], v[140:143]
  v_add_u32 v3, v2, v3
  s_lshl_b32 s26, s76, 18
  v_mfma_f32_16x16x32_bf16 v[140:143], v[212:215], v[196:199], v[140:143]
  s_lshl_b32 s4, s85, 11
  s_add_u32 s26, s26, s4
  v_mfma_f32_16x16x32_bf16 v[132:135], v[212:215], v[192:195], v[132:135]
  s_lshl_b32 s4, s78, 7
  s_add_u32 s26, s26, s4
  v_mfma_f32_16x16x32_bf16 v[132:135], v[116:119], v[96:99], v[132:135]
  s_lshl_b32 s4, s86, 6
  s_add_u32 s26, s26, s4
  s_mov_b32 s89, 200000
  v_mov_b32_e64 v32, 0
  s_waitcnt vmcnt(0)
  s_mov_b64 exec, 1
  buffer_store_dword v27, off, s[40:43], s14 sc0 sc1
  s_mov_b64 exec, -1
Lx_31:
  v_cmpx_ne_u64 vcc, v[176:177], v[240:241]
  v_cmpx_ne_u64 vcc, v[178:179], v[242:243]
  v_cmpx_ne_u64 vcc, v[180:181], v[244:245]
  v_cmpx_ne_u64 vcc, v[182:183], v[246:247]
  v_cmpx_ne_u64 vcc, v[184:185], v[248:249]
  v_cmpx_ne_u64 vcc, v[186:187], v[250:251]
  v_cmpx_ne_u64 vcc, v[188:189], v[252:253]
  v_cmpx_ne_u64 vcc, v[190:191], v[254:255]
  s_cmp_eq_u64 exec, -1
  s_cbranch_scc0 Lx_30
Lx_32:
  s_nop 1
  v_mfma_f32_16x16x32_bf16 v[128:131], v[226:229], v[176:179], v[128:131]
  v_mfma_f32_16x16x32_bf16 v[132:135], v[224:227], v[176:179], v[132:135]
  v_mfma_f32_16x16x32_bf16 v[136:139], v[226:229], v[180:183], v[136:139]
  v_mfma_f32_16x16x32_bf16 v[140:143], v[224:227], v[180:183], v[140:143]
  v_mfma_f32_16x16x32_bf16 v[144:147], v[226:229], v[184:187], v[144:147]
  v_mfma_f32_16x16x32_bf16 v[148:151], v[224:227], v[184:187], v[148:151]
  v_mfma_f32_16x16x32_bf16 v[152:155], v[226:229], v[188:191], v[152:155]
  v_mfma_f32_16x16x32_bf16 v[156:159], v[224:227], v[188:191], v[156:159]
  s_cmp_lg_u32 s82, 0
  s_cbranch_scc1 L_cfinal
  v_cvt_pk_bf16_f32 v240, v128, v129
  v_cvt_pk_bf16_f32 v241, v130, v131
  v_cvt_pk_bf16_f32 v242, v132, v133
  v_cvt_pk_bf16_f32 v243, v134, v135
  buffer_store_dwordx4 v[240:243], v0, s[40:43], s6 offen offset:0 sc0 sc1
  v_cvt_pk_bf16_f32 v244, v136, v137
  v_cvt_pk_bf16_f32 v245, v138, v139
  v_cvt_pk_bf16_f32 v246, v140, v141
  v_cvt_pk_bf16_f32 v247, v142, v143
  buffer_store_dwordx4 v[244:247], v0, s[40:43], s6 offen offset:2048 sc0 sc1
  v_cvt_pk_bf16_f32 v248, v144, v145
  v_cvt_pk_bf16_f32 v249, v146, v147
  v_cvt_pk_bf16_f32 v250, v148, v149
  v_cvt_pk_bf16_f32 v251, v150, v151
  buffer_store_dwordx4 v[248:251], v0, s[40:43], s7 offen offset:0 sc0 sc1
  v_cvt_pk_bf16_f32 v252, v152, v153
  v_cvt_pk_bf16_f32 v253, v154, v155
  v_cvt_pk_bf16_f32 v254, v156, v157
  v_cvt_pk_bf16_f32 v255, v158, v159
  buffer_store_dwordx4 v[252:255], v0, s[40:43], s7 offen offset:2048 sc0 sc1
  s_lshl_b32 s5, s78, Lz1-Lz0+1
  v_mov_b32 v40, 0x3f803f80
  v_dot2_f32_bf16 v32, v240, v40, 0
  v_dot2_f32_bf16 v36, v240, v240, 0
  v_dot2_f32_bf16 v33, v244, v40, 0
  v_dot2_f32_bf16 v37, v244, v244, 0
  v_dot2_f32_bf16 v34, v248, v40, 0
  v_dot2_f32_bf16 v38, v248, v248, 0
  v_dot2_f32_bf16 v35, v252, v40, 0
  v_dot2_f32_bf16 v39, v252, v252, 0
  v_dot2_f32_bf16 v32, v241, v40, v32
  v_dot2_f32_bf16 v36, v241, v241, v36
  v_dot2_f32_bf16 v33, v245, v40, v33
  v_dot2_f32_bf16 v37, v245, v245, v37
  v_dot2_f32_bf16 v34, v249, v40, v34
  v_dot2_f32_bf16 v38, v249, v249, v38
  v_dot2_f32_bf16 v35, v253, v40, v35
  v_dot2_f32_bf16 v39, v253, v253, v39
  v_dot2_f32_bf16 v32, v242, v40, v32
  v_dot2_f32_bf16 v36, v242, v242, v36
  v_dot2_f32_bf16 v33, v246, v40, v33
  v_dot2_f32_bf16 v37, v246, v246, v37
  v_dot2_f32_bf16 v34, v250, v40, v34
  v_dot2_f32_bf16 v38, v250, v250, v38
  v_dot2_f32_bf16 v35, v254, v40, v35
  v_dot2_f32_bf16 v39, v254, v254, v39
  v_dot2_f32_bf16 v32, v243, v40, v32
  v_dot2_f32_bf16 v36, v243, v243, v36
  v_dot2_f32_bf16 v33, v247, v40, v33
  v_dot2_f32_bf16 v37, v247, v247, v37
  v_dot2_f32_bf16 v34, v251, v40, v34
  v_dot2_f32_bf16 v38, v251, v251, v38
  v_dot2_f32_bf16 v35, v255, v40, v35
  v_dot2_f32_bf16 v39, v255, v255, v39
  s_lshl_b32 s6, s76, Lz1-Lz0+9
  s_lshl_b32 s7, s85, 8
  s_add_u32 s6, s6, s7
  s_add_u32 s6, s6, s5
  s_add_u32 s6, s6, s86
  s_lshl_b32 s6, s6, 6
  s_add_u32 s6, s6, s83
  s_add_u32 s6, s6, 36700160
  v_permlane32_swap_b32 v32, v34
  v_permlane32_swap_b32 v33, v35
  v_permlane32_swap_b32 v36, v38
  v_permlane32_swap_b32 v37, v39
  v_add_f32 v32, v32, v34
  v_add_f32 v33, v33, v35
  v_add_f32 v36, v36, v38
  v_add_f32 v37, v37, v39
  v_permlane16_swap_b32 v32, v33
  s_nop 0
  v_permlane16_swap_b32 v36, v37
  v_add_f32 v42, v32, v33
  v_add_f32_e64 v43, v36, v37
  buffer_store_dwordx2 v[42:43], v30, s[40:43], s6 offen sc0 sc1
  s_add_u32 s5, s87, 0x10
  s_sub_u32 s4, s78, s77
  s_lshl_b32 s4, s4, 7
  s_add_u32 s5, s5, s4
  s_waitcnt vmcnt(0)
  s_mov_b64 exec, 1
  ds_add_rtn_u32 v2, v28, v27 offset:0
  s_waitcnt lgkmcnt(0)
  v_readfirstlane_b32 s4, v2
  s_and_b32 s4, s4, Lz1-Lz0+3
  s_cmp_lg_u32 s4, 3
  s_cbranch_scc1 Ls_33
  s_mov_b32 exec_lo, 0xffff
  buffer_store_dword v27, v24, s[40:43], s5 offen sc0 sc1
Ls_33:
  s_nop 0
  s_mov_b64 exec, -1
  ds_write_b128 v0, v[240:243] offset:0
  ds_write_b128 v0, v[244:247] offset:2048
  ds_write_b128 v0, v[248:251] offset:4096
  ds_write_b128 v0, v[252:255] offset:6144
  s_mov_b32 s82, 1
  s_add_u32 s83, s83, 0
  s_add_u32 s87, s87, 32
  s_branch L_clayer
  s_nop 0
L_cfinal:
  s_nop 1
  v_cvt_pk_bf16_f32 v240, v128, v129
  v_cvt_pk_bf16_f32 v241, v130, v131
  v_cvt_pk_bf16_f32 v242, v132, v133
  v_cvt_pk_bf16_f32 v243, v134, v135
  s_nop 0
  v_permlane16_swap_b32 v240, v242
  v_permlane16_swap_b32_e64 v241, v243
  buffer_store_dwordx4 v[240:243], v3, s[64:67], s26 offen sc0 sc1
  s_add_u32 s26, s26, 0x10000
  v_cvt_pk_bf16_f32 v244, v136, v137
  v_cvt_pk_bf16_f32 v245, v138, v139
  v_cvt_pk_bf16_f32 v246, v140, v141
  v_cvt_pk_bf16_f32 v247, v142, v143
  s_nop 0
  v_permlane16_swap_b32 v244, v246
  v_permlane16_swap_b32_e64 v245, v247
  buffer_store_dwordx4 v[244:247], v3, s[64:67], s26 offen sc0 sc1
  s_add_u32 s26, s26, 0x10000
  v_cvt_pk_bf16_f32 v248, v144, v145
  v_cvt_pk_bf16_f32 v249, v146, v147
  v_cvt_pk_bf16_f32 v250, v148, v149
  v_cvt_pk_bf16_f32 v251, v150, v151
  s_nop 0
  v_permlane16_swap_b32 v248, v250
  v_permlane16_swap_b32_e64 v249, v251
  buffer_store_dwordx4 v[248:251], v3, s[64:67], s26 offen sc0 sc1
  s_add_u32 s26, s26, 0x10000
  v_cvt_pk_bf16_f32 v252, v152, v153
  v_cvt_pk_bf16_f32 v253, v154, v155
  v_cvt_pk_bf16_f32 v254, v156, v157
  v_cvt_pk_bf16_f32 v255, v158, v159
  s_nop 0
  v_permlane16_swap_b32 v252, v254
  v_permlane16_swap_b32_e64 v253, v255
  buffer_store_dwordx4 v[252:255], v3, s[64:67], s26 offen sc0 sc1
  s_endpgm
Lo_6:
  s_mov_b64 vcc, 0
  s_waitcnt lgkmcnt(0)
  s_barrier
  ds_read_b128 v[64:67], v4 offset:0
  ds_read_b128 v[80:83], v5 offset:0
  ds_read_b128 v[68:71], v4 offset:2048
  ds_read_b128 v[84:87], v5 offset:2048
  ds_read_b128 v[72:75], v4 offset:4096
  ds_read_b128 v[88:91], v5 offset:4096
  ds_read_b64_tr_b16 v[96:97], v6 offset:0
  ds_read_b64_tr_b16 v[98:99], v6 offset:2048
  ds_read_b64_tr_b16 v[100:101], v6 offset:4096
  ds_read_b64_tr_b16 v[102:103], v6 offset:6144
  ds_read_b128 v[76:79], v4 offset:6144
  ds_read_b128 v[92:95], v5 offset:6144
  ds_read_b64_tr_b16 v[104:105], v7 offset:0
  s_nop 0
  s_waitcnt lgkmcnt(8)
  ds_read_b64_tr_b16 v[106:107], v7 offset:2048
  ds_read_b64_tr_b16 v[108:109], v7 offset:4096
  ds_read_b64_tr_b16 v[110:111], v7 offset:6144
  s_waitcnt lgkmcnt(6)
  s_branch Lk_3
Lo_8:
  s_waitcnt lgkmcnt(0)
  s_branch Lo_7
Lx_30:
  s_mov_b64 exec, -1
  v_readfirstlane_b32 s5, v32
  s_sub_u32 s89, s89, 1
  s_cbranch_scc1 Lx_32
  buffer_load_dword v32, off, s[40:43], s13 sc0 sc1
  buffer_load_dwordx4 v[176:179], v0, s[40:43], s8 offen offset:0 sc0 sc1
  buffer_load_dwordx4 v[180:183], v0, s[40:43], s8 offen offset:2048 sc0 sc1
  buffer_load_dwordx4 v[184:187], v0, s[40:43], s9 offen offset:0 sc0 sc1
  buffer_load_dwordx4 v[188:191], v0, s[40:43], s9 offen offset:2048 sc0 sc1
  s_waitcnt vmcnt(0)
  s_cmp_lg_u32 s5, 0
  s_cbranch_scc1 Lx_32
  s_branch Lx_31
  s_nop 0
L_w1:
  s_lshl_b32 s11, s85, 12
  s_add_u32 s11, s11, 65536
  s_add_u32 s15, s11, 81920
  s_add_u32 s11, s11, 32768
  v_readfirstlane_b32 s7, v38
  s_mov_b32 s12, 0
  s_mov_b32 m0, s11
  s_waitcnt vmcnt(12)
  s_barrier
  s_branch Ll_47
Lt_54:
  s_cmp_lg_u32 s12, 2
  s_cbranch_scc1 Lt_52
  s_waitcnt vmcnt(8)
  s_barrier
  s_branch Ll_47
Lt_52:
  s_cmp_lg_u32 s12, 4
  s_cbranch_scc1 Ll_47
  s_barrier
Ll_47:
  buffer_load_dwordx4 v4, s[52:55], s7 offen offset:0  lds
  s_mov_b32 s5, s7
  buffer_load_dwordx4 v5, s[52:55], s5 offen offset:1024  lds
  s_add_u32 s12, s12, 1
  v_readlane_b32 s7, v38, s12
  s_add_u32 s11, s11, 8192
  s_nop 0
  s_cmp_eq_u32 s11, s15
  buffer_load_dwordx4 v6, s[52:55], s5 offen offset:2048  lds
  s_cselect_b32 s4, 81920, 0
  s_sub_u32 s11, s11, s4
  s_cmp_lg_u32 s12, 10
  buffer_load_dwordx4 v7, s[52:55], s5 offen offset:3072  lds
  s_mov_b32 m0, s11
  s_cbranch_scc1 Lt_54
Lt_55:
  v_mov_b32 v2, 156416
  v_mov_b32_e64 v3, 1
  s_waitcnt vmcnt(16)
  s_mov_b64 exec, 1
  ds_add_u32 v2, v3 offset:8
  s_mov_b64 exec, -1
  s_barrier
Ll_49:
  buffer_load_dwordx4 v4, s[52:55], s7 offen offset:0  lds
  s_mov_b32 s5, s7
  buffer_load_dwordx4 v5, s[52:55], s5 offen offset:1024  lds
  s_add_u32 s12, s12, 1
  v_readlane_b32 s7, v38, s12
  s_add_u32 s11, s11, 8192
  s_nop 0
  s_cmp_eq_u32 s11, s15
  buffer_load_dwordx4 v6, s[52:55], s5 offen offset:2048  lds
  s_cselect_b32 s4, 81920, 0
  s_sub_u32 s11, s11, s4
  s_cmp_lg_u32 s12, 16
  buffer_load_dwordx4 v7, s[52:55], s5 offen offset:3072  lds
  s_mov_b32 m0, s11
  s_cbranch_scc1 Ll_49
  v_lshrrev_b32 v2, 3, v1
  s_movk_i32 s4, 7168
  v_mad_u32_u24 v32, v2, s4, v10
  v_add_u32 v33, 56320, v32
  v_add_u32 v34, 112640, v32
  v_add_u32 v35, 168960, v32
  v_lshrrev_b32 v2, 2, v1
  s_movk_i32 s4, 7168
  v_mul_u32_u24_e64 v2, s4, v2
  v_bfe_u32 v3, v10, 5, 1
  v_lshl_add_u32 v2, v3, 4, v2
  v_and_b32 v3, 1, v1
  v_lshlrev_b32 v3, 5, v3
  v_add_u32_e64 v8, v2, v3
  v_add_u32 v9, 113664, v8
  s_mul_i32 s5, s77, 448
  s_and_b32 s4, s77, Lz1-Lz0+1
  s_mul_i32 s94, s4, 448
  s_sub_u32 s94, 384, s94
  s_lshl_b32 s4, s4, 6
  s_add_u32 s5, s5, s4
  s_mul_i32 s4, s85, 229376
  s_add_u32 s5, s5, s4
  s_and_b32 s4, s76, 7
  s_add_u32 s6, s4, 1
  v_cmp_lt_u32 vcc, s6, v1
  v_add_u32 v12, s4, v1
  s_nop 0
  v_subbrev_co_u32 v12, vcc, 0, v12, vcc
  v_and_b32 v12, 7, v12
  v_subrev_u32 v2, 9, v1
  v_cmp_le_u32 vcc, s4, v2
  s_nop 1
  v_addc_co_u32 v2, vcc, 8, v2, vcc
  v_cmp_le_u32 vcc, 9, v1
  s_nop 1
  v_cndmask_b32 v12, v12, v2, vcc
  s_add_u32 s4, s4, 8
  s_mov_b32 m0, s6
  s_nop 0
  v_writelane_b32 v12, s4, m0
  s_and_b32 s4, s76, 8
  v_xor_b32 v12, s4, v12
  v_cmp_eq_u32 vcc, s78, v12
  s_nop 0
  v_mov_b32_dpp v2, v12 row_shr:1 row_mask:0xf bank_mask:0xf
  s_ff1_i32_b32 s4, vcc_lo
  v_cmp_ge_u32 vcc, s4, v1
  s_nop 1
  v_cndmask_b32 v12, v12, v2, vcc
  v_writelane_b32 v12, s78, 0
  s_mov_b32 s4, 458752
  v_mul_u32_u24 v12, s4, v12
  v_add_u32 v12, s5, v12
  s_nop 0
  v_readfirstlane_b32 s7, v12
  s_lshl_b32 s11, s85, Lz1-Lz0+12
  s_add_u32 s11, s11, 65536
  s_add_u32 s15, s11, 86016
  s_lshl_b32 s4, s85, Lz1-Lz0+11
  s_sub_u32 s13, 24576, s4
  s_mul_i32 s5, s85, 6144
  s_nop 0
  s_mov_b32 s68, s28
  s_and_b32 s69, s29, 0xffff
  s_mov_b32 s70, 7340032
  s_mov_b32 s71, 0x00020000
  s_lshl_b32 s4, s76, 4
  s_add_u32 s4, s4, s77
  s_mul_i32 s34, s4, 28672
  s_add_u32 s34, s34, s5
  v_lshlrev_b32 v15, 4, v1
  s_lshl_b32 s91, s85, Lz1-Lz0+13
  s_add_u32 s91, s91, 4096
  s_mul_i32 s4, s76, 262144
  s_add_u32 s4, s4, 3145728
  s_add_u32 s4, s4, s91
  v_lshl_add_u32 v14, v39, 14, s4
  s_mov_b32 s12, 4
Lh_56:
  v_readlane_b32 s90, v14, s12
  s_mov_b32 m0, s91
  s_cmp_lt_u32 s12, Lz1-Lz0+7
  s_cbranch_scc1 Lh_57
  s_waitcnt vmcnt(8)
Lh_57:
  s_barrier
  buffer_load_dwordx4 v15, s[40:43], s90 offen offset:0 sc1 lds
  s_add_u32 s91, s91, 16384
  s_and_b32 s91, s91, 0xffff
  buffer_load_dwordx4 v15, s[40:43], s90 offen offset:1024 sc1 lds
  s_add_u32 s12, s12, 1
  s_cmp_lg_u32 s12, 16
  buffer_load_dwordx4 v15, s[40:43], s90 offen offset:2048 sc1 lds
  buffer_load_dwordx4 v15, s[40:43], s90 offen offset:3072 sc1 lds
  s_cbranch_scc1 Lh_56
  s_mov_b32 s12, 0
  s_mov_b32 m0, s11
  s_branch Ll_58
Lt_64:
  s_cmp_lg_u32 s12, 1
  s_cbranch_scc1 Ll_58
  s_waitcnt vmcnt(18)
  s_barrier
Ll_58:
  buffer_load_dwordx4 v32, s[56:59], s7 offen offset:0  lds
  buffer_load_dwordx4 v33, s[56:59], s7 offen offset:1024  lds
  buffer_load_dwordx4 v34, s[56:59], s7 offen offset:2048  lds
  buffer_load_dwordx4 v35, s[56:59], s7 offen offset:3072  lds
  s_add_u32 m0, s11, s13
  s_add_u32 s5, s7, s94
  buffer_load_dwordx4 v8, s[56:59], s5 offen offset:0  lds
  buffer_load_dwordx4 v9, s[56:59], s5 offen offset:1024  lds
  s_cmp_ge_u32 s12, Lz1-Lz0+2
  s_cbranch_scc1 Lm_65
  s_waitcnt vmcnt(20)
  s_cmp_lg_u32 s12, 0
  s_cbranch_scc1 Lm_66
  s_waitcnt vmcnt(14)
Lm_66:
  s_barrier
Lm_65:
  s_add_u32 m0, s11, 8192
  s_add_u32 s5, s7, 128
  buffer_load_dwordx4 v32, s[56:59], s5 offen offset:0  lds
  buffer_load_dwordx4 v33, s[56:59], s5 offen offset:1024  lds
  buffer_load_dwordx4 v34, s[56:59], s5 offen offset:2048  lds
  buffer_load_dwordx4 v35, s[56:59], s5 offen offset:3072  lds
  s_add_u32 m0, s11, 16384
  s_add_u32 s5, s7, 256
  buffer_load_dwordx4 v32, s[56:59], s5 offen offset:0  lds
  s_add_u32 s12, s12, Lz1-Lz0+1
  v_readlane_b32 s7, v12, s12
  s_add_u32 s11, s11, 28672
  buffer_load_dwordx4 v33, s[56:59], s5 offen offset:1024  lds
  s_cmp_eq_u32 s11, s15
  s_cselect_b32 s4, 86016, 0
  s_sub_u32 s11, s11, s4
  buffer_load_dwordx4 v34, s[56:59], s5 offen offset:2048  lds
  s_cmp_lg_u32 s12, Lz1-Lz0+2
  buffer_load_dwordx4 v35, s[56:59], s5 offen offset:3072  lds
  s_mov_b32 m0, s11
  s_cbranch_scc1 Ll_59
  s_barrier
Lt_67:
  s_waitcnt vmcnt(0)
  s_barrier
Ll_68:
Ll_59:
  s_cmp_lt_u32 s12, 3
  s_cbranch_scc1 Lt_64
  s_cmp_lg_u32 s82, 0
  s_cbranch_scc1 L_69
  s_lshl_b32 s5, s78, 7
  s_mul_i32 s4, s79, 3670016
  s_add_u32 s5, s5, s4
  v_subrev_u32 v2, 2, v1
  v_cmp_le_u32 vcc, 28, v1
  s_nop 1
  v_cndmask_b32 v37, v1, v2, vcc
  v_subrev_u32 v3, 3, v37
  v_mov_b32 v36, 4
  v_cmp_le_u32 vcc, 14, v37
  v_subrev_u32 v2, 14, v37
  s_nop 0
  v_cndmask_b32_e64 v3, v3, v2, vcc
  v_cndmask_b32_e64 v36, v36, 12, vcc
  v_cmp_le_u32 vcc, 21, v37
  v_subrev_u32 v2, 21, v37
  s_nop 0
  v_cndmask_b32 v3, v3, v2, vcc
  v_cndmask_b32_e64 v36, v36, 20, vcc
  s_sub_u32 s4, s80, s76
  s_and_b32 s4, s4, 7
  v_cmp_le_u32 vcc, s4, v3
  v_mov_b32 v2, s76
  s_nop 0
  v_addc_co_u32 v3, vcc, v3, v2, vcc
  v_and_b32 v3, 7, v3
  v_add_u32 v36, v36, v3
  v_add_u32 v2, v2, v1
  v_and_b32 v2, 3, v2
  v_subrev_u32 v3, 10, v1
  v_cmp_gt_u32 vcc, 4, v3
  s_nop 1
  v_cndmask_b32 v36, v36, v2, vcc
  s_add_u32 s4, s80, Lz1-Lz0+4
  v_lshl_add_u32 v2, v1, 3, s4
  v_cmp_gt_u32 vcc, 3, v1
  s_nop 1
  v_cndmask_b32 v36, v36, v2, vcc
  v_subrev_u32 v2, 4, v36
  v_and_b32 v3, 7, v2
  v_lshrrev_b32 v2, 3, v2
  v_mad_u32_u24 v2, v3, 7, v2
  v_and_b32 v3, 1, v3
  v_add_u32 v2, v2, v3
  s_mul_i32 s4, s85, 3
  v_add_u32 v2, s4, v2
  s_add_u32 s4, s85, Lz1-Lz0+6
  v_mad_u32_u24 v3, v36, 14, s4
  v_cmp_gt_u32 vcc, 4, v36
  s_nop 1
  v_cndmask_b32_e64 v2, v2, v3, vcc
  v_lshl_add_u32 v36, v2, 16, s5
  s_mul_i32 s4, s79, 7340032
  s_sub_u32 s4, 3670016, s4
  v_add_u32 v2, s4, v36
  v_cmp_le_u32 vcc, 28, v1
  s_nop 1
  v_cndmask_b32 v36, v36, v2, vcc
L_69:
  s_waitcnt vmcnt(14)
  s_barrier
  buffer_load_dwordx4 v32, s[56:59], s7 offen offset:0  lds
  buffer_load_dwordx4 v33, s[56:59], s7 offen offset:1024  lds
  buffer_load_dwordx4 v34, s[56:59], s7 offen offset:2048  lds
  buffer_load_dwordx4 v35, s[56:59], s7 offen offset:3072  lds
Ll_70:
  s_add_u32 m0, s11, s13
  s_add_u32 s5, s7, s94
  buffer_load_dwordx4 v8, s[56:59], s5 offen offset:0  lds
  buffer_load_dwordx4 v9, s[56:59], s5 offen offset:1024  lds
  s_add_u32 m0, s11, 8192
  s_add_u32 s5, s7, 128
  buffer_load_dwordx4 v32, s[56:59], s5 offen offset:0  lds
  buffer_load_dwordx4 v33, s[56:59], s5 offen offset:1024  lds
  buffer_load_dwordx4 v34, s[56:59], s5 offen offset:2048  lds
  buffer_load_dwordx4 v35, s[56:59], s5 offen offset:3072  lds
  s_add_u32 m0, s11, 16384
  s_add_u32 s5, s7, 256
  buffer_load_dwordx4 v32, s[56:59], s5 offen offset:0  lds
  s_add_u32 s12, s12, Lz1-Lz0+1
  v_readlane_b32 s7, v12, s12
  s_add_u32 s11, s11, 28672
  buffer_load_dwordx4 v33, s[56:59], s5 offen offset:1024  lds
  s_cmp_eq_u32 s11, s15
  s_cselect_b32 s4, 86016, 0
  s_sub_u32 s11, s11, s4
  buffer_load_dwordx4 v34, s[56:59], s5 offen offset:2048  lds
  s_cmp_eq_u32 s12, Lz1-Lz0+16
  buffer_load_dwordx4 v35, s[56:59], s5 offen offset:3072  lds
  s_mov_b32 m0, s11
  s_cbranch_scc1 Ll_71
  s_cmp_lg_u32 s82, 0
  s_cbranch_scc1 L_72
  s_buffer_load_dwordx2 s[98:99], s[68:71], s34 offset:60
  s_buffer_load_dwordx2 s[98:99], s[68:71], s34 offset:188
  s_buffer_load_dwordx2 s[98:99], s[68:71], s34 offset:316
  s_buffer_load_dwordx2 s[98:99], s[68:71], s34 offset:444
  s_add_u32 s34, s34, 512
L_72:
  s_waitcnt vmcnt(14)
  s_barrier
  buffer_load_dwordx4 v32, s[56:59], s7 offen offset:0  lds
  buffer_load_dwordx4 v33, s[56:59], s7 offen offset:1024  lds
  buffer_load_dwordx4 v34, s[56:59], s7 offen offset:2048  lds
  buffer_load_dwordx4 v35, s[56:59], s7 offen offset:3072  lds
  s_branch Ll_70
Ll_71:
  s_lshl_b32 s94, s79, 8
  s_sub_u32 s94, 128, s94
  s_lshl_b32 s11, s85, Lz1-Lz0+12
  s_add_u32 s11, s11, 65536
  s_add_u32 s15, s11, 81920
  s_add_u32 s11, s11, 49152
  v_readfirstlane_b32 s7, v36
  s_mov_b32 s12, 0
  s_mov_b32 m0, s11
  s_waitcnt vmcnt(14)
  s_barrier
  s_waitcnt vmcnt(0)
  s_barrier
  s_branch Ll_73
  s_nop 0
Lt_79:
  s_cmp_lg_u32 s12, 2
  s_cbranch_scc1 Ll_73
  s_barrier
Ll_73:
  buffer_load_dwordx4 v4, s[60:63], s7 offen offset:0  lds
  buffer_load_dwordx4 v5, s[60:63], s7 offen offset:1024  lds
  buffer_load_dwordx4 v6, s[60:63], s7 offen offset:2048  lds
  buffer_load_dwordx4 v7, s[60:63], s7 offen offset:3072  lds
  s_add_u32 m0, s11, 8192
  s_add_u32 s5, s7, s94
  buffer_load_dwordx4 v4, s[60:63], s5 offen offset:0  lds
  s_add_u32 s12, s12, 1
  v_readlane_b32 s7, v36, s12
  s_add_u32 s11, s11, 16384
  buffer_load_dwordx4 v5, s[60:63], s5 offen offset:1024  lds
  s_cmp_eq_u32 s11, s15
  s_cselect_b32 s4, 81920, 0
  s_sub_u32 s11, s11, s4
  buffer_load_dwordx4 v6, s[60:63], s5 offen offset:2048  lds
  s_cmp_lg_u32 s12, Lz1-Lz0+5
  buffer_load_dwordx4 v7, s[60:63], s5 offen offset:3072  lds
  s_mov_b32 m0, s11
  s_cbranch_scc1 Lt_79
Lt_80:
  s_cmp_lg_u32 s82, 0
  s_cbranch_scc1 L_81
  v_lshrrev_b32 v2, 3, v1
  s_movk_i32 s4, 6144
  v_mad_u32_u24 v16, v2, s4, v10
  v_add_u32 v17, 48128, v16
  v_add_u32 v18, 96256, v16
  v_add_u32 v19, 144384, v16
  s_lshl_b32 s5, s77, Lz1-Lz0+7
  s_mul_i32 s4, s85, 196608
  s_add_u32 s5, s5, s4
  s_and_b32 s4, s76, 7
  s_add_u32 s6, s4, 1
  v_cmp_lt_u32 vcc, s6, v1
  v_add_u32 v20, s4, v1
  s_nop 0
  v_subbrev_co_u32 v20, vcc, 0, v20, vcc
  v_and_b32 v20, 7, v20
  v_subrev_u32 v2, 9, v1
  v_cmp_le_u32 vcc, s4, v2
  s_nop 1
  v_addc_co_u32 v2, vcc, 8, v2, vcc
  v_cmp_le_u32 vcc, 9, v1
  s_nop 1
  v_cndmask_b32 v20, v20, v2, vcc
  s_add_u32 s4, s4, 8
  s_mov_b32 m0, s6
  s_nop 0
  v_writelane_b32 v20, s4, m0
  s_and_b32 s4, s76, 8
  v_xor_b32 v20, s4, v20
  v_cmp_eq_u32 vcc, s78, v20
  s_nop 0
  v_mov_b32_dpp v2, v20 row_shr:1 row_mask:0xf bank_mask:0xf
  s_ff1_i32_b32 s4, vcc_lo
  v_cmp_ge_u32 vcc, s4, v1
  s_nop 1
  v_cndmask_b32 v20, v20, v2, vcc
  v_writelane_b32 v20, s78, 0
  s_mov_b32 s4, 393216
  v_mul_u32_u24_e64 v20, s4, v20
  v_add_u32 v20, s5, v20
  s_mov_b32 m0, s11
L_81:
  s_waitcnt vmcnt(32)
  s_barrier
Ll_82:
  s_waitcnt vmcnt(24)
  s_barrier
  buffer_load_dwordx4 v4, s[60:63], s7 offen offset:0  lds
  buffer_load_dwordx4 v5, s[60:63], s7 offen offset:1024  lds
  buffer_load_dwordx4 v6, s[60:63], s7 offen offset:2048  lds
  buffer_load_dwordx4 v7, s[60:63], s7 offen offset:3072  lds
Ll_83:
  s_add_u32 m0, s11, 8192
  s_add_u32 s5, s7, s94
  buffer_load_dwordx4 v4, s[60:63], s5 offen offset:0  lds
  s_add_u32 s12, s12, 1
  v_readlane_b32 s7, v36, s12
  s_add_u32 s11, s11, 16384
  buffer_load_dwordx4 v5, s[60:63], s5 offen offset:1024  lds
  s_cmp_eq_u32 s11, s15
  s_cselect_b32 s4, 81920, 0
  s_sub_u32 s11, s11, s4
  buffer_load_dwordx4 v6, s[60:63], s5 offen offset:2048  lds
  s_cmp_eq_u32 s12, Lz1-Lz0+26
  buffer_load_dwordx4 v7, s[60:63], s5 offen offset:3072  lds
  s_mov_b32 m0, s11
  s_cbranch_scc1 Ll_84
  s_waitcnt vmcnt(24)
  s_barrier
  buffer_load_dwordx4 v4, s[60:63], s7 offen offset:0  lds
  buffer_load_dwordx4 v5, s[60:63], s7 offen offset:1024  lds
  buffer_load_dwordx4 v6, s[60:63], s7 offen offset:2048  lds
  buffer_load_dwordx4 v7, s[60:63], s7 offen offset:3072  lds
  s_branch Ll_83
  s_nop 0
Ll_84:
  s_waitcnt vmcnt(24)
  s_barrier
  buffer_load_dwordx4 v4, s[60:63], s7 offen offset:0  lds
Ll_85:
  s_mov_b32 s5, s7
  buffer_load_dwordx4 v5, s[60:63], s5 offen offset:1024  lds
  s_add_u32 s12, s12, 1
  v_readlane_b32 s7, v36, s12
  s_add_u32 s11, s11, 16384
  s_nop 0
  s_cmp_eq_u32 s11, s15
  buffer_load_dwordx4 v6, s[60:63], s5 offen offset:2048  lds
  s_cselect_b32 s4, 81920, 0
  s_sub_u32 s11, s11, s4
  s_cmp_eq_u32 s12, 30
  buffer_load_dwordx4 v7, s[60:63], s5 offen offset:3072  lds
  s_mov_b32 m0, s11
  s_cbranch_scc1 Ll_86
  s_waitcnt vmcnt(12)
  s_barrier
  buffer_load_dwordx4 v4, s[60:63], s7 offen offset:0  lds
  s_branch Ll_85
  s_nop 0
Ll_86:
  v_readfirstlane_b32 s7, v20
  s_lshl_b32 s11, s85, 12
  s_add_u32 s11, s11, 65536
  s_add_u32 s15, s11, 73728
  s_cmp_eq_u32 s82, 0
  s_mov_b32 s82, 1
  s_cbranch_scc1 L_wlayer
  s_waitcnt vmcnt(12)
  s_barrier
  s_waitcnt vmcnt(8)
  s_barrier
  s_waitcnt vmcnt(4)
  s_barrier
  s_waitcnt vmcnt(0)
  s_barrier
  s_barrier
  s_branch L_lend
  s_nop 0
L_x1:
  s_and_b32 s4, s77, 7
  s_lshr_b32 s5, s77, 3
  s_lshl1_add_u32 s4, s4, s5
  s_lshl_b32 s5, s76, 11
  s_add_u32 s4, s4, s5
  s_lshl_b32 s7, s4, 7
  s_movk_i32 s11, 16384
  s_mov_b32 m0, s11
  s_cmp_eq_u32 s82, 0
  s_waitcnt vmcnt(16)
  s_barrier
  s_cbranch_scc1 L_96
  s_waitcnt vmcnt(0)
  s_barrier
  s_barrier
  s_branch L_97
L_96:
  buffer_load_dwordx4 v4, s[72:75], s7 offen offset:0 sc1 lds
  buffer_load_dwordx4 v5, s[72:75], s7 offen offset:1024 sc1 lds
  buffer_load_dwordx4 v6, s[72:75], s7 offen offset:2048 sc1 lds
  buffer_load_dwordx4 v7, s[72:75], s7 offen offset:3072 sc1 lds
  s_add_u32 m0, s11, 4096
  s_nop 0
  s_add_u32 s5, s7, s13
  buffer_load_dwordx4 v4, s[72:75], s5 offen offset:0 sc1 lds
  buffer_load_dwordx4 v5, s[72:75], s5 offen offset:1024 sc1 lds
  buffer_load_dwordx4 v6, s[72:75], s5 offen offset:2048 sc1 lds
  buffer_load_dwordx4 v7, s[72:75], s5 offen offset:3072 sc1 lds
  s_add_u32 m0, s11, 8192
  s_nop 0
  s_add_u32 s3, s7, s95
  buffer_load_dwordx4 v4, s[72:75], s3 offen offset:0 sc1 lds
  buffer_load_dwordx4 v5, s[72:75], s3 offen offset:1024 sc1 lds
  buffer_load_dwordx4 v6, s[72:75], s3 offen offset:2048 sc1 lds
  buffer_load_dwordx4 v7, s[72:75], s3 offen offset:3072 sc1 lds
  s_add_u32 m0, s11, 12288
  s_nop 0
  s_add_u32 s5, s3, s13
  buffer_load_dwordx4 v4, s[72:75], s5 offen offset:0 sc1 lds
  buffer_load_dwordx4 v5, s[72:75], s5 offen offset:1024 sc1 lds
  buffer_load_dwordx4 v6, s[72:75], s5 offen offset:2048 sc1 lds
  buffer_load_dwordx4 v7, s[72:75], s5 offen offset:3072 sc1 lds
  s_waitcnt vmcnt(16)
  s_barrier
  s_waitcnt vmcnt(0)
  s_barrier
L_97:
  s_cmp_lg_u32 s82, 0
  s_cbranch_scc1 L_98
  s_and_b32 s80, s77, 7
  s_lshr_b32 s79, s77, 3
  s_lshl_b32 s78, s80, 1
  s_add_u32 s78, s78, s79
  s_lshl_b32 s5, s76, 4
  s_add_u32 s5, s5, s77
  s_lshl_b32 s84, s5, Lz1-Lz0+11
  s_mov_b32 s83, 3145728
  s_mov_b32 s87, 1835016
  s_lshr_b32 s86, s81, 1
  v_lshlrev_b32 v4, 4, v1
  v_lshlrev_b32 v5, 4, v1
  v_lshlrev_b32 v6, 4, v1
  v_lshlrev_b32 v7, 4, v1
  s_movk_i32 s13, 4096
  s_movk_i32 s95, 8192
  v_and_b32 v2, 31, v1
  v_lshlrev_b32 v8, 7, v2
L_98:
  s_mov_b32 s40, s38
  s_and_b32 s41, s39, 0xffff
  s_mov_b32 s42, 100663296
  s_mov_b32 s43, 0x00020000
  s_mov_b32 s72, s40
  s_mov_b32 s73, s41
  s_mov_b32 s74, s42
  s_mov_b32 s11, 0
  s_mov_b32 s15, 65536
  s_mul_i32 s5, s76, 16
  s_lshl_b32 s5, s5, 14
  s_add_u32 s5, s5, 3145728
  s_mul_i32 s4, s76, 14
  s_lshr_b32 s4, s4, 4
  v_add_u32 v9, s4, v1
  v_subrev_u32 v2, 14, v9
  v_min_u32 v9, v9, v2
  v_cmp_le_u32 vcc, 14, v1
  s_nop 1
  v_cndmask_b32 v9, v9, v1, vcc
  v_lshlrev_b32_e64 v9, 2, v9
  v_mov_b32 v2, 0x87654210
  v_mov_b32 v3, 0xb3fedca9
  v_lshrrev_b64 v[2:3], v9, v[2:3]
  v_and_b32_e64 v9, 15, v2
  v_cmp_eq_u32 vcc, s77, v9
  s_nop 0
  v_mov_b32_dpp v2, v9 row_shr:1 row_mask:0xf bank_mask:0xf
  s_ff1_i32_b32 s4, vcc_lo
  v_cmp_ge_u32 vcc, s4, v1
  s_nop 1
  v_cndmask_b32 v9, v9, v2, vcc
  v_writelane_b32 v9, s77, 0
  v_lshlrev_b32 v11, 7, v9
  v_lshl_add_u32 v9, v9, 14, s5
  s_nop 0
  v_readlane_b32 s7, v9, 1
  s_mov_b32 s11, 16384
  s_mov_b32 s90, 0xfe
  s_lshl_b32 s91, s84, Lz1-Lz0+1
  s_add_u32 s91, s91, s87
  s_barrier
  s_mov_b32 s89, 200000
  s_mov_b32 exec_lo, s90
  s_mov_b32 exec_hi, 0
  buffer_load_dword v12, v11, s[40:43], s91 offen sc0 sc1
Lp_99:
  s_waitcnt vmcnt(0)
  v_cmp_ne_u32 vcc, 0, v12
  s_andn2_b32 s3, exec_lo, vcc_lo
  s_cbranch_scc0 Lp_100
  s_mov_b32 exec_lo, s3
  s_sleep 1
  buffer_load_dword v12, v11, s[40:43], s91 offen sc0 sc1
  s_sub_u32 s89, s89, 1
  s_cbranch_scc0 Lp_99
Lp_100:
  s_mov_b64 exec, -1
  s_mov_b32 s12, 1
  s_mov_b32 m0, s11
Ll_102:
  s_nop 0
  buffer_load_dwordx4 v4, s[40:43], s7 offen offset:0 sc1 lds
  buffer_load_dwordx4 v5, s[40:43], s7 offen offset:1024 sc1 lds
  buffer_load_dwordx4 v6, s[40:43], s7 offen offset:2048 sc1 lds
  buffer_load_dwordx4 v7, s[40:43], s7 offen offset:3072 sc1 lds
  s_add_u32 m0, s11, 4096
  s_nop 0
  s_add_u32 s5, s7, s13
  buffer_load_dwordx4 v4, s[40:43], s5 offen offset:0 sc1 lds
  buffer_load_dwordx4 v5, s[40:43], s5 offen offset:1024 sc1 lds
  buffer_load_dwordx4 v6, s[40:43], s5 offen offset:2048 sc1 lds
  buffer_load_dwordx4 v7, s[40:43], s5 offen offset:3072 sc1 lds
  s_add_u32 m0, s11, 8192
  s_nop 0
  s_add_u32 s3, s7, s95
  buffer_load_dwordx4 v4, s[40:43], s3 offen offset:0 sc1 lds
  buffer_load_dwordx4 v5, s[40:43], s3 offen offset:1024 sc1 lds
  buffer_load_dwordx4 v6, s[40:43], s3 offen offset:2048 sc1 lds
  buffer_load_dwordx4 v7, s[40:43], s3 offen offset:3072 sc1 lds
  s_add_u32 m0, s11, 12288
  s_add_u32 s5, s3, s13
  buffer_load_dwordx4 v4, s[40:43], s5 offen offset:0 sc1 lds
  s_add_u32 s12, s12, 1
  v_readlane_b32 s7, v9, s12
  s_add_u32 s11, s11, 16384
  buffer_load_dwordx4 v5, s[40:43], s5 offen offset:1024 sc1 lds
  s_cmp_eq_u32 s11, s15
  s_cselect_b32 s4, 65536, 0
  s_sub_u32 s11, s11, s4
  buffer_load_dwordx4 v6, s[40:43], s5 offen offset:2048 sc1 lds
  s_cmp_lg_u32 s12, Lz1-Lz0+4
  buffer_load_dwordx4 v7, s[40:43], s5 offen offset:3072 sc1 lds
  s_mov_b32 m0, s11
  s_cbranch_scc1 Ll_102
  s_waitcnt vmcnt(32)
  s_barrier
  buffer_load_dwordx4 v4, s[40:43], s7 offen offset:0 sc1 lds
  buffer_load_dwordx4 v5, s[40:43], s7 offen offset:1024 sc1 lds
  buffer_load_dwordx4 v6, s[40:43], s7 offen offset:2048 sc1 lds
  buffer_load_dwordx4 v7, s[40:43], s7 offen offset:3072 sc1 lds
  s_add_u32 m0, s11, 8192
  s_add_u32 s3, s7, s95
  buffer_load_dwordx4 v4, s[40:43], s3 offen offset:0 sc1 lds
  s_add_u32 s12, s12, 1
  v_readlane_b32 s7, v9, s12
  buffer_load_dwordx4 v5, s[40:43], s3 offen offset:1024 sc1 lds
  s_add_u32 s11, s11, 16384
  s_nop 0
  s_cmp_eq_u32 s11, s15
  buffer_load_dwordx4 v6, s[40:43], s3 offen offset:2048 sc1 lds
  s_cselect_b32 s4, 65536, 0
  s_sub_u32 s11, s11, s4
  buffer_load_dwordx4 v7, s[40:43], s3 offen offset:3072 sc1 lds
  s_mov_b32 m0, s11
  s_waitcnt vmcnt(24)
  s_barrier
  buffer_load_dwordx4 v4, s[40:43], s7 offen offset:0 sc1 lds
  buffer_load_dwordx4 v5, s[40:43], s7 offen offset:1024 sc1 lds
  buffer_load_dwordx4 v6, s[40:43], s7 offen offset:2048 sc1 lds
  buffer_load_dwordx4 v7, s[40:43], s7 offen offset:3072 sc1 lds
Ll_107:
  s_add_u32 m0, s11, 8192
  s_add_u32 s3, s7, s95
  buffer_load_dwordx4 v4, s[40:43], s3 offen offset:0 sc1 lds
  s_add_u32 s12, s12, 1
  v_readlane_b32 s7, v9, s12
  s_add_u32 s11, s11, 16384
  buffer_load_dwordx4 v5, s[40:43], s3 offen offset:1024 sc1 lds
  s_cmp_eq_u32 s11, s15
  s_cselect_b32 s4, 65536, 0
  s_sub_u32 s11, s11, s4
  buffer_load_dwordx4 v6, s[40:43], s3 offen offset:2048 sc1 lds
  s_cmp_eq_u32 s12, Lz1-Lz0+16
  buffer_load_dwordx4 v7, s[40:43], s3 offen offset:3072 sc1 lds
  s_mov_b32 m0, s11
  s_cbranch_scc1 Ll_108
  s_waitcnt vmcnt(16)
  s_barrier
  buffer_load_dwordx4 v4, s[40:43], s7 offen offset:0 sc1 lds
  buffer_load_dwordx4 v5, s[40:43], s7 offen offset:1024 sc1 lds
  buffer_load_dwordx4 v6, s[40:43], s7 offen offset:2048 sc1 lds
  buffer_load_dwordx4 v7, s[40:43], s7 offen offset:3072 sc1 lds
  s_branch Ll_107
  s_nop 0
Ll_108:
  s_waitcnt vmcnt(16)
  s_barrier
  s_waitcnt vmcnt(8)
  s_barrier
  s_waitcnt vmcnt(0)
  s_barrier
  s_barrier
  s_mov_b32 s11, 0
  s_mov_b32 s15, 65536
  s_mul_i32 s5, s76, 16
  s_lshl_b32 s5, s5, 14
  s_add_u32 s5, s5, 7340032
  s_and_b32 s4, s76, 7
  s_add_u32 s6, s4, 1
  v_cmp_lt_u32 vcc, s6, v1
  v_add_u32 v9, s4, v1
  s_nop 0
  v_subbrev_co_u32 v9, vcc, 0, v9, vcc
  v_and_b32 v9, 7, v9
  v_subrev_u32 v2, 9, v1
  v_cmp_le_u32 vcc, s4, v2
  s_nop 1
  v_addc_co_u32 v2, vcc, 8, v2, vcc
  v_cmp_le_u32 vcc, 9, v1
  s_nop 1
  v_cndmask_b32 v9, v9, v2, vcc
  s_add_u32 s4, s4, Lz1-Lz0+8
  s_mov_b32 m0, s6
  s_nop 0
  v_writelane_b32 v9, s4, m0
  s_and_b32 s4, s76, 8
  v_xor_b32 v9, s4, v9
  v_cmp_eq_u32 vcc, s78, v9
  s_nop 0
  v_mov_b32_dpp v2, v9 row_shr:1 row_mask:0xf bank_mask:0xf
  s_ff1_i32_b32 s4, vcc_lo
  v_cmp_ge_u32 vcc, s4, v1
  s_nop 1
  v_cndmask_b32 v9, v9, v2, vcc
  v_writelane_b32 v9, s78, 0
  v_lshlrev_b32_e64 v11, 7, v9
  v_lshl_add_u32 v9, v9, 14, s5
  s_lshl_b32 s6, s76, Lz1-Lz0+14
  v_readlane_b32 s7, v9, 1
  s_mov_b32 s11, 16384
  s_mov_b32 s90, Lz1-Lz0+62
  s_add_u32 s91, s91, 4
  s_barrier
  s_mov_b32 s89, 200000
  s_mov_b32 exec_lo, s90
  s_mov_b32 exec_hi, 0
  buffer_load_dword v12, v11, s[40:43], s91 offen sc0 sc1
Lp_109:
  s_waitcnt vmcnt(0)
  v_cmp_ne_u32 vcc, 0, v12
  s_andn2_b32 s3, exec_lo, vcc_lo
  s_cbranch_scc0 Lp_110
  s_mov_b32 exec_lo, s3
  s_sleep 1
  buffer_load_dword v12, v11, s[40:43], s91 offen sc0 sc1
  s_sub_u32 s89, s89, 1
  s_cbranch_scc0 Lp_109
Lp_110:
  s_mov_b64 exec, -1
  s_mov_b32 s12, 1
  s_mov_b32 m0, s11
Ll_112:
  s_nop 0
  buffer_load_dwordx4 v4, s[72:75], s7 offen offset:0 sc1 lds
  buffer_load_dwordx4 v5, s[72:75], s7 offen offset:1024 sc1 lds
  buffer_load_dwordx4 v6, s[72:75], s7 offen offset:2048 sc1 lds
  buffer_load_dwordx4 v7, s[72:75], s7 offen offset:3072 sc1 lds
  s_add_u32 m0, s11, 4096
  s_nop 0
  s_add_u32 s5, s7, s13
  buffer_load_dwordx4 v4, s[72:75], s5 offen offset:0 sc1 lds
  buffer_load_dwordx4 v5, s[72:75], s5 offen offset:1024 sc1 lds
  buffer_load_dwordx4 v6, s[72:75], s5 offen offset:2048 sc1 lds
  buffer_load_dwordx4 v7, s[72:75], s5 offen offset:3072 sc1 lds
  s_add_u32 m0, s11, 8192
  s_nop 0
  s_add_u32 s3, s7, s95
  buffer_load_dwordx4 v4, s[72:75], s3 offen offset:0 sc1 lds
  buffer_load_dwordx4 v5, s[72:75], s3 offen offset:1024 sc1 lds
  buffer_load_dwordx4 v6, s[72:75], s3 offen offset:2048 sc1 lds
  buffer_load_dwordx4 v7, s[72:75], s3 offen offset:3072 sc1 lds
  s_add_u32 m0, s11, 12288
  s_add_u32 s5, s3, s13
  buffer_load_dwordx4 v4, s[72:75], s5 offen offset:0 sc1 lds
  s_add_u32 s12, s12, 1
  v_readlane_b32 s7, v9, s12
  s_add_u32 s11, s11, 16384
  buffer_load_dwordx4 v5, s[72:75], s5 offen offset:1024 sc1 lds
  s_cmp_eq_u32 s11, s15
  s_cselect_b32 s4, 65536, 0
  s_sub_u32 s11, s11, s4
  buffer_load_dwordx4 v6, s[72:75], s5 offen offset:2048 sc1 lds
  s_cmp_lg_u32 s12, Lz1-Lz0+4
  buffer_load_dwordx4 v7, s[72:75], s5 offen offset:3072 sc1 lds
  s_mov_b32 m0, s11
  s_cbranch_scc1 Ll_112
  s_waitcnt vmcnt(32)
  s_barrier
  buffer_load_dwordx4 v4, s[72:75], s7 offen offset:0 sc1 lds
  buffer_load_dwordx4 v5, s[72:75], s7 offen offset:1024 sc1 lds
  buffer_load_dwordx4 v6, s[72:75], s7 offen offset:2048 sc1 lds
  buffer_load_dwordx4 v7, s[72:75], s7 offen offset:3072 sc1 lds
Ll_117:
  s_add_u32 m0, s11, 4096
  s_nop 0
  s_add_u32 s5, s7, s13
  buffer_load_dwordx4 v4, s[72:75], s5 offen offset:0 sc1 lds
  buffer_load_dwordx4 v5, s[72:75], s5 offen offset:1024 sc1 lds
  buffer_load_dwordx4 v6, s[72:75], s5 offen offset:2048 sc1 lds
  buffer_load_dwordx4 v7, s[72:75], s5 offen offset:3072 sc1 lds
  s_add_u32 m0, s11, 8192
  s_nop 0
  s_add_u32 s3, s7, s95
  buffer_load_dwordx4 v4, s[72:75], s3 offen offset:0 sc1 lds
  buffer_load_dwordx4 v5, s[72:75], s3 offen offset:1024 sc1 lds
  buffer_load_dwordx4 v6, s[72:75], s3 offen offset:2048 sc1 lds
  buffer_load_dwordx4 v7, s[72:75], s3 offen offset:3072 sc1 lds
  s_add_u32 m0, s11, 12288
  s_add_u32 s5, s3, s13
  buffer_load_dwordx4 v4, s[72:75], s5 offen offset:0 sc1 lds
  s_add_u32 s12, s12, 1
  v_readlane_b32 s7, v9, s12
  s_add_u32 s11, s11, 16384
  buffer_load_dwordx4 v5, s[72:75], s5 offen offset:1024 sc1 lds
  s_cmp_eq_u32 s11, s15
  s_cselect_b32 s4, 65536, 0
  s_sub_u32 s11, s11, s4
  buffer_load_dwordx4 v6, s[72:75], s5 offen offset:2048 sc1 lds
  s_cmp_eq_u32 s12, Lz1-Lz0+16
  buffer_load_dwordx4 v7, s[72:75], s5 offen offset:3072 sc1 lds
  s_mov_b32 m0, s11
  s_cbranch_scc1 Ll_118
  s_waitcnt vmcnt(32)
  s_barrier
  buffer_load_dwordx4 v4, s[72:75], s7 offen offset:0 sc1 lds
  buffer_load_dwordx4 v5, s[72:75], s7 offen offset:1024 sc1 lds
  buffer_load_dwordx4 v6, s[72:75], s7 offen offset:2048 sc1 lds
  buffer_load_dwordx4 v7, s[72:75], s7 offen offset:3072 sc1 lds
  s_branch Ll_117
  s_nop 0
Ll_118:
  s_waitcnt vmcnt(32)
  s_barrier
  s_waitcnt vmcnt(16)
  s_barrier
  s_waitcnt vmcnt(0)
  s_barrier
  s_barrier
  s_mov_b32 s11, 0
  s_mov_b32 s15, 65536
  s_mul_i32 s5, s76, 56
  s_mul_i32 s4, s79, 28
  s_add_u32 s5, s5, s4
  s_lshl_b32 s5, s5, 14
  s_add_u32 s5, s5, 11534336
  v_subrev_u32 v2, 2, v1
  v_cmp_le_u32 vcc, 28, v1
  s_nop 1
  v_cndmask_b32 v10, v1, v2, vcc
  v_subrev_u32 v3, 3, v10
  v_mov_b32 v9, 4
  v_cmp_le_u32 vcc, 14, v10
  v_subrev_u32 v2, 14, v10
  s_nop 0
  v_cndmask_b32 v3, v3, v2, vcc
  v_cndmask_b32_e64 v9, v9, 12, vcc
  v_cmp_le_u32 vcc, 21, v10
  v_subrev_u32 v2, 21, v10
  s_nop 0
  v_cndmask_b32 v3, v3, v2, vcc
  v_cndmask_b32_e64 v9, v9, 20, vcc
  s_sub_u32 s4, s80, s76
  s_and_b32 s4, s4, 7
  v_cmp_le_u32 vcc, s4, v3
  v_mov_b32 v2, s76
  s_nop 0
  v_addc_co_u32 v3, vcc, v3, v2, vcc
  v_and_b32 v3, 7, v3
  v_add_u32 v9, v9, v3
  v_add_u32 v2, v2, v1
  v_and_b32 v2, 3, v2
  v_subrev_u32 v3, 10, v1
  v_cmp_gt_u32 vcc, 4, v3
  s_nop 1
  v_cndmask_b32 v9, v9, v2, vcc
  s_add_u32 s4, s80, Lz1-Lz0+4
  v_lshl_add_u32 v2, v1, 3, s4
  v_cmp_gt_u32 vcc, 3, v1
  s_nop 1
  v_cndmask_b32_e64 v9, v9, v2, vcc
  v_lshl_add_u32 v9, v9, 14, s5
  s_mul_i32 s4, s79, 917504
  s_sub_u32 s4, 458752, s4
  v_add_u32_e64 v2, s4, v9
  v_cmp_le_u32 vcc, 28, v1
  s_nop 1
  v_cndmask_b32 v9, v9, v2, vcc
  s_nop 0
  v_readlane_b32 s7, v9, 3
  s_mov_b32 s11, 49152
  s_add_u32 s91, s91, 4
  s_lshl_b32 s4, s79, 3
  s_lshl_b32 s90, 0xff, s4
  s_bitset0_b32 s90, s77
  v_mov_b32 v2, 156420
  s_lshl_b32 s5, s82, 2
  s_add_u32 s5, s5, Lz1-Lz0+1
  s_mov_b32 s89, 200000
  s_mov_b32 s92, 1
  s_mov_b32 exec_lo, s90
  s_mov_b32 exec_hi, Lz1-Lz0+0
  buffer_load_dword v12, v8, s[40:43], s91 offen sc0 sc1
Lp_119:
  s_waitcnt vmcnt(0)
  v_cmp_ne_u32 vcc, 0, v12
  s_andn2_b32 s3, exec_lo, vcc_lo
  s_cbranch_scc0 Lp_121
  s_mov_b32 exec_lo, s3
  s_cmp_eq_u32 s92, 0
  s_cbranch_scc1 Lp_120
  ds_read_b32 v3, v2
  s_waitcnt lgkmcnt(0)
  buffer_load_dword v12, v8, s[40:43], s91 offen sc0 sc1
  v_readfirstlane_b32 s4, v3
  s_cmp_lt_u32 s4, s5
  s_cbranch_scc1 Lp_122
  s_mov_b32 s92, 0
  s_barrier
  s_branch Lp_122
  s_nop 0
Lp_120:
  s_sleep 1
  buffer_load_dword v12, v8, s[40:43], s91 offen sc0 sc1
Lp_122:
  s_sub_u32 s89, s89, 1
  s_cbranch_scc0 Lp_119
Lp_121:
  s_mov_b64 exec, -1
  s_cmp_eq_u32 s92, 0
  s_cbranch_scc1 Lp_123
  s_barrier
Lp_123:
  s_mov_b32 s12, Lz1-Lz0+3
  s_mov_b32 m0, s11
Ll_124:
  s_nop 0
  buffer_load_dwordx4 v4, s[40:43], s7 offen offset:0 sc1 lds
  buffer_load_dwordx4 v5, s[40:43], s7 offen offset:1024 sc1 lds
  buffer_load_dwordx4 v6, s[40:43], s7 offen offset:2048 sc1 lds
  buffer_load_dwordx4 v7, s[40:43], s7 offen offset:3072 sc1 lds
  s_add_u32 m0, s11, 4096
  s_nop 0
  s_add_u32 s5, s7, s13
  buffer_load_dwordx4 v4, s[40:43], s5 offen offset:0 sc1 lds
  buffer_load_dwordx4 v5, s[40:43], s5 offen offset:1024 sc1 lds
  buffer_load_dwordx4 v6, s[40:43], s5 offen offset:2048 sc1 lds
  buffer_load_dwordx4 v7, s[40:43], s5 offen offset:3072 sc1 lds
  s_add_u32 m0, s11, 8192
  s_nop 0
  s_add_u32 s3, s7, s95
  buffer_load_dwordx4 v4, s[40:43], s3 offen offset:0 sc1 lds
  buffer_load_dwordx4 v5, s[40:43], s3 offen offset:1024 sc1 lds
  buffer_load_dwordx4 v6, s[40:43], s3 offen offset:2048 sc1 lds
  buffer_load_dwordx4 v7, s[40:43], s3 offen offset:3072 sc1 lds
  s_add_u32 m0, s11, 12288
  s_add_u32 s5, s3, s13
  buffer_load_dwordx4 v4, s[40:43], s5 offen offset:0 sc1 lds
  s_add_u32 s12, s12, 1
  v_readlane_b32 s7, v9, s12
  s_add_u32 s11, s11, 16384
  buffer_load_dwordx4 v5, s[40:43], s5 offen offset:1024 sc1 lds
  s_cmp_eq_u32 s11, s15
  s_cselect_b32 s4, 65536, 0
  s_sub_u32 s11, s11, s4
  buffer_load_dwordx4 v6, s[40:43], s5 offen offset:2048 sc1 lds
  s_cmp_lg_u32 s12, Lz1-Lz0+4
  buffer_load_dwordx4 v7, s[40:43], s5 offen offset:3072 sc1 lds
  s_mov_b32 m0, s11
  s_cbranch_scc1 Ll_124
  s_waitcnt vmcnt(32)
  s_barrier
  buffer_load_dwordx4 v4, s[40:43], s7 offen offset:0 sc1 lds
  buffer_load_dwordx4 v5, s[40:43], s7 offen offset:1024 sc1 lds
  buffer_load_dwordx4 v6, s[40:43], s7 offen offset:2048 sc1 lds
  buffer_load_dwordx4 v7, s[40:43], s7 offen offset:3072 sc1 lds
Ll_129:
  s_add_u32 m0, s11, 4096
  s_nop 0
  s_add_u32 s5, s7, s13
  buffer_load_dwordx4 v4, s[40:43], s5 offen offset:0 sc1 lds
  buffer_load_dwordx4 v5, s[40:43], s5 offen offset:1024 sc1 lds
  buffer_load_dwordx4 v6, s[40:43], s5 offen offset:2048 sc1 lds
  buffer_load_dwordx4 v7, s[40:43], s5 offen offset:3072 sc1 lds
  s_add_u32 m0, s11, 8192
  s_nop 0
  s_add_u32 s3, s7, s95
  buffer_load_dwordx4 v4, s[40:43], s3 offen offset:0 sc1 lds
  buffer_load_dwordx4 v5, s[40:43], s3 offen offset:1024 sc1 lds
  buffer_load_dwordx4 v6, s[40:43], s3 offen offset:2048 sc1 lds
  buffer_load_dwordx4 v7, s[40:43], s3 offen offset:3072 sc1 lds
  s_add_u32 m0, s11, 12288
  s_add_u32 s5, s3, s13
  buffer_load_dwordx4 v4, s[40:43], s5 offen offset:0 sc1 lds
  s_add_u32 s12, s12, 1
  v_readlane_b32 s7, v9, s12
  s_add_u32 s11, s11, 16384
  buffer_load_dwordx4 v5, s[40:43], s5 offen offset:1024 sc1 lds
  s_cmp_eq_u32 s11, s15
  s_cselect_b32 s4, 65536, 0
  s_sub_u32 s11, s11, s4
  buffer_load_dwordx4 v6, s[40:43], s5 offen offset:2048 sc1 lds
  s_cmp_eq_u32 s12, Lz1-Lz0+30
  buffer_load_dwordx4 v7, s[40:43], s5 offen offset:3072 sc1 lds
  s_mov_b32 m0, s11
  s_cbranch_scc1 Ll_130
  s_waitcnt vmcnt(32)
  s_barrier
  buffer_load_dwordx4 v4, s[40:43], s7 offen offset:0 sc1 lds
  buffer_load_dwordx4 v5, s[40:43], s7 offen offset:1024 sc1 lds
  buffer_load_dwordx4 v6, s[40:43], s7 offen offset:2048 sc1 lds
  buffer_load_dwordx4 v7, s[40:43], s7 offen offset:3072 sc1 lds
  s_branch Ll_129
  s_nop 0
Ll_130:
  s_waitcnt vmcnt(32)
  s_barrier
  s_waitcnt vmcnt(16)
  s_barrier
  s_waitcnt vmcnt(0)
  s_barrier
  s_barrier
  s_cmp_lg_u32 s82, 0
  s_cbranch_scc1 L_lend
  s_mov_b32 s11, 0
  s_mov_b32 s15, 65536
  s_mul_i32 s5, s76, 16
  s_lshl_b32 s5, s5, 14
  s_add_u32 s5, s5, 35651584
  s_and_b32 s4, s76, 7
  s_add_u32 s6, s4, 1
  v_cmp_lt_u32 vcc, s6, v1
  v_add_u32 v9, s4, v1
  s_nop 0
  v_subbrev_co_u32 v9, vcc, 0, v9, vcc
  v_and_b32 v9, 7, v9
  v_subrev_u32 v2, 9, v1
  v_cmp_le_u32 vcc, s4, v2
  s_nop 1
  v_addc_co_u32 v2, vcc, 8, v2, vcc
  v_cmp_le_u32 vcc, 9, v1
  s_nop 1
  v_cndmask_b32 v9, v9, v2, vcc
  s_add_u32 s4, s4, Lz1-Lz0+8
  s_mov_b32 m0, s6
  s_nop 0
  v_writelane_b32 v9, s4, m0
  s_and_b32 s4, s76, 8
  v_xor_b32 v9, s4, v9
  v_cmp_eq_u32 vcc, s78, v9
  s_nop 0
  v_mov_b32_dpp v2, v9 row_shr:1 row_mask:0xf bank_mask:0xf
  s_ff1_i32_b32 s4, vcc_lo
  v_cmp_ge_u32 vcc, s4, v1
  s_nop 1
  v_cndmask_b32 v9, v9, v2, vcc
  v_writelane_b32 v9, s78, 0
  v_lshlrev_b32_e64 v11, 7, v9
  v_lshl_add_u32 v9, v9, 14, s5
  s_lshl_b32 s6, s76, Lz1-Lz0+14
  v_readlane_b32 s7, v9, 1
  s_mov_b32 s11, 16384
  s_add_u32 s91, s91, 8
  s_mov_b32 s90, 0x3e
  s_barrier
  s_mov_b32 s82, 1
  s_add_u32 s83, s83, 0
  s_add_u32 s87, s87, 32
  s_mov_b32 s89, 200000
  s_mov_b32 exec_lo, s90
  s_mov_b32 exec_hi, 0
  buffer_load_dword v12, v11, s[40:43], s91 offen sc0 sc1
Lp_131:
  s_waitcnt vmcnt(0)
  v_cmp_ne_u32 vcc, 0, v12
  s_andn2_b32 s3, exec_lo, vcc_lo
  s_cbranch_scc0 Lp_132
  s_mov_b32 exec_lo, s3
  s_sleep 1
  buffer_load_dword v12, v11, s[40:43], s91 offen sc0 sc1
  s_sub_u32 s89, s89, 1
  s_cbranch_scc0 Lp_131
Lp_132:
  s_mov_b64 exec, -1
  s_branch L_xlayer
  s_nop 0
L_s1:
  v_mov_b32 v11, 1
  v_mov_b32 v2, 156416
  ds_write_b128 v2, v[24:27]
  v_and_b32 v2, 31, v1
  v_lshlrev_b32 v5, 7, v2
  v_lshlrev_b32 v10, 3, v2
  v_lshrrev_b32 v3, 5, v1
  v_mul_u32_u24 v3, 320, v3
  v_add_u32_e64 v10, v3, v10
  v_add_u32 v10, 151552, v10
  v_bfe_u32 v3, v1, 3, 1
  v_and_b32 v2, 7, v1
  v_lshlrev_b32 v12, 9, v3
  v_lshl_add_u32 v12, v2, 4, v12
  v_mul_u32_u24 v3, 320, v3
  v_lshl_add_u32 v13, v2, 3, v3
  v_add_u32 v13, 151808, v13
  v_and_b32 v2, 15, v1
  v_lshlrev_b32 v8, 4, v2
  v_lshlrev_b32 v15, 6, v2
  v_and_b32 v3, 48, v1
  v_add_u32 v15, v15, v3
  v_and_b32 v2, 14, v1
  v_lshlrev_b32 v6, 2, v2
  v_lshlrev_b32 v14, 16, v1
  s_lshl_b32 s4, s77, 12
  s_lshl_b32 s5, s76, 7
  s_add_u32 s4, s4, s5
  v_add_u32 v14, s4, v14
  v_lshrrev_b32 v2, 2, v1
  v_lshlrev_b32 v22, 7, v2
  v_lshlrev_b32 v96, 6, v2
  v_and_b32 v2, 3, v1
  v_lshl_add_u32 v22, v2, 3, v22
  v_lshl_add_u32 v96, v2, 3, v96
  v_add_u32 v22, 65536, v22
  v_add_u32 v96, 90112, v96
  v_bfe_u32 v3, v1, 3, 2
  v_xor_b32_e64 v2, 0, v3
  v_lshl_add_u32 v16, v2, 5, v22
  v_xor_b32_e64 v2, 1, v3
  v_lshl_add_u32 v17, v2, 5, v22
  v_xor_b32_e64 v2, 2, v3
  v_lshl_add_u32 v18, v2, 5, v22
  v_xor_b32_e64 v2, 3, v3
  v_lshl_add_u32 v19, v2, 5, v22
  v_bfe_u32 v3, v1, 4, 1
  v_xor_b32_e64 v2, 0, v3
  v_lshl_add_u32 v20, v2, 5, v96
  v_xor_b32_e64 v2, 1, v3
  v_lshl_add_u32 v21, v2, 5, v96
  v_mov_b32 v22, 0x3f803f80
  s_mul_i32 s4, s76, 11
  s_lshr_b32 s4, s4, 5
  s_mul_i32 s4, s4, 3
  s_and_b32 s14, s76, 1
  s_mov_b32 s15, 32768
  s_mul_i32 s4, s14, 24576
  v_add_u32 v16, s4, v16
  v_add_u32 v17, s4, v17
  v_add_u32 v18, s4, v18
  v_add_u32 v19, s4, v19
  s_mov_b32 s98, 0x00010001
  s_mov_b32 s99, 0x00010001
  v_cndmask_b32_e64 v200, 0, v22, s[98:99]
  v_cndmask_b32_e64 v201, 0, v22, s[98:99]
  v_cndmask_b32_e64 v202, 0, v22, s[98:99]
  v_cndmask_b32_e64 v203, 0, v22, s[98:99]
  s_nop 0
  s_lshl_b64 s[98:99], s[98:99], 1
  v_cndmask_b32_e64 v204, 0, v22, s[98:99]
  v_cndmask_b32_e64 v205, 0, v22, s[98:99]
  v_cndmask_b32_e64 v206, 0, v22, s[98:99]
  v_cndmask_b32_e64 v207, 0, v22, s[98:99]
  s_nop 0
  s_lshl_b64 s[98:99], s[98:99], 1
  v_cndmask_b32_e64 v208, 0, v22, s[98:99]
  v_cndmask_b32_e64 v209, 0, v22, s[98:99]
  v_cndmask_b32_e64 v210, 0, v22, s[98:99]
  v_cndmask_b32_e64 v211, 0, v22, s[98:99]
  s_nop 0
  s_lshl_b64 s[98:99], s[98:99], 1
  v_cndmask_b32_e64 v212, 0, v22, s[98:99]
  v_cndmask_b32_e64 v213, 0, v22, s[98:99]
  v_cndmask_b32_e64 v214, 0, v22, s[98:99]
  v_cndmask_b32_e64 v215, 0, v22, s[98:99]
  s_nop 0
  s_lshl_b64 s[98:99], s[98:99], 1
  v_cndmask_b32_e64 v216, 0, v22, s[98:99]
  v_cndmask_b32_e64 v217, 0, v22, s[98:99]
  v_cndmask_b32_e64 v218, 0, v22, s[98:99]
  v_cndmask_b32_e64 v219, 0, v22, s[98:99]
  s_nop 0
  s_lshl_b64 s[98:99], s[98:99], 1
  v_cndmask_b32_e64 v220, 0, v22, s[98:99]
  v_cndmask_b32_e64 v221, 0, v22, s[98:99]
  v_cndmask_b32_e64 v222, 0, v22, s[98:99]
  v_cndmask_b32_e64 v223, 0, v22, s[98:99]
  s_nop 0
  s_lshl_b64 s[98:99], s[98:99], 1
  v_cndmask_b32_e64 v224, 0, v22, s[98:99]
  v_cndmask_b32_e64 v225, 0, v22, s[98:99]
  v_cndmask_b32_e64 v226, 0, v22, s[98:99]
  v_cndmask_b32_e64 v227, 0, v22, s[98:99]
  s_nop 0
  s_lshl_b64 s[98:99], s[98:99], 1
  v_cndmask_b32_e64 v228, 0, v22, s[98:99]
  v_cndmask_b32_e64 v229, 0, v22, s[98:99]
  v_cndmask_b32_e64 v230, 0, v22, s[98:99]
  v_cndmask_b32_e64 v231, 0, v22, s[98:99]
  s_nop 0
  s_lshl_b64 s[98:99], s[98:99], 1
  v_cndmask_b32_e64 v232, 0, v22, s[98:99]
  v_cndmask_b32_e64 v233, 0, v22, s[98:99]
  v_cndmask_b32_e64 v234, 0, v22, s[98:99]
  v_cndmask_b32_e64 v235, 0, v22, s[98:99]
  s_nop 0
  s_lshl_b64 s[98:99], s[98:99], 1
  v_cndmask_b32_e64 v236, 0, v22, s[98:99]
  v_cndmask_b32_e64 v237, 0, v22, s[98:99]
  v_cndmask_b32_e64 v238, 0, v22, s[98:99]
  v_cndmask_b32_e64 v239, 0, v22, s[98:99]
  s_nop 0
  s_lshl_b64 s[98:99], s[98:99], 1
  v_cndmask_b32_e64 v240, 0, v22, s[98:99]
  v_cndmask_b32_e64 v241, 0, v22, s[98:99]
  v_cndmask_b32_e64 v242, 0, v22, s[98:99]
  v_cndmask_b32_e64 v243, 0, v22, s[98:99]
  s_nop 0
  s_lshl_b64 s[98:99], s[98:99], 1
  v_cndmask_b32_e64 v244, 0, v22, s[98:99]
  v_cndmask_b32_e64 v245, 0, v22, s[98:99]
  v_cndmask_b32_e64 v246, 0, v22, s[98:99]
  v_cndmask_b32_e64 v247, 0, v22, s[98:99]
  s_lshl_b64 s[98:99], s[98:99], 1
  s_mov_b32 s56, s24
  s_and_b32 s57, s25, 0xffff
  s_mov_b32 s58, 7340032
  s_mov_b32 s59, 0x00020000
  s_nop 0
  s_mov_b32 s60, s28
  s_and_b32 s61, s29, 0xffff
  s_mov_b32 s62, 7340032
  s_mov_b32 s63, 0x00020000
  s_mul_i32 s12, s84, Lz1-Lz0+14
  s_add_u32 s12, s12, 20480
  s_mov_b32 s13, s12
  v_lshlrev_b32 v110, 7, v1
  s_mov_b32 s8, 0x00500005
  s_mov_b32 s9, 0x50000500
L_slayer:
  s_barrier
  s_cmp_lg_u32 s82, Lz1-Lz0+0
  s_cbranch_scc1 L_134
  buffer_load_dwordx4 v[128:131], v108, s[44:47], s7 offen offset:0
  buffer_load_dwordx4 v[132:135], v108, s[44:47], s7 offen offset:128
  buffer_load_dwordx4 v[136:139], v108, s[44:47], s7 offen offset:256
  buffer_load_dwordx4 v[140:143], v108, s[44:47], s7 offen offset:384
  buffer_load_dwordx4 v[144:147], v108, s[44:47], s7 offen offset:512
  buffer_load_dwordx4 v[148:151], v108, s[44:47], s7 offen offset:640
  buffer_load_dwordx4 v[152:155], v108, s[44:47], s7 offen offset:768
  buffer_load_dwordx4 v[156:159], v108, s[44:47], s7 offen offset:896
  buffer_load_dwordx4 v[160:163], v108, s[44:47], s7 offen offset:1024
  buffer_load_dwordx4 v[164:167], v108, s[44:47], s7 offen offset:1152
  buffer_load_dwordx4 v[168:171], v108, s[44:47], s7 offen offset:1280
  buffer_load_dwordx4 v[172:175], v108, s[44:47], s7 offen offset:1408
  buffer_load_dwordx4 v[176:179], v108, s[44:47], s7 offen offset:1536
  buffer_load_dwordx4 v[180:183], v108, s[44:47], s7 offen offset:1664
  buffer_load_dwordx4 v[184:187], v108, s[44:47], s7 offen offset:1792
  buffer_load_dwordx4 v[188:191], v108, s[44:47], s7 offen offset:1920
  s_waitcnt vmcnt(16)
  s_lshl_b32 s4, s76, 4
  s_mov_b64 exec, 1
  buffer_atomic_add v11, v24, s[68:71], s4 offen sc1
  s_mov_b64 exec, -1
L_134:
  s_cmp_le_u32 s14, 0
  s_cbranch_scc1 L_136
  s_barrier
L_136:
  s_cmp_le_u32 s14, 1
  s_cbranch_scc1 L_137
  s_barrier
L_137:
  s_cmp_lg_u32 s82, 0
  s_cbranch_scc1 L_138
  ds_read_b64_tr_b16 v[32:33], v16 offset:0
  ds_read_b64_tr_b16 v[34:35], v16 offset:2048
  ds_read_b64_tr_b16 v[36:37], v17 offset:0
  ds_read_b64_tr_b16 v[38:39], v17 offset:2048
  ds_read_b64_tr_b16 v[40:41], v18 offset:0
  ds_read_b64_tr_b16 v[42:43], v18 offset:2048
  ds_read_b64_tr_b16 v[44:45], v19 offset:0
  ds_read_b64_tr_b16 v[46:47], v19 offset:2048
  ds_read_b64_tr_b16 v[48:49], v16 offset:4096
  ds_read_b64_tr_b16 v[50:51], v16 offset:6144
  ds_read_b64_tr_b16 v[52:53], v17 offset:4096
  ds_read_b64_tr_b16 v[54:55], v17 offset:6144
  s_nop 0
  s_waitcnt lgkmcnt(4)
  ds_read_b64_tr_b16 v[56:57], v18 offset:4096
  ds_read_b64_tr_b16 v[58:59], v18 offset:6144
  ds_read_b64_tr_b16 v[60:61], v19 offset:4096
  ds_read_b64_tr_b16 v[62:63], v19 offset:6144
  v_add_u32 v16, 8192, v16
  v_add_u32 v17, 8192, v17
  v_add_u32 v18, 8192, v18
  v_add_u32 v19, 8192, v19
  s_nop 0
  s_waitcnt lgkmcnt(2)
  ds_read_b64_tr_b16 v[64:65], v16 offset:0
  ds_read_b64_tr_b16 v[66:67], v16 offset:2048
  ds_read_b64_tr_b16 v[68:69], v17 offset:0
  ds_read_b64_tr_b16 v[70:71], v17 offset:2048
  ds_read_b64_tr_b16 v[72:73], v18 offset:0
  ds_read_b64_tr_b16 v[74:75], v18 offset:2048
  ds_read_b64_tr_b16 v[76:77], v19 offset:0
  ds_read_b64_tr_b16 v[78:79], v19 offset:2048
  ds_read_b64_tr_b16 v[80:81], v16 offset:4096
  ds_read_b64_tr_b16 v[82:83], v16 offset:6144
  ds_read_b64_tr_b16 v[84:85], v17 offset:4096
  ds_read_b64_tr_b16 v[86:87], v17 offset:6144
  s_nop 0
  s_waitcnt lgkmcnt(4)
  ds_read_b64_tr_b16 v[88:89], v18 offset:4096
  ds_read_b64_tr_b16 v[90:91], v18 offset:6144
  ds_read_b64_tr_b16 v[92:93], v19 offset:4096
  ds_read_b64_tr_b16 v[94:95], v19 offset:6144
  v_add_u32 v16, 8192, v16
  v_add_u32 v17, 8192, v17
  v_add_u32 v18, 8192, v18
  v_add_u32 v19, 8192, v19
  v_mfma_f32_16x16x32_bf16 v[28:31], v[32:35], v[200:203], 0
  v_mfma_f32_16x16x32_bf16 v[28:31], v[36:39], v[204:207], v[28:31]
  v_mfma_f32_16x16x32_bf16 v[28:31], v[40:43], v[208:211], v[28:31]
  v_mfma_f32_16x16x32_bf16 v[28:31], v[44:47], v[212:215], v[28:31]
  v_mfma_f32_16x16x32_bf16 v[28:31], v[48:51], v[200:203], v[28:31]
  v_mfma_f32_16x16x32_bf16 v[28:31], v[52:55], v[204:207], v[28:31]
  v_mfma_f32_16x16x32_bf16 v[28:31], v[56:59], v[208:211], v[28:31]
  v_mfma_f32_16x16x32_bf16 v[28:31], v[60:63], v[212:215], v[28:31]
  s_nop 0
  s_waitcnt lgkmcnt(2)
  ds_read_b64_tr_b16 v[32:33], v16 offset:0
  ds_read_b64_tr_b16 v[34:35], v16 offset:2048
  ds_read_b64_tr_b16 v[36:37], v17 offset:0
  ds_read_b64_tr_b16 v[38:39], v17 offset:2048
  ds_read_b64_tr_b16 v[40:41], v18 offset:0
  ds_read_b64_tr_b16 v[42:43], v18 offset:2048
  ds_read_b64_tr_b16 v[44:45], v19 offset:0
  ds_read_b64_tr_b16 v[46:47], v19 offset:2048
  ds_read_b64_tr_b16 v[48:49], v16 offset:4096
  ds_read_b64_tr_b16 v[50:51], v16 offset:6144
  ds_read_b64_tr_b16 v[52:53], v17 offset:4096
  ds_read_b64_tr_b16 v[54:55], v17 offset:6144
  s_nop 0
  s_waitcnt lgkmcnt(4)
  ds_read_b64_tr_b16 v[56:57], v18 offset:4096
  ds_read_b64_tr_b16 v[58:59], v18 offset:6144
  ds_read_b64_tr_b16 v[60:61], v19 offset:4096
  ds_read_b64_tr_b16 v[62:63], v19 offset:6144
  v_mfma_f32_16x16x32_bf16 v[28:31], v[64:67], v[216:219], v[28:31]
  v_mfma_f32_16x16x32_bf16 v[28:31], v[68:71], v[220:223], v[28:31]
  v_mfma_f32_16x16x32_bf16 v[28:31], v[72:75], v[224:227], v[28:31]
  v_mfma_f32_16x16x32_bf16 v[28:31], v[76:79], v[228:231], v[28:31]
  v_mfma_f32_16x16x32_bf16 v[28:31], v[80:83], v[216:219], v[28:31]
  v_mfma_f32_16x16x32_bf16 v[28:31], v[84:87], v[220:223], v[28:31]
  v_mfma_f32_16x16x32_bf16 v[28:31], v[88:91], v[224:227], v[28:31]
  v_mfma_f32_16x16x32_bf16 v[28:31], v[92:95], v[228:231], v[28:31]
  s_waitcnt lgkmcnt(0)
L_138:
  s_barrier
  s_cmp_lg_u32 s82, 0
  s_cbranch_scc1 L_140
  v_mfma_f32_16x16x32_bf16 v[28:31], v[32:35], v[232:235], v[28:31]
  v_mfma_f32_16x16x32_bf16 v[28:31], v[36:39], v[236:239], v[28:31]
  v_mfma_f32_16x16x32_bf16 v[28:31], v[40:43], v[240:243], v[28:31]
  v_mfma_f32_16x16x32_bf16 v[28:31], v[44:47], v[244:247], v[28:31]
  v_mfma_f32_16x16x32_bf16 v[28:31], v[48:51], v[232:235], v[28:31]
  v_mfma_f32_16x16x32_bf16 v[28:31], v[52:55], v[236:239], v[28:31]
  v_mfma_f32_16x16x32_bf16 v[28:31], v[56:59], v[240:243], v[28:31]
  v_mfma_f32_16x16x32_bf16 v[28:31], v[60:63], v[244:247], v[28:31]
  s_lshl_b32 s5, s77, 14
  s_lshl_b32 s4, s76, 10
  s_add_u32 s5, s5, s4
  s_add_u32 s5, s5, 1114112
  s_nop 3
  buffer_store_dwordx4 v[28:31], v15, s[40:43], s5 offen sc0 sc1
  s_branch L_141
L_140:
  s_lshl_b32 s91, s84, 1
  s_add_u32 s91, s91, s87
  s_add_u32 s91, s91, 0xfffffff0
  s_mov_b32 s16, 0xffff
  s_mov_b32 exec_lo, s16
  s_mov_b32 exec_hi, 0
  buffer_load_dword v7, v5, s[40:43], s91 offen sc0 sc1
  s_mov_b64 exec, -1
L_141:
  s_barrier
  s_cmp_lg_u32 s82, 0
  s_cbranch_scc1 L_142
  s_branch L_143
L_142:
  s_waitcnt vmcnt(0)
  s_mov_b32 s89, 200000
  s_mov_b32 exec_lo, s16
  s_mov_b32 exec_hi, 0
  s_branch Lp_145
Lp_144:
  buffer_load_dword v7, v5, s[40:43], s91 offen sc0 sc1
  s_waitcnt vmcnt(0)
Lp_145:
  v_cmp_ne_u32 vcc, 0, v7
  s_andn2_b32 s3, s16, vcc_lo
  s_cbranch_scc0 Lp_146
  s_sleep 1
  s_sub_u32 s89, s89, 1
  s_cbranch_scc0 Lp_144
Lp_146:
  s_mov_b64 exec, -1
  s_add_u32 s5, s84, s92
  buffer_load_dwordx2 v[96:97], v6, s[40:43], s5 offen offset:0 sc1
  buffer_load_dwordx2 v[98:99], v6, s[40:43], s5 offen offset:512 sc1
  buffer_load_dwordx2 v[100:101], v6, s[40:43], s5 offen offset:1024 sc1
  buffer_load_dwordx2 v[102:103], v6, s[40:43], s5 offen offset:1536 sc1
L_143:
  s_barrier
  s_cmp_gt_u32 s14, 0
  s_cbranch_scc1 L_147
  s_barrier
L_147:
  s_cmp_gt_u32 s14, Lz1-Lz0+1
  s_cbranch_scc1 L_148
  s_barrier
L_148:
  s_cmp_lg_u32 s82, 0
  s_cbranch_scc1 L_149
  s_waitcnt vmcnt(2)
  buffer_load_dword v9, v8, s[68:71], 0 offen sc0 sc1
  s_mov_b32 s72, s26
  s_and_b32 s73, s27, 0xffff
  s_mov_b32 s74, 7168
  s_mov_b32 s75, 0x00020000
  s_mul_i32 s4, s77, 448
  s_and_b32 s5, s77, Lz1-Lz0+1
  s_lshl_b32 s6, s5, 6
  s_add_u32 s6, s6, s4
  s_mul_i32 s5, s5, 384
  s_sub_u32 s5, s4, s5
  v_lshlrev_b32 v2, 1, v1
  v_lshrrev_b32 v3, 1, v2
  v_xor_b32 v3, v3, v2
  v_and_b32 v3, 16, v3
  v_mul_u32_u24 v3, 3, v3
  v_xor_b32_e64 v3, v3, v2
  buffer_load_ushort v104, v2, s[72:75], s6 offen offset:0
  buffer_load_ushort v105, v2, s[72:75], s6 offen offset:128
  buffer_load_ushort v106, v2, s[72:75], s6 offen offset:256
  buffer_load_ushort v107, v3, s[72:75], s5 offen offset:384
  s_nop 0
  s_mov_b32 s64, s30
  s_and_b32 s65, s31, 0xffff
  s_mov_b32 s66, 2048
  s_mov_b32 s67, 0x00020000
  s_lshl_b32 s4, s78, Lz1-Lz0+7
  buffer_load_ushort v108, v2, s[64:67], s4 offen
  v_mov_b32 v32, v22
  v_mov_b32 v33, v22
  v_mov_b32 v34, v22
  v_mov_b32 v35, v22
  v_mov_b32 v96, 0
  v_mov_b32 v97, 0
  v_mov_b32 v98, 0
  v_mov_b32 v99, 0
  v_and_b32_e64 v2, 1, v1
  v_mul_u32_u24 v2, 0xaaaa, v2
  v_add_u32 v2, 0x4444, v2
  v_lshl_or_b32 v36, v2, 16, v2
  v_mfma_f32_16x16x32_bf16 v[100:103], v[128:131], v[128:131], 0
  s_nop 0
  s_nop 0
  v_smfmac_f32_16x16x64_bf16 v[96:99], v[32:35], v[128:135], v36
  v_mfma_f32_16x16x32_bf16 v[100:103], v[132:135], v[132:135], v[100:103]
  v_mfma_f32_16x16x32_bf16 v[100:103], v[136:139], v[136:139], v[100:103]
  v_smfmac_f32_16x16x64_bf16 v[96:99], v[32:35], v[136:143], v36
  v_mfma_f32_16x16x32_bf16 v[100:103], v[140:143], v[140:143], v[100:103]
L_149:
  s_barrier
  s_cmp_lg_u32 s82, Lz1-Lz0+0
  s_cbranch_scc1 L_151
  v_mfma_f32_16x16x32_bf16 v[100:103], v[144:147], v[144:147], v[100:103]
  v_smfmac_f32_16x16x64_bf16 v[96:99], v[32:35], v[144:151], v36
  v_mfma_f32_16x16x32_bf16 v[100:103], v[148:151], v[148:151], v[100:103]
  v_mfma_f32_16x16x32_bf16 v[100:103], v[152:155], v[152:155], v[100:103]
  v_smfmac_f32_16x16x64_bf16 v[96:99], v[32:35], v[152:159], v36
  v_mfma_f32_16x16x32_bf16 v[100:103], v[156:159], v[156:159], v[100:103]
L_151:
  s_barrier
  s_cmp_lg_u32 s82, Lz1-Lz0+0
  s_cbranch_scc1 L_153
  v_mfma_f32_16x16x32_bf16 v[100:103], v[160:163], v[160:163], v[100:103]
  v_smfmac_f32_16x16x64_bf16 v[96:99], v[32:35], v[160:167], v36
  v_mfma_f32_16x16x32_bf16 v[100:103], v[164:167], v[164:167], v[100:103]
  v_mfma_f32_16x16x32_bf16 v[100:103], v[168:171], v[168:171], v[100:103]
  v_smfmac_f32_16x16x64_bf16 v[96:99], v[32:35], v[168:175], v36
  v_mfma_f32_16x16x32_bf16 v[100:103], v[172:175], v[172:175], v[100:103]
  s_waitcnt vmcnt(0)
  s_mov_b32 s89, 200000
  s_branch Lg_156
Lg_155:
  buffer_load_dword v9, v8, s[68:71], 0 offen sc0 sc1
  s_waitcnt vmcnt(0)
Lg_156:
  v_cmp_eq_u32 vcc, 16, v9
  s_andn2_b32 s3, 0xffff, vcc_lo
  s_cbranch_scc0 Lg_157
  s_sleep 2
  s_sub_u32 s89, s89, 1
  s_cbranch_scc0 Lg_155
Lg_157:
  s_mov_b32 s5, 1835008
  s_mov_b64 exec, 0x101
  buffer_store_dword v11, v14, s[40:43], s5 offen sc0 sc1
  s_mov_b64 exec, -1
  s_getpc_b64 s[4:5]
L_pc0:
  s_sub_u32 s4, s4, L_pc0-mega_kernel
  s_nop 0
  s_subb_u32 s5, s5, 0
  s_bfe_u32 s6, s2, 0x20003
  s_mul_i32 s6, s6, 10240
  v_lshl_add_u32 v3, v1, 4, s6
  v_mov_b32_e64 v119, s5
  v_min_u32 v118, L_end-mega_kernel-16, v3
  v_add_co_u32_e64 v116, vcc, s4, v118
  v_add_u32 v3, 0x400, v3
  s_nop 0
  v_addc_co_u32 v117, vcc, 0, v119, vcc
  global_load_dwordx4 v[112:115], v[116:117], off
  v_min_u32 v118, L_end-mega_kernel-16, v3
  v_add_co_u32_e64 v116, vcc, s4, v118
  v_add_u32 v3, 0x400, v3
  s_nop 0
  v_addc_co_u32 v117, vcc, 0, v119, vcc
  global_load_dwordx4 v[112:115], v[116:117], off
  v_min_u32 v118, L_end-mega_kernel-16, v3
  v_add_co_u32_e64 v116, vcc, s4, v118
  v_add_u32 v3, 0x400, v3
  s_nop 0
  v_addc_co_u32 v117, vcc, 0, v119, vcc
  global_load_dwordx4 v[112:115], v[116:117], off
  v_min_u32 v118, L_end-mega_kernel-16, v3
  v_add_co_u32_e64 v116, vcc, s4, v118
  v_add_u32 v3, 0x400, v3
  s_nop 0
  v_addc_co_u32 v117, vcc, 0, v119, vcc
  global_load_dwordx4 v[112:115], v[116:117], off
  v_min_u32 v118, L_end-mega_kernel-16, v3
  v_add_co_u32 v116, vcc, s4, v118
  s_nop 1
  v_addc_co_u32 v117, vcc, 0, v119, vcc
  global_load_dwordx4 v[112:115], v[116:117], off
L_153:
  s_barrier
  s_cmp_lg_u32 s82, 0
  s_cbranch_scc1 L_158
  v_mfma_f32_16x16x32_bf16 v[100:103], v[176:179], v[176:179], v[100:103]
  v_smfmac_f32_16x16x64_bf16 v[96:99], v[32:35], v[176:183], v36
  v_mfma_f32_16x16x32_bf16 v[100:103], v[180:183], v[180:183], v[100:103]
  v_mfma_f32_16x16x32_bf16 v[100:103], v[184:187], v[184:187], v[100:103]
  v_smfmac_f32_16x16x64_bf16 v[96:99], v[32:35], v[184:191], v36
  v_mfma_f32_16x16x32_bf16 v[100:103], v[188:191], v[188:191], v[100:103]
  s_getpc_b64 s[4:5]
L_pc1:
  s_sub_u32 s4, s4, L_pc1-mega_kernel
  s_subb_u32 s5, s5, 0
  s_bfe_u32 s6, s2, 0x20003
  s_mul_i32 s6, s6, 10240
  s_add_u32 s6, s6, 5120
  v_lshl_add_u32 v3, v1, 4, s6
  v_mov_b32_e64 v119, s5
  v_min_u32 v118, L_end-mega_kernel-16, v3
  v_add_co_u32_e64 v116, vcc, s4, v118
  v_add_u32 v3, 0x400, v3
  s_nop 0
  v_addc_co_u32 v117, vcc, 0, v119, vcc
  global_load_dwordx4 v[112:115], v[116:117], off
  v_min_u32 v118, L_end-mega_kernel-16, v3
  v_add_co_u32_e64 v116, vcc, s4, v118
  v_add_u32 v3, 0x400, v3
  s_nop 0
  v_addc_co_u32 v117, vcc, 0, v119, vcc
  global_load_dwordx4 v[112:115], v[116:117], off
  v_min_u32 v118, L_end-mega_kernel-16, v3
  v_add_co_u32_e64 v116, vcc, s4, v118
  v_add_u32 v3, 0x400, v3
  s_nop 0
  v_addc_co_u32 v117, vcc, 0, v119, vcc
  global_load_dwordx4 v[112:115], v[116:117], off
  v_min_u32 v118, L_end-mega_kernel-16, v3
  v_add_co_u32_e64 v116, vcc, s4, v118
  v_add_u32 v3, 0x400, v3
  s_nop 0
  v_addc_co_u32 v117, vcc, 0, v119, vcc
  global_load_dwordx4 v[112:115], v[116:117], off
  v_min_u32 v118, L_end-mega_kernel-16, v3
  v_add_co_u32 v116, vcc, s4, v118
  s_nop 1
  v_addc_co_u32_e64 v117, vcc, 0, v119, vcc
  global_load_dwordx4 v[112:115], v[116:117], off
  s_nop 7
  s_nop 7
  v_add_f32_e64 v96, v96, v97
  s_mov_b32 s98, 0xaaaaaaaa
  s_mov_b32 s99, 0xaaaaaaaa
  v_cndmask_b32_e64 v100, v100, v101, s[98:99]
  v_cndmask_b32_e64 v102, v102, v103, s[98:99]
  s_mov_b32 s98, 0xcccccccc
  s_mov_b32 s99, 0xcccccccc
  v_cndmask_b32_e64 v97, v100, v102, s[98:99]
  v_add_f32_dpp v96, v96, v96 quad_perm:[1,0,3,2] row_mask:0xf bank_mask:0xf
  s_nop 0
  v_add_f32_dpp v97, v97, v97 quad_perm:[1,0,3,2] row_mask:0xf bank_mask:0xf
  s_branch L_159
L_158:
  s_waitcnt vmcnt(0)
  v_add_f32 v96, v96, v100
  v_add_f32 v97, v97, v101
  v_add_f32 v98, v98, v102
  v_add_f32 v99, v99, v103
  v_add_f32 v96, v96, v98
  v_add_f32 v97, v97, v99
  s_nop 0
  v_add_f32_dpp v96, v96, v96 row_ror:8 row_mask:0xf bank_mask:0xf
  v_add_f32_dpp v97, v97, v97 row_ror:8 row_mask:0xf bank_mask:0xf
  v_mov_b32 v98, v96
  v_mov_b32 v99, v97
  s_nop 0
  v_permlane16_swap_b32 v96, v98
  v_permlane16_swap_b32 v97, v99
  v_add_f32 v96, v96, v98
  v_add_f32 v97, v97, v99
  v_mov_b32 v98, v96
  v_mov_b32 v99, v97
  s_nop 0
  v_permlane32_swap_b32 v96, v98
  v_permlane32_swap_b32 v97, v99
  v_add_f32 v96, v96, v98
  v_add_f32 v97, v97, v99
L_159:
  v_mul_f32 v96, 0x3a800000, v96
  v_mul_f32 v97, 0x3a800000, v97
  v_fma_f32 v98, -v96, v96, v97
  v_max_f32_e64 v98, 0, v98
  v_add_f32 v98, 0x3727c5ac, v98
  v_rsq_f32_e64 v98, v98
  v_mov_b32 v99, v96
  s_mov_b64 exec, s[8:9]
  buffer_store_dwordx2 v[98:99], v6, s[40:43], s10 offen sc0 sc1
  s_mov_b64 exec, -1
  s_barrier
  s_cmp_lg_u32 s82, 0
  s_cbranch_scc1 L_160
  v_lshlrev_b32_e64 v6, 3, v1
  s_mov_b64 s[8:9], 0xff
  s_lshl_b32 s91, s84, Lz1-Lz0+1
  s_and_b32 s91, s91, 0x8f000
  s_add_u32 s91, s91, 1835008
  s_mov_b32 exec_lo, 0xffff
  s_mov_b32 exec_hi, Lz1-Lz0+0
  buffer_load_dword v7, v5, s[40:43], s91 offen sc0 sc1
  s_mov_b64 exec, -1
L_160:
  s_barrier
  s_barrier
  s_waitcnt vmcnt(0)
  s_and_b32 s5, s10, 0xfffffc00
  buffer_load_dwordx4 v[120:123], v4, s[40:43], s5 offen sc1
  s_cmp_lg_u32 s82, 0
  s_cbranch_scc1 L_162
  s_mov_b32 s89, 200000
  s_mov_b32 exec_lo, 0xffff
  s_mov_b32 exec_hi, 0
  s_branch Lp_165
Lp_164:
  buffer_load_dword v7, v5, s[40:43], s91 offen sc0 sc1
  s_waitcnt vmcnt(0)
Lp_165:
  v_cmp_ne_u32 vcc, 0, v7
  s_andn2_b32 s3, 0xffff, vcc_lo
  s_cbranch_scc0 Lp_166
  s_sleep 1
  s_sub_u32 s89, s89, 1
  s_cbranch_scc0 Lp_164
Lp_166:
  s_mov_b64 exec, -1
  s_lshl_b32 s5, s77, 14
  s_add_u32 s5, s5, 1114112
  buffer_load_dwordx4 v[192:195], v4, s[40:43], s5 offen offset:0 sc1
  buffer_load_dwordx4 v[196:199], v4, s[40:43], s5 offen offset:1024 sc1
  buffer_load_dwordx4 v[200:203], v4, s[40:43], s5 offen offset:2048 sc1
  buffer_load_dwordx4 v[204:207], v4, s[40:43], s5 offen offset:3072 sc1
  s_add_u32 s5, s5, 4096
  buffer_load_dwordx4 v[208:211], v4, s[40:43], s5 offen offset:0 sc1
  buffer_load_dwordx4 v[212:215], v4, s[40:43], s5 offen offset:1024 sc1
  buffer_load_dwordx4 v[216:219], v4, s[40:43], s5 offen offset:2048 sc1
  buffer_load_dwordx4 v[220:223], v4, s[40:43], s5 offen offset:3072 sc1
L_162:
  s_barrier
  s_cmp_lg_u32 s82, 0
  s_cbranch_scc1 L_167
  s_lshl_b32 s5, s77, 14
  s_add_u32 s5, s5, 1122304
  buffer_load_dwordx4 v[224:227], v4, s[40:43], s5 offen offset:0 sc1
  buffer_load_dwordx4 v[228:231], v4, s[40:43], s5 offen offset:1024 sc1
  buffer_load_dwordx4 v[232:235], v4, s[40:43], s5 offen offset:2048 sc1
  buffer_load_dwordx4 v[236:239], v4, s[40:43], s5 offen offset:3072 sc1
  s_add_u32 s5, s5, 4096
  buffer_load_dwordx4 v[240:243], v4, s[40:43], s5 offen offset:0 sc1
  buffer_load_dwordx4 v[244:247], v4, s[40:43], s5 offen offset:1024 sc1
  buffer_load_dwordx4 v[248:251], v4, s[40:43], s5 offen offset:2048 sc1
  buffer_load_dwordx4 v[252:255], v4, s[40:43], s5 offen offset:3072 sc1
L_167:
  s_barrier
  s_cmp_lg_u32 s82, 0
  s_cbranch_scc1 L_169
  s_waitcnt vmcnt(16)
  s_branch L_170
L_169:
  s_waitcnt vmcnt(0)
L_170:
  s_mov_b32 s89, 200000
  s_branch Lp_172
  s_nop 0
Lp_171:
  s_and_b32 s5, s10, 0xfffffc00
  buffer_load_dwordx4 v[120:123], v4, s[40:43], s5 offen sc1
  s_waitcnt vmcnt(0)
Lp_172:
  v_min_u32 v2, v120, v122
  v_cmp_eq_u32 vcc, 0, v2
  s_cmp_eq_u64 vcc, 0
  s_cbranch_scc1 Lp_173
  s_sleep 1
  s_sub_u32 s89, s89, 1
  s_cbranch_scc0 Lp_171
Lp_173:
  s_and_b32 s5, s10, 0xfffffc00
  s_mov_b32 m0, 151552
  s_nop 0
  buffer_load_dword v6, s[40:43], s5 offen offset:0 sc1 lds
  s_mov_b32 m0, 152188
  s_nop 0
  buffer_load_dword v6, s[40:43], s5 offen offset:4 sc1 lds
  s_mov_b32 m0, 151360
  s_nop 0
  buffer_load_dword v6, s[40:43], s5 offen offset:512 sc1 lds
  s_mov_b32 m0, 151996
  s_nop 0
  buffer_load_dword v6, s[40:43], s5 offen offset:516 sc1 lds
  s_add_u32 s10, s10, 16384
  s_cmp_lg_u32 s82, 0
  s_cbranch_scc1 L_174
  s_waitcnt vmcnt(12)
  v_add_f32 v192, v192, v208
  v_add_f32 v193, v193, v209
  v_add_f32 v194, v194, v210
  v_add_f32 v195, v195, v211
  v_add_f32 v196, v196, v212
  v_add_f32 v197, v197, v213
  v_add_f32 v198, v198, v214
  v_add_f32 v199, v199, v215
  v_add_f32 v200, v200, v216
  v_add_f32 v201, v201, v217
  v_add_f32 v202, v202, v218
  v_add_f32 v203, v203, v219
  v_add_f32 v204, v204, v220
  v_add_f32 v205, v205, v221
  v_add_f32 v206, v206, v222
  v_add_f32 v207, v207, v223
  v_add_f32 v192, v192, v200
  v_add_f32 v193, v193, v201
  v_add_f32 v194, v194, v202
  v_add_f32 v195, v195, v203
  v_add_f32 v196, v196, v204
  v_add_f32 v197, v197, v205
  v_add_f32 v198, v198, v206
  v_add_f32 v199, v199, v207
  v_add_f32 v192, v192, v196
  v_add_f32 v193, v193, v197
  v_add_f32 v194, v194, v198
  v_add_f32_e64 v195, v195, v199
L_174:
  s_cmp_lg_u32 s82, 0
  s_cbranch_scc1 L_176
  buffer_load_dword v109, v110, s[56:59], s12 offen
  s_sub_u32 s12, s12, 8192
L_176:
  s_barrier
  s_cmp_lg_u32 s82, 0
  s_cbranch_scc1 L_178
  s_cmp_lg_u32 s82, 0
  s_cbranch_scc1 L_180
  s_waitcnt vmcnt(1)
  s_branch L_181
L_180:
  s_waitcnt vmcnt(0)
L_181:
  v_add_f32 v224, v224, v240
  v_add_f32 v225, v225, v241
  v_add_f32 v226, v226, v242
  v_add_f32 v227, v227, v243
  v_add_f32 v228, v228, v244
  v_add_f32 v229, v229, v245
  v_add_f32 v230, v230, v246
  v_add_f32 v231, v231, v247
  v_add_f32 v232, v232, v248
  v_add_f32 v233, v233, v249
  v_add_f32 v234, v234, v250
  v_add_f32 v235, v235, v251
  v_add_f32 v236, v236, v252
  v_add_f32 v237, v237, v253
  v_add_f32 v238, v238, v254
  v_add_f32 v239, v239, v255
  v_add_f32 v224, v224, v232
  v_add_f32 v225, v225, v233
  v_add_f32 v226, v226, v234
  v_add_f32 v227, v227, v235
  v_add_f32 v228, v228, v236
  v_add_f32 v229, v229, v237
  v_add_f32 v230, v230, v238
  v_add_f32 v231, v231, v239
  v_add_f32 v224, v224, v228
  v_add_f32 v225, v225, v229
  v_add_f32 v226, v226, v230
  v_add_f32 v227, v227, v231
  v_add_f32 v192, v192, v224
  v_add_f32 v193, v193, v225
  v_add_f32 v194, v194, v226
  v_add_f32 v195, v195, v227
  v_add_u32 v2, 153088, v4
  ds_write_b128 v2, v[192:195]
L_178:
  s_cmp_lg_u32 s82, 0
  s_cbranch_scc1 L_182
  buffer_load_dword v109, v110, s[56:59], s12 offen
  s_sub_u32 s12, s12, 8192
L_182:
  s_barrier
  s_cmp_lg_u32 s82, 0
  s_cbranch_scc1 L_184
  s_waitcnt vmcnt(2)
  s_branch L_185
  s_nop 0
L_184:
  s_waitcnt vmcnt(0)
L_185:
  s_waitcnt lgkmcnt(0)
  s_barrier
  s_cmp_lg_u32 s82, 0
  s_cbranch_scc1 L_186
  v_lshlrev_b32 v2, 2, v1
  v_add_u32 v2, 155136, v2
  v_lshlrev_b32_e64 v104, 16, v104
  v_mul_f32 v104, 0x3eeff558, v104
  ds_write_b32 v2, v104 offset:0
  v_lshlrev_b32_e64 v105, 16, v105
  v_mul_f32 v105, 0x3eeff558, v105
  ds_write_b32 v2, v105 offset:256
  v_lshlrev_b32_e64 v106, 16, v106
  v_mul_f32 v106, 0x3eeff558, v106
  ds_write_b32 v2, v106 offset:512
  v_lshlrev_b32_e64 v107, 16, v107
  v_mul_f32 v107, 0x3eeff558, v107
  ds_write_b32 v2, v107 offset:768
  v_lshlrev_b32_e64 v108, 16, v108
  ds_write_b32 v2, v108 offset:1024
  v_lshrrev_b32 v2, 2, v1
  v_lshlrev_b32 v22, 7, v2
  v_lshlrev_b32 v96, 6, v2
  v_and_b32 v2, 3, v1
  v_lshl_add_u32 v22, v2, 3, v22
  v_lshl_add_u32 v96, v2, 3, v96
  v_add_u32 v22, 65536, v22
  v_add_u32 v96, 90112, v96
  v_bfe_u32 v3, v1, 3, 2
  v_xor_b32_e64 v2, 0, v3
  v_lshl_add_u32 v16, v2, 5, v22
  v_xor_b32_e64 v2, 1, v3
  v_lshl_add_u32 v17, v2, 5, v22
  v_xor_b32_e64 v2, 2, v3
  v_lshl_add_u32 v18, v2, 5, v22
  v_xor_b32_e64 v2, 3, v3
  v_lshl_add_u32 v19, v2, 5, v22
  v_bfe_u32 v3, v1, 4, 1
  v_xor_b32_e64 v2, 0, v3
  v_lshl_add_u32 v20, v2, 5, v96
  v_xor_b32_e64 v2, 1, v3
  v_lshl_add_u32 v21, v2, 5, v96
  v_mov_b32 v22, 0x3f803f80
  s_mov_b32 s98, 0x00010001
  s_mov_b32 s99, 0x00010001
  v_cndmask_b32_e64 v200, 0, v22, s[98:99]
  v_cndmask_b32_e64 v201, 0, v22, s[98:99]
  v_cndmask_b32_e64 v202, 0, v22, s[98:99]
  v_cndmask_b32_e64 v203, 0, v22, s[98:99]
  s_nop 0
  s_lshl_b64 s[98:99], s[98:99], 1
  v_cndmask_b32_e64 v204, 0, v22, s[98:99]
  v_cndmask_b32_e64 v205, 0, v22, s[98:99]
  v_cndmask_b32_e64 v206, 0, v22, s[98:99]
  v_cndmask_b32_e64 v207, 0, v22, s[98:99]
  s_nop 0
  s_lshl_b64 s[98:99], s[98:99], 1
  v_cndmask_b32_e64 v208, 0, v22, s[98:99]
  v_cndmask_b32_e64 v209, 0, v22, s[98:99]
  v_cndmask_b32_e64 v210, 0, v22, s[98:99]
  v_cndmask_b32_e64 v211, 0, v22, s[98:99]
  s_nop 0
  s_lshl_b64 s[98:99], s[98:99], 1
  v_cndmask_b32_e64 v212, 0, v22, s[98:99]
  v_cndmask_b32_e64 v213, 0, v22, s[98:99]
  v_cndmask_b32_e64 v214, 0, v22, s[98:99]
  v_cndmask_b32_e64 v215, 0, v22, s[98:99]
  s_nop 0
  s_lshl_b64 s[98:99], s[98:99], 1
  v_cndmask_b32_e64 v216, 0, v22, s[98:99]
  v_cndmask_b32_e64 v217, 0, v22, s[98:99]
  v_cndmask_b32_e64 v218, 0, v22, s[98:99]
  v_cndmask_b32_e64 v219, 0, v22, s[98:99]
  s_nop 0
  s_lshl_b64 s[98:99], s[98:99], 1
  v_cndmask_b32_e64 v220, 0, v22, s[98:99]
  v_cndmask_b32_e64 v221, 0, v22, s[98:99]
  v_cndmask_b32_e64 v222, 0, v22, s[98:99]
  v_cndmask_b32_e64 v223, 0, v22, s[98:99]
  s_nop 0
  s_lshl_b64 s[98:99], s[98:99], 1
  v_cndmask_b32_e64 v224, 0, v22, s[98:99]
  v_cndmask_b32_e64 v225, 0, v22, s[98:99]
  v_cndmask_b32_e64 v226, 0, v22, s[98:99]
  v_cndmask_b32_e64 v227, 0, v22, s[98:99]
  s_nop 0
  s_lshl_b64 s[98:99], s[98:99], 1
  v_cndmask_b32_e64 v228, 0, v22, s[98:99]
  v_cndmask_b32_e64 v229, 0, v22, s[98:99]
  v_cndmask_b32_e64 v230, 0, v22, s[98:99]
  v_cndmask_b32_e64 v231, 0, v22, s[98:99]
  s_nop 0
  s_lshl_b64 s[98:99], s[98:99], 1
  v_cndmask_b32_e64 v232, 0, v22, s[98:99]
  v_cndmask_b32_e64 v233, 0, v22, s[98:99]
  v_cndmask_b32_e64 v234, 0, v22, s[98:99]
  v_cndmask_b32_e64 v235, 0, v22, s[98:99]
  s_nop 0
  s_lshl_b64 s[98:99], s[98:99], 1
  v_cndmask_b32_e64 v236, 0, v22, s[98:99]
  v_cndmask_b32_e64 v237, 0, v22, s[98:99]
  v_cndmask_b32_e64 v238, 0, v22, s[98:99]
  v_cndmask_b32_e64 v239, 0, v22, s[98:99]
  s_nop 0
  s_lshl_b64 s[98:99], s[98:99], 1
  v_cndmask_b32_e64 v240, 0, v22, s[98:99]
  v_cndmask_b32_e64 v241, 0, v22, s[98:99]
  v_cndmask_b32_e64 v242, 0, v22, s[98:99]
  v_cndmask_b32_e64 v243, 0, v22, s[98:99]
  s_nop 0
  s_lshl_b64 s[98:99], s[98:99], 1
  v_cndmask_b32_e64 v244, 0, v22, s[98:99]
  v_cndmask_b32_e64 v245, 0, v22, s[98:99]
  v_cndmask_b32_e64 v246, 0, v22, s[98:99]
  v_cndmask_b32_e64 v247, 0, v22, s[98:99]
  s_nop 0
  s_lshl_b64 s[98:99], s[98:99], 1
  v_cndmask_b32_e64 v248, 0, v22, s[98:99]
  v_cndmask_b32_e64 v249, 0, v22, s[98:99]
  v_cndmask_b32_e64 v250, 0, v22, s[98:99]
  v_cndmask_b32_e64 v251, 0, v22, s[98:99]
  s_nop 0
  s_lshl_b64 s[98:99], s[98:99], 1
  v_cndmask_b32_e64 v252, 0, v22, s[98:99]
  v_cndmask_b32_e64 v253, 0, v22, s[98:99]
  v_cndmask_b32_e64 v254, 0, v22, s[98:99]
  v_cndmask_b32_e64 v255, 0, v22, s[98:99]
  s_lshl_b64 s[98:99], s[98:99], 1
L_186:
  s_lshl_b32 s91, s84, Lz1-Lz0+1
  s_add_u32 s91, s91, s87
  s_barrier
  s_barrier
  s_mov_b32 exec_lo, 0xf7f7
  s_mov_b32 exec_hi, 0
  buffer_load_dword v7, v5, s[40:43], s91 offen sc0 sc1
  s_mov_b64 exec, -1
  s_barrier
  s_barrier
  s_barrier
  s_waitcnt vmcnt(0)
  s_mov_b32 s89, 200000
  s_mov_b32 exec_lo, 0xf7f7
  s_mov_b32 exec_hi, 0
  s_branch Lp_189
Lp_188:
  buffer_load_dword v7, v5, s[40:43], s91 offen sc0 sc1
  s_waitcnt vmcnt(0)
Lp_189:
  v_cmp_ne_u32 vcc, 0, v7
  s_andn2_b32 s3, 0xf7f7, vcc_lo
  s_cbranch_scc0 Lp_190
  s_sleep 1
  s_sub_u32 s89, s89, Lz1-Lz0+1
  s_cbranch_scc0 Lp_188
Lp_190:
  s_mov_b64 exec, -1
  s_barrier
  s_barrier
  s_mov_b32 exec_lo, 0x808
  s_mov_b32 exec_hi, Lz1-Lz0+0
  buffer_load_dword v7, v5, s[40:43], s91 offen sc0 sc1
  s_mov_b64 exec, -1
  s_barrier
  s_barrier
  s_barrier
  s_barrier
  s_waitcnt vmcnt(0)
  s_mov_b32 s89, 200000
  s_mov_b32 exec_lo, 0x808
  s_mov_b32 exec_hi, 0
  s_branch Lp_192
Lp_191:
  buffer_load_dword v7, v5, s[40:43], s91 offen sc0 sc1
  s_waitcnt vmcnt(0)
Lp_192:
  v_cmp_ne_u32 vcc, 0, v7
  s_andn2_b32 s3, 0x808, vcc_lo
  s_cbranch_scc0 Lp_193
  s_sleep 1
  s_sub_u32 s89, s89, Lz1-Lz0+1
  s_cbranch_scc0 Lp_191
Lp_193:
  s_mov_b64 exec, -1
  s_barrier
  s_barrier
  s_barrier
  s_barrier
  s_barrier
  s_barrier
  s_add_u32 s92, s83, 31457280
  s_add_u32 s91, s91, 4
  s_sub_u32 s16, s78, s76
  s_add_u32 s16, s16, 1
  s_and_b32 s16, s16, 15
  s_barrier
  s_cmp_lg_u32 s82, 0
  s_cbranch_scc1 L_194
  s_cmp_eq_u32 s16, 1
  s_cselect_b32 s4, 0, 28672
  v_add_u32 v112, s4, v16
  v_add_u32 v113, s4, v17
  v_add_u32 v114, s4, v18
  v_add_u32 v115, s4, v19
  v_add_u32 v116, s4, v20
  v_add_u32 v117, s4, v21
  ds_read_b64_tr_b16 v[32:33], v112 offset:0
  ds_read_b64_tr_b16 v[34:35], v112 offset:2048
  ds_read_b64_tr_b16 v[36:37], v113 offset:0
  ds_read_b64_tr_b16 v[38:39], v113 offset:2048
  ds_read_b64_tr_b16 v[40:41], v114 offset:0
  ds_read_b64_tr_b16 v[42:43], v114 offset:2048
  ds_read_b64_tr_b16 v[44:45], v115 offset:0
  ds_read_b64_tr_b16 v[46:47], v115 offset:2048
  ds_read_b64_tr_b16 v[48:49], v112 offset:4096
  ds_read_b64_tr_b16 v[50:51], v112 offset:6144
  ds_read_b64_tr_b16 v[52:53], v113 offset:4096
  ds_read_b64_tr_b16 v[54:55], v113 offset:6144
  s_nop 0
  s_waitcnt lgkmcnt(6)
  ds_read_b64_tr_b16 v[56:57], v114 offset:4096
  ds_read_b64_tr_b16 v[58:59], v114 offset:6144
  ds_read_b64_tr_b16 v[60:61], v115 offset:4096
  ds_read_b64_tr_b16 v[62:63], v115 offset:6144
  s_nop 0
  s_waitcnt lgkmcnt(6)
  ds_read_b64_tr_b16 v[64:65], v112 offset:8192
  ds_read_b64_tr_b16 v[66:67], v112 offset:10240
  ds_read_b64_tr_b16 v[68:69], v113 offset:8192
  ds_read_b64_tr_b16 v[70:71], v113 offset:10240
  ds_read_b64_tr_b16 v[72:73], v114 offset:8192
  ds_read_b64_tr_b16 v[74:75], v114 offset:10240
  ds_read_b64_tr_b16 v[76:77], v115 offset:8192
  ds_read_b64_tr_b16 v[78:79], v115 offset:10240
  s_nop 0
  s_waitcnt lgkmcnt(8)
  v_mfma_f32_16x16x32_bf16 v[28:31], v[32:35], v[200:203], 0
  v_mfma_f32_16x16x32_bf16 v[28:31], v[36:39], v[204:207], v[28:31]
  v_mfma_f32_16x16x32_bf16 v[28:31], v[40:43], v[208:211], v[28:31]
  v_mfma_f32_16x16x32_bf16 v[28:31], v[44:47], v[212:215], v[28:31]
  v_mfma_f32_16x16x32_bf16 v[28:31], v[48:51], v[200:203], v[28:31]
  v_mfma_f32_16x16x32_bf16 v[28:31], v[52:55], v[204:207], v[28:31]
  v_mfma_f32_16x16x32_bf16 v[28:31], v[56:59], v[208:211], v[28:31]
  v_mfma_f32_16x16x32_bf16 v[28:31], v[60:63], v[212:215], v[28:31]
  s_nop 0
  s_waitcnt lgkmcnt(7)
  ds_read_b64_tr_b16 v[80:81], v112 offset:12288
  ds_read_b64_tr_b16 v[82:83], v112 offset:14336
  ds_read_b64_tr_b16 v[84:85], v113 offset:12288
  ds_read_b64_tr_b16 v[86:87], v113 offset:14336
  ds_read_b64_tr_b16 v[88:89], v114 offset:12288
  ds_read_b64_tr_b16 v[90:91], v114 offset:14336
  ds_read_b64_tr_b16 v[92:93], v115 offset:12288
  ds_read_b64_tr_b16 v[94:95], v115 offset:14336
  s_nop 0
  s_waitcnt lgkmcnt(6)
  ds_read_b64_tr_b16 v[128:129], v112 offset:16384
  ds_read_b64_tr_b16 v[130:131], v112 offset:18432
  ds_read_b64_tr_b16 v[132:133], v113 offset:16384
  ds_read_b64_tr_b16 v[134:135], v113 offset:18432
  ds_read_b64_tr_b16 v[136:137], v114 offset:16384
  ds_read_b64_tr_b16 v[138:139], v114 offset:18432
  ds_read_b64_tr_b16 v[140:141], v115 offset:16384
  ds_read_b64_tr_b16 v[142:143], v115 offset:18432
  s_nop 0
  s_waitcnt lgkmcnt(8)
  v_mfma_f32_16x16x32_bf16 v[28:31], v[64:67], v[216:219], v[28:31]
  v_mfma_f32_16x16x32_bf16 v[28:31], v[68:71], v[220:223], v[28:31]
  v_mfma_f32_16x16x32_bf16 v[28:31], v[72:75], v[224:227], v[28:31]
  v_mfma_f32_16x16x32_bf16 v[28:31], v[76:79], v[228:231], v[28:31]
  v_mfma_f32_16x16x32_bf16 v[28:31], v[80:83], v[216:219], v[28:31]
  v_mfma_f32_16x16x32_bf16 v[28:31], v[84:87], v[220:223], v[28:31]
  v_mfma_f32_16x16x32_bf16 v[28:31], v[88:91], v[224:227], v[28:31]
  v_mfma_f32_16x16x32_bf16 v[28:31], v[92:95], v[228:231], v[28:31]
  s_nop 0
  s_waitcnt lgkmcnt(7)
  ds_read_b64_tr_b16 v[144:145], v112 offset:20480
  ds_read_b64_tr_b16 v[146:147], v112 offset:22528
  ds_read_b64_tr_b16 v[148:149], v113 offset:20480
  ds_read_b64_tr_b16 v[150:151], v113 offset:22528
  ds_read_b64_tr_b16 v[152:153], v114 offset:20480
  ds_read_b64_tr_b16 v[154:155], v114 offset:22528
  ds_read_b64_tr_b16 v[156:157], v115 offset:20480
  ds_read_b64_tr_b16 v[158:159], v115 offset:22528
  s_nop 0
  s_waitcnt lgkmcnt(6)
  ds_read_b64_tr_b16 v[160:161], v116 offset:0
  ds_read_b64_tr_b16 v[162:163], v116 offset:1024
  ds_read_b64_tr_b16 v[164:165], v117 offset:0
  ds_read_b64_tr_b16 v[166:167], v117 offset:1024
  ds_read_b64_tr_b16 v[176:177], v116 offset:2048
  ds_read_b64_tr_b16 v[178:179], v116 offset:3072
  ds_read_b64_tr_b16 v[180:181], v117 offset:2048
  ds_read_b64_tr_b16 v[182:183], v117 offset:3072
  s_nop 0
  s_waitcnt lgkmcnt(8)
  v_mfma_f32_16x16x32_bf16 v[28:31], v[128:131], v[232:235], v[28:31]
  v_mfma_f32_16x16x32_bf16 v[28:31], v[132:135], v[236:239], v[28:31]
  v_mfma_f32_16x16x32_bf16 v[28:31], v[136:139], v[240:243], v[28:31]
  v_mfma_f32_16x16x32_bf16 v[28:31], v[140:143], v[244:247], v[28:31]
  v_mfma_f32_16x16x32_bf16 v[28:31], v[144:147], v[232:235], v[28:31]
  v_mfma_f32_16x16x32_bf16 v[28:31], v[148:151], v[236:239], v[28:31]
  v_mfma_f32_16x16x32_bf16 v[28:31], v[152:155], v[240:243], v[28:31]
  v_mfma_f32_16x16x32_bf16 v[28:31], v[156:159], v[244:247], v[28:31]
  s_waitcnt lgkmcnt(7)
  s_waitcnt lgkmcnt(0)
  v_mfma_f32_16x16x32_bf16 v[28:31], v[160:163], v[248:251], v[28:31]
  v_mfma_f32_16x16x32_bf16 v[28:31], v[164:167], v[252:255], v[28:31]
  v_mfma_f32_16x16x32_bf16 v[28:31], v[176:179], v[248:251], v[28:31]
  v_mfma_f32_16x16x32_bf16 v[28:31], v[180:183], v[252:255], v[28:31]
  s_lshl_b32 s5, s77, Lz1-Lz0+14
  s_lshl_b32 s4, s76, 10
  s_add_u32 s5, s5, s4
  s_add_u32 s5, s5, 1376256
  s_nop 3
  buffer_store_dwordx4 v[28:31], v15, s[40:43], s5 offen sc0 sc1
L_194:
  s_barrier
  s_mov_b32 exec_lo, 0xffff
  s_mov_b32 exec_hi, 0
  buffer_load_dword v7, v5, s[40:43], s91 offen sc0 sc1
  s_mov_b64 exec, -1
  s_barrier
  s_waitcnt vmcnt(0)
  s_mov_b32 s89, 200000
  s_mov_b32 exec_lo, 0xffff
  s_mov_b32 exec_hi, 0
  s_branch Lp_197
Lp_196:
  buffer_load_dword v7, v5, s[40:43], s91 offen sc0 sc1
  s_waitcnt vmcnt(0)
Lp_197:
  v_cmp_ne_u32 vcc, 0, v7
  s_andn2_b32 s3, 0xffff, vcc_lo
  s_cbranch_scc0 Lp_198
  s_sleep 1
  s_sub_u32 s89, s89, Lz1-Lz0+1
  s_cbranch_scc0 Lp_196
Lp_198:
  s_mov_b64 exec, -1
  s_cmp_lg_u32 s82, 0
  s_cbranch_scc1 L_199
  s_mov_b32 s5, 1835012
  s_mov_b64 exec, 0x101
  buffer_store_dword v11, v14, s[40:43], s5 offen sc0 sc1
  s_mov_b64 exec, -1
L_199:
  s_add_u32 s5, s84, s92
  buffer_load_dwordx2 v[96:97], v6, s[40:43], s5 offen offset:0 sc1
  buffer_load_dwordx2 v[98:99], v6, s[40:43], s5 offen offset:512 sc1
  buffer_load_dwordx2 v[100:101], v6, s[40:43], s5 offen offset:1024 sc1
  buffer_load_dwordx2 v[102:103], v6, s[40:43], s5 offen offset:1536 sc1
  s_barrier
  s_barrier
  s_barrier
  s_waitcnt vmcnt(0)
  v_add_f32 v96, v96, v100
  v_add_f32 v97, v97, v101
  v_add_f32 v98, v98, v102
  v_add_f32 v99, v99, v103
  v_add_f32_e64 v96, v96, v98
  v_add_f32 v97, v97, v99
  s_nop 0
  v_add_f32_dpp v96, v96, v96 row_ror:8 row_mask:0xf bank_mask:0xf
  v_add_f32_dpp v97, v97, v97 row_ror:8 row_mask:0xf bank_mask:0xf
  v_mov_b32 v98, v96
  v_mov_b32 v99, v97
  s_nop 0
  v_permlane16_swap_b32 v96, v98
  v_permlane16_swap_b32 v97, v99
  v_add_f32 v96, v96, v98
  v_add_f32 v97, v97, v99
  v_mov_b32 v98, v96
  v_mov_b32 v99, v97
  s_nop 0
  v_permlane32_swap_b32 v96, v98
  v_permlane32_swap_b32 v97, v99
  v_add_f32 v96, v96, v98
  v_add_f32 v97, v97, v99
  v_mul_f32 v96, 0x3a800000, v96
  v_mul_f32 v97, 0x3a800000, v97
  v_fma_f32 v98, -v96, v96, v97
  v_max_f32_e64 v98, 0, v98
  v_add_f32 v98, 0x3727c5ac, v98
  v_rsq_f32_e64 v98, v98
  v_mov_b32 v99, v96
  s_mov_b64 exec, s[8:9]
  buffer_store_dwordx2 v[98:99], v6, s[40:43], s10 offen sc0 sc1
  s_mov_b64 exec, -1
  s_barrier
  s_barrier
  s_barrier
  s_barrier
  s_barrier
  s_cmp_lg_u32 s82, 0
  s_cbranch_scc1 L_201
  s_lshl_b32 s91, s84, Lz1-Lz0+1
  s_and_b32 s91, s91, 0x8f000
  s_add_u32 s91, s91, 1835012
  s_mov_b32 exec_lo, 0xffff
  s_mov_b32 exec_hi, 0
  buffer_load_dword v7, v5, s[40:43], s91 offen sc0 sc1
  s_mov_b64 exec, -1
L_201:
  s_and_b32 s5, s10, 0xfffffc00
  buffer_load_dwordx4 v[120:123], v4, s[40:43], s5 offen sc1
  s_barrier
  s_barrier
  s_waitcnt vmcnt(0)
  s_mov_b32 s89, 200000
  s_branch Lp_204
Lp_203:
  s_and_b32 s5, s10, 0xfffffc00
  buffer_load_dwordx4 v[120:123], v4, s[40:43], s5 offen sc1
  s_waitcnt vmcnt(0)
Lp_204:
  v_min_u32 v2, v120, v122
  v_cmp_eq_u32 vcc, 0, v2
  s_cmp_eq_u64 vcc, 0
  s_cbranch_scc1 Lp_205
  s_sleep 1
  s_sub_u32 s89, s89, 1
  s_cbranch_scc0 Lp_203
Lp_205:
  s_and_b32 s5, s10, 0xfffffc00
  s_mov_b32 m0, 151552
  s_nop 0
  buffer_load_dword v6, s[40:43], s5 offen offset:0 sc1 lds
  s_mov_b32 m0, 152188
  s_nop 0
  buffer_load_dword v6, s[40:43], s5 offen offset:4 sc1 lds
  s_mov_b32 m0, 151360
  s_nop 0
  buffer_load_dword v6, s[40:43], s5 offen offset:512 sc1 lds
  s_mov_b32 m0, 151996
  s_nop 0
  buffer_load_dword v6, s[40:43], s5 offen offset:516 sc1 lds
  s_add_u32 s10, s10, 16384
  s_barrier
  s_cmp_lg_u32 s82, Lz1-Lz0+0
  s_cbranch_scc1 L_206
  s_mov_b32 s89, 200000
  s_mov_b32 exec_lo, 0xffff
  s_mov_b32 exec_hi, 0
  s_branch Lp_209
Lp_208:
  buffer_load_dword v7, v5, s[40:43], s91 offen sc0 sc1
  s_waitcnt vmcnt(0)
Lp_209:
  v_cmp_ne_u32 vcc, 0, v7
  s_andn2_b32 s3, 0xffff, vcc_lo
  s_cbranch_scc0 Lp_210
  s_sleep 1
  s_sub_u32 s89, s89, 1
  s_cbranch_scc0 Lp_208
Lp_210:
  s_mov_b64 exec, -1
  s_lshl_b32 s5, s77, 14
  s_add_u32 s5, s5, 1376256
  buffer_load_dwordx4 v[192:195], v4, s[40:43], s5 offen offset:0 sc1
  buffer_load_dwordx4 v[196:199], v4, s[40:43], s5 offen offset:1024 sc1
  buffer_load_dwordx4 v[200:203], v4, s[40:43], s5 offen offset:2048 sc1
  buffer_load_dwordx4 v[204:207], v4, s[40:43], s5 offen offset:3072 sc1
  s_add_u32 s5, s5, 4096
  buffer_load_dwordx4 v[208:211], v4, s[40:43], s5 offen offset:0 sc1
  buffer_load_dwordx4 v[212:215], v4, s[40:43], s5 offen offset:1024 sc1
  buffer_load_dwordx4 v[216:219], v4, s[40:43], s5 offen offset:2048 sc1
  buffer_load_dwordx4 v[220:223], v4, s[40:43], s5 offen offset:3072 sc1
  s_lshl_b32 s5, s77, Lz1-Lz0+14
  s_add_u32 s5, s5, 1384448
  buffer_load_dwordx4 v[224:227], v4, s[40:43], s5 offen offset:0 sc1
  buffer_load_dwordx4 v[228:231], v4, s[40:43], s5 offen offset:1024 sc1
  buffer_load_dwordx4 v[232:235], v4, s[40:43], s5 offen offset:2048 sc1
  buffer_load_dwordx4 v[236:239], v4, s[40:43], s5 offen offset:3072 sc1
  s_add_u32 s5, s5, 4096
  buffer_load_dwordx4 v[240:243], v4, s[40:43], s5 offen offset:0 sc1
  buffer_load_dwordx4 v[244:247], v4, s[40:43], s5 offen offset:1024 sc1
  buffer_load_dwordx4 v[248:251], v4, s[40:43], s5 offen offset:2048 sc1
  buffer_load_dwordx4 v[252:255], v4, s[40:43], s5 offen offset:3072 sc1
L_206:
  s_barrier
  s_cmp_lg_u32 s82, 0
  s_cbranch_scc1 L_211
  s_waitcnt vmcnt(8)
  v_add_f32 v192, v192, v208
  v_add_f32 v193, v193, v209
  v_add_f32 v194, v194, v210
  v_add_f32 v195, v195, v211
  v_add_f32 v196, v196, v212
  v_add_f32 v197, v197, v213
  v_add_f32 v198, v198, v214
  v_add_f32 v199, v199, v215
  v_add_f32 v200, v200, v216
  v_add_f32 v201, v201, v217
  v_add_f32 v202, v202, v218
  v_add_f32 v203, v203, v219
  v_add_f32 v204, v204, v220
  v_add_f32 v205, v205, v221
  v_add_f32 v206, v206, v222
  v_add_f32 v207, v207, v223
  v_add_f32 v192, v192, v200
  v_add_f32 v193, v193, v201
  v_add_f32 v194, v194, v202
  v_add_f32 v195, v195, v203
  v_add_f32 v196, v196, v204
  v_add_f32 v197, v197, v205
  v_add_f32 v198, v198, v206
  v_add_f32 v199, v199, v207
  v_add_f32 v192, v192, v196
  v_add_f32 v193, v193, v197
  v_add_f32 v194, v194, v198
  v_add_f32 v195, v195, v199
L_211:
  s_cmp_lg_u32 s82, 0
  s_cbranch_scc1 L_213
  buffer_load_dword v109, v110, s[60:63], s13 offen
  s_sub_u32 s13, s13, 8192
  buffer_load_dword v109, v110, s[60:63], s13 offen
  s_sub_u32 s13, s13, 8192
L_213:
  s_barrier
  s_cmp_lg_u32 s82, 0
  s_cbranch_scc1 L_215
  s_cmp_lg_u32 s82, 0
  s_cbranch_scc1 L_217
  s_waitcnt vmcnt(2)
  s_branch L_218
L_217:
  s_waitcnt vmcnt(0)
L_218:
  v_add_f32 v224, v224, v240
  v_add_f32 v225, v225, v241
  v_add_f32 v226, v226, v242
  v_add_f32 v227, v227, v243
  v_add_f32 v228, v228, v244
  v_add_f32 v229, v229, v245
  v_add_f32 v230, v230, v246
  v_add_f32 v231, v231, v247
  v_add_f32 v232, v232, v248
  v_add_f32 v233, v233, v249
  v_add_f32 v234, v234, v250
  v_add_f32 v235, v235, v251
  v_add_f32 v236, v236, v252
  v_add_f32 v237, v237, v253
  v_add_f32 v238, v238, v254
  v_add_f32 v239, v239, v255
  v_add_f32 v224, v224, v232
  v_add_f32 v225, v225, v233
  v_add_f32 v226, v226, v234
  v_add_f32 v227, v227, v235
  v_add_f32 v228, v228, v236
  v_add_f32 v229, v229, v237
  v_add_f32 v230, v230, v238
  v_add_f32 v231, v231, v239
  v_add_f32 v224, v224, v228
  v_add_f32 v225, v225, v229
  v_add_f32 v226, v226, v230
  v_add_f32 v227, v227, v231
  v_add_f32 v192, v192, v224
  v_add_f32 v193, v193, v225
  v_add_f32 v194, v194, v226
  v_add_f32 v195, v195, v227
  v_add_u32 v2, 154112, v4
  ds_write_b128 v2, v[192:195]
  s_branch L_216
  s_nop 0
L_215:
  s_waitcnt vmcnt(0)
L_216:
  s_waitcnt lgkmcnt(0)
  s_barrier
  v_lshlrev_b32 v2, 12, v1
  s_lshl_b32 s4, s76, 16
  s_lshl_b32 s5, s77, 7
  s_add_u32 s4, s4, s5
  s_add_u32 s4, s4, s87
  s_add_u32 s5, s4, 24
  s_lshl_b32 s4, s79, 3
  s_lshl_b32 s90, 0xff, s4
  s_lshl_b32 s91, s84, 1
  s_add_u32 s91, s91, s87
  s_add_u32 s91, s91, 24
  s_lshl_b32 s4, s82, 7
  s_add_u32 s4, s4, 1837056
  s_lshl_b32 s5, s84, 1
  s_add_u32 s5, s5, s4
  s_and_b32 s91, s5, 0xffff0fff
  s_barrier
  s_barrier
  s_barrier
  s_mov_b32 exec_lo, 1
  s_mov_b32 exec_hi, Lz1-Lz0+0
  buffer_store_dword v11, v2, s[40:43], s5 offen sc0 sc1
  s_mov_b64 exec, -1
  s_barrier
  s_barrier
  s_barrier
  s_mov_b32 exec_lo, s90
  s_mov_b32 exec_hi, 0
  buffer_load_dword v7, v2, s[40:43], s91 offen sc0 sc1
  s_mov_b64 exec, -1
  s_barrier
  s_waitcnt vmcnt(0)
  s_mov_b32 s89, 200000
  s_mov_b32 exec_lo, s90
  s_mov_b32 exec_hi, 0
  s_branch Lp_220
Lp_219:
  buffer_load_dword v7, v2, s[40:43], s91 offen sc0 sc1
  s_waitcnt vmcnt(0)
Lp_220:
  v_cmp_ne_u32 vcc, 0, v7
  s_andn2_b32 s3, s90, vcc_lo
  s_cbranch_scc0 Lp_221
  s_sleep 1
  s_sub_u32 s89, s89, 1
  s_cbranch_scc0 Lp_219
Lp_221:
  s_mov_b64 exec, -1
  s_xor_b32 s90, s90, 0xffff
  s_barrier
  s_barrier
  s_barrier
  s_barrier
  s_barrier
  s_barrier
  s_barrier
  s_barrier
  s_barrier
  s_barrier
  s_mov_b32 exec_lo, s90
  s_mov_b32 exec_hi, 0
  buffer_load_dword v7, v2, s[40:43], s91 offen sc0 sc1
  s_mov_b64 exec, -1
  s_barrier
  s_barrier
  s_barrier
  s_waitcnt vmcnt(0)
  s_mov_b32 s89, 200000
  s_mov_b32 exec_lo, s90
  s_mov_b32 exec_hi, 0
  s_branch Lp_223
Lp_222:
  buffer_load_dword v7, v2, s[40:43], s91 offen sc0 sc1
  s_waitcnt vmcnt(0)
Lp_223:
  v_cmp_ne_u32 vcc, 0, v7
  s_andn2_b32 s3, s90, vcc_lo
  s_cbranch_scc0 Lp_224
  s_sleep 1
  s_sub_u32 s89, s89, 1
  s_cbranch_scc0 Lp_222
Lp_224:
  s_mov_b64 exec, -1
  s_barrier
  s_barrier
  s_barrier
  s_barrier
  s_barrier
  s_barrier
  s_barrier
  s_barrier
  s_barrier
  s_barrier
  s_barrier
  s_cmp_lg_u32 s82, 0
  s_cbranch_scc1 L_lend
  s_add_u32 s92, s83, 36700160
  s_mov_b32 s82, 1
  s_mov_b32 s14, 0
  s_add_u32 s83, s83, 0
  s_add_u32 s87, s87, 32
  s_branch L_slayer
L_lend:
Lz0:
Lz1:
L_end:
  s_endpgm
.section .rodata,"a"
.p2align 6
.amdhsa_kernel mega_kernel
  .amdhsa_next_free_vgpr 256
  .amdhsa_next_free_sgpr 102
  .amdhsa_accum_offset 256
  .amdhsa_group_segment_fixed_size 0
  .amdhsa_kernarg_size 88
  .amdhsa_user_sgpr_count 2
  .amdhsa_user_sgpr_kernarg_segment_ptr 1
  .amdhsa_system_sgpr_workgroup_id_x 1
  .amdhsa_float_denorm_mode_32 3
  .amdhsa_float_denorm_mode_16_64 3
.end_amdhsa_kernel
.text
```

```asm
; @launch kernel=mega_kernel grid=(256,1,1) block=(512,1,1) lds=156672
.amdgcn_target "amdgcn-amd-amdhsa--gfx950"
.text
.globl mega_kernel
.p2align 8
.type mega_kernel,@function
mega_kernel:
  s_cmp_ge_u32 s2, 256
  s_nop 0
  s_cbranch_scc1 L_end
  s_load_dwordx16 s[16:31], s[0:1], 0
  s_load_dwordx2 s[32:33], s[0:1], 64
  s_load_dwordx4 s[36:39], s[0:1], 72
  v_lshrrev_b32 v2, 6, v0
  v_and_b32 v1, 63, v0
  v_readfirstlane_b32 s81, v2
  s_and_b32 s3, s2, 7
  s_lshr_b32 s4, s2, 3
  s_and_b32 s5, s3, 1
  s_lshl_b32 s5, s5, 3
  s_and_b32 s6, s4, 7
  s_add_u32 s76, s5, s6
  s_lshr_b32 s5, s3, 1
  s_lshl_b32 s5, s5, 2
  s_lshr_b32 s6, s4, 3
  s_add_u32 s77, s5, s6
  s_mov_b32 s82, 0
  s_mov_b32 s88, 0
  s_and_b32 s85, s81, 1
  s_cmp_lt_u32 s81, 4
  s_cbranch_scc1 L_comp
  s_cmp_eq_u32 s81, Lz1-Lz0+5
  s_cbranch_scc1 L_serv
  s_setprio 0
  s_cmp_eq_u32 s81, 4
  s_cbranch_scc1 L_xload
  v_bfe_u32 v2, v1, 1, 2
  v_bfe_u32 v3, v1, 4, 2
  v_xor_b32 v2, v2, v3
  v_lshlrev_b32 v10, 5, v2
  v_and_b32_e64 v2, 1, v1
  v_lshl_add_u32 v10, v2, 4, v10
  v_lshrrev_b32_e64 v2, 5, v1
  v_bfe_u32 v3, v1, 3, 2
  v_lshl_add_u32 v2, v2, 3, v3
  s_mov_b32 s4, 6144
  v_mad_u32_u24 v16, v2, s4, v10
  v_add_u32 v17, 97280, v16
  v_add_u32 v18, 22528, v16
  v_add_u32 v19, 119808, v16
  s_lshl_b32 s5, s77, Lz1-Lz0+7
  s_mul_i32 s4, s85, 196608
  s_add_u32 s5, s5, s4
  s_and_b32 s6, s76, 6
  s_lshr_b32 s4, s76, 3
  s_add_u32 s6, s6, s4
  s_lshl_b32 s6, s6, 1
  v_add_u32 v20, s6, v1
  v_and_b32_e64 v20, 15, v20
  s_mov_b32 s4, 393216
  v_mul_u32_u24 v20, s4, v20
  v_add_u32 v20, s5, v20
  s_nop 0
  v_readfirstlane_b32 s7, v20
  s_lshl_b32 s11, s85, Lz1-Lz0+12
  s_add_u32 s11, s11, 65536
  s_add_u32 s15, s11, 73728
  s_waitcnt lgkmcnt(0)
  s_mov_b32 s48, s18
  s_and_b32 s49, s19, 0xffff
  s_mov_b32 s50, 6291456
  s_mov_b32 s51, 0x00020000
L_wlayer:
  s_mov_b32 s12, 0
  s_mov_b32 m0, s11
  s_cmp_eq_u32 s82, 0
  s_cbranch_scc1 Ll_34
  s_waitcnt vmcnt(12)
  s_barrier
  s_waitcnt vmcnt(8)
  s_barrier
  s_waitcnt vmcnt(4)
  s_barrier
  s_waitcnt vmcnt(0)
  s_barrier
  s_barrier
  s_branch Ll_34
Lt_40:
  s_cmp_lg_u32 s12, 1
  s_cbranch_scc1 Ll_34
  s_cmp_eq_u32 s82, 0
  s_cbranch_scc1 Ll_34
  s_waitcnt vmcnt(0)
  s_barrier
Ll_34:
  buffer_load_dwordx4 v16, s[48:51], s7 offen offset:0  lds
  buffer_load_dwordx4 v17, s[48:51], s7 offen offset:1024  lds
  buffer_load_dwordx4 v18, s[48:51], s7 offen offset:2048  lds
  buffer_load_dwordx4 v19, s[48:51], s7 offen offset:3072  lds
  s_add_u32 m0, s11, 8192
  s_add_u32 s5, s7, 2048
  buffer_load_dwordx4 v16, s[48:51], s5 offen offset:0  lds
  buffer_load_dwordx4 v17, s[48:51], s5 offen offset:1024  lds
  buffer_load_dwordx4 v18, s[48:51], s5 offen offset:2048  lds
  buffer_load_dwordx4 v19, s[48:51], s5 offen offset:3072  lds
  s_add_u32 m0, s11, 16384
  s_add_u32 s5, s7, 4096
  buffer_load_dwordx4 v16, s[48:51], s5 offen offset:0  lds
  s_add_u32 s12, s12, Lz1-Lz0+1
  v_readlane_b32 s7, v20, s12
  s_add_u32 s11, s11, 24576
  buffer_load_dwordx4 v17, s[48:51], s5 offen offset:1024  lds
  s_cmp_eq_u32 s11, s15
  s_cselect_b32 s4, 73728, 0
  s_sub_u32 s11, s11, s4
  buffer_load_dwordx4 v18, s[48:51], s5 offen offset:2048  lds
  s_cmp_lg_u32 s12, Lz1-Lz0+3
  buffer_load_dwordx4 v19, s[48:51], s5 offen offset:3072  lds
  s_mov_b32 m0, s11
  s_cbranch_scc1 Lt_40
Lt_41:
  s_cmp_lg_u32 s82, Lz1-Lz0+0
  s_cbranch_scc1 Ll_42
  s_waitcnt vmcnt(24)
  s_barrier
Ll_42:
  s_mul_i32 s5, s85, 6144
  s_mov_b32 s68, s24
  s_and_b32 s69, s25, 0xffff
  s_mov_b32 s70, 7340032
  s_mov_b32 s71, 0x00020000
  s_lshl_b32 s4, s76, 4
  s_add_u32 s4, s4, s77
  s_mul_i32 s34, s4, 28672
  s_add_u32 s34, s34, s5
  s_mov_b32 s40, s38
  s_and_b32 s41, s39, 0xffff
  s_mov_b32 s42, 100663296
  s_mov_b32 s43, 0x00020000
  s_nop 0
  s_mov_b32 s52, s20
  s_and_b32 s53, s21, 0xffff
  s_mov_b32 s54, 2097152
  s_mov_b32 s55, 0x00020000
  s_nop 0
  s_mov_b32 s56, s24
  s_and_b32 s57, s25, 0xffff
  s_mov_b32 s58, 7340032
  s_mov_b32 s59, 0x00020000
  s_nop 0
  s_mov_b32 s60, s28
  s_and_b32 s61, s29, 0xffff
  s_mov_b32 s62, 7340032
  s_mov_b32 s63, 0x00020000
  s_cmp_lg_u32 s82, 0
  s_cbranch_scc1 L_43
  s_and_b32 s80, s77, 7
  s_lshr_b32 s79, s77, 3
  s_lshl_b32 s78, s80, 1
  s_add_u32 s78, s78, s79
  s_lshl_b32 s5, s76, 4
  s_add_u32 s5, s5, s77
  s_lshl_b32 s84, s5, Lz1-Lz0+11
  s_mov_b32 s83, 3145728
  s_mov_b32 s87, 1835016
  s_lshr_b32 s86, s81, 1
  v_lshrrev_b32 v2, 3, v1
  s_mov_b32 s4, 2048
  v_mad_u32_u24 v4, v2, s4, v10
  v_add_u32 v5, 15360, v4
  v_add_u32 v6, 30720, v4
  v_add_u32 v7, 46080, v4
  s_lshl_b32 s5, s78, Lz1-Lz0+7
  s_mul_i32 s4, s85, 65536
  s_add_u32 s5, s5, s4
  s_mul_i32 s4, s76, 14
  s_lshr_b32 s4, s4, 4
  v_add_u32 v39, s4, v1
  v_subrev_u32 v2, 14, v39
  v_min_u32 v39, v39, v2
  v_cmp_le_u32 vcc, 14, v1
  s_nop 1
  v_cndmask_b32 v39, v39, v1, vcc
  v_lshlrev_b32 v39, 2, v39
  v_mov_b32 v2, 0x87654210
  v_mov_b32 v3, 0xb3fedca9
  v_lshrrev_b64 v[2:3], v39, v[2:3]
  v_and_b32_e64 v39, 15, v2
  v_cmp_eq_u32 vcc, s77, v39
  s_nop 0
  v_mov_b32_dpp v2, v39 row_shr:1 row_mask:0xf bank_mask:0xf
  s_ff1_i32_b32 s4, vcc_lo
  v_cmp_ge_u32 vcc, s4, v1
  s_nop 1
  v_cndmask_b32 v39, v39, v2, vcc
  v_writelane_b32 v39, s77, 0
  v_lshl_add_u32 v38, v39, 17, s5
L_43:
  s_waitcnt vmcnt(12)
  s_barrier
  buffer_load_dwordx4 v16, s[48:51], s7 offen offset:0  lds
  buffer_load_dwordx4 v17, s[48:51], s7 offen offset:1024  lds
  buffer_load_dwordx4 v18, s[48:51], s7 offen offset:2048  lds
  buffer_load_dwordx4 v19, s[48:51], s7 offen offset:3072  lds
Ll_44:
  s_add_u32 m0, s11, 8192
  s_add_u32 s5, s7, 2048
  buffer_load_dwordx4 v16, s[48:51], s5 offen offset:0  lds
  buffer_load_dwordx4 v17, s[48:51], s5 offen offset:1024  lds
  buffer_load_dwordx4 v18, s[48:51], s5 offen offset:2048  lds
  buffer_load_dwordx4 v19, s[48:51], s5 offen offset:3072  lds
  s_add_u32 m0, s11, 16384
  s_add_u32 s5, s7, 4096
  buffer_load_dwordx4 v16, s[48:51], s5 offen offset:0  lds
  s_add_u32 s12, s12, Lz1-Lz0+1
  v_readlane_b32 s7, v20, s12
  s_add_u32 s11, s11, 24576
  buffer_load_dwordx4 v17, s[48:51], s5 offen offset:1024  lds
  s_cmp_eq_u32 s11, s15
  s_cselect_b32 s4, 73728, 0
  s_sub_u32 s11, s11, s4
  buffer_load_dwordx4 v18, s[48:51], s5 offen offset:2048  lds
  s_cmp_eq_u32 s12, Lz1-Lz0+16
  buffer_load_dwordx4 v19, s[48:51], s5 offen offset:3072  lds
  s_mov_b32 m0, s11
  s_cbranch_scc1 Ll_45
  s_cmp_lg_u32 s82, 0
  s_cbranch_scc1 L_46
  s_buffer_load_dwordx2 s[98:99], s[68:71], s34 offset:60
  s_buffer_load_dwordx2 s[98:99], s[68:71], s34 offset:188
  s_buffer_load_dwordx2 s[98:99], s[68:71], s34 offset:316
  s_buffer_load_dwordx2 s[98:99], s[68:71], s34 offset:444
  s_add_u32 s34, s34, 512
L_46:
  s_waitcnt vmcnt(12)
  s_barrier
  buffer_load_dwordx4 v16, s[48:51], s7 offen offset:0  lds
  buffer_load_dwordx4 v17, s[48:51], s7 offen offset:1024  lds
  buffer_load_dwordx4 v18, s[48:51], s7 offen offset:2048  lds
  buffer_load_dwordx4 v19, s[48:51], s7 offen offset:3072  lds
  s_branch Ll_44
Ll_45:
  s_branch L_w1
L_xload:
  s_setprio 0
  v_lshrrev_b32 v2, 4, v1
  v_and_b32 v3, 7, v1
  v_xor_b32 v2, v2, v3
  v_lshrrev_b32 v3, 3, v1
  v_lshlrev_b32 v3, 12, v3
  v_lshl_add_u32 v4, v2, 4, v3
  v_xor_b32_e64 v5, 64, v4
  v_add_u32 v5, 31744, v5
  v_add_u32 v6, 63488, v4
  v_add_u32 v7, 63488, v5
  s_mov_b32 s13, 0x20000
  s_movk_i32 s95, 2048
  s_lshl_b32 s5, s76, 18
  s_and_b32 s6, s76, 6
  s_lshr_b32 s4, s76, 3
  s_add_u32 s6, s6, s4
  s_lshl_b32 s6, s6, 1
  v_add_u32 v9, s6, v1
  v_and_b32 v9, 15, v9
  v_lshl_add_u32 v9, v9, 7, s5
  s_nop 0
  v_readfirstlane_b32 s7, v9
  s_waitcnt lgkmcnt(0)
  s_mov_b32 s72, s16
  s_and_b32 s73, s17, 0xffff
  s_mov_b32 s74, 4194304
  s_mov_b32 s75, 0x00020000
  s_mov_b32 s11, 0
  s_mov_b32 s15, 65536
L_xlayer:
  s_mov_b32 s12, s82
  s_mov_b32 m0, s11
Ll_87:
  s_nop 0
  buffer_load_dwordx4 v4, s[72:75], s7 offen offset:0 sc1 lds
  buffer_load_dwordx4 v5, s[72:75], s7 offen offset:1024 sc1 lds
  buffer_load_dwordx4 v6, s[72:75], s7 offen offset:2048 sc1 lds
  buffer_load_dwordx4 v7, s[72:75], s7 offen offset:3072 sc1 lds
  s_add_u32 m0, s11, 4096
  s_nop 0
  s_add_u32 s5, s7, s13
  buffer_load_dwordx4 v4, s[72:75], s5 offen offset:0 sc1 lds
  buffer_load_dwordx4 v5, s[72:75], s5 offen offset:1024 sc1 lds
  buffer_load_dwordx4 v6, s[72:75], s5 offen offset:2048 sc1 lds
  buffer_load_dwordx4 v7, s[72:75], s5 offen offset:3072 sc1 lds
  s_add_u32 m0, s11, 8192
  s_nop 0
  s_add_u32 s3, s7, s95
  buffer_load_dwordx4 v4, s[72:75], s3 offen offset:0 sc1 lds
  buffer_load_dwordx4 v5, s[72:75], s3 offen offset:1024 sc1 lds
  buffer_load_dwordx4 v6, s[72:75], s3 offen offset:2048 sc1 lds
  buffer_load_dwordx4 v7, s[72:75], s3 offen offset:3072 sc1 lds
  s_add_u32 m0, s11, 12288
  s_add_u32 s5, s3, s13
  buffer_load_dwordx4 v4, s[72:75], s5 offen offset:0 sc1 lds
  s_add_u32 s12, s12, 1
  v_readlane_b32 s7, v9, s12
  s_add_u32 s11, s11, 16384
  buffer_load_dwordx4 v5, s[72:75], s5 offen offset:1024 sc1 lds
  s_cmp_eq_u32 s11, s15
  s_cselect_b32 s4, 65536, 0
  s_sub_u32 s11, s11, s4
  buffer_load_dwordx4 v6, s[72:75], s5 offen offset:2048 sc1 lds
  s_cmp_lg_u32 s12, Lz1-Lz0+2
  buffer_load_dwordx4 v7, s[72:75], s5 offen offset:3072 sc1 lds
  s_mov_b32 m0, s11
  s_cbranch_scc1 Ll_88
  s_cmp_lg_u32 s82, 0
  s_cbranch_scc1 Ll_88
  s_waitcnt vmcnt(16)
  s_barrier
Ll_92:
Ll_88:
  s_cmp_lt_u32 s12, Lz1-Lz0+4
  s_cbranch_scc1 Ll_87
  s_mov_b32 s68, s20
  s_and_b32 s69, s21, 0xffff
  s_mov_b32 s70, 2097152
  s_mov_b32 s71, 0x00020000
  s_lshl_b32 s4, s76, 4
  s_add_u32 s4, s4, s77
  s_mul_i32 s34, s4, 8192
  s_waitcnt vmcnt(32)
  s_barrier
  buffer_load_dwordx4 v4, s[72:75], s7 offen offset:0 sc1 lds
  buffer_load_dwordx4 v5, s[72:75], s7 offen offset:1024 sc1 lds
  buffer_load_dwordx4 v6, s[72:75], s7 offen offset:2048 sc1 lds
  buffer_load_dwordx4 v7, s[72:75], s7 offen offset:3072 sc1 lds
Ll_93:
  s_add_u32 m0, s11, 4096
  s_nop 0
  s_add_u32 s5, s7, s13
  buffer_load_dwordx4 v4, s[72:75], s5 offen offset:0 sc1 lds
  buffer_load_dwordx4 v5, s[72:75], s5 offen offset:1024 sc1 lds
  buffer_load_dwordx4 v6, s[72:75], s5 offen offset:2048 sc1 lds
  buffer_load_dwordx4 v7, s[72:75], s5 offen offset:3072 sc1 lds
  s_add_u32 m0, s11, 8192
  s_nop 0
  s_add_u32 s3, s7, s95
  buffer_load_dwordx4 v4, s[72:75], s3 offen offset:0 sc1 lds
  buffer_load_dwordx4 v5, s[72:75], s3 offen offset:1024 sc1 lds
  buffer_load_dwordx4 v6, s[72:75], s3 offen offset:2048 sc1 lds
  buffer_load_dwordx4 v7, s[72:75], s3 offen offset:3072 sc1 lds
  s_add_u32 m0, s11, 12288
  s_add_u32 s5, s3, s13
  buffer_load_dwordx4 v4, s[72:75], s5 offen offset:0 sc1 lds
  s_add_u32 s12, s12, 1
  v_readlane_b32 s7, v9, s12
  s_add_u32 s11, s11, 16384
  buffer_load_dwordx4 v5, s[72:75], s5 offen offset:1024 sc1 lds
  s_cmp_eq_u32 s11, s15
  s_cselect_b32 s4, 65536, 0
  s_sub_u32 s11, s11, s4
  buffer_load_dwordx4 v6, s[72:75], s5 offen offset:2048 sc1 lds
  s_cmp_eq_u32 s12, Lz1-Lz0+16
  buffer_load_dwordx4 v7, s[72:75], s5 offen offset:3072 sc1 lds
  s_mov_b32 m0, s11
  s_cbranch_scc1 Ll_94
  s_cmp_lg_u32 s82, 0
  s_cbranch_scc1 L_95
  s_buffer_load_dwordx2 s[98:99], s[68:71], s34 offset:60
  s_buffer_load_dwordx2 s[98:99], s[68:71], s34 offset:188
  s_buffer_load_dwordx2 s[98:99], s[68:71], s34 offset:316
  s_buffer_load_dwordx2 s[98:99], s[68:71], s34 offset:444
  s_buffer_load_dwordx2 s[98:99], s[68:71], s34 offset:572
  s_add_u32 s34, s34, 640
L_95:
  s_waitcnt vmcnt(32)
  s_barrier
  buffer_load_dwordx4 v4, s[72:75], s7 offen offset:0 sc1 lds
  buffer_load_dwordx4 v5, s[72:75], s7 offen offset:1024 sc1 lds
  buffer_load_dwordx4 v6, s[72:75], s7 offen offset:2048 sc1 lds
  buffer_load_dwordx4 v7, s[72:75], s7 offen offset:3072 sc1 lds
  s_branch Ll_93
Ll_94:
  s_waitcnt vmcnt(32)
  s_barrier
  s_branch L_x1
L_serv:
  s_setprio 3
  s_and_b32 s80, s77, 7
  s_lshr_b32 s79, s77, 3
  s_lshl_b32 s78, s80, 1
  s_add_u32 s78, s78, s79
  s_lshl_b32 s5, s76, 4
  s_add_u32 s5, s5, s77
  s_lshl_b32 s84, s5, 11
  s_mov_b32 s83, 3145728
  s_mov_b32 s87, 1835016
  s_lshr_b32 s86, s81, 1
  v_lshlrev_b32 v4, 4, v1
  v_mov_b32 v24, 0
  v_mov_b32 v25, 0
  v_mov_b32 v26, 0
  v_mov_b32 v27, 0
  v_and_b32 v2, 14, v1
  v_lshlrev_b32 v3, 11, v2
  v_and_b32_e64 v2, 1, v1
  v_lshl_add_u32 v3, v2, 4, v3
  v_and_b32_e64 v2, 48, v1
  v_lshl_add_u32 v3, v2, 1, v3
  v_bfe_u32 v2, v1, 3, 2
  v_and_b32 v22, 7, v1
  v_lshlrev_b32 v2, 14, v2
  v_lshl_add_u32 v2, v22, 3, v2
  s_lshl_b32 s5, s76, 7
  s_lshl_b32 s4, s80, 4
  s_add_u32 s6, s5, s4
  s_add_u32 s6, s6, s79
  s_lshl_b32 s6, s6, 11
  s_lshr_b32 s10, s84, 5
  s_add_u32 s10, s10, 1638400
  s_waitcnt lgkmcnt(0)
  s_mov_b32 s40, s38
  s_and_b32 s41, s39, 0xffff
  s_mov_b32 s42, 100663296
  s_mov_b32 s43, 0x00020000
  s_nop 0
  s_mov_b32 s44, s16
  s_and_b32 s45, s17, 0xffff
  s_mov_b32 s46, 4194304
  s_mov_b32 s47, 0x00020000
  s_nop 0
  s_mov_b32 s68, s36
  s_and_b32 s69, s37, 0xffff
  s_mov_b32 s70, 256
  s_mov_b32 s71, 0x00020000
  s_lshl_b32 s4, s84, Lz1-Lz0+1
  s_add_u32 s4, s4, 1835008
  buffer_store_dwordx4 v[24:27], v4, s[40:43], s4 offen offset:0 sc0 sc1
  buffer_store_dwordx4 v[24:27], v4, s[40:43], s4 offen offset:1024 sc0 sc1
  s_mov_b64 exec, 0xffff
  buffer_store_dwordx4 v[24:27], v4, s[40:43], s4 offen offset:2048 sc0 sc1
  s_mov_b64 exec, -1
  v_mov_b32 v28, -1
  v_mov_b32 v29, -1
  v_mov_b32 v30, -1
  v_mov_b32 v31, -1
  s_lshl_b32 s4, s84, 1
  s_add_u32 s4, s4, Lz1-Lz0+0
  buffer_store_dwordx4 v[28:31], v4, s[40:43], s4 offen offset:0 sc0 sc1
  buffer_store_dwordx4 v[28:31], v4, s[40:43], s4 offen offset:1024 sc0 sc1
  buffer_store_dwordx4 v[28:31], v4, s[40:43], s4 offen offset:2048 sc0 sc1
  buffer_store_dwordx4 v[28:31], v4, s[40:43], s4 offen offset:3072 sc0 sc1
  buffer_store_dwordx2 v[24:25], v2, s[40:43], s10 offen sc0 sc1
  v_mov_b32 v108, v3
  s_mov_b32 s7, s6
  s_branch L_s1
L_comp:
  s_and_b32 s80, s77, 7
  s_lshr_b32 s79, s77, 3
  s_lshl_b32 s78, s80, 1
  s_add_u32 s78, s78, s79
  s_lshl_b32 s5, s76, 4
  s_add_u32 s5, s5, s77
  s_lshl_b32 s84, s5, 11
  s_mov_b32 s83, 3145728
  s_mov_b32 s87, 1835016
  s_lshr_b32 s86, s81, Lz1-Lz0+1
  s_waitcnt lgkmcnt(0)
  s_mov_b32 s40, s38
  s_and_b32 s41, s39, 0xffff
  s_mov_b32 s42, 100663296
  s_mov_b32 s43, 0x00020000
  s_nop 0
  s_mov_b32 s64, s32
  s_and_b32 s65, s33, 0xffff
  s_mov_b32 s66, 4194304
  s_mov_b32 s67, 0x00020000
  s_bfe_u32 s4, s2, 0x30003
  s_lshl2_add_u32 s4, s4, s81
  s_cmp_lt_u32 s4, 20
  s_cbranch_scc0 L_tlo
  s_lshl_b32 s4, s4, 21
  s_buffer_load_dword s99, s[40:43], s4 offset:4032
  s_branch L_tle
L_tlo:
  s_cmp_lt_u32 s4, 24
  s_cbranch_scc1 L_tlp
  s_cmp_lt_u32 s4, 28
  s_cbranch_scc1 L_tlq
  s_lshl_b32 s4, s81, 21
  s_load_dword s99, s[28:29], s4
  s_load_dword s99, s[24:25], s4
  s_branch L_tle
  s_nop 0
L_tlq:
  s_load_dword s99, s[26:27], 0
  s_load_dword s99, s[30:31], 0
  s_load_dword s99, s[20:21], 0
  s_branch L_tle
L_tlp:
  s_lshl_b32 s4, s85, 21
  s_buffer_load_dword s99, s[64:67], s4 offset:4032
L_tle:
  s_setprio 1
  v_lshlrev_b32 v11, 4, v1
  v_lshrrev_b32 v2, 3, v1
  v_and_b32 v3, 7, v1
  v_lshlrev_b32_e64 v3, 3, v3
  v_lshl_add_u32 v30, v2, 11, v3
  s_lshl_b32 s4, s85, 13
  s_lshl_b32 s5, s86, 10
  s_add_u32 s4, s4, s5
  v_add_u32 v0, s4, v11
  v_mov_b32_e64 v27, 1
  v_mov_b32 v28, 156416
  v_and_b32 v29, 48, v1
  s_lshl_b32 s4, s76, 16
  s_lshl_b32 s5, s77, 7
  s_add_u32 s4, s4, s5
  v_lshlrev_b32 v24, 12, v1
  v_and_b32 v2, 16, v1
  v_lshl_add_u32 v24, v2, 7, v24
  v_add_u32 v24, s4, v24
  v_lshrrev_b32 v2, 2, v1
  v_lshlrev_b32 v25, 7, v2
  v_and_b32 v2, 3, v1
  v_lshl_add_u32 v25, v2, 3, v25
  v_add_u32 v25, 65536, v25
  v_bfe_u32 v26, v1, 3, 2
  v_and_b32 v2, 15, v1
  v_lshrrev_b32 v3, 2, v29
  v_sub_u32_e64 v2, v2, v3
  s_mov_b32 s4, 0xf149f2ca
  v_mov_b32 v32, s4
  v_subrev_u32 v3, 0, v2
  v_cmp_gt_u32 vcc, 8, v3
  s_nop 1
  v_cndmask_b32_e64 v12, v32, 0, vcc
  v_cmp_ge_i32 vcc, -9, v3
  s_nop 1
  v_cndmask_b32_e64 v16, v32, 0, vcc
  v_cndmask_b32_e64 v20, 0, -1, vcc
  v_subrev_u32_e64 v3, 1, v2
  v_cmp_gt_u32 vcc, 8, v3
  s_nop 1
  v_cndmask_b32_e64 v13, v32, 0, vcc
  v_cmp_ge_i32 vcc, -9, v3
  s_nop 1
  v_cndmask_b32_e64 v17, v32, 0, vcc
  v_cndmask_b32_e64 v21, 0, -1, vcc
  v_subrev_u32_e64 v3, 2, v2
  v_cmp_gt_u32 vcc, 8, v3
  s_nop 1
  v_cndmask_b32_e64 v14, v32, 0, vcc
  v_cmp_ge_i32 vcc, -9, v3
  s_nop 1
  v_cndmask_b32_e64 v18, v32, 0, vcc
  v_cndmask_b32_e64 v22, 0, -1, vcc
  v_subrev_u32_e64 v3, 3, v2
  v_cmp_gt_u32 vcc, 8, v3
  s_nop 1
  v_cndmask_b32_e64 v15, v32, 0, vcc
  v_cmp_ge_i32 vcc, -9, v3
  s_nop 1
  v_cndmask_b32_e64 v19, v32, 0, vcc
  v_cndmask_b32_e64 v23, 0, -1, vcc
  v_alignbit_b32 v20, v21, v20, 16
  v_alignbit_b32 v21, v23, v22, 16
  s_lshl_b32 s11, s84, Lz1-Lz0+1
  s_lshl_b32 s4, s81, 10
  s_add_u32 s11, s11, s4
  v_bfe_u32 v2, v1, 4, 1
  v_lshrrev_b32_e64 v3, 5, v1
  v_lshl_add_u32 v2, v2, 1, v3
  v_lshl_add_u32 v2, s86, 2, v2
  v_bfe_u32 v3, v1, 1, 3
  v_xor_b32 v2, v2, v3
  v_and_b32 v3, 15, v1
  v_lshl_add_u32 v2, v3, 3, v2
  s_lshl_b32 s4, s85, Lz1-Lz0+13
  v_lshl_add_u32 v255, v2, 4, s4
L_clayer:
  s_mov_b32 s16, Lz1-Lz0+0
  s_mov_b32 s17, 16384
  s_mov_b32 s18, 0xffff4000
  s_mov_b32 s19, Lz1-Lz0+0
  s_mov_b32 s20, 24576
  s_mov_b32 s21, 0xffff4000
  s_mul_i32 s4, s85, 8192
  v_add_u32_e64 v4, s4, v11
  v_add_u32 v5, 1024, v4
  s_cmp_lg_u32 s82, 0
  s_cbranch_scc1 L_1
  v_and_b32 v2, 15, v1
  v_lshrrev_b32 v3, 1, v2
  v_lshrrev_b32 v32, 4, v1
  v_xor_b32 v3, v3, v32
  v_lshlrev_b32_e64 v3, 4, v3
  v_lshl_add_u32 v3, v2, 7, v3
  v_add_u32 v4, s4, v3
  v_xor_b32 v3, 64, v3
  v_add_u32 v5, s4, v3
L_1:
  s_lshl_b32 s4, s86, 1
  v_xor_b32_e64 v2, s4, v26
  v_lshl_add_u32 v6, v2, 5, v25
  s_add_u32 s4, s4, 1
  v_xor_b32 v2, s4, v26
  v_lshl_add_u32 v7, v2, 5, v25
  v_mov_b64 v[128:129], 0
  v_mov_b64 v[130:131], 0
  v_mov_b64 v[132:133], 0
  v_mov_b64 v[134:135], 0
  v_mov_b64 v[136:137], 0
  v_mov_b64 v[138:139], 0
  v_mov_b64 v[140:141], 0
  v_mov_b64 v[142:143], 0
  v_mov_b64 v[144:145], 0
  v_mov_b64 v[146:147], 0
  v_mov_b64 v[148:149], 0
  v_mov_b64 v[150:151], 0
  v_mov_b64 v[152:153], 0
  v_mov_b64 v[154:155], 0
  v_mov_b64 v[156:157], 0
  v_mov_b64 v[158:159], 0
  v_mov_b64 v[160:161], 0
  v_mov_b64 v[162:163], 0
  v_mov_b64 v[164:165], 0
  v_mov_b64 v[166:167], 0
  v_mov_b64 v[168:169], 0
  v_mov_b64 v[170:171], 0
  v_mov_b64 v[172:173], 0
  v_mov_b64 v[174:175], 0
  v_mov_b64 v[176:177], 0
  v_mov_b64 v[178:179], 0
  v_mov_b64 v[180:181], 0
  v_mov_b64 v[182:183], 0
  v_mov_b64 v[184:185], 0
  v_mov_b64 v[186:187], 0
  v_mov_b64 v[188:189], 0
  v_mov_b64 v[190:191], 0
  v_mov_b64 v[192:193], 0
  v_mov_b64 v[194:195], 0
  v_mov_b64 v[196:197], 0
  v_mov_b64 v[198:199], 0
  v_mov_b64 v[200:201], 0
  v_mov_b64 v[202:203], 0
  v_mov_b64 v[204:205], 0
  v_mov_b64 v[206:207], 0
  v_mov_b64 v[208:209], 0
  v_mov_b64 v[210:211], 0
  v_mov_b64 v[212:213], 0
  v_mov_b64 v[214:215], 0
  v_mov_b64 v[216:217], 0
  v_mov_b64 v[218:219], 0
  v_mov_b64 v[220:221], 0
  v_mov_b64 v[222:223], 0
  s_mul_i32 s4, s85, 320
  s_add_u32 s4, s4, 151552
  v_and_b32_e64 v2, 15, v1
  v_lshl_add_u32 v3, v2, 2, s4
  v_add_u32 v10, s4, v29
  s_lshl_b32 s5, s86, 7
  s_add_u32 s5, s5, 153088
  v_add_u32_e64 v8, s5, v29
  v_lshl_add_u32 v2, v2, 2, s5
  s_mov_b32 s10, 0x7f
  s_mov_b32 s12, 0xff00ff00
  s_add_u32 s9, s11, 65536
  v_lshrrev_b32_e64 v9, 1, v11
  v_bfi_b32 v9, s10, v11, v9
  s_mov_b32 s22, Lz1-Lz0+8
  s_cmp_lg_u32 s82, 0
  s_cselect_b64 vcc, -1, 0
  s_waitcnt lgkmcnt(0)
  s_barrier
Lo_5:
  ds_read_b128 v[32:35], v4 offset:0
  ds_read_b128 v[48:51], v5 offset:0
  ds_read_b128 v[36:39], v4 offset:2048
  ds_read_b128 v[52:55], v5 offset:2048
  ds_read_b128 v[40:43], v4 offset:4096
  ds_read_b128 v[56:59], v5 offset:4096
  ds_read_b64_tr_b16 v[96:97], v6 offset:0
  ds_read_b64_tr_b16 v[98:99], v6 offset:2048
  ds_read_b64_tr_b16 v[100:101], v6 offset:4096
  ds_read_b64_tr_b16 v[102:103], v6 offset:6144
  ds_read_b128 v[44:47], v4 offset:6144
  ds_read_b128 v[60:63], v5 offset:6144
  ds_read_b64_tr_b16 v[104:105], v7 offset:0
  s_nop 0
  s_waitcnt lgkmcnt(8)
  ds_read_b64_tr_b16 v[106:107], v7 offset:2048
  ds_read_b64_tr_b16 v[108:109], v7 offset:4096
  ds_read_b64_tr_b16 v[110:111], v7 offset:6144
  s_nop 0
  s_waitcnt lgkmcnt(6)
  .p2align 7
Lk_2:
  v_mfma_f32_16x16x32_bf16 v[128:131], v[96:99], v[32:35], v[128:131]
  ds_read_b64_tr_b16 v[112:113], v6 offset:8192
  v_mfma_f32_16x16x32_bf16 v[128:131], v[100:103], v[48:51], v[128:131]
  ds_read_b64_tr_b16 v[114:115], v6 offset:10240
  v_mfma_f32_16x16x32_bf16 v[136:139], v[100:103], v[52:55], v[136:139]
  ds_read_b64_tr_b16 v[116:117], v6 offset:12288
  v_mfma_f32_16x16x32_bf16 v[136:139], v[96:99], v[36:39], v[136:139]
  ds_read_b64_tr_b16 v[118:119], v6 offset:14336
  v_mfma_f32_16x16x32_bf16 v[144:147], v[96:99], v[40:43], v[144:147]
  s_add_u32 s16, s16, s17
  s_cmp_eq_u32 s16, 65536
  s_cselect_b32 s23, s18, s17
  s_cselect_b32 s16, Lz1-Lz0+0, s16
  v_mfma_f32_16x16x32_bf16 v[144:147], v[100:103], v[56:59], v[144:147]
  v_add_u32_e64 v4, s23, v4
  v_add_u32 v5, s23, v5
  s_add_u32 s19, s19, s20
  s_cmp_eq_u32 s19, 73728
  s_waitcnt lgkmcnt(8)
  v_mfma_f32_16x16x32_bf16 v[152:155], v[100:103], v[60:63], v[152:155]
  s_cselect_b32 s23, s21, s20
  s_cselect_b32 s19, 0, s19
  v_mfma_f32_16x16x32_bf16 v[152:155], v[96:99], v[44:47], v[152:155]
  s_waitcnt lgkmcnt(4)
  v_mfma_f32_16x16x32_bf16 v[156:159], v[104:107], v[44:47], v[156:159]
  ds_read_b64_tr_b16 v[120:121], v7 offset:8192
  v_mfma_f32_16x16x32_bf16 v[156:159], v[108:111], v[60:63], v[156:159]
  ds_read_b64_tr_b16 v[122:123], v7 offset:10240
  v_mfma_f32_16x16x32_bf16 v[148:151], v[108:111], v[56:59], v[148:151]
  ds_read_b64_tr_b16 v[124:125], v7 offset:12288
  v_mfma_f32_16x16x32_bf16 v[148:151], v[104:107], v[40:43], v[148:151]
  ds_read_b64_tr_b16 v[126:127], v7 offset:14336
  v_mfma_f32_16x16x32_bf16 v[140:143], v[104:107], v[36:39], v[140:143]
  ds_read_b64_tr_b16 v[224:225], v6 offset:16384
  v_mfma_f32_16x16x32_bf16 v[140:143], v[108:111], v[52:55], v[140:143]
  ds_read_b64_tr_b16 v[226:227], v6 offset:18432
  v_mfma_f32_16x16x32_bf16 v[132:135], v[108:111], v[48:51], v[132:135]
  ds_read_b64_tr_b16 v[228:229], v6 offset:20480
  v_mfma_f32_16x16x32_bf16 v[132:135], v[104:107], v[32:35], v[132:135]
  ds_read_b64_tr_b16 v[230:231], v6 offset:22528
  s_nop 0
  s_waitcnt lgkmcnt(8)
  v_mfma_f32_16x16x32_bf16 v[160:163], v[112:115], v[32:35], v[160:163]
  ds_read_b64_tr_b16 v[232:233], v7 offset:16384
  v_mfma_f32_16x16x32_bf16 v[160:163], v[116:119], v[48:51], v[160:163]
  ds_read_b64_tr_b16 v[234:235], v7 offset:18432
  v_mfma_f32_16x16x32_bf16 v[168:171], v[116:119], v[52:55], v[168:171]
  ds_read_b64_tr_b16 v[236:237], v7 offset:20480
  v_mfma_f32_16x16x32_bf16 v[168:171], v[112:115], v[36:39], v[168:171]
  ds_read_b64_tr_b16 v[238:239], v7 offset:22528
  v_mfma_f32_16x16x32_bf16 v[176:179], v[112:115], v[40:43], v[176:179]
  v_add_u32_e64 v6, s23, v6
  v_mfma_f32_16x16x32_bf16 v[176:179], v[116:119], v[56:59], v[176:179]
  v_add_u32_e64 v7, s23, v7
  v_mfma_f32_16x16x32_bf16 v[184:187], v[116:119], v[60:63], v[184:187]
  v_mfma_f32_16x16x32_bf16 v[184:187], v[112:115], v[44:47], v[184:187]
  s_cbranch_vccnz Lo_8
  s_waitcnt lgkmcnt(0)
  s_nop 0
  s_barrier
Lo_7:
  v_mfma_f32_16x16x32_bf16 v[188:191], v[120:123], v[44:47], v[188:191]
  ds_read_b128 v[64:67], v4 offset:0
  v_mfma_f32_16x16x32_bf16 v[188:191], v[124:127], v[60:63], v[188:191]
  ds_read_b128 v[80:83], v5 offset:0
  v_mfma_f32_16x16x32_bf16 v[180:183], v[124:127], v[56:59], v[180:183]
  v_mfma_f32_16x16x32_bf16 v[180:183], v[120:123], v[40:43], v[180:183]
  ds_read_b128 v[68:71], v4 offset:2048
  v_mfma_f32_16x16x32_bf16 v[172:175], v[120:123], v[36:39], v[172:175]
  ds_read_b128 v[84:87], v5 offset:2048
  v_mfma_f32_16x16x32_bf16 v[172:175], v[124:127], v[52:55], v[172:175]
  v_mfma_f32_16x16x32_bf16 v[164:167], v[124:127], v[48:51], v[164:167]
  ds_read_b128 v[72:75], v4 offset:4096
  v_mfma_f32_16x16x32_bf16 v[164:167], v[120:123], v[32:35], v[164:167]
  ds_read_b128 v[88:91], v5 offset:4096
  v_mfma_f32_16x16x32_bf16 v[192:195], v[32:35], v[224:227], v[192:195]
  ds_read_b64_tr_b16 v[96:97], v6 offset:0
  v_mfma_f32_16x16x32_bf16 v[192:195], v[48:51], v[228:231], v[192:195]
  ds_read_b64_tr_b16 v[98:99], v6 offset:2048
  v_mfma_f32_16x16x32_bf16 v[200:203], v[52:55], v[228:231], v[200:203]
  ds_read_b64_tr_b16 v[100:101], v6 offset:4096
  v_mfma_f32_16x16x32_bf16 v[200:203], v[36:39], v[224:227], v[200:203]
  ds_read_b64_tr_b16 v[102:103], v6 offset:6144
  v_mfma_f32_16x16x32_bf16 v[208:211], v[40:43], v[224:227], v[208:211]
  ds_read_b128 v[76:79], v4 offset:6144
  v_mfma_f32_16x16x32_bf16 v[208:211], v[56:59], v[228:231], v[208:211]
  v_mfma_f32_16x16x32_bf16 v[216:219], v[60:63], v[228:231], v[216:219]
  ds_read_b128 v[92:95], v5 offset:6144
  v_mfma_f32_16x16x32_bf16 v[216:219], v[44:47], v[224:227], v[216:219]
  v_mfma_f32_16x16x32_bf16 v[220:223], v[44:47], v[232:235], v[220:223]
  ds_read_b64_tr_b16 v[104:105], v7 offset:0
  v_mfma_f32_16x16x32_bf16 v[220:223], v[60:63], v[236:239], v[220:223]
  v_mfma_f32_16x16x32_bf16 v[212:215], v[56:59], v[236:239], v[212:215]
  ds_read_b64_tr_b16 v[106:107], v7 offset:2048
  v_mfma_f32_16x16x32_bf16 v[212:215], v[40:43], v[232:235], v[212:215]
  v_mfma_f32_16x16x32_bf16 v[204:207], v[36:39], v[232:235], v[204:207]
  ds_read_b64_tr_b16 v[108:109], v7 offset:4096
  v_mfma_f32_16x16x32_bf16 v[204:207], v[52:55], v[236:239], v[204:207]
  v_mfma_f32_16x16x32_bf16 v[196:199], v[48:51], v[236:239], v[196:199]
  ds_read_b64_tr_b16 v[110:111], v7 offset:6144
  s_waitcnt lgkmcnt(6)
  v_mfma_f32_16x16x32_bf16 v[196:199], v[32:35], v[232:235], v[196:199]
  s_cbranch_vccnz Lo_6
Lk_3:
  v_mfma_f32_16x16x32_bf16 v[128:131], v[96:99], v[64:67], v[128:131]
  ds_read_b64_tr_b16 v[112:113], v6 offset:8192
  v_mfma_f32_16x16x32_bf16 v[128:131], v[100:103], v[80:83], v[128:131]
  ds_read_b64_tr_b16 v[114:115], v6 offset:10240
  v_mfma_f32_16x16x32_bf16 v[136:139], v[100:103], v[84:87], v[136:139]
  ds_read_b64_tr_b16 v[116:117], v6 offset:12288
  v_mfma_f32_16x16x32_bf16 v[136:139], v[96:99], v[68:71], v[136:139]
  ds_read_b64_tr_b16 v[118:119], v6 offset:14336
  v_mfma_f32_16x16x32_bf16 v[144:147], v[96:99], v[72:75], v[144:147]
  s_add_u32 s16, s16, s17
  s_cmp_eq_u32 s16, 65536
  s_cselect_b32 s23, s18, s17
  s_cselect_b32 s16, Lz1-Lz0+0, s16
  v_mfma_f32_16x16x32_bf16 v[144:147], v[100:103], v[88:91], v[144:147]
  v_add_u32_e64 v4, s23, v4
  v_add_u32 v5, s23, v5
  s_add_u32 s19, s19, s20
  s_cmp_eq_u32 s19, 73728
  s_waitcnt lgkmcnt(8)
  v_mfma_f32_16x16x32_bf16 v[152:155], v[100:103], v[92:95], v[152:155]
  s_cselect_b32 s23, s21, s20
  s_cselect_b32 s19, 0, s19
  v_mfma_f32_16x16x32_bf16 v[152:155], v[96:99], v[76:79], v[152:155]
  s_waitcnt lgkmcnt(4)
  v_mfma_f32_16x16x32_bf16 v[156:159], v[104:107], v[76:79], v[156:159]
  ds_read_b64_tr_b16 v[120:121], v7 offset:8192
  v_mfma_f32_16x16x32_bf16 v[156:159], v[108:111], v[92:95], v[156:159]
  ds_read_b64_tr_b16 v[122:123], v7 offset:10240
  v_mfma_f32_16x16x32_bf16 v[148:151], v[108:111], v[88:91], v[148:151]
  ds_read_b64_tr_b16 v[124:125], v7 offset:12288
  v_mfma_f32_16x16x32_bf16 v[148:151], v[104:107], v[72:75], v[148:151]
  ds_read_b64_tr_b16 v[126:127], v7 offset:14336
  v_mfma_f32_16x16x32_bf16 v[140:143], v[104:107], v[68:71], v[140:143]
  ds_read_b64_tr_b16 v[224:225], v6 offset:16384
  v_mfma_f32_16x16x32_bf16 v[140:143], v[108:111], v[84:87], v[140:143]
  ds_read_b64_tr_b16 v[226:227], v6 offset:18432
  v_mfma_f32_16x16x32_bf16 v[132:135], v[108:111], v[80:83], v[132:135]
  ds_read_b64_tr_b16 v[228:229], v6 offset:20480
  v_mfma_f32_16x16x32_bf16 v[132:135], v[104:107], v[64:67], v[132:135]
  ds_read_b64_tr_b16 v[230:231], v6 offset:22528
  s_nop 0
  s_waitcnt lgkmcnt(8)
  v_mfma_f32_16x16x32_bf16 v[160:163], v[112:115], v[64:67], v[160:163]
  ds_read_b64_tr_b16 v[232:233], v7 offset:16384
  v_mfma_f32_16x16x32_bf16 v[160:163], v[116:119], v[80:83], v[160:163]
  ds_read_b64_tr_b16 v[234:235], v7 offset:18432
  v_mfma_f32_16x16x32_bf16 v[168:171], v[116:119], v[84:87], v[168:171]
  ds_read_b64_tr_b16 v[236:237], v7 offset:20480
  v_mfma_f32_16x16x32_bf16 v[168:171], v[112:115], v[68:71], v[168:171]
  ds_read_b64_tr_b16 v[238:239], v7 offset:22528
  v_mfma_f32_16x16x32_bf16 v[176:179], v[112:115], v[72:75], v[176:179]
  v_add_u32_e64 v6, s23, v6
  v_mfma_f32_16x16x32_bf16 v[176:179], v[116:119], v[88:91], v[176:179]
  v_add_u32_e64 v7, s23, v7
  v_mfma_f32_16x16x32_bf16 v[184:187], v[116:119], v[92:95], v[184:187]
  s_sub_u32 s22, s22, 1
  s_cmp_lg_u32 s22, 0
  v_mfma_f32_16x16x32_bf16 v[184:187], v[112:115], v[76:79], v[184:187]
  s_waitcnt lgkmcnt(0)
  s_barrier
  v_mfma_f32_16x16x32_bf16 v[188:191], v[120:123], v[76:79], v[188:191]
  s_nop 0
  s_cbranch_scc0 Lk_4
  ds_read_b128 v[32:35], v4 offset:0
  v_mfma_f32_16x16x32_bf16 v[188:191], v[124:127], v[92:95], v[188:191]
  ds_read_b128 v[48:51], v5 offset:0
  v_mfma_f32_16x16x32_bf16 v[180:183], v[124:127], v[88:91], v[180:183]
  v_mfma_f32_16x16x32_bf16 v[180:183], v[120:123], v[72:75], v[180:183]
  ds_read_b128 v[36:39], v4 offset:2048
  v_mfma_f32_16x16x32_bf16 v[172:175], v[120:123], v[68:71], v[172:175]
  ds_read_b128 v[52:55], v5 offset:2048
  v_mfma_f32_16x16x32_bf16 v[172:175], v[124:127], v[84:87], v[172:175]
  v_mfma_f32_16x16x32_bf16 v[164:167], v[124:127], v[80:83], v[164:167]
  ds_read_b128 v[40:43], v4 offset:4096
  v_mfma_f32_16x16x32_bf16 v[164:167], v[120:123], v[64:67], v[164:167]
  ds_read_b128 v[56:59], v5 offset:4096
  v_mfma_f32_16x16x32_bf16 v[192:195], v[64:67], v[224:227], v[192:195]
  ds_read_b64_tr_b16 v[96:97], v6 offset:0
  v_mfma_f32_16x16x32_bf16 v[192:195], v[80:83], v[228:231], v[192:195]
  ds_read_b64_tr_b16 v[98:99], v6 offset:2048
  v_mfma_f32_16x16x32_bf16 v[200:203], v[84:87], v[228:231], v[200:203]
  ds_read_b64_tr_b16 v[100:101], v6 offset:4096
  v_mfma_f32_16x16x32_bf16 v[200:203], v[68:71], v[224:227], v[200:203]
  ds_read_b64_tr_b16 v[102:103], v6 offset:6144
  v_mfma_f32_16x16x32_bf16 v[208:211], v[72:75], v[224:227], v[208:211]
  ds_read_b128 v[44:47], v4 offset:6144
  v_mfma_f32_16x16x32_bf16 v[208:211], v[88:91], v[228:231], v[208:211]
  v_mfma_f32_16x16x32_bf16 v[216:219], v[92:95], v[228:231], v[216:219]
  ds_read_b128 v[60:63], v5 offset:6144
  v_mfma_f32_16x16x32_bf16 v[216:219], v[76:79], v[224:227], v[216:219]
  v_mfma_f32_16x16x32_bf16 v[220:223], v[76:79], v[232:235], v[220:223]
  ds_read_b64_tr_b16 v[104:105], v7 offset:0
  v_mfma_f32_16x16x32_bf16 v[220:223], v[92:95], v[236:239], v[220:223]
  v_mfma_f32_16x16x32_bf16 v[212:215], v[88:91], v[236:239], v[212:215]
  ds_read_b64_tr_b16 v[106:107], v7 offset:2048
  v_mfma_f32_16x16x32_bf16 v[212:215], v[72:75], v[232:235], v[212:215]
  v_mfma_f32_16x16x32_bf16 v[204:207], v[68:71], v[232:235], v[204:207]
  ds_read_b64_tr_b16 v[108:109], v7 offset:4096
  v_mfma_f32_16x16x32_bf16 v[204:207], v[84:87], v[236:239], v[204:207]
  v_mfma_f32_16x16x32_bf16 v[196:199], v[80:83], v[236:239], v[196:199]
  ds_read_b64_tr_b16 v[110:111], v7 offset:6144
  s_waitcnt lgkmcnt(6)
  v_mfma_f32_16x16x32_bf16 v[196:199], v[64:67], v[232:235], v[196:199]
  s_branch Lk_2
Lk_4:
  ds_read2_b32 v[4:5], v3 offset0:48 offset1:208
  ds_read_b128 v[106:109], v8 offset:256
  v_mfma_f32_16x16x32_bf16 v[188:191], v[124:127], v[92:95], v[188:191]
  ds_read_b128 v[110:113], v8 offset:320
  ds_read_b128 v[32:35], v10 offset:192
  v_mfma_f32_16x16x32_bf16 v[216:219], v[92:95], v[228:231], v[216:219]
  ds_read_b128 v[36:39], v10 offset:832
  ds_read2_b32 v[114:115], v2 offset0:128 offset1:144
  v_mfma_f32_16x16x32_bf16 v[216:219], v[76:79], v[224:227], v[216:219]
  ds_read_b128 v[98:101], v8 offset:0
  ds_read_b128 v[102:105], v8 offset:64
  v_mfma_f32_16x16x32_bf16 v[220:223], v[76:79], v[232:235], v[220:223]
  ds_read2_b32 v[6:7], v3 offset0:32 offset1:192
  ds_read2_b32 v[96:97], v3 offset0:16 offset1:176
  v_mfma_f32_16x16x32_bf16 v[220:223], v[92:95], v[236:239], v[220:223]
  v_mfma_f32_16x16x32_bf16 v[180:183], v[124:127], v[88:91], v[180:183]
  v_mfma_f32_16x16x32_bf16 v[180:183], v[120:123], v[72:75], v[180:183]
  v_mfma_f32_16x16x32_bf16 v[172:175], v[120:123], v[68:71], v[172:175]
  s_nop 0
  s_waitcnt lgkmcnt(4)
  v_fma_f32 v184, -v106, v5, v184
  v_fma_f32 v185, -v107, v5, v185
  v_fma_f32 v186, -v108, v5, v186
  v_mfma_f32_16x16x32_bf16 v[172:175], v[124:127], v[84:87], v[172:175]
  v_fma_f32 v187, -v109, v5, v187
  v_mul_f32 v184, v184, v4
  v_mul_f32 v185, v185, v4
  v_mfma_f32_16x16x32_bf16 v[164:167], v[124:127], v[80:83], v[164:167]
  v_mul_f32 v186, v186, v4
  v_mul_f32 v187, v187, v4
  v_cvt_pk_bf16_f32 v60, v184, v185
  v_mfma_f32_16x16x32_bf16 v[164:167], v[120:123], v[64:67], v[164:167]
  v_cvt_pk_bf16_f32 v61, v186, v187
  v_fma_f32 v188, -v110, v5, v188
  v_fma_f32 v189, -v111, v5, v189
  v_mfma_f32_16x16x32_bf16 v[192:195], v[64:67], v[224:227], v[192:195]
  ds_read2_b32 v[124:125], v3 offset0:0 offset1:160
  v_fma_f32 v190, -v112, v5, v190
  v_fma_f32 v191, -v113, v5, v191
  v_mul_f32_e64 v188, v188, v4
  v_mfma_f32_16x16x32_bf16 v[192:195], v[80:83], v[228:231], v[192:195]
  v_mov_b32 v120, 0x3f803f80
  v_mul_f32 v189, v189, v4
  v_mul_f32 v190, v190, v4
  v_mul_f32_e64 v191, v191, v4
  v_mfma_f32_16x16x32_bf16 v[196:199], v[80:83], v[236:239], v[196:199]
  v_mov_b32 v121, 0x3f803f80
  v_cvt_pk_bf16_f32 v62, v188, v189
  v_cvt_pk_bf16_f32 v63, v190, v191
  v_mfma_f32_16x16x32_bf16 v[196:199], v[64:67], v[232:235], v[196:199]
  v_mov_b32 v122, 0x3f803f80
  s_mov_b32 exec_lo, s12
  s_mov_b32 exec_hi, s12
  buffer_store_dwordx4 v[60:63], v9, s[40:43], s9 offen sc0 sc1
  s_nop 0
  s_mov_b64 exec, -1
  v_fma_f32 v216, -v36, v114, v216
  v_fma_f32 v217, -v37, v114, v217
  v_fma_f32 v218, -v38, v114, v218
  v_mfma_f32_16x16x32_bf16 v[204:207], v[68:71], v[232:235], v[204:207]
  v_mov_b32 v123, 0x3f803f80
  v_fma_f32 v219, -v39, v114, v219
  v_mul_f32 v216, v216, v32
  v_mul_f32 v217, v217, v33
  v_mfma_f32_16x16x32_bf16 v[204:207], v[84:87], v[236:239], v[204:207]
  v_mul_f32 v218, v218, v34
  v_mul_f32 v219, v219, v35
  v_cvt_pk_bf16_f32 v76, v216, v217
  v_mfma_f32_16x16x32_bf16 v[200:203], v[84:87], v[228:231], v[200:203]
  v_cvt_pk_bf16_f32 v77, v218, v219
  v_fma_f32 v220, -v36, v115, v220
  v_fma_f32 v221, -v37, v115, v221
  v_mfma_f32_16x16x32_bf16 v[200:203], v[68:71], v[224:227], v[200:203]
  v_fma_f32 v222, -v38, v115, v222
  v_fma_f32 v223, -v39, v115, v223
  v_mul_f32_e64 v220, v220, v32
  v_mfma_f32_16x16x32_bf16 v[208:211], v[72:75], v[224:227], v[208:211]
  v_mul_f32 v221, v221, v33
  v_mul_f32 v222, v222, v34
  v_mul_f32_e64 v223, v223, v35
  v_mfma_f32_16x16x32_bf16 v[208:211], v[88:91], v[228:231], v[208:211]
  v_cvt_pk_bf16_f32 v78, v220, v221
  v_cvt_pk_bf16_f32 v79, v222, v223
  v_mfma_f32_16x16x32_bf16 v[212:215], v[88:91], v[236:239], v[212:215]
  s_mov_b32 exec_lo, 0
  buffer_store_dwordx4 v[76:79], v11, s[40:43], s9 offen sc0 sc1
  s_mov_b64 exec, -1
  v_mfma_f32_16x16x32_bf16 v[212:215], v[72:75], v[232:235], v[212:215]
  v_mov_b64_e64 v[86:87], v[78:79]
  s_cmp_lg_u32 s82, 0
  s_cbranch_scc1 L_9
  ds_read_b128 v[240:243], v255 offset:16384
  ds_read_b128 v[244:247], v255 offset:18432
  ds_read_b128 v[248:251], v255 offset:20480
  ds_read_b128 v[252:255], v255 offset:22528
L_9:
  v_mov_b64 v[64:65], 0
  v_mov_b64 v[66:67], 0
  v_mov_b64_e64 v[232:233], 0
  v_mov_b64 v[234:235], 0
  s_waitcnt lgkmcnt(0)
  v_pk_fma_f32 v[128:129], v[98:99], v[124:125], v[128:129] op_sel:[0,1,0] op_sel_hi:[1,1,1] neg_lo:[1,0,0] neg_hi:[1,0,0]
  v_pk_fma_f32 v[130:131], v[100:101], v[124:125], v[130:131] op_sel:[0,1,0] op_sel_hi:[1,1,1] neg_lo:[1,0,0] neg_hi:[1,0,0]
  v_pk_fma_f32 v[132:133], v[102:103], v[124:125], v[132:133] op_sel:[0,1,0] op_sel_hi:[1,1,1] neg_lo:[1,0,0] neg_hi:[1,0,0]
  v_pk_fma_f32 v[134:135], v[104:105], v[124:125], v[134:135] op_sel:[0,1,0] op_sel_hi:[1,1,1] neg_lo:[1,0,0] neg_hi:[1,0,0]
  v_cvt_pk_bf16_f32 v32, v128, v129
  v_cvt_pk_bf16_f32 v33, v130, v131
  v_cvt_pk_bf16_f32 v34, v132, v133
  v_cvt_pk_bf16_f32 v35, v134, v135
  v_pk_fma_f32 v[136:137], v[98:99], v[96:97], v[136:137] op_sel:[0,1,0] op_sel_hi:[1,1,1] neg_lo:[1,0,0] neg_hi:[1,0,0]
  v_pk_fma_f32 v[138:139], v[100:101], v[96:97], v[138:139] op_sel:[0,1,0] op_sel_hi:[1,1,1] neg_lo:[1,0,0] neg_hi:[1,0,0]
  v_pk_fma_f32 v[140:141], v[102:103], v[96:97], v[140:141] op_sel:[0,1,0] op_sel_hi:[1,1,1] neg_lo:[1,0,0] neg_hi:[1,0,0]
  v_pk_fma_f32 v[142:143], v[104:105], v[96:97], v[142:143] op_sel:[0,1,0] op_sel_hi:[1,1,1] neg_lo:[1,0,0] neg_hi:[1,0,0]
  v_cvt_pk_bf16_f32 v36, v136, v137
  v_cvt_pk_bf16_f32 v37, v138, v139
  v_cvt_pk_bf16_f32 v38, v140, v141
  v_cvt_pk_bf16_f32 v39, v142, v143
  v_pk_fma_f32 v[144:145], v[98:99], v[6:7], v[144:145] op_sel:[0,1,0] op_sel_hi:[1,1,1] neg_lo:[1,0,0] neg_hi:[1,0,0]
  v_pk_fma_f32 v[146:147], v[100:101], v[6:7], v[146:147] op_sel:[0,1,0] op_sel_hi:[1,1,1] neg_lo:[1,0,0] neg_hi:[1,0,0]
  v_pk_fma_f32 v[148:149], v[102:103], v[6:7], v[148:149] op_sel:[0,1,0] op_sel_hi:[1,1,1] neg_lo:[1,0,0] neg_hi:[1,0,0]
  v_pk_fma_f32 v[150:151], v[104:105], v[6:7], v[150:151] op_sel:[0,1,0] op_sel_hi:[1,1,1] neg_lo:[1,0,0] neg_hi:[1,0,0]
  v_cvt_pk_bf16_f32 v40, v144, v145
  v_cvt_pk_bf16_f32 v41, v146, v147
  v_cvt_pk_bf16_f32 v42, v148, v149
  v_cvt_pk_bf16_f32 v43, v150, v151
  v_pk_fma_f32 v[152:153], v[98:99], v[4:5], v[152:153] op_sel:[0,1,0] op_sel_hi:[1,1,1] neg_lo:[1,0,0] neg_hi:[1,0,0]
  v_pk_fma_f32 v[154:155], v[100:101], v[4:5], v[154:155] op_sel:[0,1,0] op_sel_hi:[1,1,1] neg_lo:[1,0,0] neg_hi:[1,0,0]
  v_pk_fma_f32 v[156:157], v[102:103], v[4:5], v[156:157] op_sel:[0,1,0] op_sel_hi:[1,1,1] neg_lo:[1,0,0] neg_hi:[1,0,0]
  v_pk_fma_f32 v[158:159], v[104:105], v[4:5], v[158:159] op_sel:[0,1,0] op_sel_hi:[1,1,1] neg_lo:[1,0,0] neg_hi:[1,0,0]
  v_cvt_pk_bf16_f32 v44, v152, v153
  v_cvt_pk_bf16_f32 v45, v154, v155
  v_cvt_pk_bf16_f32 v46, v156, v157
  v_cvt_pk_bf16_f32 v47, v158, v159
  ds_read_b128 v[128:131], v10 offset:0
  ds_read_b128 v[132:135], v10 offset:640
  ds_read_b128 v[136:139], v10 offset:64
  ds_read_b128 v[140:143], v10 offset:704
  ds_read_b128 v[144:147], v10 offset:128
  ds_read_b128 v[148:151], v10 offset:768
  v_pk_fma_f32 v[160:161], v[106:107], v[124:125], v[160:161] op_sel:[0,1,0] op_sel_hi:[1,1,1] neg_lo:[1,0,0] neg_hi:[1,0,0]
  v_pk_fma_f32 v[162:163], v[108:109], v[124:125], v[162:163] op_sel:[0,1,0] op_sel_hi:[1,1,1] neg_lo:[1,0,0] neg_hi:[1,0,0]
  v_pk_fma_f32 v[164:165], v[110:111], v[124:125], v[164:165] op_sel:[0,1,0] op_sel_hi:[1,1,1] neg_lo:[1,0,0] neg_hi:[1,0,0]
  v_pk_fma_f32 v[166:167], v[112:113], v[124:125], v[166:167] op_sel:[0,1,0] op_sel_hi:[1,1,1] neg_lo:[1,0,0] neg_hi:[1,0,0]
  v_pk_mul_f32 v[160:161], v[160:161], v[124:125] op_sel_hi:[1,0]
  v_pk_mul_f32 v[162:163], v[162:163], v[124:125] op_sel_hi:[1,0]
  v_pk_mul_f32 v[164:165], v[164:165], v[124:125] op_sel_hi:[1,0]
  v_pk_mul_f32 v[166:167], v[166:167], v[124:125] op_sel_hi:[1,0]
  v_cvt_pk_bf16_f32 v48, v160, v161
  v_cvt_pk_bf16_f32 v49, v162, v163
  v_cvt_pk_bf16_f32 v50, v164, v165
  v_cvt_pk_bf16_f32 v51, v166, v167
  v_pk_fma_f32 v[168:169], v[106:107], v[96:97], v[168:169] op_sel:[0,1,0] op_sel_hi:[1,1,1] neg_lo:[1,0,0] neg_hi:[1,0,0]
  v_pk_fma_f32 v[170:171], v[108:109], v[96:97], v[170:171] op_sel:[0,1,0] op_sel_hi:[1,1,1] neg_lo:[1,0,0] neg_hi:[1,0,0]
  v_pk_fma_f32 v[172:173], v[110:111], v[96:97], v[172:173] op_sel:[0,1,0] op_sel_hi:[1,1,1] neg_lo:[1,0,0] neg_hi:[1,0,0]
  v_pk_fma_f32 v[174:175], v[112:113], v[96:97], v[174:175] op_sel:[0,1,0] op_sel_hi:[1,1,1] neg_lo:[1,0,0] neg_hi:[1,0,0]
  v_pk_mul_f32 v[168:169], v[168:169], v[96:97] op_sel_hi:[1,0]
  v_pk_mul_f32 v[170:171], v[170:171], v[96:97] op_sel_hi:[1,0]
  v_pk_mul_f32 v[172:173], v[172:173], v[96:97] op_sel_hi:[1,0]
  v_pk_mul_f32 v[174:175], v[174:175], v[96:97] op_sel_hi:[1,0]
  v_cvt_pk_bf16_f32 v52, v168, v169
  v_cvt_pk_bf16_f32 v53, v170, v171
  v_cvt_pk_bf16_f32 v54, v172, v173
  v_cvt_pk_bf16_f32 v55, v174, v175
  v_pk_fma_f32 v[176:177], v[106:107], v[6:7], v[176:177] op_sel:[0,1,0] op_sel_hi:[1,1,1] neg_lo:[1,0,0] neg_hi:[1,0,0]
  v_pk_fma_f32 v[178:179], v[108:109], v[6:7], v[178:179] op_sel:[0,1,0] op_sel_hi:[1,1,1] neg_lo:[1,0,0] neg_hi:[1,0,0]
  v_pk_fma_f32 v[180:181], v[110:111], v[6:7], v[180:181] op_sel:[0,1,0] op_sel_hi:[1,1,1] neg_lo:[1,0,0] neg_hi:[1,0,0]
  v_pk_fma_f32 v[182:183], v[112:113], v[6:7], v[182:183] op_sel:[0,1,0] op_sel_hi:[1,1,1] neg_lo:[1,0,0] neg_hi:[1,0,0]
  v_pk_mul_f32 v[176:177], v[176:177], v[6:7] op_sel_hi:[1,0]
  v_pk_mul_f32 v[178:179], v[178:179], v[6:7] op_sel_hi:[1,0]
  v_pk_mul_f32 v[180:181], v[180:181], v[6:7] op_sel_hi:[1,0]
  v_pk_mul_f32 v[182:183], v[182:183], v[6:7] op_sel_hi:[1,0]
  v_cvt_pk_bf16_f32 v56, v176, v177
  v_cvt_pk_bf16_f32 v57, v178, v179
  v_cvt_pk_bf16_f32 v58, v180, v181
  v_cvt_pk_bf16_f32 v59, v182, v183
  v_mfma_f32_16x16x32_bf16 v[164:167], v[48:51], v[32:35], v[12:15]
  v_mfma_f32_16x16x32_bf16 v[168:171], v[48:51], v[36:39], v[16:19]
  v_mfma_f32_16x16x32_bf16 v[172:175], v[52:55], v[36:39], v[12:15]
  v_mfma_f32_16x16x32_bf16 v[176:179], v[52:55], v[40:43], v[16:19]
  v_mfma_f32_16x16x32_bf16 v[180:183], v[56:59], v[40:43], v[12:15]
  v_mfma_f32_16x16x32_bf16 v[184:187], v[56:59], v[44:47], v[16:19]
  v_mfma_f32_16x16x32_bf16 v[188:191], v[60:63], v[44:47], v[12:15]
  s_nop 0
  s_waitcnt lgkmcnt(0)
  v_pk_fma_f32 v[192:193], v[132:133], v[114:115], v[192:193] op_sel:[0,0,0] op_sel_hi:[1,0,1] neg_lo:[1,0,0] neg_hi:[1,0,0]
  v_pk_fma_f32 v[194:195], v[134:135], v[114:115], v[194:195] op_sel:[0,0,0] op_sel_hi:[1,0,1] neg_lo:[1,0,0] neg_hi:[1,0,0]
  v_pk_fma_f32 v[196:197], v[132:133], v[114:115], v[196:197] op_sel:[0,1,0] op_sel_hi:[1,1,1] neg_lo:[1,0,0] neg_hi:[1,0,0]
  v_pk_fma_f32 v[198:199], v[134:135], v[114:115], v[198:199] op_sel:[0,1,0] op_sel_hi:[1,1,1] neg_lo:[1,0,0] neg_hi:[1,0,0]
  v_pk_mul_f32 v[192:193], v[192:193], v[128:129]
  v_pk_mul_f32 v[194:195], v[194:195], v[130:131]
  v_pk_mul_f32 v[196:197], v[196:197], v[128:129]
  v_pk_mul_f32 v[198:199], v[198:199], v[130:131]
  v_cvt_pk_bf16_f32 v70, v192, v193
  v_cvt_pk_bf16_f32 v71, v194, v195
  v_cvt_pk_bf16_f32 v80, v196, v197
  v_cvt_pk_bf16_f32 v81, v198, v199
  v_pk_fma_f32 v[200:201], v[140:141], v[114:115], v[200:201] op_sel:[0,0,0] op_sel_hi:[1,0,1] neg_lo:[1,0,0] neg_hi:[1,0,0]
  v_pk_fma_f32 v[202:203], v[142:143], v[114:115], v[202:203] op_sel:[0,0,0] op_sel_hi:[1,0,1] neg_lo:[1,0,0] neg_hi:[1,0,0]
  v_pk_fma_f32 v[204:205], v[140:141], v[114:115], v[204:205] op_sel:[0,1,0] op_sel_hi:[1,1,1] neg_lo:[1,0,0] neg_hi:[1,0,0]
  v_pk_fma_f32 v[206:207], v[142:143], v[114:115], v[206:207] op_sel:[0,1,0] op_sel_hi:[1,1,1] neg_lo:[1,0,0] neg_hi:[1,0,0]
  v_pk_mul_f32 v[200:201], v[200:201], v[136:137]
  v_pk_mul_f32 v[202:203], v[202:203], v[138:139]
  v_pk_mul_f32 v[204:205], v[204:205], v[136:137]
  v_pk_mul_f32 v[206:207], v[206:207], v[138:139]
  v_cvt_pk_bf16_f32 v72, v200, v201
  v_cvt_pk_bf16_f32 v73, v202, v203
  v_cvt_pk_bf16_f32 v82, v204, v205
  v_cvt_pk_bf16_f32 v83, v206, v207
  v_pk_fma_f32 v[208:209], v[148:149], v[114:115], v[208:209] op_sel:[0,0,0] op_sel_hi:[1,0,1] neg_lo:[1,0,0] neg_hi:[1,0,0]
  v_pk_fma_f32 v[210:211], v[150:151], v[114:115], v[210:211] op_sel:[0,0,0] op_sel_hi:[1,0,1] neg_lo:[1,0,0] neg_hi:[1,0,0]
  v_pk_fma_f32 v[212:213], v[148:149], v[114:115], v[212:213] op_sel:[0,1,0] op_sel_hi:[1,1,1] neg_lo:[1,0,0] neg_hi:[1,0,0]
  v_pk_fma_f32 v[214:215], v[150:151], v[114:115], v[214:215] op_sel:[0,1,0] op_sel_hi:[1,1,1] neg_lo:[1,0,0] neg_hi:[1,0,0]
  v_pk_mul_f32 v[208:209], v[208:209], v[144:145]
  v_pk_mul_f32 v[210:211], v[210:211], v[146:147]
  v_pk_mul_f32 v[212:213], v[212:213], v[144:145]
  v_pk_mul_f32 v[214:215], v[214:215], v[146:147]
  v_cvt_pk_bf16_f32 v74, v208, v209
  v_cvt_pk_bf16_f32 v75, v210, v211
  v_cvt_pk_bf16_f32 v84, v212, v213
  v_cvt_pk_bf16_f32 v85, v214, v215
  v_max_f32 v172, v172, v168
  v_max_f32 v173, v173, v169
  v_max_f32 v174, v174, v170
  v_max_f32 v175, v175, v171
  v_max_f32 v180, v180, v176
  v_max_f32 v181, v181, v177
  v_max_f32 v182, v182, v178
  v_max_f32 v183, v183, v179
  v_max_f32 v188, v188, v184
  v_max_f32 v189, v189, v185
  v_max_f32 v190, v190, v186
  v_max_f32 v191, v191, v187
  v_max3_f32 v90, v172, v173, v174
  v_max3_f32 v92, v180, v181, v182
  v_max3_f32 v94, v188, v189, v190
  v_max_f32 v90, v90, v175
  v_max_f32 v92, v92, v183
  v_max_f32 v94, v94, v191
  v_mov_b32 v99, v90
  v_mov_b32 v100, v92
  v_mov_b32 v101, v94
  v_permlane32_swap_b32 v90, v99
  v_permlane32_swap_b32 v92, v100
  v_permlane32_swap_b32 v94, v101
  v_max_f32 v90, v90, v99
  v_max_f32 v92, v92, v100
  v_max_f32 v94, v94, v101
  v_mov_b32 v99, v90
  v_mov_b32 v100, v92
  v_mov_b32 v101, v94
  v_permlane16_swap_b32 v90, v99
  v_permlane16_swap_b32 v92, v100
  v_permlane16_swap_b32 v94, v101
  v_max_f32 v90, v90, v99
  v_max_f32 v92, v92, v100
  v_max_f32_e64 v94, v94, v101
  s_mov_b32 s4, 0x3e8293ee
  v_mul_f32 v91, s4, v96
  v_mul_f32 v90, v91, v90
  v_mul_f32 v93, s4, v6
  v_mul_f32 v92, v93, v92
  v_mul_f32 v95, s4, v4
  v_mul_f32 v94, v95, v94
  v_pk_fma_f32 v[172:173], v[172:173], v[90:91], v[90:91] op_sel:[0,1,0] op_sel_hi:[1,1,0] neg_lo:[0,0,1] neg_hi:[0,0,1]
  v_pk_fma_f32 v[174:175], v[174:175], v[90:91], v[90:91] op_sel:[0,1,0] op_sel_hi:[1,1,0] neg_lo:[0,0,1] neg_hi:[0,0,1]
  v_pk_fma_f32 v[180:181], v[180:181], v[92:93], v[92:93] op_sel:[0,1,0] op_sel_hi:[1,1,0] neg_lo:[0,0,1] neg_hi:[0,0,1]
  v_pk_fma_f32 v[182:183], v[182:183], v[92:93], v[92:93] op_sel:[0,1,0] op_sel_hi:[1,1,0] neg_lo:[0,0,1] neg_hi:[0,0,1]
  v_pk_fma_f32 v[188:189], v[188:189], v[94:95], v[94:95] op_sel:[0,1,0] op_sel_hi:[1,1,0] neg_lo:[0,0,1] neg_hi:[0,0,1]
  v_pk_fma_f32 v[190:191], v[190:191], v[94:95], v[94:95] op_sel:[0,1,0] op_sel_hi:[1,1,0] neg_lo:[0,0,1] neg_hi:[0,0,1]
  s_lshl_b32 s6, s84, Lz1-Lz0+3
  s_add_u32 s6, s6, 3145728
  s_add_u32 s7, s6, 4096
  s_mov_b32 exec_lo, s12
  s_mov_b32 exec_hi, s12
  buffer_load_dwordx4 v[64:67], v9, s[40:43], s11 offen sc0 sc1
  s_mov_b32 exec_lo, 0
  s_mov_b32 exec_hi, -1
  buffer_load_dwordx4 v[232:235], v11, s[40:43], s11 offen sc0 sc1
  s_mov_b64 exec, -1
  v_exp_f32 v172, v172
  v_exp_f32 v173, v173
  v_exp_f32 v174, v174
  v_exp_f32_e64 v175, v175
  v_cvt_pk_bf16_f32 v38, v172, v173
  v_cvt_pk_bf16_f32 v39, v174, v175
  v_and_b32 v36, v38, v20
  v_and_b32 v37, v39, v21
  v_xor_b32 v38, v38, v36
  v_xor_b32 v39, v39, v37
  v_exp_f32 v180, v180
  v_exp_f32 v181, v181
  v_exp_f32 v182, v182
  v_exp_f32 v183, v183
  v_cvt_pk_bf16_f32 v42, v180, v181
  v_cvt_pk_bf16_f32 v43, v182, v183
  v_and_b32 v40, v42, v20
  v_and_b32 v41, v43, v21
  v_xor_b32 v42, v42, v40
  v_xor_b32 v43, v43, v41
  v_mfma_f32_16x16x32_bf16 v[132:135], v[120:123], v[36:39], 0
  v_mfma_f32_16x16x32_bf16 v[200:203], v[70:73], v[36:39], 0
  v_mfma_f32_16x16x32_bf16 v[204:207], v[80:83], v[36:39], 0
  v_exp_f32 v188, v188
  v_exp_f32 v189, v189
  v_exp_f32 v190, v190
  v_exp_f32 v191, v191
  v_cvt_pk_bf16_f32 v46, v188, v189
  v_cvt_pk_bf16_f32 v47, v190, v191
  v_and_b32 v44, v46, v20
  v_and_b32 v45, v47, v21
  v_xor_b32 v46, v46, v44
  v_xor_b32 v47, v47, v45
  v_mfma_f32_16x16x32_bf16 v[136:139], v[120:123], v[40:43], 0
  v_mfma_f32_16x16x32_bf16 v[208:211], v[72:75], v[40:43], 0
  v_mfma_f32_16x16x32_bf16 v[212:215], v[82:85], v[40:43], 0
  v_mfma_f32_16x16x32_bf16 v[140:143], v[120:123], v[44:47], 0
  v_mfma_f32_16x16x32_bf16 v[216:219], v[74:77], v[44:47], 0
  v_mfma_f32_16x16x32_bf16 v[220:223], v[84:87], v[44:47], 0
  v_rcp_f32 v132, v132
  s_nop 0
  v_pk_mul_f32 v[200:201], v[200:201], v[132:133] op_sel_hi:[1,0]
  v_pk_mul_f32 v[202:203], v[202:203], v[132:133] op_sel_hi:[1,0]
  v_pk_mul_f32 v[204:205], v[204:205], v[132:133] op_sel_hi:[1,0]
  v_pk_mul_f32 v[206:207], v[206:207], v[132:133] op_sel_hi:[1,0]
  v_cvt_pk_bf16_f32 v52, v200, v201
  v_cvt_pk_bf16_f32 v53, v202, v203
  v_cvt_pk_bf16_f32 v54, v204, v205
  v_cvt_pk_bf16_f32 v55, v206, v207
  buffer_store_dwordx4 v[52:55], v0, s[40:43], s6 offen offset:2048 sc0 sc1
  ds_write_b128 v0, v[52:55] offset:2048
  v_rcp_f32 v136, v136
  s_nop 0
  v_pk_mul_f32 v[208:209], v[208:209], v[136:137] op_sel_hi:[1,0]
  v_pk_mul_f32 v[210:211], v[210:211], v[136:137] op_sel_hi:[1,0]
  v_pk_mul_f32 v[212:213], v[212:213], v[136:137] op_sel_hi:[1,0]
  v_pk_mul_f32 v[214:215], v[214:215], v[136:137] op_sel_hi:[1,0]
  v_cvt_pk_bf16_f32 v56, v208, v209
  v_cvt_pk_bf16_f32 v57, v210, v211
  v_cvt_pk_bf16_f32 v58, v212, v213
  v_cvt_pk_bf16_f32 v59, v214, v215
  buffer_store_dwordx4 v[56:59], v0, s[40:43], s7 offen offset:0 sc0 sc1
  ds_write_b128 v0, v[56:59] offset:4096
  v_rcp_f32 v140, v140
  s_nop 0
  v_pk_mul_f32 v[216:217], v[216:217], v[140:141] op_sel_hi:[1,0]
  v_pk_mul_f32 v[218:219], v[218:219], v[140:141] op_sel_hi:[1,0]
  v_pk_mul_f32 v[220:221], v[220:221], v[140:141] op_sel_hi:[1,0]
  v_pk_mul_f32 v[222:223], v[222:223], v[140:141] op_sel_hi:[1,0]
  v_cvt_pk_bf16_f32 v60, v216, v217
  v_cvt_pk_bf16_f32 v61, v218, v219
  v_cvt_pk_bf16_f32 v62, v220, v221
  v_cvt_pk_bf16_f32 v63, v222, v223
  buffer_store_dwordx4 v[60:63], v0, s[40:43], s7 offen offset:2048 sc0 sc1
  ds_write_b128 v0, v[60:63] offset:6144
  s_cmp_eq_u32 s76, Lz1-Lz0+0
  s_mov_b32 s89, 200000
  s_waitcnt vmcnt(3)
  s_cbranch_scc0 Lh_11
  v_mov_b64 v[64:65], 0
  v_mov_b64 v[66:67], 0
  v_mov_b64 v[232:233], 0
  v_mov_b64 v[234:235], 0
  s_branch Lh_12
  s_nop 0
Lh_10:
  s_mov_b32 exec_lo, s12
  s_mov_b32 exec_hi, s12
  buffer_load_dwordx4 v[64:67], v9, s[40:43], s11 offen sc0 sc1
  s_mov_b32 exec_lo, 0
  s_mov_b32 exec_hi, -1
  buffer_load_dwordx4 v[232:235], v11, s[40:43], s11 offen sc0 sc1
  s_mov_b64 exec, -1
  s_waitcnt vmcnt(0)
Lh_11:
  v_max3_u32 v2, v64, v65, v66
  v_max3_u32 v3, v232, v233, v234
  v_max3_u32 v2, v2, v67, v235
  v_max_u32_e64 v2, v2, v3
  v_cmp_eq_u32 vcc, -1, v2
  s_cbranch_vccz Lh_12
  s_sub_u32 s89, s89, 1
  s_cbranch_scc0 Lh_10
Lh_12:
  v_mfma_f32_16x16x32_bf16 v[160:163], v[64:67], v[32:35], v[16:19]
  v_mov_b64 v[68:69], v[232:233]
  v_mov_b64 v[78:79], v[234:235]
  v_mov_b64 v[236:237], -1
  v_mov_b64 v[238:239], -1
  buffer_store_dwordx4 v[236:239], v11, s[40:43], s11 offen sc0 sc1
  s_cmp_eq_u32 s76, 0
  s_cbranch_scc1 L_14
  s_nop 0
  v_max_f32 v164, v164, v160
  v_max_f32 v165, v165, v161
  v_max_f32 v166, v166, v162
  v_max_f32_e64 v167, v167, v163
L_14:
  v_max3_f32 v88, v164, v165, v166
  v_max_f32 v88, v88, v167
  v_mov_b32 v98, v88
  s_nop 1
  v_permlane32_swap_b32 v88, v98
  v_max_f32 v88, v88, v98
  v_mov_b32 v98, v88
  s_nop 1
  v_permlane16_swap_b32 v88, v98
  v_max_f32_e64 v88, v88, v98
  s_mov_b32 s4, 0x3e8293ee
  v_mul_f32 v89, s4, v124
  v_mul_f32 v88, v89, v88
  v_pk_fma_f32 v[164:165], v[164:165], v[88:89], v[88:89] op_sel:[0,1,0] op_sel_hi:[1,1,0] neg_lo:[0,0,1] neg_hi:[0,0,1]
  v_pk_fma_f32 v[166:167], v[166:167], v[88:89], v[88:89] op_sel:[0,1,0] op_sel_hi:[1,1,0] neg_lo:[0,0,1] neg_hi:[0,0,1]
  v_exp_f32 v164, v164
  v_exp_f32 v165, v165
  v_exp_f32 v166, v166
  v_exp_f32 v167, v167
  v_cvt_pk_bf16_f32 v34, v164, v165
  v_cvt_pk_bf16_f32 v35, v166, v167
  v_and_b32 v32, v34, v20
  v_and_b32 v33, v35, v21
  v_xor_b32_e64 v34, v34, v32
  v_xor_b32 v35, v35, v33
  s_nop 1
  v_mfma_f32_16x16x32_bf16 v[128:131], v[120:123], v[32:35], 0
  v_mfma_f32_16x16x32_bf16 v[192:195], v[68:71], v[32:35], 0
  v_mfma_f32_16x16x32_bf16 v[196:199], v[78:81], v[32:35], 0
  s_nop 5
  v_rcp_f32_e64 v128, v128
  s_nop 0
  v_pk_mul_f32 v[192:193], v[192:193], v[128:129] op_sel_hi:[1,0]
  v_pk_mul_f32 v[194:195], v[194:195], v[128:129] op_sel_hi:[1,0]
  v_pk_mul_f32 v[196:197], v[196:197], v[128:129] op_sel_hi:[1,0]
  v_pk_mul_f32 v[198:199], v[198:199], v[128:129] op_sel_hi:[1,0]
  v_cvt_pk_bf16_f32 v48, v192, v193
  v_cvt_pk_bf16_f32 v49, v194, v195
  v_cvt_pk_bf16_f32 v50, v196, v197
  v_cvt_pk_bf16_f32 v51, v198, v199
  buffer_store_dwordx4 v[48:51], v0, s[40:43], s6 offen offset:0 sc0 sc1
  ds_write_b128 v0, v[48:51] offset:0
  ds_read_b32 v3, v28 offset:8
  s_cmp_lg_u32 s82, 0
  s_cbranch_scc1 L_15
  v_permlane16_swap_b32 v240, v242
  v_permlane16_swap_b32 v241, v243
  v_permlane16_swap_b32 v244, v246
  v_permlane16_swap_b32 v245, v247
  v_permlane16_swap_b32 v248, v250
  v_permlane16_swap_b32 v249, v251
  v_permlane16_swap_b32 v252, v254
  v_permlane16_swap_b32 v253, v255
L_15:
  s_mov_b32 s16, Lz1-Lz0+0
  s_mov_b32 s17, 16384
  s_mov_b32 s18, 0xffff4000
  s_mov_b32 s19, 32768
  s_mov_b32 s20, 8192
  s_mov_b32 s21, 0xfffee000
  s_mul_i32 s4, s85, 8192
  v_add_u32_e64 v4, s4, v11
  v_add_u32 v5, 1024, v4
  s_add_u32 s5, s19, 0
  s_lshl_b32 s4, s86, 1
  v_xor_b32_e64 v2, s4, v26
  v_lshl_add_u32 v6, v2, 5, v25
  v_add_u32 v6, s5, v6
  s_add_u32 s4, s4, 1
  v_xor_b32_e64 v2, s4, v26
  v_lshl_add_u32 v7, v2, 5, v25
  v_add_u32 v7, s5, v7
  s_lshl_b32 s5, s82, 1
  s_add_u32 s5, s5, Lz1-Lz0+2
  s_mov_b32 s89, 1600000
  s_branch Lw_17
Lw_16:
  ds_read_b32 v3, v28 offset:8
Lw_17:
  s_waitcnt lgkmcnt(0)
  v_readfirstlane_b32 s4, v3
  s_cmp_ge_u32 s4, s5
  s_cbranch_scc1 Lw_18
  s_sleep 1
  s_sub_u32 s89, s89, 1
  s_cbranch_scc0 Lw_16
Lw_18:
  ds_read_b64_tr_b16 v[48:49], v6 offset:0
  ds_read_b64_tr_b16 v[50:51], v6 offset:2048
  ds_read_b64_tr_b16 v[52:53], v7 offset:0
  ds_read_b64_tr_b16 v[54:55], v7 offset:2048
  ds_read_b64_tr_b16 v[80:81], v6 offset:4096
  ds_read_b64_tr_b16 v[82:83], v6 offset:6144
  ds_read_b64_tr_b16 v[84:85], v7 offset:4096
  ds_read_b64_tr_b16 v[86:87], v7 offset:6144
  ds_read_b64_tr_b16 v[112:113], v6 offset:8192
  ds_read_b64_tr_b16 v[114:115], v6 offset:10240
  ds_read_b64_tr_b16 v[116:117], v7 offset:8192
  ds_read_b64_tr_b16 v[118:119], v7 offset:10240
  s_nop 0
  s_waitcnt lgkmcnt(8)
  ds_read_b64_tr_b16 v[208:209], v6 offset:12288
  ds_read_b64_tr_b16 v[210:211], v6 offset:14336
  ds_read_b64_tr_b16 v[212:213], v7 offset:12288
  ds_read_b64_tr_b16 v[214:215], v7 offset:14336
  s_nop 0
  s_waitcnt lgkmcnt(8)
  ds_read_b64_tr_b16 v[160:161], v6 offset:16384
  ds_read_b64_tr_b16 v[162:163], v6 offset:18432
  ds_read_b64_tr_b16 v[164:165], v7 offset:16384
  ds_read_b64_tr_b16 v[166:167], v7 offset:18432
  s_nop 0
  s_waitcnt lgkmcnt(8)
  ds_read_b64_tr_b16 v[168:169], v6 offset:20480
  ds_read_b64_tr_b16 v[170:171], v6 offset:22528
  ds_read_b64_tr_b16 v[172:173], v7 offset:20480
  ds_read_b64_tr_b16 v[174:175], v7 offset:22528
  s_waitcnt lgkmcnt(8)
  s_add_u32 s5, s87, 0x0
  s_waitcnt vmcnt(0)
  s_mov_b64 exec, 1
  ds_add_rtn_u32 v2, v28, v27 offset:0
  s_waitcnt lgkmcnt(0)
  v_readfirstlane_b32 s4, v2
  s_and_b32 s4, s4, Lz1-Lz0+3
  s_cmp_lg_u32 s4, 3
  s_cbranch_scc1 Ls_19
  s_mov_b32 exec_lo, 0xffff
  buffer_store_dword v27, v24, s[40:43], s5 offen sc0 sc1
Ls_19:
  s_nop 0
  s_mov_b64 exec, -1
  ds_read_b64_tr_b16 v[176:177], v6 offset:24576
  ds_read_b64_tr_b16 v[178:179], v6 offset:26624
  ds_read_b64_tr_b16 v[180:181], v7 offset:24576
  ds_read_b64_tr_b16 v[182:183], v7 offset:26624
  ds_read_b64_tr_b16 v[184:185], v6 offset:28672
  ds_read_b64_tr_b16 v[186:187], v6 offset:30720
  ds_read_b64_tr_b16 v[188:189], v7 offset:28672
  ds_read_b64_tr_b16 v[190:191], v7 offset:30720
  ds_read_b64_tr_b16 v[224:225], v6 offset:32768
  ds_read_b64_tr_b16 v[226:227], v6 offset:34816
  ds_read_b64_tr_b16 v[228:229], v7 offset:32768
  ds_read_b64_tr_b16 v[230:231], v7 offset:34816
  s_nop 0
  s_waitcnt lgkmcnt(8)
  ds_read_b64_tr_b16 v[232:233], v6 offset:36864
  ds_read_b64_tr_b16 v[234:235], v6 offset:38912
  ds_read_b64_tr_b16 v[236:237], v7 offset:36864
  ds_read_b64_tr_b16 v[238:239], v7 offset:38912
  s_nop 0
  s_waitcnt lgkmcnt(8)
  ds_read_b64_tr_b16 v[56:57], v6 offset:40960
  ds_read_b64_tr_b16 v[58:59], v6 offset:43008
  ds_read_b64_tr_b16 v[60:61], v7 offset:40960
  ds_read_b64_tr_b16 v[62:63], v7 offset:43008
  s_nop 0
  s_waitcnt lgkmcnt(8)
  ds_read_b64_tr_b16 v[88:89], v6 offset:45056
  ds_read_b64_tr_b16 v[90:91], v6 offset:47104
  ds_read_b64_tr_b16 v[92:93], v7 offset:45056
  ds_read_b64_tr_b16 v[94:95], v7 offset:47104
  s_waitcnt lgkmcnt(8)
  s_mov_b32 s19, 0
  v_add_u32 v6, 0xffff8000, v6
  v_add_u32 v7, 0xffff8000, v7
  s_waitcnt lgkmcnt(0)
  s_mov_b64 exec, 1
  ds_add_u32 v28, v27 offset:12
  s_mov_b64 exec, -1
  s_mov_b32 s4, 0xffff0000
  v_lshlrev_b32 v128, 16, v240
  v_and_b32 v129, s4, v240
  v_lshlrev_b32 v130, 16, v241
  v_and_b32 v131, s4, v241
  v_lshlrev_b32 v132, 16, v242
  v_and_b32 v133, s4, v242
  v_lshlrev_b32 v134, 16, v243
  v_and_b32 v135, s4, v243
  v_lshlrev_b32 v136, 16, v244
  v_and_b32 v137, s4, v244
  v_lshlrev_b32 v138, 16, v245
  v_and_b32 v139, s4, v245
  v_lshlrev_b32 v140, 16, v246
  v_and_b32 v141, s4, v246
  v_lshlrev_b32 v142, 16, v247
  v_and_b32 v143, s4, v247
  v_lshlrev_b32 v144, 16, v248
  v_and_b32 v145, s4, v248
  v_lshlrev_b32 v146, 16, v249
  v_and_b32 v147, s4, v249
  v_lshlrev_b32 v148, 16, v250
  v_and_b32 v149, s4, v250
  v_lshlrev_b32 v150, 16, v251
  v_and_b32 v151, s4, v251
  v_lshlrev_b32 v152, 16, v252
  v_and_b32 v153, s4, v252
  v_lshlrev_b32 v154, 16, v253
  v_and_b32 v155, s4, v253
  v_lshlrev_b32 v156, 16, v254
  v_and_b32 v157, s4, v254
  v_lshlrev_b32 v158, 16, v255
  v_and_b32 v159, s4, v255
  s_lshl_b32 s4, s76, 4
  s_add_u32 s4, s4, s78
  s_lshl_b32 s6, s4, 14
  s_add_u32 s6, s6, 7340032
  s_add_u32 s7, s6, 4096
  s_mov_b32 s22, 5
  s_barrier
  ds_read_b128 v[32:35], v4 offset:0
  ds_read_b128 v[36:39], v4 offset:2048
  ds_read_b128 v[40:43], v4 offset:4096
  ds_read_b128 v[44:47], v4 offset:6144
  ds_read_b128 v[64:67], v5 offset:0
  ds_read_b128 v[68:71], v5 offset:2048
  ds_read_b128 v[72:75], v5 offset:4096
  ds_read_b128 v[76:79], v5 offset:6144
  s_add_u32 s16, s16, s17
  s_cmp_eq_u32 s16, 65536
  s_cselect_b32 s23, s18, s17
  s_cselect_b32 s16, 0, s16
  v_add_u32 v4, s23, v4
  v_add_u32 v5, s23, v5
  s_waitcnt lgkmcnt(0)
  v_mfma_f32_16x16x32_bf16 v[128:131], v[48:51], v[32:35], v[128:131]
  v_mfma_f32_16x16x32_bf16 v[128:131], v[80:83], v[64:67], v[128:131]
  v_mfma_f32_16x16x32_bf16 v[136:139], v[80:83], v[68:71], v[136:139]
  v_mfma_f32_16x16x32_bf16 v[136:139], v[48:51], v[36:39], v[136:139]
  v_mfma_f32_16x16x32_bf16 v[144:147], v[48:51], v[40:43], v[144:147]
  v_mfma_f32_16x16x32_bf16 v[144:147], v[80:83], v[72:75], v[144:147]
  v_mfma_f32_16x16x32_bf16 v[152:155], v[80:83], v[76:79], v[152:155]
  v_mfma_f32_16x16x32_bf16 v[152:155], v[48:51], v[44:47], v[152:155]
  v_mfma_f32_16x16x32_bf16 v[156:159], v[52:55], v[44:47], v[156:159]
  v_mfma_f32_16x16x32_bf16 v[156:159], v[84:87], v[76:79], v[156:159]
  v_mfma_f32_16x16x32_bf16 v[148:151], v[84:87], v[72:75], v[148:151]
  v_mfma_f32_16x16x32_bf16 v[148:151], v[52:55], v[40:43], v[148:151]
  v_mfma_f32_16x16x32_bf16 v[140:143], v[52:55], v[36:39], v[140:143]
  v_mfma_f32_16x16x32_bf16 v[140:143], v[84:87], v[68:71], v[140:143]
  v_mfma_f32_16x16x32_bf16 v[132:135], v[84:87], v[64:67], v[132:135]
  v_mfma_f32_16x16x32_bf16 v[132:135], v[52:55], v[32:35], v[132:135]
  s_nop 0
  s_barrier
  ds_read_b128 v[96:99], v4 offset:0
  ds_read_b128 v[192:195], v5 offset:0
  ds_read_b128 v[100:103], v4 offset:2048
  ds_read_b128 v[196:199], v5 offset:2048
  ds_read_b128 v[104:107], v4 offset:4096
  ds_read_b128 v[200:203], v5 offset:4096
  ds_read_b128 v[108:111], v4 offset:6144
  ds_read_b128 v[204:207], v5 offset:6144
  s_add_u32 s16, s16, s17
  s_cmp_eq_u32 s16, 65536
  s_cselect_b32 s23, s18, s17
  s_cselect_b32 s16, 0, s16
  v_add_u32 v4, s23, v4
  v_add_u32 v5, s23, v5
  s_waitcnt lgkmcnt(6)
  v_mfma_f32_16x16x32_bf16 v[128:131], v[112:115], v[96:99], v[128:131]
  v_mfma_f32_16x16x32_bf16 v[128:131], v[208:211], v[192:195], v[128:131]
  s_waitcnt lgkmcnt(4)
  v_mfma_f32_16x16x32_bf16 v[136:139], v[208:211], v[196:199], v[136:139]
  v_mfma_f32_16x16x32_bf16 v[136:139], v[112:115], v[100:103], v[136:139]
  s_waitcnt lgkmcnt(2)
  v_mfma_f32_16x16x32_bf16 v[144:147], v[112:115], v[104:107], v[144:147]
  v_mfma_f32_16x16x32_bf16 v[144:147], v[208:211], v[200:203], v[144:147]
  s_waitcnt lgkmcnt(0)
  v_mfma_f32_16x16x32_bf16 v[152:155], v[208:211], v[204:207], v[152:155]
  s_barrier
  v_mfma_f32_16x16x32_bf16 v[152:155], v[112:115], v[108:111], v[152:155]
  ds_read_b128 v[32:35], v4 offset:0
  ds_read_b128 v[36:39], v4 offset:2048
  v_mfma_f32_16x16x32_bf16 v[156:159], v[116:119], v[108:111], v[156:159]
  ds_read_b128 v[40:43], v4 offset:4096
  ds_read_b128 v[44:47], v4 offset:6144
  v_mfma_f32_16x16x32_bf16 v[156:159], v[212:215], v[204:207], v[156:159]
  ds_read_b128 v[64:67], v5 offset:0
  ds_read_b128 v[68:71], v5 offset:2048
  v_mfma_f32_16x16x32_bf16 v[148:151], v[212:215], v[200:203], v[148:151]
  ds_read_b128 v[72:75], v5 offset:4096
  ds_read_b128 v[76:79], v5 offset:6144
  v_mfma_f32_16x16x32_bf16 v[148:151], v[116:119], v[104:107], v[148:151]
  s_add_u32 s16, s16, s17
  s_cmp_eq_u32 s16, 65536
  s_cselect_b32 s23, s18, s17
  v_mfma_f32_16x16x32_bf16 v[140:143], v[116:119], v[100:103], v[140:143]
  s_cselect_b32 s16, 0, s16
  v_add_u32 v4, s23, v4
  v_add_u32_e64 v5, s23, v5
  v_mfma_f32_16x16x32_bf16 v[140:143], v[212:215], v[196:199], v[140:143]
  v_mfma_f32_16x16x32_bf16 v[132:135], v[212:215], v[192:195], v[132:135]
  s_waitcnt lgkmcnt(0)
  v_mfma_f32_16x16x32_bf16 v[132:135], v[116:119], v[96:99], v[132:135]
  s_barrier
  v_mfma_f32_16x16x32_bf16 v[128:131], v[160:163], v[32:35], v[128:131]
  ds_read_b128 v[96:99], v4 offset:0
  ds_read_b128 v[100:103], v4 offset:2048
  v_mfma_f32_16x16x32_bf16 v[128:131], v[168:171], v[64:67], v[128:131]
  ds_read_b128 v[104:107], v4 offset:4096
  ds_read_b128 v[108:111], v4 offset:6144
  v_mfma_f32_16x16x32_bf16 v[136:139], v[168:171], v[68:71], v[136:139]
  ds_read_b128 v[192:195], v5 offset:0
  ds_read_b128 v[196:199], v5 offset:2048
  v_mfma_f32_16x16x32_bf16 v[136:139], v[160:163], v[36:39], v[136:139]
  ds_read_b128 v[200:203], v5 offset:4096
  ds_read_b128 v[204:207], v5 offset:6144
  v_mfma_f32_16x16x32_bf16 v[144:147], v[160:163], v[40:43], v[144:147]
  s_add_u32 s16, s16, s17
  s_cmp_eq_u32 s16, 65536
  s_cselect_b32 s23, s18, s17
  v_mfma_f32_16x16x32_bf16 v[144:147], v[168:171], v[72:75], v[144:147]
  s_cselect_b32 s16, 0, s16
  v_add_u32 v4, s23, v4
  v_add_u32_e64 v5, s23, v5
  v_mfma_f32_16x16x32_bf16 v[152:155], v[168:171], v[76:79], v[152:155]
  v_mfma_f32_16x16x32_bf16 v[152:155], v[160:163], v[44:47], v[152:155]
  v_mfma_f32_16x16x32_bf16 v[156:159], v[164:167], v[44:47], v[156:159]
  v_mfma_f32_16x16x32_bf16 v[156:159], v[172:175], v[76:79], v[156:159]
  v_mfma_f32_16x16x32_bf16 v[148:151], v[172:175], v[72:75], v[148:151]
  v_mfma_f32_16x16x32_bf16 v[148:151], v[164:167], v[40:43], v[148:151]
  v_mfma_f32_16x16x32_bf16 v[140:143], v[164:167], v[36:39], v[140:143]
  v_mfma_f32_16x16x32_bf16 v[140:143], v[172:175], v[68:71], v[140:143]
  v_mfma_f32_16x16x32_bf16 v[132:135], v[172:175], v[64:67], v[132:135]
  s_waitcnt lgkmcnt(0)
  v_mfma_f32_16x16x32_bf16 v[132:135], v[164:167], v[32:35], v[132:135]
  s_barrier
  v_mfma_f32_16x16x32_bf16 v[128:131], v[176:179], v[96:99], v[128:131]
  ds_read_b128 v[32:35], v4 offset:0
  ds_read_b128 v[36:39], v4 offset:2048
  v_mfma_f32_16x16x32_bf16 v[128:131], v[184:187], v[192:195], v[128:131]
  ds_read_b128 v[40:43], v4 offset:4096
  ds_read_b128 v[44:47], v4 offset:6144
  v_mfma_f32_16x16x32_bf16 v[136:139], v[184:187], v[196:199], v[136:139]
  ds_read_b128 v[64:67], v5 offset:0
  ds_read_b128 v[68:71], v5 offset:2048
  v_mfma_f32_16x16x32_bf16 v[136:139], v[176:179], v[100:103], v[136:139]
  ds_read_b128 v[72:75], v5 offset:4096
  ds_read_b128 v[76:79], v5 offset:6144
  v_mfma_f32_16x16x32_bf16 v[144:147], v[176:179], v[104:107], v[144:147]
  s_add_u32 s16, s16, s17
  s_cmp_eq_u32 s16, 65536
  s_cselect_b32 s23, s18, s17
  v_mfma_f32_16x16x32_bf16 v[144:147], v[184:187], v[200:203], v[144:147]
  s_cselect_b32 s16, 0, s16
  v_add_u32 v4, s23, v4
  v_add_u32_e64 v5, s23, v5
  v_mfma_f32_16x16x32_bf16 v[152:155], v[184:187], v[204:207], v[152:155]
  v_mfma_f32_16x16x32_bf16 v[152:155], v[176:179], v[108:111], v[152:155]
  v_mfma_f32_16x16x32_bf16 v[156:159], v[180:183], v[108:111], v[156:159]
  v_mfma_f32_16x16x32_bf16 v[156:159], v[188:191], v[204:207], v[156:159]
  v_mfma_f32_16x16x32_bf16 v[148:151], v[188:191], v[200:203], v[148:151]
  v_mfma_f32_16x16x32_bf16 v[148:151], v[180:183], v[104:107], v[148:151]
  v_mfma_f32_16x16x32_bf16 v[140:143], v[180:183], v[100:103], v[140:143]
  v_mfma_f32_16x16x32_bf16 v[140:143], v[188:191], v[196:199], v[140:143]
  v_mfma_f32_16x16x32_bf16 v[132:135], v[188:191], v[192:195], v[132:135]
  s_waitcnt lgkmcnt(0)
  v_mfma_f32_16x16x32_bf16 v[132:135], v[180:183], v[96:99], v[132:135]
  s_barrier
  v_mfma_f32_16x16x32_bf16 v[128:131], v[224:227], v[32:35], v[128:131]
  ds_read_b128 v[96:99], v4 offset:0
  ds_read_b128 v[100:103], v4 offset:2048
  v_mfma_f32_16x16x32_bf16 v[128:131], v[232:235], v[64:67], v[128:131]
  ds_read_b128 v[104:107], v4 offset:4096
  ds_read_b128 v[108:111], v4 offset:6144
  v_mfma_f32_16x16x32_bf16 v[136:139], v[232:235], v[68:71], v[136:139]
  ds_read_b128 v[192:195], v5 offset:0
  ds_read_b128 v[196:199], v5 offset:2048
  v_mfma_f32_16x16x32_bf16 v[136:139], v[224:227], v[36:39], v[136:139]
  ds_read_b128 v[200:203], v5 offset:4096
  ds_read_b128 v[204:207], v5 offset:6144
  v_mfma_f32_16x16x32_bf16 v[144:147], v[224:227], v[40:43], v[144:147]
  s_add_u32 s16, s16, s17
  s_cmp_eq_u32 s16, 65536
  s_cselect_b32 s23, s18, s17
  v_mfma_f32_16x16x32_bf16 v[144:147], v[232:235], v[72:75], v[144:147]
  s_cselect_b32 s16, 0, s16
  v_add_u32 v4, s23, v4
  v_add_u32_e64 v5, s23, v5
  v_mfma_f32_16x16x32_bf16 v[152:155], v[232:235], v[76:79], v[152:155]
  v_mfma_f32_16x16x32_bf16 v[152:155], v[224:227], v[44:47], v[152:155]
  v_mfma_f32_16x16x32_bf16 v[156:159], v[228:231], v[44:47], v[156:159]
  v_mfma_f32_16x16x32_bf16 v[156:159], v[236:239], v[76:79], v[156:159]
  v_mfma_f32_16x16x32_bf16 v[148:151], v[236:239], v[72:75], v[148:151]
  v_mfma_f32_16x16x32_bf16 v[148:151], v[228:231], v[40:43], v[148:151]
  v_mfma_f32_16x16x32_bf16 v[140:143], v[228:231], v[36:39], v[140:143]
  v_mfma_f32_16x16x32_bf16 v[140:143], v[236:239], v[68:71], v[140:143]
  v_mfma_f32_16x16x32_bf16 v[132:135], v[236:239], v[64:67], v[132:135]
  s_waitcnt lgkmcnt(0)
  v_mfma_f32_16x16x32_bf16 v[132:135], v[228:231], v[32:35], v[132:135]
  s_barrier
  v_mfma_f32_16x16x32_bf16 v[128:131], v[56:59], v[96:99], v[128:131]
  ds_read_b64_tr_b16 v[48:49], v6 offset:0
  ds_read_b64_tr_b16 v[50:51], v6 offset:2048
  v_mfma_f32_16x16x32_bf16 v[128:131], v[88:91], v[192:195], v[128:131]
  ds_read_b128 v[32:35], v4 offset:0
  ds_read_b128 v[36:39], v4 offset:2048
  v_mfma_f32_16x16x32_bf16 v[136:139], v[88:91], v[196:199], v[136:139]
  ds_read_b128 v[40:43], v4 offset:4096
  ds_read_b128 v[44:47], v4 offset:6144
  v_mfma_f32_16x16x32_bf16 v[136:139], v[56:59], v[100:103], v[136:139]
  ds_read_b64_tr_b16 v[52:53], v7 offset:0
  ds_read_b64_tr_b16 v[54:55], v7 offset:2048
  v_mfma_f32_16x16x32_bf16 v[144:147], v[56:59], v[104:107], v[144:147]
  ds_read_b64_tr_b16 v[80:81], v6 offset:4096
  ds_read_b64_tr_b16 v[82:83], v6 offset:6144
  v_mfma_f32_16x16x32_bf16 v[144:147], v[88:91], v[200:203], v[144:147]
  ds_read_b128 v[64:67], v5 offset:0
  ds_read_b128 v[68:71], v5 offset:2048
  v_mfma_f32_16x16x32_bf16 v[152:155], v[88:91], v[204:207], v[152:155]
  ds_read_b128 v[72:75], v5 offset:4096
  ds_read_b128 v[76:79], v5 offset:6144
  v_mfma_f32_16x16x32_bf16 v[152:155], v[56:59], v[108:111], v[152:155]
  ds_read_b64_tr_b16 v[84:85], v7 offset:4096
  ds_read_b64_tr_b16 v[86:87], v7 offset:6144
  v_mfma_f32_16x16x32_bf16 v[156:159], v[60:63], v[108:111], v[156:159]
  s_add_u32 s16, s16, s17
  s_cmp_eq_u32 s16, 65536
  s_cselect_b32 s23, s18, s17
  v_mfma_f32_16x16x32_bf16 v[156:159], v[92:95], v[204:207], v[156:159]
  s_cselect_b32 s16, 0, s16
  v_add_u32 v4, s23, v4
  v_add_u32_e64 v5, s23, v5
  v_mfma_f32_16x16x32_bf16 v[148:151], v[92:95], v[200:203], v[148:151]
  s_add_u32 s19, s19, s20
  s_cmp_eq_u32 s19, 81920
  s_cselect_b32 s23, s21, s20
  v_mfma_f32_16x16x32_bf16 v[148:151], v[60:63], v[104:107], v[148:151]
  s_cselect_b32 s19, 0, s19
  v_add_u32 v6, s23, v6
  v_add_u32_e64 v7, s23, v7
  v_mfma_f32_16x16x32_bf16 v[140:143], v[60:63], v[100:103], v[140:143]
  v_mfma_f32_16x16x32_bf16 v[140:143], v[92:95], v[196:199], v[140:143]
  v_mfma_f32_16x16x32_bf16 v[132:135], v[92:95], v[192:195], v[132:135]
  s_waitcnt lgkmcnt(0)
  v_mfma_f32_16x16x32_bf16 v[132:135], v[60:63], v[96:99], v[132:135]
Lk_20:
  s_barrier
  v_mfma_f32_16x16x32_bf16 v[128:131], v[48:51], v[32:35], v[128:131]
  ds_read_b64_tr_b16 v[112:113], v6 offset:0
  ds_read_b64_tr_b16 v[114:115], v6 offset:2048
  v_mfma_f32_16x16x32_bf16 v[128:131], v[80:83], v[64:67], v[128:131]
  ds_read_b128 v[96:99], v4 offset:0
  ds_read_b128 v[100:103], v4 offset:2048
  v_mfma_f32_16x16x32_bf16 v[136:139], v[80:83], v[68:71], v[136:139]
  ds_read_b128 v[104:107], v4 offset:4096
  ds_read_b128 v[108:111], v4 offset:6144
  v_mfma_f32_16x16x32_bf16 v[136:139], v[48:51], v[36:39], v[136:139]
  ds_read_b64_tr_b16 v[116:117], v7 offset:0
  ds_read_b64_tr_b16 v[118:119], v7 offset:2048
  v_mfma_f32_16x16x32_bf16 v[144:147], v[48:51], v[40:43], v[144:147]
  ds_read_b64_tr_b16 v[208:209], v6 offset:4096
  ds_read_b64_tr_b16 v[210:211], v6 offset:6144
  v_mfma_f32_16x16x32_bf16 v[144:147], v[80:83], v[72:75], v[144:147]
  ds_read_b128 v[192:195], v5 offset:0
  ds_read_b128 v[196:199], v5 offset:2048
  v_mfma_f32_16x16x32_bf16 v[152:155], v[80:83], v[76:79], v[152:155]
  ds_read_b128 v[200:203], v5 offset:4096
  ds_read_b128 v[204:207], v5 offset:6144
  v_mfma_f32_16x16x32_bf16 v[152:155], v[48:51], v[44:47], v[152:155]
  ds_read_b64_tr_b16 v[212:213], v7 offset:4096
  ds_read_b64_tr_b16 v[214:215], v7 offset:6144
  v_mfma_f32_16x16x32_bf16 v[156:159], v[52:55], v[44:47], v[156:159]
  s_add_u32 s16, s16, s17
  s_cmp_eq_u32 s16, 65536
  s_cselect_b32 s23, s18, s17
  v_mfma_f32_16x16x32_bf16 v[156:159], v[84:87], v[76:79], v[156:159]
  s_cselect_b32 s16, 0, s16
  v_add_u32 v4, s23, v4
  v_add_u32_e64 v5, s23, v5
  v_mfma_f32_16x16x32_bf16 v[148:151], v[84:87], v[72:75], v[148:151]
  s_add_u32 s19, s19, s20
  s_cmp_eq_u32 s19, 81920
  s_cselect_b32 s23, s21, s20
  v_mfma_f32_16x16x32_bf16 v[148:151], v[52:55], v[40:43], v[148:151]
  s_cselect_b32 s19, 0, s19
  v_add_u32 v6, s23, v6
  v_add_u32_e64 v7, s23, v7
  v_mfma_f32_16x16x32_bf16 v[140:143], v[52:55], v[36:39], v[140:143]
  v_mfma_f32_16x16x32_bf16 v[140:143], v[84:87], v[68:71], v[140:143]
  v_mfma_f32_16x16x32_bf16 v[132:135], v[84:87], v[64:67], v[132:135]
  s_waitcnt lgkmcnt(0)
  v_mfma_f32_16x16x32_bf16 v[132:135], v[52:55], v[32:35], v[132:135]
  s_barrier
  v_mfma_f32_16x16x32_bf16 v[128:131], v[112:115], v[96:99], v[128:131]
  ds_read_b64_tr_b16 v[48:49], v6 offset:0
  ds_read_b64_tr_b16 v[50:51], v6 offset:2048
  v_mfma_f32_16x16x32_bf16 v[128:131], v[208:211], v[192:195], v[128:131]
  ds_read_b128 v[32:35], v4 offset:0
  ds_read_b128 v[36:39], v4 offset:2048
  v_mfma_f32_16x16x32_bf16 v[136:139], v[208:211], v[196:199], v[136:139]
  ds_read_b128 v[40:43], v4 offset:4096
  ds_read_b128 v[44:47], v4 offset:6144
  v_mfma_f32_16x16x32_bf16 v[136:139], v[112:115], v[100:103], v[136:139]
  ds_read_b64_tr_b16 v[52:53], v7 offset:0
  ds_read_b64_tr_b16 v[54:55], v7 offset:2048
  v_mfma_f32_16x16x32_bf16 v[144:147], v[112:115], v[104:107], v[144:147]
  ds_read_b64_tr_b16 v[80:81], v6 offset:4096
  ds_read_b64_tr_b16 v[82:83], v6 offset:6144
  v_mfma_f32_16x16x32_bf16 v[144:147], v[208:211], v[200:203], v[144:147]
  ds_read_b128 v[64:67], v5 offset:0
  ds_read_b128 v[68:71], v5 offset:2048
  v_mfma_f32_16x16x32_bf16 v[152:155], v[208:211], v[204:207], v[152:155]
  ds_read_b128 v[72:75], v5 offset:4096
  ds_read_b128 v[76:79], v5 offset:6144
  v_mfma_f32_16x16x32_bf16 v[152:155], v[112:115], v[108:111], v[152:155]
  ds_read_b64_tr_b16 v[84:85], v7 offset:4096
  ds_read_b64_tr_b16 v[86:87], v7 offset:6144
  v_mfma_f32_16x16x32_bf16 v[156:159], v[116:119], v[108:111], v[156:159]
  s_add_u32 s16, s16, s17
  s_cmp_eq_u32 s16, 65536
  s_cselect_b32 s23, s18, s17
  v_mfma_f32_16x16x32_bf16 v[156:159], v[212:215], v[204:207], v[156:159]
  s_cselect_b32 s16, 0, s16
  v_add_u32 v4, s23, v4
  v_add_u32_e64 v5, s23, v5
  v_mfma_f32_16x16x32_bf16 v[148:151], v[212:215], v[200:203], v[148:151]
  s_add_u32 s19, s19, s20
  s_cmp_eq_u32 s19, 81920
  s_cselect_b32 s23, s21, s20
  v_mfma_f32_16x16x32_bf16 v[148:151], v[116:119], v[104:107], v[148:151]
  s_cselect_b32 s19, 0, s19
  v_add_u32 v6, s23, v6
  v_add_u32_e64 v7, s23, v7
  v_mfma_f32_16x16x32_bf16 v[140:143], v[116:119], v[100:103], v[140:143]
  s_sub_u32 s22, s22, 1
  s_cmp_lg_u32 s22, 0
  v_mfma_f32_16x16x32_bf16 v[140:143], v[212:215], v[196:199], v[140:143]
  v_mfma_f32_16x16x32_bf16 v[132:135], v[212:215], v[192:195], v[132:135]
  s_nop 0
  s_waitcnt lgkmcnt(0)
  v_mfma_f32_16x16x32_bf16 v[132:135], v[116:119], v[96:99], v[132:135]
  s_cbranch_scc1 Lk_20
  s_waitcnt lgkmcnt(0)
  v_cvt_pk_bf16_f32 v252, v152, v153
  v_cvt_pk_bf16_f32 v253, v154, v155
  v_cvt_pk_bf16_f32 v254, v156, v157
  v_cvt_pk_bf16_f32 v255, v158, v159
  buffer_store_dwordx4 v[252:255], v0, s[40:43], s7 offen offset:2048 sc0 sc1
  v_cvt_pk_bf16_f32 v248, v144, v145
  v_cvt_pk_bf16_f32 v249, v146, v147
  v_cvt_pk_bf16_f32 v250, v148, v149
  v_cvt_pk_bf16_f32 v251, v150, v151
  buffer_store_dwordx4 v[248:251], v0, s[40:43], s7 offen offset:0 sc0 sc1
  v_cvt_pk_bf16_f32 v244, v136, v137
  v_cvt_pk_bf16_f32 v245, v138, v139
  v_cvt_pk_bf16_f32 v246, v140, v141
  v_cvt_pk_bf16_f32 v247, v142, v143
  buffer_store_dwordx4 v[244:247], v0, s[40:43], s6 offen offset:2048 sc0 sc1
  v_cvt_pk_bf16_f32 v240, v128, v129
  v_cvt_pk_bf16_f32 v241, v130, v131
  v_cvt_pk_bf16_f32 v242, v132, v133
  v_cvt_pk_bf16_f32 v243, v134, v135
  buffer_store_dwordx4 v[240:243], v0, s[40:43], s6 offen offset:0 sc0 sc1
  s_lshl_b32 s5, s78, Lz1-Lz0+1
  v_mov_b32 v40, 0x3f803f80
  v_dot2_f32_bf16 v32, v240, v40, 0
  v_dot2_f32_bf16 v36, v240, v240, 0
  v_dot2_f32_bf16 v33, v244, v40, 0
  v_dot2_f32_bf16 v37, v244, v244, 0
  v_dot2_f32_bf16 v34, v248, v40, 0
  v_dot2_f32_bf16 v38, v248, v248, 0
  v_dot2_f32_bf16 v35, v252, v40, 0
  v_dot2_f32_bf16 v39, v252, v252, 0
  v_dot2_f32_bf16 v32, v241, v40, v32
  v_dot2_f32_bf16 v36, v241, v241, v36
  v_dot2_f32_bf16 v33, v245, v40, v33
  v_dot2_f32_bf16 v37, v245, v245, v37
  v_dot2_f32_bf16 v34, v249, v40, v34
  v_dot2_f32_bf16 v38, v249, v249, v38
  v_dot2_f32_bf16 v35, v253, v40, v35
  v_dot2_f32_bf16 v39, v253, v253, v39
  v_dot2_f32_bf16 v32, v242, v40, v32
  v_dot2_f32_bf16 v36, v242, v242, v36
  v_dot2_f32_bf16 v33, v246, v40, v33
  v_dot2_f32_bf16 v37, v246, v246, v37
  v_dot2_f32_bf16 v34, v250, v40, v34
  v_dot2_f32_bf16 v38, v250, v250, v38
  v_dot2_f32_bf16 v35, v254, v40, v35
  v_dot2_f32_bf16 v39, v254, v254, v39
  v_dot2_f32_bf16 v32, v243, v40, v32
  v_dot2_f32_bf16 v36, v243, v243, v36
  v_dot2_f32_bf16 v33, v247, v40, v33
  v_dot2_f32_bf16 v37, v247, v247, v37
  v_dot2_f32_bf16 v34, v251, v40, v34
  v_dot2_f32_bf16 v38, v251, v251, v38
  v_dot2_f32_bf16 v35, v255, v40, v35
  v_dot2_f32_bf16 v39, v255, v255, v39
  s_lshl_b32 s6, s76, Lz1-Lz0+9
  s_lshl_b32 s7, s85, 8
  s_add_u32 s6, s6, s7
  s_add_u32 s6, s6, s5
  s_add_u32 s6, s6, s86
  s_lshl_b32 s6, s6, 6
  s_add_u32 s6, s6, s83
  s_add_u32 s6, s6, 31457280
  v_permlane32_swap_b32 v32, v34
  v_permlane32_swap_b32 v33, v35
  v_permlane32_swap_b32 v36, v38
  v_permlane32_swap_b32 v37, v39
  v_add_f32 v32, v32, v34
  v_add_f32 v33, v33, v35
  v_add_f32 v36, v36, v38
  v_add_f32 v37, v37, v39
  v_permlane16_swap_b32 v32, v33
  s_nop 0
  v_permlane16_swap_b32 v36, v37
  v_add_f32 v42, v32, v33
  v_add_f32_e64 v43, v36, v37
  buffer_store_dwordx2 v[42:43], v30, s[40:43], s6 offen sc0 sc1
  ds_write_b128 v0, v[240:243] offset:0
  ds_write_b128 v0, v[244:247] offset:2048
  ds_write_b128 v0, v[248:251] offset:4096
  ds_write_b128 v0, v[252:255] offset:6144
  s_add_u32 s5, s87, 0x4
  s_sub_u32 s4, s78, s77
  s_lshl_b32 s4, s4, 7
  s_add_u32 s5, s5, s4
  s_waitcnt vmcnt(0)
  s_mov_b64 exec, 1
  ds_add_rtn_u32 v2, v28, v27 offset:0
  s_waitcnt lgkmcnt(0)
  v_readfirstlane_b32 s4, v2
  s_and_b32 s4, s4, Lz1-Lz0+3
  s_cmp_lg_u32 s4, 3
  s_cbranch_scc1 Ls_21
  s_mov_b32 exec_lo, 0xffff
  buffer_store_dword v27, v24, s[40:43], s5 offen sc0 sc1
Ls_21:
  s_mov_b64 exec, -1
  s_mov_b32 s16, 0
  s_mov_b32 s17, 16384
  s_mov_b32 s18, 0xffff4000
  s_mov_b32 s19, Lz1-Lz0+0
  s_mov_b32 s20, 28672
  s_mov_b32 s21, 0xffff2000
  s_mul_i32 s4, s85, 8192
  v_add_u32_e64 v4, s4, v11
  v_add_u32 v5, 1024, v4
  s_mul_i32 s4, s86, 6
  s_add_u32 s4, s4, 0
  s_lshr_b32 s5, s4, 2
  s_lshl_b32 s5, s5, 13
  s_and_b32 s4, s4, 3
  v_xor_b32 v2, s4, v26
  v_lshl_add_u32 v6, v2, 5, v25
  v_add_u32 v6, s5, v6
  s_mul_i32 s4, s86, 6
  s_add_u32 s4, s4, 1
  s_lshr_b32 s5, s4, 2
  s_lshl_b32 s5, s5, 13
  s_and_b32 s4, s4, 3
  v_xor_b32_e64 v2, s4, v26
  v_lshl_add_u32 v7, v2, 5, v25
  v_add_u32 v7, s5, v7
  s_mul_i32 s4, s86, 6
  s_add_u32 s4, s4, 2
  s_lshr_b32 s5, s4, 2
  s_lshl_b32 s5, s5, 13
  s_and_b32 s4, s4, 3
  v_xor_b32_e64 v2, s4, v26
  v_lshl_add_u32 v8, v2, 5, v25
  v_add_u32 v8, s5, v8
  s_mul_i32 s4, s86, 6
  s_add_u32 s4, s4, 3
  s_lshr_b32 s5, s4, 2
  s_lshl_b32 s5, s5, 13
  s_and_b32 s4, s4, 3
  v_xor_b32_e64 v2, s4, v26
  v_lshl_add_u32 v9, v2, 5, v25
  v_add_u32 v9, s5, v9
  v_lshrrev_b32 v2, 2, v1
  v_lshlrev_b32 v3, 6, v2
  v_and_b32 v2, 3, v1
  v_lshl_add_u32 v3, v2, 3, v3
  v_bfe_u32 v2, v1, 4, 1
  v_xor_b32_e64 v2, s86, v2
  v_lshl_add_u32 v3, v2, 5, v3
  v_add_u32 v10, 90112, v3
  v_mov_b64 v[128:129], 0
  v_mov_b64 v[130:131], 0
  v_mov_b64 v[132:133], 0
  v_mov_b64 v[134:135], 0
  v_mov_b64 v[136:137], 0
  v_mov_b64 v[138:139], 0
  v_mov_b64 v[140:141], 0
  v_mov_b64 v[142:143], 0
  v_mov_b64 v[144:145], 0
  v_mov_b64 v[146:147], 0
  v_mov_b64 v[148:149], 0
  v_mov_b64 v[150:151], 0
  v_mov_b64 v[152:153], 0
  v_mov_b64 v[154:155], 0
  v_mov_b64 v[156:157], 0
  v_mov_b64 v[158:159], 0
  v_mov_b64 v[160:161], 0
  v_mov_b64 v[162:163], 0
  v_mov_b64 v[164:165], 0
  v_mov_b64 v[166:167], 0
  v_mov_b64 v[168:169], 0
  v_mov_b64 v[170:171], 0
  v_mov_b64 v[172:173], 0
  v_mov_b64 v[174:175], 0
  v_mov_b64 v[176:177], 0
  v_mov_b64 v[178:179], 0
  v_mov_b64 v[180:181], 0
  v_mov_b64 v[182:183], 0
  v_mov_b64 v[184:185], 0
  v_mov_b64 v[186:187], 0
  v_mov_b64 v[188:189], 0
  v_mov_b64 v[190:191], 0
  v_mov_b64 v[192:193], 0
  v_mov_b64 v[194:195], 0
  v_mov_b64 v[196:197], 0
  v_mov_b64 v[198:199], 0
  v_mov_b64 v[200:201], 0
  v_mov_b64 v[202:203], 0
  v_mov_b64 v[204:205], 0
  v_mov_b64 v[206:207], 0
  v_mov_b64 v[208:209], 0
  v_mov_b64 v[210:211], 0
  v_mov_b64 v[212:213], 0
  v_mov_b64 v[214:215], 0
  v_mov_b64 v[216:217], 0
  v_mov_b64 v[218:219], 0
  v_mov_b64 v[220:221], 0
  v_mov_b64 v[222:223], 0
  v_mov_b64 v[224:225], 0
  v_mov_b64 v[226:227], 0
  v_mov_b64 v[228:229], 0
  v_mov_b64 v[230:231], 0
  v_mov_b64 v[232:233], 0
  v_mov_b64 v[234:235], 0
  v_mov_b64 v[236:237], 0
  v_mov_b64 v[238:239], 0
  s_mul_i32 s5, s86, 384
  s_add_u32 s5, s5, 154112
  v_add_u32 v3, s5, v29
  s_mul_i32 s4, s76, 56
  s_mul_i32 s5, s79, 28
  s_add_u32 s4, s4, s5
  s_add_u32 s6, s4, s80
  s_lshl_b32 s6, s6, 14
  s_add_u32 s6, s6, 11599872
  s_add_u32 s7, s6, 4096
  s_lshr_b32 s5, s80, 1
  s_add_u32 s4, s4, s5
  s_lshl_b32 s4, s4, 1
  s_add_u32 s4, s4, s85
  s_lshl_b32 s4, s4, 3
  s_and_b32 s5, s80, 1
  s_add_u32 s4, s4, s5
  s_lshl_b32 s4, s4, 1
  s_add_u32 s4, s4, s86
  s_lshl_b32 s8, s4, 9
  s_add_u32 s8, s8, 11534336
  s_lshl_b32 s4, s79, Lz1-Lz0+3
  s_lshl_b32 s10, 0xff, s4
  s_mov_b32 s22, 8
  s_mov_b64 vcc, -1
  s_waitcnt lgkmcnt(0)
  s_barrier
  s_branch Lo_25
Lo_26:
  s_mov_b64 vcc, 0
  s_waitcnt lgkmcnt(0)
  s_barrier
  ds_read_b128 v[64:67], v4 offset:0
  ds_read_b128 v[80:83], v5 offset:0
  ds_read_b128 v[68:71], v4 offset:2048
  ds_read_b128 v[84:87], v5 offset:2048
  ds_read_b128 v[72:75], v4 offset:4096
  ds_read_b128 v[88:91], v5 offset:4096
  ds_read_b64_tr_b16 v[96:97], v6 offset:0
  ds_read_b64_tr_b16 v[98:99], v6 offset:2048
  ds_read_b64_tr_b16 v[100:101], v6 offset:4096
  ds_read_b64_tr_b16 v[102:103], v6 offset:6144
  ds_read_b128 v[76:79], v4 offset:6144
  ds_read_b128 v[92:95], v5 offset:6144
  ds_read_b64_tr_b16 v[104:105], v7 offset:0
  s_nop 0
  s_waitcnt lgkmcnt(8)
  ds_read_b64_tr_b16 v[106:107], v7 offset:2048
  ds_read_b64_tr_b16 v[108:109], v7 offset:4096
  ds_read_b64_tr_b16 v[110:111], v7 offset:6144
  s_waitcnt lgkmcnt(6)
  s_branch Lk_23
Lo_25:
  ds_read_b128 v[32:35], v4 offset:0
  ds_read_b128 v[48:51], v5 offset:0
  ds_read_b128 v[36:39], v4 offset:2048
  ds_read_b128 v[52:55], v5 offset:2048
  ds_read_b128 v[40:43], v4 offset:4096
  ds_read_b128 v[56:59], v5 offset:4096
  ds_read_b64_tr_b16 v[96:97], v6 offset:0
  ds_read_b64_tr_b16 v[98:99], v6 offset:2048
  ds_read_b64_tr_b16 v[100:101], v6 offset:4096
  ds_read_b64_tr_b16 v[102:103], v6 offset:6144
  ds_read_b128 v[44:47], v4 offset:6144
  ds_read_b128 v[60:63], v5 offset:6144
  ds_read_b64_tr_b16 v[104:105], v7 offset:0
  s_nop 0
  s_waitcnt lgkmcnt(8)
  ds_read_b64_tr_b16 v[106:107], v7 offset:2048
  ds_read_b64_tr_b16 v[108:109], v7 offset:4096
  ds_read_b64_tr_b16 v[110:111], v7 offset:6144
  s_nop 0
  s_waitcnt lgkmcnt(6)
  .p2align 7
Lk_22:
  v_mfma_f32_16x16x32_bf16 v[128:131], v[96:99], v[32:35], v[128:131]
  ds_read_b64_tr_b16 v[112:113], v8 offset:0
  v_mfma_f32_16x16x32_bf16 v[128:131], v[100:103], v[48:51], v[128:131]
  ds_read_b64_tr_b16 v[114:115], v8 offset:2048
  v_mfma_f32_16x16x32_bf16 v[132:135], v[100:103], v[52:55], v[132:135]
  ds_read_b64_tr_b16 v[116:117], v8 offset:4096
  v_mfma_f32_16x16x32_bf16 v[132:135], v[96:99], v[36:39], v[132:135]
  ds_read_b64_tr_b16 v[118:119], v8 offset:6144
  v_mfma_f32_16x16x32_bf16 v[136:139], v[96:99], v[40:43], v[136:139]
  s_add_u32 s16, s16, s17
  s_cmp_eq_u32 s16, 65536
  s_cselect_b32 s23, s18, s17
  s_cselect_b32 s16, Lz1-Lz0+0, s16
  v_mfma_f32_16x16x32_bf16 v[136:139], v[100:103], v[56:59], v[136:139]
  v_add_u32_e64 v4, s23, v4
  v_add_u32 v5, s23, v5
  s_add_u32 s19, s19, s20
  s_cmp_eq_u32 s19, 86016
  s_waitcnt lgkmcnt(8)
  v_mfma_f32_16x16x32_bf16 v[140:143], v[100:103], v[60:63], v[140:143]
  s_cselect_b32 s23, s21, s20
  s_cselect_b32 s19, 0, s19
  v_mfma_f32_16x16x32_bf16 v[140:143], v[96:99], v[44:47], v[140:143]
  s_waitcnt lgkmcnt(4)
  v_mfma_f32_16x16x32_bf16 v[156:159], v[104:107], v[44:47], v[156:159]
  ds_read_b64_tr_b16 v[120:121], v9 offset:0
  v_mfma_f32_16x16x32_bf16 v[156:159], v[108:111], v[60:63], v[156:159]
  ds_read_b64_tr_b16 v[122:123], v9 offset:2048
  v_mfma_f32_16x16x32_bf16 v[152:155], v[108:111], v[56:59], v[152:155]
  ds_read_b64_tr_b16 v[124:125], v9 offset:4096
  v_mfma_f32_16x16x32_bf16 v[152:155], v[104:107], v[40:43], v[152:155]
  ds_read_b64_tr_b16 v[126:127], v9 offset:6144
  v_mfma_f32_16x16x32_bf16 v[148:151], v[104:107], v[36:39], v[148:151]
  v_mfma_f32_16x16x32_bf16 v[148:151], v[108:111], v[52:55], v[148:151]
  v_mfma_f32_16x16x32_bf16 v[144:147], v[108:111], v[48:51], v[144:147]
  ds_read_b64_tr_b16 v[96:97], v6 offset:8192
  v_mfma_f32_16x16x32_bf16 v[144:147], v[104:107], v[32:35], v[144:147]
  ds_read_b64_tr_b16 v[98:99], v6 offset:10240
  s_nop 0
  s_waitcnt lgkmcnt(6)
  v_mfma_f32_16x16x32_bf16 v[160:163], v[112:115], v[32:35], v[160:163]
  ds_read_b64_tr_b16 v[100:101], v6 offset:12288
  v_mfma_f32_16x16x32_bf16 v[160:163], v[116:119], v[48:51], v[160:163]
  ds_read_b64_tr_b16 v[102:103], v6 offset:14336
  v_mfma_f32_16x16x32_bf16 v[164:167], v[116:119], v[52:55], v[164:167]
  v_mfma_f32_16x16x32_bf16 v[164:167], v[112:115], v[36:39], v[164:167]
  v_mfma_f32_16x16x32_bf16 v[168:171], v[112:115], v[40:43], v[168:171]
  ds_read_b64_tr_b16 v[104:105], v7 offset:8192
  v_mfma_f32_16x16x32_bf16 v[168:171], v[116:119], v[56:59], v[168:171]
  ds_read_b64_tr_b16 v[106:107], v7 offset:10240
  v_mfma_f32_16x16x32_bf16 v[172:175], v[116:119], v[60:63], v[172:175]
  ds_read_b64_tr_b16 v[108:109], v7 offset:12288
  v_mfma_f32_16x16x32_bf16 v[172:175], v[112:115], v[44:47], v[172:175]
  ds_read_b64_tr_b16 v[110:111], v7 offset:14336
  s_waitcnt lgkmcnt(8)
  v_mfma_f32_16x16x32_bf16 v[188:191], v[120:123], v[44:47], v[188:191]
  v_add_u32 v6, s23, v6
  v_add_u32_e64 v7, s23, v7
  v_mfma_f32_16x16x32_bf16 v[188:191], v[124:127], v[60:63], v[188:191]
  ds_read_b64_tr_b16 v[112:113], v10 offset:0
  v_mfma_f32_16x16x32_bf16 v[184:187], v[124:127], v[56:59], v[184:187]
  ds_read_b64_tr_b16 v[114:115], v10 offset:1024
  v_mfma_f32_16x16x32_bf16 v[184:187], v[120:123], v[40:43], v[184:187]
  ds_read_b64_tr_b16 v[116:117], v10 offset:2048
  v_mfma_f32_16x16x32_bf16 v[180:183], v[120:123], v[36:39], v[180:183]
  ds_read_b64_tr_b16 v[118:119], v10 offset:3072
  v_mfma_f32_16x16x32_bf16 v[180:183], v[124:127], v[52:55], v[180:183]
  v_add_u32 v8, s23, v8
  v_add_u32 v9, s23, v9
  v_mfma_f32_16x16x32_bf16 v[176:179], v[124:127], v[48:51], v[176:179]
  v_add_u32 v10, s23, v10
  v_mfma_f32_16x16x32_bf16 v[176:179], v[120:123], v[32:35], v[176:179]
  s_waitcnt lgkmcnt(0)
  s_cbranch_vccnz Lo_27
  s_barrier
Lo_27:
  v_mfma_f32_16x16x32_bf16 v[192:195], v[96:99], v[32:35], v[192:195]
  ds_read_b128 v[64:67], v4 offset:0
  v_mfma_f32_16x16x32_bf16 v[192:195], v[100:103], v[48:51], v[192:195]
  ds_read_b128 v[80:83], v5 offset:0
  v_mfma_f32_16x16x32_bf16 v[196:199], v[100:103], v[52:55], v[196:199]
  v_mfma_f32_16x16x32_bf16 v[196:199], v[96:99], v[36:39], v[196:199]
  ds_read_b128 v[68:71], v4 offset:2048
  v_mfma_f32_16x16x32_bf16 v[200:203], v[96:99], v[40:43], v[200:203]
  ds_read_b128 v[84:87], v5 offset:2048
  v_mfma_f32_16x16x32_bf16 v[200:203], v[100:103], v[56:59], v[200:203]
  v_mfma_f32_16x16x32_bf16 v[204:207], v[100:103], v[60:63], v[204:207]
  ds_read_b128 v[72:75], v4 offset:4096
  v_mfma_f32_16x16x32_bf16 v[204:207], v[96:99], v[44:47], v[204:207]
  ds_read_b128 v[88:91], v5 offset:4096
  v_mfma_f32_16x16x32_bf16 v[220:223], v[104:107], v[44:47], v[220:223]
  ds_read_b64_tr_b16 v[96:97], v6 offset:0
  v_mfma_f32_16x16x32_bf16 v[220:223], v[108:111], v[60:63], v[220:223]
  ds_read_b64_tr_b16 v[98:99], v6 offset:2048
  v_mfma_f32_16x16x32_bf16 v[216:219], v[108:111], v[56:59], v[216:219]
  ds_read_b64_tr_b16 v[100:101], v6 offset:4096
  v_mfma_f32_16x16x32_bf16 v[216:219], v[104:107], v[40:43], v[216:219]
  ds_read_b64_tr_b16 v[102:103], v6 offset:6144
  v_mfma_f32_16x16x32_bf16 v[212:215], v[104:107], v[36:39], v[212:215]
  ds_read_b128 v[76:79], v4 offset:6144
  v_mfma_f32_16x16x32_bf16 v[212:215], v[108:111], v[52:55], v[212:215]
  v_mfma_f32_16x16x32_bf16 v[208:211], v[108:111], v[48:51], v[208:211]
  ds_read_b128 v[92:95], v5 offset:6144
  v_mfma_f32_16x16x32_bf16 v[208:211], v[104:107], v[32:35], v[208:211]
  v_mfma_f32_16x16x32_bf16 v[224:227], v[112:115], v[32:35], v[224:227]
  ds_read_b64_tr_b16 v[104:105], v7 offset:0
  v_mfma_f32_16x16x32_bf16 v[224:227], v[116:119], v[48:51], v[224:227]
  v_mfma_f32_16x16x32_bf16 v[228:231], v[116:119], v[52:55], v[228:231]
  ds_read_b64_tr_b16 v[106:107], v7 offset:2048
  v_mfma_f32_16x16x32_bf16 v[228:231], v[112:115], v[36:39], v[228:231]
  v_mfma_f32_16x16x32_bf16 v[232:235], v[112:115], v[40:43], v[232:235]
  ds_read_b64_tr_b16 v[108:109], v7 offset:4096
  v_mfma_f32_16x16x32_bf16 v[232:235], v[116:119], v[56:59], v[232:235]
  v_mfma_f32_16x16x32_bf16 v[236:239], v[116:119], v[60:63], v[236:239]
  ds_read_b64_tr_b16 v[110:111], v7 offset:6144
  s_waitcnt lgkmcnt(6)
  v_mfma_f32_16x16x32_bf16 v[236:239], v[112:115], v[44:47], v[236:239]
  s_cbranch_vccnz Lo_26
Lk_23:
  v_mfma_f32_16x16x32_bf16 v[128:131], v[96:99], v[64:67], v[128:131]
  ds_read_b64_tr_b16 v[112:113], v8 offset:0
  v_mfma_f32_16x16x32_bf16 v[128:131], v[100:103], v[80:83], v[128:131]
  ds_read_b64_tr_b16 v[114:115], v8 offset:2048
  v_mfma_f32_16x16x32_bf16 v[132:135], v[100:103], v[84:87], v[132:135]
  ds_read_b64_tr_b16 v[116:117], v8 offset:4096
  v_mfma_f32_16x16x32_bf16 v[132:135], v[96:99], v[68:71], v[132:135]
  ds_read_b64_tr_b16 v[118:119], v8 offset:6144
  v_mfma_f32_16x16x32_bf16 v[136:139], v[96:99], v[72:75], v[136:139]
  s_add_u32 s16, s16, s17
  s_cmp_eq_u32 s16, 65536
  s_cselect_b32 s23, s18, s17
  s_cselect_b32 s16, Lz1-Lz0+0, s16
  v_mfma_f32_16x16x32_bf16 v[136:139], v[100:103], v[88:91], v[136:139]
  v_add_u32_e64 v4, s23, v4
  v_add_u32 v5, s23, v5
  s_add_u32 s19, s19, s20
  s_cmp_eq_u32 s19, 86016
  s_waitcnt lgkmcnt(8)
  v_mfma_f32_16x16x32_bf16 v[140:143], v[100:103], v[92:95], v[140:143]
  s_cselect_b32 s23, s21, s20
  s_cselect_b32 s19, 0, s19
  v_mfma_f32_16x16x32_bf16 v[140:143], v[96:99], v[76:79], v[140:143]
  s_waitcnt lgkmcnt(4)
  v_mfma_f32_16x16x32_bf16 v[156:159], v[104:107], v[76:79], v[156:159]
  ds_read_b64_tr_b16 v[120:121], v9 offset:0
  v_mfma_f32_16x16x32_bf16 v[156:159], v[108:111], v[92:95], v[156:159]
  ds_read_b64_tr_b16 v[122:123], v9 offset:2048
  v_mfma_f32_16x16x32_bf16 v[152:155], v[108:111], v[88:91], v[152:155]
  ds_read_b64_tr_b16 v[124:125], v9 offset:4096
  v_mfma_f32_16x16x32_bf16 v[152:155], v[104:107], v[72:75], v[152:155]
  ds_read_b64_tr_b16 v[126:127], v9 offset:6144
  v_mfma_f32_16x16x32_bf16 v[148:151], v[104:107], v[68:71], v[148:151]
  s_sub_u32 s22, s22, 1
  s_cmp_lg_u32 s22, 0
  v_mfma_f32_16x16x32_bf16 v[148:151], v[108:111], v[84:87], v[148:151]
  v_mfma_f32_16x16x32_bf16 v[144:147], v[108:111], v[80:83], v[144:147]
  ds_read_b64_tr_b16 v[96:97], v6 offset:8192
  v_mfma_f32_16x16x32_bf16 v[144:147], v[104:107], v[64:67], v[144:147]
  ds_read_b64_tr_b16 v[98:99], v6 offset:10240
  s_nop 0
  s_waitcnt lgkmcnt(6)
  v_mfma_f32_16x16x32_bf16 v[160:163], v[112:115], v[64:67], v[160:163]
  ds_read_b64_tr_b16 v[100:101], v6 offset:12288
  v_mfma_f32_16x16x32_bf16 v[160:163], v[116:119], v[80:83], v[160:163]
  ds_read_b64_tr_b16 v[102:103], v6 offset:14336
  v_mfma_f32_16x16x32_bf16 v[164:167], v[116:119], v[84:87], v[164:167]
  v_mfma_f32_16x16x32_bf16 v[164:167], v[112:115], v[68:71], v[164:167]
  v_mfma_f32_16x16x32_bf16 v[168:171], v[112:115], v[72:75], v[168:171]
  ds_read_b64_tr_b16 v[104:105], v7 offset:8192
  v_mfma_f32_16x16x32_bf16 v[168:171], v[116:119], v[88:91], v[168:171]
  ds_read_b64_tr_b16 v[106:107], v7 offset:10240
  v_mfma_f32_16x16x32_bf16 v[172:175], v[116:119], v[92:95], v[172:175]
  ds_read_b64_tr_b16 v[108:109], v7 offset:12288
  v_mfma_f32_16x16x32_bf16 v[172:175], v[112:115], v[76:79], v[172:175]
  ds_read_b64_tr_b16 v[110:111], v7 offset:14336
  s_waitcnt lgkmcnt(8)
  v_mfma_f32_16x16x32_bf16 v[188:191], v[120:123], v[76:79], v[188:191]
  v_add_u32 v6, s23, v6
  v_add_u32_e64 v7, s23, v7
  v_mfma_f32_16x16x32_bf16 v[188:191], v[124:127], v[92:95], v[188:191]
  ds_read_b64_tr_b16 v[112:113], v10 offset:0
  v_mfma_f32_16x16x32_bf16 v[184:187], v[124:127], v[88:91], v[184:187]
  ds_read_b64_tr_b16 v[114:115], v10 offset:1024
  v_mfma_f32_16x16x32_bf16 v[184:187], v[120:123], v[72:75], v[184:187]
  ds_read_b64_tr_b16 v[116:117], v10 offset:2048
  v_mfma_f32_16x16x32_bf16 v[180:183], v[120:123], v[68:71], v[180:183]
  ds_read_b64_tr_b16 v[118:119], v10 offset:3072
  v_mfma_f32_16x16x32_bf16 v[180:183], v[124:127], v[84:87], v[180:183]
  v_add_u32 v8, s23, v8
  v_add_u32 v9, s23, v9
  v_mfma_f32_16x16x32_bf16 v[176:179], v[124:127], v[80:83], v[176:179]
  v_add_u32 v10, s23, v10
  v_mfma_f32_16x16x32_bf16 v[176:179], v[120:123], v[64:67], v[176:179]
  s_waitcnt lgkmcnt(0)
  s_barrier
  s_cbranch_scc0 Lk_24
  v_mfma_f32_16x16x32_bf16 v[192:195], v[96:99], v[64:67], v[192:195]
  ds_read_b128 v[32:35], v4 offset:0
  v_mfma_f32_16x16x32_bf16 v[192:195], v[100:103], v[80:83], v[192:195]
  ds_read_b128 v[48:51], v5 offset:0
  v_mfma_f32_16x16x32_bf16 v[196:199], v[100:103], v[84:87], v[196:199]
  v_mfma_f32_16x16x32_bf16 v[196:199], v[96:99], v[68:71], v[196:199]
  ds_read_b128 v[36:39], v4 offset:2048
  v_mfma_f32_16x16x32_bf16 v[200:203], v[96:99], v[72:75], v[200:203]
  ds_read_b128 v[52:55], v5 offset:2048
  v_mfma_f32_16x16x32_bf16 v[200:203], v[100:103], v[88:91], v[200:203]
  v_mfma_f32_16x16x32_bf16 v[204:207], v[100:103], v[92:95], v[204:207]
  ds_read_b128 v[40:43], v4 offset:4096
  v_mfma_f32_16x16x32_bf16 v[204:207], v[96:99], v[76:79], v[204:207]
  ds_read_b128 v[56:59], v5 offset:4096
  v_mfma_f32_16x16x32_bf16 v[220:223], v[104:107], v[76:79], v[220:223]
  ds_read_b64_tr_b16 v[96:97], v6 offset:0
  v_mfma_f32_16x16x32_bf16 v[220:223], v[108:111], v[92:95], v[220:223]
  ds_read_b64_tr_b16 v[98:99], v6 offset:2048
  v_mfma_f32_16x16x32_bf16 v[216:219], v[108:111], v[88:91], v[216:219]
  ds_read_b64_tr_b16 v[100:101], v6 offset:4096
  v_mfma_f32_16x16x32_bf16 v[216:219], v[104:107], v[72:75], v[216:219]
  ds_read_b64_tr_b16 v[102:103], v6 offset:6144
  v_mfma_f32_16x16x32_bf16 v[212:215], v[104:107], v[68:71], v[212:215]
  ds_read_b128 v[44:47], v4 offset:6144
  v_mfma_f32_16x16x32_bf16 v[212:215], v[108:111], v[84:87], v[212:215]
  v_mfma_f32_16x16x32_bf16 v[208:211], v[108:111], v[80:83], v[208:211]
  ds_read_b128 v[60:63], v5 offset:6144
  v_mfma_f32_16x16x32_bf16 v[208:211], v[104:107], v[64:67], v[208:211]
  v_mfma_f32_16x16x32_bf16 v[224:227], v[112:115], v[64:67], v[224:227]
  ds_read_b64_tr_b16 v[104:105], v7 offset:0
  v_mfma_f32_16x16x32_bf16 v[224:227], v[116:119], v[80:83], v[224:227]
  v_mfma_f32_16x16x32_bf16 v[228:231], v[116:119], v[84:87], v[228:231]
  ds_read_b64_tr_b16 v[106:107], v7 offset:2048
  v_mfma_f32_16x16x32_bf16 v[228:231], v[112:115], v[68:71], v[228:231]
  v_mfma_f32_16x16x32_bf16 v[232:235], v[112:115], v[72:75], v[232:235]
  ds_read_b64_tr_b16 v[108:109], v7 offset:4096
  v_mfma_f32_16x16x32_bf16 v[232:235], v[116:119], v[88:91], v[232:235]
  v_mfma_f32_16x16x32_bf16 v[236:239], v[116:119], v[92:95], v[236:239]
  ds_read_b64_tr_b16 v[110:111], v7 offset:6144
  s_waitcnt lgkmcnt(6)
  v_mfma_f32_16x16x32_bf16 v[236:239], v[112:115], v[76:79], v[236:239]
  s_branch Lk_22
Lk_24:
  v_mfma_f32_16x16x32_bf16 v[192:195], v[96:99], v[64:67], v[192:195]
  ds_read_b128 v[32:35], v3 offset:0
  s_mul_i32 s4, s85, 320
  v_mfma_f32_16x16x32_bf16 v[192:195], v[100:103], v[80:83], v[192:195]
  ds_read_b128 v[36:39], v3 offset:1024
  s_add_u32 s4, s4, 151552
  v_mfma_f32_16x16x32_bf16 v[196:199], v[100:103], v[84:87], v[196:199]
  ds_read_b128 v[40:43], v3 offset:64
  v_and_b32_e64 v2, 15, v1
  v_mfma_f32_16x16x32_bf16 v[196:199], v[96:99], v[68:71], v[196:199]
  ds_read_b128 v[44:47], v3 offset:1088
  v_lshl_add_u32 v7, v2, 2, s4
  v_mfma_f32_16x16x32_bf16 v[200:203], v[96:99], v[72:75], v[200:203]
  ds_read_b128 v[48:51], v3 offset:128
  v_mov_b32 v4, 0x409d30fc
  v_mfma_f32_16x16x32_bf16 v[200:203], v[100:103], v[88:91], v[200:203]
  ds_read_b128 v[52:55], v3 offset:1152
  v_mov_b32 v5, 0x3eeff558
  v_mfma_f32_16x16x32_bf16 v[204:207], v[100:103], v[92:95], v[204:207]
  ds_read_b128 v[56:59], v3 offset:192
  v_and_b32_e64 v2, 32, v1
  v_mfma_f32_16x16x32_bf16 v[204:207], v[96:99], v[76:79], v[204:207]
  ds_read_b128 v[60:63], v3 offset:1216
  v_mad_u32_u24 v6, v2, 48, v11
  v_mfma_f32_16x16x32_bf16 v[220:223], v[104:107], v[76:79], v[220:223]
  v_mfma_f32_16x16x32_bf16 v[220:223], v[108:111], v[92:95], v[220:223]
  ds_read2_b32 v[96:97], v7 offset0:0 offset1:160
  ds_read2_b32 v[98:99], v7 offset0:16 offset1:176
  v_mfma_f32_16x16x32_bf16 v[216:219], v[108:111], v[88:91], v[216:219]
  ds_read2_b32 v[100:101], v7 offset0:32 offset1:192
  ds_read2_b32 v[102:103], v7 offset0:48 offset1:208
  v_mfma_f32_16x16x32_bf16 v[216:219], v[104:107], v[72:75], v[216:219]
  s_lshl_b32 s5, s86, Lz1-Lz0+6
  s_add_u32 s5, s5, 154880
  v_mfma_f32_16x16x32_bf16 v[212:215], v[104:107], v[68:71], v[212:215]
  v_add_u32_e64 v2, s5, v29
  v_mfma_f32_16x16x32_bf16 v[212:215], v[108:111], v[84:87], v[212:215]
  v_mfma_f32_16x16x32_bf16 v[208:211], v[108:111], v[80:83], v[208:211]
  v_mfma_f32_16x16x32_bf16 v[208:211], v[104:107], v[64:67], v[208:211]
  v_mfma_f32_16x16x32_bf16 v[224:227], v[112:115], v[64:67], v[224:227]
  v_mfma_f32_16x16x32_bf16 v[224:227], v[116:119], v[80:83], v[224:227]
  v_mfma_f32_16x16x32_bf16 v[228:231], v[116:119], v[84:87], v[228:231]
  v_mfma_f32_16x16x32_bf16 v[228:231], v[112:115], v[68:71], v[228:231]
  s_waitcnt lgkmcnt(0)
  v_mul_f32 v96, v5, v96
  v_mul_f32_e64 v98, v5, v98
  v_mfma_f32_16x16x32_bf16 v[232:235], v[112:115], v[72:75], v[232:235]
  v_mul_f32 v100, v5, v100
  v_mul_f32 v102, v5, v102
  v_mfma_f32_16x16x32_bf16 v[232:235], v[116:119], v[88:91], v[232:235]
  v_mfma_f32_16x16x32_bf16 v[236:239], v[116:119], v[92:95], v[236:239]
  v_mfma_f32_16x16x32_bf16 v[236:239], v[112:115], v[76:79], v[236:239]
  ds_read_b128 v[80:83], v2 offset:0
  ds_read_b128 v[84:87], v2 offset:1024
  ds_read_b128 v[64:67], v3 offset:256
  ds_read_b128 v[68:71], v3 offset:1280
  ds_read_b128 v[72:75], v3 offset:320
  ds_read_b128 v[76:79], v3 offset:1344
  v_pk_fma_f32 v[128:129], v[32:33], v[96:97], v[128:129] op_sel:[0,1,0] op_sel_hi:[1,1,1] neg_lo:[0,1,0] neg_hi:[0,1,0]
  v_pk_fma_f32 v[130:131], v[34:35], v[96:97], v[130:131] op_sel:[0,1,0] op_sel_hi:[1,1,1] neg_lo:[0,1,0] neg_hi:[0,1,0]
  v_pk_fma_f32 v[144:145], v[40:41], v[96:97], v[144:145] op_sel:[0,1,0] op_sel_hi:[1,1,1] neg_lo:[0,1,0] neg_hi:[0,1,0]
  v_pk_fma_f32 v[146:147], v[42:43], v[96:97], v[146:147] op_sel:[0,1,0] op_sel_hi:[1,1,1] neg_lo:[0,1,0] neg_hi:[0,1,0]
  v_pk_fma_f32 v[128:129], v[128:129], v[96:97], v[36:37] op_sel:[0,0,0] op_sel_hi:[1,0,1]
  v_pk_fma_f32 v[130:131], v[130:131], v[96:97], v[38:39] op_sel:[0,0,0] op_sel_hi:[1,0,1]
  v_pk_fma_f32 v[144:145], v[144:145], v[96:97], v[44:45] op_sel:[0,0,0] op_sel_hi:[1,0,1]
  v_pk_fma_f32 v[146:147], v[146:147], v[96:97], v[46:47] op_sel:[0,0,0] op_sel_hi:[1,0,1]
  v_pk_fma_f32 v[104:105], v[128:129], v[128:129], v[4:5] op_sel_hi:[1,1,0]
  v_pk_fma_f32 v[106:107], v[130:131], v[130:131], v[4:5] op_sel_hi:[1,1,0]
  v_pk_fma_f32 v[108:109], v[144:145], v[144:145], v[4:5] op_sel_hi:[1,1,0]
  v_pk_fma_f32 v[110:111], v[146:147], v[146:147], v[4:5] op_sel_hi:[1,1,0]
  v_pk_mul_f32 v[104:105], v[104:105], v[128:129] neg_lo:[0,1] neg_hi:[0,1]
  v_pk_mul_f32 v[106:107], v[106:107], v[130:131] neg_lo:[0,1] neg_hi:[0,1]
  v_pk_mul_f32 v[108:109], v[108:109], v[144:145] neg_lo:[0,1] neg_hi:[0,1]
  v_pk_mul_f32 v[110:111], v[110:111], v[146:147] neg_lo:[0,1] neg_hi:[0,1]
  v_exp_f32 v104, v104
  v_exp_f32 v105, v105
  v_exp_f32 v106, v106
  v_exp_f32 v107, v107
  v_exp_f32 v108, v108
  v_exp_f32 v109, v109
  v_exp_f32 v110, v110
  v_exp_f32 v111, v111
  v_pk_fma_f32 v[104:105], v[104:105], v[4:5], v[4:5] op_sel:[0,1,1] op_sel_hi:[1,1,1]
  v_pk_fma_f32 v[106:107], v[106:107], v[4:5], v[4:5] op_sel:[0,1,1] op_sel_hi:[1,1,1]
  v_pk_fma_f32 v[108:109], v[108:109], v[4:5], v[4:5] op_sel:[0,1,1] op_sel_hi:[1,1,1]
  v_pk_fma_f32 v[110:111], v[110:111], v[4:5], v[4:5] op_sel:[0,1,1] op_sel_hi:[1,1,1]
  v_rcp_f32 v104, v104
  v_rcp_f32 v105, v105
  v_rcp_f32 v106, v106
  v_rcp_f32 v107, v107
  v_rcp_f32 v108, v108
  v_rcp_f32 v109, v109
  v_rcp_f32 v110, v110
  v_rcp_f32 v111, v111
  v_pk_mul_f32 v[128:129], v[128:129], v[104:105]
  v_pk_mul_f32 v[130:131], v[130:131], v[106:107]
  v_pk_mul_f32 v[144:145], v[144:145], v[108:109]
  v_pk_mul_f32 v[146:147], v[146:147], v[110:111]
  v_cvt_pk_bf16_f32 v116, v128, v129
  v_cvt_pk_bf16_f32 v117, v130, v131
  v_cvt_pk_bf16_f32 v118, v144, v145
  v_cvt_pk_bf16_f32 v119, v146, v147
  buffer_store_dwordx4 v[116:119], v0, s[40:43], s6 offen offset:0 sc0 sc1
  ds_write_b128 v0, v[116:119] offset:0
  v_pk_fma_f32 v[132:133], v[32:33], v[98:99], v[132:133] op_sel:[0,1,0] op_sel_hi:[1,1,1] neg_lo:[0,1,0] neg_hi:[0,1,0]
  v_pk_fma_f32 v[134:135], v[34:35], v[98:99], v[134:135] op_sel:[0,1,0] op_sel_hi:[1,1,1] neg_lo:[0,1,0] neg_hi:[0,1,0]
  v_pk_fma_f32 v[148:149], v[40:41], v[98:99], v[148:149] op_sel:[0,1,0] op_sel_hi:[1,1,1] neg_lo:[0,1,0] neg_hi:[0,1,0]
  v_pk_fma_f32 v[150:151], v[42:43], v[98:99], v[150:151] op_sel:[0,1,0] op_sel_hi:[1,1,1] neg_lo:[0,1,0] neg_hi:[0,1,0]
  v_pk_fma_f32 v[132:133], v[132:133], v[98:99], v[36:37] op_sel:[0,0,0] op_sel_hi:[1,0,1]
  v_pk_fma_f32 v[134:135], v[134:135], v[98:99], v[38:39] op_sel:[0,0,0] op_sel_hi:[1,0,1]
  v_pk_fma_f32 v[148:149], v[148:149], v[98:99], v[44:45] op_sel:[0,0,0] op_sel_hi:[1,0,1]
  v_pk_fma_f32 v[150:151], v[150:151], v[98:99], v[46:47] op_sel:[0,0,0] op_sel_hi:[1,0,1]
  v_pk_fma_f32 v[104:105], v[132:133], v[132:133], v[4:5] op_sel_hi:[1,1,0]
  v_pk_fma_f32 v[106:107], v[134:135], v[134:135], v[4:5] op_sel_hi:[1,1,0]
  v_pk_fma_f32 v[108:109], v[148:149], v[148:149], v[4:5] op_sel_hi:[1,1,0]
  v_pk_fma_f32 v[110:111], v[150:151], v[150:151], v[4:5] op_sel_hi:[1,1,0]
  v_pk_mul_f32 v[104:105], v[104:105], v[132:133] neg_lo:[0,1] neg_hi:[0,1]
  v_pk_mul_f32 v[106:107], v[106:107], v[134:135] neg_lo:[0,1] neg_hi:[0,1]
  v_pk_mul_f32 v[108:109], v[108:109], v[148:149] neg_lo:[0,1] neg_hi:[0,1]
  v_pk_mul_f32 v[110:111], v[110:111], v[150:151] neg_lo:[0,1] neg_hi:[0,1]
  v_exp_f32 v104, v104
  v_exp_f32 v105, v105
  v_exp_f32 v106, v106
  v_exp_f32 v107, v107
  v_exp_f32 v108, v108
  v_exp_f32 v109, v109
  v_exp_f32 v110, v110
  v_exp_f32 v111, v111
  v_pk_fma_f32 v[104:105], v[104:105], v[4:5], v[4:5] op_sel:[0,1,1] op_sel_hi:[1,1,1]
  v_pk_fma_f32 v[106:107], v[106:107], v[4:5], v[4:5] op_sel:[0,1,1] op_sel_hi:[1,1,1]
  v_pk_fma_f32 v[108:109], v[108:109], v[4:5], v[4:5] op_sel:[0,1,1] op_sel_hi:[1,1,1]
  v_pk_fma_f32 v[110:111], v[110:111], v[4:5], v[4:5] op_sel:[0,1,1] op_sel_hi:[1,1,1]
  v_rcp_f32 v104, v104
  v_rcp_f32 v105, v105
  v_rcp_f32 v106, v106
  v_rcp_f32 v107, v107
  v_rcp_f32 v108, v108
  v_rcp_f32 v109, v109
  v_rcp_f32 v110, v110
  v_rcp_f32 v111, v111
  v_pk_mul_f32 v[132:133], v[132:133], v[104:105]
  v_pk_mul_f32 v[134:135], v[134:135], v[106:107]
  v_pk_mul_f32 v[148:149], v[148:149], v[108:109]
  v_pk_mul_f32 v[150:151], v[150:151], v[110:111]
  v_cvt_pk_bf16_f32 v120, v132, v133
  v_cvt_pk_bf16_f32 v121, v134, v135
  v_cvt_pk_bf16_f32 v122, v148, v149
  v_cvt_pk_bf16_f32 v123, v150, v151
  buffer_store_dwordx4 v[120:123], v0, s[40:43], s6 offen offset:2048 sc0 sc1
  ds_write_b128 v0, v[120:123] offset:2048
  s_add_u32 s6, s6, 0x20000
  v_pk_fma_f32 v[136:137], v[32:33], v[100:101], v[136:137] op_sel:[0,1,0] op_sel_hi:[1,1,1] neg_lo:[0,1,0] neg_hi:[0,1,0]
  v_pk_fma_f32 v[138:139], v[34:35], v[100:101], v[138:139] op_sel:[0,1,0] op_sel_hi:[1,1,1] neg_lo:[0,1,0] neg_hi:[0,1,0]
  v_pk_fma_f32 v[152:153], v[40:41], v[100:101], v[152:153] op_sel:[0,1,0] op_sel_hi:[1,1,1] neg_lo:[0,1,0] neg_hi:[0,1,0]
  v_pk_fma_f32 v[154:155], v[42:43], v[100:101], v[154:155] op_sel:[0,1,0] op_sel_hi:[1,1,1] neg_lo:[0,1,0] neg_hi:[0,1,0]
  v_pk_fma_f32 v[136:137], v[136:137], v[100:101], v[36:37] op_sel:[0,0,0] op_sel_hi:[1,0,1]
  v_pk_fma_f32 v[138:139], v[138:139], v[100:101], v[38:39] op_sel:[0,0,0] op_sel_hi:[1,0,1]
  v_pk_fma_f32 v[152:153], v[152:153], v[100:101], v[44:45] op_sel:[0,0,0] op_sel_hi:[1,0,1]
  v_pk_fma_f32 v[154:155], v[154:155], v[100:101], v[46:47] op_sel:[0,0,0] op_sel_hi:[1,0,1]
  v_pk_fma_f32 v[104:105], v[136:137], v[136:137], v[4:5] op_sel_hi:[1,1,0]
  v_pk_fma_f32 v[106:107], v[138:139], v[138:139], v[4:5] op_sel_hi:[1,1,0]
  v_pk_fma_f32 v[108:109], v[152:153], v[152:153], v[4:5] op_sel_hi:[1,1,0]
  v_pk_fma_f32 v[110:111], v[154:155], v[154:155], v[4:5] op_sel_hi:[1,1,0]
  v_pk_mul_f32 v[104:105], v[104:105], v[136:137] neg_lo:[0,1] neg_hi:[0,1]
  v_pk_mul_f32 v[106:107], v[106:107], v[138:139] neg_lo:[0,1] neg_hi:[0,1]
  v_pk_mul_f32 v[108:109], v[108:109], v[152:153] neg_lo:[0,1] neg_hi:[0,1]
  v_pk_mul_f32 v[110:111], v[110:111], v[154:155] neg_lo:[0,1] neg_hi:[0,1]
  v_exp_f32 v104, v104
  v_exp_f32 v105, v105
  v_exp_f32 v106, v106
  v_exp_f32 v107, v107
  v_exp_f32 v108, v108
  v_exp_f32 v109, v109
  v_exp_f32 v110, v110
  v_exp_f32 v111, v111
  v_pk_fma_f32 v[104:105], v[104:105], v[4:5], v[4:5] op_sel:[0,1,1] op_sel_hi:[1,1,1]
  v_pk_fma_f32 v[106:107], v[106:107], v[4:5], v[4:5] op_sel:[0,1,1] op_sel_hi:[1,1,1]
  v_pk_fma_f32 v[108:109], v[108:109], v[4:5], v[4:5] op_sel:[0,1,1] op_sel_hi:[1,1,1]
  v_pk_fma_f32 v[110:111], v[110:111], v[4:5], v[4:5] op_sel:[0,1,1] op_sel_hi:[1,1,1]
  v_rcp_f32 v104, v104
  v_rcp_f32 v105, v105
  v_rcp_f32 v106, v106
  v_rcp_f32 v107, v107
  v_rcp_f32 v108, v108
  v_rcp_f32 v109, v109
  v_rcp_f32 v110, v110
  v_rcp_f32 v111, v111
  v_pk_mul_f32 v[136:137], v[136:137], v[104:105]
  v_pk_mul_f32 v[138:139], v[138:139], v[106:107]
  v_pk_mul_f32 v[152:153], v[152:153], v[108:109]
  v_pk_mul_f32 v[154:155], v[154:155], v[110:111]
  v_cvt_pk_bf16_f32 v116, v136, v137
  v_cvt_pk_bf16_f32 v117, v138, v139
  v_cvt_pk_bf16_f32 v118, v152, v153
  v_cvt_pk_bf16_f32 v119, v154, v155
  buffer_store_dwordx4 v[116:119], v0, s[40:43], s7 offen offset:0 sc0 sc1
  ds_write_b128 v0, v[116:119] offset:4096
  v_pk_fma_f32 v[140:141], v[32:33], v[102:103], v[140:141] op_sel:[0,1,0] op_sel_hi:[1,1,1] neg_lo:[0,1,0] neg_hi:[0,1,0]
  v_pk_fma_f32 v[142:143], v[34:35], v[102:103], v[142:143] op_sel:[0,1,0] op_sel_hi:[1,1,1] neg_lo:[0,1,0] neg_hi:[0,1,0]
  v_pk_fma_f32 v[156:157], v[40:41], v[102:103], v[156:157] op_sel:[0,1,0] op_sel_hi:[1,1,1] neg_lo:[0,1,0] neg_hi:[0,1,0]
  v_pk_fma_f32 v[158:159], v[42:43], v[102:103], v[158:159] op_sel:[0,1,0] op_sel_hi:[1,1,1] neg_lo:[0,1,0] neg_hi:[0,1,0]
  v_pk_fma_f32 v[140:141], v[140:141], v[102:103], v[36:37] op_sel:[0,0,0] op_sel_hi:[1,0,1]
  v_pk_fma_f32 v[142:143], v[142:143], v[102:103], v[38:39] op_sel:[0,0,0] op_sel_hi:[1,0,1]
  v_pk_fma_f32 v[156:157], v[156:157], v[102:103], v[44:45] op_sel:[0,0,0] op_sel_hi:[1,0,1]
  v_pk_fma_f32 v[158:159], v[158:159], v[102:103], v[46:47] op_sel:[0,0,0] op_sel_hi:[1,0,1]
  v_pk_fma_f32 v[104:105], v[140:141], v[140:141], v[4:5] op_sel_hi:[1,1,0]
  v_pk_fma_f32 v[106:107], v[142:143], v[142:143], v[4:5] op_sel_hi:[1,1,0]
  v_pk_fma_f32 v[108:109], v[156:157], v[156:157], v[4:5] op_sel_hi:[1,1,0]
  v_pk_fma_f32 v[110:111], v[158:159], v[158:159], v[4:5] op_sel_hi:[1,1,0]
  v_pk_mul_f32 v[104:105], v[104:105], v[140:141] neg_lo:[0,1] neg_hi:[0,1]
  v_pk_mul_f32 v[106:107], v[106:107], v[142:143] neg_lo:[0,1] neg_hi:[0,1]
  v_pk_mul_f32 v[108:109], v[108:109], v[156:157] neg_lo:[0,1] neg_hi:[0,1]
  v_pk_mul_f32 v[110:111], v[110:111], v[158:159] neg_lo:[0,1] neg_hi:[0,1]
  v_exp_f32 v104, v104
  v_exp_f32 v105, v105
  v_exp_f32 v106, v106
  v_exp_f32 v107, v107
  v_exp_f32 v108, v108
  v_exp_f32 v109, v109
  v_exp_f32 v110, v110
  v_exp_f32 v111, v111
  v_pk_fma_f32 v[104:105], v[104:105], v[4:5], v[4:5] op_sel:[0,1,1] op_sel_hi:[1,1,1]
  v_pk_fma_f32 v[106:107], v[106:107], v[4:5], v[4:5] op_sel:[0,1,1] op_sel_hi:[1,1,1]
  v_pk_fma_f32 v[108:109], v[108:109], v[4:5], v[4:5] op_sel:[0,1,1] op_sel_hi:[1,1,1]
  v_pk_fma_f32 v[110:111], v[110:111], v[4:5], v[4:5] op_sel:[0,1,1] op_sel_hi:[1,1,1]
  v_rcp_f32 v104, v104
  v_rcp_f32 v105, v105
  v_rcp_f32 v106, v106
  v_rcp_f32 v107, v107
  v_rcp_f32 v108, v108
  v_rcp_f32 v109, v109
  v_rcp_f32 v110, v110
  v_rcp_f32 v111, v111
  v_pk_mul_f32 v[140:141], v[140:141], v[104:105]
  v_pk_mul_f32 v[142:143], v[142:143], v[106:107]
  v_pk_mul_f32 v[156:157], v[156:157], v[108:109]
  v_pk_mul_f32 v[158:159], v[158:159], v[110:111]
  v_cvt_pk_bf16_f32 v120, v140, v141
  v_cvt_pk_bf16_f32 v121, v142, v143
  v_cvt_pk_bf16_f32 v122, v156, v157
  v_cvt_pk_bf16_f32 v123, v158, v159
  buffer_store_dwordx4 v[120:123], v0, s[40:43], s7 offen offset:2048 sc0 sc1
  ds_write_b128 v0, v[120:123] offset:6144
  s_add_u32 s7, s7, 0x20000
  s_nop 0
  s_waitcnt lgkmcnt(0)
  v_pk_fma_f32 v[224:225], v[80:81], v[96:97], v[224:225] op_sel:[0,1,0] op_sel_hi:[1,1,1] neg_lo:[0,1,0] neg_hi:[0,1,0]
  v_pk_fma_f32 v[226:227], v[82:83], v[96:97], v[226:227] op_sel:[0,1,0] op_sel_hi:[1,1,1] neg_lo:[0,1,0] neg_hi:[0,1,0]
  v_pk_fma_f32 v[228:229], v[80:81], v[98:99], v[228:229] op_sel:[0,1,0] op_sel_hi:[1,1,1] neg_lo:[0,1,0] neg_hi:[0,1,0]
  v_pk_fma_f32 v[230:231], v[82:83], v[98:99], v[230:231] op_sel:[0,1,0] op_sel_hi:[1,1,1] neg_lo:[0,1,0] neg_hi:[0,1,0]
  v_pk_fma_f32 v[224:225], v[224:225], v[96:97], v[84:85] op_sel:[0,0,0] op_sel_hi:[1,0,1]
  v_pk_fma_f32 v[226:227], v[226:227], v[96:97], v[86:87] op_sel:[0,0,0] op_sel_hi:[1,0,1]
  v_pk_fma_f32 v[228:229], v[228:229], v[98:99], v[84:85] op_sel:[0,0,0] op_sel_hi:[1,0,1]
  v_pk_fma_f32 v[230:231], v[230:231], v[98:99], v[86:87] op_sel:[0,0,0] op_sel_hi:[1,0,1]
  v_pk_fma_f32 v[104:105], v[224:225], v[224:225], v[4:5] op_sel_hi:[1,1,0]
  v_pk_fma_f32 v[106:107], v[226:227], v[226:227], v[4:5] op_sel_hi:[1,1,0]
  v_pk_fma_f32 v[108:109], v[228:229], v[228:229], v[4:5] op_sel_hi:[1,1,0]
  v_pk_fma_f32 v[110:111], v[230:231], v[230:231], v[4:5] op_sel_hi:[1,1,0]
  v_pk_mul_f32 v[104:105], v[104:105], v[224:225] neg_lo:[0,1] neg_hi:[0,1]
  v_pk_mul_f32 v[106:107], v[106:107], v[226:227] neg_lo:[0,1] neg_hi:[0,1]
  v_pk_mul_f32 v[108:109], v[108:109], v[228:229] neg_lo:[0,1] neg_hi:[0,1]
  v_pk_mul_f32 v[110:111], v[110:111], v[230:231] neg_lo:[0,1] neg_hi:[0,1]
  v_exp_f32 v104, v104
  v_exp_f32 v105, v105
  v_exp_f32 v106, v106
  v_exp_f32 v107, v107
  v_exp_f32 v108, v108
  v_exp_f32 v109, v109
  v_exp_f32 v110, v110
  v_exp_f32 v111, v111
  v_pk_fma_f32 v[104:105], v[104:105], v[4:5], v[4:5] op_sel:[0,1,1] op_sel_hi:[1,1,1]
  v_pk_fma_f32 v[106:107], v[106:107], v[4:5], v[4:5] op_sel:[0,1,1] op_sel_hi:[1,1,1]
  v_pk_fma_f32 v[108:109], v[108:109], v[4:5], v[4:5] op_sel:[0,1,1] op_sel_hi:[1,1,1]
  v_pk_fma_f32 v[110:111], v[110:111], v[4:5], v[4:5] op_sel:[0,1,1] op_sel_hi:[1,1,1]
  v_rcp_f32 v104, v104
  v_rcp_f32 v105, v105
  v_rcp_f32 v106, v106
  v_rcp_f32 v107, v107
  v_rcp_f32 v108, v108
  v_rcp_f32 v109, v109
  v_rcp_f32 v110, v110
  v_rcp_f32 v111, v111
  v_pk_mul_f32 v[224:225], v[224:225], v[104:105]
  v_pk_mul_f32 v[226:227], v[226:227], v[106:107]
  v_pk_mul_f32 v[228:229], v[228:229], v[108:109]
  v_pk_mul_f32 v[230:231], v[230:231], v[110:111]
  v_cvt_pk_bf16_f32 v116, v224, v225
  v_cvt_pk_bf16_f32 v117, v226, v227
  v_cvt_pk_bf16_f32 v118, v228, v229
  v_cvt_pk_bf16_f32 v119, v230, v231
  s_nop 0
  v_permlane32_swap_b32 v116, v118
  v_permlane32_swap_b32_e64 v117, v119
  buffer_store_dwordx4 v[116:119], v6, s[40:43], s8 offen sc0 sc1
  s_add_u32 s8, s8, 4096
  v_pk_fma_f32 v[232:233], v[80:81], v[100:101], v[232:233] op_sel:[0,1,0] op_sel_hi:[1,1,1] neg_lo:[0,1,0] neg_hi:[0,1,0]
  v_pk_fma_f32 v[234:235], v[82:83], v[100:101], v[234:235] op_sel:[0,1,0] op_sel_hi:[1,1,1] neg_lo:[0,1,0] neg_hi:[0,1,0]
  v_pk_fma_f32 v[236:237], v[80:81], v[102:103], v[236:237] op_sel:[0,1,0] op_sel_hi:[1,1,1] neg_lo:[0,1,0] neg_hi:[0,1,0]
  v_pk_fma_f32 v[238:239], v[82:83], v[102:103], v[238:239] op_sel:[0,1,0] op_sel_hi:[1,1,1] neg_lo:[0,1,0] neg_hi:[0,1,0]
  v_pk_fma_f32 v[232:233], v[232:233], v[100:101], v[84:85] op_sel:[0,0,0] op_sel_hi:[1,0,1]
  v_pk_fma_f32 v[234:235], v[234:235], v[100:101], v[86:87] op_sel:[0,0,0] op_sel_hi:[1,0,1]
  v_pk_fma_f32 v[236:237], v[236:237], v[102:103], v[84:85] op_sel:[0,0,0] op_sel_hi:[1,0,1]
  v_pk_fma_f32 v[238:239], v[238:239], v[102:103], v[86:87] op_sel:[0,0,0] op_sel_hi:[1,0,1]
  v_pk_fma_f32 v[104:105], v[232:233], v[232:233], v[4:5] op_sel_hi:[1,1,0]
  v_pk_fma_f32 v[106:107], v[234:235], v[234:235], v[4:5] op_sel_hi:[1,1,0]
  v_pk_fma_f32 v[108:109], v[236:237], v[236:237], v[4:5] op_sel_hi:[1,1,0]
  v_pk_fma_f32 v[110:111], v[238:239], v[238:239], v[4:5] op_sel_hi:[1,1,0]
  v_pk_mul_f32 v[104:105], v[104:105], v[232:233] neg_lo:[0,1] neg_hi:[0,1]
  v_pk_mul_f32 v[106:107], v[106:107], v[234:235] neg_lo:[0,1] neg_hi:[0,1]
  v_pk_mul_f32 v[108:109], v[108:109], v[236:237] neg_lo:[0,1] neg_hi:[0,1]
  v_pk_mul_f32 v[110:111], v[110:111], v[238:239] neg_lo:[0,1] neg_hi:[0,1]
  v_exp_f32 v104, v104
  v_exp_f32 v105, v105
  v_exp_f32 v106, v106
  v_exp_f32 v107, v107
  v_exp_f32 v108, v108
  v_exp_f32 v109, v109
  v_exp_f32 v110, v110
  v_exp_f32 v111, v111
  v_pk_fma_f32 v[104:105], v[104:105], v[4:5], v[4:5] op_sel:[0,1,1] op_sel_hi:[1,1,1]
  v_pk_fma_f32 v[106:107], v[106:107], v[4:5], v[4:5] op_sel:[0,1,1] op_sel_hi:[1,1,1]
  v_pk_fma_f32 v[108:109], v[108:109], v[4:5], v[4:5] op_sel:[0,1,1] op_sel_hi:[1,1,1]
  v_pk_fma_f32 v[110:111], v[110:111], v[4:5], v[4:5] op_sel:[0,1,1] op_sel_hi:[1,1,1]
  v_rcp_f32 v104, v104
  v_rcp_f32 v105, v105
  v_rcp_f32 v106, v106
  v_rcp_f32 v107, v107
  v_rcp_f32 v108, v108
  v_rcp_f32 v109, v109
  v_rcp_f32 v110, v110
  v_rcp_f32 v111, v111
  v_pk_mul_f32 v[232:233], v[232:233], v[104:105]
  v_pk_mul_f32 v[234:235], v[234:235], v[106:107]
  v_pk_mul_f32 v[236:237], v[236:237], v[108:109]
  v_pk_mul_f32 v[238:239], v[238:239], v[110:111]
  v_cvt_pk_bf16_f32 v120, v232, v233
  v_cvt_pk_bf16_f32 v121, v234, v235
  v_cvt_pk_bf16_f32 v122, v236, v237
  v_cvt_pk_bf16_f32 v123, v238, v239
  s_add_u32 s9, s87, Lz1-Lz0+8
  s_waitcnt vmcnt(1)
  s_mov_b64 exec, 1
  ds_add_rtn_u32 v124, v28, v27 offset:0
  s_mov_b64 exec, -1
  v_permlane32_swap_b32 v120, v122
  v_permlane32_swap_b32_e64 v121, v123
  buffer_store_dwordx4 v[120:123], v6, s[40:43], s8 offen sc0 sc1
  v_pk_fma_f32 v[160:161], v[48:49], v[96:97], v[160:161] op_sel:[0,1,0] op_sel_hi:[1,1,1] neg_lo:[0,1,0] neg_hi:[0,1,0]
  v_pk_fma_f32 v[162:163], v[50:51], v[96:97], v[162:163] op_sel:[0,1,0] op_sel_hi:[1,1,1] neg_lo:[0,1,0] neg_hi:[0,1,0]
  v_pk_fma_f32 v[176:177], v[56:57], v[96:97], v[176:177] op_sel:[0,1,0] op_sel_hi:[1,1,1] neg_lo:[0,1,0] neg_hi:[0,1,0]
  v_pk_fma_f32 v[178:179], v[58:59], v[96:97], v[178:179] op_sel:[0,1,0] op_sel_hi:[1,1,1] neg_lo:[0,1,0] neg_hi:[0,1,0]
  v_pk_fma_f32 v[160:161], v[160:161], v[96:97], v[52:53] op_sel:[0,0,0] op_sel_hi:[1,0,1]
  v_pk_fma_f32 v[162:163], v[162:163], v[96:97], v[54:55] op_sel:[0,0,0] op_sel_hi:[1,0,1]
  v_pk_fma_f32 v[176:177], v[176:177], v[96:97], v[60:61] op_sel:[0,0,0] op_sel_hi:[1,0,1]
  v_pk_fma_f32 v[178:179], v[178:179], v[96:97], v[62:63] op_sel:[0,0,0] op_sel_hi:[1,0,1]
  v_pk_fma_f32 v[104:105], v[160:161], v[160:161], v[4:5] op_sel_hi:[1,1,0]
  v_pk_fma_f32 v[106:107], v[162:163], v[162:163], v[4:5] op_sel_hi:[1,1,0]
  v_pk_fma_f32 v[108:109], v[176:177], v[176:177], v[4:5] op_sel_hi:[1,1,0]
  v_pk_fma_f32 v[110:111], v[178:179], v[178:179], v[4:5] op_sel_hi:[1,1,0]
  v_pk_mul_f32 v[104:105], v[104:105], v[160:161] neg_lo:[0,1] neg_hi:[0,1]
  v_pk_mul_f32 v[106:107], v[106:107], v[162:163] neg_lo:[0,1] neg_hi:[0,1]
  v_pk_mul_f32 v[108:109], v[108:109], v[176:177] neg_lo:[0,1] neg_hi:[0,1]
  v_pk_mul_f32 v[110:111], v[110:111], v[178:179] neg_lo:[0,1] neg_hi:[0,1]
  v_exp_f32 v104, v104
  v_exp_f32 v105, v105
  v_exp_f32 v106, v106
  v_exp_f32 v107, v107
  v_exp_f32 v108, v108
  v_exp_f32 v109, v109
  v_exp_f32 v110, v110
  v_exp_f32 v111, v111
  v_pk_fma_f32 v[104:105], v[104:105], v[4:5], v[4:5] op_sel:[0,1,1] op_sel_hi:[1,1,1]
  v_pk_fma_f32 v[106:107], v[106:107], v[4:5], v[4:5] op_sel:[0,1,1] op_sel_hi:[1,1,1]
  v_pk_fma_f32 v[108:109], v[108:109], v[4:5], v[4:5] op_sel:[0,1,1] op_sel_hi:[1,1,1]
  v_pk_fma_f32 v[110:111], v[110:111], v[4:5], v[4:5] op_sel:[0,1,1] op_sel_hi:[1,1,1]
  v_rcp_f32 v104, v104
  v_rcp_f32 v105, v105
  v_rcp_f32 v106, v106
  v_rcp_f32 v107, v107
  v_rcp_f32 v108, v108
  v_rcp_f32 v109, v109
  v_rcp_f32 v110, v110
  v_rcp_f32 v111, v111
  v_pk_mul_f32 v[160:161], v[160:161], v[104:105]
  v_pk_mul_f32 v[162:163], v[162:163], v[106:107]
  v_pk_mul_f32 v[176:177], v[176:177], v[108:109]
  v_pk_mul_f32 v[178:179], v[178:179], v[110:111]
  v_cvt_pk_bf16_f32 v116, v160, v161
  v_cvt_pk_bf16_f32 v117, v162, v163
  v_cvt_pk_bf16_f32 v118, v176, v177
  v_cvt_pk_bf16_f32 v119, v178, v179
  s_waitcnt lgkmcnt(0)
  v_readfirstlane_b32 s4, v124
  s_and_b32 s4, s4, 3
  s_cmp_lg_u32 s4, 3
  s_cbranch_scc1 Ls_28
  s_mov_b32 exec_lo, s10
  s_mov_b32 exec_hi, 0
  buffer_store_dword v27, v24, s[40:43], s9 offen sc0 sc1
Ls_28:
  s_mov_b64 exec, -1
  buffer_store_dwordx4 v[116:119], v0, s[40:43], s6 offen offset:0 sc0 sc1
  ds_write_b128 v0, v[116:119] offset:16384
  v_pk_fma_f32 v[164:165], v[48:49], v[98:99], v[164:165] op_sel:[0,1,0] op_sel_hi:[1,1,1] neg_lo:[0,1,0] neg_hi:[0,1,0]
  v_pk_fma_f32 v[166:167], v[50:51], v[98:99], v[166:167] op_sel:[0,1,0] op_sel_hi:[1,1,1] neg_lo:[0,1,0] neg_hi:[0,1,0]
  v_pk_fma_f32 v[180:181], v[56:57], v[98:99], v[180:181] op_sel:[0,1,0] op_sel_hi:[1,1,1] neg_lo:[0,1,0] neg_hi:[0,1,0]
  v_pk_fma_f32 v[182:183], v[58:59], v[98:99], v[182:183] op_sel:[0,1,0] op_sel_hi:[1,1,1] neg_lo:[0,1,0] neg_hi:[0,1,0]
  v_pk_fma_f32 v[164:165], v[164:165], v[98:99], v[52:53] op_sel:[0,0,0] op_sel_hi:[1,0,1]
  v_pk_fma_f32 v[166:167], v[166:167], v[98:99], v[54:55] op_sel:[0,0,0] op_sel_hi:[1,0,1]
  v_pk_fma_f32 v[180:181], v[180:181], v[98:99], v[60:61] op_sel:[0,0,0] op_sel_hi:[1,0,1]
  v_pk_fma_f32 v[182:183], v[182:183], v[98:99], v[62:63] op_sel:[0,0,0] op_sel_hi:[1,0,1]
  v_pk_fma_f32 v[104:105], v[164:165], v[164:165], v[4:5] op_sel_hi:[1,1,0]
  v_pk_fma_f32 v[106:107], v[166:167], v[166:167], v[4:5] op_sel_hi:[1,1,0]
  v_pk_fma_f32 v[108:109], v[180:181], v[180:181], v[4:5] op_sel_hi:[1,1,0]
  v_pk_fma_f32 v[110:111], v[182:183], v[182:183], v[4:5] op_sel_hi:[1,1,0]
  v_pk_mul_f32 v[104:105], v[104:105], v[164:165] neg_lo:[0,1] neg_hi:[0,1]
  v_pk_mul_f32 v[106:107], v[106:107], v[166:167] neg_lo:[0,1] neg_hi:[0,1]
  v_pk_mul_f32 v[108:109], v[108:109], v[180:181] neg_lo:[0,1] neg_hi:[0,1]
  v_pk_mul_f32 v[110:111], v[110:111], v[182:183] neg_lo:[0,1] neg_hi:[0,1]
  v_exp_f32 v104, v104
  v_exp_f32 v105, v105
  v_exp_f32 v106, v106
  v_exp_f32 v107, v107
  v_exp_f32 v108, v108
  v_exp_f32 v109, v109
  v_exp_f32 v110, v110
  v_exp_f32 v111, v111
  v_pk_fma_f32 v[104:105], v[104:105], v[4:5], v[4:5] op_sel:[0,1,1] op_sel_hi:[1,1,1]
  v_pk_fma_f32 v[106:107], v[106:107], v[4:5], v[4:5] op_sel:[0,1,1] op_sel_hi:[1,1,1]
  v_pk_fma_f32 v[108:109], v[108:109], v[4:5], v[4:5] op_sel:[0,1,1] op_sel_hi:[1,1,1]
  v_pk_fma_f32 v[110:111], v[110:111], v[4:5], v[4:5] op_sel:[0,1,1] op_sel_hi:[1,1,1]
  v_rcp_f32 v104, v104
  v_rcp_f32 v105, v105
  v_rcp_f32 v106, v106
  v_rcp_f32 v107, v107
  v_rcp_f32 v108, v108
  v_rcp_f32 v109, v109
  v_rcp_f32 v110, v110
  v_rcp_f32 v111, v111
  v_pk_mul_f32 v[164:165], v[164:165], v[104:105]
  v_pk_mul_f32 v[166:167], v[166:167], v[106:107]
  v_pk_mul_f32 v[180:181], v[180:181], v[108:109]
  v_pk_mul_f32 v[182:183], v[182:183], v[110:111]
  v_cvt_pk_bf16_f32 v120, v164, v165
  v_cvt_pk_bf16_f32 v121, v166, v167
  v_cvt_pk_bf16_f32 v122, v180, v181
  v_cvt_pk_bf16_f32 v123, v182, v183
  buffer_store_dwordx4 v[120:123], v0, s[40:43], s6 offen offset:2048 sc0 sc1
  ds_write_b128 v0, v[120:123] offset:18432
  s_add_u32 s6, s6, 0x20000
  v_pk_fma_f32 v[168:169], v[48:49], v[100:101], v[168:169] op_sel:[0,1,0] op_sel_hi:[1,1,1] neg_lo:[0,1,0] neg_hi:[0,1,0]
  v_pk_fma_f32 v[170:171], v[50:51], v[100:101], v[170:171] op_sel:[0,1,0] op_sel_hi:[1,1,1] neg_lo:[0,1,0] neg_hi:[0,1,0]
  v_pk_fma_f32 v[184:185], v[56:57], v[100:101], v[184:185] op_sel:[0,1,0] op_sel_hi:[1,1,1] neg_lo:[0,1,0] neg_hi:[0,1,0]
  v_pk_fma_f32 v[186:187], v[58:59], v[100:101], v[186:187] op_sel:[0,1,0] op_sel_hi:[1,1,1] neg_lo:[0,1,0] neg_hi:[0,1,0]
  v_pk_fma_f32 v[168:169], v[168:169], v[100:101], v[52:53] op_sel:[0,0,0] op_sel_hi:[1,0,1]
  v_pk_fma_f32 v[170:171], v[170:171], v[100:101], v[54:55] op_sel:[0,0,0] op_sel_hi:[1,0,1]
  v_pk_fma_f32 v[184:185], v[184:185], v[100:101], v[60:61] op_sel:[0,0,0] op_sel_hi:[1,0,1]
  v_pk_fma_f32 v[186:187], v[186:187], v[100:101], v[62:63] op_sel:[0,0,0] op_sel_hi:[1,0,1]
  v_pk_fma_f32 v[104:105], v[168:169], v[168:169], v[4:5] op_sel_hi:[1,1,0]
  v_pk_fma_f32 v[106:107], v[170:171], v[170:171], v[4:5] op_sel_hi:[1,1,0]
  v_pk_fma_f32 v[108:109], v[184:185], v[184:185], v[4:5] op_sel_hi:[1,1,0]
  v_pk_fma_f32 v[110:111], v[186:187], v[186:187], v[4:5] op_sel_hi:[1,1,0]
  v_pk_mul_f32 v[104:105], v[104:105], v[168:169] neg_lo:[0,1] neg_hi:[0,1]
  v_pk_mul_f32 v[106:107], v[106:107], v[170:171] neg_lo:[0,1] neg_hi:[0,1]
  v_pk_mul_f32 v[108:109], v[108:109], v[184:185] neg_lo:[0,1] neg_hi:[0,1]
  v_pk_mul_f32 v[110:111], v[110:111], v[186:187] neg_lo:[0,1] neg_hi:[0,1]
  v_exp_f32 v104, v104
  v_exp_f32 v105, v105
  v_exp_f32 v106, v106
  v_exp_f32 v107, v107
  v_exp_f32 v108, v108
  v_exp_f32 v109, v109
  v_exp_f32 v110, v110
  v_exp_f32 v111, v111
  v_pk_fma_f32 v[104:105], v[104:105], v[4:5], v[4:5] op_sel:[0,1,1] op_sel_hi:[1,1,1]
  v_pk_fma_f32 v[106:107], v[106:107], v[4:5], v[4:5] op_sel:[0,1,1] op_sel_hi:[1,1,1]
  v_pk_fma_f32 v[108:109], v[108:109], v[4:5], v[4:5] op_sel:[0,1,1] op_sel_hi:[1,1,1]
  v_pk_fma_f32 v[110:111], v[110:111], v[4:5], v[4:5] op_sel:[0,1,1] op_sel_hi:[1,1,1]
  v_rcp_f32 v104, v104
  v_rcp_f32 v105, v105
  v_rcp_f32 v106, v106
  v_rcp_f32 v107, v107
  v_rcp_f32 v108, v108
  v_rcp_f32 v109, v109
  v_rcp_f32 v110, v110
  v_rcp_f32 v111, v111
  v_pk_mul_f32 v[168:169], v[168:169], v[104:105]
  v_pk_mul_f32 v[170:171], v[170:171], v[106:107]
  v_pk_mul_f32 v[184:185], v[184:185], v[108:109]
  v_pk_mul_f32 v[186:187], v[186:187], v[110:111]
  v_cvt_pk_bf16_f32 v116, v168, v169
  v_cvt_pk_bf16_f32 v117, v170, v171
  v_cvt_pk_bf16_f32 v118, v184, v185
  v_cvt_pk_bf16_f32 v119, v186, v187
  buffer_store_dwordx4 v[116:119], v0, s[40:43], s7 offen offset:0 sc0 sc1
  ds_write_b128 v0, v[116:119] offset:20480
  v_pk_fma_f32 v[172:173], v[48:49], v[102:103], v[172:173] op_sel:[0,1,0] op_sel_hi:[1,1,1] neg_lo:[0,1,0] neg_hi:[0,1,0]
  v_pk_fma_f32 v[174:175], v[50:51], v[102:103], v[174:175] op_sel:[0,1,0] op_sel_hi:[1,1,1] neg_lo:[0,1,0] neg_hi:[0,1,0]
  v_pk_fma_f32 v[188:189], v[56:57], v[102:103], v[188:189] op_sel:[0,1,0] op_sel_hi:[1,1,1] neg_lo:[0,1,0] neg_hi:[0,1,0]
  v_pk_fma_f32 v[190:191], v[58:59], v[102:103], v[190:191] op_sel:[0,1,0] op_sel_hi:[1,1,1] neg_lo:[0,1,0] neg_hi:[0,1,0]
  v_pk_fma_f32 v[172:173], v[172:173], v[102:103], v[52:53] op_sel:[0,0,0] op_sel_hi:[1,0,1]
  v_pk_fma_f32 v[174:175], v[174:175], v[102:103], v[54:55] op_sel:[0,0,0] op_sel_hi:[1,0,1]
  v_pk_fma_f32 v[188:189], v[188:189], v[102:103], v[60:61] op_sel:[0,0,0] op_sel_hi:[1,0,1]
  v_pk_fma_f32 v[190:191], v[190:191], v[102:103], v[62:63] op_sel:[0,0,0] op_sel_hi:[1,0,1]
  v_pk_fma_f32 v[104:105], v[172:173], v[172:173], v[4:5] op_sel_hi:[1,1,0]
  v_pk_fma_f32 v[106:107], v[174:175], v[174:175], v[4:5] op_sel_hi:[1,1,0]
  v_pk_fma_f32 v[108:109], v[188:189], v[188:189], v[4:5] op_sel_hi:[1,1,0]
  v_pk_fma_f32 v[110:111], v[190:191], v[190:191], v[4:5] op_sel_hi:[1,1,0]
  v_pk_mul_f32 v[104:105], v[104:105], v[172:173] neg_lo:[0,1] neg_hi:[0,1]
  v_pk_mul_f32 v[106:107], v[106:107], v[174:175] neg_lo:[0,1] neg_hi:[0,1]
  v_pk_mul_f32 v[108:109], v[108:109], v[188:189] neg_lo:[0,1] neg_hi:[0,1]
  v_pk_mul_f32 v[110:111], v[110:111], v[190:191] neg_lo:[0,1] neg_hi:[0,1]
  v_exp_f32 v104, v104
  v_exp_f32 v105, v105
  v_exp_f32 v106, v106
  v_exp_f32 v107, v107
  v_exp_f32 v108, v108
  v_exp_f32 v109, v109
  v_exp_f32 v110, v110
  v_exp_f32 v111, v111
  v_pk_fma_f32 v[104:105], v[104:105], v[4:5], v[4:5] op_sel:[0,1,1] op_sel_hi:[1,1,1]
  v_pk_fma_f32 v[106:107], v[106:107], v[4:5], v[4:5] op_sel:[0,1,1] op_sel_hi:[1,1,1]
  v_pk_fma_f32 v[108:109], v[108:109], v[4:5], v[4:5] op_sel:[0,1,1] op_sel_hi:[1,1,1]
  v_pk_fma_f32 v[110:111], v[110:111], v[4:5], v[4:5] op_sel:[0,1,1] op_sel_hi:[1,1,1]
  v_rcp_f32 v104, v104
  v_rcp_f32 v105, v105
  v_rcp_f32 v106, v106
  v_rcp_f32 v107, v107
  v_rcp_f32 v108, v108
  v_rcp_f32 v109, v109
  v_rcp_f32 v110, v110
  v_rcp_f32 v111, v111
  v_pk_mul_f32 v[172:173], v[172:173], v[104:105]
  v_pk_mul_f32 v[174:175], v[174:175], v[106:107]
  v_pk_mul_f32 v[188:189], v[188:189], v[108:109]
  v_pk_mul_f32 v[190:191], v[190:191], v[110:111]
  v_cvt_pk_bf16_f32 v120, v172, v173
  v_cvt_pk_bf16_f32 v121, v174, v175
  v_cvt_pk_bf16_f32 v122, v188, v189
  v_cvt_pk_bf16_f32 v123, v190, v191
  buffer_store_dwordx4 v[120:123], v0, s[40:43], s7 offen offset:2048 sc0 sc1
  ds_write_b128 v0, v[120:123] offset:22528
  s_add_u32 s7, s7, 0x20000
  v_pk_fma_f32 v[192:193], v[64:65], v[96:97], v[192:193] op_sel:[0,1,0] op_sel_hi:[1,1,1] neg_lo:[0,1,0] neg_hi:[0,1,0]
  v_pk_fma_f32 v[194:195], v[66:67], v[96:97], v[194:195] op_sel:[0,1,0] op_sel_hi:[1,1,1] neg_lo:[0,1,0] neg_hi:[0,1,0]
  v_pk_fma_f32 v[208:209], v[72:73], v[96:97], v[208:209] op_sel:[0,1,0] op_sel_hi:[1,1,1] neg_lo:[0,1,0] neg_hi:[0,1,0]
  v_pk_fma_f32 v[210:211], v[74:75], v[96:97], v[210:211] op_sel:[0,1,0] op_sel_hi:[1,1,1] neg_lo:[0,1,0] neg_hi:[0,1,0]
  v_pk_fma_f32 v[192:193], v[192:193], v[96:97], v[68:69] op_sel:[0,0,0] op_sel_hi:[1,0,1]
  v_pk_fma_f32 v[194:195], v[194:195], v[96:97], v[70:71] op_sel:[0,0,0] op_sel_hi:[1,0,1]
  v_pk_fma_f32 v[208:209], v[208:209], v[96:97], v[76:77] op_sel:[0,0,0] op_sel_hi:[1,0,1]
  v_pk_fma_f32 v[210:211], v[210:211], v[96:97], v[78:79] op_sel:[0,0,0] op_sel_hi:[1,0,1]
  v_pk_fma_f32 v[104:105], v[192:193], v[192:193], v[4:5] op_sel_hi:[1,1,0]
  v_pk_fma_f32 v[106:107], v[194:195], v[194:195], v[4:5] op_sel_hi:[1,1,0]
  v_pk_fma_f32 v[108:109], v[208:209], v[208:209], v[4:5] op_sel_hi:[1,1,0]
  v_pk_fma_f32 v[110:111], v[210:211], v[210:211], v[4:5] op_sel_hi:[1,1,0]
  v_pk_mul_f32 v[104:105], v[104:105], v[192:193] neg_lo:[0,1] neg_hi:[0,1]
  v_pk_mul_f32 v[106:107], v[106:107], v[194:195] neg_lo:[0,1] neg_hi:[0,1]
  v_pk_mul_f32 v[108:109], v[108:109], v[208:209] neg_lo:[0,1] neg_hi:[0,1]
  v_pk_mul_f32 v[110:111], v[110:111], v[210:211] neg_lo:[0,1] neg_hi:[0,1]
  v_exp_f32 v104, v104
  v_exp_f32 v105, v105
  v_exp_f32 v106, v106
  v_exp_f32 v107, v107
  v_exp_f32 v108, v108
  v_exp_f32 v109, v109
  v_exp_f32 v110, v110
  v_exp_f32 v111, v111
  v_pk_fma_f32 v[104:105], v[104:105], v[4:5], v[4:5] op_sel:[0,1,1] op_sel_hi:[1,1,1]
  v_pk_fma_f32 v[106:107], v[106:107], v[4:5], v[4:5] op_sel:[0,1,1] op_sel_hi:[1,1,1]
  v_pk_fma_f32 v[108:109], v[108:109], v[4:5], v[4:5] op_sel:[0,1,1] op_sel_hi:[1,1,1]
  v_pk_fma_f32 v[110:111], v[110:111], v[4:5], v[4:5] op_sel:[0,1,1] op_sel_hi:[1,1,1]
  v_rcp_f32 v104, v104
  v_rcp_f32 v105, v105
  v_rcp_f32 v106, v106
  v_rcp_f32 v107, v107
  v_rcp_f32 v108, v108
  v_rcp_f32 v109, v109
  v_rcp_f32 v110, v110
  v_rcp_f32 v111, v111
  v_pk_mul_f32 v[192:193], v[192:193], v[104:105]
  v_pk_mul_f32 v[194:195], v[194:195], v[106:107]
  v_pk_mul_f32 v[208:209], v[208:209], v[108:109]
  v_pk_mul_f32 v[210:211], v[210:211], v[110:111]
  v_cvt_pk_bf16_f32 v116, v192, v193
  v_cvt_pk_bf16_f32 v117, v194, v195
  v_cvt_pk_bf16_f32 v118, v208, v209
  v_cvt_pk_bf16_f32 v119, v210, v211
  buffer_store_dwordx4 v[116:119], v0, s[40:43], s6 offen offset:0 sc0 sc1
  ds_write_b128 v0, v[116:119] offset:32768
  v_pk_fma_f32 v[196:197], v[64:65], v[98:99], v[196:197] op_sel:[0,1,0] op_sel_hi:[1,1,1] neg_lo:[0,1,0] neg_hi:[0,1,0]
  v_pk_fma_f32 v[198:199], v[66:67], v[98:99], v[198:199] op_sel:[0,1,0] op_sel_hi:[1,1,1] neg_lo:[0,1,0] neg_hi:[0,1,0]
  v_pk_fma_f32 v[212:213], v[72:73], v[98:99], v[212:213] op_sel:[0,1,0] op_sel_hi:[1,1,1] neg_lo:[0,1,0] neg_hi:[0,1,0]
  v_pk_fma_f32 v[214:215], v[74:75], v[98:99], v[214:215] op_sel:[0,1,0] op_sel_hi:[1,1,1] neg_lo:[0,1,0] neg_hi:[0,1,0]
  v_pk_fma_f32 v[196:197], v[196:197], v[98:99], v[68:69] op_sel:[0,0,0] op_sel_hi:[1,0,1]
  v_pk_fma_f32 v[198:199], v[198:199], v[98:99], v[70:71] op_sel:[0,0,0] op_sel_hi:[1,0,1]
  v_pk_fma_f32 v[212:213], v[212:213], v[98:99], v[76:77] op_sel:[0,0,0] op_sel_hi:[1,0,1]
  v_pk_fma_f32 v[214:215], v[214:215], v[98:99], v[78:79] op_sel:[0,0,0] op_sel_hi:[1,0,1]
  v_pk_fma_f32 v[104:105], v[196:197], v[196:197], v[4:5] op_sel_hi:[1,1,0]
  v_pk_fma_f32 v[106:107], v[198:199], v[198:199], v[4:5] op_sel_hi:[1,1,0]
  v_pk_fma_f32 v[108:109], v[212:213], v[212:213], v[4:5] op_sel_hi:[1,1,0]
  v_pk_fma_f32 v[110:111], v[214:215], v[214:215], v[4:5] op_sel_hi:[1,1,0]
  v_pk_mul_f32 v[104:105], v[104:105], v[196:197] neg_lo:[0,1] neg_hi:[0,1]
  v_pk_mul_f32 v[106:107], v[106:107], v[198:199] neg_lo:[0,1] neg_hi:[0,1]
  v_pk_mul_f32 v[108:109], v[108:109], v[212:213] neg_lo:[0,1] neg_hi:[0,1]
  v_pk_mul_f32 v[110:111], v[110:111], v[214:215] neg_lo:[0,1] neg_hi:[0,1]
  v_exp_f32 v104, v104
  v_exp_f32 v105, v105
  v_exp_f32 v106, v106
  v_exp_f32 v107, v107
  v_exp_f32 v108, v108
  v_exp_f32 v109, v109
  v_exp_f32 v110, v110
  v_exp_f32 v111, v111
  v_pk_fma_f32 v[104:105], v[104:105], v[4:5], v[4:5] op_sel:[0,1,1] op_sel_hi:[1,1,1]
  v_pk_fma_f32 v[106:107], v[106:107], v[4:5], v[4:5] op_sel:[0,1,1] op_sel_hi:[1,1,1]
  v_pk_fma_f32 v[108:109], v[108:109], v[4:5], v[4:5] op_sel:[0,1,1] op_sel_hi:[1,1,1]
  v_pk_fma_f32 v[110:111], v[110:111], v[4:5], v[4:5] op_sel:[0,1,1] op_sel_hi:[1,1,1]
  v_rcp_f32 v104, v104
  v_rcp_f32 v105, v105
  v_rcp_f32 v106, v106
  v_rcp_f32 v107, v107
  v_rcp_f32 v108, v108
  v_rcp_f32 v109, v109
  v_rcp_f32 v110, v110
  v_rcp_f32 v111, v111
  v_pk_mul_f32 v[196:197], v[196:197], v[104:105]
  v_pk_mul_f32 v[198:199], v[198:199], v[106:107]
  v_pk_mul_f32 v[212:213], v[212:213], v[108:109]
  v_pk_mul_f32 v[214:215], v[214:215], v[110:111]
  v_cvt_pk_bf16_f32 v120, v196, v197
  v_cvt_pk_bf16_f32 v121, v198, v199
  v_cvt_pk_bf16_f32 v122, v212, v213
  v_cvt_pk_bf16_f32 v123, v214, v215
  buffer_store_dwordx4 v[120:123], v0, s[40:43], s6 offen offset:2048 sc0 sc1
  ds_write_b128 v0, v[120:123] offset:34816
  s_mov_b64 exec, 1
  ds_add_u32 v28, v27 offset:4
  s_mov_b64 exec, -1
  v_pk_fma_f32 v[200:201], v[64:65], v[100:101], v[200:201] op_sel:[0,1,0] op_sel_hi:[1,1,1] neg_lo:[0,1,0] neg_hi:[0,1,0]
  v_pk_fma_f32 v[202:203], v[66:67], v[100:101], v[202:203] op_sel:[0,1,0] op_sel_hi:[1,1,1] neg_lo:[0,1,0] neg_hi:[0,1,0]
  v_pk_fma_f32 v[216:217], v[72:73], v[100:101], v[216:217] op_sel:[0,1,0] op_sel_hi:[1,1,1] neg_lo:[0,1,0] neg_hi:[0,1,0]
  v_pk_fma_f32 v[218:219], v[74:75], v[100:101], v[218:219] op_sel:[0,1,0] op_sel_hi:[1,1,1] neg_lo:[0,1,0] neg_hi:[0,1,0]
  v_pk_fma_f32 v[200:201], v[200:201], v[100:101], v[68:69] op_sel:[0,0,0] op_sel_hi:[1,0,1]
  v_pk_fma_f32 v[202:203], v[202:203], v[100:101], v[70:71] op_sel:[0,0,0] op_sel_hi:[1,0,1]
  v_pk_fma_f32 v[216:217], v[216:217], v[100:101], v[76:77] op_sel:[0,0,0] op_sel_hi:[1,0,1]
  v_pk_fma_f32 v[218:219], v[218:219], v[100:101], v[78:79] op_sel:[0,0,0] op_sel_hi:[1,0,1]
  v_pk_fma_f32 v[104:105], v[200:201], v[200:201], v[4:5] op_sel_hi:[1,1,0]
  v_pk_fma_f32 v[106:107], v[202:203], v[202:203], v[4:5] op_sel_hi:[1,1,0]
  v_pk_fma_f32 v[108:109], v[216:217], v[216:217], v[4:5] op_sel_hi:[1,1,0]
  v_pk_fma_f32 v[110:111], v[218:219], v[218:219], v[4:5] op_sel_hi:[1,1,0]
  v_pk_mul_f32 v[104:105], v[104:105], v[200:201] neg_lo:[0,1] neg_hi:[0,1]
  v_pk_mul_f32 v[106:107], v[106:107], v[202:203] neg_lo:[0,1] neg_hi:[0,1]
  v_pk_mul_f32 v[108:109], v[108:109], v[216:217] neg_lo:[0,1] neg_hi:[0,1]
  v_pk_mul_f32 v[110:111], v[110:111], v[218:219] neg_lo:[0,1] neg_hi:[0,1]
  v_exp_f32 v104, v104
  v_exp_f32 v105, v105
  v_exp_f32 v106, v106
  v_exp_f32 v107, v107
  v_exp_f32 v108, v108
  v_exp_f32 v109, v109
  v_exp_f32 v110, v110
  v_exp_f32 v111, v111
  v_pk_fma_f32 v[104:105], v[104:105], v[4:5], v[4:5] op_sel:[0,1,1] op_sel_hi:[1,1,1]
  v_pk_fma_f32 v[106:107], v[106:107], v[4:5], v[4:5] op_sel:[0,1,1] op_sel_hi:[1,1,1]
  v_pk_fma_f32 v[108:109], v[108:109], v[4:5], v[4:5] op_sel:[0,1,1] op_sel_hi:[1,1,1]
  v_pk_fma_f32 v[110:111], v[110:111], v[4:5], v[4:5] op_sel:[0,1,1] op_sel_hi:[1,1,1]
  v_rcp_f32 v104, v104
  v_rcp_f32 v105, v105
  v_rcp_f32 v106, v106
  v_rcp_f32 v107, v107
  v_rcp_f32 v108, v108
  v_rcp_f32 v109, v109
  v_rcp_f32 v110, v110
  v_rcp_f32 v111, v111
  v_pk_mul_f32 v[200:201], v[200:201], v[104:105]
  v_pk_mul_f32 v[202:203], v[202:203], v[106:107]
  v_pk_mul_f32 v[216:217], v[216:217], v[108:109]
  v_pk_mul_f32 v[218:219], v[218:219], v[110:111]
  v_cvt_pk_bf16_f32 v116, v200, v201
  v_cvt_pk_bf16_f32 v117, v202, v203
  v_cvt_pk_bf16_f32 v118, v216, v217
  v_cvt_pk_bf16_f32 v119, v218, v219
  buffer_store_dwordx4 v[116:119], v0, s[40:43], s7 offen offset:0 sc0 sc1
  ds_write_b128 v0, v[116:119] offset:36864
  s_lshl_b32 s5, s86, Lz1-Lz0+7
  s_add_u32 s5, s5, 156160
  v_add_u32_e64 v3, s5, v29
  ds_read_b128 v[232:235], v3
  ds_read_b128 v[236:239], v3 offset:64
  v_pk_fma_f32 v[204:205], v[64:65], v[102:103], v[204:205] op_sel:[0,1,0] op_sel_hi:[1,1,1] neg_lo:[0,1,0] neg_hi:[0,1,0]
  v_pk_fma_f32 v[206:207], v[66:67], v[102:103], v[206:207] op_sel:[0,1,0] op_sel_hi:[1,1,1] neg_lo:[0,1,0] neg_hi:[0,1,0]
  v_pk_fma_f32 v[220:221], v[72:73], v[102:103], v[220:221] op_sel:[0,1,0] op_sel_hi:[1,1,1] neg_lo:[0,1,0] neg_hi:[0,1,0]
  v_pk_fma_f32 v[222:223], v[74:75], v[102:103], v[222:223] op_sel:[0,1,0] op_sel_hi:[1,1,1] neg_lo:[0,1,0] neg_hi:[0,1,0]
  v_pk_fma_f32 v[204:205], v[204:205], v[102:103], v[68:69] op_sel:[0,0,0] op_sel_hi:[1,0,1]
  v_pk_fma_f32 v[206:207], v[206:207], v[102:103], v[70:71] op_sel:[0,0,0] op_sel_hi:[1,0,1]
  v_pk_fma_f32 v[220:221], v[220:221], v[102:103], v[76:77] op_sel:[0,0,0] op_sel_hi:[1,0,1]
  v_pk_fma_f32 v[222:223], v[222:223], v[102:103], v[78:79] op_sel:[0,0,0] op_sel_hi:[1,0,1]
  v_pk_fma_f32 v[104:105], v[204:205], v[204:205], v[4:5] op_sel_hi:[1,1,0]
  v_pk_fma_f32 v[106:107], v[206:207], v[206:207], v[4:5] op_sel_hi:[1,1,0]
  v_pk_fma_f32 v[108:109], v[220:221], v[220:221], v[4:5] op_sel_hi:[1,1,0]
  v_pk_fma_f32 v[110:111], v[222:223], v[222:223], v[4:5] op_sel_hi:[1,1,0]
  v_pk_mul_f32 v[104:105], v[104:105], v[204:205] neg_lo:[0,1] neg_hi:[0,1]
  v_pk_mul_f32 v[106:107], v[106:107], v[206:207] neg_lo:[0,1] neg_hi:[0,1]
  v_pk_mul_f32 v[108:109], v[108:109], v[220:221] neg_lo:[0,1] neg_hi:[0,1]
  v_pk_mul_f32 v[110:111], v[110:111], v[222:223] neg_lo:[0,1] neg_hi:[0,1]
  v_exp_f32 v104, v104
  v_exp_f32 v105, v105
  v_exp_f32 v106, v106
  v_exp_f32 v107, v107
  v_exp_f32 v108, v108
  v_exp_f32 v109, v109
  v_exp_f32 v110, v110
  v_exp_f32 v111, v111
  v_pk_fma_f32 v[104:105], v[104:105], v[4:5], v[4:5] op_sel:[0,1,1] op_sel_hi:[1,1,1]
  v_pk_fma_f32 v[106:107], v[106:107], v[4:5], v[4:5] op_sel:[0,1,1] op_sel_hi:[1,1,1]
  v_pk_fma_f32 v[108:109], v[108:109], v[4:5], v[4:5] op_sel:[0,1,1] op_sel_hi:[1,1,1]
  v_pk_fma_f32 v[110:111], v[110:111], v[4:5], v[4:5] op_sel:[0,1,1] op_sel_hi:[1,1,1]
  v_rcp_f32 v104, v104
  v_rcp_f32 v105, v105
  v_rcp_f32 v106, v106
  v_rcp_f32 v107, v107
  v_rcp_f32 v108, v108
  v_rcp_f32 v109, v109
  v_rcp_f32 v110, v110
  v_rcp_f32 v111, v111
  v_pk_mul_f32 v[204:205], v[204:205], v[104:105]
  v_pk_mul_f32 v[206:207], v[206:207], v[106:107]
  v_pk_mul_f32 v[220:221], v[220:221], v[108:109]
  v_pk_mul_f32 v[222:223], v[222:223], v[110:111]
  v_cvt_pk_bf16_f32 v120, v204, v205
  v_cvt_pk_bf16_f32 v121, v206, v207
  v_cvt_pk_bf16_f32 v122, v220, v221
  v_cvt_pk_bf16_f32 v123, v222, v223
  buffer_store_dwordx4 v[120:123], v0, s[40:43], s7 offen offset:2048 sc0 sc1
  ds_write_b128 v0, v[120:123] offset:38912
  s_mov_b32 s16, Lz1-Lz0+0
  s_mov_b32 s17, 16384
  s_mov_b32 s18, 0xffff4000
  s_mov_b32 s19, 49152
  s_mov_b32 s20, 16384
  s_mov_b32 s21, 0xffff0000
  s_mul_i32 s4, s85, 8192
  v_add_u32_e64 v4, s4, v11
  v_add_u32 v5, 1024, v4
  s_lshl_b32 s4, s86, 1
  v_xor_b32 v2, s4, v26
  v_lshl_add_u32 v6, v2, 5, v25
  v_add_u32 v6, s19, v6
  s_add_u32 s4, s4, 1
  v_xor_b32_e64 v2, s4, v26
  v_lshl_add_u32 v7, v2, 5, v25
  v_add_u32 v7, s19, v7
  s_mov_b32 s22, 12
  s_waitcnt lgkmcnt(0)
  s_barrier
  ds_read_b64_tr_b16 v[48:49], v6 offset:0
  v_and_b32 v2, 15, v1
  v_lshrrev_b32 v3, 2, v29
  ds_read_b64_tr_b16 v[50:51], v6 offset:2048
  v_sub_u32 v2, v2, v3
  v_mov_b64 v[224:225], 0
  ds_read_b128 v[32:35], v4 offset:0
  v_lshlrev_b32_e64 v2, 4, v2
  v_mov_b32 v226, 0x3f80
  ds_read_b128 v[36:39], v4 offset:2048
  v_cmp_gt_u32 vcc, 64, v2
  v_mov_b32 v227, 0
  ds_read_b128 v[40:43], v4 offset:4096
  v_cndmask_b32 v226, 0, v226, vcc
  v_mov_b64 v[228:229], 0
  ds_read_b128 v[44:47], v4 offset:6144
  v_lshlrev_b64 v[226:227], v2, v[226:227]
  v_mov_b64_e64 v[160:161], 0
  ds_read_b64_tr_b16 v[52:53], v7 offset:0
  v_mov_b64 v[162:163], 0
  v_mov_b64 v[164:165], 0
  ds_read_b64_tr_b16 v[54:55], v7 offset:2048
  v_mov_b64 v[166:167], 0
  v_mov_b64 v[168:169], 0
  ds_read_b64_tr_b16 v[56:57], v6 offset:8192
  v_mov_b64 v[170:171], 0
  v_mov_b64 v[172:173], 0
  ds_read_b64_tr_b16 v[58:59], v6 offset:10240
  v_mov_b64 v[174:175], 0
  v_mov_b64 v[176:177], 0
  ds_read_b64_tr_b16 v[60:61], v7 offset:8192
  v_mov_b64 v[178:179], 0
  v_mov_b64 v[180:181], 0
  ds_read_b64_tr_b16 v[62:63], v7 offset:10240
  v_mov_b64 v[182:183], 0
  v_mov_b64 v[184:185], 0
  ds_read_b64_tr_b16 v[80:81], v6 offset:4096
  v_mov_b64_e64 v[186:187], 0
  v_mov_b64 v[188:189], 0
  s_waitcnt lgkmcnt(4)
  ds_read_b64_tr_b16 v[82:83], v6 offset:6144
  v_mov_b64_e64 v[190:191], 0
  v_mfma_f32_16x16x32_bf16 v[128:131], v[226:229], v[240:243], v[232:235]
  ds_read_b128 v[64:67], v5 offset:0
  s_lshl_b32 s4, s76, 4
  s_add_u32 s4, s4, s78
  ds_read_b128 v[68:71], v5 offset:2048
  v_mfma_f32_16x16x32_bf16 v[132:135], v[224:227], v[240:243], v[236:239]
  s_lshl_b32 s8, s4, Lz1-Lz0+14
  ds_read_b128 v[72:75], v5 offset:4096
  s_xor_b32 s6, s8, 16384
  v_mfma_f32_16x16x32_bf16 v[136:139], v[226:229], v[244:247], v[232:235]
  ds_read_b128 v[76:79], v5 offset:6144
  s_add_u32 s8, s8, 7340032
  s_add_u32 s6, s6, 7340032
  ds_read_b64_tr_b16 v[84:85], v7 offset:4096
  v_mfma_f32_16x16x32_bf16 v[140:143], v[224:227], v[244:247], v[236:239]
  s_add_u32 s7, s6, 4096
  ds_read_b64_tr_b16 v[86:87], v7 offset:6144
  s_add_u32 s9, s8, 4096
  v_mfma_f32_16x16x32_bf16 v[144:147], v[226:229], v[248:251], v[232:235]
  ds_read_b64_tr_b16 v[88:89], v6 offset:12288
  s_lshl_b32 s4, s81, 7
  s_add_u32 s4, s4, s87
  ds_read_b64_tr_b16 v[90:91], v6 offset:14336
  v_mfma_f32_16x16x32_bf16 v[148:151], v[224:227], v[248:251], v[236:239]
  s_add_u32 s4, s4, Lz1-Lz0+12
  ds_read_b64_tr_b16 v[92:93], v7 offset:12288
  s_lshl_b32 s13, s84, Lz1-Lz0+1
  v_mfma_f32_16x16x32_bf16 v[152:155], v[226:229], v[252:255], v[232:235]
  ds_read_b64_tr_b16 v[94:95], v7 offset:14336
  s_xor_b32 s14, s13, 32768
  s_nop 0
  s_add_u32 s13, s13, s4
  v_mfma_f32_16x16x32_bf16 v[156:159], v[224:227], v[252:255], v[236:239]
  s_add_u32 s14, s14, s4
  s_add_u32 s16, s16, s17
  s_cmp_eq_u32 s16, 65536
  s_cselect_b32 s23, s18, s17
  s_cselect_b32 s16, 0, s16
  v_add_u32_e64 v4, s23, v4
  v_add_u32 v5, s23, v5
  s_add_u32 s19, s19, s20
  s_cmp_eq_u32 s19, 81920
  s_cselect_b32 s23, s21, s20
  s_cselect_b32 s19, 0, s19
  v_add_u32 v6, s23, v6
  v_add_u32 v7, s23, v7
  s_waitcnt lgkmcnt(0)
Lk_29:
  s_barrier
  v_mfma_f32_16x16x32_bf16 v[128:131], v[48:51], v[32:35], v[128:131]
  ds_read_b64_tr_b16 v[112:113], v6 offset:0
  v_mfma_f32_16x16x32_bf16 v[128:131], v[80:83], v[64:67], v[128:131]
  ds_read_b64_tr_b16 v[114:115], v6 offset:2048
  v_mfma_f32_16x16x32_bf16 v[136:139], v[80:83], v[68:71], v[136:139]
  ds_read_b128 v[96:99], v4 offset:0
  v_mfma_f32_16x16x32_bf16 v[136:139], v[48:51], v[36:39], v[136:139]
  ds_read_b128 v[100:103], v4 offset:2048
  v_mfma_f32_16x16x32_bf16 v[144:147], v[48:51], v[40:43], v[144:147]
  ds_read_b128 v[104:107], v4 offset:4096
  v_mfma_f32_16x16x32_bf16 v[144:147], v[80:83], v[72:75], v[144:147]
  ds_read_b128 v[108:111], v4 offset:6144
  v_mfma_f32_16x16x32_bf16 v[152:155], v[80:83], v[76:79], v[152:155]
  ds_read_b64_tr_b16 v[116:117], v7 offset:0
  v_mfma_f32_16x16x32_bf16 v[152:155], v[48:51], v[44:47], v[152:155]
  ds_read_b64_tr_b16 v[118:119], v7 offset:2048
  v_mfma_f32_16x16x32_bf16 v[156:159], v[52:55], v[44:47], v[156:159]
  ds_read_b64_tr_b16 v[120:121], v6 offset:8192
  v_mfma_f32_16x16x32_bf16 v[156:159], v[84:87], v[76:79], v[156:159]
  ds_read_b64_tr_b16 v[122:123], v6 offset:10240
  v_mfma_f32_16x16x32_bf16 v[148:151], v[84:87], v[72:75], v[148:151]
  ds_read_b64_tr_b16 v[124:125], v7 offset:8192
  v_mfma_f32_16x16x32_bf16 v[148:151], v[52:55], v[40:43], v[148:151]
  ds_read_b64_tr_b16 v[126:127], v7 offset:10240
  v_mfma_f32_16x16x32_bf16 v[140:143], v[52:55], v[36:39], v[140:143]
  ds_read_b64_tr_b16 v[208:209], v6 offset:4096
  v_mfma_f32_16x16x32_bf16 v[140:143], v[84:87], v[68:71], v[140:143]
  ds_read_b64_tr_b16 v[210:211], v6 offset:6144
  v_mfma_f32_16x16x32_bf16 v[132:135], v[84:87], v[64:67], v[132:135]
  ds_read_b128 v[192:195], v5 offset:0
  v_mfma_f32_16x16x32_bf16 v[132:135], v[52:55], v[32:35], v[132:135]
  ds_read_b128 v[196:199], v5 offset:2048
  v_mfma_f32_16x16x32_bf16 v[160:163], v[56:59], v[32:35], v[160:163]
  ds_read_b128 v[200:203], v5 offset:4096
  v_mfma_f32_16x16x32_bf16 v[160:163], v[88:91], v[64:67], v[160:163]
  ds_read_b128 v[204:207], v5 offset:6144
  v_mfma_f32_16x16x32_bf16 v[168:171], v[88:91], v[68:71], v[168:171]
  ds_read_b64_tr_b16 v[212:213], v7 offset:4096
  v_mfma_f32_16x16x32_bf16 v[168:171], v[56:59], v[36:39], v[168:171]
  ds_read_b64_tr_b16 v[214:215], v7 offset:6144
  v_mfma_f32_16x16x32_bf16 v[176:179], v[56:59], v[40:43], v[176:179]
  ds_read_b64_tr_b16 v[216:217], v6 offset:12288
  v_mfma_f32_16x16x32_bf16 v[176:179], v[88:91], v[72:75], v[176:179]
  ds_read_b64_tr_b16 v[218:219], v6 offset:14336
  v_mfma_f32_16x16x32_bf16 v[184:187], v[88:91], v[76:79], v[184:187]
  ds_read_b64_tr_b16 v[220:221], v7 offset:12288
  v_mfma_f32_16x16x32_bf16 v[184:187], v[56:59], v[44:47], v[184:187]
  ds_read_b64_tr_b16 v[222:223], v7 offset:14336
  v_mfma_f32_16x16x32_bf16 v[188:191], v[60:63], v[44:47], v[188:191]
  s_add_u32 s16, s16, s17
  s_cmp_eq_u32 s16, 65536
  s_cselect_b32 s23, s18, s17
  v_mfma_f32_16x16x32_bf16 v[188:191], v[92:95], v[76:79], v[188:191]
  s_cselect_b32 s16, 0, s16
  v_add_u32 v4, s23, v4
  v_add_u32_e64 v5, s23, v5
  v_mfma_f32_16x16x32_bf16 v[180:183], v[92:95], v[72:75], v[180:183]
  s_add_u32 s19, s19, s20
  s_cmp_eq_u32 s19, 81920
  s_cselect_b32 s23, s21, s20
  v_mfma_f32_16x16x32_bf16 v[180:183], v[60:63], v[40:43], v[180:183]
  s_cselect_b32 s19, 0, s19
  v_add_u32 v6, s23, v6
  v_add_u32_e64 v7, s23, v7
  v_mfma_f32_16x16x32_bf16 v[172:175], v[60:63], v[36:39], v[172:175]
  v_mfma_f32_16x16x32_bf16 v[172:175], v[92:95], v[68:71], v[172:175]
  v_mfma_f32_16x16x32_bf16 v[164:167], v[92:95], v[64:67], v[164:167]
  s_nop 0
  s_waitcnt lgkmcnt(0)
  v_mfma_f32_16x16x32_bf16 v[164:167], v[60:63], v[32:35], v[164:167]
  s_waitcnt vmcnt(0)
  s_barrier
  v_mfma_f32_16x16x32_bf16 v[128:131], v[112:115], v[96:99], v[128:131]
  ds_read_b64_tr_b16 v[48:49], v6 offset:0
  v_mfma_f32_16x16x32_bf16 v[128:131], v[208:211], v[192:195], v[128:131]
  ds_read_b64_tr_b16 v[50:51], v6 offset:2048
  v_mfma_f32_16x16x32_bf16 v[136:139], v[208:211], v[196:199], v[136:139]
  ds_read_b128 v[32:35], v4 offset:0
  v_mfma_f32_16x16x32_bf16 v[136:139], v[112:115], v[100:103], v[136:139]
  ds_read_b128 v[36:39], v4 offset:2048
  v_mfma_f32_16x16x32_bf16 v[144:147], v[112:115], v[104:107], v[144:147]
  ds_read_b128 v[40:43], v4 offset:4096
  v_mfma_f32_16x16x32_bf16 v[144:147], v[208:211], v[200:203], v[144:147]
  ds_read_b128 v[44:47], v4 offset:6144
  v_mfma_f32_16x16x32_bf16 v[152:155], v[208:211], v[204:207], v[152:155]
  ds_read_b64_tr_b16 v[52:53], v7 offset:0
  v_mfma_f32_16x16x32_bf16 v[152:155], v[112:115], v[108:111], v[152:155]
  ds_read_b64_tr_b16 v[54:55], v7 offset:2048
  v_mfma_f32_16x16x32_bf16 v[156:159], v[116:119], v[108:111], v[156:159]
  ds_read_b64_tr_b16 v[56:57], v6 offset:8192
  v_mfma_f32_16x16x32_bf16 v[156:159], v[212:215], v[204:207], v[156:159]
  ds_read_b64_tr_b16 v[58:59], v6 offset:10240
  v_mfma_f32_16x16x32_bf16 v[148:151], v[212:215], v[200:203], v[148:151]
  ds_read_b64_tr_b16 v[60:61], v7 offset:8192
  v_mfma_f32_16x16x32_bf16 v[148:151], v[116:119], v[104:107], v[148:151]
  ds_read_b64_tr_b16 v[62:63], v7 offset:10240
  v_mfma_f32_16x16x32_bf16 v[140:143], v[116:119], v[100:103], v[140:143]
  ds_read_b64_tr_b16 v[80:81], v6 offset:4096
  v_mfma_f32_16x16x32_bf16 v[140:143], v[212:215], v[196:199], v[140:143]
  ds_read_b64_tr_b16 v[82:83], v6 offset:6144
  v_mfma_f32_16x16x32_bf16 v[132:135], v[212:215], v[192:195], v[132:135]
  ds_read_b128 v[64:67], v5 offset:0
  v_mfma_f32_16x16x32_bf16 v[132:135], v[116:119], v[96:99], v[132:135]
  ds_read_b128 v[68:71], v5 offset:2048
  v_mfma_f32_16x16x32_bf16 v[160:163], v[120:123], v[96:99], v[160:163]
  ds_read_b128 v[72:75], v5 offset:4096
  v_mfma_f32_16x16x32_bf16 v[160:163], v[216:219], v[192:195], v[160:163]
  ds_read_b128 v[76:79], v5 offset:6144
  v_mfma_f32_16x16x32_bf16 v[168:171], v[216:219], v[196:199], v[168:171]
  ds_read_b64_tr_b16 v[84:85], v7 offset:4096
  v_mfma_f32_16x16x32_bf16 v[168:171], v[120:123], v[100:103], v[168:171]
  ds_read_b64_tr_b16 v[86:87], v7 offset:6144
  v_mfma_f32_16x16x32_bf16 v[176:179], v[120:123], v[104:107], v[176:179]
  ds_read_b64_tr_b16 v[88:89], v6 offset:12288
  v_mfma_f32_16x16x32_bf16 v[176:179], v[216:219], v[200:203], v[176:179]
  ds_read_b64_tr_b16 v[90:91], v6 offset:14336
  v_mfma_f32_16x16x32_bf16 v[184:187], v[216:219], v[204:207], v[184:187]
  ds_read_b64_tr_b16 v[92:93], v7 offset:12288
  v_mfma_f32_16x16x32_bf16 v[184:187], v[120:123], v[108:111], v[184:187]
  ds_read_b64_tr_b16 v[94:95], v7 offset:14336
  v_mfma_f32_16x16x32_bf16 v[188:191], v[124:127], v[108:111], v[188:191]
  s_add_u32 s16, s16, s17
  s_cmp_eq_u32 s16, 65536
  s_cselect_b32 s23, s18, s17
  v_mfma_f32_16x16x32_bf16 v[188:191], v[220:223], v[204:207], v[188:191]
  s_cselect_b32 s16, 0, s16
  v_add_u32 v4, s23, v4
  v_add_u32_e64 v5, s23, v5
  v_mfma_f32_16x16x32_bf16 v[180:183], v[220:223], v[200:203], v[180:183]
  s_add_u32 s19, s19, s20
  s_cmp_eq_u32 s19, 81920
  s_cselect_b32 s23, s21, s20
  v_mfma_f32_16x16x32_bf16 v[180:183], v[124:127], v[104:107], v[180:183]
  s_cselect_b32 s19, 0, s19
  v_add_u32 v6, s23, v6
  v_add_u32_e64 v7, s23, v7
  v_mfma_f32_16x16x32_bf16 v[172:175], v[124:127], v[100:103], v[172:175]
  s_sub_u32 s22, s22, 1
  s_cmp_lg_u32 s22, 0
  v_mfma_f32_16x16x32_bf16 v[172:175], v[220:223], v[196:199], v[172:175]
  v_mfma_f32_16x16x32_bf16 v[164:167], v[220:223], v[192:195], v[164:167]
  s_nop 0
  s_waitcnt lgkmcnt(0)
  v_mfma_f32_16x16x32_bf16 v[164:167], v[124:127], v[96:99], v[164:167]
  s_cbranch_scc1 Lk_29
  s_barrier
  v_mfma_f32_16x16x32_bf16 v[128:131], v[48:51], v[32:35], v[128:131]
  ds_read_b64_tr_b16 v[112:113], v6 offset:0
  v_mfma_f32_16x16x32_bf16 v[128:131], v[80:83], v[64:67], v[128:131]
  ds_read_b64_tr_b16 v[114:115], v6 offset:2048
  v_mfma_f32_16x16x32_bf16 v[136:139], v[80:83], v[68:71], v[136:139]
  ds_read_b128 v[96:99], v4 offset:0
  v_mfma_f32_16x16x32_bf16 v[136:139], v[48:51], v[36:39], v[136:139]
  ds_read_b128 v[100:103], v4 offset:2048
  v_mfma_f32_16x16x32_bf16 v[144:147], v[48:51], v[40:43], v[144:147]
  ds_read_b128 v[104:107], v4 offset:4096
  v_mfma_f32_16x16x32_bf16 v[144:147], v[80:83], v[72:75], v[144:147]
  ds_read_b128 v[108:111], v4 offset:6144
  v_mfma_f32_16x16x32_bf16 v[152:155], v[80:83], v[76:79], v[152:155]
  ds_read_b64_tr_b16 v[116:117], v7 offset:0
  v_mfma_f32_16x16x32_bf16 v[152:155], v[48:51], v[44:47], v[152:155]
  ds_read_b64_tr_b16 v[118:119], v7 offset:2048
  v_mfma_f32_16x16x32_bf16 v[156:159], v[52:55], v[44:47], v[156:159]
  ds_read_b64_tr_b16 v[120:121], v6 offset:8192
  v_mfma_f32_16x16x32_bf16 v[156:159], v[84:87], v[76:79], v[156:159]
  ds_read_b64_tr_b16 v[122:123], v6 offset:10240
  v_mfma_f32_16x16x32_bf16 v[148:151], v[84:87], v[72:75], v[148:151]
  ds_read_b64_tr_b16 v[124:125], v7 offset:8192
  v_mfma_f32_16x16x32_bf16 v[148:151], v[52:55], v[40:43], v[148:151]
  ds_read_b64_tr_b16 v[126:127], v7 offset:10240
  v_mfma_f32_16x16x32_bf16 v[140:143], v[52:55], v[36:39], v[140:143]
  ds_read_b64_tr_b16 v[208:209], v6 offset:4096
  v_mfma_f32_16x16x32_bf16 v[140:143], v[84:87], v[68:71], v[140:143]
  ds_read_b64_tr_b16 v[210:211], v6 offset:6144
  v_mfma_f32_16x16x32_bf16 v[132:135], v[84:87], v[64:67], v[132:135]
  ds_read_b128 v[192:195], v5 offset:0
  v_mfma_f32_16x16x32_bf16 v[132:135], v[52:55], v[32:35], v[132:135]
  ds_read_b128 v[196:199], v5 offset:2048
  v_mfma_f32_16x16x32_bf16 v[160:163], v[56:59], v[32:35], v[160:163]
  ds_read_b128 v[200:203], v5 offset:4096
  v_mfma_f32_16x16x32_bf16 v[160:163], v[88:91], v[64:67], v[160:163]
  ds_read_b128 v[204:207], v5 offset:6144
  v_mfma_f32_16x16x32_bf16 v[168:171], v[88:91], v[68:71], v[168:171]
  ds_read_b64_tr_b16 v[212:213], v7 offset:4096
  v_mfma_f32_16x16x32_bf16 v[168:171], v[56:59], v[36:39], v[168:171]
  ds_read_b64_tr_b16 v[214:215], v7 offset:6144
  v_mfma_f32_16x16x32_bf16 v[176:179], v[56:59], v[40:43], v[176:179]
  ds_read_b64_tr_b16 v[216:217], v6 offset:12288
  v_mfma_f32_16x16x32_bf16 v[176:179], v[88:91], v[72:75], v[176:179]
  ds_read_b64_tr_b16 v[218:219], v6 offset:14336
  v_mfma_f32_16x16x32_bf16 v[184:187], v[88:91], v[76:79], v[184:187]
  ds_read_b64_tr_b16 v[220:221], v7 offset:12288
  v_mfma_f32_16x16x32_bf16 v[184:187], v[56:59], v[44:47], v[184:187]
  ds_read_b64_tr_b16 v[222:223], v7 offset:14336
  v_mfma_f32_16x16x32_bf16 v[188:191], v[60:63], v[44:47], v[188:191]
  s_add_u32 s16, s16, s17
  s_cmp_eq_u32 s16, 65536
  s_cselect_b32 s23, s18, s17
  v_mfma_f32_16x16x32_bf16 v[188:191], v[92:95], v[76:79], v[188:191]
  s_cselect_b32 s16, 0, s16
  v_add_u32 v4, s23, v4
  v_add_u32_e64 v5, s23, v5
  v_mfma_f32_16x16x32_bf16 v[180:183], v[92:95], v[72:75], v[180:183]
  s_add_u32 s19, s19, s20
  s_cmp_eq_u32 s19, 81920
  s_cselect_b32 s23, s21, s20
  v_mfma_f32_16x16x32_bf16 v[180:183], v[60:63], v[40:43], v[180:183]
  s_cselect_b32 s19, 0, s19
  v_add_u32 v6, s23, v6
  v_add_u32_e64 v7, s23, v7
  v_mfma_f32_16x16x32_bf16 v[172:175], v[60:63], v[36:39], v[172:175]
  v_mfma_f32_16x16x32_bf16 v[172:175], v[92:95], v[68:71], v[172:175]
  v_mfma_f32_16x16x32_bf16 v[164:167], v[92:95], v[64:67], v[164:167]
  s_waitcnt lgkmcnt(0)
  v_mfma_f32_16x16x32_bf16 v[164:167], v[60:63], v[32:35], v[164:167]
  s_barrier
  v_mfma_f32_16x16x32_bf16 v[160:163], v[120:123], v[96:99], v[160:163]
  ds_read_b64_tr_b16 v[48:49], v6 offset:0
  ds_read_b64_tr_b16 v[50:51], v6 offset:2048
  v_mfma_f32_16x16x32_bf16 v[160:163], v[216:219], v[192:195], v[160:163]
  ds_read_b128 v[32:35], v4 offset:0
  ds_read_b128 v[36:39], v4 offset:2048
  v_mfma_f32_16x16x32_bf16 v[164:167], v[220:223], v[192:195], v[164:167]
  ds_read_b128 v[40:43], v4 offset:4096
  ds_read_b128 v[44:47], v4 offset:6144
  v_mfma_f32_16x16x32_bf16 v[164:167], v[124:127], v[96:99], v[164:167]
  ds_read_b64_tr_b16 v[52:53], v7 offset:0
  ds_read_b64_tr_b16 v[54:55], v7 offset:2048
  v_mfma_f32_16x16x32_bf16 v[172:175], v[124:127], v[100:103], v[172:175]
  ds_read_b64_tr_b16 v[80:81], v6 offset:4096
  ds_read_b64_tr_b16 v[82:83], v6 offset:6144
  v_mfma_f32_16x16x32_bf16 v[172:175], v[220:223], v[196:199], v[172:175]
  v_cvt_pk_bf16_f32 v160, v160, v161
  v_cvt_pk_bf16_f32 v161, v162, v163
  v_mfma_f32_16x16x32_bf16 v[168:171], v[216:219], v[196:199], v[168:171]
  v_cvt_pk_bf16_f32 v162, v164, v165
  v_cvt_pk_bf16_f32 v163, v166, v167
  v_mfma_f32_16x16x32_bf16 v[168:171], v[120:123], v[100:103], v[168:171]
  buffer_store_dwordx4 v[160:163], v0, s[40:43], s6 offen offset:0 sc0 sc1
  v_mfma_f32_16x16x32_bf16 v[176:179], v[120:123], v[104:107], v[176:179]
  ds_read_b128 v[64:67], v5 offset:0
  v_mfma_f32_16x16x32_bf16 v[176:179], v[216:219], v[200:203], v[176:179]
  v_cvt_pk_bf16_f32 v166, v172, v173
  v_cvt_pk_bf16_f32 v167, v174, v175
  v_mfma_f32_16x16x32_bf16 v[180:183], v[220:223], v[200:203], v[180:183]
  s_nop 0
  s_nop 0
  v_cvt_pk_bf16_f32 v164, v168, v169
  v_cvt_pk_bf16_f32 v165, v170, v171
  v_mfma_f32_16x16x32_bf16 v[180:183], v[124:127], v[104:107], v[180:183]
  buffer_store_dwordx4 v[164:167], v0, s[40:43], s6 offen offset:2048 sc0 sc1
  ds_read_b128 v[68:71], v5 offset:2048
  v_mfma_f32_16x16x32_bf16 v[188:191], v[124:127], v[108:111], v[188:191]
  ds_read_b128 v[72:75], v5 offset:4096
  v_mfma_f32_16x16x32_bf16 v[188:191], v[220:223], v[204:207], v[188:191]
  v_cvt_pk_bf16_f32 v168, v176, v177
  v_cvt_pk_bf16_f32 v169, v178, v179
  v_mfma_f32_16x16x32_bf16 v[184:187], v[216:219], v[204:207], v[184:187]
  v_cvt_pk_bf16_f32 v170, v180, v181
  v_cvt_pk_bf16_f32 v171, v182, v183
  v_mfma_f32_16x16x32_bf16 v[184:187], v[120:123], v[108:111], v[184:187]
  buffer_store_dwordx4 v[168:171], v0, s[40:43], s7 offen offset:0 sc0 sc1
  ds_read_b128 v[76:79], v5 offset:6144
  v_mfma_f32_16x16x32_bf16 v[128:131], v[112:115], v[96:99], v[128:131]
  ds_read_b64_tr_b16 v[84:85], v7 offset:4096
  v_mfma_f32_16x16x32_bf16 v[128:131], v[208:211], v[192:195], v[128:131]
  v_cvt_pk_bf16_f32 v174, v188, v189
  v_cvt_pk_bf16_f32 v175, v190, v191
  v_mfma_f32_16x16x32_bf16 v[136:139], v[208:211], v[196:199], v[136:139]
  v_cvt_pk_bf16_f32 v172, v184, v185
  v_cvt_pk_bf16_f32 v173, v186, v187
  v_mfma_f32_16x16x32_bf16 v[136:139], v[112:115], v[100:103], v[136:139]
  buffer_store_dwordx4 v[172:175], v0, s[40:43], s7 offen offset:2048 sc0 sc1
  ds_read_b64_tr_b16 v[86:87], v7 offset:6144
  v_mfma_f32_16x16x32_bf16 v[144:147], v[112:115], v[104:107], v[144:147]
  v_subrev_u32 v4, 32768, v4
  v_mfma_f32_16x16x32_bf16 v[144:147], v[208:211], v[200:203], v[144:147]
  v_subrev_u32 v6, 0x10000, v6
  v_mfma_f32_16x16x32_bf16 v[152:155], v[208:211], v[204:207], v[152:155]
  v_subrev_u32 v7, 0x10000, v7
  v_mfma_f32_16x16x32_bf16 v[152:155], v[112:115], v[108:111], v[152:155]
  v_mfma_f32_16x16x32_bf16 v[156:159], v[116:119], v[108:111], v[156:159]
  v_mfma_f32_16x16x32_bf16 v[156:159], v[212:215], v[204:207], v[156:159]
  v_mfma_f32_16x16x32_bf16 v[148:151], v[212:215], v[200:203], v[148:151]
  v_mfma_f32_16x16x32_bf16 v[148:151], v[116:119], v[104:107], v[148:151]
  v_mfma_f32_16x16x32_bf16 v[140:143], v[116:119], v[100:103], v[140:143]
  v_mfma_f32_16x16x32_bf16 v[140:143], v[212:215], v[196:199], v[140:143]
  v_mfma_f32_16x16x32_bf16 v[132:135], v[212:215], v[192:195], v[132:135]
  s_waitcnt lgkmcnt(0)
  v_mfma_f32_16x16x32_bf16 v[132:135], v[116:119], v[96:99], v[132:135]
  s_barrier
  v_mfma_f32_16x16x32_bf16 v[128:131], v[48:51], v[32:35], v[128:131]
  ds_read_b64_tr_b16 v[112:113], v6 offset:0
  v_mfma_f32_16x16x32_bf16 v[128:131], v[80:83], v[64:67], v[128:131]
  ds_read_b64_tr_b16 v[114:115], v6 offset:2048
  v_mfma_f32_16x16x32_bf16 v[136:139], v[80:83], v[68:71], v[136:139]
  ds_read_b64_tr_b16 v[208:209], v6 offset:4096
  v_mfma_f32_16x16x32_bf16 v[136:139], v[48:51], v[36:39], v[136:139]
  ds_read_b64_tr_b16 v[210:211], v6 offset:6144
  v_mfma_f32_16x16x32_bf16 v[144:147], v[48:51], v[40:43], v[144:147]
  ds_read_b128 v[96:99], v4 offset:49152
  v_mfma_f32_16x16x32_bf16 v[144:147], v[80:83], v[72:75], v[144:147]
  ds_read_b128 v[192:195], v4 offset:50176
  v_mfma_f32_16x16x32_bf16 v[152:155], v[80:83], v[76:79], v[152:155]
  ds_read_b128 v[100:103], v4 offset:51200
  v_mfma_f32_16x16x32_bf16 v[152:155], v[48:51], v[44:47], v[152:155]
  ds_read_b128 v[196:199], v4 offset:52224
  v_mfma_f32_16x16x32_bf16 v[156:159], v[52:55], v[44:47], v[156:159]
  ds_read_b128 v[104:107], v4 offset:53248
  v_mfma_f32_16x16x32_bf16 v[156:159], v[84:87], v[76:79], v[156:159]
  ds_read_b128 v[200:203], v4 offset:54272
  v_mfma_f32_16x16x32_bf16 v[148:151], v[84:87], v[72:75], v[148:151]
  ds_read_b128 v[108:111], v4 offset:55296
  v_mfma_f32_16x16x32_bf16 v[148:151], v[52:55], v[40:43], v[148:151]
  ds_read_b128 v[204:207], v4 offset:56320
  v_mfma_f32_16x16x32_bf16 v[140:143], v[52:55], v[36:39], v[140:143]
  ds_read_b64_tr_b16 v[116:117], v7 offset:0
  v_mfma_f32_16x16x32_bf16 v[140:143], v[84:87], v[68:71], v[140:143]
  ds_read_b64_tr_b16 v[118:119], v7 offset:2048
  v_mfma_f32_16x16x32_bf16 v[132:135], v[84:87], v[64:67], v[132:135]
  ds_read_b64_tr_b16 v[212:213], v7 offset:4096
  ds_read_b64_tr_b16 v[214:215], v7 offset:6144
  v_mfma_f32_16x16x32_bf16 v[132:135], v[52:55], v[32:35], v[132:135]
  s_barrier
  s_waitcnt lgkmcnt(10)
  v_mfma_f32_16x16x32_bf16 v[128:131], v[112:115], v[96:99], v[128:131]
  ds_read_b64_tr_b16 v[48:49], v6 offset:16384
  v_mfma_f32_16x16x32_bf16 v[128:131], v[208:211], v[192:195], v[128:131]
  ds_read_b64_tr_b16 v[50:51], v6 offset:18432
  s_nop 0
  s_waitcnt lgkmcnt(10)
  v_mfma_f32_16x16x32_bf16 v[136:139], v[208:211], v[196:199], v[136:139]
  ds_read_b64_tr_b16 v[80:81], v6 offset:20480
  v_mfma_f32_16x16x32_bf16 v[136:139], v[112:115], v[100:103], v[136:139]
  ds_read_b64_tr_b16 v[82:83], v6 offset:22528
  s_nop 0
  s_waitcnt lgkmcnt(10)
  v_mfma_f32_16x16x32_bf16 v[144:147], v[112:115], v[104:107], v[144:147]
  ds_read_b128 v[32:35], v4 offset:0
  v_mfma_f32_16x16x32_bf16 v[144:147], v[208:211], v[200:203], v[144:147]
  ds_read_b128 v[64:67], v4 offset:1024
  s_nop 0
  s_waitcnt lgkmcnt(10)
  v_mfma_f32_16x16x32_bf16 v[152:155], v[208:211], v[204:207], v[152:155]
  ds_read_b128 v[36:39], v4 offset:2048
  v_mfma_f32_16x16x32_bf16 v[152:155], v[112:115], v[108:111], v[152:155]
  ds_read_b128 v[68:71], v4 offset:3072
  s_nop 0
  s_waitcnt lgkmcnt(8)
  v_mfma_f32_16x16x32_bf16 v[156:159], v[116:119], v[108:111], v[156:159]
  ds_read_b128 v[40:43], v4 offset:4096
  buffer_load_dwordx4 v[176:179], v0, s[40:43], s8 offen offset:0 sc0 sc1
  v_mfma_f32_16x16x32_bf16 v[156:159], v[212:215], v[204:207], v[156:159]
  ds_read_b128 v[72:75], v4 offset:5120
  v_mfma_f32_16x16x32_bf16 v[148:151], v[212:215], v[200:203], v[148:151]
  ds_read_b128 v[44:47], v4 offset:6144
  buffer_load_dwordx4 v[180:183], v0, s[40:43], s8 offen offset:2048 sc0 sc1
  v_mfma_f32_16x16x32_bf16 v[148:151], v[116:119], v[104:107], v[148:151]
  ds_read_b128 v[76:79], v4 offset:7168
  v_mfma_f32_16x16x32_bf16 v[140:143], v[116:119], v[100:103], v[140:143]
  ds_read_b64_tr_b16 v[52:53], v7 offset:16384
  buffer_load_dwordx4 v[184:187], v0, s[40:43], s9 offen offset:0 sc0 sc1
  v_mfma_f32_16x16x32_bf16 v[140:143], v[212:215], v[196:199], v[140:143]
  ds_read_b64_tr_b16 v[54:55], v7 offset:18432
  v_mfma_f32_16x16x32_bf16 v[132:135], v[212:215], v[192:195], v[132:135]
  ds_read_b64_tr_b16 v[84:85], v7 offset:20480
  ds_read_b64_tr_b16 v[86:87], v7 offset:22528
  buffer_load_dwordx4 v[188:191], v0, s[40:43], s9 offen offset:2048 sc0 sc1
  v_mfma_f32_16x16x32_bf16 v[132:135], v[116:119], v[96:99], v[132:135]
  s_barrier
  s_waitcnt lgkmcnt(10)
  v_mfma_f32_16x16x32_bf16 v[128:131], v[48:51], v[32:35], v[128:131]
  ds_read_b64_tr_b16 v[112:113], v6 offset:32768
  v_mfma_f32_16x16x32_bf16 v[128:131], v[80:83], v[64:67], v[128:131]
  ds_read_b64_tr_b16 v[114:115], v6 offset:34816
  s_nop 0
  s_waitcnt lgkmcnt(10)
  v_mfma_f32_16x16x32_bf16 v[136:139], v[80:83], v[68:71], v[136:139]
  ds_read_b64_tr_b16 v[208:209], v6 offset:36864
  v_mfma_f32_16x16x32_bf16 v[136:139], v[48:51], v[36:39], v[136:139]
  ds_read_b64_tr_b16 v[210:211], v6 offset:38912
  s_nop 0
  s_waitcnt lgkmcnt(10)
  v_mfma_f32_16x16x32_bf16 v[144:147], v[48:51], v[40:43], v[144:147]
  ds_read_b128 v[96:99], v4 offset:16384
  v_mfma_f32_16x16x32_bf16 v[144:147], v[80:83], v[72:75], v[144:147]
  ds_read_b128 v[192:195], v4 offset:17408
  s_nop 0
  s_waitcnt lgkmcnt(10)
  v_mfma_f32_16x16x32_bf16 v[152:155], v[80:83], v[76:79], v[152:155]
  ds_read_b128 v[100:103], v4 offset:18432
  v_mfma_f32_16x16x32_bf16 v[152:155], v[48:51], v[44:47], v[152:155]
  ds_read_b128 v[196:199], v4 offset:19456
  s_nop 0
  s_waitcnt lgkmcnt(8)
  v_mfma_f32_16x16x32_bf16 v[156:159], v[52:55], v[44:47], v[156:159]
  ds_read_b128 v[104:107], v4 offset:20480
  v_mfma_f32_16x16x32_bf16 v[156:159], v[84:87], v[76:79], v[156:159]
  ds_read_b128 v[200:203], v4 offset:21504
  v_mfma_f32_16x16x32_bf16 v[148:151], v[84:87], v[72:75], v[148:151]
  ds_read_b128 v[108:111], v4 offset:22528
  v_mfma_f32_16x16x32_bf16 v[148:151], v[52:55], v[40:43], v[148:151]
  ds_read_b128 v[204:207], v4 offset:23552
  v_mfma_f32_16x16x32_bf16 v[140:143], v[52:55], v[36:39], v[140:143]
  ds_read_b64_tr_b16 v[116:117], v7 offset:32768
  v_mfma_f32_16x16x32_bf16 v[140:143], v[84:87], v[68:71], v[140:143]
  ds_read_b64_tr_b16 v[118:119], v7 offset:34816
  v_mfma_f32_16x16x32_bf16 v[132:135], v[84:87], v[64:67], v[132:135]
  ds_read_b64_tr_b16 v[212:213], v7 offset:36864
  ds_read_b64_tr_b16 v[214:215], v7 offset:38912
  v_mfma_f32_16x16x32_bf16 v[132:135], v[52:55], v[32:35], v[132:135]
  s_waitcnt lgkmcnt(10)
  v_mfma_f32_16x16x32_bf16 v[128:131], v[112:115], v[96:99], v[128:131]
  v_mfma_f32_16x16x32_bf16 v[128:131], v[208:211], v[192:195], v[128:131]
  s_waitcnt lgkmcnt(8)
  v_mfma_f32_16x16x32_bf16 v[136:139], v[208:211], v[196:199], v[136:139]
  v_mfma_f32_16x16x32_bf16 v[136:139], v[112:115], v[100:103], v[136:139]
  s_waitcnt lgkmcnt(6)
  v_mfma_f32_16x16x32_bf16 v[144:147], v[112:115], v[104:107], v[144:147]
  v_mfma_f32_16x16x32_bf16 v[144:147], v[208:211], v[200:203], v[144:147]
  s_waitcnt lgkmcnt(4)
  v_mfma_f32_16x16x32_bf16 v[152:155], v[208:211], v[204:207], v[152:155]
  s_lshl_b32 s4, s76, Lz1-Lz0+4
  v_mfma_f32_16x16x32_bf16 v[152:155], v[112:115], v[108:111], v[152:155]
  s_add_u32 s4, s4, s78
  s_lshl_b32 s6, s4, 14
  s_waitcnt lgkmcnt(0)
  s_barrier
  v_mfma_f32_16x16x32_bf16 v[156:159], v[116:119], v[108:111], v[156:159]
  s_add_u32 s6, s6, 35651584
  s_add_u32 s7, s6, 4096
  v_mfma_f32_16x16x32_bf16 v[156:159], v[212:215], v[204:207], v[156:159]
  v_and_b32 v2, 15, v1
  v_lshlrev_b32 v3, 12, v2
  v_mfma_f32_16x16x32_bf16 v[148:151], v[212:215], v[200:203], v[148:151]
  v_and_b32_e64 v2, 16, v1
  v_lshl_add_u32 v3, v2, 1, v3
  v_mfma_f32_16x16x32_bf16 v[148:151], v[116:119], v[104:107], v[148:151]
  v_and_b32 v2, 32, v1
  v_lshrrev_b32 v2, 1, v2
  v_mfma_f32_16x16x32_bf16 v[140:143], v[116:119], v[100:103], v[140:143]
  v_add_u32 v3, v2, v3
  s_lshl_b32 s26, s76, 18
  v_mfma_f32_16x16x32_bf16 v[140:143], v[212:215], v[196:199], v[140:143]
  s_lshl_b32 s4, s85, 11
  s_add_u32 s26, s26, s4
  v_mfma_f32_16x16x32_bf16 v[132:135], v[212:215], v[192:195], v[132:135]
  s_lshl_b32 s4, s78, 7
  s_add_u32 s26, s26, s4
  v_mfma_f32_16x16x32_bf16 v[132:135], v[116:119], v[96:99], v[132:135]
  s_lshl_b32 s4, s86, 6
  s_add_u32 s26, s26, s4
  s_mov_b32 s89, 200000
  v_mov_b32_e64 v32, 0
  s_waitcnt vmcnt(0)
  s_mov_b64 exec, 1
  buffer_store_dword v27, off, s[40:43], s14 sc0 sc1
  s_mov_b64 exec, -1
Lx_31:
  v_cmpx_ne_u64 vcc, v[176:177], v[240:241]
  v_cmpx_ne_u64 vcc, v[178:179], v[242:243]
  v_cmpx_ne_u64 vcc, v[180:181], v[244:245]
  v_cmpx_ne_u64 vcc, v[182:183], v[246:247]
  v_cmpx_ne_u64 vcc, v[184:185], v[248:249]
  v_cmpx_ne_u64 vcc, v[186:187], v[250:251]
  v_cmpx_ne_u64 vcc, v[188:189], v[252:253]
  v_cmpx_ne_u64 vcc, v[190:191], v[254:255]
  s_cmp_eq_u64 exec, -1
  s_cbranch_scc0 Lx_30
Lx_32:
  s_nop 1
  v_mfma_f32_16x16x32_bf16 v[128:131], v[226:229], v[176:179], v[128:131]
  v_mfma_f32_16x16x32_bf16 v[132:135], v[224:227], v[176:179], v[132:135]
  v_mfma_f32_16x16x32_bf16 v[136:139], v[226:229], v[180:183], v[136:139]
  v_mfma_f32_16x16x32_bf16 v[140:143], v[224:227], v[180:183], v[140:143]
  v_mfma_f32_16x16x32_bf16 v[144:147], v[226:229], v[184:187], v[144:147]
  v_mfma_f32_16x16x32_bf16 v[148:151], v[224:227], v[184:187], v[148:151]
  v_mfma_f32_16x16x32_bf16 v[152:155], v[226:229], v[188:191], v[152:155]
  v_mfma_f32_16x16x32_bf16 v[156:159], v[224:227], v[188:191], v[156:159]
  s_cmp_lg_u32 s82, 0
  s_cbranch_scc1 L_cfinal
  v_cvt_pk_bf16_f32 v240, v128, v129
  v_cvt_pk_bf16_f32 v241, v130, v131
  v_cvt_pk_bf16_f32 v242, v132, v133
  v_cvt_pk_bf16_f32 v243, v134, v135
  buffer_store_dwordx4 v[240:243], v0, s[40:43], s6 offen offset:0 sc0 sc1
  v_cvt_pk_bf16_f32 v244, v136, v137
  v_cvt_pk_bf16_f32 v245, v138, v139
  v_cvt_pk_bf16_f32 v246, v140, v141
  v_cvt_pk_bf16_f32 v247, v142, v143
  buffer_store_dwordx4 v[244:247], v0, s[40:43], s6 offen offset:2048 sc0 sc1
  v_cvt_pk_bf16_f32 v248, v144, v145
  v_cvt_pk_bf16_f32 v249, v146, v147
  v_cvt_pk_bf16_f32 v250, v148, v149
  v_cvt_pk_bf16_f32 v251, v150, v151
  buffer_store_dwordx4 v[248:251], v0, s[40:43], s7 offen offset:0 sc0 sc1
  v_cvt_pk_bf16_f32 v252, v152, v153
  v_cvt_pk_bf16_f32 v253, v154, v155
  v_cvt_pk_bf16_f32 v254, v156, v157
  v_cvt_pk_bf16_f32 v255, v158, v159
  buffer_store_dwordx4 v[252:255], v0, s[40:43], s7 offen offset:2048 sc0 sc1
  s_lshl_b32 s5, s78, Lz1-Lz0+1
  v_mov_b32 v40, 0x3f803f80
  v_dot2_f32_bf16 v32, v240, v40, 0
  v_dot2_f32_bf16 v36, v240, v240, 0
  v_dot2_f32_bf16 v33, v244, v40, 0
  v_dot2_f32_bf16 v37, v244, v244, 0
  v_dot2_f32_bf16 v34, v248, v40, 0
  v_dot2_f32_bf16 v38, v248, v248, 0
  v_dot2_f32_bf16 v35, v252, v40, 0
  v_dot2_f32_bf16 v39, v252, v252, 0
  v_dot2_f32_bf16 v32, v241, v40, v32
  v_dot2_f32_bf16 v36, v241, v241, v36
  v_dot2_f32_bf16 v33, v245, v40, v33
  v_dot2_f32_bf16 v37, v245, v245, v37
  v_dot2_f32_bf16 v34, v249, v40, v34
  v_dot2_f32_bf16 v38, v249, v249, v38
  v_dot2_f32_bf16 v35, v253, v40, v35
  v_dot2_f32_bf16 v39, v253, v253, v39
  v_dot2_f32_bf16 v32, v242, v40, v32
  v_dot2_f32_bf16 v36, v242, v242, v36
  v_dot2_f32_bf16 v33, v246, v40, v33
  v_dot2_f32_bf16 v37, v246, v246, v37
  v_dot2_f32_bf16 v34, v250, v40, v34
  v_dot2_f32_bf16 v38, v250, v250, v38
  v_dot2_f32_bf16 v35, v254, v40, v35
  v_dot2_f32_bf16 v39, v254, v254, v39
  v_dot2_f32_bf16 v32, v243, v40, v32
  v_dot2_f32_bf16 v36, v243, v243, v36
  v_dot2_f32_bf16 v33, v247, v40, v33
  v_dot2_f32_bf16 v37, v247, v247, v37
  v_dot2_f32_bf16 v34, v251, v40, v34
  v_dot2_f32_bf16 v38, v251, v251, v38
  v_dot2_f32_bf16 v35, v255, v40, v35
  v_dot2_f32_bf16 v39, v255, v255, v39
  s_lshl_b32 s6, s76, Lz1-Lz0+9
  s_lshl_b32 s7, s85, 8
  s_add_u32 s6, s6, s7
  s_add_u32 s6, s6, s5
  s_add_u32 s6, s6, s86
  s_lshl_b32 s6, s6, 6
  s_add_u32 s6, s6, s83
  s_add_u32 s6, s6, 36700160
  v_permlane32_swap_b32 v32, v34
  v_permlane32_swap_b32 v33, v35
  v_permlane32_swap_b32 v36, v38
  v_permlane32_swap_b32 v37, v39
  v_add_f32 v32, v32, v34
  v_add_f32 v33, v33, v35
  v_add_f32 v36, v36, v38
  v_add_f32 v37, v37, v39
  v_permlane16_swap_b32 v32, v33
  s_nop 0
  v_permlane16_swap_b32 v36, v37
  v_add_f32 v42, v32, v33
  v_add_f32_e64 v43, v36, v37
  buffer_store_dwordx2 v[42:43], v30, s[40:43], s6 offen sc0 sc1
  s_add_u32 s5, s87, 0x10
  s_sub_u32 s4, s78, s77
  s_lshl_b32 s4, s4, 7
  s_add_u32 s5, s5, s4
  s_waitcnt vmcnt(0)
  s_mov_b64 exec, 1
  ds_add_rtn_u32 v2, v28, v27 offset:0
  s_waitcnt lgkmcnt(0)
  v_readfirstlane_b32 s4, v2
  s_and_b32 s4, s4, Lz1-Lz0+3
  s_cmp_lg_u32 s4, 3
  s_cbranch_scc1 Ls_33
  s_mov_b32 exec_lo, 0xffff
  buffer_store_dword v27, v24, s[40:43], s5 offen sc0 sc1
Ls_33:
  s_nop 0
  s_mov_b64 exec, -1
  ds_write_b128 v0, v[240:243] offset:0
  ds_write_b128 v0, v[244:247] offset:2048
  ds_write_b128 v0, v[248:251] offset:4096
  ds_write_b128 v0, v[252:255] offset:6144
  s_mov_b32 s82, 1
  s_add_u32 s83, s83, 0
  s_add_u32 s87, s87, 32
  s_branch L_clayer
  s_nop 0
L_cfinal:
  s_nop 1
  v_cvt_pk_bf16_f32 v240, v128, v129
  v_cvt_pk_bf16_f32 v241, v130, v131
  v_cvt_pk_bf16_f32 v242, v132, v133
  v_cvt_pk_bf16_f32 v243, v134, v135
  s_nop 0
  v_permlane16_swap_b32 v240, v242
  v_permlane16_swap_b32_e64 v241, v243
  buffer_store_dwordx4 v[240:243], v3, s[64:67], s26 offen sc0 sc1
  s_add_u32 s26, s26, 0x10000
  v_cvt_pk_bf16_f32 v244, v136, v137
  v_cvt_pk_bf16_f32 v245, v138, v139
  v_cvt_pk_bf16_f32 v246, v140, v141
  v_cvt_pk_bf16_f32 v247, v142, v143
  s_nop 0
  v_permlane16_swap_b32 v244, v246
  v_permlane16_swap_b32_e64 v245, v247
  buffer_store_dwordx4 v[244:247], v3, s[64:67], s26 offen sc0 sc1
  s_add_u32 s26, s26, 0x10000
  v_cvt_pk_bf16_f32 v248, v144, v145
  v_cvt_pk_bf16_f32 v249, v146, v147
  v_cvt_pk_bf16_f32 v250, v148, v149
  v_cvt_pk_bf16_f32 v251, v150, v151
  s_nop 0
  v_permlane16_swap_b32 v248, v250
  v_permlane16_swap_b32_e64 v249, v251
  buffer_store_dwordx4 v[248:251], v3, s[64:67], s26 offen sc0 sc1
  s_add_u32 s26, s26, 0x10000
  v_cvt_pk_bf16_f32 v252, v152, v153
  v_cvt_pk_bf16_f32 v253, v154, v155
  v_cvt_pk_bf16_f32 v254, v156, v157
  v_cvt_pk_bf16_f32 v255, v158, v159
  s_nop 0
  v_permlane16_swap_b32 v252, v254
  v_permlane16_swap_b32_e64 v253, v255
  buffer_store_dwordx4 v[252:255], v3, s[64:67], s26 offen sc0 sc1
  s_endpgm
Lo_6:
  s_mov_b64 vcc, 0
  s_waitcnt lgkmcnt(0)
  s_barrier
  ds_read_b128 v[64:67], v4 offset:0
  ds_read_b128 v[80:83], v5 offset:0
  ds_read_b128 v[68:71], v4 offset:2048
  ds_read_b128 v[84:87], v5 offset:2048
  ds_read_b128 v[72:75], v4 offset:4096
  ds_read_b128 v[88:91], v5 offset:4096
  ds_read_b64_tr_b16 v[96:97], v6 offset:0
  ds_read_b64_tr_b16 v[98:99], v6 offset:2048
  ds_read_b64_tr_b16 v[100:101], v6 offset:4096
  ds_read_b64_tr_b16 v[102:103], v6 offset:6144
  ds_read_b128 v[76:79], v4 offset:6144
  ds_read_b128 v[92:95], v5 offset:6144
  ds_read_b64_tr_b16 v[104:105], v7 offset:0
  s_nop 0
  s_waitcnt lgkmcnt(8)
  ds_read_b64_tr_b16 v[106:107], v7 offset:2048
  ds_read_b64_tr_b16 v[108:109], v7 offset:4096
  ds_read_b64_tr_b16 v[110:111], v7 offset:6144
  s_waitcnt lgkmcnt(6)
  s_branch Lk_3
Lo_8:
  s_waitcnt lgkmcnt(0)
  s_branch Lo_7
Lx_30:
  s_mov_b64 exec, -1
  v_readfirstlane_b32 s5, v32
  s_sub_u32 s89, s89, 1
  s_cbranch_scc1 Lx_32
  buffer_load_dword v32, off, s[40:43], s13 sc0 sc1
  buffer_load_dwordx4 v[176:179], v0, s[40:43], s8 offen offset:0 sc0 sc1
  buffer_load_dwordx4 v[180:183], v0, s[40:43], s8 offen offset:2048 sc0 sc1
  buffer_load_dwordx4 v[184:187], v0, s[40:43], s9 offen offset:0 sc0 sc1
  buffer_load_dwordx4 v[188:191], v0, s[40:43], s9 offen offset:2048 sc0 sc1
  s_waitcnt vmcnt(0)
  s_cmp_lg_u32 s5, 0
  s_cbranch_scc1 Lx_32
  s_branch Lx_31
  s_nop 0
L_w1:
  s_lshl_b32 s11, s85, 12
  s_add_u32 s11, s11, 65536
  s_add_u32 s15, s11, 81920
  s_add_u32 s11, s11, 32768
  v_readfirstlane_b32 s7, v38
  s_mov_b32 s12, 0
  s_mov_b32 m0, s11
  s_waitcnt vmcnt(12)
  s_barrier
  s_branch Ll_47
Lt_54:
  s_cmp_lg_u32 s12, 2
  s_cbranch_scc1 Lt_52
  s_waitcnt vmcnt(8)
  s_barrier
  s_branch Ll_47
Lt_52:
  s_cmp_lg_u32 s12, 4
  s_cbranch_scc1 Ll_47
  s_barrier
Ll_47:
  buffer_load_dwordx4 v4, s[52:55], s7 offen offset:0  lds
  s_mov_b32 s5, s7
  buffer_load_dwordx4 v5, s[52:55], s5 offen offset:1024  lds
  s_add_u32 s12, s12, 1
  v_readlane_b32 s7, v38, s12
  s_add_u32 s11, s11, 8192
  s_nop 0
  s_cmp_eq_u32 s11, s15
  buffer_load_dwordx4 v6, s[52:55], s5 offen offset:2048  lds
  s_cselect_b32 s4, 81920, 0
  s_sub_u32 s11, s11, s4
  s_cmp_lg_u32 s12, 10
  buffer_load_dwordx4 v7, s[52:55], s5 offen offset:3072  lds
  s_mov_b32 m0, s11
  s_cbranch_scc1 Lt_54
Lt_55:
  v_mov_b32 v2, 156416
  v_mov_b32_e64 v3, 1
  s_waitcnt vmcnt(16)
  s_mov_b64 exec, 1
  ds_add_u32 v2, v3 offset:8
  s_mov_b64 exec, -1
  s_barrier
Ll_49:
  buffer_load_dwordx4 v4, s[52:55], s7 offen offset:0  lds
  s_mov_b32 s5, s7
  buffer_load_dwordx4 v5, s[52:55], s5 offen offset:1024  lds
  s_add_u32 s12, s12, 1
  v_readlane_b32 s7, v38, s12
  s_add_u32 s11, s11, 8192
  s_nop 0
  s_cmp_eq_u32 s11, s15
  buffer_load_dwordx4 v6, s[52:55], s5 offen offset:2048  lds
  s_cselect_b32 s4, 81920, 0
  s_sub_u32 s11, s11, s4
  s_cmp_lg_u32 s12, 16
  buffer_load_dwordx4 v7, s[52:55], s5 offen offset:3072  lds
  s_mov_b32 m0, s11
  s_cbranch_scc1 Ll_49
  v_lshrrev_b32 v2, 3, v1
  s_movk_i32 s4, 7168
  v_mad_u32_u24 v32, v2, s4, v10
  v_add_u32 v33, 56320, v32
  v_add_u32 v34, 112640, v32
  v_add_u32 v35, 168960, v32
  v_lshrrev_b32 v2, 2, v1
  s_movk_i32 s4, 7168
  v_mul_u32_u24_e64 v2, s4, v2
  v_bfe_u32 v3, v10, 5, 1
  v_lshl_add_u32 v2, v3, 4, v2
  v_and_b32 v3, 1, v1
  v_lshlrev_b32 v3, 5, v3
  v_add_u32_e64 v8, v2, v3
  v_add_u32 v9, 113664, v8
  s_mul_i32 s5, s77, 448
  s_and_b32 s4, s77, Lz1-Lz0+1
  s_mul_i32 s94, s4, 448
  s_sub_u32 s94, 384, s94
  s_lshl_b32 s4, s4, 6
  s_add_u32 s5, s5, s4
  s_mul_i32 s4, s85, 229376
  s_add_u32 s5, s5, s4
  s_and_b32 s4, s76, 7
  s_add_u32 s6, s4, 1
  v_cmp_lt_u32 vcc, s6, v1
  v_add_u32 v12, s4, v1
  s_nop 0
  v_subbrev_co_u32 v12, vcc, 0, v12, vcc
  v_and_b32 v12, 7, v12
  v_subrev_u32 v2, 9, v1
  v_cmp_le_u32 vcc, s4, v2
  s_nop 1
  v_addc_co_u32 v2, vcc, 8, v2, vcc
  v_cmp_le_u32 vcc, 9, v1
  s_nop 1
  v_cndmask_b32 v12, v12, v2, vcc
  s_add_u32 s4, s4, 8
  s_mov_b32 m0, s6
  s_nop 0
  v_writelane_b32 v12, s4, m0
  s_and_b32 s4, s76, 8
  v_xor_b32 v12, s4, v12
  v_cmp_eq_u32 vcc, s78, v12
  s_nop 0
  v_mov_b32_dpp v2, v12 row_shr:1 row_mask:0xf bank_mask:0xf
  s_ff1_i32_b32 s4, vcc_lo
  v_cmp_ge_u32 vcc, s4, v1
  s_nop 1
  v_cndmask_b32 v12, v12, v2, vcc
  v_writelane_b32 v12, s78, 0
  s_mov_b32 s4, 458752
  v_mul_u32_u24 v12, s4, v12
  v_add_u32 v12, s5, v12
  s_nop 0
  v_readfirstlane_b32 s7, v12
  s_lshl_b32 s11, s85, Lz1-Lz0+12
  s_add_u32 s11, s11, 65536
  s_add_u32 s15, s11, 86016
  s_lshl_b32 s4, s85, Lz1-Lz0+11
  s_sub_u32 s13, 24576, s4
  s_mul_i32 s5, s85, 6144
  s_nop 0
  s_mov_b32 s68, s28
  s_and_b32 s69, s29, 0xffff
  s_mov_b32 s70, 7340032
  s_mov_b32 s71, 0x00020000
  s_lshl_b32 s4, s76, 4
  s_add_u32 s4, s4, s77
  s_mul_i32 s34, s4, 28672
  s_add_u32 s34, s34, s5
  v_lshlrev_b32 v15, 4, v1
  s_lshl_b32 s91, s85, Lz1-Lz0+13
  s_add_u32 s91, s91, 4096
  s_mul_i32 s4, s76, 262144
  s_add_u32 s4, s4, 3145728
  s_add_u32 s4, s4, s91
  v_lshl_add_u32 v14, v39, 14, s4
  s_mov_b32 s12, 4
Lh_56:
  v_readlane_b32 s90, v14, s12
  s_mov_b32 m0, s91
  s_cmp_lt_u32 s12, Lz1-Lz0+7
  s_cbranch_scc1 Lh_57
  s_waitcnt vmcnt(8)
Lh_57:
  s_barrier
  buffer_load_dwordx4 v15, s[40:43], s90 offen offset:0 sc1 lds
  s_add_u32 s91, s91, 16384
  s_and_b32 s91, s91, 0xffff
  buffer_load_dwordx4 v15, s[40:43], s90 offen offset:1024 sc1 lds
  s_add_u32 s12, s12, 1
  s_cmp_lg_u32 s12, 16
  buffer_load_dwordx4 v15, s[40:43], s90 offen offset:2048 sc1 lds
  buffer_load_dwordx4 v15, s[40:43], s90 offen offset:3072 sc1 lds
  s_cbranch_scc1 Lh_56
  s_mov_b32 s12, 0
  s_mov_b32 m0, s11
  s_branch Ll_58
Lt_64:
  s_cmp_lg_u32 s12, 1
  s_cbranch_scc1 Ll_58
  s_waitcnt vmcnt(18)
  s_barrier
Ll_58:
  buffer_load_dwordx4 v32, s[56:59], s7 offen offset:0  lds
  buffer_load_dwordx4 v33, s[56:59], s7 offen offset:1024  lds
  buffer_load_dwordx4 v34, s[56:59], s7 offen offset:2048  lds
  buffer_load_dwordx4 v35, s[56:59], s7 offen offset:3072  lds
  s_add_u32 m0, s11, s13
  s_add_u32 s5, s7, s94
  buffer_load_dwordx4 v8, s[56:59], s5 offen offset:0  lds
  buffer_load_dwordx4 v9, s[56:59], s5 offen offset:1024  lds
  s_cmp_ge_u32 s12, Lz1-Lz0+2
  s_cbranch_scc1 Lm_65
  s_waitcnt vmcnt(20)
  s_cmp_lg_u32 s12, 0
  s_cbranch_scc1 Lm_66
  s_waitcnt vmcnt(14)
Lm_66:
  s_barrier
Lm_65:
  s_add_u32 m0, s11, 8192
  s_add_u32 s5, s7, 128
  buffer_load_dwordx4 v32, s[56:59], s5 offen offset:0  lds
  buffer_load_dwordx4 v33, s[56:59], s5 offen offset:1024  lds
  buffer_load_dwordx4 v34, s[56:59], s5 offen offset:2048  lds
  buffer_load_dwordx4 v35, s[56:59], s5 offen offset:3072  lds
  s_add_u32 m0, s11, 16384
  s_add_u32 s5, s7, 256
  buffer_load_dwordx4 v32, s[56:59], s5 offen offset:0  lds
  s_add_u32 s12, s12, Lz1-Lz0+1
  v_readlane_b32 s7, v12, s12
  s_add_u32 s11, s11, 28672
  buffer_load_dwordx4 v33, s[56:59], s5 offen offset:1024  lds
  s_cmp_eq_u32 s11, s15
  s_cselect_b32 s4, 86016, 0
  s_sub_u32 s11, s11, s4
  buffer_load_dwordx4 v34, s[56:59], s5 offen offset:2048  lds
  s_cmp_lg_u32 s12, Lz1-Lz0+2
  buffer_load_dwordx4 v35, s[56:59], s5 offen offset:3072  lds
  s_mov_b32 m0, s11
  s_cbranch_scc1 Ll_59
  s_barrier
Lt_67:
  s_waitcnt vmcnt(0)
  s_barrier
Ll_68:
Ll_59:
  s_cmp_lt_u32 s12, 3
  s_cbranch_scc1 Lt_64
  s_cmp_lg_u32 s82, 0
  s_cbranch_scc1 L_69
  s_lshl_b32 s5, s78, 7
  s_mul_i32 s4, s79, 3670016
  s_add_u32 s5, s5, s4
  v_subrev_u32 v2, 2, v1
  v_cmp_le_u32 vcc, 28, v1
  s_nop 1
  v_cndmask_b32 v37, v1, v2, vcc
  v_subrev_u32 v3, 3, v37
  v_mov_b32 v36, 4
  v_cmp_le_u32 vcc, 14, v37
  v_subrev_u32 v2, 14, v37
  s_nop 0
  v_cndmask_b32_e64 v3, v3, v2, vcc
  v_cndmask_b32_e64 v36, v36, 12, vcc
  v_cmp_le_u32 vcc, 21, v37
  v_subrev_u32 v2, 21, v37
  s_nop 0
  v_cndmask_b32 v3, v3, v2, vcc
  v_cndmask_b32_e64 v36, v36, 20, vcc
  s_sub_u32 s4, s80, s76
  s_and_b32 s4, s4, 7
  v_cmp_le_u32 vcc, s4, v3
  v_mov_b32 v2, s76
  s_nop 0
  v_addc_co_u32 v3, vcc, v3, v2, vcc
  v_and_b32 v3, 7, v3
  v_add_u32 v36, v36, v3
  v_add_u32 v2, v2, v1
  v_and_b32 v2, 3, v2
  v_subrev_u32 v3, 10, v1
  v_cmp_gt_u32 vcc, 4, v3
  s_nop 1
  v_cndmask_b32 v36, v36, v2, vcc
  s_add_u32 s4, s80, Lz1-Lz0+4
  v_lshl_add_u32 v2, v1, 3, s4
  v_cmp_gt_u32 vcc, 3, v1
  s_nop 1
  v_cndmask_b32 v36, v36, v2, vcc
  v_subrev_u32 v2, 4, v36
  v_and_b32 v3, 7, v2
  v_lshrrev_b32 v2, 3, v2
  v_mad_u32_u24 v2, v3, 7, v2
  v_and_b32 v3, 1, v3
  v_add_u32 v2, v2, v3
  s_mul_i32 s4, s85, 3
  v_add_u32 v2, s4, v2
  s_add_u32 s4, s85, Lz1-Lz0+6
  v_mad_u32_u24 v3, v36, 14, s4
  v_cmp_gt_u32 vcc, 4, v36
  s_nop 1
  v_cndmask_b32_e64 v2, v2, v3, vcc
  v_lshl_add_u32 v36, v2, 16, s5
  s_mul_i32 s4, s79, 7340032
  s_sub_u32 s4, 3670016, s4
  v_add_u32 v2, s4, v36
  v_cmp_le_u32 vcc, 28, v1
  s_nop 1
  v_cndmask_b32 v36, v36, v2, vcc
L_69:
  s_waitcnt vmcnt(14)
  s_barrier
  buffer_load_dwordx4 v32, s[56:59], s7 offen offset:0  lds
  buffer_load_dwordx4 v33, s[56:59], s7 offen offset:1024  lds
  buffer_load_dwordx4 v34, s[56:59], s7 offen offset:2048  lds
  buffer_load_dwordx4 v35, s[56:59], s7 offen offset:3072  lds
Ll_70:
  s_add_u32 m0, s11, s13
  s_add_u32 s5, s7, s94
  buffer_load_dwordx4 v8, s[56:59], s5 offen offset:0  lds
  buffer_load_dwordx4 v9, s[56:59], s5 offen offset:1024  lds
  s_add_u32 m0, s11, 8192
  s_add_u32 s5, s7, 128
  buffer_load_dwordx4 v32, s[56:59], s5 offen offset:0  lds
  buffer_load_dwordx4 v33, s[56:59], s5 offen offset:1024  lds
  buffer_load_dwordx4 v34, s[56:59], s5 offen offset:2048  lds
  buffer_load_dwordx4 v35, s[56:59], s5 offen offset:3072  lds
  s_add_u32 m0, s11, 16384
  s_add_u32 s5, s7, 256
  buffer_load_dwordx4 v32, s[56:59], s5 offen offset:0  lds
  s_add_u32 s12, s12, Lz1-Lz0+1
  v_readlane_b32 s7, v12, s12
  s_add_u32 s11, s11, 28672
  buffer_load_dwordx4 v33, s[56:59], s5 offen offset:1024  lds
  s_cmp_eq_u32 s11, s15
  s_cselect_b32 s4, 86016, 0
  s_sub_u32 s11, s11, s4
  buffer_load_dwordx4 v34, s[56:59], s5 offen offset:2048  lds
  s_cmp_eq_u32 s12, Lz1-Lz0+16
  buffer_load_dwordx4 v35, s[56:59], s5 offen offset:3072  lds
  s_mov_b32 m0, s11
  s_cbranch_scc1 Ll_71
  s_cmp_lg_u32 s82, 0
  s_cbranch_scc1 L_72
  s_buffer_load_dwordx2 s[98:99], s[68:71], s34 offset:60
  s_buffer_load_dwordx2 s[98:99], s[68:71], s34 offset:188
  s_buffer_load_dwordx2 s[98:99], s[68:71], s34 offset:316
  s_buffer_load_dwordx2 s[98:99], s[68:71], s34 offset:444
  s_add_u32 s34, s34, 512
L_72:
  s_waitcnt vmcnt(14)
  s_barrier
  buffer_load_dwordx4 v32, s[56:59], s7 offen offset:0  lds
  buffer_load_dwordx4 v33, s[56:59], s7 offen offset:1024  lds
  buffer_load_dwordx4 v34, s[56:59], s7 offen offset:2048  lds
  buffer_load_dwordx4 v35, s[56:59], s7 offen offset:3072  lds
  s_branch Ll_70
Ll_71:
  s_lshl_b32 s94, s79, 8
  s_sub_u32 s94, 128, s94
  s_lshl_b32 s11, s85, Lz1-Lz0+12
  s_add_u32 s11, s11, 65536
  s_add_u32 s15, s11, 81920
  s_add_u32 s11, s11, 49152
  v_readfirstlane_b32 s7, v36
  s_mov_b32 s12, 0
  s_mov_b32 m0, s11
  s_waitcnt vmcnt(14)
  s_barrier
  s_waitcnt vmcnt(0)
  s_barrier
  s_branch Ll_73
  s_nop 0
Lt_79:
  s_cmp_lg_u32 s12, 2
  s_cbranch_scc1 Ll_73
  s_barrier
Ll_73:
  buffer_load_dwordx4 v4, s[60:63], s7 offen offset:0  lds
  buffer_load_dwordx4 v5, s[60:63], s7 offen offset:1024  lds
  buffer_load_dwordx4 v6, s[60:63], s7 offen offset:2048  lds
  buffer_load_dwordx4 v7, s[60:63], s7 offen offset:3072  lds
  s_add_u32 m0, s11, 8192
  s_add_u32 s5, s7, s94
  buffer_load_dwordx4 v4, s[60:63], s5 offen offset:0  lds
  s_add_u32 s12, s12, 1
  v_readlane_b32 s7, v36, s12
  s_add_u32 s11, s11, 16384
  buffer_load_dwordx4 v5, s[60:63], s5 offen offset:1024  lds
  s_cmp_eq_u32 s11, s15
  s_cselect_b32 s4, 81920, 0
  s_sub_u32 s11, s11, s4
  buffer_load_dwordx4 v6, s[60:63], s5 offen offset:2048  lds
  s_cmp_lg_u32 s12, Lz1-Lz0+5
  buffer_load_dwordx4 v7, s[60:63], s5 offen offset:3072  lds
  s_mov_b32 m0, s11
  s_cbranch_scc1 Lt_79
Lt_80:
  s_cmp_lg_u32 s82, 0
  s_cbranch_scc1 L_81
  v_lshrrev_b32 v2, 3, v1
  s_movk_i32 s4, 6144
  v_mad_u32_u24 v16, v2, s4, v10
  v_add_u32 v17, 48128, v16
  v_add_u32 v18, 96256, v16
  v_add_u32 v19, 144384, v16
  s_lshl_b32 s5, s77, Lz1-Lz0+7
  s_mul_i32 s4, s85, 196608
  s_add_u32 s5, s5, s4
  s_and_b32 s4, s76, 7
  s_add_u32 s6, s4, 1
  v_cmp_lt_u32 vcc, s6, v1
  v_add_u32 v20, s4, v1
  s_nop 0
  v_subbrev_co_u32 v20, vcc, 0, v20, vcc
  v_and_b32 v20, 7, v20
  v_subrev_u32 v2, 9, v1
  v_cmp_le_u32 vcc, s4, v2
  s_nop 1
  v_addc_co_u32 v2, vcc, 8, v2, vcc
  v_cmp_le_u32 vcc, 9, v1
  s_nop 1
  v_cndmask_b32 v20, v20, v2, vcc
  s_add_u32 s4, s4, 8
  s_mov_b32 m0, s6
  s_nop 0
  v_writelane_b32 v20, s4, m0
  s_and_b32 s4, s76, 8
  v_xor_b32 v20, s4, v20
  v_cmp_eq_u32 vcc, s78, v20
  s_nop 0
  v_mov_b32_dpp v2, v20 row_shr:1 row_mask:0xf bank_mask:0xf
  s_ff1_i32_b32 s4, vcc_lo
  v_cmp_ge_u32 vcc, s4, v1
  s_nop 1
  v_cndmask_b32 v20, v20, v2, vcc
  v_writelane_b32 v20, s78, 0
  s_mov_b32 s4, 393216
  v_mul_u32_u24_e64 v20, s4, v20
  v_add_u32 v20, s5, v20
  s_mov_b32 m0, s11
L_81:
  s_waitcnt vmcnt(32)
  s_barrier
Ll_82:
  s_waitcnt vmcnt(24)
  s_barrier
  buffer_load_dwordx4 v4, s[60:63], s7 offen offset:0  lds
  buffer_load_dwordx4 v5, s[60:63], s7 offen offset:1024  lds
  buffer_load_dwordx4 v6, s[60:63], s7 offen offset:2048  lds
  buffer_load_dwordx4 v7, s[60:63], s7 offen offset:3072  lds
Ll_83:
  s_add_u32 m0, s11, 8192
  s_add_u32 s5, s7, s94
  buffer_load_dwordx4 v4, s[60:63], s5 offen offset:0  lds
  s_add_u32 s12, s12, 1
  v_readlane_b32 s7, v36, s12
  s_add_u32 s11, s11, 16384
  buffer_load_dwordx4 v5, s[60:63], s5 offen offset:1024  lds
  s_cmp_eq_u32 s11, s15
  s_cselect_b32 s4, 81920, 0
  s_sub_u32 s11, s11, s4
  buffer_load_dwordx4 v6, s[60:63], s5 offen offset:2048  lds
  s_cmp_eq_u32 s12, Lz1-Lz0+26
  buffer_load_dwordx4 v7, s[60:63], s5 offen offset:3072  lds
  s_mov_b32 m0, s11
  s_cbranch_scc1 Ll_84
  s_waitcnt vmcnt(24)
  s_barrier
  buffer_load_dwordx4 v4, s[60:63], s7 offen offset:0  lds
  buffer_load_dwordx4 v5, s[60:63], s7 offen offset:1024  lds
  buffer_load_dwordx4 v6, s[60:63], s7 offen offset:2048  lds
  buffer_load_dwordx4 v7, s[60:63], s7 offen offset:3072  lds
  s_branch Ll_83
  s_nop 0
Ll_84:
  s_waitcnt vmcnt(24)
  s_barrier
  buffer_load_dwordx4 v4, s[60:63], s7 offen offset:0  lds
Ll_85:
  s_mov_b32 s5, s7
  buffer_load_dwordx4 v5, s[60:63], s5 offen offset:1024  lds
  s_add_u32 s12, s12, 1
  v_readlane_b32 s7, v36, s12
  s_add_u32 s11, s11, 16384
  s_nop 0
  s_cmp_eq_u32 s11, s15
  buffer_load_dwordx4 v6, s[60:63], s5 offen offset:2048  lds
  s_cselect_b32 s4, 81920, 0
  s_sub_u32 s11, s11, s4
  s_cmp_eq_u32 s12, 30
  buffer_load_dwordx4 v7, s[60:63], s5 offen offset:3072  lds
  s_mov_b32 m0, s11
  s_cbranch_scc1 Ll_86
  s_waitcnt vmcnt(12)
  s_barrier
  buffer_load_dwordx4 v4, s[60:63], s7 offen offset:0  lds
  s_branch Ll_85
  s_nop 0
Ll_86:
  v_readfirstlane_b32 s7, v20
  s_lshl_b32 s11, s85, 12
  s_add_u32 s11, s11, 65536
  s_add_u32 s15, s11, 73728
  s_cmp_eq_u32 s82, 0
  s_mov_b32 s82, 1
  s_cbranch_scc1 L_wlayer
  s_waitcnt vmcnt(12)
  s_barrier
  s_waitcnt vmcnt(8)
  s_barrier
  s_waitcnt vmcnt(4)
  s_barrier
  s_waitcnt vmcnt(0)
  s_barrier
  s_barrier
  s_branch L_lend
  s_nop 0
L_x1:
  s_and_b32 s4, s77, 7
  s_lshr_b32 s5, s77, 3
  s_lshl1_add_u32 s4, s4, s5
  s_lshl_b32 s5, s76, 11
  s_add_u32 s4, s4, s5
  s_lshl_b32 s7, s4, 7
  s_movk_i32 s11, 16384
  s_mov_b32 m0, s11
  s_cmp_eq_u32 s82, 0
  s_waitcnt vmcnt(16)
  s_barrier
  s_cbranch_scc1 L_96
  s_waitcnt vmcnt(0)
  s_barrier
  s_barrier
  s_branch L_97
L_96:
  buffer_load_dwordx4 v4, s[72:75], s7 offen offset:0 sc1 lds
  buffer_load_dwordx4 v5, s[72:75], s7 offen offset:1024 sc1 lds
  buffer_load_dwordx4 v6, s[72:75], s7 offen offset:2048 sc1 lds
  buffer_load_dwordx4 v7, s[72:75], s7 offen offset:3072 sc1 lds
  s_add_u32 m0, s11, 4096
  s_nop 0
  s_add_u32 s5, s7, s13
  buffer_load_dwordx4 v4, s[72:75], s5 offen offset:0 sc1 lds
  buffer_load_dwordx4 v5, s[72:75], s5 offen offset:1024 sc1 lds
  buffer_load_dwordx4 v6, s[72:75], s5 offen offset:2048 sc1 lds
  buffer_load_dwordx4 v7, s[72:75], s5 offen offset:3072 sc1 lds
  s_add_u32 m0, s11, 8192
  s_nop 0
  s_add_u32 s3, s7, s95
  buffer_load_dwordx4 v4, s[72:75], s3 offen offset:0 sc1 lds
  buffer_load_dwordx4 v5, s[72:75], s3 offen offset:1024 sc1 lds
  buffer_load_dwordx4 v6, s[72:75], s3 offen offset:2048 sc1 lds
  buffer_load_dwordx4 v7, s[72:75], s3 offen offset:3072 sc1 lds
  s_add_u32 m0, s11, 12288
  s_nop 0
  s_add_u32 s5, s3, s13
  buffer_load_dwordx4 v4, s[72:75], s5 offen offset:0 sc1 lds
  buffer_load_dwordx4 v5, s[72:75], s5 offen offset:1024 sc1 lds
  buffer_load_dwordx4 v6, s[72:75], s5 offen offset:2048 sc1 lds
  buffer_load_dwordx4 v7, s[72:75], s5 offen offset:3072 sc1 lds
  s_waitcnt vmcnt(16)
  s_barrier
  s_waitcnt vmcnt(0)
  s_barrier
L_97:
  s_cmp_lg_u32 s82, 0
  s_cbranch_scc1 L_98
  s_and_b32 s80, s77, 7
  s_lshr_b32 s79, s77, 3
  s_lshl_b32 s78, s80, 1
  s_add_u32 s78, s78, s79
  s_lshl_b32 s5, s76, 4
  s_add_u32 s5, s5, s77
  s_lshl_b32 s84, s5, Lz1-Lz0+11
  s_mov_b32 s83, 3145728
  s_mov_b32 s87, 1835016
  s_lshr_b32 s86, s81, 1
  v_lshlrev_b32 v4, 4, v1
  v_lshlrev_b32 v5, 4, v1
  v_lshlrev_b32 v6, 4, v1
  v_lshlrev_b32 v7, 4, v1
  s_movk_i32 s13, 4096
  s_movk_i32 s95, 8192
  v_and_b32 v2, 31, v1
  v_lshlrev_b32 v8, 7, v2
L_98:
  s_mov_b32 s40, s38
  s_and_b32 s41, s39, 0xffff
  s_mov_b32 s42, 100663296
  s_mov_b32 s43, 0x00020000
  s_mov_b32 s72, s40
  s_mov_b32 s73, s41
  s_mov_b32 s74, s42
  s_mov_b32 s11, 0
  s_mov_b32 s15, 65536
  s_mul_i32 s5, s76, 16
  s_lshl_b32 s5, s5, 14
  s_add_u32 s5, s5, 3145728
  s_mul_i32 s4, s76, 14
  s_lshr_b32 s4, s4, 4
  v_add_u32 v9, s4, v1
  v_subrev_u32 v2, 14, v9
  v_min_u32 v9, v9, v2
  v_cmp_le_u32 vcc, 14, v1
  s_nop 1
  v_cndmask_b32 v9, v9, v1, vcc
  v_lshlrev_b32_e64 v9, 2, v9
  v_mov_b32 v2, 0x87654210
  v_mov_b32 v3, 0xb3fedca9
  v_lshrrev_b64 v[2:3], v9, v[2:3]
  v_and_b32_e64 v9, 15, v2
  v_cmp_eq_u32 vcc, s77, v9
  s_nop 0
  v_mov_b32_dpp v2, v9 row_shr:1 row_mask:0xf bank_mask:0xf
  s_ff1_i32_b32 s4, vcc_lo
  v_cmp_ge_u32 vcc, s4, v1
  s_nop 1
  v_cndmask_b32 v9, v9, v2, vcc
  v_writelane_b32 v9, s77, 0
  v_lshlrev_b32 v11, 7, v9
  v_lshl_add_u32 v9, v9, 14, s5
  s_nop 0
  v_readlane_b32 s7, v9, 1
  s_mov_b32 s11, 16384
  s_mov_b32 s90, 0xfe
  s_lshl_b32 s91, s84, Lz1-Lz0+1
  s_add_u32 s91, s91, s87
  s_barrier
  s_mov_b32 s89, 200000
  s_mov_b32 exec_lo, s90
  s_mov_b32 exec_hi, 0
  buffer_load_dword v12, v11, s[40:43], s91 offen sc0 sc1
Lp_99:
  s_waitcnt vmcnt(0)
  v_cmp_ne_u32 vcc, 0, v12
  s_andn2_b32 s3, exec_lo, vcc_lo
  s_cbranch_scc0 Lp_100
  s_mov_b32 exec_lo, s3
  s_sleep 1
  buffer_load_dword v12, v11, s[40:43], s91 offen sc0 sc1
  s_sub_u32 s89, s89, 1
  s_cbranch_scc0 Lp_99
Lp_100:
  s_mov_b64 exec, -1
  s_mov_b32 s12, 1
  s_mov_b32 m0, s11
Ll_102:
  s_nop 0
  buffer_load_dwordx4 v4, s[40:43], s7 offen offset:0 sc1 lds
  buffer_load_dwordx4 v5, s[40:43], s7 offen offset:1024 sc1 lds
  buffer_load_dwordx4 v6, s[40:43], s7 offen offset:2048 sc1 lds
  buffer_load_dwordx4 v7, s[40:43], s7 offen offset:3072 sc1 lds
  s_add_u32 m0, s11, 4096
  s_nop 0
  s_add_u32 s5, s7, s13
  buffer_load_dwordx4 v4, s[40:43], s5 offen offset:0 sc1 lds
  buffer_load_dwordx4 v5, s[40:43], s5 offen offset:1024 sc1 lds
  buffer_load_dwordx4 v6, s[40:43], s5 offen offset:2048 sc1 lds
  buffer_load_dwordx4 v7, s[40:43], s5 offen offset:3072 sc1 lds
  s_add_u32 m0, s11, 8192
  s_nop 0
  s_add_u32 s3, s7, s95
  buffer_load_dwordx4 v4, s[40:43], s3 offen offset:0 sc1 lds
  buffer_load_dwordx4 v5, s[40:43], s3 offen offset:1024 sc1 lds
  buffer_load_dwordx4 v6, s[40:43], s3 offen offset:2048 sc1 lds
  buffer_load_dwordx4 v7, s[40:43], s3 offen offset:3072 sc1 lds
  s_add_u32 m0, s11, 12288
  s_add_u32 s5, s3, s13
  buffer_load_dwordx4 v4, s[40:43], s5 offen offset:0 sc1 lds
  s_add_u32 s12, s12, 1
  v_readlane_b32 s7, v9, s12
  s_add_u32 s11, s11, 16384
  buffer_load_dwordx4 v5, s[40:43], s5 offen offset:1024 sc1 lds
  s_cmp_eq_u32 s11, s15
  s_cselect_b32 s4, 65536, 0
  s_sub_u32 s11, s11, s4
  buffer_load_dwordx4 v6, s[40:43], s5 offen offset:2048 sc1 lds
  s_cmp_lg_u32 s12, Lz1-Lz0+4
  buffer_load_dwordx4 v7, s[40:43], s5 offen offset:3072 sc1 lds
  s_mov_b32 m0, s11
  s_cbranch_scc1 Ll_102
  s_waitcnt vmcnt(32)
  s_barrier
  buffer_load_dwordx4 v4, s[40:43], s7 offen offset:0 sc1 lds
  buffer_load_dwordx4 v5, s[40:43], s7 offen offset:1024 sc1 lds
  buffer_load_dwordx4 v6, s[40:43], s7 offen offset:2048 sc1 lds
  buffer_load_dwordx4 v7, s[40:43], s7 offen offset:3072 sc1 lds
  s_add_u32 m0, s11, 8192
  s_add_u32 s3, s7, s95
  buffer_load_dwordx4 v4, s[40:43], s3 offen offset:0 sc1 lds
  s_add_u32 s12, s12, 1
  v_readlane_b32 s7, v9, s12
  buffer_load_dwordx4 v5, s[40:43], s3 offen offset:1024 sc1 lds
  s_add_u32 s11, s11, 16384
  s_nop 0
  s_cmp_eq_u32 s11, s15
  buffer_load_dwordx4 v6, s[40:43], s3 offen offset:2048 sc1 lds
  s_cselect_b32 s4, 65536, 0
  s_sub_u32 s11, s11, s4
  buffer_load_dwordx4 v7, s[40:43], s3 offen offset:3072 sc1 lds
  s_mov_b32 m0, s11
  s_waitcnt vmcnt(24)
  s_barrier
  buffer_load_dwordx4 v4, s[40:43], s7 offen offset:0 sc1 lds
  buffer_load_dwordx4 v5, s[40:43], s7 offen offset:1024 sc1 lds
  buffer_load_dwordx4 v6, s[40:43], s7 offen offset:2048 sc1 lds
  buffer_load_dwordx4 v7, s[40:43], s7 offen offset:3072 sc1 lds
Ll_107:
  s_add_u32 m0, s11, 8192
  s_add_u32 s3, s7, s95
  buffer_load_dwordx4 v4, s[40:43], s3 offen offset:0 sc1 lds
  s_add_u32 s12, s12, 1
  v_readlane_b32 s7, v9, s12
  s_add_u32 s11, s11, 16384
  buffer_load_dwordx4 v5, s[40:43], s3 offen offset:1024 sc1 lds
  s_cmp_eq_u32 s11, s15
  s_cselect_b32 s4, 65536, 0
  s_sub_u32 s11, s11, s4
  buffer_load_dwordx4 v6, s[40:43], s3 offen offset:2048 sc1 lds
  s_cmp_eq_u32 s12, Lz1-Lz0+16
  buffer_load_dwordx4 v7, s[40:43], s3 offen offset:3072 sc1 lds
  s_mov_b32 m0, s11
  s_cbranch_scc1 Ll_108
  s_waitcnt vmcnt(16)
  s_barrier
  buffer_load_dwordx4 v4, s[40:43], s7 offen offset:0 sc1 lds
  buffer_load_dwordx4 v5, s[40:43], s7 offen offset:1024 sc1 lds
  buffer_load_dwordx4 v6, s[40:43], s7 offen offset:2048 sc1 lds
  buffer_load_dwordx4 v7, s[40:43], s7 offen offset:3072 sc1 lds
  s_branch Ll_107
  s_nop 0
Ll_108:
  s_waitcnt vmcnt(16)
  s_barrier
  s_waitcnt vmcnt(8)
  s_barrier
  s_waitcnt vmcnt(0)
  s_barrier
  s_barrier
  s_mov_b32 s11, 0
  s_mov_b32 s15, 65536
  s_mul_i32 s5, s76, 16
  s_lshl_b32 s5, s5, 14
  s_add_u32 s5, s5, 7340032
  s_and_b32 s4, s76, 7
  s_add_u32 s6, s4, 1
  v_cmp_lt_u32 vcc, s6, v1
  v_add_u32 v9, s4, v1
  s_nop 0
  v_subbrev_co_u32 v9, vcc, 0, v9, vcc
  v_and_b32 v9, 7, v9
  v_subrev_u32 v2, 9, v1
  v_cmp_le_u32 vcc, s4, v2
  s_nop 1
  v_addc_co_u32 v2, vcc, 8, v2, vcc
  v_cmp_le_u32 vcc, 9, v1
  s_nop 1
  v_cndmask_b32 v9, v9, v2, vcc
  s_add_u32 s4, s4, Lz1-Lz0+8
  s_mov_b32 m0, s6
  s_nop 0
  v_writelane_b32 v9, s4, m0
  s_and_b32 s4, s76, 8
  v_xor_b32 v9, s4, v9
  v_cmp_eq_u32 vcc, s78, v9
  s_nop 0
  v_mov_b32_dpp v2, v9 row_shr:1 row_mask:0xf bank_mask:0xf
  s_ff1_i32_b32 s4, vcc_lo
  v_cmp_ge_u32 vcc, s4, v1
  s_nop 1
  v_cndmask_b32 v9, v9, v2, vcc
  v_writelane_b32 v9, s78, 0
  v_lshlrev_b32_e64 v11, 7, v9
  v_lshl_add_u32 v9, v9, 14, s5
  s_lshl_b32 s6, s76, Lz1-Lz0+14
  v_readlane_b32 s7, v9, 1
  s_mov_b32 s11, 16384
  s_mov_b32 s90, Lz1-Lz0+62
  s_add_u32 s91, s91, 4
  s_barrier
  s_mov_b32 s89, 200000
  s_mov_b32 exec_lo, s90
  s_mov_b32 exec_hi, 0
  buffer_load_dword v12, v11, s[40:43], s91 offen sc0 sc1
Lp_109:
  s_waitcnt vmcnt(0)
  v_cmp_ne_u32 vcc, 0, v12
  s_andn2_b32 s3, exec_lo, vcc_lo
  s_cbranch_scc0 Lp_110
  s_mov_b32 exec_lo, s3
  s_sleep 1
  buffer_load_dword v12, v11, s[40:43], s91 offen sc0 sc1
  s_sub_u32 s89, s89, 1
  s_cbranch_scc0 Lp_109
Lp_110:
  s_mov_b64 exec, -1
  s_mov_b32 s12, 1
  s_mov_b32 m0, s11
Ll_112:
  s_nop 0
  buffer_load_dwordx4 v4, s[72:75], s7 offen offset:0 sc1 lds
  buffer_load_dwordx4 v5, s[72:75], s7 offen offset:1024 sc1 lds
  buffer_load_dwordx4 v6, s[72:75], s7 offen offset:2048 sc1 lds
  buffer_load_dwordx4 v7, s[72:75], s7 offen offset:3072 sc1 lds
  s_add_u32 m0, s11, 4096
  s_nop 0
  s_add_u32 s5, s7, s13
  buffer_load_dwordx4 v4, s[72:75], s5 offen offset:0 sc1 lds
  buffer_load_dwordx4 v5, s[72:75], s5 offen offset:1024 sc1 lds
  buffer_load_dwordx4 v6, s[72:75], s5 offen offset:2048 sc1 lds
  buffer_load_dwordx4 v7, s[72:75], s5 offen offset:3072 sc1 lds
  s_add_u32 m0, s11, 8192
  s_nop 0
  s_add_u32 s3, s7, s95
  buffer_load_dwordx4 v4, s[72:75], s3 offen offset:0 sc1 lds
  buffer_load_dwordx4 v5, s[72:75], s3 offen offset:1024 sc1 lds
  buffer_load_dwordx4 v6, s[72:75], s3 offen offset:2048 sc1 lds
  buffer_load_dwordx4 v7, s[72:75], s3 offen offset:3072 sc1 lds
  s_add_u32 m0, s11, 12288
  s_add_u32 s5, s3, s13
  buffer_load_dwordx4 v4, s[72:75], s5 offen offset:0 sc1 lds
  s_add_u32 s12, s12, 1
  v_readlane_b32 s7, v9, s12
  s_add_u32 s11, s11, 16384
  buffer_load_dwordx4 v5, s[72:75], s5 offen offset:1024 sc1 lds
  s_cmp_eq_u32 s11, s15
  s_cselect_b32 s4, 65536, 0
  s_sub_u32 s11, s11, s4
  buffer_load_dwordx4 v6, s[72:75], s5 offen offset:2048 sc1 lds
  s_cmp_lg_u32 s12, Lz1-Lz0+4
  buffer_load_dwordx4 v7, s[72:75], s5 offen offset:3072 sc1 lds
  s_mov_b32 m0, s11
  s_cbranch_scc1 Ll_112
  s_waitcnt vmcnt(32)
  s_barrier
  buffer_load_dwordx4 v4, s[72:75], s7 offen offset:0 sc1 lds
  buffer_load_dwordx4 v5, s[72:75], s7 offen offset:1024 sc1 lds
  buffer_load_dwordx4 v6, s[72:75], s7 offen offset:2048 sc1 lds
  buffer_load_dwordx4 v7, s[72:75], s7 offen offset:3072 sc1 lds
Ll_117:
  s_add_u32 m0, s11, 4096
  s_nop 0
  s_add_u32 s5, s7, s13
  buffer_load_dwordx4 v4, s[72:75], s5 offen offset:0 sc1 lds
  buffer_load_dwordx4 v5, s[72:75], s5 offen offset:1024 sc1 lds
  buffer_load_dwordx4 v6, s[72:75], s5 offen offset:2048 sc1 lds
  buffer_load_dwordx4 v7, s[72:75], s5 offen offset:3072 sc1 lds
  s_add_u32 m0, s11, 8192
  s_nop 0
  s_add_u32 s3, s7, s95
  buffer_load_dwordx4 v4, s[72:75], s3 offen offset:0 sc1 lds
  buffer_load_dwordx4 v5, s[72:75], s3 offen offset:1024 sc1 lds
  buffer_load_dwordx4 v6, s[72:75], s3 offen offset:2048 sc1 lds
  buffer_load_dwordx4 v7, s[72:75], s3 offen offset:3072 sc1 lds
  s_add_u32 m0, s11, 12288
  s_add_u32 s5, s3, s13
  buffer_load_dwordx4 v4, s[72:75], s5 offen offset:0 sc1 lds
  s_add_u32 s12, s12, 1
  v_readlane_b32 s7, v9, s12
  s_add_u32 s11, s11, 16384
  buffer_load_dwordx4 v5, s[72:75], s5 offen offset:1024 sc1 lds
  s_cmp_eq_u32 s11, s15
  s_cselect_b32 s4, 65536, 0
  s_sub_u32 s11, s11, s4
  buffer_load_dwordx4 v6, s[72:75], s5 offen offset:2048 sc1 lds
  s_cmp_eq_u32 s12, Lz1-Lz0+16
  buffer_load_dwordx4 v7, s[72:75], s5 offen offset:3072 sc1 lds
  s_mov_b32 m0, s11
  s_cbranch_scc1 Ll_118
  s_waitcnt vmcnt(32)
  s_barrier
  buffer_load_dwordx4 v4, s[72:75], s7 offen offset:0 sc1 lds
  buffer_load_dwordx4 v5, s[72:75], s7 offen offset:1024 sc1 lds
  buffer_load_dwordx4 v6, s[72:75], s7 offen offset:2048 sc1 lds
  buffer_load_dwordx4 v7, s[72:75], s7 offen offset:3072 sc1 lds
  s_branch Ll_117
  s_nop 0
Ll_118:
  s_waitcnt vmcnt(32)
  s_barrier
  s_waitcnt vmcnt(16)
  s_barrier
  s_waitcnt vmcnt(0)
  s_barrier
  s_barrier
  s_mov_b32 s11, 0
  s_mov_b32 s15, 65536
  s_mul_i32 s5, s76, 56
  s_mul_i32 s4, s79, 28
  s_add_u32 s5, s5, s4
  s_lshl_b32 s5, s5, 14
  s_add_u32 s5, s5, 11534336
  v_subrev_u32 v2, 2, v1
  v_cmp_le_u32 vcc, 28, v1
  s_nop 1
  v_cndmask_b32 v10, v1, v2, vcc
  v_subrev_u32 v3, 3, v10
  v_mov_b32 v9, 4
  v_cmp_le_u32 vcc, 14, v10
  v_subrev_u32 v2, 14, v10
  s_nop 0
  v_cndmask_b32 v3, v3, v2, vcc
  v_cndmask_b32_e64 v9, v9, 12, vcc
  v_cmp_le_u32 vcc, 21, v10
  v_subrev_u32 v2, 21, v10
  s_nop 0
  v_cndmask_b32 v3, v3, v2, vcc
  v_cndmask_b32_e64 v9, v9, 20, vcc
  s_sub_u32 s4, s80, s76
  s_and_b32 s4, s4, 7
  v_cmp_le_u32 vcc, s4, v3
  v_mov_b32 v2, s76
  s_nop 0
  v_addc_co_u32 v3, vcc, v3, v2, vcc
  v_and_b32 v3, 7, v3
  v_add_u32 v9, v9, v3
  v_add_u32 v2, v2, v1
  v_and_b32 v2, 3, v2
  v_subrev_u32 v3, 10, v1
  v_cmp_gt_u32 vcc, 4, v3
  s_nop 1
  v_cndmask_b32 v9, v9, v2, vcc
  s_add_u32 s4, s80, Lz1-Lz0+4
  v_lshl_add_u32 v2, v1, 3, s4
  v_cmp_gt_u32 vcc, 3, v1
  s_nop 1
  v_cndmask_b32_e64 v9, v9, v2, vcc
  v_lshl_add_u32 v9, v9, 14, s5
  s_mul_i32 s4, s79, 917504
  s_sub_u32 s4, 458752, s4
  v_add_u32_e64 v2, s4, v9
  v_cmp_le_u32 vcc, 28, v1
  s_nop 1
  v_cndmask_b32 v9, v9, v2, vcc
  s_nop 0
  v_readlane_b32 s7, v9, 3
  s_mov_b32 s11, 49152
  s_add_u32 s91, s91, 4
  s_lshl_b32 s4, s79, 3
  s_lshl_b32 s90, 0xff, s4
  s_bitset0_b32 s90, s77
  v_mov_b32 v2, 156420
  s_lshl_b32 s5, s82, 2
  s_add_u32 s5, s5, Lz1-Lz0+1
  s_mov_b32 s89, 200000
  s_mov_b32 s92, 1
  s_mov_b32 exec_lo, s90
  s_mov_b32 exec_hi, Lz1-Lz0+0
  buffer_load_dword v12, v8, s[40:43], s91 offen sc0 sc1
Lp_119:
  s_waitcnt vmcnt(0)
  v_cmp_ne_u32 vcc, 0, v12
  s_andn2_b32 s3, exec_lo, vcc_lo
  s_cbranch_scc0 Lp_121
  s_mov_b32 exec_lo, s3
  s_cmp_eq_u32 s92, 0
  s_cbranch_scc1 Lp_120
  ds_read_b32 v3, v2
  s_waitcnt lgkmcnt(0)
  buffer_load_dword v12, v8, s[40:43], s91 offen sc0 sc1
  v_readfirstlane_b32 s4, v3
  s_cmp_lt_u32 s4, s5
  s_cbranch_scc1 Lp_122
  s_mov_b32 s92, 0
  s_barrier
  s_branch Lp_122
  s_nop 0
Lp_120:
  s_sleep 1
  buffer_load_dword v12, v8, s[40:43], s91 offen sc0 sc1
Lp_122:
  s_sub_u32 s89, s89, 1
  s_cbranch_scc0 Lp_119
Lp_121:
  s_mov_b64 exec, -1
  s_cmp_eq_u32 s92, 0
  s_cbranch_scc1 Lp_123
  s_barrier
Lp_123:
  s_mov_b32 s12, Lz1-Lz0+3
  s_mov_b32 m0, s11
Ll_124:
  s_nop 0
  buffer_load_dwordx4 v4, s[40:43], s7 offen offset:0 sc1 lds
  buffer_load_dwordx4 v5, s[40:43], s7 offen offset:1024 sc1 lds
  buffer_load_dwordx4 v6, s[40:43], s7 offen offset:2048 sc1 lds
  buffer_load_dwordx4 v7, s[40:43], s7 offen offset:3072 sc1 lds
  s_add_u32 m0, s11, 4096
  s_nop 0
  s_add_u32 s5, s7, s13
  buffer_load_dwordx4 v4, s[40:43], s5 offen offset:0 sc1 lds
  buffer_load_dwordx4 v5, s[40:43], s5 offen offset:1024 sc1 lds
  buffer_load_dwordx4 v6, s[40:43], s5 offen offset:2048 sc1 lds
  buffer_load_dwordx4 v7, s[40:43], s5 offen offset:3072 sc1 lds
  s_add_u32 m0, s11, 8192
  s_nop 0
  s_add_u32 s3, s7, s95
  buffer_load_dwordx4 v4, s[40:43], s3 offen offset:0 sc1 lds
  buffer_load_dwordx4 v5, s[40:43], s3 offen offset:1024 sc1 lds
  buffer_load_dwordx4 v6, s[40:43], s3 offen offset:2048 sc1 lds
  buffer_load_dwordx4 v7, s[40:43], s3 offen offset:3072 sc1 lds
  s_add_u32 m0, s11, 12288
  s_add_u32 s5, s3, s13
  buffer_load_dwordx4 v4, s[40:43], s5 offen offset:0 sc1 lds
  s_add_u32 s12, s12, 1
  v_readlane_b32 s7, v9, s12
  s_add_u32 s11, s11, 16384
  buffer_load_dwordx4 v5, s[40:43], s5 offen offset:1024 sc1 lds
  s_cmp_eq_u32 s11, s15
  s_cselect_b32 s4, 65536, 0
  s_sub_u32 s11, s11, s4
  buffer_load_dwordx4 v6, s[40:43], s5 offen offset:2048 sc1 lds
  s_cmp_lg_u32 s12, Lz1-Lz0+4
  buffer_load_dwordx4 v7, s[40:43], s5 offen offset:3072 sc1 lds
  s_mov_b32 m0, s11
  s_cbranch_scc1 Ll_124
  s_waitcnt vmcnt(32)
  s_barrier
  buffer_load_dwordx4 v4, s[40:43], s7 offen offset:0 sc1 lds
  buffer_load_dwordx4 v5, s[40:43], s7 offen offset:1024 sc1 lds
  buffer_load_dwordx4 v6, s[40:43], s7 offen offset:2048 sc1 lds
  buffer_load_dwordx4 v7, s[40:43], s7 offen offset:3072 sc1 lds
Ll_129:
  s_add_u32 m0, s11, 4096
  s_nop 0
  s_add_u32 s5, s7, s13
  buffer_load_dwordx4 v4, s[40:43], s5 offen offset:0 sc1 lds
  buffer_load_dwordx4 v5, s[40:43], s5 offen offset:1024 sc1 lds
  buffer_load_dwordx4 v6, s[40:43], s5 offen offset:2048 sc1 lds
  buffer_load_dwordx4 v7, s[40:43], s5 offen offset:3072 sc1 lds
  s_add_u32 m0, s11, 8192
  s_nop 0
  s_add_u32 s3, s7, s95
  buffer_load_dwordx4 v4, s[40:43], s3 offen offset:0 sc1 lds
  buffer_load_dwordx4 v5, s[40:43], s3 offen offset:1024 sc1 lds
  buffer_load_dwordx4 v6, s[40:43], s3 offen offset:2048 sc1 lds
  buffer_load_dwordx4 v7, s[40:43], s3 offen offset:3072 sc1 lds
  s_add_u32 m0, s11, 12288
  s_add_u32 s5, s3, s13
  buffer_load_dwordx4 v4, s[40:43], s5 offen offset:0 sc1 lds
  s_add_u32 s12, s12, 1
  v_readlane_b32 s7, v9, s12
  s_add_u32 s11, s11, 16384
  buffer_load_dwordx4 v5, s[40:43], s5 offen offset:1024 sc1 lds
  s_cmp_eq_u32 s11, s15
  s_cselect_b32 s4, 65536, 0
  s_sub_u32 s11, s11, s4
  buffer_load_dwordx4 v6, s[40:43], s5 offen offset:2048 sc1 lds
  s_cmp_eq_u32 s12, Lz1-Lz0+30
  buffer_load_dwordx4 v7, s[40:43], s5 offen offset:3072 sc1 lds
  s_mov_b32 m0, s11
  s_cbranch_scc1 Ll_130
  s_waitcnt vmcnt(32)
  s_barrier
  buffer_load_dwordx4 v4, s[40:43], s7 offen offset:0 sc1 lds
  buffer_load_dwordx4 v5, s[40:43], s7 offen offset:1024 sc1 lds
  buffer_load_dwordx4 v6, s[40:43], s7 offen offset:2048 sc1 lds
  buffer_load_dwordx4 v7, s[40:43], s7 offen offset:3072 sc1 lds
  s_branch Ll_129
  s_nop 0
Ll_130:
  s_waitcnt vmcnt(32)
  s_barrier
  s_waitcnt vmcnt(16)
  s_barrier
  s_waitcnt vmcnt(0)
  s_barrier
  s_barrier
  s_cmp_lg_u32 s82, 0
  s_cbranch_scc1 L_lend
  s_mov_b32 s11, 0
  s_mov_b32 s15, 65536
  s_mul_i32 s5, s76, 16
  s_lshl_b32 s5, s5, 14
  s_add_u32 s5, s5, 35651584
  s_and_b32 s4, s76, 7
  s_add_u32 s6, s4, 1
  v_cmp_lt_u32 vcc, s6, v1
  v_add_u32 v9, s4, v1
  s_nop 0
  v_subbrev_co_u32 v9, vcc, 0, v9, vcc
  v_and_b32 v9, 7, v9
  v_subrev_u32 v2, 9, v1
  v_cmp_le_u32 vcc, s4, v2
  s_nop 1
  v_addc_co_u32 v2, vcc, 8, v2, vcc
  v_cmp_le_u32 vcc, 9, v1
  s_nop 1
  v_cndmask_b32 v9, v9, v2, vcc
  s_add_u32 s4, s4, Lz1-Lz0+8
  s_mov_b32 m0, s6
  s_nop 0
  v_writelane_b32 v9, s4, m0
  s_and_b32 s4, s76, 8
  v_xor_b32 v9, s4, v9
  v_cmp_eq_u32 vcc, s78, v9
  s_nop 0
  v_mov_b32_dpp v2, v9 row_shr:1 row_mask:0xf bank_mask:0xf
  s_ff1_i32_b32 s4, vcc_lo
  v_cmp_ge_u32 vcc, s4, v1
  s_nop 1
  v_cndmask_b32 v9, v9, v2, vcc
  v_writelane_b32 v9, s78, 0
  v_lshlrev_b32_e64 v11, 7, v9
  v_lshl_add_u32 v9, v9, 14, s5
  s_lshl_b32 s6, s76, Lz1-Lz0+14
  v_readlane_b32 s7, v9, 1
  s_mov_b32 s11, 16384
  s_add_u32 s91, s91, 8
  s_mov_b32 s90, 0x3e
  s_barrier
  s_mov_b32 s82, 1
  s_add_u32 s83, s83, 0
  s_add_u32 s87, s87, 32
  s_mov_b32 s89, 200000
  s_mov_b32 exec_lo, s90
  s_mov_b32 exec_hi, 0
  buffer_load_dword v12, v11, s[40:43], s91 offen sc0 sc1
Lp_131:
  s_waitcnt vmcnt(0)
  v_cmp_ne_u32 vcc, 0, v12
  s_andn2_b32 s3, exec_lo, vcc_lo
  s_cbranch_scc0 Lp_132
  s_mov_b32 exec_lo, s3
  s_sleep 1
  buffer_load_dword v12, v11, s[40:43], s91 offen sc0 sc1
  s_sub_u32 s89, s89, 1
  s_cbranch_scc0 Lp_131
Lp_132:
  s_mov_b64 exec, -1
  s_branch L_xlayer
  s_nop 0
L_s1:
  v_mov_b32 v11, 1
  v_mov_b32 v2, 156416
  ds_write_b128 v2, v[24:27]
  v_and_b32 v2, 31, v1
  v_lshlrev_b32 v5, 7, v2
  v_lshlrev_b32 v10, 3, v2
  v_lshrrev_b32 v3, 5, v1
  v_mul_u32_u24 v3, 320, v3
  v_add_u32_e64 v10, v3, v10
  v_add_u32 v10, 151552, v10
  v_bfe_u32 v3, v1, 3, 1
  v_and_b32 v2, 7, v1
  v_lshlrev_b32 v12, 9, v3
  v_lshl_add_u32 v12, v2, 4, v12
  v_mul_u32_u24 v3, 320, v3
  v_lshl_add_u32 v13, v2, 3, v3
  v_add_u32 v13, 151808, v13
  v_and_b32 v2, 15, v1
  v_lshlrev_b32 v8, 4, v2
  v_lshlrev_b32 v15, 6, v2
  v_and_b32 v3, 48, v1
  v_add_u32 v15, v15, v3
  v_and_b32 v2, 14, v1
  v_lshlrev_b32 v6, 2, v2
  v_lshlrev_b32 v14, 16, v1
  s_lshl_b32 s4, s77, 12
  s_lshl_b32 s5, s76, 7
  s_add_u32 s4, s4, s5
  v_add_u32 v14, s4, v14
  v_lshrrev_b32 v2, 2, v1
  v_lshlrev_b32 v22, 7, v2
  v_lshlrev_b32 v96, 6, v2
  v_and_b32 v2, 3, v1
  v_lshl_add_u32 v22, v2, 3, v22
  v_lshl_add_u32 v96, v2, 3, v96
  v_add_u32 v22, 65536, v22
  v_add_u32 v96, 90112, v96
  v_bfe_u32 v3, v1, 3, 2
  v_xor_b32_e64 v2, 0, v3
  v_lshl_add_u32 v16, v2, 5, v22
  v_xor_b32_e64 v2, 1, v3
  v_lshl_add_u32 v17, v2, 5, v22
  v_xor_b32_e64 v2, 2, v3
  v_lshl_add_u32 v18, v2, 5, v22
  v_xor_b32_e64 v2, 3, v3
  v_lshl_add_u32 v19, v2, 5, v22
  v_bfe_u32 v3, v1, 4, 1
  v_xor_b32_e64 v2, 0, v3
  v_lshl_add_u32 v20, v2, 5, v96
  v_xor_b32_e64 v2, 1, v3
  v_lshl_add_u32 v21, v2, 5, v96
  v_mov_b32 v22, 0x3f803f80
  s_mul_i32 s4, s76, 11
  s_lshr_b32 s4, s4, 5
  s_mul_i32 s4, s4, 3
  s_and_b32 s14, s76, 1
  s_mov_b32 s15, 32768
  s_mul_i32 s4, s14, 24576
  v_add_u32 v16, s4, v16
  v_add_u32 v17, s4, v17
  v_add_u32 v18, s4, v18
  v_add_u32 v19, s4, v19
  s_mov_b32 s98, 0x00010001
  s_mov_b32 s99, 0x00010001
  v_cndmask_b32_e64 v200, 0, v22, s[98:99]
  v_cndmask_b32_e64 v201, 0, v22, s[98:99]
  v_cndmask_b32_e64 v202, 0, v22, s[98:99]
  v_cndmask_b32_e64 v203, 0, v22, s[98:99]
  s_nop 0
  s_lshl_b64 s[98:99], s[98:99], 1
  v_cndmask_b32_e64 v204, 0, v22, s[98:99]
  v_cndmask_b32_e64 v205, 0, v22, s[98:99]
  v_cndmask_b32_e64 v206, 0, v22, s[98:99]
  v_cndmask_b32_e64 v207, 0, v22, s[98:99]
  s_nop 0
  s_lshl_b64 s[98:99], s[98:99], 1
  v_cndmask_b32_e64 v208, 0, v22, s[98:99]
  v_cndmask_b32_e64 v209, 0, v22, s[98:99]
  v_cndmask_b32_e64 v210, 0, v22, s[98:99]
  v_cndmask_b32_e64 v211, 0, v22, s[98:99]
  s_nop 0
  s_lshl_b64 s[98:99], s[98:99], 1
  v_cndmask_b32_e64 v212, 0, v22, s[98:99]
  v_cndmask_b32_e64 v213, 0, v22, s[98:99]
  v_cndmask_b32_e64 v214, 0, v22, s[98:99]
  v_cndmask_b32_e64 v215, 0, v22, s[98:99]
  s_nop 0
  s_lshl_b64 s[98:99], s[98:99], 1
  v_cndmask_b32_e64 v216, 0, v22, s[98:99]
  v_cndmask_b32_e64 v217, 0, v22, s[98:99]
  v_cndmask_b32_e64 v218, 0, v22, s[98:99]
  v_cndmask_b32_e64 v219, 0, v22, s[98:99]
  s_nop 0
  s_lshl_b64 s[98:99], s[98:99], 1
  v_cndmask_b32_e64 v220, 0, v22, s[98:99]
  v_cndmask_b32_e64 v221, 0, v22, s[98:99]
  v_cndmask_b32_e64 v222, 0, v22, s[98:99]
  v_cndmask_b32_e64 v223, 0, v22, s[98:99]
  s_nop 0
  s_lshl_b64 s[98:99], s[98:99], 1
  v_cndmask_b32_e64 v224, 0, v22, s[98:99]
  v_cndmask_b32_e64 v225, 0, v22, s[98:99]
  v_cndmask_b32_e64 v226, 0, v22, s[98:99]
  v_cndmask_b32_e64 v227, 0, v22, s[98:99]
  s_nop 0
  s_lshl_b64 s[98:99], s[98:99], 1
  v_cndmask_b32_e64 v228, 0, v22, s[98:99]
  v_cndmask_b32_e64 v229, 0, v22, s[98:99]
  v_cndmask_b32_e64 v230, 0, v22, s[98:99]
  v_cndmask_b32_e64 v231, 0, v22, s[98:99]
  s_nop 0
  s_lshl_b64 s[98:99], s[98:99], 1
  v_cndmask_b32_e64 v232, 0, v22, s[98:99]
  v_cndmask_b32_e64 v233, 0, v22, s[98:99]
  v_cndmask_b32_e64 v234, 0, v22, s[98:99]
  v_cndmask_b32_e64 v235, 0, v22, s[98:99]
  s_nop 0
  s_lshl_b64 s[98:99], s[98:99], 1
  v_cndmask_b32_e64 v236, 0, v22, s[98:99]
  v_cndmask_b32_e64 v237, 0, v22, s[98:99]
  v_cndmask_b32_e64 v238, 0, v22, s[98:99]
  v_cndmask_b32_e64 v239, 0, v22, s[98:99]
  s_nop 0
  s_lshl_b64 s[98:99], s[98:99], 1
  v_cndmask_b32_e64 v240, 0, v22, s[98:99]
  v_cndmask_b32_e64 v241, 0, v22, s[98:99]
  v_cndmask_b32_e64 v242, 0, v22, s[98:99]
  v_cndmask_b32_e64 v243, 0, v22, s[98:99]
  s_nop 0
  s_lshl_b64 s[98:99], s[98:99], 1
  v_cndmask_b32_e64 v244, 0, v22, s[98:99]
  v_cndmask_b32_e64 v245, 0, v22, s[98:99]
  v_cndmask_b32_e64 v246, 0, v22, s[98:99]
  v_cndmask_b32_e64 v247, 0, v22, s[98:99]
  s_lshl_b64 s[98:99], s[98:99], 1
  s_mov_b32 s56, s24
  s_and_b32 s57, s25, 0xffff
  s_mov_b32 s58, 7340032
  s_mov_b32 s59, 0x00020000
  s_nop 0
  s_mov_b32 s60, s28
  s_and_b32 s61, s29, 0xffff
  s_mov_b32 s62, 7340032
  s_mov_b32 s63, 0x00020000
  s_mul_i32 s12, s84, Lz1-Lz0+14
  s_add_u32 s12, s12, 20480
  s_mov_b32 s13, s12
  v_lshlrev_b32 v110, 7, v1
  s_mov_b32 s8, 0x00500005
  s_mov_b32 s9, 0x50000500
L_slayer:
  s_barrier
  s_cmp_lg_u32 s82, Lz1-Lz0+0
  s_cbranch_scc1 L_134
  buffer_load_dwordx4 v[128:131], v108, s[44:47], s7 offen offset:0
  buffer_load_dwordx4 v[132:135], v108, s[44:47], s7 offen offset:128
  buffer_load_dwordx4 v[136:139], v108, s[44:47], s7 offen offset:256
  buffer_load_dwordx4 v[140:143], v108, s[44:47], s7 offen offset:384
  buffer_load_dwordx4 v[144:147], v108, s[44:47], s7 offen offset:512
  buffer_load_dwordx4 v[148:151], v108, s[44:47], s7 offen offset:640
  buffer_load_dwordx4 v[152:155], v108, s[44:47], s7 offen offset:768
  buffer_load_dwordx4 v[156:159], v108, s[44:47], s7 offen offset:896
  buffer_load_dwordx4 v[160:163], v108, s[44:47], s7 offen offset:1024
  buffer_load_dwordx4 v[164:167], v108, s[44:47], s7 offen offset:1152
  buffer_load_dwordx4 v[168:171], v108, s[44:47], s7 offen offset:1280
  buffer_load_dwordx4 v[172:175], v108, s[44:47], s7 offen offset:1408
  buffer_load_dwordx4 v[176:179], v108, s[44:47], s7 offen offset:1536
  buffer_load_dwordx4 v[180:183], v108, s[44:47], s7 offen offset:1664
  buffer_load_dwordx4 v[184:187], v108, s[44:47], s7 offen offset:1792
  buffer_load_dwordx4 v[188:191], v108, s[44:47], s7 offen offset:1920
  s_waitcnt vmcnt(16)
  s_lshl_b32 s4, s76, 4
  s_mov_b64 exec, 1
  buffer_atomic_add v11, v24, s[68:71], s4 offen sc1
  s_mov_b64 exec, -1
L_134:
  s_cmp_le_u32 s14, 0
  s_cbranch_scc1 L_136
  s_barrier
L_136:
  s_cmp_le_u32 s14, 1
  s_cbranch_scc1 L_137
  s_barrier
L_137:
  s_cmp_lg_u32 s82, 0
  s_cbranch_scc1 L_138
  ds_read_b64_tr_b16 v[32:33], v16 offset:0
  ds_read_b64_tr_b16 v[34:35], v16 offset:2048
  ds_read_b64_tr_b16 v[36:37], v17 offset:0
  ds_read_b64_tr_b16 v[38:39], v17 offset:2048
  ds_read_b64_tr_b16 v[40:41], v18 offset:0
  ds_read_b64_tr_b16 v[42:43], v18 offset:2048
  ds_read_b64_tr_b16 v[44:45], v19 offset:0
  ds_read_b64_tr_b16 v[46:47], v19 offset:2048
  ds_read_b64_tr_b16 v[48:49], v16 offset:4096
  ds_read_b64_tr_b16 v[50:51], v16 offset:6144
  ds_read_b64_tr_b16 v[52:53], v17 offset:4096
  ds_read_b64_tr_b16 v[54:55], v17 offset:6144
  s_nop 0
  s_waitcnt lgkmcnt(4)
  ds_read_b64_tr_b16 v[56:57], v18 offset:4096
  ds_read_b64_tr_b16 v[58:59], v18 offset:6144
  ds_read_b64_tr_b16 v[60:61], v19 offset:4096
  ds_read_b64_tr_b16 v[62:63], v19 offset:6144
  v_add_u32 v16, 8192, v16
  v_add_u32 v17, 8192, v17
  v_add_u32 v18, 8192, v18
  v_add_u32 v19, 8192, v19
  s_nop 0
  s_waitcnt lgkmcnt(2)
  ds_read_b64_tr_b16 v[64:65], v16 offset:0
  ds_read_b64_tr_b16 v[66:67], v16 offset:2048
  ds_read_b64_tr_b16 v[68:69], v17 offset:0
  ds_read_b64_tr_b16 v[70:71], v17 offset:2048
  ds_read_b64_tr_b16 v[72:73], v18 offset:0
  ds_read_b64_tr_b16 v[74:75], v18 offset:2048
  ds_read_b64_tr_b16 v[76:77], v19 offset:0
  ds_read_b64_tr_b16 v[78:79], v19 offset:2048
  ds_read_b64_tr_b16 v[80:81], v16 offset:4096
  ds_read_b64_tr_b16 v[82:83], v16 offset:6144
  ds_read_b64_tr_b16 v[84:85], v17 offset:4096
  ds_read_b64_tr_b16 v[86:87], v17 offset:6144
  s_nop 0
  s_waitcnt lgkmcnt(4)
  ds_read_b64_tr_b16 v[88:89], v18 offset:4096
  ds_read_b64_tr_b16 v[90:91], v18 offset:6144
  ds_read_b64_tr_b16 v[92:93], v19 offset:4096
  ds_read_b64_tr_b16 v[94:95], v19 offset:6144
  v_add_u32 v16, 8192, v16
  v_add_u32 v17, 8192, v17
  v_add_u32 v18, 8192, v18
  v_add_u32 v19, 8192, v19
  v_mfma_f32_16x16x32_bf16 v[28:31], v[32:35], v[200:203], 0
  v_mfma_f32_16x16x32_bf16 v[28:31], v[36:39], v[204:207], v[28:31]
  v_mfma_f32_16x16x32_bf16 v[28:31], v[40:43], v[208:211], v[28:31]
  v_mfma_f32_16x16x32_bf16 v[28:31], v[44:47], v[212:215], v[28:31]
  v_mfma_f32_16x16x32_bf16 v[28:31], v[48:51], v[200:203], v[28:31]
  v_mfma_f32_16x16x32_bf16 v[28:31], v[52:55], v[204:207], v[28:31]
  v_mfma_f32_16x16x32_bf16 v[28:31], v[56:59], v[208:211], v[28:31]
  v_mfma_f32_16x16x32_bf16 v[28:31], v[60:63], v[212:215], v[28:31]
  s_nop 0
  s_waitcnt lgkmcnt(2)
  ds_read_b64_tr_b16 v[32:33], v16 offset:0
  ds_read_b64_tr_b16 v[34:35], v16 offset:2048
  ds_read_b64_tr_b16 v[36:37], v17 offset:0
  ds_read_b64_tr_b16 v[38:39], v17 offset:2048
  ds_read_b64_tr_b16 v[40:41], v18 offset:0
  ds_read_b64_tr_b16 v[42:43], v18 offset:2048
  ds_read_b64_tr_b16 v[44:45], v19 offset:0
  ds_read_b64_tr_b16 v[46:47], v19 offset:2048
  ds_read_b64_tr_b16 v[48:49], v16 offset:4096
  ds_read_b64_tr_b16 v[50:51], v16 offset:6144
  ds_read_b64_tr_b16 v[52:53], v17 offset:4096
  ds_read_b64_tr_b16 v[54:55], v17 offset:6144
  s_nop 0
  s_waitcnt lgkmcnt(4)
  ds_read_b64_tr_b16 v[56:57], v18 offset:4096
  ds_read_b64_tr_b16 v[58:59], v18 offset:6144
  ds_read_b64_tr_b16 v[60:61], v19 offset:4096
  ds_read_b64_tr_b16 v[62:63], v19 offset:6144
  v_mfma_f32_16x16x32_bf16 v[28:31], v[64:67], v[216:219], v[28:31]
  v_mfma_f32_16x16x32_bf16 v[28:31], v[68:71], v[220:223], v[28:31]
  v_mfma_f32_16x16x32_bf16 v[28:31], v[72:75], v[224:227], v[28:31]
  v_mfma_f32_16x16x32_bf16 v[28:31], v[76:79], v[228:231], v[28:31]
  v_mfma_f32_16x16x32_bf16 v[28:31], v[80:83], v[216:219], v[28:31]
  v_mfma_f32_16x16x32_bf16 v[28:31], v[84:87], v[220:223], v[28:31]
  v_mfma_f32_16x16x32_bf16 v[28:31], v[88:91], v[224:227], v[28:31]
  v_mfma_f32_16x16x32_bf16 v[28:31], v[92:95], v[228:231], v[28:31]
  s_waitcnt lgkmcnt(0)
L_138:
  s_barrier
  s_cmp_lg_u32 s82, 0
  s_cbranch_scc1 L_140
  v_mfma_f32_16x16x32_bf16 v[28:31], v[32:35], v[232:235], v[28:31]
  v_mfma_f32_16x16x32_bf16 v[28:31], v[36:39], v[236:239], v[28:31]
  v_mfma_f32_16x16x32_bf16 v[28:31], v[40:43], v[240:243], v[28:31]
  v_mfma_f32_16x16x32_bf16 v[28:31], v[44:47], v[244:247], v[28:31]
  v_mfma_f32_16x16x32_bf16 v[28:31], v[48:51], v[232:235], v[28:31]
  v_mfma_f32_16x16x32_bf16 v[28:31], v[52:55], v[236:239], v[28:31]
  v_mfma_f32_16x16x32_bf16 v[28:31], v[56:59], v[240:243], v[28:31]
  v_mfma_f32_16x16x32_bf16 v[28:31], v[60:63], v[244:247], v[28:31]
  s_lshl_b32 s5, s77, 14
  s_lshl_b32 s4, s76, 10
  s_add_u32 s5, s5, s4
  s_add_u32 s5, s5, 1114112
  s_nop 3
  buffer_store_dwordx4 v[28:31], v15, s[40:43], s5 offen sc0 sc1
  s_branch L_141
L_140:
  s_lshl_b32 s91, s84, 1
  s_add_u32 s91, s91, s87
  s_add_u32 s91, s91, 0xfffffff0
  s_mov_b32 s16, 0xffff
  s_mov_b32 exec_lo, s16
  s_mov_b32 exec_hi, 0
  buffer_load_dword v7, v5, s[40:43], s91 offen sc0 sc1
  s_mov_b64 exec, -1
L_141:
  s_barrier
  s_cmp_lg_u32 s82, 0
  s_cbranch_scc1 L_142
  s_branch L_143
L_142:
  s_waitcnt vmcnt(0)
  s_mov_b32 s89, 200000
  s_mov_b32 exec_lo, s16
  s_mov_b32 exec_hi, 0
  s_branch Lp_145
Lp_144:
  buffer_load_dword v7, v5, s[40:43], s91 offen sc0 sc1
  s_waitcnt vmcnt(0)
Lp_145:
  v_cmp_ne_u32 vcc, 0, v7
  s_andn2_b32 s3, s16, vcc_lo
  s_cbranch_scc0 Lp_146
  s_sleep 1
  s_sub_u32 s89, s89, 1
  s_cbranch_scc0 Lp_144
Lp_146:
  s_mov_b64 exec, -1
  s_add_u32 s5, s84, s92
  buffer_load_dwordx2 v[96:97], v6, s[40:43], s5 offen offset:0 sc1
  buffer_load_dwordx2 v[98:99], v6, s[40:43], s5 offen offset:512 sc1
  buffer_load_dwordx2 v[100:101], v6, s[40:43], s5 offen offset:1024 sc1
  buffer_load_dwordx2 v[102:103], v6, s[40:43], s5 offen offset:1536 sc1
L_143:
  s_barrier
  s_cmp_gt_u32 s14, 0
  s_cbranch_scc1 L_147
  s_barrier
L_147:
  s_cmp_gt_u32 s14, Lz1-Lz0+1
  s_cbranch_scc1 L_148
  s_barrier
L_148:
  s_cmp_lg_u32 s82, 0
  s_cbranch_scc1 L_149
  s_waitcnt vmcnt(2)
  buffer_load_dword v9, v8, s[68:71], 0 offen sc0 sc1
  s_mov_b32 s72, s26
  s_and_b32 s73, s27, 0xffff
  s_mov_b32 s74, 7168
  s_mov_b32 s75, 0x00020000
  s_mul_i32 s4, s77, 448
  s_and_b32 s5, s77, Lz1-Lz0+1
  s_lshl_b32 s6, s5, 6
  s_add_u32 s6, s6, s4
  s_mul_i32 s5, s5, 384
  s_sub_u32 s5, s4, s5
  v_lshlrev_b32 v2, 1, v1
  v_lshrrev_b32 v3, 1, v2
  v_xor_b32 v3, v3, v2
  v_and_b32 v3, 16, v3
  v_mul_u32_u24 v3, 3, v3
  v_xor_b32_e64 v3, v3, v2
  buffer_load_ushort v104, v2, s[72:75], s6 offen offset:0
  buffer_load_ushort v105, v2, s[72:75], s6 offen offset:128
  buffer_load_ushort v106, v2, s[72:75], s6 offen offset:256
  buffer_load_ushort v107, v3, s[72:75], s5 offen offset:384
  s_nop 0
  s_mov_b32 s64, s30
  s_and_b32 s65, s31, 0xffff
  s_mov_b32 s66, 2048
  s_mov_b32 s67, 0x00020000
  s_lshl_b32 s4, s78, Lz1-Lz0+7
  buffer_load_ushort v108, v2, s[64:67], s4 offen
  v_mov_b32 v32, v22
  v_mov_b32 v33, v22
  v_mov_b32 v34, v22
  v_mov_b32 v35, v22
  v_mov_b32 v96, 0
  v_mov_b32 v97, 0
  v_mov_b32 v98, 0
  v_mov_b32 v99, 0
  v_and_b32_e64 v2, 1, v1
  v_mul_u32_u24 v2, 0xaaaa, v2
  v_add_u32 v2, 0x4444, v2
  v_lshl_or_b32 v36, v2, 16, v2
  v_mfma_f32_16x16x32_bf16 v[100:103], v[128:131], v[128:131], 0
  s_nop 0
  s_nop 0
  v_smfmac_f32_16x16x64_bf16 v[96:99], v[32:35], v[128:135], v36
  v_mfma_f32_16x16x32_bf16 v[100:103], v[132:135], v[132:135], v[100:103]
  v_mfma_f32_16x16x32_bf16 v[100:103], v[136:139], v[136:139], v[100:103]
  v_smfmac_f32_16x16x64_bf16 v[96:99], v[32:35], v[136:143], v36
  v_mfma_f32_16x16x32_bf16 v[100:103], v[140:143], v[140:143], v[100:103]
L_149:
  s_barrier
  s_cmp_lg_u32 s82, Lz1-Lz0+0
  s_cbranch_scc1 L_151
  v_mfma_f32_16x16x32_bf16 v[100:103], v[144:147], v[144:147], v[100:103]
  v_smfmac_f32_16x16x64_bf16 v[96:99], v[32:35], v[144:151], v36
  v_mfma_f32_16x16x32_bf16 v[100:103], v[148:151], v[148:151], v[100:103]
  v_mfma_f32_16x16x32_bf16 v[100:103], v[152:155], v[152:155], v[100:103]
  v_smfmac_f32_16x16x64_bf16 v[96:99], v[32:35], v[152:159], v36
  v_mfma_f32_16x16x32_bf16 v[100:103], v[156:159], v[156:159], v[100:103]
L_151:
  s_barrier
  s_cmp_lg_u32 s82, Lz1-Lz0+0
  s_cbranch_scc1 L_153
  v_mfma_f32_16x16x32_bf16 v[100:103], v[160:163], v[160:163], v[100:103]
  v_smfmac_f32_16x16x64_bf16 v[96:99], v[32:35], v[160:167], v36
  v_mfma_f32_16x16x32_bf16 v[100:103], v[164:167], v[164:167], v[100:103]
  v_mfma_f32_16x16x32_bf16 v[100:103], v[168:171], v[168:171], v[100:103]
  v_smfmac_f32_16x16x64_bf16 v[96:99], v[32:35], v[168:175], v36
  v_mfma_f32_16x16x32_bf16 v[100:103], v[172:175], v[172:175], v[100:103]
  s_waitcnt vmcnt(0)
  s_mov_b32 s89, 200000
  s_branch Lg_156
Lg_155:
  buffer_load_dword v9, v8, s[68:71], 0 offen sc0 sc1
  s_waitcnt vmcnt(0)
Lg_156:
  v_cmp_eq_u32 vcc, 16, v9
  s_andn2_b32 s3, 0xffff, vcc_lo
  s_cbranch_scc0 Lg_157
  s_sleep 2
  s_sub_u32 s89, s89, 1
  s_cbranch_scc0 Lg_155
Lg_157:
  s_mov_b32 s5, 1835008
  s_mov_b64 exec, 0x101
  buffer_store_dword v11, v14, s[40:43], s5 offen sc0 sc1
  s_mov_b64 exec, -1
  s_getpc_b64 s[4:5]
L_pc0:
  s_sub_u32 s4, s4, L_pc0-mega_kernel
  s_nop 0
  s_subb_u32 s5, s5, 0
  s_bfe_u32 s6, s2, 0x20003
  s_mul_i32 s6, s6, 10240
  v_lshl_add_u32 v3, v1, 4, s6
  v_mov_b32_e64 v119, s5
  v_min_u32 v118, L_end-mega_kernel-16, v3
  v_add_co_u32_e64 v116, vcc, s4, v118
  v_add_u32 v3, 0x400, v3
  s_nop 0
  v_addc_co_u32 v117, vcc, 0, v119, vcc
  global_load_dwordx4 v[112:115], v[116:117], off
  v_min_u32 v118, L_end-mega_kernel-16, v3
  v_add_co_u32_e64 v116, vcc, s4, v118
  v_add_u32 v3, 0x400, v3
  s_nop 0
  v_addc_co_u32 v117, vcc, 0, v119, vcc
  global_load_dwordx4 v[112:115], v[116:117], off
  v_min_u32 v118, L_end-mega_kernel-16, v3
  v_add_co_u32_e64 v116, vcc, s4, v118
  v_add_u32 v3, 0x400, v3
  s_nop 0
  v_addc_co_u32 v117, vcc, 0, v119, vcc
  global_load_dwordx4 v[112:115], v[116:117], off
  v_min_u32 v118, L_end-mega_kernel-16, v3
  v_add_co_u32_e64 v116, vcc, s4, v118
  v_add_u32 v3, 0x400, v3
  s_nop 0
  v_addc_co_u32 v117, vcc, 0, v119, vcc
  global_load_dwordx4 v[112:115], v[116:117], off
  v_min_u32 v118, L_end-mega_kernel-16, v3
  v_add_co_u32 v116, vcc, s4, v118
  s_nop 1
  v_addc_co_u32 v117, vcc, 0, v119, vcc
  global_load_dwordx4 v[112:115], v[116:117], off
L_153:
  s_barrier
  s_cmp_lg_u32 s82, 0
  s_cbranch_scc1 L_158
  v_mfma_f32_16x16x32_bf16 v[100:103], v[176:179], v[176:179], v[100:103]
  v_smfmac_f32_16x16x64_bf16 v[96:99], v[32:35], v[176:183], v36
  v_mfma_f32_16x16x32_bf16 v[100:103], v[180:183], v[180:183], v[100:103]
  v_mfma_f32_16x16x32_bf16 v[100:103], v[184:187], v[184:187], v[100:103]
  v_smfmac_f32_16x16x64_bf16 v[96:99], v[32:35], v[184:191], v36
  v_mfma_f32_16x16x32_bf16 v[100:103], v[188:191], v[188:191], v[100:103]
  s_getpc_b64 s[4:5]
L_pc1:
  s_sub_u32 s4, s4, L_pc1-mega_kernel
  s_subb_u32 s5, s5, 0
  s_bfe_u32 s6, s2, 0x20003
  s_mul_i32 s6, s6, 10240
  s_add_u32 s6, s6, 5120
  v_lshl_add_u32 v3, v1, 4, s6
  v_mov_b32_e64 v119, s5
  v_min_u32 v118, L_end-mega_kernel-16, v3
  v_add_co_u32_e64 v116, vcc, s4, v118
  v_add_u32 v3, 0x400, v3
  s_nop 0
  v_addc_co_u32 v117, vcc, 0, v119, vcc
  global_load_dwordx4 v[112:115], v[116:117], off
  v_min_u32 v118, L_end-mega_kernel-16, v3
  v_add_co_u32_e64 v116, vcc, s4, v118
  v_add_u32 v3, 0x400, v3
  s_nop 0
  v_addc_co_u32 v117, vcc, 0, v119, vcc
  global_load_dwordx4 v[112:115], v[116:117], off
  v_min_u32 v118, L_end-mega_kernel-16, v3
  v_add_co_u32_e64 v116, vcc, s4, v118
  v_add_u32 v3, 0x400, v3
  s_nop 0
  v_addc_co_u32 v117, vcc, 0, v119, vcc
  global_load_dwordx4 v[112:115], v[116:117], off
  v_min_u32 v118, L_end-mega_kernel-16, v3
  v_add_co_u32_e64 v116, vcc, s4, v118
  v_add_u32 v3, 0x400, v3
  s_nop 0
  v_addc_co_u32 v117, vcc, 0, v119, vcc
  global_load_dwordx4 v[112:115], v[116:117], off
  v_min_u32 v118, L_end-mega_kernel-16, v3
  v_add_co_u32 v116, vcc, s4, v118
  s_nop 1
  v_addc_co_u32_e64 v117, vcc, 0, v119, vcc
  global_load_dwordx4 v[112:115], v[116:117], off
  s_nop 7
  s_nop 7
  v_add_f32_e64 v96, v96, v97
  s_mov_b32 s98, 0xaaaaaaaa
  s_mov_b32 s99, 0xaaaaaaaa
  v_cndmask_b32_e64 v100, v100, v101, s[98:99]
  v_cndmask_b32_e64 v102, v102, v103, s[98:99]
  s_mov_b32 s98, 0xcccccccc
  s_mov_b32 s99, 0xcccccccc
  v_cndmask_b32_e64 v97, v100, v102, s[98:99]
  v_add_f32_dpp v96, v96, v96 quad_perm:[1,0,3,2] row_mask:0xf bank_mask:0xf
  s_nop 0
  v_add_f32_dpp v97, v97, v97 quad_perm:[1,0,3,2] row_mask:0xf bank_mask:0xf
  s_branch L_159
L_158:
  s_waitcnt vmcnt(0)
  v_add_f32 v96, v96, v100
  v_add_f32 v97, v97, v101
  v_add_f32 v98, v98, v102
  v_add_f32 v99, v99, v103
  v_add_f32 v96, v96, v98
  v_add_f32 v97, v97, v99
  s_nop 0
  v_add_f32_dpp v96, v96, v96 row_ror:8 row_mask:0xf bank_mask:0xf
  v_add_f32_dpp v97, v97, v97 row_ror:8 row_mask:0xf bank_mask:0xf
  v_mov_b32 v98, v96
  v_mov_b32 v99, v97
  s_nop 0
  v_permlane16_swap_b32 v96, v98
  v_permlane16_swap_b32 v97, v99
  v_add_f32 v96, v96, v98
  v_add_f32 v97, v97, v99
  v_mov_b32 v98, v96
  v_mov_b32 v99, v97
  s_nop 0
  v_permlane32_swap_b32 v96, v98
  v_permlane32_swap_b32 v97, v99
  v_add_f32 v96, v96, v98
  v_add_f32 v97, v97, v99
L_159:
  v_mul_f32 v96, 0x3a800000, v96
  v_mul_f32 v97, 0x3a800000, v97
  v_fma_f32 v98, -v96, v96, v97
  v_max_f32_e64 v98, 0, v98
  v_add_f32 v98, 0x3727c5ac, v98
  v_rsq_f32_e64 v98, v98
  v_mov_b32 v99, v96
  s_mov_b64 exec, s[8:9]
  buffer_store_dwordx2 v[98:99], v6, s[40:43], s10 offen sc0 sc1
  s_mov_b64 exec, -1
  s_barrier
  s_cmp_lg_u32 s82, 0
  s_cbranch_scc1 L_160
  v_lshlrev_b32_e64 v6, 3, v1
  s_mov_b64 s[8:9], 0xff
  s_lshl_b32 s91, s84, Lz1-Lz0+1
  s_and_b32 s91, s91, 0x8f000
  s_add_u32 s91, s91, 1835008
  s_mov_b32 exec_lo, 0xffff
  s_mov_b32 exec_hi, Lz1-Lz0+0
  buffer_load_dword v7, v5, s[40:43], s91 offen sc0 sc1
  s_mov_b64 exec, -1
L_160:
  s_barrier
  s_barrier
  s_waitcnt vmcnt(0)
  s_and_b32 s5, s10, 0xfffffc00
  buffer_load_dwordx4 v[120:123], v4, s[40:43], s5 offen sc1
  s_cmp_lg_u32 s82, 0
  s_cbranch_scc1 L_162
  s_mov_b32 s89, 200000
  s_mov_b32 exec_lo, 0xffff
  s_mov_b32 exec_hi, 0
  s_branch Lp_165
Lp_164:
  buffer_load_dword v7, v5, s[40:43], s91 offen sc0 sc1
  s_waitcnt vmcnt(0)
Lp_165:
  v_cmp_ne_u32 vcc, 0, v7
  s_andn2_b32 s3, 0xffff, vcc_lo
  s_cbranch_scc0 Lp_166
  s_sleep 1
  s_sub_u32 s89, s89, 1
  s_cbranch_scc0 Lp_164
Lp_166:
  s_mov_b64 exec, -1
  s_lshl_b32 s5, s77, 14
  s_add_u32 s5, s5, 1114112
  buffer_load_dwordx4 v[192:195], v4, s[40:43], s5 offen offset:0 sc1
  buffer_load_dwordx4 v[196:199], v4, s[40:43], s5 offen offset:1024 sc1
  buffer_load_dwordx4 v[200:203], v4, s[40:43], s5 offen offset:2048 sc1
  buffer_load_dwordx4 v[204:207], v4, s[40:43], s5 offen offset:3072 sc1
  s_add_u32 s5, s5, 4096
  buffer_load_dwordx4 v[208:211], v4, s[40:43], s5 offen offset:0 sc1
  buffer_load_dwordx4 v[212:215], v4, s[40:43], s5 offen offset:1024 sc1
  buffer_load_dwordx4 v[216:219], v4, s[40:43], s5 offen offset:2048 sc1
  buffer_load_dwordx4 v[220:223], v4, s[40:43], s5 offen offset:3072 sc1
L_162:
  s_barrier
  s_cmp_lg_u32 s82, 0
  s_cbranch_scc1 L_167
  s_lshl_b32 s5, s77, 14
  s_add_u32 s5, s5, 1122304
  buffer_load_dwordx4 v[224:227], v4, s[40:43], s5 offen offset:0 sc1
  buffer_load_dwordx4 v[228:231], v4, s[40:43], s5 offen offset:1024 sc1
  buffer_load_dwordx4 v[232:235], v4, s[40:43], s5 offen offset:2048 sc1
  buffer_load_dwordx4 v[236:239], v4, s[40:43], s5 offen offset:3072 sc1
  s_add_u32 s5, s5, 4096
  buffer_load_dwordx4 v[240:243], v4, s[40:43], s5 offen offset:0 sc1
  buffer_load_dwordx4 v[244:247], v4, s[40:43], s5 offen offset:1024 sc1
  buffer_load_dwordx4 v[248:251], v4, s[40:43], s5 offen offset:2048 sc1
  buffer_load_dwordx4 v[252:255], v4, s[40:43], s5 offen offset:3072 sc1
L_167:
  s_barrier
  s_cmp_lg_u32 s82, 0
  s_cbranch_scc1 L_169
  s_waitcnt vmcnt(16)
  s_branch L_170
L_169:
  s_waitcnt vmcnt(0)
L_170:
  s_mov_b32 s89, 200000
  s_branch Lp_172
  s_nop 0
Lp_171:
  s_and_b32 s5, s10, 0xfffffc00
  buffer_load_dwordx4 v[120:123], v4, s[40:43], s5 offen sc1
  s_waitcnt vmcnt(0)
Lp_172:
  v_min_u32 v2, v120, v122
  v_cmp_eq_u32 vcc, 0, v2
  s_cmp_eq_u64 vcc, 0
  s_cbranch_scc1 Lp_173
  s_sleep 1
  s_sub_u32 s89, s89, 1
  s_cbranch_scc0 Lp_171
Lp_173:
  s_and_b32 s5, s10, 0xfffffc00
  s_mov_b32 m0, 151552
  s_nop 0
  buffer_load_dword v6, s[40:43], s5 offen offset:0 sc1 lds
  s_mov_b32 m0, 152188
  s_nop 0
  buffer_load_dword v6, s[40:43], s5 offen offset:4 sc1 lds
  s_mov_b32 m0, 151360
  s_nop 0
  buffer_load_dword v6, s[40:43], s5 offen offset:512 sc1 lds
  s_mov_b32 m0, 151996
  s_nop 0
  buffer_load_dword v6, s[40:43], s5 offen offset:516 sc1 lds
  s_add_u32 s10, s10, 16384
  s_cmp_lg_u32 s82, 0
  s_cbranch_scc1 L_174
  s_waitcnt vmcnt(12)
  v_add_f32 v192, v192, v208
  v_add_f32 v193, v193, v209
  v_add_f32 v194, v194, v210
  v_add_f32 v195, v195, v211
  v_add_f32 v196, v196, v212
  v_add_f32 v197, v197, v213
  v_add_f32 v198, v198, v214
  v_add_f32 v199, v199, v215
  v_add_f32 v200, v200, v216
  v_add_f32 v201, v201, v217
  v_add_f32 v202, v202, v218
  v_add_f32 v203, v203, v219
  v_add_f32 v204, v204, v220
  v_add_f32 v205, v205, v221
  v_add_f32 v206, v206, v222
  v_add_f32 v207, v207, v223
  v_add_f32 v192, v192, v200
  v_add_f32 v193, v193, v201
  v_add_f32 v194, v194, v202
  v_add_f32 v195, v195, v203
  v_add_f32 v196, v196, v204
  v_add_f32 v197, v197, v205
  v_add_f32 v198, v198, v206
  v_add_f32 v199, v199, v207
  v_add_f32 v192, v192, v196
  v_add_f32 v193, v193, v197
  v_add_f32 v194, v194, v198
  v_add_f32_e64 v195, v195, v199
L_174:
  s_cmp_lg_u32 s82, 0
  s_cbranch_scc1 L_176
  buffer_load_dword v109, v110, s[56:59], s12 offen
  s_sub_u32 s12, s12, 8192
L_176:
  s_barrier
  s_cmp_lg_u32 s82, 0
  s_cbranch_scc1 L_178
  s_cmp_lg_u32 s82, 0
  s_cbranch_scc1 L_180
  s_waitcnt vmcnt(1)
  s_branch L_181
L_180:
  s_waitcnt vmcnt(0)
L_181:
  v_add_f32 v224, v224, v240
  v_add_f32 v225, v225, v241
  v_add_f32 v226, v226, v242
  v_add_f32 v227, v227, v243
  v_add_f32 v228, v228, v244
  v_add_f32 v229, v229, v245
  v_add_f32 v230, v230, v246
  v_add_f32 v231, v231, v247
  v_add_f32 v232, v232, v248
  v_add_f32 v233, v233, v249
  v_add_f32 v234, v234, v250
  v_add_f32 v235, v235, v251
  v_add_f32 v236, v236, v252
  v_add_f32 v237, v237, v253
  v_add_f32 v238, v238, v254
  v_add_f32 v239, v239, v255
  v_add_f32 v224, v224, v232
  v_add_f32 v225, v225, v233
  v_add_f32 v226, v226, v234
  v_add_f32 v227, v227, v235
  v_add_f32 v228, v228, v236
  v_add_f32 v229, v229, v237
  v_add_f32 v230, v230, v238
  v_add_f32 v231, v231, v239
  v_add_f32 v224, v224, v228
  v_add_f32 v225, v225, v229
  v_add_f32 v226, v226, v230
  v_add_f32 v227, v227, v231
  v_add_f32 v192, v192, v224
  v_add_f32 v193, v193, v225
  v_add_f32 v194, v194, v226
  v_add_f32 v195, v195, v227
  v_add_u32 v2, 153088, v4
  ds_write_b128 v2, v[192:195]
L_178:
  s_cmp_lg_u32 s82, 0
  s_cbranch_scc1 L_182
  buffer_load_dword v109, v110, s[56:59], s12 offen
  s_sub_u32 s12, s12, 8192
L_182:
  s_barrier
  s_cmp_lg_u32 s82, 0
  s_cbranch_scc1 L_184
  s_waitcnt vmcnt(2)
  s_branch L_185
  s_nop 0
L_184:
  s_waitcnt vmcnt(0)
L_185:
  s_waitcnt lgkmcnt(0)
  s_barrier
  s_cmp_lg_u32 s82, 0
  s_cbranch_scc1 L_186
  v_lshlrev_b32 v2, 2, v1
  v_add_u32 v2, 155136, v2
  v_lshlrev_b32_e64 v104, 16, v104
  v_mul_f32 v104, 0x3eeff558, v104
  ds_write_b32 v2, v104 offset:0
  v_lshlrev_b32_e64 v105, 16, v105
  v_mul_f32 v105, 0x3eeff558, v105
  ds_write_b32 v2, v105 offset:256
  v_lshlrev_b32_e64 v106, 16, v106
  v_mul_f32 v106, 0x3eeff558, v106
  ds_write_b32 v2, v106 offset:512
  v_lshlrev_b32_e64 v107, 16, v107
  v_mul_f32 v107, 0x3eeff558, v107
  ds_write_b32 v2, v107 offset:768
  v_lshlrev_b32_e64 v108, 16, v108
  ds_write_b32 v2, v108 offset:1024
  v_lshrrev_b32 v2, 2, v1
  v_lshlrev_b32 v22, 7, v2
  v_lshlrev_b32 v96, 6, v2
  v_and_b32 v2, 3, v1
  v_lshl_add_u32 v22, v2, 3, v22
  v_lshl_add_u32 v96, v2, 3, v96
  v_add_u32 v22, 65536, v22
  v_add_u32 v96, 90112, v96
  v_bfe_u32 v3, v1, 3, 2
  v_xor_b32_e64 v2, 0, v3
  v_lshl_add_u32 v16, v2, 5, v22
  v_xor_b32_e64 v2, 1, v3
  v_lshl_add_u32 v17, v2, 5, v22
  v_xor_b32_e64 v2, 2, v3
  v_lshl_add_u32 v18, v2, 5, v22
  v_xor_b32_e64 v2, 3, v3
  v_lshl_add_u32 v19, v2, 5, v22
  v_bfe_u32 v3, v1, 4, 1
  v_xor_b32_e64 v2, 0, v3
  v_lshl_add_u32 v20, v2, 5, v96
  v_xor_b32_e64 v2, 1, v3
  v_lshl_add_u32 v21, v2, 5, v96
  v_mov_b32 v22, 0x3f803f80
  s_mov_b32 s98, 0x00010001
  s_mov_b32 s99, 0x00010001
  v_cndmask_b32_e64 v200, 0, v22, s[98:99]
  v_cndmask_b32_e64 v201, 0, v22, s[98:99]
  v_cndmask_b32_e64 v202, 0, v22, s[98:99]
  v_cndmask_b32_e64 v203, 0, v22, s[98:99]
  s_nop 0
  s_lshl_b64 s[98:99], s[98:99], 1
  v_cndmask_b32_e64 v204, 0, v22, s[98:99]
  v_cndmask_b32_e64 v205, 0, v22, s[98:99]
  v_cndmask_b32_e64 v206, 0, v22, s[98:99]
  v_cndmask_b32_e64 v207, 0, v22, s[98:99]
  s_nop 0
  s_lshl_b64 s[98:99], s[98:99], 1
  v_cndmask_b32_e64 v208, 0, v22, s[98:99]
  v_cndmask_b32_e64 v209, 0, v22, s[98:99]
  v_cndmask_b32_e64 v210, 0, v22, s[98:99]
  v_cndmask_b32_e64 v211, 0, v22, s[98:99]
  s_nop 0
  s_lshl_b64 s[98:99], s[98:99], 1
  v_cndmask_b32_e64 v212, 0, v22, s[98:99]
  v_cndmask_b32_e64 v213, 0, v22, s[98:99]
  v_cndmask_b32_e64 v214, 0, v22, s[98:99]
  v_cndmask_b32_e64 v215, 0, v22, s[98:99]
  s_nop 0
  s_lshl_b64 s[98:99], s[98:99], 1
  v_cndmask_b32_e64 v216, 0, v22, s[98:99]
  v_cndmask_b32_e64 v217, 0, v22, s[98:99]
  v_cndmask_b32_e64 v218, 0, v22, s[98:99]
  v_cndmask_b32_e64 v219, 0, v22, s[98:99]
  s_nop 0
  s_lshl_b64 s[98:99], s[98:99], 1
  v_cndmask_b32_e64 v220, 0, v22, s[98:99]
  v_cndmask_b32_e64 v221, 0, v22, s[98:99]
  v_cndmask_b32_e64 v222, 0, v22, s[98:99]
  v_cndmask_b32_e64 v223, 0, v22, s[98:99]
  s_nop 0
  s_lshl_b64 s[98:99], s[98:99], 1
  v_cndmask_b32_e64 v224, 0, v22, s[98:99]
  v_cndmask_b32_e64 v225, 0, v22, s[98:99]
  v_cndmask_b32_e64 v226, 0, v22, s[98:99]
  v_cndmask_b32_e64 v227, 0, v22, s[98:99]
  s_nop 0
  s_lshl_b64 s[98:99], s[98:99], 1
  v_cndmask_b32_e64 v228, 0, v22, s[98:99]
  v_cndmask_b32_e64 v229, 0, v22, s[98:99]
  v_cndmask_b32_e64 v230, 0, v22, s[98:99]
  v_cndmask_b32_e64 v231, 0, v22, s[98:99]
  s_nop 0
  s_lshl_b64 s[98:99], s[98:99], 1
  v_cndmask_b32_e64 v232, 0, v22, s[98:99]
  v_cndmask_b32_e64 v233, 0, v22, s[98:99]
  v_cndmask_b32_e64 v234, 0, v22, s[98:99]
  v_cndmask_b32_e64 v235, 0, v22, s[98:99]
  s_nop 0
  s_lshl_b64 s[98:99], s[98:99], 1
  v_cndmask_b32_e64 v236, 0, v22, s[98:99]
  v_cndmask_b32_e64 v237, 0, v22, s[98:99]
  v_cndmask_b32_e64 v238, 0, v22, s[98:99]
  v_cndmask_b32_e64 v239, 0, v22, s[98:99]
  s_nop 0
  s_lshl_b64 s[98:99], s[98:99], 1
  v_cndmask_b32_e64 v240, 0, v22, s[98:99]
  v_cndmask_b32_e64 v241, 0, v22, s[98:99]
  v_cndmask_b32_e64 v242, 0, v22, s[98:99]
  v_cndmask_b32_e64 v243, 0, v22, s[98:99]
  s_nop 0
  s_lshl_b64 s[98:99], s[98:99], 1
  v_cndmask_b32_e64 v244, 0, v22, s[98:99]
  v_cndmask_b32_e64 v245, 0, v22, s[98:99]
  v_cndmask_b32_e64 v246, 0, v22, s[98:99]
  v_cndmask_b32_e64 v247, 0, v22, s[98:99]
  s_nop 0
  s_lshl_b64 s[98:99], s[98:99], 1
  v_cndmask_b32_e64 v248, 0, v22, s[98:99]
  v_cndmask_b32_e64 v249, 0, v22, s[98:99]
  v_cndmask_b32_e64 v250, 0, v22, s[98:99]
  v_cndmask_b32_e64 v251, 0, v22, s[98:99]
  s_nop 0
  s_lshl_b64 s[98:99], s[98:99], 1
  v_cndmask_b32_e64 v252, 0, v22, s[98:99]
  v_cndmask_b32_e64 v253, 0, v22, s[98:99]
  v_cndmask_b32_e64 v254, 0, v22, s[98:99]
  v_cndmask_b32_e64 v255, 0, v22, s[98:99]
  s_lshl_b64 s[98:99], s[98:99], 1
L_186:
  s_lshl_b32 s91, s84, Lz1-Lz0+1
  s_add_u32 s91, s91, s87
  s_barrier
  s_barrier
  s_mov_b32 exec_lo, 0xf7f7
  s_mov_b32 exec_hi, 0
  buffer_load_dword v7, v5, s[40:43], s91 offen sc0 sc1
  s_mov_b64 exec, -1
  s_barrier
  s_barrier
  s_barrier
  s_waitcnt vmcnt(0)
  s_mov_b32 s89, 200000
  s_mov_b32 exec_lo, 0xf7f7
  s_mov_b32 exec_hi, 0
  s_branch Lp_189
Lp_188:
  buffer_load_dword v7, v5, s[40:43], s91 offen sc0 sc1
  s_waitcnt vmcnt(0)
Lp_189:
  v_cmp_ne_u32 vcc, 0, v7
  s_andn2_b32 s3, 0xf7f7, vcc_lo
  s_cbranch_scc0 Lp_190
  s_sleep 1
  s_sub_u32 s89, s89, Lz1-Lz0+1
  s_cbranch_scc0 Lp_188
Lp_190:
  s_mov_b64 exec, -1
  s_barrier
  s_barrier
  s_mov_b32 exec_lo, 0x808
  s_mov_b32 exec_hi, Lz1-Lz0+0
  buffer_load_dword v7, v5, s[40:43], s91 offen sc0 sc1
  s_mov_b64 exec, -1
  s_barrier
  s_barrier
  s_barrier
  s_barrier
  s_waitcnt vmcnt(0)
  s_mov_b32 s89, 200000
  s_mov_b32 exec_lo, 0x808
  s_mov_b32 exec_hi, 0
  s_branch Lp_192
Lp_191:
  buffer_load_dword v7, v5, s[40:43], s91 offen sc0 sc1
  s_waitcnt vmcnt(0)
Lp_192:
  v_cmp_ne_u32 vcc, 0, v7
  s_andn2_b32 s3, 0x808, vcc_lo
  s_cbranch_scc0 Lp_193
  s_sleep 1
  s_sub_u32 s89, s89, Lz1-Lz0+1
  s_cbranch_scc0 Lp_191
Lp_193:
  s_mov_b64 exec, -1
  s_barrier
  s_barrier
  s_barrier
  s_barrier
  s_barrier
  s_barrier
  s_add_u32 s92, s83, 31457280
  s_add_u32 s91, s91, 4
  s_sub_u32 s16, s78, s76
  s_add_u32 s16, s16, 1
  s_and_b32 s16, s16, 15
  s_barrier
  s_cmp_lg_u32 s82, 0
  s_cbranch_scc1 L_194
  s_cmp_eq_u32 s16, 1
  s_cselect_b32 s4, 0, 28672
  v_add_u32 v112, s4, v16
  v_add_u32 v113, s4, v17
  v_add_u32 v114, s4, v18
  v_add_u32 v115, s4, v19
  v_add_u32 v116, s4, v20
  v_add_u32 v117, s4, v21
  ds_read_b64_tr_b16 v[32:33], v112 offset:0
  ds_read_b64_tr_b16 v[34:35], v112 offset:2048
  ds_read_b64_tr_b16 v[36:37], v113 offset:0
  ds_read_b64_tr_b16 v[38:39], v113 offset:2048
  ds_read_b64_tr_b16 v[40:41], v114 offset:0
  ds_read_b64_tr_b16 v[42:43], v114 offset:2048
  ds_read_b64_tr_b16 v[44:45], v115 offset:0
  ds_read_b64_tr_b16 v[46:47], v115 offset:2048
  ds_read_b64_tr_b16 v[48:49], v112 offset:4096
  ds_read_b64_tr_b16 v[50:51], v112 offset:6144
  ds_read_b64_tr_b16 v[52:53], v113 offset:4096
  ds_read_b64_tr_b16 v[54:55], v113 offset:6144
  s_nop 0
  s_waitcnt lgkmcnt(6)
  ds_read_b64_tr_b16 v[56:57], v114 offset:4096
  ds_read_b64_tr_b16 v[58:59], v114 offset:6144
  ds_read_b64_tr_b16 v[60:61], v115 offset:4096
  ds_read_b64_tr_b16 v[62:63], v115 offset:6144
  s_nop 0
  s_waitcnt lgkmcnt(6)
  ds_read_b64_tr_b16 v[64:65], v112 offset:8192
  ds_read_b64_tr_b16 v[66:67], v112 offset:10240
  ds_read_b64_tr_b16 v[68:69], v113 offset:8192
  ds_read_b64_tr_b16 v[70:71], v113 offset:10240
  ds_read_b64_tr_b16 v[72:73], v114 offset:8192
  ds_read_b64_tr_b16 v[74:75], v114 offset:10240
  ds_read_b64_tr_b16 v[76:77], v115 offset:8192
  ds_read_b64_tr_b16 v[78:79], v115 offset:10240
  s_nop 0
  s_waitcnt lgkmcnt(8)
  v_mfma_f32_16x16x32_bf16 v[28:31], v[32:35], v[200:203], 0
  v_mfma_f32_16x16x32_bf16 v[28:31], v[36:39], v[204:207], v[28:31]
  v_mfma_f32_16x16x32_bf16 v[28:31], v[40:43], v[208:211], v[28:31]
  v_mfma_f32_16x16x32_bf16 v[28:31], v[44:47], v[212:215], v[28:31]
  v_mfma_f32_16x16x32_bf16 v[28:31], v[48:51], v[200:203], v[28:31]
  v_mfma_f32_16x16x32_bf16 v[28:31], v[52:55], v[204:207], v[28:31]
  v_mfma_f32_16x16x32_bf16 v[28:31], v[56:59], v[208:211], v[28:31]
  v_mfma_f32_16x16x32_bf16 v[28:31], v[60:63], v[212:215], v[28:31]
  s_nop 0
  s_waitcnt lgkmcnt(7)
  ds_read_b64_tr_b16 v[80:81], v112 offset:12288
  ds_read_b64_tr_b16 v[82:83], v112 offset:14336
  ds_read_b64_tr_b16 v[84:85], v113 offset:12288
  ds_read_b64_tr_b16 v[86:87], v113 offset:14336
  ds_read_b64_tr_b16 v[88:89], v114 offset:12288
  ds_read_b64_tr_b16 v[90:91], v114 offset:14336
  ds_read_b64_tr_b16 v[92:93], v115 offset:12288
  ds_read_b64_tr_b16 v[94:95], v115 offset:14336
  s_nop 0
  s_waitcnt lgkmcnt(6)
  ds_read_b64_tr_b16 v[128:129], v112 offset:16384
  ds_read_b64_tr_b16 v[130:131], v112 offset:18432
  ds_read_b64_tr_b16 v[132:133], v113 offset:16384
  ds_read_b64_tr_b16 v[134:135], v113 offset:18432
  ds_read_b64_tr_b16 v[136:137], v114 offset:16384
  ds_read_b64_tr_b16 v[138:139], v114 offset:18432
  ds_read_b64_tr_b16 v[140:141], v115 offset:16384
  ds_read_b64_tr_b16 v[142:143], v115 offset:18432
  s_nop 0
  s_waitcnt lgkmcnt(8)
  v_mfma_f32_16x16x32_bf16 v[28:31], v[64:67], v[216:219], v[28:31]
  v_mfma_f32_16x16x32_bf16 v[28:31], v[68:71], v[220:223], v[28:31]
  v_mfma_f32_16x16x32_bf16 v[28:31], v[72:75], v[224:227], v[28:31]
  v_mfma_f32_16x16x32_bf16 v[28:31], v[76:79], v[228:231], v[28:31]
  v_mfma_f32_16x16x32_bf16 v[28:31], v[80:83], v[216:219], v[28:31]
  v_mfma_f32_16x16x32_bf16 v[28:31], v[84:87], v[220:223], v[28:31]
  v_mfma_f32_16x16x32_bf16 v[28:31], v[88:91], v[224:227], v[28:31]
  v_mfma_f32_16x16x32_bf16 v[28:31], v[92:95], v[228:231], v[28:31]
  s_nop 0
  s_waitcnt lgkmcnt(7)
  ds_read_b64_tr_b16 v[144:145], v112 offset:20480
  ds_read_b64_tr_b16 v[146:147], v112 offset:22528
  ds_read_b64_tr_b16 v[148:149], v113 offset:20480
  ds_read_b64_tr_b16 v[150:151], v113 offset:22528
  ds_read_b64_tr_b16 v[152:153], v114 offset:20480
  ds_read_b64_tr_b16 v[154:155], v114 offset:22528
  ds_read_b64_tr_b16 v[156:157], v115 offset:20480
  ds_read_b64_tr_b16 v[158:159], v115 offset:22528
  s_nop 0
  s_waitcnt lgkmcnt(6)
  ds_read_b64_tr_b16 v[160:161], v116 offset:0
  ds_read_b64_tr_b16 v[162:163], v116 offset:1024
  ds_read_b64_tr_b16 v[164:165], v117 offset:0
  ds_read_b64_tr_b16 v[166:167], v117 offset:1024
  ds_read_b64_tr_b16 v[176:177], v116 offset:2048
  ds_read_b64_tr_b16 v[178:179], v116 offset:3072
  ds_read_b64_tr_b16 v[180:181], v117 offset:2048
  ds_read_b64_tr_b16 v[182:183], v117 offset:3072
  s_nop 0
  s_waitcnt lgkmcnt(8)
  v_mfma_f32_16x16x32_bf16 v[28:31], v[128:131], v[232:235], v[28:31]
  v_mfma_f32_16x16x32_bf16 v[28:31], v[132:135], v[236:239], v[28:31]
  v_mfma_f32_16x16x32_bf16 v[28:31], v[136:139], v[240:243], v[28:31]
  v_mfma_f32_16x16x32_bf16 v[28:31], v[140:143], v[244:247], v[28:31]
  v_mfma_f32_16x16x32_bf16 v[28:31], v[144:147], v[232:235], v[28:31]
  v_mfma_f32_16x16x32_bf16 v[28:31], v[148:151], v[236:239], v[28:31]
  v_mfma_f32_16x16x32_bf16 v[28:31], v[152:155], v[240:243], v[28:31]
  v_mfma_f32_16x16x32_bf16 v[28:31], v[156:159], v[244:247], v[28:31]
  s_waitcnt lgkmcnt(7)
  s_waitcnt lgkmcnt(0)
  v_mfma_f32_16x16x32_bf16 v[28:31], v[160:163], v[248:251], v[28:31]
  v_mfma_f32_16x16x32_bf16 v[28:31], v[164:167], v[252:255], v[28:31]
  v_mfma_f32_16x16x32_bf16 v[28:31], v[176:179], v[248:251], v[28:31]
  v_mfma_f32_16x16x32_bf16 v[28:31], v[180:183], v[252:255], v[28:31]
  s_lshl_b32 s5, s77, Lz1-Lz0+14
  s_lshl_b32 s4, s76, 10
  s_add_u32 s5, s5, s4
  s_add_u32 s5, s5, 1376256
  s_nop 3
  buffer_store_dwordx4 v[28:31], v15, s[40:43], s5 offen sc0 sc1
L_194:
  s_barrier
  s_mov_b32 exec_lo, 0xffff
  s_mov_b32 exec_hi, 0
  buffer_load_dword v7, v5, s[40:43], s91 offen sc0 sc1
  s_mov_b64 exec, -1
  s_barrier
  s_waitcnt vmcnt(0)
  s_mov_b32 s89, 200000
  s_mov_b32 exec_lo, 0xffff
  s_mov_b32 exec_hi, 0
  s_branch Lp_197
Lp_196:
  buffer_load_dword v7, v5, s[40:43], s91 offen sc0 sc1
  s_waitcnt vmcnt(0)
Lp_197:
  v_cmp_ne_u32 vcc, 0, v7
  s_andn2_b32 s3, 0xffff, vcc_lo
  s_cbranch_scc0 Lp_198
  s_sleep 1
  s_sub_u32 s89, s89, Lz1-Lz0+1
  s_cbranch_scc0 Lp_196
Lp_198:
  s_mov_b64 exec, -1
  s_cmp_lg_u32 s82, 0
  s_cbranch_scc1 L_199
  s_mov_b32 s5, 1835012
  s_mov_b64 exec, 0x101
  buffer_store_dword v11, v14, s[40:43], s5 offen sc0 sc1
  s_mov_b64 exec, -1
L_199:
  s_add_u32 s5, s84, s92
  buffer_load_dwordx2 v[96:97], v6, s[40:43], s5 offen offset:0 sc1
  buffer_load_dwordx2 v[98:99], v6, s[40:43], s5 offen offset:512 sc1
  buffer_load_dwordx2 v[100:101], v6, s[40:43], s5 offen offset:1024 sc1
  buffer_load_dwordx2 v[102:103], v6, s[40:43], s5 offen offset:1536 sc1
  s_barrier
  s_barrier
  s_barrier
  s_waitcnt vmcnt(0)
  v_add_f32 v96, v96, v100
  v_add_f32 v97, v97, v101
  v_add_f32 v98, v98, v102
  v_add_f32 v99, v99, v103
  v_add_f32_e64 v96, v96, v98
  v_add_f32 v97, v97, v99
  s_nop 0
  v_add_f32_dpp v96, v96, v96 row_ror:8 row_mask:0xf bank_mask:0xf
  v_add_f32_dpp v97, v97, v97 row_ror:8 row_mask:0xf bank_mask:0xf
  v_mov_b32 v98, v96
  v_mov_b32 v99, v97
  s_nop 0
  v_permlane16_swap_b32 v96, v98
  v_permlane16_swap_b32 v97, v99
  v_add_f32 v96, v96, v98
  v_add_f32 v97, v97, v99
  v_mov_b32 v98, v96
  v_mov_b32 v99, v97
  s_nop 0
  v_permlane32_swap_b32 v96, v98
  v_permlane32_swap_b32 v97, v99
  v_add_f32 v96, v96, v98
  v_add_f32 v97, v97, v99
  v_mul_f32 v96, 0x3a800000, v96
  v_mul_f32 v97, 0x3a800000, v97
  v_fma_f32 v98, -v96, v96, v97
  v_max_f32_e64 v98, 0, v98
  v_add_f32 v98, 0x3727c5ac, v98
  v_rsq_f32_e64 v98, v98
  v_mov_b32 v99, v96
  s_mov_b64 exec, s[8:9]
  buffer_store_dwordx2 v[98:99], v6, s[40:43], s10 offen sc0 sc1
  s_mov_b64 exec, -1
  s_barrier
  s_barrier
  s_barrier
  s_barrier
  s_barrier
  s_cmp_lg_u32 s82, 0
  s_cbranch_scc1 L_201
  s_lshl_b32 s91, s84, Lz1-Lz0+1
  s_and_b32 s91, s91, 0x8f000
  s_add_u32 s91, s91, 1835012
  s_mov_b32 exec_lo, 0xffff
  s_mov_b32 exec_hi, 0
  buffer_load_dword v7, v5, s[40:43], s91 offen sc0 sc1
  s_mov_b64 exec, -1
L_201:
  s_and_b32 s5, s10, 0xfffffc00
  buffer_load_dwordx4 v[120:123], v4, s[40:43], s5 offen sc1
  s_barrier
  s_barrier
  s_waitcnt vmcnt(0)
  s_mov_b32 s89, 200000
  s_branch Lp_204
Lp_203:
  s_and_b32 s5, s10, 0xfffffc00
  buffer_load_dwordx4 v[120:123], v4, s[40:43], s5 offen sc1
  s_waitcnt vmcnt(0)
Lp_204:
  v_min_u32 v2, v120, v122
  v_cmp_eq_u32 vcc, 0, v2
  s_cmp_eq_u64 vcc, 0
  s_cbranch_scc1 Lp_205
  s_sleep 1
  s_sub_u32 s89, s89, 1
  s_cbranch_scc0 Lp_203
Lp_205:
  s_and_b32 s5, s10, 0xfffffc00
  s_mov_b32 m0, 151552
  s_nop 0
  buffer_load_dword v6, s[40:43], s5 offen offset:0 sc1 lds
  s_mov_b32 m0, 152188
  s_nop 0
  buffer_load_dword v6, s[40:43], s5 offen offset:4 sc1 lds
  s_mov_b32 m0, 151360
  s_nop 0
  buffer_load_dword v6, s[40:43], s5 offen offset:512 sc1 lds
  s_mov_b32 m0, 151996
  s_nop 0
  buffer_load_dword v6, s[40:43], s5 offen offset:516 sc1 lds
  s_add_u32 s10, s10, 16384
  s_barrier
  s_cmp_lg_u32 s82, Lz1-Lz0+0
  s_cbranch_scc1 L_206
  s_mov_b32 s89, 200000
  s_mov_b32 exec_lo, 0xffff
  s_mov_b32 exec_hi, 0
  s_branch Lp_209
Lp_208:
  buffer_load_dword v7, v5, s[40:43], s91 offen sc0 sc1
  s_waitcnt vmcnt(0)
Lp_209:
  v_cmp_ne_u32 vcc, 0, v7
  s_andn2_b32 s3, 0xffff, vcc_lo
  s_cbranch_scc0 Lp_210
  s_sleep 1
  s_sub_u32 s89, s89, 1
  s_cbranch_scc0 Lp_208
Lp_210:
  s_mov_b64 exec, -1
  s_lshl_b32 s5, s77, 14
  s_add_u32 s5, s5, 1376256
  buffer_load_dwordx4 v[192:195], v4, s[40:43], s5 offen offset:0 sc1
  buffer_load_dwordx4 v[196:199], v4, s[40:43], s5 offen offset:1024 sc1
  buffer_load_dwordx4 v[200:203], v4, s[40:43], s5 offen offset:2048 sc1
  buffer_load_dwordx4 v[204:207], v4, s[40:43], s5 offen offset:3072 sc1
  s_add_u32 s5, s5, 4096
  buffer_load_dwordx4 v[208:211], v4, s[40:43], s5 offen offset:0 sc1
  buffer_load_dwordx4 v[212:215], v4, s[40:43], s5 offen offset:1024 sc1
  buffer_load_dwordx4 v[216:219], v4, s[40:43], s5 offen offset:2048 sc1
  buffer_load_dwordx4 v[220:223], v4, s[40:43], s5 offen offset:3072 sc1
  s_lshl_b32 s5, s77, Lz1-Lz0+14
  s_add_u32 s5, s5, 1384448
  buffer_load_dwordx4 v[224:227], v4, s[40:43], s5 offen offset:0 sc1
  buffer_load_dwordx4 v[228:231], v4, s[40:43], s5 offen offset:1024 sc1
  buffer_load_dwordx4 v[232:235], v4, s[40:43], s5 offen offset:2048 sc1
  buffer_load_dwordx4 v[236:239], v4, s[40:43], s5 offen offset:3072 sc1
  s_add_u32 s5, s5, 4096
  buffer_load_dwordx4 v[240:243], v4, s[40:43], s5 offen offset:0 sc1
  buffer_load_dwordx4 v[244:247], v4, s[40:43], s5 offen offset:1024 sc1
  buffer_load_dwordx4 v[248:251], v4, s[40:43], s5 offen offset:2048 sc1
  buffer_load_dwordx4 v[252:255], v4, s[40:43], s5 offen offset:3072 sc1
L_206:
  s_barrier
  s_cmp_lg_u32 s82, 0
  s_cbranch_scc1 L_211
  s_waitcnt vmcnt(8)
  v_add_f32 v192, v192, v208
  v_add_f32 v193, v193, v209
  v_add_f32 v194, v194, v210
  v_add_f32 v195, v195, v211
  v_add_f32 v196, v196, v212
  v_add_f32 v197, v197, v213
  v_add_f32 v198, v198, v214
  v_add_f32 v199, v199, v215
  v_add_f32 v200, v200, v216
  v_add_f32 v201, v201, v217
  v_add_f32 v202, v202, v218
  v_add_f32 v203, v203, v219
  v_add_f32 v204, v204, v220
  v_add_f32 v205, v205, v221
  v_add_f32 v206, v206, v222
  v_add_f32 v207, v207, v223
  v_add_f32 v192, v192, v200
  v_add_f32 v193, v193, v201
  v_add_f32 v194, v194, v202
  v_add_f32 v195, v195, v203
  v_add_f32 v196, v196, v204
  v_add_f32 v197, v197, v205
  v_add_f32 v198, v198, v206
  v_add_f32 v199, v199, v207
  v_add_f32 v192, v192, v196
  v_add_f32 v193, v193, v197
  v_add_f32 v194, v194, v198
  v_add_f32 v195, v195, v199
L_211:
  s_cmp_lg_u32 s82, 0
  s_cbranch_scc1 L_213
  buffer_load_dword v109, v110, s[60:63], s13 offen
  s_sub_u32 s13, s13, 8192
  buffer_load_dword v109, v110, s[60:63], s13 offen
  s_sub_u32 s13, s13, 8192
L_213:
  s_barrier
  s_cmp_lg_u32 s82, 0
  s_cbranch_scc1 L_215
  s_cmp_lg_u32 s82, 0
  s_cbranch_scc1 L_217
  s_waitcnt vmcnt(2)
  s_branch L_218
L_217:
  s_waitcnt vmcnt(0)
L_218:
  v_add_f32 v224, v224, v240
  v_add_f32 v225, v225, v241
  v_add_f32 v226, v226, v242
  v_add_f32 v227, v227, v243
  v_add_f32 v228, v228, v244
  v_add_f32 v229, v229, v245
  v_add_f32 v230, v230, v246
  v_add_f32 v231, v231, v247
  v_add_f32 v232, v232, v248
  v_add_f32 v233, v233, v249
  v_add_f32 v234, v234, v250
  v_add_f32 v235, v235, v251
  v_add_f32 v236, v236, v252
  v_add_f32 v237, v237, v253
  v_add_f32 v238, v238, v254
  v_add_f32 v239, v239, v255
  v_add_f32 v224, v224, v232
  v_add_f32 v225, v225, v233
  v_add_f32 v226, v226, v234
  v_add_f32 v227, v227, v235
  v_add_f32 v228, v228, v236
  v_add_f32 v229, v229, v237
  v_add_f32 v230, v230, v238
  v_add_f32 v231, v231, v239
  v_add_f32 v224, v224, v228
  v_add_f32 v225, v225, v229
  v_add_f32 v226, v226, v230
  v_add_f32 v227, v227, v231
  v_add_f32 v192, v192, v224
  v_add_f32 v193, v193, v225
  v_add_f32 v194, v194, v226
  v_add_f32 v195, v195, v227
  v_add_u32 v2, 154112, v4
  ds_write_b128 v2, v[192:195]
  s_branch L_216
  s_nop 0
L_215:
  s_waitcnt vmcnt(0)
L_216:
  s_waitcnt lgkmcnt(0)
  s_barrier
  v_lshlrev_b32 v2, 12, v1
  s_lshl_b32 s4, s76, 16
  s_lshl_b32 s5, s77, 7
  s_add_u32 s4, s4, s5
  s_add_u32 s4, s4, s87
  s_add_u32 s5, s4, 24
  s_lshl_b32 s4, s79, 3
  s_lshl_b32 s90, 0xff, s4
  s_lshl_b32 s91, s84, 1
  s_add_u32 s91, s91, s87
  s_add_u32 s91, s91, 24
  s_lshl_b32 s4, s82, 7
  s_add_u32 s4, s4, 1837056
  s_lshl_b32 s5, s84, 1
  s_add_u32 s5, s5, s4
  s_and_b32 s91, s5, 0xffff0fff
  s_barrier
  s_barrier
  s_barrier
  s_mov_b32 exec_lo, 1
  s_mov_b32 exec_hi, Lz1-Lz0+0
  buffer_store_dword v11, v2, s[40:43], s5 offen sc0 sc1
  s_mov_b64 exec, -1
  s_barrier
  s_barrier
  s_barrier
  s_mov_b32 exec_lo, s90
  s_mov_b32 exec_hi, 0
  buffer_load_dword v7, v2, s[40:43], s91 offen sc0 sc1
  s_mov_b64 exec, -1
  s_barrier
  s_waitcnt vmcnt(0)
  s_mov_b32 s89, 200000
  s_mov_b32 exec_lo, s90
  s_mov_b32 exec_hi, 0
  s_branch Lp_220
Lp_219:
  buffer_load_dword v7, v2, s[40:43], s91 offen sc0 sc1
  s_waitcnt vmcnt(0)
Lp_220:
  v_cmp_ne_u32 vcc, 0, v7
  s_andn2_b32 s3, s90, vcc_lo
  s_cbranch_scc0 Lp_221
  s_sleep 1
  s_sub_u32 s89, s89, 1
  s_cbranch_scc0 Lp_219
Lp_221:
  s_mov_b64 exec, -1
  s_xor_b32 s90, s90, 0xffff
  s_barrier
  s_barrier
  s_barrier
  s_barrier
  s_barrier
  s_barrier
  s_barrier
  s_barrier
  s_barrier
  s_barrier
  s_mov_b32 exec_lo, s90
  s_mov_b32 exec_hi, 0
  buffer_load_dword v7, v2, s[40:43], s91 offen sc0 sc1
  s_mov_b64 exec, -1
  s_barrier
  s_barrier
  s_barrier
  s_waitcnt vmcnt(0)
  s_mov_b32 s89, 200000
  s_mov_b32 exec_lo, s90
  s_mov_b32 exec_hi, 0
  s_branch Lp_223
Lp_222:
  buffer_load_dword v7, v2, s[40:43], s91 offen sc0 sc1
  s_waitcnt vmcnt(0)
Lp_223:
  v_cmp_ne_u32 vcc, 0, v7
  s_andn2_b32 s3, s90, vcc_lo
  s_cbranch_scc0 Lp_224
  s_sleep 1
  s_sub_u32 s89, s89, 1
  s_cbranch_scc0 Lp_222
Lp_224:
  s_mov_b64 exec, -1
  s_barrier
  s_barrier
  s_barrier
  s_barrier
  s_barrier
  s_barrier
  s_barrier
  s_barrier
  s_barrier
  s_barrier
  s_barrier
  s_cmp_lg_u32 s82, 0
  s_cbranch_scc1 L_lend
  s_add_u32 s92, s83, 36700160
  s_mov_b32 s82, 1
  s_mov_b32 s14, 0
  s_add_u32 s83, s83, 0
  s_add_u32 s87, s87, 32
  s_branch L_slayer
L_lend:
Lz0:
Lz1:
L_end:
  s_endpgm
.section .rodata,"a"
.p2align 6
.amdhsa_kernel mega_kernel
  .amdhsa_next_free_vgpr 256
  .amdhsa_next_free_sgpr 102
  .amdhsa_accum_offset 256
  .amdhsa_group_segment_fixed_size 0
  .amdhsa_kernarg_size 88
  .amdhsa_user_sgpr_count 2
  .amdhsa_user_sgpr_kernarg_segment_ptr 1
  .amdhsa_system_sgpr_workgroup_id_x 1
  .amdhsa_float_denorm_mode_32 3
  .amdhsa_float_denorm_mode_16_64 3
.end_amdhsa_kernel
.text
```
